```python
import torch

def _softmax(x, axis=-1):
    return torch.softmax(x, dim=axis)

def _gelu(x):
    return torch.nn.functional.gelu(x, approximate='tanh')

def _silu(x):
    return torch.nn.functional.silu(x)

def _sigmoid(x):
    return torch.sigmoid(x)

def _layernorm(x, axis=-1, eps=1e-05):
    m = x.mean(dim=axis, keepdim=True)
    v = x.var(dim=axis, keepdim=True, unbiased=False)
    return (x - m) / torch.sqrt(v + eps)

def _scatter_add(tgt, idx, src, axis=0):
    return tgt.clone().index_add_(axis, idx, src)

def _segment_sum(src, seg, n):
    out = torch.zeros((n,) + src.shape[1:], dtype=src.dtype)
    return out.index_add_(0, seg, src)

def _pad(x, pw):
    flat = tuple((v for pair in reversed(pw) for v in pair))
    return torch.nn.functional.pad(x, flat)
kernel_name = 'adaLN_cond__sliding_local_dilated__moe_arch_mod__prompt'

def setup_inputs():

    _w = lambda a: (lambda t: t.to(torch.bfloat16) if t.is_floating_point() else t)(torch.as_tensor(a))

    def _A_setup():
        B, S, D = (1, 2048, 640)
        return {'x': _w((lambda *s: torch.randn(*s, dtype=torch.bfloat16) * 0.05)(B, S, D)), 'wqkv': _w((lambda *s: torch.randn(*s, dtype=torch.bfloat16) * 0.05)(D, 3 * D)), 'wo': _w((lambda *s: torch.randn(*s, dtype=torch.bfloat16) * 0.05)(D, D))}
    _A_in = _A_setup()

    def _B_setup():
        B, S, D, F, C = (1, 2048, 640, 1728, 1)
        return {'x': _w((lambda *s: torch.randn(*s, dtype=torch.bfloat16) * 0.05)(B, S, D)), 'w_r': _w((lambda *s: torch.randn(*s, dtype=torch.bfloat16) * 3.2)(D)), 'w_gate': _w((lambda *s: torch.randn(*s, dtype=torch.bfloat16) * 0.1)(D, F)), 'w_up': _w((lambda *s: torch.randn(*s, dtype=torch.bfloat16) * 0.1)(D, F)), 'w_down': _w((lambda *s: torch.randn(*s, dtype=torch.bfloat16) * 0.1)(F, D))}
    _B_in = _B_setup()
    return {'A_x': _A_in['x'], 'A_wqkv': _A_in['wqkv'], 'A_wo': _A_in['wo'], 'B_x': _B_in['x'], 'B_w_r': _B_in['w_r'], 'B_w_gate': _B_in['w_gate'], 'B_w_up': _B_in['w_up'], 'B_w_down': _B_in['w_down'], 'c': _w((lambda *s: torch.randn(*s, dtype=torch.bfloat16) * 0.1)(1, 640) * 8.0), 'w_mod': _w((lambda *s: torch.randn(*s, dtype=torch.bfloat16) * 0.1)(640, 6 * 640) * 640 ** (-0.5) * 8.0)}

def reference(A_x, A_wqkv, A_wo, B_x, B_w_r, B_w_gate, B_w_up, B_w_down, c, w_mod):

    def _A_ref(x, wqkv, wo):
        B, S, D = x.shape
        H = 32
        Dh = D // H
        W, dil = (8, 2)
        qkv = (lambda x, *d: x.permute(*d))((x @ wqkv).reshape(B, S, 3, H, Dh), 2, 0, 3, 1, 4)
        q, k, v = (qkv[0], qkv[1], qkv[2])
        scale = Dh ** (-0.5)
        pos = torch.arange(S)
        off = torch.arange(W) * dil
        idx = pos[:, None] - off[None, :]
        mask = idx >= 0
        idx_c = torch.where(mask, idx, 0).reshape(-1)
        kg = k[:, :, idx_c, :].reshape(B, H, S, W, Dh)
        vg = v[:, :, idx_c, :].reshape(B, H, S, W, Dh)
        logits = torch.einsum('bhsd,bhswd->bhsw', q, kg) * scale
        logits = torch.where(mask[None, None, :, :], logits, -1000000000.0)
        attn = _softmax(logits, axis=-1)
        o = torch.einsum('bhsw,bhswd->bhsd', attn, vg)
        return (lambda x, *d: x.permute(*d))(o, 0, 2, 1, 3).reshape(B, S, D) @ wo

    def _B_ref(x, w_r, w_gate, w_up, w_down):
        B, S, D = x.shape
        C = 1
        r = x @ w_r
        idx = torch.argsort(-r, axis=-1)[:, :C]
        idx_e = (lambda x, n, axis: torch.repeat_interleave(x, n, dim=axis))(idx.reshape(B, C, 1), D, axis=2)
        x_sel = (lambda x, i, axis: torch.take_along_dim(x, i, dim=axis))(x, idx_e, axis=1)
        g = _silu(x_sel @ w_gate)
        u = x_sel @ w_up
        y = g * u @ w_down
        r_sel = _sigmoid((lambda x, i, axis: torch.take_along_dim(x, i, dim=axis))(r, idx, axis=1))
        y = y * r_sel.reshape(B, C, 1)
        b_off = (torch.arange(B) * S).reshape(B, 1)
        flat_idx = (idx + b_off).reshape(B * C)
        zero = (x * 0.0).reshape(B * S, D)
        upd = _scatter_add(zero, flat_idx, y.reshape(B * C, D), axis=0)
        return x + upd.reshape(B, S, D)
    x = A_x
    mod = (_silu(c) @ w_mod).reshape(c.shape[0], 6, 1, -1)
    sa, ca, ga, sb, cb, gb = (mod[:, 0].clone(), mod[:, 1].clone(), mod[:, 2].clone(), mod[:, 3].clone(), mod[:, 4].clone(), mod[:, 5].clone())
    h = _layernorm(x, axis=-1) * (1 + ca) + sa
    x = x + ga * _A_ref(h, A_wqkv, A_wo)
    h = _layernorm(x, axis=-1) * (1 + cb) + sb
    x = x + gb * _B_ref(h, B_w_r, B_w_gate, B_w_up, B_w_down)
    return x
```

```asm
; @launch kernel=mod_kernel grid=(60,1,1) block=(256,1,1) lds=16384
; @launch kernel=tw_kernel grid=(600,1,1) block=(256,1,1) lds=0
; @launch kernel=two_kernel grid=(200,1,1) block=(256,1,1) lds=0
; @launch kernel=ln1_kernel grid=(512,1,1) block=(256,1,1) lds=0
; @launch kernel=qkv_kernel grid=(960,1,1) block=(256,1,1) lds=0
; @launch kernel=attn_kernel grid=(256,1,1) block=(256,1,1) lds=0
; @launch kernel=wo_kernel grid=(320,1,1) block=(256,1,1) lds=0
; @launch kernel=ln2_kernel grid=(512,1,1) block=(256,1,1) lds=0
; @launch kernel=gu_kernel grid=(27,1,1) block=(256,1,1) lds=16384
; @launch kernel=down_kernel grid=(10,1,1) block=(256,1,1) lds=16384
.amdgcn_target "amdgcn-amd-amdhsa--gfx950"
.text
.globl mod_kernel
.p2align 8
.type mod_kernel,@function
mod_kernel:
s_cmp_ge_u32 s2, 60
s_cbranch_scc1 mod_kernel_end
s_load_dwordx2 s[4:5], s[0:1], 64
s_load_dwordx2 s[8:9], s[0:1], 72
s_load_dwordx2 s[12:13], s[0:1], 96
s_waitcnt lgkmcnt(0)
s_mov_b32 s6, 1280
s_mov_b32 s7, 0x20000
s_mov_b32 s10, 4915200
s_mov_b32 s11, 0x20000
s_mov_b32 s14, 67108864
s_mov_b32 s15, 0x20000
v_add_u32 v1, 0, v0
v_lshlrev_b32 v2, 1, v1
buffer_load_ushort v3, v2, s[4:7], 0 offen
s_waitcnt vmcnt(0)
v_lshlrev_b32 v3, 16, v3
v_mul_f32 v4, 0xbfb8aa3b, v3
v_exp_f32 v4, v4
s_nop 0
v_add_f32 v4, 1.0, v4
v_rcp_f32 v4, v4
s_nop 0
v_mul_f32 v3, v3, v4
v_cvt_pk_bf16_f32 v3, v3, v3
v_lshlrev_b32 v3, 16, v3
v_lshlrev_b32 v2, 2, v1
ds_write_b32 v2, v3
v_add_u32 v1, 256, v0
v_lshlrev_b32 v2, 1, v1
buffer_load_ushort v3, v2, s[4:7], 0 offen
s_waitcnt vmcnt(0)
v_lshlrev_b32 v3, 16, v3
v_mul_f32 v4, 0xbfb8aa3b, v3
v_exp_f32 v4, v4
s_nop 0
v_add_f32 v4, 1.0, v4
v_rcp_f32 v4, v4
s_nop 0
v_mul_f32 v3, v3, v4
v_cvt_pk_bf16_f32 v3, v3, v3
v_lshlrev_b32 v3, 16, v3
v_lshlrev_b32 v2, 2, v1
ds_write_b32 v2, v3
v_add_u32 v1, 512, v0
v_lshlrev_b32 v2, 1, v1
buffer_load_ushort v3, v2, s[4:7], 0 offen
s_waitcnt vmcnt(0)
v_lshlrev_b32 v3, 16, v3
v_mul_f32 v4, 0xbfb8aa3b, v3
v_exp_f32 v4, v4
s_nop 0
v_add_f32 v4, 1.0, v4
v_rcp_f32 v4, v4
s_nop 0
v_mul_f32 v3, v3, v4
v_cvt_pk_bf16_f32 v3, v3, v3
v_lshlrev_b32 v3, 16, v3
v_lshlrev_b32 v2, 2, v1
ds_write_b32 v2, v3
s_waitcnt lgkmcnt(0)
s_barrier
v_and_b32 v1, 31, v0
v_lshrrev_b32 v2, 5, v0
s_lshl_b32 s3, s2, 7
v_mul_u32_u24 v3, 614400, v2
v_lshl_add_u32 v3, v1, 2, v3
v_add_u32 v3, s3, v3
v_mul_u32_u24 v4, 320, v2
v_mov_b32 v10, 0
v_mov_b32 v11, 0
s_mov_b32 s40, 0
s_mov_b32 s41, 0
mod_kernel_g10:
buffer_load_dword v20, v3, s[8:11], s41 offen
s_add_u32 s41, s41, 7680
buffer_load_dword v21, v3, s[8:11], s41 offen
s_add_u32 s41, s41, 7680
buffer_load_dword v22, v3, s[8:11], s41 offen
s_add_u32 s41, s41, 7680
buffer_load_dword v23, v3, s[8:11], s41 offen
s_add_u32 s41, s41, 7680
buffer_load_dword v24, v3, s[8:11], s41 offen
s_add_u32 s41, s41, 7680
buffer_load_dword v25, v3, s[8:11], s41 offen
s_add_u32 s41, s41, 7680
buffer_load_dword v26, v3, s[8:11], s41 offen
s_add_u32 s41, s41, 7680
buffer_load_dword v27, v3, s[8:11], s41 offen
s_add_u32 s41, s41, 7680
ds_read_b128 v[32:35], v4
ds_read_b128 v[36:39], v4 offset:16
v_add_u32 v4, 32, v4
s_waitcnt vmcnt(0) lgkmcnt(0)
v_lshlrev_b32 v5, 16, v20
v_and_b32 v6, 0xffff0000, v20
v_fmac_f32 v10, v5, v32
v_fmac_f32 v11, v6, v32
v_lshlrev_b32 v5, 16, v21
v_and_b32 v6, 0xffff0000, v21
v_fmac_f32 v10, v5, v33
v_fmac_f32 v11, v6, v33
v_lshlrev_b32 v5, 16, v22
v_and_b32 v6, 0xffff0000, v22
v_fmac_f32 v10, v5, v34
v_fmac_f32 v11, v6, v34
v_lshlrev_b32 v5, 16, v23
v_and_b32 v6, 0xffff0000, v23
v_fmac_f32 v10, v5, v35
v_fmac_f32 v11, v6, v35
v_lshlrev_b32 v5, 16, v24
v_and_b32 v6, 0xffff0000, v24
v_fmac_f32 v10, v5, v36
v_fmac_f32 v11, v6, v36
v_lshlrev_b32 v5, 16, v25
v_and_b32 v6, 0xffff0000, v25
v_fmac_f32 v10, v5, v37
v_fmac_f32 v11, v6, v37
v_lshlrev_b32 v5, 16, v26
v_and_b32 v6, 0xffff0000, v26
v_fmac_f32 v10, v5, v38
v_fmac_f32 v11, v6, v38
v_lshlrev_b32 v5, 16, v27
v_and_b32 v6, 0xffff0000, v27
v_fmac_f32 v10, v5, v39
v_fmac_f32 v11, v6, v39
s_add_u32 s40, s40, 8
s_cmp_lt_u32 s40, 80
s_cbranch_scc1 mod_kernel_g10
v_lshlrev_b32 v5, 3, v0
s_barrier
ds_write_b64 v5, v[10:11] offset:8192
s_waitcnt lgkmcnt(0)
s_barrier
v_and_b32 v5, 63, v0
v_lshlrev_b32 v5, 2, v5
v_mov_b32 v10, 0
ds_read_b32 v6, v5 offset:8192
s_waitcnt lgkmcnt(0)
v_add_f32 v10, v10, v6
ds_read_b32 v6, v5 offset:8448
s_waitcnt lgkmcnt(0)
v_add_f32 v10, v10, v6
ds_read_b32 v6, v5 offset:8704
s_waitcnt lgkmcnt(0)
v_add_f32 v10, v10, v6
ds_read_b32 v6, v5 offset:8960
s_waitcnt lgkmcnt(0)
v_add_f32 v10, v10, v6
ds_read_b32 v6, v5 offset:9216
s_waitcnt lgkmcnt(0)
v_add_f32 v10, v10, v6
ds_read_b32 v6, v5 offset:9472
s_waitcnt lgkmcnt(0)
v_add_f32 v10, v10, v6
ds_read_b32 v6, v5 offset:9728
s_waitcnt lgkmcnt(0)
v_add_f32 v10, v10, v6
ds_read_b32 v6, v5 offset:9984
s_waitcnt lgkmcnt(0)
v_add_f32 v10, v10, v6
v_cvt_pk_bf16_f32 v10, v10, v10
v_lshlrev_b32 v10, 16, v10
s_mul_hi_u32 s3, s2, 0x1999999a
s_cmp_eq_u32 s3, 1
s_cbranch_scc1 mod_kernel_add1
s_cmp_eq_u32 s3, 4
s_cbranch_scc0 mod_kernel_noadd
mod_kernel_add1:
v_add_f32 v10, 1.0, v10
v_cvt_pk_bf16_f32 v10, v10, v10
v_lshlrev_b32 v10, 16, v10
mod_kernel_noadd:
s_lshl_b32 s3, s2, 8
buffer_store_dword v10, v5, s[12:15], s3 offen offset:0
s_waitcnt vmcnt(0)
mod_kernel_end:
s_endpgm
.globl tw_kernel
.p2align 8
.type tw_kernel,@function
tw_kernel:
s_cmp_ge_u32 s2, 600
s_cbranch_scc1 tw_kernel_end
s_load_dwordx2 s[4:5], s[0:1], 8
s_load_dwordx2 s[8:9], s[0:1], 96
s_waitcnt lgkmcnt(0)
s_mov_b32 s6, 2457600
s_mov_b32 s7, 0x20000
s_mov_b32 s10, 67108864
s_mov_b32 s11, 0x20000
s_lshl_b32 s3, s2, 8
v_add_u32 v1, s3, v0
s_mov_b32 s3, 2236963
v_mul_hi_u32 v2, v1, s3
v_mul_u32_u24 v3, 1920, v2
v_sub_u32 v3, v1, v3
v_mul_u32_u24 v4, 30720, v2
v_lshl_add_u32 v4, v3, 1, v4
s_mov_b32 s3, 0
buffer_load_ushort v10, v4, s[4:7], s3 offen
s_add_u32 s3, s3, 3840
buffer_load_ushort v11, v4, s[4:7], s3 offen
s_add_u32 s3, s3, 3840
buffer_load_ushort v12, v4, s[4:7], s3 offen
s_add_u32 s3, s3, 3840
buffer_load_ushort v13, v4, s[4:7], s3 offen
s_add_u32 s3, s3, 3840
buffer_load_ushort v14, v4, s[4:7], s3 offen
s_add_u32 s3, s3, 3840
buffer_load_ushort v15, v4, s[4:7], s3 offen
s_add_u32 s3, s3, 3840
buffer_load_ushort v16, v4, s[4:7], s3 offen
s_add_u32 s3, s3, 3840
buffer_load_ushort v17, v4, s[4:7], s3 offen
s_add_u32 s3, s3, 3840
s_waitcnt vmcnt(0)
v_lshl_or_b32 v20, v11, 16, v10
v_lshl_or_b32 v21, v13, 16, v12
v_lshl_or_b32 v22, v15, 16, v14
v_lshl_or_b32 v23, v17, 16, v16
v_mul_u32_u24 v4, 1280, v3
v_lshl_add_u32 v4, v2, 4, v4
s_mov_b32 s3, 4194304
buffer_store_dwordx4 v[20:23], v4, s[8:11], s3 offen
s_waitcnt vmcnt(0)
tw_kernel_end:
s_endpgm
.globl two_kernel
.p2align 8
.type two_kernel,@function
two_kernel:
s_cmp_ge_u32 s2, 200
s_cbranch_scc1 two_kernel_end
s_load_dwordx2 s[4:5], s[0:1], 16
s_load_dwordx2 s[8:9], s[0:1], 96
s_waitcnt lgkmcnt(0)
s_mov_b32 s6, 819200
s_mov_b32 s7, 0x20000
s_mov_b32 s10, 67108864
s_mov_b32 s11, 0x20000
s_lshl_b32 s3, s2, 8
v_add_u32 v1, s3, v0
s_mov_b32 s3, 6710887
v_mul_hi_u32 v2, v1, s3
v_mul_u32_u24 v3, 640, v2
v_sub_u32 v3, v1, v3
v_mul_u32_u24 v4, 10240, v2
v_lshl_add_u32 v4, v3, 1, v4
s_mov_b32 s3, 0
buffer_load_ushort v10, v4, s[4:7], s3 offen
s_add_u32 s3, s3, 1280
buffer_load_ushort v11, v4, s[4:7], s3 offen
s_add_u32 s3, s3, 1280
buffer_load_ushort v12, v4, s[4:7], s3 offen
s_add_u32 s3, s3, 1280
buffer_load_ushort v13, v4, s[4:7], s3 offen
s_add_u32 s3, s3, 1280
buffer_load_ushort v14, v4, s[4:7], s3 offen
s_add_u32 s3, s3, 1280
buffer_load_ushort v15, v4, s[4:7], s3 offen
s_add_u32 s3, s3, 1280
buffer_load_ushort v16, v4, s[4:7], s3 offen
s_add_u32 s3, s3, 1280
buffer_load_ushort v17, v4, s[4:7], s3 offen
s_add_u32 s3, s3, 1280
s_waitcnt vmcnt(0)
v_lshl_or_b32 v20, v11, 16, v10
v_lshl_or_b32 v21, v13, 16, v12
v_lshl_or_b32 v22, v15, 16, v14
v_lshl_or_b32 v23, v17, 16, v16
v_mul_u32_u24 v4, 1280, v3
v_lshl_add_u32 v4, v2, 4, v4
s_mov_b32 s3, 7340032
buffer_store_dwordx4 v[20:23], v4, s[8:11], s3 offen
s_waitcnt vmcnt(0)
two_kernel_end:
s_endpgm
.globl ln1_kernel
.p2align 8
.type ln1_kernel,@function
ln1_kernel:
s_cmp_ge_u32 s2, 512
s_cbranch_scc1 ln1_kernel_end
s_load_dwordx2 s[4:5], s[0:1], 0
s_load_dwordx2 s[8:9], s[0:1], 96
s_waitcnt lgkmcnt(0)
s_mov_b32 s6, 2621440
s_mov_b32 s7, 0x20000
s_mov_b32 s10, 67108864
s_mov_b32 s11, 0x20000
v_lshrrev_b32 v1, 6, v0
s_lshl_b32 s3, s2, 2
v_add_u32 v1, s3, v1
v_and_b32 v2, 63, v0
v_mul_u32_u24 v3, 1280, v1
v_lshl_add_u32 v3, v2, 2, v3
v_lshlrev_b32 v4, 3, v2
v_lshlrev_b32 v5, 1, v3
buffer_load_dword v10, v3, s[4:7], 0 offen offset:0
buffer_load_dword v11, v3, s[4:7], 0 offen offset:256
buffer_load_dword v12, v3, s[4:7], 0 offen offset:512
buffer_load_dword v13, v3, s[4:7], 0 offen offset:768
buffer_load_dword v14, v3, s[4:7], 0 offen offset:1024
s_waitcnt vmcnt(0)
v_lshlrev_b32 v20, 16, v10
v_and_b32 v21, 0xffff0000, v10
v_lshlrev_b32 v22, 16, v11
v_and_b32 v23, 0xffff0000, v11
v_lshlrev_b32 v24, 16, v12
v_and_b32 v25, 0xffff0000, v12
v_lshlrev_b32 v26, 16, v13
v_and_b32 v27, 0xffff0000, v13
v_lshlrev_b32 v28, 16, v14
v_and_b32 v29, 0xffff0000, v14
v_mov_b32 v6, 0
v_add_f32 v6, v6, v20
v_add_f32 v6, v6, v21
v_add_f32 v6, v6, v22
v_add_f32 v6, v6, v23
v_add_f32 v6, v6, v24
v_add_f32 v6, v6, v25
v_add_f32 v6, v6, v26
v_add_f32 v6, v6, v27
v_add_f32 v6, v6, v28
v_add_f32 v6, v6, v29
ds_swizzle_b32 v7, v6 offset:1055
s_waitcnt lgkmcnt(0)
v_add_f32 v6, v6, v7
ds_swizzle_b32 v7, v6 offset:2079
s_waitcnt lgkmcnt(0)
v_add_f32 v6, v6, v7
ds_swizzle_b32 v7, v6 offset:4127
s_waitcnt lgkmcnt(0)
v_add_f32 v6, v6, v7
ds_swizzle_b32 v7, v6 offset:8223
s_waitcnt lgkmcnt(0)
v_add_f32 v6, v6, v7
ds_swizzle_b32 v7, v6 offset:16415
s_waitcnt lgkmcnt(0)
v_add_f32 v6, v6, v7
v_mov_b32 v7, v6
s_nop 1
v_permlane32_swap_b32 v6, v7
s_nop 1
v_add_f32 v6, v6, v7
v_mul_f32 v6, 0x3acccccd, v6
v_mov_b32 v8, 0
v_sub_f32 v20, v20, v6
v_fmac_f32 v8, v20, v20
v_sub_f32 v21, v21, v6
v_fmac_f32 v8, v21, v21
v_sub_f32 v22, v22, v6
v_fmac_f32 v8, v22, v22
v_sub_f32 v23, v23, v6
v_fmac_f32 v8, v23, v23
v_sub_f32 v24, v24, v6
v_fmac_f32 v8, v24, v24
v_sub_f32 v25, v25, v6
v_fmac_f32 v8, v25, v25
v_sub_f32 v26, v26, v6
v_fmac_f32 v8, v26, v26
v_sub_f32 v27, v27, v6
v_fmac_f32 v8, v27, v27
v_sub_f32 v28, v28, v6
v_fmac_f32 v8, v28, v28
v_sub_f32 v29, v29, v6
v_fmac_f32 v8, v29, v29
ds_swizzle_b32 v7, v8 offset:1055
s_waitcnt lgkmcnt(0)
v_add_f32 v8, v8, v7
ds_swizzle_b32 v7, v8 offset:2079
s_waitcnt lgkmcnt(0)
v_add_f32 v8, v8, v7
ds_swizzle_b32 v7, v8 offset:4127
s_waitcnt lgkmcnt(0)
v_add_f32 v8, v8, v7
ds_swizzle_b32 v7, v8 offset:8223
s_waitcnt lgkmcnt(0)
v_add_f32 v8, v8, v7
ds_swizzle_b32 v7, v8 offset:16415
s_waitcnt lgkmcnt(0)
v_add_f32 v8, v8, v7
v_mov_b32 v7, v8
s_nop 1
v_permlane32_swap_b32 v8, v7
s_nop 1
v_add_f32 v8, v8, v7
v_mov_b32 v7, 0x3727c5ac
v_fmac_f32 v7, 0x3acccccd, v8
v_rsq_f32 v7, v7
s_nop 0
v_mul_f32 v20, v20, v7
v_mul_f32 v21, v21, v7
v_mul_f32 v22, v22, v7
v_mul_f32 v23, v23, v7
v_mul_f32 v24, v24, v7
v_mul_f32 v25, v25, v7
v_mul_f32 v26, v26, v7
v_mul_f32 v27, v27, v7
v_mul_f32 v28, v28, v7
v_mul_f32 v29, v29, v7
s_mov_b32 s3, 0
buffer_load_dwordx2 v[30:31], v4, s[8:11], s3 offen offset:0
buffer_load_dwordx2 v[32:33], v4, s[8:11], s3 offen offset:512
buffer_load_dwordx2 v[34:35], v4, s[8:11], s3 offen offset:1024
buffer_load_dwordx2 v[36:37], v4, s[8:11], s3 offen offset:1536
buffer_load_dwordx2 v[38:39], v4, s[8:11], s3 offen offset:2048
s_waitcnt vmcnt(0)
s_mov_b32 s3, 2560
buffer_load_dwordx2 v[40:41], v4, s[8:11], s3 offen offset:0
buffer_load_dwordx2 v[42:43], v4, s[8:11], s3 offen offset:512
buffer_load_dwordx2 v[44:45], v4, s[8:11], s3 offen offset:1024
buffer_load_dwordx2 v[46:47], v4, s[8:11], s3 offen offset:1536
buffer_load_dwordx2 v[48:49], v4, s[8:11], s3 offen offset:2048
s_waitcnt vmcnt(0)
v_fma_f32 v20, v20, v40, v30
v_fma_f32 v21, v21, v41, v31
v_fma_f32 v22, v22, v42, v32
v_fma_f32 v23, v23, v43, v33
v_fma_f32 v24, v24, v44, v34
v_fma_f32 v25, v25, v45, v35
v_fma_f32 v26, v26, v46, v36
v_fma_f32 v27, v27, v47, v37
v_fma_f32 v28, v28, v48, v38
v_fma_f32 v29, v29, v49, v39
s_mov_b32 s3, 1048576
v_cvt_pk_bf16_f32 v10, v20, v21
buffer_store_dword v10, v3, s[8:11], s3 offen offset:0
v_cvt_pk_bf16_f32 v11, v22, v23
buffer_store_dword v11, v3, s[8:11], s3 offen offset:256
v_cvt_pk_bf16_f32 v12, v24, v25
buffer_store_dword v12, v3, s[8:11], s3 offen offset:512
v_cvt_pk_bf16_f32 v13, v26, v27
buffer_store_dword v13, v3, s[8:11], s3 offen offset:768
v_cvt_pk_bf16_f32 v14, v28, v29
buffer_store_dword v14, v3, s[8:11], s3 offen offset:1024
s_waitcnt vmcnt(0)
ln1_kernel_end:
s_endpgm
.globl qkv_kernel
.p2align 8
.type qkv_kernel,@function
qkv_kernel:
s_cmp_ge_u32 s2, 960
s_cbranch_scc1 qkv_kernel_end
s_load_dwordx2 s[4:5], s[0:1], 96
s_waitcnt lgkmcnt(0)
s_mov_b32 s6, 67108864
s_mov_b32 s7, 0x20000
s_and_b32 s8, s2, 31
s_lshr_b32 s9, s2, 5
v_lshrrev_b32 v1, 6, v0
v_and_b32 v2, 1, v1
v_lshrrev_b32 v3, 1, v1
s_lshl_b32 s8, s8, 6
s_lshl_b32 s9, s9, 6
v_lshl_add_u32 v2, v2, 5, s8
v_lshl_add_u32 v3, v3, 5, s9
v_and_b32 v4, 15, v0
v_bfe_u32 v5, v0, 4, 2
v_add_u32 v6, v2, v4
v_mul_u32_u24 v6, 1280, v6
v_lshl_add_u32 v6, v5, 4, v6
v_add_u32 v7, 20480, v6
v_add_u32 v8, v3, v4
v_mul_u32_u24 v8, 1280, v8
v_lshl_add_u32 v8, v5, 4, v8
v_add_u32 v9, 20480, v8
v_mov_b32 v40, 0
v_mov_b32 v41, 0
v_mov_b32 v42, 0
v_mov_b32 v43, 0
v_mov_b32 v44, 0
v_mov_b32 v45, 0
v_mov_b32 v46, 0
v_mov_b32 v47, 0
v_mov_b32 v48, 0
v_mov_b32 v49, 0
v_mov_b32 v50, 0
v_mov_b32 v51, 0
v_mov_b32 v52, 0
v_mov_b32 v53, 0
v_mov_b32 v54, 0
v_mov_b32 v55, 0
s_mov_b32 s10, 1048576
s_mov_b32 s11, 4194304
s_mov_b32 s12, 0
qkv_kernel_loop:
buffer_load_dwordx4 v[60:63], v6, s[4:7], s10 offen offset:0
buffer_load_dwordx4 v[64:67], v7, s[4:7], s10 offen offset:0
buffer_load_dwordx4 v[68:71], v8, s[4:7], s11 offen offset:0
buffer_load_dwordx4 v[72:75], v9, s[4:7], s11 offen offset:0
buffer_load_dwordx4 v[76:79], v6, s[4:7], s10 offen offset:64
buffer_load_dwordx4 v[80:83], v7, s[4:7], s10 offen offset:64
buffer_load_dwordx4 v[84:87], v8, s[4:7], s11 offen offset:64
buffer_load_dwordx4 v[88:91], v9, s[4:7], s11 offen offset:64
s_waitcnt vmcnt(4)
v_mfma_f32_16x16x32_bf16 v[40:43], v[68:71], v[60:63], v[40:43]
v_mfma_f32_16x16x32_bf16 v[44:47], v[72:75], v[60:63], v[44:47]
v_mfma_f32_16x16x32_bf16 v[48:51], v[68:71], v[64:67], v[48:51]
v_mfma_f32_16x16x32_bf16 v[52:55], v[72:75], v[64:67], v[52:55]
s_waitcnt vmcnt(0)
v_mfma_f32_16x16x32_bf16 v[40:43], v[84:87], v[76:79], v[40:43]
v_mfma_f32_16x16x32_bf16 v[44:47], v[88:91], v[76:79], v[44:47]
v_mfma_f32_16x16x32_bf16 v[48:51], v[84:87], v[80:83], v[48:51]
v_mfma_f32_16x16x32_bf16 v[52:55], v[88:91], v[80:83], v[52:55]
s_add_u32 s10, s10, 128
s_add_u32 s11, s11, 128
s_add_u32 s12, s12, 1
s_cmp_lt_u32 s12, 10
s_cbranch_scc1 qkv_kernel_loop
s_nop 7
s_nop 7
v_add_u32 v6, v2, v4
v_mul_u32_u24 v6, 3840, v6
v_lshl_add_u32 v7, v5, 2, v3
v_mul_u32_u24 v7, 2, v7
v_add_u32 v6, v6, v7
s_mov_b32 s10, 8388608
s_mov_b32 s11, 8450048
v_cvt_pk_bf16_f32 v40, v40, v41
v_cvt_pk_bf16_f32 v41, v42, v43
buffer_store_dwordx2 v[40:41], v6, s[4:7], s10 offen offset:0
v_cvt_pk_bf16_f32 v44, v44, v45
v_cvt_pk_bf16_f32 v45, v46, v47
buffer_store_dwordx2 v[44:45], v6, s[4:7], s10 offen offset:32
v_cvt_pk_bf16_f32 v48, v48, v49
v_cvt_pk_bf16_f32 v49, v50, v51
buffer_store_dwordx2 v[48:49], v6, s[4:7], s11 offen offset:0
v_cvt_pk_bf16_f32 v52, v52, v53
v_cvt_pk_bf16_f32 v53, v54, v55
buffer_store_dwordx2 v[52:53], v6, s[4:7], s11 offen offset:32
s_waitcnt vmcnt(0)
qkv_kernel_end:
s_endpgm
.globl attn_kernel
.p2align 8
.type attn_kernel,@function
attn_kernel:
s_cmp_ge_u32 s2, 256
s_cbranch_scc1 attn_kernel_end
s_load_dwordx2 s[4:5], s[0:1], 96
s_waitcnt lgkmcnt(0)
s_mov_b32 s6, 67108864
s_mov_b32 s7, 0x20000
v_and_b32 v1, 31, v0
v_lshrrev_b32 v2, 5, v0
s_lshl_b32 s3, s2, 3
v_add_u32 v2, s3, v2
v_mul_u32_u24 v3, 40, v1
v_mul_u32_u24 v4, 3840, v2
v_add_u32 v4, v4, v3
s_mov_b32 s8, 8388608
buffer_load_dwordx2 v[10:11], v4, s[4:7], s8 offen offset:0
buffer_load_dwordx2 v[12:13], v4, s[4:7], s8 offen offset:8
buffer_load_dwordx2 v[14:15], v4, s[4:7], s8 offen offset:16
buffer_load_dwordx2 v[16:17], v4, s[4:7], s8 offen offset:24
buffer_load_dwordx2 v[18:19], v4, s[4:7], s8 offen offset:32
v_subrev_u32 v5, 0, v2
v_max_i32 v5, 0, v5
v_mul_u32_u24 v5, 3840, v5
v_add_u32 v5, v5, v3
buffer_load_dwordx2 v[60:61], v5, s[4:7], s8 offen offset:1280
buffer_load_dwordx2 v[140:141], v5, s[4:7], s8 offen offset:2560
buffer_load_dwordx2 v[62:63], v5, s[4:7], s8 offen offset:1288
buffer_load_dwordx2 v[142:143], v5, s[4:7], s8 offen offset:2568
buffer_load_dwordx2 v[64:65], v5, s[4:7], s8 offen offset:1296
buffer_load_dwordx2 v[144:145], v5, s[4:7], s8 offen offset:2576
buffer_load_dwordx2 v[66:67], v5, s[4:7], s8 offen offset:1304
buffer_load_dwordx2 v[146:147], v5, s[4:7], s8 offen offset:2584
buffer_load_dwordx2 v[68:69], v5, s[4:7], s8 offen offset:1312
buffer_load_dwordx2 v[148:149], v5, s[4:7], s8 offen offset:2592
s_waitcnt vmcnt(40)
v_subrev_u32 v5, 2, v2
v_max_i32 v5, 0, v5
v_mul_u32_u24 v5, 3840, v5
v_add_u32 v5, v5, v3
buffer_load_dwordx2 v[70:71], v5, s[4:7], s8 offen offset:1280
buffer_load_dwordx2 v[150:151], v5, s[4:7], s8 offen offset:2560
buffer_load_dwordx2 v[72:73], v5, s[4:7], s8 offen offset:1288
buffer_load_dwordx2 v[152:153], v5, s[4:7], s8 offen offset:2568
buffer_load_dwordx2 v[74:75], v5, s[4:7], s8 offen offset:1296
buffer_load_dwordx2 v[154:155], v5, s[4:7], s8 offen offset:2576
buffer_load_dwordx2 v[76:77], v5, s[4:7], s8 offen offset:1304
buffer_load_dwordx2 v[156:157], v5, s[4:7], s8 offen offset:2584
buffer_load_dwordx2 v[78:79], v5, s[4:7], s8 offen offset:1312
buffer_load_dwordx2 v[158:159], v5, s[4:7], s8 offen offset:2592
s_waitcnt vmcnt(40)
v_subrev_u32 v5, 4, v2
v_max_i32 v5, 0, v5
v_mul_u32_u24 v5, 3840, v5
v_add_u32 v5, v5, v3
buffer_load_dwordx2 v[80:81], v5, s[4:7], s8 offen offset:1280
buffer_load_dwordx2 v[160:161], v5, s[4:7], s8 offen offset:2560
buffer_load_dwordx2 v[82:83], v5, s[4:7], s8 offen offset:1288
buffer_load_dwordx2 v[162:163], v5, s[4:7], s8 offen offset:2568
buffer_load_dwordx2 v[84:85], v5, s[4:7], s8 offen offset:1296
buffer_load_dwordx2 v[164:165], v5, s[4:7], s8 offen offset:2576
buffer_load_dwordx2 v[86:87], v5, s[4:7], s8 offen offset:1304
buffer_load_dwordx2 v[166:167], v5, s[4:7], s8 offen offset:2584
buffer_load_dwordx2 v[88:89], v5, s[4:7], s8 offen offset:1312
buffer_load_dwordx2 v[168:169], v5, s[4:7], s8 offen offset:2592
s_waitcnt vmcnt(40)
v_subrev_u32 v5, 6, v2
v_max_i32 v5, 0, v5
v_mul_u32_u24 v5, 3840, v5
v_add_u32 v5, v5, v3
buffer_load_dwordx2 v[90:91], v5, s[4:7], s8 offen offset:1280
buffer_load_dwordx2 v[170:171], v5, s[4:7], s8 offen offset:2560
buffer_load_dwordx2 v[92:93], v5, s[4:7], s8 offen offset:1288
buffer_load_dwordx2 v[172:173], v5, s[4:7], s8 offen offset:2568
buffer_load_dwordx2 v[94:95], v5, s[4:7], s8 offen offset:1296
buffer_load_dwordx2 v[174:175], v5, s[4:7], s8 offen offset:2576
buffer_load_dwordx2 v[96:97], v5, s[4:7], s8 offen offset:1304
buffer_load_dwordx2 v[176:177], v5, s[4:7], s8 offen offset:2584
buffer_load_dwordx2 v[98:99], v5, s[4:7], s8 offen offset:1312
buffer_load_dwordx2 v[178:179], v5, s[4:7], s8 offen offset:2592
s_waitcnt vmcnt(40)
v_subrev_u32 v5, 8, v2
v_max_i32 v5, 0, v5
v_mul_u32_u24 v5, 3840, v5
v_add_u32 v5, v5, v3
buffer_load_dwordx2 v[100:101], v5, s[4:7], s8 offen offset:1280
buffer_load_dwordx2 v[180:181], v5, s[4:7], s8 offen offset:2560
buffer_load_dwordx2 v[102:103], v5, s[4:7], s8 offen offset:1288
buffer_load_dwordx2 v[182:183], v5, s[4:7], s8 offen offset:2568
buffer_load_dwordx2 v[104:105], v5, s[4:7], s8 offen offset:1296
buffer_load_dwordx2 v[184:185], v5, s[4:7], s8 offen offset:2576
buffer_load_dwordx2 v[106:107], v5, s[4:7], s8 offen offset:1304
buffer_load_dwordx2 v[186:187], v5, s[4:7], s8 offen offset:2584
buffer_load_dwordx2 v[108:109], v5, s[4:7], s8 offen offset:1312
buffer_load_dwordx2 v[188:189], v5, s[4:7], s8 offen offset:2592
s_waitcnt vmcnt(40)
v_subrev_u32 v5, 10, v2
v_max_i32 v5, 0, v5
v_mul_u32_u24 v5, 3840, v5
v_add_u32 v5, v5, v3
buffer_load_dwordx2 v[110:111], v5, s[4:7], s8 offen offset:1280
buffer_load_dwordx2 v[190:191], v5, s[4:7], s8 offen offset:2560
buffer_load_dwordx2 v[112:113], v5, s[4:7], s8 offen offset:1288
buffer_load_dwordx2 v[192:193], v5, s[4:7], s8 offen offset:2568
buffer_load_dwordx2 v[114:115], v5, s[4:7], s8 offen offset:1296
buffer_load_dwordx2 v[194:195], v5, s[4:7], s8 offen offset:2576
buffer_load_dwordx2 v[116:117], v5, s[4:7], s8 offen offset:1304
buffer_load_dwordx2 v[196:197], v5, s[4:7], s8 offen offset:2584
buffer_load_dwordx2 v[118:119], v5, s[4:7], s8 offen offset:1312
buffer_load_dwordx2 v[198:199], v5, s[4:7], s8 offen offset:2592
s_waitcnt vmcnt(40)
v_subrev_u32 v5, 12, v2
v_max_i32 v5, 0, v5
v_mul_u32_u24 v5, 3840, v5
v_add_u32 v5, v5, v3
buffer_load_dwordx2 v[120:121], v5, s[4:7], s8 offen offset:1280
buffer_load_dwordx2 v[200:201], v5, s[4:7], s8 offen offset:2560
buffer_load_dwordx2 v[122:123], v5, s[4:7], s8 offen offset:1288
buffer_load_dwordx2 v[202:203], v5, s[4:7], s8 offen offset:2568
buffer_load_dwordx2 v[124:125], v5, s[4:7], s8 offen offset:1296
buffer_load_dwordx2 v[204:205], v5, s[4:7], s8 offen offset:2576
buffer_load_dwordx2 v[126:127], v5, s[4:7], s8 offen offset:1304
buffer_load_dwordx2 v[206:207], v5, s[4:7], s8 offen offset:2584
buffer_load_dwordx2 v[128:129], v5, s[4:7], s8 offen offset:1312
buffer_load_dwordx2 v[208:209], v5, s[4:7], s8 offen offset:2592
s_waitcnt vmcnt(40)
v_subrev_u32 v5, 14, v2
v_max_i32 v5, 0, v5
v_mul_u32_u24 v5, 3840, v5
v_add_u32 v5, v5, v3
buffer_load_dwordx2 v[130:131], v5, s[4:7], s8 offen offset:1280
buffer_load_dwordx2 v[210:211], v5, s[4:7], s8 offen offset:2560
buffer_load_dwordx2 v[132:133], v5, s[4:7], s8 offen offset:1288
buffer_load_dwordx2 v[212:213], v5, s[4:7], s8 offen offset:2568
buffer_load_dwordx2 v[134:135], v5, s[4:7], s8 offen offset:1296
buffer_load_dwordx2 v[214:215], v5, s[4:7], s8 offen offset:2576
buffer_load_dwordx2 v[136:137], v5, s[4:7], s8 offen offset:1304
buffer_load_dwordx2 v[216:217], v5, s[4:7], s8 offen offset:2584
buffer_load_dwordx2 v[138:139], v5, s[4:7], s8 offen offset:1312
buffer_load_dwordx2 v[218:219], v5, s[4:7], s8 offen offset:2592
s_waitcnt vmcnt(40)
s_waitcnt vmcnt(0)
v_lshlrev_b32 v20, 16, v10
v_and_b32 v21, 0xffff0000, v10
v_lshlrev_b32 v22, 16, v11
v_and_b32 v23, 0xffff0000, v11
v_lshlrev_b32 v24, 16, v12
v_and_b32 v25, 0xffff0000, v12
v_lshlrev_b32 v26, 16, v13
v_and_b32 v27, 0xffff0000, v13
v_lshlrev_b32 v28, 16, v14
v_and_b32 v29, 0xffff0000, v14
v_lshlrev_b32 v30, 16, v15
v_and_b32 v31, 0xffff0000, v15
v_lshlrev_b32 v32, 16, v16
v_and_b32 v33, 0xffff0000, v16
v_lshlrev_b32 v34, 16, v17
v_and_b32 v35, 0xffff0000, v17
v_lshlrev_b32 v36, 16, v18
v_and_b32 v37, 0xffff0000, v18
v_lshlrev_b32 v38, 16, v19
v_and_b32 v39, 0xffff0000, v19
v_mov_b32 v40, 0
v_lshlrev_b32 v5, 16, v60
v_and_b32 v6, 0xffff0000, v60
v_fmac_f32 v40, v5, v20
v_fmac_f32 v40, v6, v21
v_lshlrev_b32 v5, 16, v61
v_and_b32 v6, 0xffff0000, v61
v_fmac_f32 v40, v5, v22
v_fmac_f32 v40, v6, v23
v_lshlrev_b32 v5, 16, v62
v_and_b32 v6, 0xffff0000, v62
v_fmac_f32 v40, v5, v24
v_fmac_f32 v40, v6, v25
v_lshlrev_b32 v5, 16, v63
v_and_b32 v6, 0xffff0000, v63
v_fmac_f32 v40, v5, v26
v_fmac_f32 v40, v6, v27
v_lshlrev_b32 v5, 16, v64
v_and_b32 v6, 0xffff0000, v64
v_fmac_f32 v40, v5, v28
v_fmac_f32 v40, v6, v29
v_lshlrev_b32 v5, 16, v65
v_and_b32 v6, 0xffff0000, v65
v_fmac_f32 v40, v5, v30
v_fmac_f32 v40, v6, v31
v_lshlrev_b32 v5, 16, v66
v_and_b32 v6, 0xffff0000, v66
v_fmac_f32 v40, v5, v32
v_fmac_f32 v40, v6, v33
v_lshlrev_b32 v5, 16, v67
v_and_b32 v6, 0xffff0000, v67
v_fmac_f32 v40, v5, v34
v_fmac_f32 v40, v6, v35
v_lshlrev_b32 v5, 16, v68
v_and_b32 v6, 0xffff0000, v68
v_fmac_f32 v40, v5, v36
v_fmac_f32 v40, v6, v37
v_lshlrev_b32 v5, 16, v69
v_and_b32 v6, 0xffff0000, v69
v_fmac_f32 v40, v5, v38
v_fmac_f32 v40, v6, v39
v_mul_f32 v40, 0x3ea52b5c, v40
v_mov_b32 v5, 0xceac0000
v_cmp_le_u32 vcc, 0, v2
s_nop 1
v_cndmask_b32 v40, v5, v40, vcc
v_mov_b32 v41, 0
v_lshlrev_b32 v5, 16, v70
v_and_b32 v6, 0xffff0000, v70
v_fmac_f32 v41, v5, v20
v_fmac_f32 v41, v6, v21
v_lshlrev_b32 v5, 16, v71
v_and_b32 v6, 0xffff0000, v71
v_fmac_f32 v41, v5, v22
v_fmac_f32 v41, v6, v23
v_lshlrev_b32 v5, 16, v72
v_and_b32 v6, 0xffff0000, v72
v_fmac_f32 v41, v5, v24
v_fmac_f32 v41, v6, v25
v_lshlrev_b32 v5, 16, v73
v_and_b32 v6, 0xffff0000, v73
v_fmac_f32 v41, v5, v26
v_fmac_f32 v41, v6, v27
v_lshlrev_b32 v5, 16, v74
v_and_b32 v6, 0xffff0000, v74
v_fmac_f32 v41, v5, v28
v_fmac_f32 v41, v6, v29
v_lshlrev_b32 v5, 16, v75
v_and_b32 v6, 0xffff0000, v75
v_fmac_f32 v41, v5, v30
v_fmac_f32 v41, v6, v31
v_lshlrev_b32 v5, 16, v76
v_and_b32 v6, 0xffff0000, v76
v_fmac_f32 v41, v5, v32
v_fmac_f32 v41, v6, v33
v_lshlrev_b32 v5, 16, v77
v_and_b32 v6, 0xffff0000, v77
v_fmac_f32 v41, v5, v34
v_fmac_f32 v41, v6, v35
v_lshlrev_b32 v5, 16, v78
v_and_b32 v6, 0xffff0000, v78
v_fmac_f32 v41, v5, v36
v_fmac_f32 v41, v6, v37
v_lshlrev_b32 v5, 16, v79
v_and_b32 v6, 0xffff0000, v79
v_fmac_f32 v41, v5, v38
v_fmac_f32 v41, v6, v39
v_mul_f32 v41, 0x3ea52b5c, v41
v_mov_b32 v5, 0xceac0000
v_cmp_le_u32 vcc, 2, v2
s_nop 1
v_cndmask_b32 v41, v5, v41, vcc
v_mov_b32 v42, 0
v_lshlrev_b32 v5, 16, v80
v_and_b32 v6, 0xffff0000, v80
v_fmac_f32 v42, v5, v20
v_fmac_f32 v42, v6, v21
v_lshlrev_b32 v5, 16, v81
v_and_b32 v6, 0xffff0000, v81
v_fmac_f32 v42, v5, v22
v_fmac_f32 v42, v6, v23
v_lshlrev_b32 v5, 16, v82
v_and_b32 v6, 0xffff0000, v82
v_fmac_f32 v42, v5, v24
v_fmac_f32 v42, v6, v25
v_lshlrev_b32 v5, 16, v83
v_and_b32 v6, 0xffff0000, v83
v_fmac_f32 v42, v5, v26
v_fmac_f32 v42, v6, v27
v_lshlrev_b32 v5, 16, v84
v_and_b32 v6, 0xffff0000, v84
v_fmac_f32 v42, v5, v28
v_fmac_f32 v42, v6, v29
v_lshlrev_b32 v5, 16, v85
v_and_b32 v6, 0xffff0000, v85
v_fmac_f32 v42, v5, v30
v_fmac_f32 v42, v6, v31
v_lshlrev_b32 v5, 16, v86
v_and_b32 v6, 0xffff0000, v86
v_fmac_f32 v42, v5, v32
v_fmac_f32 v42, v6, v33
v_lshlrev_b32 v5, 16, v87
v_and_b32 v6, 0xffff0000, v87
v_fmac_f32 v42, v5, v34
v_fmac_f32 v42, v6, v35
v_lshlrev_b32 v5, 16, v88
v_and_b32 v6, 0xffff0000, v88
v_fmac_f32 v42, v5, v36
v_fmac_f32 v42, v6, v37
v_lshlrev_b32 v5, 16, v89
v_and_b32 v6, 0xffff0000, v89
v_fmac_f32 v42, v5, v38
v_fmac_f32 v42, v6, v39
v_mul_f32 v42, 0x3ea52b5c, v42
v_mov_b32 v5, 0xceac0000
v_cmp_le_u32 vcc, 4, v2
s_nop 1
v_cndmask_b32 v42, v5, v42, vcc
v_mov_b32 v43, 0
v_lshlrev_b32 v5, 16, v90
v_and_b32 v6, 0xffff0000, v90
v_fmac_f32 v43, v5, v20
v_fmac_f32 v43, v6, v21
v_lshlrev_b32 v5, 16, v91
v_and_b32 v6, 0xffff0000, v91
v_fmac_f32 v43, v5, v22
v_fmac_f32 v43, v6, v23
v_lshlrev_b32 v5, 16, v92
v_and_b32 v6, 0xffff0000, v92
v_fmac_f32 v43, v5, v24
v_fmac_f32 v43, v6, v25
v_lshlrev_b32 v5, 16, v93
v_and_b32 v6, 0xffff0000, v93
v_fmac_f32 v43, v5, v26
v_fmac_f32 v43, v6, v27
v_lshlrev_b32 v5, 16, v94
v_and_b32 v6, 0xffff0000, v94
v_fmac_f32 v43, v5, v28
v_fmac_f32 v43, v6, v29
v_lshlrev_b32 v5, 16, v95
v_and_b32 v6, 0xffff0000, v95
v_fmac_f32 v43, v5, v30
v_fmac_f32 v43, v6, v31
v_lshlrev_b32 v5, 16, v96
v_and_b32 v6, 0xffff0000, v96
v_fmac_f32 v43, v5, v32
v_fmac_f32 v43, v6, v33
v_lshlrev_b32 v5, 16, v97
v_and_b32 v6, 0xffff0000, v97
v_fmac_f32 v43, v5, v34
v_fmac_f32 v43, v6, v35
v_lshlrev_b32 v5, 16, v98
v_and_b32 v6, 0xffff0000, v98
v_fmac_f32 v43, v5, v36
v_fmac_f32 v43, v6, v37
v_lshlrev_b32 v5, 16, v99
v_and_b32 v6, 0xffff0000, v99
v_fmac_f32 v43, v5, v38
v_fmac_f32 v43, v6, v39
v_mul_f32 v43, 0x3ea52b5c, v43
v_mov_b32 v5, 0xceac0000
v_cmp_le_u32 vcc, 6, v2
s_nop 1
v_cndmask_b32 v43, v5, v43, vcc
v_mov_b32 v44, 0
v_lshlrev_b32 v5, 16, v100
v_and_b32 v6, 0xffff0000, v100
v_fmac_f32 v44, v5, v20
v_fmac_f32 v44, v6, v21
v_lshlrev_b32 v5, 16, v101
v_and_b32 v6, 0xffff0000, v101
v_fmac_f32 v44, v5, v22
v_fmac_f32 v44, v6, v23
v_lshlrev_b32 v5, 16, v102
v_and_b32 v6, 0xffff0000, v102
v_fmac_f32 v44, v5, v24
v_fmac_f32 v44, v6, v25
v_lshlrev_b32 v5, 16, v103
v_and_b32 v6, 0xffff0000, v103
v_fmac_f32 v44, v5, v26
v_fmac_f32 v44, v6, v27
v_lshlrev_b32 v5, 16, v104
v_and_b32 v6, 0xffff0000, v104
v_fmac_f32 v44, v5, v28
v_fmac_f32 v44, v6, v29
v_lshlrev_b32 v5, 16, v105
v_and_b32 v6, 0xffff0000, v105
v_fmac_f32 v44, v5, v30
v_fmac_f32 v44, v6, v31
v_lshlrev_b32 v5, 16, v106
v_and_b32 v6, 0xffff0000, v106
v_fmac_f32 v44, v5, v32
v_fmac_f32 v44, v6, v33
v_lshlrev_b32 v5, 16, v107
v_and_b32 v6, 0xffff0000, v107
v_fmac_f32 v44, v5, v34
v_fmac_f32 v44, v6, v35
v_lshlrev_b32 v5, 16, v108
v_and_b32 v6, 0xffff0000, v108
v_fmac_f32 v44, v5, v36
v_fmac_f32 v44, v6, v37
v_lshlrev_b32 v5, 16, v109
v_and_b32 v6, 0xffff0000, v109
v_fmac_f32 v44, v5, v38
v_fmac_f32 v44, v6, v39
v_mul_f32 v44, 0x3ea52b5c, v44
v_mov_b32 v5, 0xceac0000
v_cmp_le_u32 vcc, 8, v2
s_nop 1
v_cndmask_b32 v44, v5, v44, vcc
v_mov_b32 v45, 0
v_lshlrev_b32 v5, 16, v110
v_and_b32 v6, 0xffff0000, v110
v_fmac_f32 v45, v5, v20
v_fmac_f32 v45, v6, v21
v_lshlrev_b32 v5, 16, v111
v_and_b32 v6, 0xffff0000, v111
v_fmac_f32 v45, v5, v22
v_fmac_f32 v45, v6, v23
v_lshlrev_b32 v5, 16, v112
v_and_b32 v6, 0xffff0000, v112
v_fmac_f32 v45, v5, v24
v_fmac_f32 v45, v6, v25
v_lshlrev_b32 v5, 16, v113
v_and_b32 v6, 0xffff0000, v113
v_fmac_f32 v45, v5, v26
v_fmac_f32 v45, v6, v27
v_lshlrev_b32 v5, 16, v114
v_and_b32 v6, 0xffff0000, v114
v_fmac_f32 v45, v5, v28
v_fmac_f32 v45, v6, v29
v_lshlrev_b32 v5, 16, v115
v_and_b32 v6, 0xffff0000, v115
v_fmac_f32 v45, v5, v30
v_fmac_f32 v45, v6, v31
v_lshlrev_b32 v5, 16, v116
v_and_b32 v6, 0xffff0000, v116
v_fmac_f32 v45, v5, v32
v_fmac_f32 v45, v6, v33
v_lshlrev_b32 v5, 16, v117
v_and_b32 v6, 0xffff0000, v117
v_fmac_f32 v45, v5, v34
v_fmac_f32 v45, v6, v35
v_lshlrev_b32 v5, 16, v118
v_and_b32 v6, 0xffff0000, v118
v_fmac_f32 v45, v5, v36
v_fmac_f32 v45, v6, v37
v_lshlrev_b32 v5, 16, v119
v_and_b32 v6, 0xffff0000, v119
v_fmac_f32 v45, v5, v38
v_fmac_f32 v45, v6, v39
v_mul_f32 v45, 0x3ea52b5c, v45
v_mov_b32 v5, 0xceac0000
v_cmp_le_u32 vcc, 10, v2
s_nop 1
v_cndmask_b32 v45, v5, v45, vcc
v_mov_b32 v46, 0
v_lshlrev_b32 v5, 16, v120
v_and_b32 v6, 0xffff0000, v120
v_fmac_f32 v46, v5, v20
v_fmac_f32 v46, v6, v21
v_lshlrev_b32 v5, 16, v121
v_and_b32 v6, 0xffff0000, v121
v_fmac_f32 v46, v5, v22
v_fmac_f32 v46, v6, v23
v_lshlrev_b32 v5, 16, v122
v_and_b32 v6, 0xffff0000, v122
v_fmac_f32 v46, v5, v24
v_fmac_f32 v46, v6, v25
v_lshlrev_b32 v5, 16, v123
v_and_b32 v6, 0xffff0000, v123
v_fmac_f32 v46, v5, v26
v_fmac_f32 v46, v6, v27
v_lshlrev_b32 v5, 16, v124
v_and_b32 v6, 0xffff0000, v124
v_fmac_f32 v46, v5, v28
v_fmac_f32 v46, v6, v29
v_lshlrev_b32 v5, 16, v125
v_and_b32 v6, 0xffff0000, v125
v_fmac_f32 v46, v5, v30
v_fmac_f32 v46, v6, v31
v_lshlrev_b32 v5, 16, v126
v_and_b32 v6, 0xffff0000, v126
v_fmac_f32 v46, v5, v32
v_fmac_f32 v46, v6, v33
v_lshlrev_b32 v5, 16, v127
v_and_b32 v6, 0xffff0000, v127
v_fmac_f32 v46, v5, v34
v_fmac_f32 v46, v6, v35
v_lshlrev_b32 v5, 16, v128
v_and_b32 v6, 0xffff0000, v128
v_fmac_f32 v46, v5, v36
v_fmac_f32 v46, v6, v37
v_lshlrev_b32 v5, 16, v129
v_and_b32 v6, 0xffff0000, v129
v_fmac_f32 v46, v5, v38
v_fmac_f32 v46, v6, v39
v_mul_f32 v46, 0x3ea52b5c, v46
v_mov_b32 v5, 0xceac0000
v_cmp_le_u32 vcc, 12, v2
s_nop 1
v_cndmask_b32 v46, v5, v46, vcc
v_mov_b32 v47, 0
v_lshlrev_b32 v5, 16, v130
v_and_b32 v6, 0xffff0000, v130
v_fmac_f32 v47, v5, v20
v_fmac_f32 v47, v6, v21
v_lshlrev_b32 v5, 16, v131
v_and_b32 v6, 0xffff0000, v131
v_fmac_f32 v47, v5, v22
v_fmac_f32 v47, v6, v23
v_lshlrev_b32 v5, 16, v132
v_and_b32 v6, 0xffff0000, v132
v_fmac_f32 v47, v5, v24
v_fmac_f32 v47, v6, v25
v_lshlrev_b32 v5, 16, v133
v_and_b32 v6, 0xffff0000, v133
v_fmac_f32 v47, v5, v26
v_fmac_f32 v47, v6, v27
v_lshlrev_b32 v5, 16, v134
v_and_b32 v6, 0xffff0000, v134
v_fmac_f32 v47, v5, v28
v_fmac_f32 v47, v6, v29
v_lshlrev_b32 v5, 16, v135
v_and_b32 v6, 0xffff0000, v135
v_fmac_f32 v47, v5, v30
v_fmac_f32 v47, v6, v31
v_lshlrev_b32 v5, 16, v136
v_and_b32 v6, 0xffff0000, v136
v_fmac_f32 v47, v5, v32
v_fmac_f32 v47, v6, v33
v_lshlrev_b32 v5, 16, v137
v_and_b32 v6, 0xffff0000, v137
v_fmac_f32 v47, v5, v34
v_fmac_f32 v47, v6, v35
v_lshlrev_b32 v5, 16, v138
v_and_b32 v6, 0xffff0000, v138
v_fmac_f32 v47, v5, v36
v_fmac_f32 v47, v6, v37
v_lshlrev_b32 v5, 16, v139
v_and_b32 v6, 0xffff0000, v139
v_fmac_f32 v47, v5, v38
v_fmac_f32 v47, v6, v39
v_mul_f32 v47, 0x3ea52b5c, v47
v_mov_b32 v5, 0xceac0000
v_cmp_le_u32 vcc, 14, v2
s_nop 1
v_cndmask_b32 v47, v5, v47, vcc
v_max3_f32 v5, v40, v41, v42
v_max3_f32 v5, v5, v43, v44
v_max3_f32 v5, v5, v45, v46
v_max_f32 v5, v5, v47
v_mov_b32 v6, 0
v_sub_f32 v40, v40, v5
v_exp_f32 v40, v40
s_nop 0
v_add_f32 v6, v6, v40
v_sub_f32 v41, v41, v5
v_exp_f32 v41, v41
s_nop 0
v_add_f32 v6, v6, v41
v_sub_f32 v42, v42, v5
v_exp_f32 v42, v42
s_nop 0
v_add_f32 v6, v6, v42
v_sub_f32 v43, v43, v5
v_exp_f32 v43, v43
s_nop 0
v_add_f32 v6, v6, v43
v_sub_f32 v44, v44, v5
v_exp_f32 v44, v44
s_nop 0
v_add_f32 v6, v6, v44
v_sub_f32 v45, v45, v5
v_exp_f32 v45, v45
s_nop 0
v_add_f32 v6, v6, v45
v_sub_f32 v46, v46, v5
v_exp_f32 v46, v46
s_nop 0
v_add_f32 v6, v6, v46
v_sub_f32 v47, v47, v5
v_exp_f32 v47, v47
s_nop 0
v_add_f32 v6, v6, v47
v_rcp_f32 v6, v6
s_nop 0
v_mov_b32 v20, 0
v_mov_b32 v21, 0
v_mov_b32 v22, 0
v_mov_b32 v23, 0
v_mov_b32 v24, 0
v_mov_b32 v25, 0
v_mov_b32 v26, 0
v_mov_b32 v27, 0
v_mov_b32 v28, 0
v_mov_b32 v29, 0
v_mov_b32 v30, 0
v_mov_b32 v31, 0
v_mov_b32 v32, 0
v_mov_b32 v33, 0
v_mov_b32 v34, 0
v_mov_b32 v35, 0
v_mov_b32 v36, 0
v_mov_b32 v37, 0
v_mov_b32 v38, 0
v_mov_b32 v39, 0
v_mul_f32 v40, v40, v6
v_lshlrev_b32 v5, 16, v140
v_and_b32 v7, 0xffff0000, v140
v_fmac_f32 v20, v5, v40
v_fmac_f32 v21, v7, v40
v_lshlrev_b32 v5, 16, v141
v_and_b32 v7, 0xffff0000, v141
v_fmac_f32 v22, v5, v40
v_fmac_f32 v23, v7, v40
v_lshlrev_b32 v5, 16, v142
v_and_b32 v7, 0xffff0000, v142
v_fmac_f32 v24, v5, v40
v_fmac_f32 v25, v7, v40
v_lshlrev_b32 v5, 16, v143
v_and_b32 v7, 0xffff0000, v143
v_fmac_f32 v26, v5, v40
v_fmac_f32 v27, v7, v40
v_lshlrev_b32 v5, 16, v144
v_and_b32 v7, 0xffff0000, v144
v_fmac_f32 v28, v5, v40
v_fmac_f32 v29, v7, v40
v_lshlrev_b32 v5, 16, v145
v_and_b32 v7, 0xffff0000, v145
v_fmac_f32 v30, v5, v40
v_fmac_f32 v31, v7, v40
v_lshlrev_b32 v5, 16, v146
v_and_b32 v7, 0xffff0000, v146
v_fmac_f32 v32, v5, v40
v_fmac_f32 v33, v7, v40
v_lshlrev_b32 v5, 16, v147
v_and_b32 v7, 0xffff0000, v147
v_fmac_f32 v34, v5, v40
v_fmac_f32 v35, v7, v40
v_lshlrev_b32 v5, 16, v148
v_and_b32 v7, 0xffff0000, v148
v_fmac_f32 v36, v5, v40
v_fmac_f32 v37, v7, v40
v_lshlrev_b32 v5, 16, v149
v_and_b32 v7, 0xffff0000, v149
v_fmac_f32 v38, v5, v40
v_fmac_f32 v39, v7, v40
v_mul_f32 v41, v41, v6
v_lshlrev_b32 v5, 16, v150
v_and_b32 v7, 0xffff0000, v150
v_fmac_f32 v20, v5, v41
v_fmac_f32 v21, v7, v41
v_lshlrev_b32 v5, 16, v151
v_and_b32 v7, 0xffff0000, v151
v_fmac_f32 v22, v5, v41
v_fmac_f32 v23, v7, v41
v_lshlrev_b32 v5, 16, v152
v_and_b32 v7, 0xffff0000, v152
v_fmac_f32 v24, v5, v41
v_fmac_f32 v25, v7, v41
v_lshlrev_b32 v5, 16, v153
v_and_b32 v7, 0xffff0000, v153
v_fmac_f32 v26, v5, v41
v_fmac_f32 v27, v7, v41
v_lshlrev_b32 v5, 16, v154
v_and_b32 v7, 0xffff0000, v154
v_fmac_f32 v28, v5, v41
v_fmac_f32 v29, v7, v41
v_lshlrev_b32 v5, 16, v155
v_and_b32 v7, 0xffff0000, v155
v_fmac_f32 v30, v5, v41
v_fmac_f32 v31, v7, v41
v_lshlrev_b32 v5, 16, v156
v_and_b32 v7, 0xffff0000, v156
v_fmac_f32 v32, v5, v41
v_fmac_f32 v33, v7, v41
v_lshlrev_b32 v5, 16, v157
v_and_b32 v7, 0xffff0000, v157
v_fmac_f32 v34, v5, v41
v_fmac_f32 v35, v7, v41
v_lshlrev_b32 v5, 16, v158
v_and_b32 v7, 0xffff0000, v158
v_fmac_f32 v36, v5, v41
v_fmac_f32 v37, v7, v41
v_lshlrev_b32 v5, 16, v159
v_and_b32 v7, 0xffff0000, v159
v_fmac_f32 v38, v5, v41
v_fmac_f32 v39, v7, v41
v_mul_f32 v42, v42, v6
v_lshlrev_b32 v5, 16, v160
v_and_b32 v7, 0xffff0000, v160
v_fmac_f32 v20, v5, v42
v_fmac_f32 v21, v7, v42
v_lshlrev_b32 v5, 16, v161
v_and_b32 v7, 0xffff0000, v161
v_fmac_f32 v22, v5, v42
v_fmac_f32 v23, v7, v42
v_lshlrev_b32 v5, 16, v162
v_and_b32 v7, 0xffff0000, v162
v_fmac_f32 v24, v5, v42
v_fmac_f32 v25, v7, v42
v_lshlrev_b32 v5, 16, v163
v_and_b32 v7, 0xffff0000, v163
v_fmac_f32 v26, v5, v42
v_fmac_f32 v27, v7, v42
v_lshlrev_b32 v5, 16, v164
v_and_b32 v7, 0xffff0000, v164
v_fmac_f32 v28, v5, v42
v_fmac_f32 v29, v7, v42
v_lshlrev_b32 v5, 16, v165
v_and_b32 v7, 0xffff0000, v165
v_fmac_f32 v30, v5, v42
v_fmac_f32 v31, v7, v42
v_lshlrev_b32 v5, 16, v166
v_and_b32 v7, 0xffff0000, v166
v_fmac_f32 v32, v5, v42
v_fmac_f32 v33, v7, v42
v_lshlrev_b32 v5, 16, v167
v_and_b32 v7, 0xffff0000, v167
v_fmac_f32 v34, v5, v42
v_fmac_f32 v35, v7, v42
v_lshlrev_b32 v5, 16, v168
v_and_b32 v7, 0xffff0000, v168
v_fmac_f32 v36, v5, v42
v_fmac_f32 v37, v7, v42
v_lshlrev_b32 v5, 16, v169
v_and_b32 v7, 0xffff0000, v169
v_fmac_f32 v38, v5, v42
v_fmac_f32 v39, v7, v42
v_mul_f32 v43, v43, v6
v_lshlrev_b32 v5, 16, v170
v_and_b32 v7, 0xffff0000, v170
v_fmac_f32 v20, v5, v43
v_fmac_f32 v21, v7, v43
v_lshlrev_b32 v5, 16, v171
v_and_b32 v7, 0xffff0000, v171
v_fmac_f32 v22, v5, v43
v_fmac_f32 v23, v7, v43
v_lshlrev_b32 v5, 16, v172
v_and_b32 v7, 0xffff0000, v172
v_fmac_f32 v24, v5, v43
v_fmac_f32 v25, v7, v43
v_lshlrev_b32 v5, 16, v173
v_and_b32 v7, 0xffff0000, v173
v_fmac_f32 v26, v5, v43
v_fmac_f32 v27, v7, v43
v_lshlrev_b32 v5, 16, v174
v_and_b32 v7, 0xffff0000, v174
v_fmac_f32 v28, v5, v43
v_fmac_f32 v29, v7, v43
v_lshlrev_b32 v5, 16, v175
v_and_b32 v7, 0xffff0000, v175
v_fmac_f32 v30, v5, v43
v_fmac_f32 v31, v7, v43
v_lshlrev_b32 v5, 16, v176
v_and_b32 v7, 0xffff0000, v176
v_fmac_f32 v32, v5, v43
v_fmac_f32 v33, v7, v43
v_lshlrev_b32 v5, 16, v177
v_and_b32 v7, 0xffff0000, v177
v_fmac_f32 v34, v5, v43
v_fmac_f32 v35, v7, v43
v_lshlrev_b32 v5, 16, v178
v_and_b32 v7, 0xffff0000, v178
v_fmac_f32 v36, v5, v43
v_fmac_f32 v37, v7, v43
v_lshlrev_b32 v5, 16, v179
v_and_b32 v7, 0xffff0000, v179
v_fmac_f32 v38, v5, v43
v_fmac_f32 v39, v7, v43
v_mul_f32 v44, v44, v6
v_lshlrev_b32 v5, 16, v180
v_and_b32 v7, 0xffff0000, v180
v_fmac_f32 v20, v5, v44
v_fmac_f32 v21, v7, v44
v_lshlrev_b32 v5, 16, v181
v_and_b32 v7, 0xffff0000, v181
v_fmac_f32 v22, v5, v44
v_fmac_f32 v23, v7, v44
v_lshlrev_b32 v5, 16, v182
v_and_b32 v7, 0xffff0000, v182
v_fmac_f32 v24, v5, v44
v_fmac_f32 v25, v7, v44
v_lshlrev_b32 v5, 16, v183
v_and_b32 v7, 0xffff0000, v183
v_fmac_f32 v26, v5, v44
v_fmac_f32 v27, v7, v44
v_lshlrev_b32 v5, 16, v184
v_and_b32 v7, 0xffff0000, v184
v_fmac_f32 v28, v5, v44
v_fmac_f32 v29, v7, v44
v_lshlrev_b32 v5, 16, v185
v_and_b32 v7, 0xffff0000, v185
v_fmac_f32 v30, v5, v44
v_fmac_f32 v31, v7, v44
v_lshlrev_b32 v5, 16, v186
v_and_b32 v7, 0xffff0000, v186
v_fmac_f32 v32, v5, v44
v_fmac_f32 v33, v7, v44
v_lshlrev_b32 v5, 16, v187
v_and_b32 v7, 0xffff0000, v187
v_fmac_f32 v34, v5, v44
v_fmac_f32 v35, v7, v44
v_lshlrev_b32 v5, 16, v188
v_and_b32 v7, 0xffff0000, v188
v_fmac_f32 v36, v5, v44
v_fmac_f32 v37, v7, v44
v_lshlrev_b32 v5, 16, v189
v_and_b32 v7, 0xffff0000, v189
v_fmac_f32 v38, v5, v44
v_fmac_f32 v39, v7, v44
v_mul_f32 v45, v45, v6
v_lshlrev_b32 v5, 16, v190
v_and_b32 v7, 0xffff0000, v190
v_fmac_f32 v20, v5, v45
v_fmac_f32 v21, v7, v45
v_lshlrev_b32 v5, 16, v191
v_and_b32 v7, 0xffff0000, v191
v_fmac_f32 v22, v5, v45
v_fmac_f32 v23, v7, v45
v_lshlrev_b32 v5, 16, v192
v_and_b32 v7, 0xffff0000, v192
v_fmac_f32 v24, v5, v45
v_fmac_f32 v25, v7, v45
v_lshlrev_b32 v5, 16, v193
v_and_b32 v7, 0xffff0000, v193
v_fmac_f32 v26, v5, v45
v_fmac_f32 v27, v7, v45
v_lshlrev_b32 v5, 16, v194
v_and_b32 v7, 0xffff0000, v194
v_fmac_f32 v28, v5, v45
v_fmac_f32 v29, v7, v45
v_lshlrev_b32 v5, 16, v195
v_and_b32 v7, 0xffff0000, v195
v_fmac_f32 v30, v5, v45
v_fmac_f32 v31, v7, v45
v_lshlrev_b32 v5, 16, v196
v_and_b32 v7, 0xffff0000, v196
v_fmac_f32 v32, v5, v45
v_fmac_f32 v33, v7, v45
v_lshlrev_b32 v5, 16, v197
v_and_b32 v7, 0xffff0000, v197
v_fmac_f32 v34, v5, v45
v_fmac_f32 v35, v7, v45
v_lshlrev_b32 v5, 16, v198
v_and_b32 v7, 0xffff0000, v198
v_fmac_f32 v36, v5, v45
v_fmac_f32 v37, v7, v45
v_lshlrev_b32 v5, 16, v199
v_and_b32 v7, 0xffff0000, v199
v_fmac_f32 v38, v5, v45
v_fmac_f32 v39, v7, v45
v_mul_f32 v46, v46, v6
v_lshlrev_b32 v5, 16, v200
v_and_b32 v7, 0xffff0000, v200
v_fmac_f32 v20, v5, v46
v_fmac_f32 v21, v7, v46
v_lshlrev_b32 v5, 16, v201
v_and_b32 v7, 0xffff0000, v201
v_fmac_f32 v22, v5, v46
v_fmac_f32 v23, v7, v46
v_lshlrev_b32 v5, 16, v202
v_and_b32 v7, 0xffff0000, v202
v_fmac_f32 v24, v5, v46
v_fmac_f32 v25, v7, v46
v_lshlrev_b32 v5, 16, v203
v_and_b32 v7, 0xffff0000, v203
v_fmac_f32 v26, v5, v46
v_fmac_f32 v27, v7, v46
v_lshlrev_b32 v5, 16, v204
v_and_b32 v7, 0xffff0000, v204
v_fmac_f32 v28, v5, v46
v_fmac_f32 v29, v7, v46
v_lshlrev_b32 v5, 16, v205
v_and_b32 v7, 0xffff0000, v205
v_fmac_f32 v30, v5, v46
v_fmac_f32 v31, v7, v46
v_lshlrev_b32 v5, 16, v206
v_and_b32 v7, 0xffff0000, v206
v_fmac_f32 v32, v5, v46
v_fmac_f32 v33, v7, v46
v_lshlrev_b32 v5, 16, v207
v_and_b32 v7, 0xffff0000, v207
v_fmac_f32 v34, v5, v46
v_fmac_f32 v35, v7, v46
v_lshlrev_b32 v5, 16, v208
v_and_b32 v7, 0xffff0000, v208
v_fmac_f32 v36, v5, v46
v_fmac_f32 v37, v7, v46
v_lshlrev_b32 v5, 16, v209
v_and_b32 v7, 0xffff0000, v209
v_fmac_f32 v38, v5, v46
v_fmac_f32 v39, v7, v46
v_mul_f32 v47, v47, v6
v_lshlrev_b32 v5, 16, v210
v_and_b32 v7, 0xffff0000, v210
v_fmac_f32 v20, v5, v47
v_fmac_f32 v21, v7, v47
v_lshlrev_b32 v5, 16, v211
v_and_b32 v7, 0xffff0000, v211
v_fmac_f32 v22, v5, v47
v_fmac_f32 v23, v7, v47
v_lshlrev_b32 v5, 16, v212
v_and_b32 v7, 0xffff0000, v212
v_fmac_f32 v24, v5, v47
v_fmac_f32 v25, v7, v47
v_lshlrev_b32 v5, 16, v213
v_and_b32 v7, 0xffff0000, v213
v_fmac_f32 v26, v5, v47
v_fmac_f32 v27, v7, v47
v_lshlrev_b32 v5, 16, v214
v_and_b32 v7, 0xffff0000, v214
v_fmac_f32 v28, v5, v47
v_fmac_f32 v29, v7, v47
v_lshlrev_b32 v5, 16, v215
v_and_b32 v7, 0xffff0000, v215
v_fmac_f32 v30, v5, v47
v_fmac_f32 v31, v7, v47
v_lshlrev_b32 v5, 16, v216
v_and_b32 v7, 0xffff0000, v216
v_fmac_f32 v32, v5, v47
v_fmac_f32 v33, v7, v47
v_lshlrev_b32 v5, 16, v217
v_and_b32 v7, 0xffff0000, v217
v_fmac_f32 v34, v5, v47
v_fmac_f32 v35, v7, v47
v_lshlrev_b32 v5, 16, v218
v_and_b32 v7, 0xffff0000, v218
v_fmac_f32 v36, v5, v47
v_fmac_f32 v37, v7, v47
v_lshlrev_b32 v5, 16, v219
v_and_b32 v7, 0xffff0000, v219
v_fmac_f32 v38, v5, v47
v_fmac_f32 v39, v7, v47
v_mul_u32_u24 v4, 1280, v2
v_add_u32 v4, v4, v3
s_mov_b32 s8, 16777216
v_cvt_pk_bf16_f32 v10, v20, v21
v_cvt_pk_bf16_f32 v11, v22, v23
v_cvt_pk_bf16_f32 v12, v24, v25
v_cvt_pk_bf16_f32 v13, v26, v27
v_cvt_pk_bf16_f32 v14, v28, v29
v_cvt_pk_bf16_f32 v15, v30, v31
v_cvt_pk_bf16_f32 v16, v32, v33
v_cvt_pk_bf16_f32 v17, v34, v35
v_cvt_pk_bf16_f32 v18, v36, v37
v_cvt_pk_bf16_f32 v19, v38, v39
buffer_store_dwordx2 v[10:11], v4, s[4:7], s8 offen offset:0
buffer_store_dwordx2 v[12:13], v4, s[4:7], s8 offen offset:8
buffer_store_dwordx2 v[14:15], v4, s[4:7], s8 offen offset:16
buffer_store_dwordx2 v[16:17], v4, s[4:7], s8 offen offset:24
buffer_store_dwordx2 v[18:19], v4, s[4:7], s8 offen offset:32
s_waitcnt vmcnt(0)
attn_kernel_end:
s_endpgm
.globl wo_kernel
.p2align 8
.type wo_kernel,@function
wo_kernel:
s_cmp_ge_u32 s2, 320
s_cbranch_scc1 wo_kernel_end
s_load_dwordx2 s[4:5], s[0:1], 96
s_waitcnt lgkmcnt(0)
s_mov_b32 s6, 67108864
s_mov_b32 s7, 0x20000
s_and_b32 s8, s2, 31
s_lshr_b32 s9, s2, 5
v_lshrrev_b32 v1, 6, v0
v_and_b32 v2, 1, v1
v_lshrrev_b32 v3, 1, v1
s_lshl_b32 s8, s8, 6
s_lshl_b32 s9, s9, 6
v_lshl_add_u32 v2, v2, 5, s8
v_lshl_add_u32 v3, v3, 5, s9
v_and_b32 v4, 15, v0
v_bfe_u32 v5, v0, 4, 2
v_add_u32 v6, v2, v4
v_mul_u32_u24 v6, 1280, v6
v_lshl_add_u32 v6, v5, 4, v6
v_add_u32 v7, 20480, v6
v_add_u32 v8, v3, v4
v_mul_u32_u24 v8, 1280, v8
v_lshl_add_u32 v8, v5, 4, v8
v_add_u32 v9, 20480, v8
v_mov_b32 v40, 0
v_mov_b32 v41, 0
v_mov_b32 v42, 0
v_mov_b32 v43, 0
v_mov_b32 v44, 0
v_mov_b32 v45, 0
v_mov_b32 v46, 0
v_mov_b32 v47, 0
v_mov_b32 v48, 0
v_mov_b32 v49, 0
v_mov_b32 v50, 0
v_mov_b32 v51, 0
v_mov_b32 v52, 0
v_mov_b32 v53, 0
v_mov_b32 v54, 0
v_mov_b32 v55, 0
s_mov_b32 s10, 16777216
s_mov_b32 s11, 7340032
s_mov_b32 s12, 0
wo_kernel_loop:
buffer_load_dwordx4 v[60:63], v6, s[4:7], s10 offen offset:0
buffer_load_dwordx4 v[64:67], v7, s[4:7], s10 offen offset:0
buffer_load_dwordx4 v[68:71], v8, s[4:7], s11 offen offset:0
buffer_load_dwordx4 v[72:75], v9, s[4:7], s11 offen offset:0
buffer_load_dwordx4 v[76:79], v6, s[4:7], s10 offen offset:64
buffer_load_dwordx4 v[80:83], v7, s[4:7], s10 offen offset:64
buffer_load_dwordx4 v[84:87], v8, s[4:7], s11 offen offset:64
buffer_load_dwordx4 v[88:91], v9, s[4:7], s11 offen offset:64
s_waitcnt vmcnt(4)
v_mfma_f32_16x16x32_bf16 v[40:43], v[68:71], v[60:63], v[40:43]
v_mfma_f32_16x16x32_bf16 v[44:47], v[72:75], v[60:63], v[44:47]
v_mfma_f32_16x16x32_bf16 v[48:51], v[68:71], v[64:67], v[48:51]
v_mfma_f32_16x16x32_bf16 v[52:55], v[72:75], v[64:67], v[52:55]
s_waitcnt vmcnt(0)
v_mfma_f32_16x16x32_bf16 v[40:43], v[84:87], v[76:79], v[40:43]
v_mfma_f32_16x16x32_bf16 v[44:47], v[88:91], v[76:79], v[44:47]
v_mfma_f32_16x16x32_bf16 v[48:51], v[84:87], v[80:83], v[48:51]
v_mfma_f32_16x16x32_bf16 v[52:55], v[88:91], v[80:83], v[52:55]
s_add_u32 s10, s10, 128
s_add_u32 s11, s11, 128
s_add_u32 s12, s12, 1
s_cmp_lt_u32 s12, 10
s_cbranch_scc1 wo_kernel_loop
s_nop 7
s_nop 7
v_add_u32 v6, v2, v4
v_mul_u32_u24 v6, 2560, v6
v_lshl_add_u32 v7, v5, 2, v3
v_mul_u32_u24 v7, 4, v7
v_add_u32 v6, v6, v7
s_mov_b32 s10, 19922944
s_mov_b32 s11, 19963904
buffer_store_dwordx4 v[40:43], v6, s[4:7], s10 offen offset:0
buffer_store_dwordx4 v[44:47], v6, s[4:7], s10 offen offset:64
buffer_store_dwordx4 v[48:51], v6, s[4:7], s11 offen offset:0
buffer_store_dwordx4 v[52:55], v6, s[4:7], s11 offen offset:64
s_waitcnt vmcnt(0)
wo_kernel_end:
s_endpgm
.globl ln2_kernel
.p2align 8
.type ln2_kernel,@function
ln2_kernel:
s_cmp_ge_u32 s2, 512
s_cbranch_scc1 ln2_kernel_end
s_load_dwordx2 s[4:5], s[0:1], 0
s_load_dwordx2 s[8:9], s[0:1], 96
s_load_dwordx2 s[12:13], s[0:1], 32
s_load_dwordx2 s[16:17], s[0:1], 80
s_waitcnt lgkmcnt(0)
s_mov_b32 s6, 2621440
s_mov_b32 s7, 0x20000
s_mov_b32 s10, 67108864
s_mov_b32 s11, 0x20000
s_mov_b32 s14, 1280
s_mov_b32 s15, 0x20000
s_mov_b32 s18, 2621440
s_mov_b32 s19, 0x20000
v_lshrrev_b32 v1, 6, v0
s_lshl_b32 s3, s2, 2
v_add_u32 v1, s3, v1
v_and_b32 v2, 63, v0
v_mul_u32_u24 v3, 1280, v1
v_lshl_add_u32 v3, v2, 2, v3
v_lshlrev_b32 v4, 3, v2
v_lshlrev_b32 v5, 1, v3
buffer_load_dword v10, v3, s[4:7], 0 offen offset:0
buffer_load_dword v11, v3, s[4:7], 0 offen offset:256
buffer_load_dword v12, v3, s[4:7], 0 offen offset:512
buffer_load_dword v13, v3, s[4:7], 0 offen offset:768
buffer_load_dword v14, v3, s[4:7], 0 offen offset:1024
s_waitcnt vmcnt(0)
v_lshlrev_b32 v20, 16, v10
v_and_b32 v21, 0xffff0000, v10
v_lshlrev_b32 v22, 16, v11
v_and_b32 v23, 0xffff0000, v11
v_lshlrev_b32 v24, 16, v12
v_and_b32 v25, 0xffff0000, v12
v_lshlrev_b32 v26, 16, v13
v_and_b32 v27, 0xffff0000, v13
v_lshlrev_b32 v28, 16, v14
v_and_b32 v29, 0xffff0000, v14
s_mov_b32 s3, 19922944
buffer_load_dwordx2 v[50:51], v5, s[8:11], s3 offen offset:0
buffer_load_dwordx2 v[52:53], v5, s[8:11], s3 offen offset:512
buffer_load_dwordx2 v[54:55], v5, s[8:11], s3 offen offset:1024
buffer_load_dwordx2 v[56:57], v5, s[8:11], s3 offen offset:1536
buffer_load_dwordx2 v[58:59], v5, s[8:11], s3 offen offset:2048
s_mov_b32 s3, 5120
buffer_load_dwordx2 v[30:31], v4, s[8:11], s3 offen offset:0
buffer_load_dwordx2 v[32:33], v4, s[8:11], s3 offen offset:512
buffer_load_dwordx2 v[34:35], v4, s[8:11], s3 offen offset:1024
buffer_load_dwordx2 v[36:37], v4, s[8:11], s3 offen offset:1536
buffer_load_dwordx2 v[38:39], v4, s[8:11], s3 offen offset:2048
s_waitcnt vmcnt(0)
v_fma_f32 v50, v50, v30, v20
v_mov_b32 v20, v50
v_fma_f32 v51, v51, v31, v21
v_mov_b32 v21, v51
v_fma_f32 v52, v52, v32, v22
v_mov_b32 v22, v52
v_fma_f32 v53, v53, v33, v23
v_mov_b32 v23, v53
v_fma_f32 v54, v54, v34, v24
v_mov_b32 v24, v54
v_fma_f32 v55, v55, v35, v25
v_mov_b32 v25, v55
v_fma_f32 v56, v56, v36, v26
v_mov_b32 v26, v56
v_fma_f32 v57, v57, v37, v27
v_mov_b32 v27, v57
v_fma_f32 v58, v58, v38, v28
v_mov_b32 v28, v58
v_fma_f32 v59, v59, v39, v29
v_mov_b32 v29, v59
s_mov_b32 s3, 29360128
buffer_store_dwordx2 v[50:51], v5, s[8:11], s3 offen offset:0
buffer_store_dwordx2 v[52:53], v5, s[8:11], s3 offen offset:512
buffer_store_dwordx2 v[54:55], v5, s[8:11], s3 offen offset:1024
buffer_store_dwordx2 v[56:57], v5, s[8:11], s3 offen offset:1536
buffer_store_dwordx2 v[58:59], v5, s[8:11], s3 offen offset:2048
v_mov_b32 v6, 0
v_add_f32 v6, v6, v20
v_add_f32 v6, v6, v21
v_add_f32 v6, v6, v22
v_add_f32 v6, v6, v23
v_add_f32 v6, v6, v24
v_add_f32 v6, v6, v25
v_add_f32 v6, v6, v26
v_add_f32 v6, v6, v27
v_add_f32 v6, v6, v28
v_add_f32 v6, v6, v29
ds_swizzle_b32 v7, v6 offset:1055
s_waitcnt lgkmcnt(0)
v_add_f32 v6, v6, v7
ds_swizzle_b32 v7, v6 offset:2079
s_waitcnt lgkmcnt(0)
v_add_f32 v6, v6, v7
ds_swizzle_b32 v7, v6 offset:4127
s_waitcnt lgkmcnt(0)
v_add_f32 v6, v6, v7
ds_swizzle_b32 v7, v6 offset:8223
s_waitcnt lgkmcnt(0)
v_add_f32 v6, v6, v7
ds_swizzle_b32 v7, v6 offset:16415
s_waitcnt lgkmcnt(0)
v_add_f32 v6, v6, v7
v_mov_b32 v7, v6
s_nop 1
v_permlane32_swap_b32 v6, v7
s_nop 1
v_add_f32 v6, v6, v7
v_mul_f32 v6, 0x3acccccd, v6
v_mov_b32 v8, 0
v_sub_f32 v20, v20, v6
v_fmac_f32 v8, v20, v20
v_sub_f32 v21, v21, v6
v_fmac_f32 v8, v21, v21
v_sub_f32 v22, v22, v6
v_fmac_f32 v8, v22, v22
v_sub_f32 v23, v23, v6
v_fmac_f32 v8, v23, v23
v_sub_f32 v24, v24, v6
v_fmac_f32 v8, v24, v24
v_sub_f32 v25, v25, v6
v_fmac_f32 v8, v25, v25
v_sub_f32 v26, v26, v6
v_fmac_f32 v8, v26, v26
v_sub_f32 v27, v27, v6
v_fmac_f32 v8, v27, v27
v_sub_f32 v28, v28, v6
v_fmac_f32 v8, v28, v28
v_sub_f32 v29, v29, v6
v_fmac_f32 v8, v29, v29
ds_swizzle_b32 v7, v8 offset:1055
s_waitcnt lgkmcnt(0)
v_add_f32 v8, v8, v7
ds_swizzle_b32 v7, v8 offset:2079
s_waitcnt lgkmcnt(0)
v_add_f32 v8, v8, v7
ds_swizzle_b32 v7, v8 offset:4127
s_waitcnt lgkmcnt(0)
v_add_f32 v8, v8, v7
ds_swizzle_b32 v7, v8 offset:8223
s_waitcnt lgkmcnt(0)
v_add_f32 v8, v8, v7
ds_swizzle_b32 v7, v8 offset:16415
s_waitcnt lgkmcnt(0)
v_add_f32 v8, v8, v7
v_mov_b32 v7, v8
s_nop 1
v_permlane32_swap_b32 v8, v7
s_nop 1
v_add_f32 v8, v8, v7
v_mov_b32 v7, 0x3727c5ac
v_fmac_f32 v7, 0x3acccccd, v8
v_rsq_f32 v7, v7
s_nop 0
v_mul_f32 v20, v20, v7
v_mul_f32 v21, v21, v7
v_mul_f32 v22, v22, v7
v_mul_f32 v23, v23, v7
v_mul_f32 v24, v24, v7
v_mul_f32 v25, v25, v7
v_mul_f32 v26, v26, v7
v_mul_f32 v27, v27, v7
v_mul_f32 v28, v28, v7
v_mul_f32 v29, v29, v7
s_mov_b32 s3, 7680
buffer_load_dwordx2 v[30:31], v4, s[8:11], s3 offen offset:0
buffer_load_dwordx2 v[32:33], v4, s[8:11], s3 offen offset:512
buffer_load_dwordx2 v[34:35], v4, s[8:11], s3 offen offset:1024
buffer_load_dwordx2 v[36:37], v4, s[8:11], s3 offen offset:1536
buffer_load_dwordx2 v[38:39], v4, s[8:11], s3 offen offset:2048
s_waitcnt vmcnt(0)
s_mov_b32 s3, 10240
buffer_load_dwordx2 v[40:41], v4, s[8:11], s3 offen offset:0
buffer_load_dwordx2 v[42:43], v4, s[8:11], s3 offen offset:512
buffer_load_dwordx2 v[44:45], v4, s[8:11], s3 offen offset:1024
buffer_load_dwordx2 v[46:47], v4, s[8:11], s3 offen offset:1536
buffer_load_dwordx2 v[48:49], v4, s[8:11], s3 offen offset:2048
s_waitcnt vmcnt(0)
v_fma_f32 v20, v20, v40, v30
v_fma_f32 v21, v21, v41, v31
v_fma_f32 v22, v22, v42, v32
v_fma_f32 v23, v23, v43, v33
v_fma_f32 v24, v24, v44, v34
v_fma_f32 v25, v25, v45, v35
v_fma_f32 v26, v26, v46, v36
v_fma_f32 v27, v27, v47, v37
v_fma_f32 v28, v28, v48, v38
v_fma_f32 v29, v29, v49, v39
s_mov_b32 s3, 26214400
v_cvt_pk_bf16_f32 v10, v20, v21
buffer_store_dword v10, v3, s[8:11], s3 offen offset:0
v_cvt_pk_bf16_f32 v11, v22, v23
buffer_store_dword v11, v3, s[8:11], s3 offen offset:256
v_cvt_pk_bf16_f32 v12, v24, v25
buffer_store_dword v12, v3, s[8:11], s3 offen offset:512
v_cvt_pk_bf16_f32 v13, v26, v27
buffer_store_dword v13, v3, s[8:11], s3 offen offset:768
v_cvt_pk_bf16_f32 v14, v28, v29
buffer_store_dword v14, v3, s[8:11], s3 offen offset:1024
v_lshlrev_b32 v9, 2, v2
buffer_load_dword v60, v9, s[12:15], 0 offen offset:0
buffer_load_dword v61, v9, s[12:15], 0 offen offset:256
buffer_load_dword v62, v9, s[12:15], 0 offen offset:512
buffer_load_dword v63, v9, s[12:15], 0 offen offset:768
buffer_load_dword v64, v9, s[12:15], 0 offen offset:1024
s_waitcnt vmcnt(0)
v_lshlrev_b32 v30, 16, v60
v_and_b32 v31, 0xffff0000, v60
v_lshlrev_b32 v32, 16, v61
v_and_b32 v33, 0xffff0000, v61
v_lshlrev_b32 v34, 16, v62
v_and_b32 v35, 0xffff0000, v62
v_lshlrev_b32 v36, 16, v63
v_and_b32 v37, 0xffff0000, v63
v_lshlrev_b32 v38, 16, v64
v_and_b32 v39, 0xffff0000, v64
v_mov_b32 v6, 0
v_fmac_f32 v6, v20, v30
v_fmac_f32 v6, v21, v31
v_fmac_f32 v6, v22, v32
v_fmac_f32 v6, v23, v33
v_fmac_f32 v6, v24, v34
v_fmac_f32 v6, v25, v35
v_fmac_f32 v6, v26, v36
v_fmac_f32 v6, v27, v37
v_fmac_f32 v6, v28, v38
v_fmac_f32 v6, v29, v39
ds_swizzle_b32 v7, v6 offset:1055
s_waitcnt lgkmcnt(0)
v_add_f32 v6, v6, v7
ds_swizzle_b32 v7, v6 offset:2079
s_waitcnt lgkmcnt(0)
v_add_f32 v6, v6, v7
ds_swizzle_b32 v7, v6 offset:4127
s_waitcnt lgkmcnt(0)
v_add_f32 v6, v6, v7
ds_swizzle_b32 v7, v6 offset:8223
s_waitcnt lgkmcnt(0)
v_add_f32 v6, v6, v7
ds_swizzle_b32 v7, v6 offset:16415
s_waitcnt lgkmcnt(0)
v_add_f32 v6, v6, v7
v_mov_b32 v7, v6
s_nop 1
v_permlane32_swap_b32 v6, v7
s_nop 1
v_add_f32 v6, v6, v7
v_lshlrev_b32 v7, 2, v1
s_mov_b32 s3, 65536
buffer_store_dword v6, v7, s[8:11], s3 offen
s_mov_b32 s3, 12800
buffer_load_dwordx2 v[30:31], v4, s[8:11], s3 offen offset:0
buffer_load_dwordx2 v[32:33], v4, s[8:11], s3 offen offset:512
buffer_load_dwordx2 v[34:35], v4, s[8:11], s3 offen offset:1024
buffer_load_dwordx2 v[36:37], v4, s[8:11], s3 offen offset:1536
buffer_load_dwordx2 v[38:39], v4, s[8:11], s3 offen offset:2048
s_waitcnt vmcnt(0)
v_fma_f32 v20, v20, v30, v50
v_fma_f32 v21, v21, v31, v51
v_fma_f32 v22, v22, v32, v52
v_fma_f32 v23, v23, v33, v53
v_fma_f32 v24, v24, v34, v54
v_fma_f32 v25, v25, v35, v55
v_fma_f32 v26, v26, v36, v56
v_fma_f32 v27, v27, v37, v57
v_fma_f32 v28, v28, v38, v58
v_fma_f32 v29, v29, v39, v59
v_cvt_pk_bf16_f32 v10, v20, v21
buffer_store_dword v10, v3, s[16:19], 0 offen offset:0
v_cvt_pk_bf16_f32 v11, v22, v23
buffer_store_dword v11, v3, s[16:19], 0 offen offset:256
v_cvt_pk_bf16_f32 v12, v24, v25
buffer_store_dword v12, v3, s[16:19], 0 offen offset:512
v_cvt_pk_bf16_f32 v13, v26, v27
buffer_store_dword v13, v3, s[16:19], 0 offen offset:768
v_cvt_pk_bf16_f32 v14, v28, v29
buffer_store_dword v14, v3, s[16:19], 0 offen offset:1024
s_waitcnt vmcnt(0)
ln2_kernel_end:
s_endpgm
.globl gu_kernel
.p2align 8
.type gu_kernel,@function
gu_kernel:
s_cmp_ge_u32 s2, 27
s_cbranch_scc1 gu_kernel_end
s_load_dwordx2 s[4:5], s[0:1], 96
s_load_dwordx2 s[8:9], s[0:1], 40
s_load_dwordx2 s[12:13], s[0:1], 48
s_waitcnt lgkmcnt(0)
s_mov_b32 s6, 67108864
s_mov_b32 s7, 0x20000
s_mov_b32 s10, 2211840
s_mov_b32 s11, 0x20000
s_mov_b32 s14, 2211840
s_mov_b32 s15, 0x20000
v_and_b32 v1, 63, v0
v_lshlrev_b32 v2, 2, v1
s_mov_b32 s3, 65536
v_mov_b32 v9, 0xff800000
v_mov_b32 v8, 0
buffer_load_dword v20, v2, s[4:7], s3 offen offset:0
buffer_load_dword v21, v2, s[4:7], s3 offen offset:256
buffer_load_dword v22, v2, s[4:7], s3 offen offset:512
buffer_load_dword v23, v2, s[4:7], s3 offen offset:768
buffer_load_dword v24, v2, s[4:7], s3 offen offset:1024
buffer_load_dword v25, v2, s[4:7], s3 offen offset:1280
buffer_load_dword v26, v2, s[4:7], s3 offen offset:1536
buffer_load_dword v27, v2, s[4:7], s3 offen offset:1792
buffer_load_dword v28, v2, s[4:7], s3 offen offset:2048
buffer_load_dword v29, v2, s[4:7], s3 offen offset:2304
buffer_load_dword v30, v2, s[4:7], s3 offen offset:2560
buffer_load_dword v31, v2, s[4:7], s3 offen offset:2816
buffer_load_dword v32, v2, s[4:7], s3 offen offset:3072
buffer_load_dword v33, v2, s[4:7], s3 offen offset:3328
buffer_load_dword v34, v2, s[4:7], s3 offen offset:3584
buffer_load_dword v35, v2, s[4:7], s3 offen offset:3840
s_add_u32 s3, s3, 4096
buffer_load_dword v36, v2, s[4:7], s3 offen offset:0
buffer_load_dword v37, v2, s[4:7], s3 offen offset:256
buffer_load_dword v38, v2, s[4:7], s3 offen offset:512
buffer_load_dword v39, v2, s[4:7], s3 offen offset:768
buffer_load_dword v40, v2, s[4:7], s3 offen offset:1024
buffer_load_dword v41, v2, s[4:7], s3 offen offset:1280
buffer_load_dword v42, v2, s[4:7], s3 offen offset:1536
buffer_load_dword v43, v2, s[4:7], s3 offen offset:1792
buffer_load_dword v44, v2, s[4:7], s3 offen offset:2048
buffer_load_dword v45, v2, s[4:7], s3 offen offset:2304
buffer_load_dword v46, v2, s[4:7], s3 offen offset:2560
buffer_load_dword v47, v2, s[4:7], s3 offen offset:2816
buffer_load_dword v48, v2, s[4:7], s3 offen offset:3072
buffer_load_dword v49, v2, s[4:7], s3 offen offset:3328
buffer_load_dword v50, v2, s[4:7], s3 offen offset:3584
buffer_load_dword v51, v2, s[4:7], s3 offen offset:3840
s_waitcnt vmcnt(0)
v_add_u32 v3, 0, v1
v_cmp_gt_f32 vcc, v20, v9
s_nop 1
v_cndmask_b32 v9, v9, v20, vcc
v_cndmask_b32 v8, v8, v3, vcc
v_add_u32 v3, 64, v1
v_cmp_gt_f32 vcc, v21, v9
s_nop 1
v_cndmask_b32 v9, v9, v21, vcc
v_cndmask_b32 v8, v8, v3, vcc
v_add_u32 v3, 128, v1
v_cmp_gt_f32 vcc, v22, v9
s_nop 1
v_cndmask_b32 v9, v9, v22, vcc
v_cndmask_b32 v8, v8, v3, vcc
v_add_u32 v3, 192, v1
v_cmp_gt_f32 vcc, v23, v9
s_nop 1
v_cndmask_b32 v9, v9, v23, vcc
v_cndmask_b32 v8, v8, v3, vcc
v_add_u32 v3, 256, v1
v_cmp_gt_f32 vcc, v24, v9
s_nop 1
v_cndmask_b32 v9, v9, v24, vcc
v_cndmask_b32 v8, v8, v3, vcc
v_add_u32 v3, 320, v1
v_cmp_gt_f32 vcc, v25, v9
s_nop 1
v_cndmask_b32 v9, v9, v25, vcc
v_cndmask_b32 v8, v8, v3, vcc
v_add_u32 v3, 384, v1
v_cmp_gt_f32 vcc, v26, v9
s_nop 1
v_cndmask_b32 v9, v9, v26, vcc
v_cndmask_b32 v8, v8, v3, vcc
v_add_u32 v3, 448, v1
v_cmp_gt_f32 vcc, v27, v9
s_nop 1
v_cndmask_b32 v9, v9, v27, vcc
v_cndmask_b32 v8, v8, v3, vcc
v_add_u32 v3, 512, v1
v_cmp_gt_f32 vcc, v28, v9
s_nop 1
v_cndmask_b32 v9, v9, v28, vcc
v_cndmask_b32 v8, v8, v3, vcc
v_add_u32 v3, 576, v1
v_cmp_gt_f32 vcc, v29, v9
s_nop 1
v_cndmask_b32 v9, v9, v29, vcc
v_cndmask_b32 v8, v8, v3, vcc
v_add_u32 v3, 640, v1
v_cmp_gt_f32 vcc, v30, v9
s_nop 1
v_cndmask_b32 v9, v9, v30, vcc
v_cndmask_b32 v8, v8, v3, vcc
v_add_u32 v3, 704, v1
v_cmp_gt_f32 vcc, v31, v9
s_nop 1
v_cndmask_b32 v9, v9, v31, vcc
v_cndmask_b32 v8, v8, v3, vcc
v_add_u32 v3, 768, v1
v_cmp_gt_f32 vcc, v32, v9
s_nop 1
v_cndmask_b32 v9, v9, v32, vcc
v_cndmask_b32 v8, v8, v3, vcc
v_add_u32 v3, 832, v1
v_cmp_gt_f32 vcc, v33, v9
s_nop 1
v_cndmask_b32 v9, v9, v33, vcc
v_cndmask_b32 v8, v8, v3, vcc
v_add_u32 v3, 896, v1
v_cmp_gt_f32 vcc, v34, v9
s_nop 1
v_cndmask_b32 v9, v9, v34, vcc
v_cndmask_b32 v8, v8, v3, vcc
v_add_u32 v3, 960, v1
v_cmp_gt_f32 vcc, v35, v9
s_nop 1
v_cndmask_b32 v9, v9, v35, vcc
v_cndmask_b32 v8, v8, v3, vcc
v_add_u32 v3, 1024, v1
v_cmp_gt_f32 vcc, v36, v9
s_nop 1
v_cndmask_b32 v9, v9, v36, vcc
v_cndmask_b32 v8, v8, v3, vcc
v_add_u32 v3, 1088, v1
v_cmp_gt_f32 vcc, v37, v9
s_nop 1
v_cndmask_b32 v9, v9, v37, vcc
v_cndmask_b32 v8, v8, v3, vcc
v_add_u32 v3, 1152, v1
v_cmp_gt_f32 vcc, v38, v9
s_nop 1
v_cndmask_b32 v9, v9, v38, vcc
v_cndmask_b32 v8, v8, v3, vcc
v_add_u32 v3, 1216, v1
v_cmp_gt_f32 vcc, v39, v9
s_nop 1
v_cndmask_b32 v9, v9, v39, vcc
v_cndmask_b32 v8, v8, v3, vcc
v_add_u32 v3, 1280, v1
v_cmp_gt_f32 vcc, v40, v9
s_nop 1
v_cndmask_b32 v9, v9, v40, vcc
v_cndmask_b32 v8, v8, v3, vcc
v_add_u32 v3, 1344, v1
v_cmp_gt_f32 vcc, v41, v9
s_nop 1
v_cndmask_b32 v9, v9, v41, vcc
v_cndmask_b32 v8, v8, v3, vcc
v_add_u32 v3, 1408, v1
v_cmp_gt_f32 vcc, v42, v9
s_nop 1
v_cndmask_b32 v9, v9, v42, vcc
v_cndmask_b32 v8, v8, v3, vcc
v_add_u32 v3, 1472, v1
v_cmp_gt_f32 vcc, v43, v9
s_nop 1
v_cndmask_b32 v9, v9, v43, vcc
v_cndmask_b32 v8, v8, v3, vcc
v_add_u32 v3, 1536, v1
v_cmp_gt_f32 vcc, v44, v9
s_nop 1
v_cndmask_b32 v9, v9, v44, vcc
v_cndmask_b32 v8, v8, v3, vcc
v_add_u32 v3, 1600, v1
v_cmp_gt_f32 vcc, v45, v9
s_nop 1
v_cndmask_b32 v9, v9, v45, vcc
v_cndmask_b32 v8, v8, v3, vcc
v_add_u32 v3, 1664, v1
v_cmp_gt_f32 vcc, v46, v9
s_nop 1
v_cndmask_b32 v9, v9, v46, vcc
v_cndmask_b32 v8, v8, v3, vcc
v_add_u32 v3, 1728, v1
v_cmp_gt_f32 vcc, v47, v9
s_nop 1
v_cndmask_b32 v9, v9, v47, vcc
v_cndmask_b32 v8, v8, v3, vcc
v_add_u32 v3, 1792, v1
v_cmp_gt_f32 vcc, v48, v9
s_nop 1
v_cndmask_b32 v9, v9, v48, vcc
v_cndmask_b32 v8, v8, v3, vcc
v_add_u32 v3, 1856, v1
v_cmp_gt_f32 vcc, v49, v9
s_nop 1
v_cndmask_b32 v9, v9, v49, vcc
v_cndmask_b32 v8, v8, v3, vcc
v_add_u32 v3, 1920, v1
v_cmp_gt_f32 vcc, v50, v9
s_nop 1
v_cndmask_b32 v9, v9, v50, vcc
v_cndmask_b32 v8, v8, v3, vcc
v_add_u32 v3, 1984, v1
v_cmp_gt_f32 vcc, v51, v9
s_nop 1
v_cndmask_b32 v9, v9, v51, vcc
v_cndmask_b32 v8, v8, v3, vcc
v_mov_b32 v6, v9
ds_swizzle_b32 v7, v6 offset:1055
s_waitcnt lgkmcnt(0)
v_max_f32 v6, v6, v7
ds_swizzle_b32 v7, v6 offset:2079
s_waitcnt lgkmcnt(0)
v_max_f32 v6, v6, v7
ds_swizzle_b32 v7, v6 offset:4127
s_waitcnt lgkmcnt(0)
v_max_f32 v6, v6, v7
ds_swizzle_b32 v7, v6 offset:8223
s_waitcnt lgkmcnt(0)
v_max_f32 v6, v6, v7
ds_swizzle_b32 v7, v6 offset:16415
s_waitcnt lgkmcnt(0)
v_max_f32 v6, v6, v7
v_mov_b32 v7, v6
s_nop 1
v_permlane32_swap_b32 v6, v7
s_nop 1
v_max_f32 v6, v6, v7
v_cmp_eq_f32 vcc, v6, v9
s_nop 4
s_ff1_i32_b64 s43, vcc
s_nop 4
v_readlane_b32 s42, v8, s43
v_mov_b32 v9, v6
s_nop 4
s_mul_i32 s3, s42, 1280
s_add_u32 s3, s3, 26214400
v_add_u32 v1, 0, v0
v_lshlrev_b32 v2, 1, v1
buffer_load_ushort v3, v2, s[4:7], s3 offen
s_waitcnt vmcnt(0)
v_lshlrev_b32 v3, 16, v3
v_lshlrev_b32 v2, 2, v1
ds_write_b32 v2, v3
v_add_u32 v1, 256, v0
v_lshlrev_b32 v2, 1, v1
buffer_load_ushort v3, v2, s[4:7], s3 offen
s_waitcnt vmcnt(0)
v_lshlrev_b32 v3, 16, v3
v_lshlrev_b32 v2, 2, v1
ds_write_b32 v2, v3
v_add_u32 v1, 512, v0
v_lshlrev_b32 v2, 1, v1
buffer_load_ushort v3, v2, s[4:7], s3 offen
s_waitcnt vmcnt(0)
v_lshlrev_b32 v3, 16, v3
v_lshlrev_b32 v2, 2, v1
ds_write_b32 v2, v3
s_waitcnt lgkmcnt(0)
s_barrier
v_and_b32 v1, 31, v0
v_lshrrev_b32 v2, 5, v0
s_lshl_b32 s3, s2, 7
v_mul_u32_u24 v3, 276480, v2
v_lshl_add_u32 v3, v1, 2, v3
v_add_u32 v3, s3, v3
v_mul_u32_u24 v4, 320, v2
v_mov_b32 v10, 0
v_mov_b32 v11, 0
s_mov_b32 s40, 0
s_mov_b32 s41, 0
gu_kernel_g10:
buffer_load_dword v20, v3, s[8:11], s41 offen
s_add_u32 s41, s41, 3456
buffer_load_dword v21, v3, s[8:11], s41 offen
s_add_u32 s41, s41, 3456
buffer_load_dword v22, v3, s[8:11], s41 offen
s_add_u32 s41, s41, 3456
buffer_load_dword v23, v3, s[8:11], s41 offen
s_add_u32 s41, s41, 3456
buffer_load_dword v24, v3, s[8:11], s41 offen
s_add_u32 s41, s41, 3456
buffer_load_dword v25, v3, s[8:11], s41 offen
s_add_u32 s41, s41, 3456
buffer_load_dword v26, v3, s[8:11], s41 offen
s_add_u32 s41, s41, 3456
buffer_load_dword v27, v3, s[8:11], s41 offen
s_add_u32 s41, s41, 3456
ds_read_b128 v[32:35], v4
ds_read_b128 v[36:39], v4 offset:16
v_add_u32 v4, 32, v4
s_waitcnt vmcnt(0) lgkmcnt(0)
v_lshlrev_b32 v5, 16, v20
v_and_b32 v6, 0xffff0000, v20
v_fmac_f32 v10, v5, v32
v_fmac_f32 v11, v6, v32
v_lshlrev_b32 v5, 16, v21
v_and_b32 v6, 0xffff0000, v21
v_fmac_f32 v10, v5, v33
v_fmac_f32 v11, v6, v33
v_lshlrev_b32 v5, 16, v22
v_and_b32 v6, 0xffff0000, v22
v_fmac_f32 v10, v5, v34
v_fmac_f32 v11, v6, v34
v_lshlrev_b32 v5, 16, v23
v_and_b32 v6, 0xffff0000, v23
v_fmac_f32 v10, v5, v35
v_fmac_f32 v11, v6, v35
v_lshlrev_b32 v5, 16, v24
v_and_b32 v6, 0xffff0000, v24
v_fmac_f32 v10, v5, v36
v_fmac_f32 v11, v6, v36
v_lshlrev_b32 v5, 16, v25
v_and_b32 v6, 0xffff0000, v25
v_fmac_f32 v10, v5, v37
v_fmac_f32 v11, v6, v37
v_lshlrev_b32 v5, 16, v26
v_and_b32 v6, 0xffff0000, v26
v_fmac_f32 v10, v5, v38
v_fmac_f32 v11, v6, v38
v_lshlrev_b32 v5, 16, v27
v_and_b32 v6, 0xffff0000, v27
v_fmac_f32 v10, v5, v39
v_fmac_f32 v11, v6, v39
s_add_u32 s40, s40, 8
s_cmp_lt_u32 s40, 80
s_cbranch_scc1 gu_kernel_g10
v_lshlrev_b32 v5, 3, v0
s_barrier
ds_write_b64 v5, v[10:11] offset:8192
s_waitcnt lgkmcnt(0)
s_barrier
v_and_b32 v5, 63, v0
v_lshlrev_b32 v5, 2, v5
v_mov_b32 v10, 0
ds_read_b32 v6, v5 offset:8192
s_waitcnt lgkmcnt(0)
v_add_f32 v10, v10, v6
ds_read_b32 v6, v5 offset:8448
s_waitcnt lgkmcnt(0)
v_add_f32 v10, v10, v6
ds_read_b32 v6, v5 offset:8704
s_waitcnt lgkmcnt(0)
v_add_f32 v10, v10, v6
ds_read_b32 v6, v5 offset:8960
s_waitcnt lgkmcnt(0)
v_add_f32 v10, v10, v6
ds_read_b32 v6, v5 offset:9216
s_waitcnt lgkmcnt(0)
v_add_f32 v10, v10, v6
ds_read_b32 v6, v5 offset:9472
s_waitcnt lgkmcnt(0)
v_add_f32 v10, v10, v6
ds_read_b32 v6, v5 offset:9728
s_waitcnt lgkmcnt(0)
v_add_f32 v10, v10, v6
ds_read_b32 v6, v5 offset:9984
s_waitcnt lgkmcnt(0)
v_add_f32 v10, v10, v6
v_and_b32 v1, 31, v0
v_lshrrev_b32 v2, 5, v0
s_lshl_b32 s3, s2, 7
v_mul_u32_u24 v3, 276480, v2
v_lshl_add_u32 v3, v1, 2, v3
v_add_u32 v3, s3, v3
v_mul_u32_u24 v4, 320, v2
v_mov_b32 v12, 0
v_mov_b32 v13, 0
s_mov_b32 s40, 0
s_mov_b32 s41, 0
gu_kernel_g12:
buffer_load_dword v20, v3, s[12:15], s41 offen
s_add_u32 s41, s41, 3456
buffer_load_dword v21, v3, s[12:15], s41 offen
s_add_u32 s41, s41, 3456
buffer_load_dword v22, v3, s[12:15], s41 offen
s_add_u32 s41, s41, 3456
buffer_load_dword v23, v3, s[12:15], s41 offen
s_add_u32 s41, s41, 3456
buffer_load_dword v24, v3, s[12:15], s41 offen
s_add_u32 s41, s41, 3456
buffer_load_dword v25, v3, s[12:15], s41 offen
s_add_u32 s41, s41, 3456
buffer_load_dword v26, v3, s[12:15], s41 offen
s_add_u32 s41, s41, 3456
buffer_load_dword v27, v3, s[12:15], s41 offen
s_add_u32 s41, s41, 3456
ds_read_b128 v[32:35], v4
ds_read_b128 v[36:39], v4 offset:16
v_add_u32 v4, 32, v4
s_waitcnt vmcnt(0) lgkmcnt(0)
v_lshlrev_b32 v5, 16, v20
v_and_b32 v6, 0xffff0000, v20
v_fmac_f32 v12, v5, v32
v_fmac_f32 v13, v6, v32
v_lshlrev_b32 v5, 16, v21
v_and_b32 v6, 0xffff0000, v21
v_fmac_f32 v12, v5, v33
v_fmac_f32 v13, v6, v33
v_lshlrev_b32 v5, 16, v22
v_and_b32 v6, 0xffff0000, v22
v_fmac_f32 v12, v5, v34
v_fmac_f32 v13, v6, v34
v_lshlrev_b32 v5, 16, v23
v_and_b32 v6, 0xffff0000, v23
v_fmac_f32 v12, v5, v35
v_fmac_f32 v13, v6, v35
v_lshlrev_b32 v5, 16, v24
v_and_b32 v6, 0xffff0000, v24
v_fmac_f32 v12, v5, v36
v_fmac_f32 v13, v6, v36
v_lshlrev_b32 v5, 16, v25
v_and_b32 v6, 0xffff0000, v25
v_fmac_f32 v12, v5, v37
v_fmac_f32 v13, v6, v37
v_lshlrev_b32 v5, 16, v26
v_and_b32 v6, 0xffff0000, v26
v_fmac_f32 v12, v5, v38
v_fmac_f32 v13, v6, v38
v_lshlrev_b32 v5, 16, v27
v_and_b32 v6, 0xffff0000, v27
v_fmac_f32 v12, v5, v39
v_fmac_f32 v13, v6, v39
s_add_u32 s40, s40, 8
s_cmp_lt_u32 s40, 80
s_cbranch_scc1 gu_kernel_g12
v_lshlrev_b32 v5, 3, v0
s_barrier
ds_write_b64 v5, v[12:13] offset:8192
s_waitcnt lgkmcnt(0)
s_barrier
v_and_b32 v5, 63, v0
v_lshlrev_b32 v5, 2, v5
v_mov_b32 v12, 0
ds_read_b32 v6, v5 offset:8192
s_waitcnt lgkmcnt(0)
v_add_f32 v12, v12, v6
ds_read_b32 v6, v5 offset:8448
s_waitcnt lgkmcnt(0)
v_add_f32 v12, v12, v6
ds_read_b32 v6, v5 offset:8704
s_waitcnt lgkmcnt(0)
v_add_f32 v12, v12, v6
ds_read_b32 v6, v5 offset:8960
s_waitcnt lgkmcnt(0)
v_add_f32 v12, v12, v6
ds_read_b32 v6, v5 offset:9216
s_waitcnt lgkmcnt(0)
v_add_f32 v12, v12, v6
ds_read_b32 v6, v5 offset:9472
s_waitcnt lgkmcnt(0)
v_add_f32 v12, v12, v6
ds_read_b32 v6, v5 offset:9728
s_waitcnt lgkmcnt(0)
v_add_f32 v12, v12, v6
ds_read_b32 v6, v5 offset:9984
s_waitcnt lgkmcnt(0)
v_add_f32 v12, v12, v6
v_cvt_pk_bf16_f32 v10, v10, v10
v_lshlrev_b32 v10, 16, v10
v_mul_f32 v6, 0xbfb8aa3b, v10
v_exp_f32 v6, v6
s_nop 0
v_add_f32 v6, 1.0, v6
v_rcp_f32 v6, v6
s_nop 0
v_mul_f32 v10, v10, v6
v_cvt_pk_bf16_f32 v10, v10, v10
v_lshlrev_b32 v10, 16, v10
v_cvt_pk_bf16_f32 v12, v12, v12
v_lshlrev_b32 v12, 16, v12
v_mul_f32 v10, v10, v12
v_cvt_pk_bf16_f32 v10, v10, v10
v_lshlrev_b32 v10, 16, v10
s_lshl_b32 s3, s2, 8
s_add_u32 s3, s3, 131072
buffer_store_dword v10, v5, s[4:7], s3 offen
s_waitcnt vmcnt(0)
gu_kernel_end:
s_endpgm
.globl down_kernel
.p2align 8
.type down_kernel,@function
down_kernel:
s_cmp_ge_u32 s2, 10
s_cbranch_scc1 down_kernel_end
s_load_dwordx2 s[4:5], s[0:1], 96
s_load_dwordx2 s[8:9], s[0:1], 56
s_load_dwordx2 s[12:13], s[0:1], 80
s_waitcnt lgkmcnt(0)
s_mov_b32 s6, 67108864
s_mov_b32 s7, 0x20000
s_mov_b32 s10, 2211840
s_mov_b32 s11, 0x20000
s_mov_b32 s14, 2621440
s_mov_b32 s15, 0x20000
v_and_b32 v1, 63, v0
v_lshlrev_b32 v2, 2, v1
s_mov_b32 s3, 65536
v_mov_b32 v9, 0xff800000
v_mov_b32 v8, 0
buffer_load_dword v20, v2, s[4:7], s3 offen offset:0
buffer_load_dword v21, v2, s[4:7], s3 offen offset:256
buffer_load_dword v22, v2, s[4:7], s3 offen offset:512
buffer_load_dword v23, v2, s[4:7], s3 offen offset:768
buffer_load_dword v24, v2, s[4:7], s3 offen offset:1024
buffer_load_dword v25, v2, s[4:7], s3 offen offset:1280
buffer_load_dword v26, v2, s[4:7], s3 offen offset:1536
buffer_load_dword v27, v2, s[4:7], s3 offen offset:1792
buffer_load_dword v28, v2, s[4:7], s3 offen offset:2048
buffer_load_dword v29, v2, s[4:7], s3 offen offset:2304
buffer_load_dword v30, v2, s[4:7], s3 offen offset:2560
buffer_load_dword v31, v2, s[4:7], s3 offen offset:2816
buffer_load_dword v32, v2, s[4:7], s3 offen offset:3072
buffer_load_dword v33, v2, s[4:7], s3 offen offset:3328
buffer_load_dword v34, v2, s[4:7], s3 offen offset:3584
buffer_load_dword v35, v2, s[4:7], s3 offen offset:3840
s_add_u32 s3, s3, 4096
buffer_load_dword v36, v2, s[4:7], s3 offen offset:0
buffer_load_dword v37, v2, s[4:7], s3 offen offset:256
buffer_load_dword v38, v2, s[4:7], s3 offen offset:512
buffer_load_dword v39, v2, s[4:7], s3 offen offset:768
buffer_load_dword v40, v2, s[4:7], s3 offen offset:1024
buffer_load_dword v41, v2, s[4:7], s3 offen offset:1280
buffer_load_dword v42, v2, s[4:7], s3 offen offset:1536
buffer_load_dword v43, v2, s[4:7], s3 offen offset:1792
buffer_load_dword v44, v2, s[4:7], s3 offen offset:2048
buffer_load_dword v45, v2, s[4:7], s3 offen offset:2304
buffer_load_dword v46, v2, s[4:7], s3 offen offset:2560
buffer_load_dword v47, v2, s[4:7], s3 offen offset:2816
buffer_load_dword v48, v2, s[4:7], s3 offen offset:3072
buffer_load_dword v49, v2, s[4:7], s3 offen offset:3328
buffer_load_dword v50, v2, s[4:7], s3 offen offset:3584
buffer_load_dword v51, v2, s[4:7], s3 offen offset:3840
s_waitcnt vmcnt(0)
v_add_u32 v3, 0, v1
v_cmp_gt_f32 vcc, v20, v9
s_nop 1
v_cndmask_b32 v9, v9, v20, vcc
v_cndmask_b32 v8, v8, v3, vcc
v_add_u32 v3, 64, v1
v_cmp_gt_f32 vcc, v21, v9
s_nop 1
v_cndmask_b32 v9, v9, v21, vcc
v_cndmask_b32 v8, v8, v3, vcc
v_add_u32 v3, 128, v1
v_cmp_gt_f32 vcc, v22, v9
s_nop 1
v_cndmask_b32 v9, v9, v22, vcc
v_cndmask_b32 v8, v8, v3, vcc
v_add_u32 v3, 192, v1
v_cmp_gt_f32 vcc, v23, v9
s_nop 1
v_cndmask_b32 v9, v9, v23, vcc
v_cndmask_b32 v8, v8, v3, vcc
v_add_u32 v3, 256, v1
v_cmp_gt_f32 vcc, v24, v9
s_nop 1
v_cndmask_b32 v9, v9, v24, vcc
v_cndmask_b32 v8, v8, v3, vcc
v_add_u32 v3, 320, v1
v_cmp_gt_f32 vcc, v25, v9
s_nop 1
v_cndmask_b32 v9, v9, v25, vcc
v_cndmask_b32 v8, v8, v3, vcc
v_add_u32 v3, 384, v1
v_cmp_gt_f32 vcc, v26, v9
s_nop 1
v_cndmask_b32 v9, v9, v26, vcc
v_cndmask_b32 v8, v8, v3, vcc
v_add_u32 v3, 448, v1
v_cmp_gt_f32 vcc, v27, v9
s_nop 1
v_cndmask_b32 v9, v9, v27, vcc
v_cndmask_b32 v8, v8, v3, vcc
v_add_u32 v3, 512, v1
v_cmp_gt_f32 vcc, v28, v9
s_nop 1
v_cndmask_b32 v9, v9, v28, vcc
v_cndmask_b32 v8, v8, v3, vcc
v_add_u32 v3, 576, v1
v_cmp_gt_f32 vcc, v29, v9
s_nop 1
v_cndmask_b32 v9, v9, v29, vcc
v_cndmask_b32 v8, v8, v3, vcc
v_add_u32 v3, 640, v1
v_cmp_gt_f32 vcc, v30, v9
s_nop 1
v_cndmask_b32 v9, v9, v30, vcc
v_cndmask_b32 v8, v8, v3, vcc
v_add_u32 v3, 704, v1
v_cmp_gt_f32 vcc, v31, v9
s_nop 1
v_cndmask_b32 v9, v9, v31, vcc
v_cndmask_b32 v8, v8, v3, vcc
v_add_u32 v3, 768, v1
v_cmp_gt_f32 vcc, v32, v9
s_nop 1
v_cndmask_b32 v9, v9, v32, vcc
v_cndmask_b32 v8, v8, v3, vcc
v_add_u32 v3, 832, v1
v_cmp_gt_f32 vcc, v33, v9
s_nop 1
v_cndmask_b32 v9, v9, v33, vcc
v_cndmask_b32 v8, v8, v3, vcc
v_add_u32 v3, 896, v1
v_cmp_gt_f32 vcc, v34, v9
s_nop 1
v_cndmask_b32 v9, v9, v34, vcc
v_cndmask_b32 v8, v8, v3, vcc
v_add_u32 v3, 960, v1
v_cmp_gt_f32 vcc, v35, v9
s_nop 1
v_cndmask_b32 v9, v9, v35, vcc
v_cndmask_b32 v8, v8, v3, vcc
v_add_u32 v3, 1024, v1
v_cmp_gt_f32 vcc, v36, v9
s_nop 1
v_cndmask_b32 v9, v9, v36, vcc
v_cndmask_b32 v8, v8, v3, vcc
v_add_u32 v3, 1088, v1
v_cmp_gt_f32 vcc, v37, v9
s_nop 1
v_cndmask_b32 v9, v9, v37, vcc
v_cndmask_b32 v8, v8, v3, vcc
v_add_u32 v3, 1152, v1
v_cmp_gt_f32 vcc, v38, v9
s_nop 1
v_cndmask_b32 v9, v9, v38, vcc
v_cndmask_b32 v8, v8, v3, vcc
v_add_u32 v3, 1216, v1
v_cmp_gt_f32 vcc, v39, v9
s_nop 1
v_cndmask_b32 v9, v9, v39, vcc
v_cndmask_b32 v8, v8, v3, vcc
v_add_u32 v3, 1280, v1
v_cmp_gt_f32 vcc, v40, v9
s_nop 1
v_cndmask_b32 v9, v9, v40, vcc
v_cndmask_b32 v8, v8, v3, vcc
v_add_u32 v3, 1344, v1
v_cmp_gt_f32 vcc, v41, v9
s_nop 1
v_cndmask_b32 v9, v9, v41, vcc
v_cndmask_b32 v8, v8, v3, vcc
v_add_u32 v3, 1408, v1
v_cmp_gt_f32 vcc, v42, v9
s_nop 1
v_cndmask_b32 v9, v9, v42, vcc
v_cndmask_b32 v8, v8, v3, vcc
v_add_u32 v3, 1472, v1
v_cmp_gt_f32 vcc, v43, v9
s_nop 1
v_cndmask_b32 v9, v9, v43, vcc
v_cndmask_b32 v8, v8, v3, vcc
v_add_u32 v3, 1536, v1
v_cmp_gt_f32 vcc, v44, v9
s_nop 1
v_cndmask_b32 v9, v9, v44, vcc
v_cndmask_b32 v8, v8, v3, vcc
v_add_u32 v3, 1600, v1
v_cmp_gt_f32 vcc, v45, v9
s_nop 1
v_cndmask_b32 v9, v9, v45, vcc
v_cndmask_b32 v8, v8, v3, vcc
v_add_u32 v3, 1664, v1
v_cmp_gt_f32 vcc, v46, v9
s_nop 1
v_cndmask_b32 v9, v9, v46, vcc
v_cndmask_b32 v8, v8, v3, vcc
v_add_u32 v3, 1728, v1
v_cmp_gt_f32 vcc, v47, v9
s_nop 1
v_cndmask_b32 v9, v9, v47, vcc
v_cndmask_b32 v8, v8, v3, vcc
v_add_u32 v3, 1792, v1
v_cmp_gt_f32 vcc, v48, v9
s_nop 1
v_cndmask_b32 v9, v9, v48, vcc
v_cndmask_b32 v8, v8, v3, vcc
v_add_u32 v3, 1856, v1
v_cmp_gt_f32 vcc, v49, v9
s_nop 1
v_cndmask_b32 v9, v9, v49, vcc
v_cndmask_b32 v8, v8, v3, vcc
v_add_u32 v3, 1920, v1
v_cmp_gt_f32 vcc, v50, v9
s_nop 1
v_cndmask_b32 v9, v9, v50, vcc
v_cndmask_b32 v8, v8, v3, vcc
v_add_u32 v3, 1984, v1
v_cmp_gt_f32 vcc, v51, v9
s_nop 1
v_cndmask_b32 v9, v9, v51, vcc
v_cndmask_b32 v8, v8, v3, vcc
v_mov_b32 v6, v9
ds_swizzle_b32 v7, v6 offset:1055
s_waitcnt lgkmcnt(0)
v_max_f32 v6, v6, v7
ds_swizzle_b32 v7, v6 offset:2079
s_waitcnt lgkmcnt(0)
v_max_f32 v6, v6, v7
ds_swizzle_b32 v7, v6 offset:4127
s_waitcnt lgkmcnt(0)
v_max_f32 v6, v6, v7
ds_swizzle_b32 v7, v6 offset:8223
s_waitcnt lgkmcnt(0)
v_max_f32 v6, v6, v7
ds_swizzle_b32 v7, v6 offset:16415
s_waitcnt lgkmcnt(0)
v_max_f32 v6, v6, v7
v_mov_b32 v7, v6
s_nop 1
v_permlane32_swap_b32 v6, v7
s_nop 1
v_max_f32 v6, v6, v7
v_cmp_eq_f32 vcc, v6, v9
s_nop 4
s_ff1_i32_b64 s43, vcc
s_nop 4
v_readlane_b32 s42, v8, s43
v_mov_b32 v9, v6
s_nop 4
s_mov_b32 s3, 131072
v_add_u32 v1, 0, v0
v_lshlrev_b32 v2, 2, v1
buffer_load_dword v3, v2, s[4:7], s3 offen
s_waitcnt vmcnt(0)
ds_write_b32 v2, v3
v_add_u32 v1, 256, v0
v_lshlrev_b32 v2, 2, v1
buffer_load_dword v3, v2, s[4:7], s3 offen
s_waitcnt vmcnt(0)
ds_write_b32 v2, v3
v_add_u32 v1, 512, v0
v_lshlrev_b32 v2, 2, v1
buffer_load_dword v3, v2, s[4:7], s3 offen
s_waitcnt vmcnt(0)
ds_write_b32 v2, v3
v_add_u32 v1, 768, v0
v_lshlrev_b32 v2, 2, v1
buffer_load_dword v3, v2, s[4:7], s3 offen
s_waitcnt vmcnt(0)
ds_write_b32 v2, v3
v_add_u32 v1, 1024, v0
v_lshlrev_b32 v2, 2, v1
buffer_load_dword v3, v2, s[4:7], s3 offen
s_waitcnt vmcnt(0)
ds_write_b32 v2, v3
v_add_u32 v1, 1280, v0
v_lshlrev_b32 v2, 2, v1
buffer_load_dword v3, v2, s[4:7], s3 offen
s_waitcnt vmcnt(0)
ds_write_b32 v2, v3
v_add_u32 v1, 1536, v0
v_lshlrev_b32 v2, 2, v1
buffer_load_dword v3, v2, s[4:7], s3 offen
s_waitcnt vmcnt(0)
ds_write_b32 v2, v3
s_waitcnt lgkmcnt(0)
s_barrier
v_and_b32 v1, 31, v0
v_lshrrev_b32 v2, 5, v0
s_lshl_b32 s3, s2, 7
v_mul_u32_u24 v3, 276480, v2
v_lshl_add_u32 v3, v1, 2, v3
v_add_u32 v3, s3, v3
v_mul_u32_u24 v4, 864, v2
v_mov_b32 v10, 0
v_mov_b32 v11, 0
s_mov_b32 s40, 0
s_mov_b32 s41, 0
down_kernel_g10:
buffer_load_dword v20, v3, s[8:11], s41 offen
s_add_u32 s41, s41, 1280
buffer_load_dword v21, v3, s[8:11], s41 offen
s_add_u32 s41, s41, 1280
buffer_load_dword v22, v3, s[8:11], s41 offen
s_add_u32 s41, s41, 1280
buffer_load_dword v23, v3, s[8:11], s41 offen
s_add_u32 s41, s41, 1280
buffer_load_dword v24, v3, s[8:11], s41 offen
s_add_u32 s41, s41, 1280
buffer_load_dword v25, v3, s[8:11], s41 offen
s_add_u32 s41, s41, 1280
buffer_load_dword v26, v3, s[8:11], s41 offen
s_add_u32 s41, s41, 1280
buffer_load_dword v27, v3, s[8:11], s41 offen
s_add_u32 s41, s41, 1280
ds_read_b128 v[32:35], v4
ds_read_b128 v[36:39], v4 offset:16
v_add_u32 v4, 32, v4
s_waitcnt vmcnt(0) lgkmcnt(0)
v_lshlrev_b32 v5, 16, v20
v_and_b32 v6, 0xffff0000, v20
v_fmac_f32 v10, v5, v32
v_fmac_f32 v11, v6, v32
v_lshlrev_b32 v5, 16, v21
v_and_b32 v6, 0xffff0000, v21
v_fmac_f32 v10, v5, v33
v_fmac_f32 v11, v6, v33
v_lshlrev_b32 v5, 16, v22
v_and_b32 v6, 0xffff0000, v22
v_fmac_f32 v10, v5, v34
v_fmac_f32 v11, v6, v34
v_lshlrev_b32 v5, 16, v23
v_and_b32 v6, 0xffff0000, v23
v_fmac_f32 v10, v5, v35
v_fmac_f32 v11, v6, v35
v_lshlrev_b32 v5, 16, v24
v_and_b32 v6, 0xffff0000, v24
v_fmac_f32 v10, v5, v36
v_fmac_f32 v11, v6, v36
v_lshlrev_b32 v5, 16, v25
v_and_b32 v6, 0xffff0000, v25
v_fmac_f32 v10, v5, v37
v_fmac_f32 v11, v6, v37
v_lshlrev_b32 v5, 16, v26
v_and_b32 v6, 0xffff0000, v26
v_fmac_f32 v10, v5, v38
v_fmac_f32 v11, v6, v38
v_lshlrev_b32 v5, 16, v27
v_and_b32 v6, 0xffff0000, v27
v_fmac_f32 v10, v5, v39
v_fmac_f32 v11, v6, v39
s_add_u32 s40, s40, 8
s_cmp_lt_u32 s40, 216
s_cbranch_scc1 down_kernel_g10
v_lshlrev_b32 v5, 3, v0
s_barrier
ds_write_b64 v5, v[10:11] offset:8192
s_waitcnt lgkmcnt(0)
s_barrier
v_and_b32 v5, 63, v0
v_lshlrev_b32 v5, 2, v5
v_mov_b32 v10, 0
ds_read_b32 v6, v5 offset:8192
s_waitcnt lgkmcnt(0)
v_add_f32 v10, v10, v6
ds_read_b32 v6, v5 offset:8448
s_waitcnt lgkmcnt(0)
v_add_f32 v10, v10, v6
ds_read_b32 v6, v5 offset:8704
s_waitcnt lgkmcnt(0)
v_add_f32 v10, v10, v6
ds_read_b32 v6, v5 offset:8960
s_waitcnt lgkmcnt(0)
v_add_f32 v10, v10, v6
ds_read_b32 v6, v5 offset:9216
s_waitcnt lgkmcnt(0)
v_add_f32 v10, v10, v6
ds_read_b32 v6, v5 offset:9472
s_waitcnt lgkmcnt(0)
v_add_f32 v10, v10, v6
ds_read_b32 v6, v5 offset:9728
s_waitcnt lgkmcnt(0)
v_add_f32 v10, v10, v6
ds_read_b32 v6, v5 offset:9984
s_waitcnt lgkmcnt(0)
v_add_f32 v10, v10, v6
v_mul_f32 v9, 0xbfb8aa3b, v9
v_exp_f32 v9, v9
s_nop 0
v_add_f32 v9, 1.0, v9
v_rcp_f32 v9, v9
s_nop 0
v_mul_f32 v10, v10, v9
s_lshl_b32 s20, s2, 8
s_mul_i32 s21, s42, 2560
s_add_u32 s21, s21, s20
s_add_u32 s22, s21, 29360128
s_lshr_b32 s21, s21, 1
s_add_u32 s23, s21, 26214400
s_add_u32 s20, s20, 12800
v_lshrrev_b32 v6, 1, v5
buffer_load_dword v11, v5, s[4:7], s22 offen
buffer_load_ushort v12, v6, s[4:7], s23 offen
buffer_load_dword v13, v5, s[4:7], s20 offen
s_waitcnt vmcnt(0)
v_lshlrev_b32 v12, 16, v12
v_add_f32 v12, v12, v10
v_fma_f32 v11, v12, v13, v11
v_cvt_pk_bf16_f32 v11, v11, v11
buffer_store_short v11, v6, s[12:15], s21 offen
s_waitcnt vmcnt(0)
down_kernel_end:
s_endpgm
.section .rodata,"a"
.p2align 6
.amdhsa_kernel mod_kernel
  .amdhsa_next_free_vgpr 128
  .amdhsa_next_free_sgpr 96
  .amdhsa_accum_offset 128
  .amdhsa_group_segment_fixed_size 0
  .amdhsa_kernarg_size 104
  .amdhsa_user_sgpr_count 2
  .amdhsa_user_sgpr_kernarg_segment_ptr 1
  .amdhsa_system_sgpr_workgroup_id_x 1
  .amdhsa_float_denorm_mode_32 3
  .amdhsa_float_denorm_mode_16_64 3
.end_amdhsa_kernel
.p2align 6
.amdhsa_kernel tw_kernel
  .amdhsa_next_free_vgpr 128
  .amdhsa_next_free_sgpr 96
  .amdhsa_accum_offset 128
  .amdhsa_group_segment_fixed_size 0
  .amdhsa_kernarg_size 104
  .amdhsa_user_sgpr_count 2
  .amdhsa_user_sgpr_kernarg_segment_ptr 1
  .amdhsa_system_sgpr_workgroup_id_x 1
  .amdhsa_float_denorm_mode_32 3
  .amdhsa_float_denorm_mode_16_64 3
.end_amdhsa_kernel
.p2align 6
.amdhsa_kernel two_kernel
  .amdhsa_next_free_vgpr 128
  .amdhsa_next_free_sgpr 96
  .amdhsa_accum_offset 128
  .amdhsa_group_segment_fixed_size 0
  .amdhsa_kernarg_size 104
  .amdhsa_user_sgpr_count 2
  .amdhsa_user_sgpr_kernarg_segment_ptr 1
  .amdhsa_system_sgpr_workgroup_id_x 1
  .amdhsa_float_denorm_mode_32 3
  .amdhsa_float_denorm_mode_16_64 3
.end_amdhsa_kernel
.p2align 6
.amdhsa_kernel ln1_kernel
  .amdhsa_next_free_vgpr 128
  .amdhsa_next_free_sgpr 96
  .amdhsa_accum_offset 128
  .amdhsa_group_segment_fixed_size 0
  .amdhsa_kernarg_size 104
  .amdhsa_user_sgpr_count 2
  .amdhsa_user_sgpr_kernarg_segment_ptr 1
  .amdhsa_system_sgpr_workgroup_id_x 1
  .amdhsa_float_denorm_mode_32 3
  .amdhsa_float_denorm_mode_16_64 3
.end_amdhsa_kernel
.p2align 6
.amdhsa_kernel qkv_kernel
  .amdhsa_next_free_vgpr 128
  .amdhsa_next_free_sgpr 96
  .amdhsa_accum_offset 128
  .amdhsa_group_segment_fixed_size 0
  .amdhsa_kernarg_size 104
  .amdhsa_user_sgpr_count 2
  .amdhsa_user_sgpr_kernarg_segment_ptr 1
  .amdhsa_system_sgpr_workgroup_id_x 1
  .amdhsa_float_denorm_mode_32 3
  .amdhsa_float_denorm_mode_16_64 3
.end_amdhsa_kernel
.p2align 6
.amdhsa_kernel attn_kernel
  .amdhsa_next_free_vgpr 256
  .amdhsa_next_free_sgpr 96
  .amdhsa_accum_offset 256
  .amdhsa_group_segment_fixed_size 0
  .amdhsa_kernarg_size 104
  .amdhsa_user_sgpr_count 2
  .amdhsa_user_sgpr_kernarg_segment_ptr 1
  .amdhsa_system_sgpr_workgroup_id_x 1
  .amdhsa_float_denorm_mode_32 3
  .amdhsa_float_denorm_mode_16_64 3
.end_amdhsa_kernel
.p2align 6
.amdhsa_kernel wo_kernel
  .amdhsa_next_free_vgpr 128
  .amdhsa_next_free_sgpr 96
  .amdhsa_accum_offset 128
  .amdhsa_group_segment_fixed_size 0
  .amdhsa_kernarg_size 104
  .amdhsa_user_sgpr_count 2
  .amdhsa_user_sgpr_kernarg_segment_ptr 1
  .amdhsa_system_sgpr_workgroup_id_x 1
  .amdhsa_float_denorm_mode_32 3
  .amdhsa_float_denorm_mode_16_64 3
.end_amdhsa_kernel
.p2align 6
.amdhsa_kernel ln2_kernel
  .amdhsa_next_free_vgpr 128
  .amdhsa_next_free_sgpr 96
  .amdhsa_accum_offset 128
  .amdhsa_group_segment_fixed_size 0
  .amdhsa_kernarg_size 104
  .amdhsa_user_sgpr_count 2
  .amdhsa_user_sgpr_kernarg_segment_ptr 1
  .amdhsa_system_sgpr_workgroup_id_x 1
  .amdhsa_float_denorm_mode_32 3
  .amdhsa_float_denorm_mode_16_64 3
.end_amdhsa_kernel
.p2align 6
.amdhsa_kernel gu_kernel
  .amdhsa_next_free_vgpr 128
  .amdhsa_next_free_sgpr 96
  .amdhsa_accum_offset 128
  .amdhsa_group_segment_fixed_size 0
  .amdhsa_kernarg_size 104
  .amdhsa_user_sgpr_count 2
  .amdhsa_user_sgpr_kernarg_segment_ptr 1
  .amdhsa_system_sgpr_workgroup_id_x 1
  .amdhsa_float_denorm_mode_32 3
  .amdhsa_float_denorm_mode_16_64 3
.end_amdhsa_kernel
.p2align 6
.amdhsa_kernel down_kernel
  .amdhsa_next_free_vgpr 128
  .amdhsa_next_free_sgpr 96
  .amdhsa_accum_offset 128
  .amdhsa_group_segment_fixed_size 0
  .amdhsa_kernarg_size 104
  .amdhsa_user_sgpr_count 2
  .amdhsa_user_sgpr_kernarg_segment_ptr 1
  .amdhsa_system_sgpr_workgroup_id_x 1
  .amdhsa_float_denorm_mode_32 3
  .amdhsa_float_denorm_mode_16_64 3
.end_amdhsa_kernel
```

```asm
; @launch grid=(256,1,1) block=(256,1,1) lds=163840
.amdgcn_target "amdgcn-amd-amdhsa--gfx950"
.text
.globl adaLN_cond__sliding_local_dilated__moe_arch_mod__prompt_kernel
.p2align 8
.type adaLN_cond__sliding_local_dilated__moe_arch_mod__prompt_kernel,@function
adaLN_cond__sliding_local_dilated__moe_arch_mod__prompt_kernel:
s_cmp_ge_u32 s2, 256
s_cbranch_scc1 L_end
s_load_dwordx2 s[4:5], s[0:1], 96
s_load_dwordx2 s[12:13], s[0:1], 8
s_load_dwordx2 s[16:17], s[0:1], 72
s_load_dwordx2 s[20:21], s[0:1], 64
s_load_dwordx2 s[8:9], s[0:1], 0
s_load_dwordx2 s[24:25], s[0:1], 16
s_load_dwordx2 s[28:29], s[0:1], 32
s_load_dwordx2 s[32:33], s[0:1], 80
s_getpc_b64 s[48:49]
v_lshrrev_b32 v4, 6, v0
v_and_b32 v1, 63, v0
v_readfirstlane_b32 s3, v4
s_and_b32 s42, s2, 7
s_lshr_b32 s43, s2, 3
s_lshl_b32 s50, s43, 2
s_add_u32 s50, s50, s3
s_mul_i32 s50, s50, 384
v_lshlrev_b32 v5, 7, v1
v_add_u32 v5, s50, v5
s_mov_b64 exec, 7
global_load_dword v19, v5, s[48:49]
s_mov_b64 exec, -1
s_mov_b32 s6, 8388608
s_mov_b32 s7, 0x20000
s_mov_b32 s14, 2457600
s_mov_b32 s15, 0x20000
s_mov_b32 s18, 4915200
s_mov_b32 s19, 0x20000
s_mov_b32 s22, 1280
s_mov_b32 s23, 0x20000
s_mov_b32 s10, 2621440
s_mov_b32 s11, 0x20000
s_mov_b32 s26, 819200
s_mov_b32 s27, 0x20000
s_mov_b32 s30, 1280
s_mov_b32 s31, 0x20000
s_mov_b32 s34, 2621440
s_mov_b32 s35, 0x20000
s_mov_b32 s38, 8388608
s_mov_b32 s39, 0x20000
s_mov_b32 s97, 0
s_mov_b32 s98, 0x0c0c0400
s_mov_b32 s99, 0x04000c0c
v_and_b32 v2, 15, v1
v_lshrrev_b32 v3, 4, v1
s_cmp_lt_u32 s2, 224
s_cselect_b32 s10, s10, 0
s_cselect_b32 s38, s38, 0
s_mul_i32 s55, s2, 10923
s_lshr_b32 s55, s55, 16
s_mul_i32 s56, s55, 6
s_sub_u32 s56, s2, s56
s_mul_i32 s50, s55, 61440
s_mul_i32 s57, s56, 640
s_add_u32 s50, s50, s57
s_lshr_b32 s57, s56, 1
s_and_b32 s56, s56, 1
s_lshl_b32 s56, s56, 2
s_add_u32 s56, s56, s3
s_mul_i32 s51, s56, 307200
s_mul_i32 s55, s55, 7680
s_mul_i32 s57, s57, 2560
s_add_u32 s51, s51, s55
s_add_u32 s51, s51, s57
s_add_u32 s51, s51, 1048576
s_mul_i32 s55, s42, 30
s_add_u32 s55, s55, s43
s_mul_i32 s56, s55, 820
s_lshr_b32 s56, s56, 16
s_mul_i32 s57, s56, 80
s_sub_u32 s57, s55, s57
s_mul_i32 s52, s56, 1720320
s_lshl_b32 s58, s57, 5
s_add_u32 s52, s52, s58
s_lshl_b32 s53, s55, 7
s_add_u32 s53, s53, 4096
s_mul_i32 s54, s56, 448
v_mov_b32 v26, 1073741824
v_add_u32 v23, 0, v0
v_mul_u32_u24 v24, 1639, v23
v_lshrrev_b32 v24, 16, v24
v_mul_u32_u24 v25, 3200, v24
v_lshl_add_u32 v20, v23, 4, v25
v_add_u32 v23, 256, v0
v_mul_u32_u24 v24, 1639, v23
v_lshrrev_b32 v24, 16, v24
v_mul_u32_u24 v25, 3200, v24
v_lshl_add_u32 v21, v23, 4, v25
v_add_u32 v23, 512, v0
v_mul_u32_u24 v24, 1639, v23
v_lshrrev_b32 v24, 16, v24
v_mul_u32_u24 v25, 3200, v24
v_lshl_add_u32 v22, v23, 4, v25
v_cmp_gt_u32 vcc, 128, v0
s_nop 1
v_cndmask_b32 v22, v26, v22, vcc
v_lshrrev_b32 v27, 1, v1
v_mul_u32_u24 v27, 7680, v27
v_and_b32 v28, 1, v1
v_lshl_add_u32 v27, v28, 4, v27
v_lshlrev_b32 v28, 3, v1
v_mov_b32 v29, 0
s_lshl_b32 s59, s3, 10
s_add_u32 s59, s59, 61440
s_waitcnt lgkmcnt(0)
s_mov_b32 s36, s4
s_mov_b32 s37, s5
s_cmp_ge_u32 s2, 240
s_cbranch_scc1 L_svc0
s_cmp_eq_u32 s3, 3
s_cbranch_scc1 L_p1b
buffer_load_dword v42, v29, s[4:7], 0 offen sc1
s_add_u32 m0, s59, 0
s_nop 0
buffer_load_dwordx4 v20, s[12:15], s50 offen nt lds
s_add_u32 m0, s59, 4096
s_nop 0
buffer_load_dwordx4 v21, s[12:15], s50 offen nt lds
s_add_u32 m0, s59, 8192
s_nop 0
buffer_load_dwordx4 v22, s[12:15], s50 offen nt lds
s_lshr_b32 s55, s42, 2
s_bfe_u32 s56, s42, 0x10001
s_mul_i32 s56, s56, 7
s_lshr_b32 s57, s43, 2
s_add_u32 s56, s56, s57
s_and_b32 s44, s42, 1
s_lshl_b32 s44, s44, 2
s_and_b32 s57, s43, 3
s_add_u32 s44, s44, s57
s_mul_i32 s57, s56, 73
s_lshl_b32 s45, s57, 1
s_add_u32 s45, s45, s55
s_mul_i32 s45, s45, 1280
s_mul_i32 s58, s43, 37
s_lshr_b32 s58, s58, 8
s_mul_i32 s60, s58, 7
s_sub_u32 s96, s43, s60
s_lshl_b32 s47, s42, 2
s_add_u32 s47, s47, s58
v_lshrrev_b32 v5, 4, v0
v_mul_u32_u24 v4, 2560, v5
v_lshl_add_u32 v4, v2, 4, v4
s_cmp_eq_u32 s56, 0
s_cselect_b32 s58, 0, 7
s_add_u32 s58, s58, s57
s_add_u32 s60, s57, 80
s_min_u32 s60, s60, 1024
s_sub_u32 s60, s60, s58
s_andn2_b32 s61, s58, 15
s_lshl_b32 s62, s55, 10
s_add_u32 s62, s62, s61
s_mul_i32 s46, s62, 1280
s_mul_i32 s62, s44, 2560
s_add_u32 s46, s46, s62
s_add_u32 s46, s46, 4194304
s_sub_u32 s62, s61, s58
s_sub_u32 s63, s58, s57
v_add_u32 v30, 0, v0
v_mul_u32_u24 v31, 410, v30
v_lshrrev_b32 v31, 16, v31
v_mul_u32_u24 v32, 17920, v31
v_lshl_add_u32 v32, v30, 4, v32
v_lshl_add_u32 v33, v31, 4, v2
v_add_u32 v33, s62, v33
v_cmp_gt_u32 vcc, s60, v33
v_add_u32 v33, s63, v33
v_mul_u32_u24 v34, 160, v31
v_cndmask_b32 v11, v26, v32, vcc
v_cndmask_b32 v33, 0, v33, vcc
v_sub_u32 v34, v30, v34
v_and_b32 v34, 0xf0, v34
v_mul_u32_u24 v33, 176, v33
v_add_u32 v15, v33, v34
v_add_u32 v30, 256, v0
v_mul_u32_u24 v31, 410, v30
v_lshrrev_b32 v31, 16, v31
v_mul_u32_u24 v32, 17920, v31
v_lshl_add_u32 v32, v30, 4, v32
v_lshl_add_u32 v33, v31, 4, v2
v_add_u32 v33, s62, v33
v_cmp_gt_u32 vcc, s60, v33
v_add_u32 v33, s63, v33
v_mul_u32_u24 v34, 160, v31
v_cndmask_b32 v12, v26, v32, vcc
v_cndmask_b32 v33, 0, v33, vcc
v_sub_u32 v34, v30, v34
v_and_b32 v34, 0xf0, v34
v_mul_u32_u24 v33, 176, v33
v_add_u32 v16, v33, v34
v_add_u32 v30, 512, v0
v_mul_u32_u24 v31, 410, v30
v_lshrrev_b32 v31, 16, v31
v_mul_u32_u24 v32, 17920, v31
v_lshl_add_u32 v32, v30, 4, v32
v_lshl_add_u32 v33, v31, 4, v2
v_add_u32 v33, s62, v33
v_cmp_gt_u32 vcc, s60, v33
v_add_u32 v33, s63, v33
v_mul_u32_u24 v34, 160, v31
v_cndmask_b32 v13, v26, v32, vcc
v_cndmask_b32 v33, 0, v33, vcc
v_sub_u32 v34, v30, v34
v_and_b32 v34, 0xf0, v34
v_mul_u32_u24 v33, 176, v33
v_add_u32 v17, v33, v34
v_add_u32 v30, 768, v0
v_mul_u32_u24 v31, 410, v30
v_lshrrev_b32 v31, 16, v31
v_mul_u32_u24 v32, 17920, v31
v_lshl_add_u32 v32, v30, 4, v32
v_lshl_add_u32 v33, v31, 4, v2
v_add_u32 v33, s62, v33
v_cmp_gt_u32 vcc, s60, v33
v_add_u32 v33, s63, v33
v_mul_u32_u24 v34, 160, v31
v_cndmask_b32 v14, v26, v32, vcc
v_cndmask_b32 v33, 0, v33, vcc
v_sub_u32 v34, v30, v34
v_and_b32 v34, 0xf0, v34
v_mul_u32_u24 v33, 176, v33
v_add_u32 v18, v33, v34
s_lshl_b32 s62, s47, 11
s_lshl_b32 s63, s96, 8
s_add_u32 s62, s62, s63
s_lshl_b32 s63, s3, 6
s_add_u32 s62, s62, s63
s_add_u32 s62, s62, 458752
v_lshlrev_b32 v35, 4, v1
v_cmp_gt_u32 vcc, 4, v1
v_mov_b32 v36, -1
v_mov_b32 v37, -1
v_cndmask_b32 v35, v26, v35, vcc
v_mov_b32 v38, -1
v_mov_b32 v39, -1
buffer_store_dwordx4 v[36:39], v11, s[36:39], s46 offen sc1
buffer_store_dwordx4 v[36:39], v12, s[36:39], s46 offen sc1
buffer_store_dwordx4 v[36:39], v13, s[36:39], s46 offen sc1
buffer_store_dwordx4 v[36:39], v14, s[36:39], s46 offen sc1
buffer_store_dwordx4 v[36:39], v35, s[36:39], s62 offen sc1
buffer_load_dwordx4 v[100:103], v4, s[8:11], s45 offen offset:0
buffer_load_dwordx4 v[104:107], v4, s[8:11], s45 offen offset:256
buffer_load_dwordx4 v[108:111], v4, s[8:11], s45 offen offset:512
buffer_load_dwordx4 v[112:115], v4, s[8:11], s45 offen offset:768
buffer_load_dwordx4 v[116:119], v4, s[8:11], s45 offen offset:1024
s_add_u32 s45, s45, 40960
v_bfe_u32 v30, v1, 2, 2
v_and_b32 v31, 3, v1
v_and_b32 v32, 1, v3
v_lshrrev_b32 v33, 1, v3
s_mul_i32 s55, s3, 160
s_add_u32 s55, s55, 61440
v_lshl_add_u32 v34, v32, 3, v30
v_mul_u32_u24 v34, 640, v34
v_mul_u32_u24 v33, 40, v33
v_lshl_add_u32 v33, v31, 3, v33
v_add3_u32 v20, v34, v33, s55
v_and_b32 v33, 1, v31
v_lshl_add_u32 v34, v33, 3, v30
v_mul_u32_u24 v34, 640, v34
v_lshrrev_b32 v33, 1, v31
v_lshl_add_u32 v33, v32, 1, v33
v_mul_u32_u24 v33, 40, v33
v_add3_u32 v21, v34, v33, s55
v_lshlrev_b32 v22, 4, v1
v_cmp_gt_u32 vcc, 32, v1
v_lshlrev_b32 v24, 2, v1
v_lshl_add_u32 v25, v3, 3, v30
v_cndmask_b32 v23, v26, v22, vcc
v_cndmask_b32 v24, v26, v24, vcc
v_lshlrev_b32 v25, 5, v25
v_lshl_add_u32 v25, v31, 3, v25
v_add_u32 v25, 73728, v25
v_mov_b32 v24, v26
s_waitcnt vmcnt(10)
v_readfirstlane_b32 s41, v42
s_barrier
ds_read_b64_tr_b16 v[44:45], v20 offset:0
ds_read_b64_tr_b16 v[46:47], v20 offset:2560
ds_read_b64_tr_b16 v[48:49], v20 offset:80
ds_read_b64_tr_b16 v[50:51], v20 offset:2640
ds_read_b64_tr_b16 v[52:53], v21 offset:32
ds_read_b64_tr_b16 v[54:55], v21 offset:2592
s_mul_i32 s40, s41, 0x9E3779B1
s_add_u32 s40, s40, 0x85EBCA6B
s_waitcnt lgkmcnt(4)
buffer_store_dwordx4 v[44:47], v22, s[4:7], s51 offen offset:0 sc1
s_waitcnt lgkmcnt(2)
buffer_store_dwordx4 v[48:51], v22, s[4:7], s51 offen offset:1024 sc1
s_waitcnt lgkmcnt(0)
buffer_store_dwordx4 v[52:55], v23, s[4:7], s51 offen offset:2048 sc1
buffer_load_dwordx4 v[120:123], v4, s[8:11], s45 offen offset:0
buffer_load_dwordx4 v[124:127], v4, s[8:11], s45 offen offset:256
buffer_load_dwordx4 v[128:131], v4, s[8:11], s45 offen offset:512
buffer_load_dwordx4 v[132:135], v4, s[8:11], s45 offen offset:768
buffer_load_dwordx4 v[136:139], v4, s[8:11], s45 offen offset:1024
s_add_u32 s45, s45, 40960
v_lshlrev_b32 v30, 3, v31
v_lshrrev_b32 v19, v30, s40
v_and_b32 v19, 0xff, v19
s_waitcnt vmcnt(5)
s_branch L_p1j
L_p1b:
buffer_load_dwordx2 v[40:41], v28, s[20:23], s54 offen
buffer_load_dword v42, v29, s[4:7], 0 offen sc1
s_add_u32 m0, s59, 0
s_nop 0
buffer_load_dwordx4 v20, s[12:15], s50 offen nt lds
s_add_u32 m0, s59, 4096
s_nop 0
buffer_load_dwordx4 v21, s[12:15], s50 offen nt lds
s_add_u32 m0, s59, 8192
s_nop 0
buffer_load_dwordx4 v22, s[12:15], s50 offen nt lds
s_mov_b32 m0, 73728
s_nop 0
buffer_load_dwordx4 v27, s[16:19], s52 offen lds
s_add_u32 s52, s52, 245760
s_mov_b32 m0, 74752
s_nop 0
buffer_load_dwordx4 v27, s[16:19], s52 offen lds
s_add_u32 s52, s52, 245760
s_mov_b32 m0, 75776
s_nop 0
buffer_load_dwordx4 v27, s[16:19], s52 offen lds
s_add_u32 s52, s52, 245760
s_mov_b32 m0, 76800
s_nop 0
buffer_load_dwordx4 v27, s[16:19], s52 offen lds
s_add_u32 s52, s52, 245760
s_mov_b32 m0, 77824
s_nop 0
buffer_load_dwordx4 v27, s[16:19], s52 offen lds
s_add_u32 s52, s52, 245760
s_mov_b32 m0, 78848
s_nop 0
buffer_load_dwordx4 v27, s[16:19], s52 offen lds
s_add_u32 s52, s52, 245760
s_mov_b32 m0, 79872
s_nop 0
buffer_load_dwordx4 v27, s[16:19], s52 offen lds
s_add_u32 s52, s52, 245760
s_lshr_b32 s55, s42, 2
s_bfe_u32 s56, s42, 0x10001
s_mul_i32 s56, s56, 7
s_lshr_b32 s57, s43, 2
s_add_u32 s56, s56, s57
s_and_b32 s44, s42, 1
s_lshl_b32 s44, s44, 2
s_and_b32 s57, s43, 3
s_add_u32 s44, s44, s57
s_mul_i32 s57, s56, 73
s_lshl_b32 s45, s57, 1
s_add_u32 s45, s45, s55
s_mul_i32 s45, s45, 1280
s_mul_i32 s58, s43, 37
s_lshr_b32 s58, s58, 8
s_mul_i32 s60, s58, 7
s_sub_u32 s96, s43, s60
s_lshl_b32 s47, s42, 2
s_add_u32 s47, s47, s58
v_lshrrev_b32 v5, 4, v0
v_mul_u32_u24 v4, 2560, v5
v_lshl_add_u32 v4, v2, 4, v4
s_cmp_eq_u32 s56, 0
s_cselect_b32 s58, 0, 7
s_add_u32 s58, s58, s57
s_add_u32 s60, s57, 80
s_min_u32 s60, s60, 1024
s_sub_u32 s60, s60, s58
s_andn2_b32 s61, s58, 15
s_lshl_b32 s62, s55, 10
s_add_u32 s62, s62, s61
s_mul_i32 s46, s62, 1280
s_mul_i32 s62, s44, 2560
s_add_u32 s46, s46, s62
s_add_u32 s46, s46, 4194304
s_sub_u32 s62, s61, s58
s_sub_u32 s63, s58, s57
v_add_u32 v30, 0, v0
v_mul_u32_u24 v31, 410, v30
v_lshrrev_b32 v31, 16, v31
v_mul_u32_u24 v32, 17920, v31
v_lshl_add_u32 v32, v30, 4, v32
v_lshl_add_u32 v33, v31, 4, v2
v_add_u32 v33, s62, v33
v_cmp_gt_u32 vcc, s60, v33
v_add_u32 v33, s63, v33
v_mul_u32_u24 v34, 160, v31
v_cndmask_b32 v11, v26, v32, vcc
v_cndmask_b32 v33, 0, v33, vcc
v_sub_u32 v34, v30, v34
v_and_b32 v34, 0xf0, v34
v_mul_u32_u24 v33, 176, v33
v_add_u32 v15, v33, v34
v_add_u32 v30, 256, v0
v_mul_u32_u24 v31, 410, v30
v_lshrrev_b32 v31, 16, v31
v_mul_u32_u24 v32, 17920, v31
v_lshl_add_u32 v32, v30, 4, v32
v_lshl_add_u32 v33, v31, 4, v2
v_add_u32 v33, s62, v33
v_cmp_gt_u32 vcc, s60, v33
v_add_u32 v33, s63, v33
v_mul_u32_u24 v34, 160, v31
v_cndmask_b32 v12, v26, v32, vcc
v_cndmask_b32 v33, 0, v33, vcc
v_sub_u32 v34, v30, v34
v_and_b32 v34, 0xf0, v34
v_mul_u32_u24 v33, 176, v33
v_add_u32 v16, v33, v34
v_add_u32 v30, 512, v0
v_mul_u32_u24 v31, 410, v30
v_lshrrev_b32 v31, 16, v31
v_mul_u32_u24 v32, 17920, v31
v_lshl_add_u32 v32, v30, 4, v32
v_lshl_add_u32 v33, v31, 4, v2
v_add_u32 v33, s62, v33
v_cmp_gt_u32 vcc, s60, v33
v_add_u32 v33, s63, v33
v_mul_u32_u24 v34, 160, v31
v_cndmask_b32 v13, v26, v32, vcc
v_cndmask_b32 v33, 0, v33, vcc
v_sub_u32 v34, v30, v34
v_and_b32 v34, 0xf0, v34
v_mul_u32_u24 v33, 176, v33
v_add_u32 v17, v33, v34
v_add_u32 v30, 768, v0
v_mul_u32_u24 v31, 410, v30
v_lshrrev_b32 v31, 16, v31
v_mul_u32_u24 v32, 17920, v31
v_lshl_add_u32 v32, v30, 4, v32
v_lshl_add_u32 v33, v31, 4, v2
v_add_u32 v33, s62, v33
v_cmp_gt_u32 vcc, s60, v33
v_add_u32 v33, s63, v33
v_mul_u32_u24 v34, 160, v31
v_cndmask_b32 v14, v26, v32, vcc
v_cndmask_b32 v33, 0, v33, vcc
v_sub_u32 v34, v30, v34
v_and_b32 v34, 0xf0, v34
v_mul_u32_u24 v33, 176, v33
v_add_u32 v18, v33, v34
s_lshl_b32 s62, s47, 11
s_lshl_b32 s63, s96, 8
s_add_u32 s62, s62, s63
s_lshl_b32 s63, s3, 6
s_add_u32 s62, s62, s63
s_add_u32 s62, s62, 458752
v_lshlrev_b32 v35, 4, v1
v_cmp_gt_u32 vcc, 4, v1
v_mov_b32 v36, -1
v_mov_b32 v37, -1
v_cndmask_b32 v35, v26, v35, vcc
v_mov_b32 v38, -1
v_mov_b32 v39, -1
buffer_store_dwordx4 v[36:39], v11, s[36:39], s46 offen sc1
buffer_store_dwordx4 v[36:39], v12, s[36:39], s46 offen sc1
buffer_store_dwordx4 v[36:39], v13, s[36:39], s46 offen sc1
buffer_store_dwordx4 v[36:39], v14, s[36:39], s46 offen sc1
buffer_store_dwordx4 v[36:39], v35, s[36:39], s62 offen sc1
buffer_load_dwordx4 v[100:103], v4, s[8:11], s45 offen offset:0
buffer_load_dwordx4 v[104:107], v4, s[8:11], s45 offen offset:256
buffer_load_dwordx4 v[108:111], v4, s[8:11], s45 offen offset:512
buffer_load_dwordx4 v[112:115], v4, s[8:11], s45 offen offset:768
buffer_load_dwordx4 v[116:119], v4, s[8:11], s45 offen offset:1024
s_add_u32 s45, s45, 40960
v_bfe_u32 v30, v1, 2, 2
v_and_b32 v31, 3, v1
v_and_b32 v32, 1, v3
v_lshrrev_b32 v33, 1, v3
s_mul_i32 s55, s3, 160
s_add_u32 s55, s55, 61440
v_lshl_add_u32 v34, v32, 3, v30
v_mul_u32_u24 v34, 640, v34
v_mul_u32_u24 v33, 40, v33
v_lshl_add_u32 v33, v31, 3, v33
v_add3_u32 v20, v34, v33, s55
v_and_b32 v33, 1, v31
v_lshl_add_u32 v34, v33, 3, v30
v_mul_u32_u24 v34, 640, v34
v_lshrrev_b32 v33, 1, v31
v_lshl_add_u32 v33, v32, 1, v33
v_mul_u32_u24 v33, 40, v33
v_add3_u32 v21, v34, v33, s55
v_lshlrev_b32 v22, 4, v1
v_cmp_gt_u32 vcc, 32, v1
v_lshlrev_b32 v24, 2, v1
v_lshl_add_u32 v25, v3, 3, v30
v_cndmask_b32 v23, v26, v22, vcc
v_cndmask_b32 v24, v26, v24, vcc
v_lshlrev_b32 v25, 5, v25
v_lshl_add_u32 v25, v31, 3, v25
v_add_u32 v25, 73728, v25
s_waitcnt vmcnt(21)
v_lshlrev_b32 v44, 16, v40
v_and_b32 v45, 0xffff0000, v40
v_lshlrev_b32 v46, 16, v41
v_and_b32 v47, 0xffff0000, v41
v_mul_f32 v48, 0xbfb8aa3b, v44
v_mul_f32 v49, 0xbfb8aa3b, v45
v_mul_f32 v50, 0xbfb8aa3b, v46
v_mul_f32 v51, 0xbfb8aa3b, v47
v_exp_f32 v48, v48
v_exp_f32 v49, v49
v_exp_f32 v50, v50
v_exp_f32 v51, v51
v_add_f32 v48, 1.0, v48
v_add_f32 v49, 1.0, v49
v_add_f32 v50, 1.0, v50
v_add_f32 v51, 1.0, v51
v_rcp_f32 v48, v48
v_rcp_f32 v49, v49
v_rcp_f32 v50, v50
v_rcp_f32 v51, v51
v_mul_f32 v44, v44, v48
v_mul_f32 v45, v45, v49
v_mul_f32 v46, v46, v50
v_mul_f32 v47, v47, v51
v_cvt_pk_bf16_f32 v40, v44, v45
v_cvt_pk_bf16_f32 v41, v46, v47
v_add_u32 v28, 80896, v28
ds_write_b64 v28, v[40:41]
v_lshlrev_b32 v28, 4, v3
v_add_u32 v28, 80896, v28
s_waitcnt lgkmcnt(0)
ds_read_b128 v[200:203], v28 offset:0
ds_read_b128 v[204:207], v28 offset:64
ds_read_b128 v[208:211], v28 offset:128
ds_read_b128 v[212:215], v28 offset:192
ds_read_b128 v[216:219], v28 offset:256
ds_read_b128 v[220:223], v28 offset:320
ds_read_b128 v[224:227], v28 offset:384
s_waitcnt vmcnt(17)
v_readfirstlane_b32 s41, v42
s_barrier
ds_read_b64_tr_b16 v[44:45], v20 offset:0
ds_read_b64_tr_b16 v[46:47], v20 offset:2560
ds_read_b64_tr_b16 v[48:49], v20 offset:80
ds_read_b64_tr_b16 v[50:51], v20 offset:2640
ds_read_b64_tr_b16 v[52:53], v21 offset:32
ds_read_b64_tr_b16 v[54:55], v21 offset:2592
s_mul_i32 s40, s41, 0x9E3779B1
s_add_u32 s40, s40, 0x85EBCA6B
s_waitcnt lgkmcnt(4)
buffer_store_dwordx4 v[44:47], v22, s[4:7], s51 offen offset:0 sc1
s_waitcnt lgkmcnt(2)
buffer_store_dwordx4 v[48:51], v22, s[4:7], s51 offen offset:1024 sc1
s_waitcnt lgkmcnt(0)
buffer_store_dwordx4 v[52:55], v23, s[4:7], s51 offen offset:2048 sc1
buffer_load_dwordx4 v[120:123], v4, s[8:11], s45 offen offset:0
buffer_load_dwordx4 v[124:127], v4, s[8:11], s45 offen offset:256
buffer_load_dwordx4 v[128:131], v4, s[8:11], s45 offen offset:512
buffer_load_dwordx4 v[132:135], v4, s[8:11], s45 offen offset:768
buffer_load_dwordx4 v[136:139], v4, s[8:11], s45 offen offset:1024
s_add_u32 s45, s45, 40960
v_lshlrev_b32 v30, 3, v31
v_lshrrev_b32 v19, v30, s40
v_and_b32 v19, 0xff, v19
s_waitcnt vmcnt(18)
ds_read_b64_tr_b16 v[60:61], v25 offset:0
ds_read_b64_tr_b16 v[62:63], v25 offset:128
ds_read_b64_tr_b16 v[64:65], v25 offset:1024
ds_read_b64_tr_b16 v[66:67], v25 offset:1152
ds_read_b64_tr_b16 v[68:69], v25 offset:2048
ds_read_b64_tr_b16 v[70:71], v25 offset:2176
ds_read_b64_tr_b16 v[72:73], v25 offset:3072
ds_read_b64_tr_b16 v[74:75], v25 offset:3200
ds_read_b64_tr_b16 v[76:77], v25 offset:4096
ds_read_b64_tr_b16 v[78:79], v25 offset:4224
ds_read_b64_tr_b16 v[80:81], v25 offset:5120
ds_read_b64_tr_b16 v[82:83], v25 offset:5248
ds_read_b64_tr_b16 v[84:85], v25 offset:6144
ds_read_b64_tr_b16 v[86:87], v25 offset:6272
s_waitcnt lgkmcnt(12)
v_mfma_f32_16x16x32_bf16 v[56:59], v[200:203], v[60:63], 0
s_waitcnt lgkmcnt(10)
v_mfma_f32_16x16x32_bf16 v[56:59], v[204:207], v[64:67], v[56:59]
s_waitcnt lgkmcnt(8)
v_mfma_f32_16x16x32_bf16 v[56:59], v[208:211], v[68:71], v[56:59]
s_waitcnt lgkmcnt(6)
v_mfma_f32_16x16x32_bf16 v[56:59], v[212:215], v[72:75], v[56:59]
s_waitcnt lgkmcnt(4)
v_mfma_f32_16x16x32_bf16 v[56:59], v[216:219], v[76:79], v[56:59]
s_waitcnt lgkmcnt(2)
v_mfma_f32_16x16x32_bf16 v[56:59], v[220:223], v[80:83], v[56:59]
s_waitcnt lgkmcnt(0)
v_mfma_f32_16x16x32_bf16 v[56:59], v[224:227], v[84:87], v[56:59]
s_mov_b32 s55, 0xffffff00
s_nop 6
v_and_or_b32 v56, v56, s55, v19
s_waitcnt vmcnt(5)
L_p1j:
s_barrier
buffer_store_dword v56, v24, s[4:7], s53 offen sc1
s_cmp_ge_u32 s2, 224
s_cbranch_scc1 L_svc1
buffer_load_dwordx4 v[140:143], v4, s[8:11], s45 offen offset:0
buffer_load_dwordx4 v[144:147], v4, s[8:11], s45 offen offset:256
buffer_load_dwordx4 v[148:151], v4, s[8:11], s45 offen offset:512
buffer_load_dwordx4 v[152:155], v4, s[8:11], s45 offen offset:768
buffer_load_dwordx4 v[156:159], v4, s[8:11], s45 offen offset:1024
s_add_u32 s45, s45, 40960
s_mul_i32 s55, s3, 80
v_add_u32 v30, s55, v1
v_add_u32 v31, 64, v30
v_cmp_gt_u32 vcc, 16, v1
v_lshrrev_b32 v32, 2, v30
v_and_b32 v33, 3, v30
v_lshlrev_b32 v33, 4, v33
v_lshl_add_u32 v248, v32, 7, v33
v_add_u32 v249, 2048, v248
v_cndmask_b32 v249, v26, v249, vcc
v_cndmask_b32 v250, 0, -1, vcc
v_lshlrev_b32 v251, 4, v30
v_add_u32 v251, 122880, v251
v_cmp_le_u32 vcc, 160, v30
s_mov_b32 s56, 4096
s_mov_b32 s57, 14336
s_mov_b32 s58, 24576
v_cndmask_b32 v252, 0, 1.0, vcc
v_mov_b32 v255, v26
v_lshrrev_b32 v30, 1, v3
v_and_b32 v31, 1, v3
v_mul_u32_u24 v30, 7680, v30
s_lshl_b32 s55, s3, 9
v_lshlrev_b32 v32, 8, v31
v_lshl_add_u32 v32, v2, 4, v32
v_add3_u32 v5, v30, v32, s55
v_lshrrev_b32 v32, 2, v2
v_cmp_ne_u32 vcc, 1, v32
v_max_u32 v32, 1, v32
v_add_u32 v32, -1, v32
v_mul_u32_u24 v32, 2560, v32
v_lshl_add_u32 v32, v31, 6, v32
v_and_b32 v33, 3, v2
v_lshl_add_u32 v32, v33, 4, v32
s_lshl_b32 s55, s3, 7
s_add_u32 s55, s55, 2048
v_add3_u32 v6, v30, v32, s55
v_cndmask_b32 v6, v26, v6, vcc
v_lshrrev_b32 v30, 4, v0
v_and_b32 v31, 7, v2
v_xor_b32 v30, v30, v31
v_lshlrev_b32 v30, 4, v30
v_lshl_add_u32 v30, v33, 8, v30
v_lshrrev_b32 v32, 2, v2
v_mul_u32_u24 v32, 5120, v32
v_add_u32 v7, v30, v32
v_xor_b32 v30, v2, v3
v_lshlrev_b32 v30, 4, v30
v_lshl_add_u32 v8, v3, 8, v30
v_xor_b32 v9, 64, v8
v_lshlrev_b32 v10, 5, v2
v_add_u32 v10, 122880, v10
s_mul_i32 s59, s44, 307200
s_add_u32 s59, s59, 1048576
s_add_u32 s60, s59, 5120
s_mov_b32 s55, 0x3f803f80
v_mov_b32 v20, 0
v_mov_b32 v21, 0
v_dot2c_f32_bf16 v20, s55, v100
v_dot2c_f32_bf16 v21, v100, v100
v_dot2c_f32_bf16 v20, s55, v101
v_dot2c_f32_bf16 v21, v101, v101
v_dot2c_f32_bf16 v20, s55, v102
v_dot2c_f32_bf16 v21, v102, v102
v_dot2c_f32_bf16 v20, s55, v103
v_dot2c_f32_bf16 v21, v103, v103
v_dot2c_f32_bf16 v20, s55, v104
v_dot2c_f32_bf16 v21, v104, v104
v_dot2c_f32_bf16 v20, s55, v105
v_dot2c_f32_bf16 v21, v105, v105
v_dot2c_f32_bf16 v20, s55, v106
v_dot2c_f32_bf16 v21, v106, v106
v_dot2c_f32_bf16 v20, s55, v107
v_dot2c_f32_bf16 v21, v107, v107
v_dot2c_f32_bf16 v20, s55, v108
v_dot2c_f32_bf16 v21, v108, v108
v_dot2c_f32_bf16 v20, s55, v109
v_dot2c_f32_bf16 v21, v109, v109
v_dot2c_f32_bf16 v20, s55, v110
v_dot2c_f32_bf16 v21, v110, v110
v_dot2c_f32_bf16 v20, s55, v111
v_dot2c_f32_bf16 v21, v111, v111
v_dot2c_f32_bf16 v20, s55, v112
v_dot2c_f32_bf16 v21, v112, v112
v_dot2c_f32_bf16 v20, s55, v113
v_dot2c_f32_bf16 v21, v113, v113
v_dot2c_f32_bf16 v20, s55, v114
v_dot2c_f32_bf16 v21, v114, v114
v_dot2c_f32_bf16 v20, s55, v115
v_dot2c_f32_bf16 v21, v115, v115
v_dot2c_f32_bf16 v20, s55, v116
v_dot2c_f32_bf16 v21, v116, v116
v_dot2c_f32_bf16 v20, s55, v117
v_dot2c_f32_bf16 v21, v117, v117
v_dot2c_f32_bf16 v20, s55, v118
v_dot2c_f32_bf16 v21, v118, v118
v_dot2c_f32_bf16 v20, s55, v119
v_dot2c_f32_bf16 v21, v119, v119
s_nop 1
v_add_f32_dpp v20, v20, v20 row_ror:8 row_mask:0xf bank_mask:0xf
v_add_f32_dpp v21, v21, v21 row_ror:8 row_mask:0xf bank_mask:0xf
v_lshlrev_b32 v24, 16, v100
v_add_f32_dpp v20, v20, v20 row_ror:4 row_mask:0xf bank_mask:0xf
v_add_f32_dpp v21, v21, v21 row_ror:4 row_mask:0xf bank_mask:0xf
v_lshlrev_b32 v26, 16, v101
v_add_f32_dpp v20, v20, v20 row_ror:2 row_mask:0xf bank_mask:0xf
v_add_f32_dpp v21, v21, v21 row_ror:2 row_mask:0xf bank_mask:0xf
v_lshlrev_b32 v28, 16, v102
v_add_f32_dpp v20, v20, v20 row_ror:1 row_mask:0xf bank_mask:0xf
v_add_f32_dpp v21, v21, v21 row_ror:1 row_mask:0xf bank_mask:0xf
v_mul_f32 v20, 0x3acccccd, v20
v_mul_f32 v21, 0x3acccccd, v21
v_fma_f32 v21, -v20, v20, v21
v_max_f32 v21, 0, v21
v_add_f32 v21, 0x3727c5ac, v21
v_rsq_f32 v22, v21
v_and_b32 v25, 0xffff0000, v100
v_mul_f32 v23, -v20, v22
v_pk_fma_f32 v[24:25], v[24:25], v[22:23], v[22:23] op_sel:[0,0,1] op_sel_hi:[1,0,1]
v_and_b32 v27, 0xffff0000, v101
v_pk_fma_f32 v[26:27], v[26:27], v[22:23], v[22:23] op_sel:[0,0,1] op_sel_hi:[1,0,1]
v_cvt_pk_f16_f32 v100, v24, v25
v_and_b32 v29, 0xffff0000, v102
v_pk_fma_f32 v[28:29], v[28:29], v[22:23], v[22:23] op_sel:[0,0,1] op_sel_hi:[1,0,1]
v_cvt_pk_f16_f32 v101, v26, v27
v_lshlrev_b32 v30, 16, v103
v_and_b32 v31, 0xffff0000, v103
v_pk_fma_f32 v[30:31], v[30:31], v[22:23], v[22:23] op_sel:[0,0,1] op_sel_hi:[1,0,1]
v_cvt_pk_f16_f32 v102, v28, v29
v_lshlrev_b32 v24, 16, v104
v_and_b32 v25, 0xffff0000, v104
v_pk_fma_f32 v[24:25], v[24:25], v[22:23], v[22:23] op_sel:[0,0,1] op_sel_hi:[1,0,1]
v_cvt_pk_f16_f32 v103, v30, v31
v_lshlrev_b32 v26, 16, v105
v_and_b32 v27, 0xffff0000, v105
v_pk_fma_f32 v[26:27], v[26:27], v[22:23], v[22:23] op_sel:[0,0,1] op_sel_hi:[1,0,1]
v_cvt_pk_f16_f32 v104, v24, v25
v_lshlrev_b32 v28, 16, v106
v_and_b32 v29, 0xffff0000, v106
v_pk_fma_f32 v[28:29], v[28:29], v[22:23], v[22:23] op_sel:[0,0,1] op_sel_hi:[1,0,1]
v_cvt_pk_f16_f32 v105, v26, v27
v_lshlrev_b32 v30, 16, v107
v_and_b32 v31, 0xffff0000, v107
v_pk_fma_f32 v[30:31], v[30:31], v[22:23], v[22:23] op_sel:[0,0,1] op_sel_hi:[1,0,1]
v_cvt_pk_f16_f32 v106, v28, v29
v_lshlrev_b32 v24, 16, v108
v_and_b32 v25, 0xffff0000, v108
v_pk_fma_f32 v[24:25], v[24:25], v[22:23], v[22:23] op_sel:[0,0,1] op_sel_hi:[1,0,1]
v_cvt_pk_f16_f32 v107, v30, v31
v_lshlrev_b32 v26, 16, v109
v_and_b32 v27, 0xffff0000, v109
v_pk_fma_f32 v[26:27], v[26:27], v[22:23], v[22:23] op_sel:[0,0,1] op_sel_hi:[1,0,1]
v_cvt_pk_f16_f32 v108, v24, v25
v_lshlrev_b32 v28, 16, v110
v_and_b32 v29, 0xffff0000, v110
v_pk_fma_f32 v[28:29], v[28:29], v[22:23], v[22:23] op_sel:[0,0,1] op_sel_hi:[1,0,1]
v_cvt_pk_f16_f32 v109, v26, v27
v_lshlrev_b32 v30, 16, v111
v_and_b32 v31, 0xffff0000, v111
v_pk_fma_f32 v[30:31], v[30:31], v[22:23], v[22:23] op_sel:[0,0,1] op_sel_hi:[1,0,1]
v_cvt_pk_f16_f32 v110, v28, v29
v_lshlrev_b32 v24, 16, v112
v_and_b32 v25, 0xffff0000, v112
v_pk_fma_f32 v[24:25], v[24:25], v[22:23], v[22:23] op_sel:[0,0,1] op_sel_hi:[1,0,1]
v_cvt_pk_f16_f32 v111, v30, v31
v_lshlrev_b32 v26, 16, v113
v_and_b32 v27, 0xffff0000, v113
v_pk_fma_f32 v[26:27], v[26:27], v[22:23], v[22:23] op_sel:[0,0,1] op_sel_hi:[1,0,1]
v_cvt_pk_f16_f32 v112, v24, v25
v_lshlrev_b32 v28, 16, v114
v_and_b32 v29, 0xffff0000, v114
v_pk_fma_f32 v[28:29], v[28:29], v[22:23], v[22:23] op_sel:[0,0,1] op_sel_hi:[1,0,1]
v_cvt_pk_f16_f32 v113, v26, v27
v_lshlrev_b32 v30, 16, v115
v_and_b32 v31, 0xffff0000, v115
v_pk_fma_f32 v[30:31], v[30:31], v[22:23], v[22:23] op_sel:[0,0,1] op_sel_hi:[1,0,1]
v_cvt_pk_f16_f32 v114, v28, v29
v_lshlrev_b32 v24, 16, v116
v_and_b32 v25, 0xffff0000, v116
v_pk_fma_f32 v[24:25], v[24:25], v[22:23], v[22:23] op_sel:[0,0,1] op_sel_hi:[1,0,1]
v_cvt_pk_f16_f32 v115, v30, v31
v_lshlrev_b32 v26, 16, v117
v_and_b32 v27, 0xffff0000, v117
v_pk_fma_f32 v[26:27], v[26:27], v[22:23], v[22:23] op_sel:[0,0,1] op_sel_hi:[1,0,1]
v_cvt_pk_f16_f32 v116, v24, v25
v_lshlrev_b32 v28, 16, v118
v_and_b32 v29, 0xffff0000, v118
v_pk_fma_f32 v[28:29], v[28:29], v[22:23], v[22:23] op_sel:[0,0,1] op_sel_hi:[1,0,1]
v_cvt_pk_f16_f32 v117, v26, v27
v_lshlrev_b32 v30, 16, v119
v_and_b32 v31, 0xffff0000, v119
v_pk_fma_f32 v[30:31], v[30:31], v[22:23], v[22:23] op_sel:[0,0,1] op_sel_hi:[1,0,1]
v_cvt_pk_f16_f32 v118, v28, v29
v_cvt_pk_f16_f32 v119, v30, v31
buffer_load_dwordx4 v[160:163], v4, s[8:11], s45 offen offset:0
buffer_load_dwordx4 v[164:167], v4, s[8:11], s45 offen offset:256
buffer_load_dwordx4 v[168:171], v4, s[8:11], s45 offen offset:512
buffer_load_dwordx4 v[172:175], v4, s[8:11], s45 offen offset:768
buffer_load_dwordx4 v[176:179], v4, s[8:11], s45 offen offset:1024
s_add_u32 s45, s45, 40960
s_waitcnt vmcnt(11)
s_mov_b32 s55, 0x3f803f80
v_mov_b32 v20, 0
v_mov_b32 v21, 0
v_dot2c_f32_bf16 v20, s55, v120
v_dot2c_f32_bf16 v21, v120, v120
v_dot2c_f32_bf16 v20, s55, v121
v_dot2c_f32_bf16 v21, v121, v121
v_dot2c_f32_bf16 v20, s55, v122
v_dot2c_f32_bf16 v21, v122, v122
v_dot2c_f32_bf16 v20, s55, v123
v_dot2c_f32_bf16 v21, v123, v123
v_dot2c_f32_bf16 v20, s55, v124
v_dot2c_f32_bf16 v21, v124, v124
v_dot2c_f32_bf16 v20, s55, v125
v_dot2c_f32_bf16 v21, v125, v125
v_dot2c_f32_bf16 v20, s55, v126
v_dot2c_f32_bf16 v21, v126, v126
v_dot2c_f32_bf16 v20, s55, v127
v_dot2c_f32_bf16 v21, v127, v127
v_dot2c_f32_bf16 v20, s55, v128
v_dot2c_f32_bf16 v21, v128, v128
v_dot2c_f32_bf16 v20, s55, v129
v_dot2c_f32_bf16 v21, v129, v129
v_dot2c_f32_bf16 v20, s55, v130
v_dot2c_f32_bf16 v21, v130, v130
v_dot2c_f32_bf16 v20, s55, v131
v_dot2c_f32_bf16 v21, v131, v131
v_dot2c_f32_bf16 v20, s55, v132
v_dot2c_f32_bf16 v21, v132, v132
v_dot2c_f32_bf16 v20, s55, v133
v_dot2c_f32_bf16 v21, v133, v133
v_dot2c_f32_bf16 v20, s55, v134
v_dot2c_f32_bf16 v21, v134, v134
v_dot2c_f32_bf16 v20, s55, v135
v_dot2c_f32_bf16 v21, v135, v135
v_dot2c_f32_bf16 v20, s55, v136
v_dot2c_f32_bf16 v21, v136, v136
v_dot2c_f32_bf16 v20, s55, v137
v_dot2c_f32_bf16 v21, v137, v137
v_dot2c_f32_bf16 v20, s55, v138
v_dot2c_f32_bf16 v21, v138, v138
v_dot2c_f32_bf16 v20, s55, v139
v_dot2c_f32_bf16 v21, v139, v139
s_nop 1
v_add_f32_dpp v20, v20, v20 row_ror:8 row_mask:0xf bank_mask:0xf
v_add_f32_dpp v21, v21, v21 row_ror:8 row_mask:0xf bank_mask:0xf
v_lshlrev_b32 v24, 16, v120
v_add_f32_dpp v20, v20, v20 row_ror:4 row_mask:0xf bank_mask:0xf
v_add_f32_dpp v21, v21, v21 row_ror:4 row_mask:0xf bank_mask:0xf
v_lshlrev_b32 v26, 16, v121
v_add_f32_dpp v20, v20, v20 row_ror:2 row_mask:0xf bank_mask:0xf
v_add_f32_dpp v21, v21, v21 row_ror:2 row_mask:0xf bank_mask:0xf
v_lshlrev_b32 v28, 16, v122
v_add_f32_dpp v20, v20, v20 row_ror:1 row_mask:0xf bank_mask:0xf
v_add_f32_dpp v21, v21, v21 row_ror:1 row_mask:0xf bank_mask:0xf
v_mul_f32 v20, 0x3acccccd, v20
v_mul_f32 v21, 0x3acccccd, v21
v_fma_f32 v21, -v20, v20, v21
v_max_f32 v21, 0, v21
v_add_f32 v21, 0x3727c5ac, v21
v_rsq_f32 v22, v21
v_and_b32 v25, 0xffff0000, v120
v_mul_f32 v23, -v20, v22
v_pk_fma_f32 v[24:25], v[24:25], v[22:23], v[22:23] op_sel:[0,0,1] op_sel_hi:[1,0,1]
v_and_b32 v27, 0xffff0000, v121
v_pk_fma_f32 v[26:27], v[26:27], v[22:23], v[22:23] op_sel:[0,0,1] op_sel_hi:[1,0,1]
v_cvt_pk_f16_f32 v120, v24, v25
v_and_b32 v29, 0xffff0000, v122
v_pk_fma_f32 v[28:29], v[28:29], v[22:23], v[22:23] op_sel:[0,0,1] op_sel_hi:[1,0,1]
v_cvt_pk_f16_f32 v121, v26, v27
v_lshlrev_b32 v30, 16, v123
v_and_b32 v31, 0xffff0000, v123
v_pk_fma_f32 v[30:31], v[30:31], v[22:23], v[22:23] op_sel:[0,0,1] op_sel_hi:[1,0,1]
v_cvt_pk_f16_f32 v122, v28, v29
v_lshlrev_b32 v24, 16, v124
v_and_b32 v25, 0xffff0000, v124
v_pk_fma_f32 v[24:25], v[24:25], v[22:23], v[22:23] op_sel:[0,0,1] op_sel_hi:[1,0,1]
v_cvt_pk_f16_f32 v123, v30, v31
v_lshlrev_b32 v26, 16, v125
v_and_b32 v27, 0xffff0000, v125
v_pk_fma_f32 v[26:27], v[26:27], v[22:23], v[22:23] op_sel:[0,0,1] op_sel_hi:[1,0,1]
v_cvt_pk_f16_f32 v124, v24, v25
v_lshlrev_b32 v28, 16, v126
v_and_b32 v29, 0xffff0000, v126
v_pk_fma_f32 v[28:29], v[28:29], v[22:23], v[22:23] op_sel:[0,0,1] op_sel_hi:[1,0,1]
v_cvt_pk_f16_f32 v125, v26, v27
v_lshlrev_b32 v30, 16, v127
v_and_b32 v31, 0xffff0000, v127
v_pk_fma_f32 v[30:31], v[30:31], v[22:23], v[22:23] op_sel:[0,0,1] op_sel_hi:[1,0,1]
v_cvt_pk_f16_f32 v126, v28, v29
v_lshlrev_b32 v24, 16, v128
v_and_b32 v25, 0xffff0000, v128
v_pk_fma_f32 v[24:25], v[24:25], v[22:23], v[22:23] op_sel:[0,0,1] op_sel_hi:[1,0,1]
v_cvt_pk_f16_f32 v127, v30, v31
v_lshlrev_b32 v26, 16, v129
v_and_b32 v27, 0xffff0000, v129
v_pk_fma_f32 v[26:27], v[26:27], v[22:23], v[22:23] op_sel:[0,0,1] op_sel_hi:[1,0,1]
v_cvt_pk_f16_f32 v128, v24, v25
v_lshlrev_b32 v28, 16, v130
v_and_b32 v29, 0xffff0000, v130
v_pk_fma_f32 v[28:29], v[28:29], v[22:23], v[22:23] op_sel:[0,0,1] op_sel_hi:[1,0,1]
v_cvt_pk_f16_f32 v129, v26, v27
v_lshlrev_b32 v30, 16, v131
v_and_b32 v31, 0xffff0000, v131
v_pk_fma_f32 v[30:31], v[30:31], v[22:23], v[22:23] op_sel:[0,0,1] op_sel_hi:[1,0,1]
v_cvt_pk_f16_f32 v130, v28, v29
v_lshlrev_b32 v24, 16, v132
v_and_b32 v25, 0xffff0000, v132
v_pk_fma_f32 v[24:25], v[24:25], v[22:23], v[22:23] op_sel:[0,0,1] op_sel_hi:[1,0,1]
v_cvt_pk_f16_f32 v131, v30, v31
v_lshlrev_b32 v26, 16, v133
v_and_b32 v27, 0xffff0000, v133
v_pk_fma_f32 v[26:27], v[26:27], v[22:23], v[22:23] op_sel:[0,0,1] op_sel_hi:[1,0,1]
v_cvt_pk_f16_f32 v132, v24, v25
v_lshlrev_b32 v28, 16, v134
v_and_b32 v29, 0xffff0000, v134
v_pk_fma_f32 v[28:29], v[28:29], v[22:23], v[22:23] op_sel:[0,0,1] op_sel_hi:[1,0,1]
v_cvt_pk_f16_f32 v133, v26, v27
v_lshlrev_b32 v30, 16, v135
v_and_b32 v31, 0xffff0000, v135
v_pk_fma_f32 v[30:31], v[30:31], v[22:23], v[22:23] op_sel:[0,0,1] op_sel_hi:[1,0,1]
v_cvt_pk_f16_f32 v134, v28, v29
v_lshlrev_b32 v24, 16, v136
v_and_b32 v25, 0xffff0000, v136
v_pk_fma_f32 v[24:25], v[24:25], v[22:23], v[22:23] op_sel:[0,0,1] op_sel_hi:[1,0,1]
v_cvt_pk_f16_f32 v135, v30, v31
v_lshlrev_b32 v26, 16, v137
v_and_b32 v27, 0xffff0000, v137
v_pk_fma_f32 v[26:27], v[26:27], v[22:23], v[22:23] op_sel:[0,0,1] op_sel_hi:[1,0,1]
v_cvt_pk_f16_f32 v136, v24, v25
v_lshlrev_b32 v28, 16, v138
v_and_b32 v29, 0xffff0000, v138
v_pk_fma_f32 v[28:29], v[28:29], v[22:23], v[22:23] op_sel:[0,0,1] op_sel_hi:[1,0,1]
v_cvt_pk_f16_f32 v137, v26, v27
v_lshlrev_b32 v30, 16, v139
v_and_b32 v31, 0xffff0000, v139
v_pk_fma_f32 v[30:31], v[30:31], v[22:23], v[22:23] op_sel:[0,0,1] op_sel_hi:[1,0,1]
v_cvt_pk_f16_f32 v138, v28, v29
v_cvt_pk_f16_f32 v139, v30, v31
buffer_load_dwordx4 v[180:183], v4, s[8:11], s45 offen offset:0
buffer_load_dwordx4 v[184:187], v4, s[8:11], s45 offen offset:256
buffer_load_dwordx4 v[188:191], v4, s[8:11], s45 offen offset:512
buffer_load_dwordx4 v[192:195], v4, s[8:11], s45 offen offset:768
buffer_load_dwordx4 v[196:199], v4, s[8:11], s45 offen offset:1024
s_add_u32 s45, s45, 40960
buffer_load_dwordx4 v[40:43], v248, s[4:7], s56 offen sc1
buffer_load_dwordx4 v[44:47], v248, s[4:7], s57 offen sc1
buffer_load_dwordx4 v[48:51], v248, s[4:7], s58 offen sc1
buffer_load_dwordx4 v[52:55], v249, s[4:7], s56 offen sc1
buffer_load_dwordx4 v[56:59], v249, s[4:7], s57 offen sc1
buffer_load_dwordx4 v[60:63], v249, s[4:7], s58 offen sc1
s_waitcnt vmcnt(16)
s_mov_b32 s55, 0x3f803f80
v_mov_b32 v20, 0
v_mov_b32 v21, 0
v_dot2c_f32_bf16 v20, s55, v140
v_dot2c_f32_bf16 v21, v140, v140
v_dot2c_f32_bf16 v20, s55, v141
v_dot2c_f32_bf16 v21, v141, v141
v_dot2c_f32_bf16 v20, s55, v142
v_dot2c_f32_bf16 v21, v142, v142
v_dot2c_f32_bf16 v20, s55, v143
v_dot2c_f32_bf16 v21, v143, v143
v_dot2c_f32_bf16 v20, s55, v144
v_dot2c_f32_bf16 v21, v144, v144
v_dot2c_f32_bf16 v20, s55, v145
v_dot2c_f32_bf16 v21, v145, v145
v_dot2c_f32_bf16 v20, s55, v146
v_dot2c_f32_bf16 v21, v146, v146
v_dot2c_f32_bf16 v20, s55, v147
v_dot2c_f32_bf16 v21, v147, v147
v_dot2c_f32_bf16 v20, s55, v148
v_dot2c_f32_bf16 v21, v148, v148
v_dot2c_f32_bf16 v20, s55, v149
v_dot2c_f32_bf16 v21, v149, v149
v_dot2c_f32_bf16 v20, s55, v150
v_dot2c_f32_bf16 v21, v150, v150
v_dot2c_f32_bf16 v20, s55, v151
v_dot2c_f32_bf16 v21, v151, v151
v_dot2c_f32_bf16 v20, s55, v152
v_dot2c_f32_bf16 v21, v152, v152
v_dot2c_f32_bf16 v20, s55, v153
v_dot2c_f32_bf16 v21, v153, v153
v_dot2c_f32_bf16 v20, s55, v154
v_dot2c_f32_bf16 v21, v154, v154
v_dot2c_f32_bf16 v20, s55, v155
v_dot2c_f32_bf16 v21, v155, v155
v_dot2c_f32_bf16 v20, s55, v156
v_dot2c_f32_bf16 v21, v156, v156
v_dot2c_f32_bf16 v20, s55, v157
v_dot2c_f32_bf16 v21, v157, v157
v_dot2c_f32_bf16 v20, s55, v158
v_dot2c_f32_bf16 v21, v158, v158
v_dot2c_f32_bf16 v20, s55, v159
v_dot2c_f32_bf16 v21, v159, v159
s_nop 1
v_add_f32_dpp v20, v20, v20 row_ror:8 row_mask:0xf bank_mask:0xf
v_add_f32_dpp v21, v21, v21 row_ror:8 row_mask:0xf bank_mask:0xf
v_lshlrev_b32 v24, 16, v140
v_add_f32_dpp v20, v20, v20 row_ror:4 row_mask:0xf bank_mask:0xf
v_add_f32_dpp v21, v21, v21 row_ror:4 row_mask:0xf bank_mask:0xf
v_lshlrev_b32 v26, 16, v141
v_add_f32_dpp v20, v20, v20 row_ror:2 row_mask:0xf bank_mask:0xf
v_add_f32_dpp v21, v21, v21 row_ror:2 row_mask:0xf bank_mask:0xf
v_lshlrev_b32 v28, 16, v142
v_add_f32_dpp v20, v20, v20 row_ror:1 row_mask:0xf bank_mask:0xf
v_add_f32_dpp v21, v21, v21 row_ror:1 row_mask:0xf bank_mask:0xf
v_mul_f32 v20, 0x3acccccd, v20
v_mul_f32 v21, 0x3acccccd, v21
v_fma_f32 v21, -v20, v20, v21
v_max_f32 v21, 0, v21
v_add_f32 v21, 0x3727c5ac, v21
v_rsq_f32 v22, v21
v_and_b32 v25, 0xffff0000, v140
v_mul_f32 v23, -v20, v22
v_pk_fma_f32 v[24:25], v[24:25], v[22:23], v[22:23] op_sel:[0,0,1] op_sel_hi:[1,0,1]
v_and_b32 v27, 0xffff0000, v141
v_pk_fma_f32 v[26:27], v[26:27], v[22:23], v[22:23] op_sel:[0,0,1] op_sel_hi:[1,0,1]
v_cvt_pk_f16_f32 v140, v24, v25
v_and_b32 v29, 0xffff0000, v142
v_pk_fma_f32 v[28:29], v[28:29], v[22:23], v[22:23] op_sel:[0,0,1] op_sel_hi:[1,0,1]
v_cvt_pk_f16_f32 v141, v26, v27
v_lshlrev_b32 v30, 16, v143
v_and_b32 v31, 0xffff0000, v143
v_pk_fma_f32 v[30:31], v[30:31], v[22:23], v[22:23] op_sel:[0,0,1] op_sel_hi:[1,0,1]
v_cvt_pk_f16_f32 v142, v28, v29
v_lshlrev_b32 v24, 16, v144
v_and_b32 v25, 0xffff0000, v144
v_pk_fma_f32 v[24:25], v[24:25], v[22:23], v[22:23] op_sel:[0,0,1] op_sel_hi:[1,0,1]
v_cvt_pk_f16_f32 v143, v30, v31
v_lshlrev_b32 v26, 16, v145
v_and_b32 v27, 0xffff0000, v145
v_pk_fma_f32 v[26:27], v[26:27], v[22:23], v[22:23] op_sel:[0,0,1] op_sel_hi:[1,0,1]
v_cvt_pk_f16_f32 v144, v24, v25
v_lshlrev_b32 v28, 16, v146
v_and_b32 v29, 0xffff0000, v146
v_pk_fma_f32 v[28:29], v[28:29], v[22:23], v[22:23] op_sel:[0,0,1] op_sel_hi:[1,0,1]
v_cvt_pk_f16_f32 v145, v26, v27
v_lshlrev_b32 v30, 16, v147
v_and_b32 v31, 0xffff0000, v147
v_pk_fma_f32 v[30:31], v[30:31], v[22:23], v[22:23] op_sel:[0,0,1] op_sel_hi:[1,0,1]
v_cvt_pk_f16_f32 v146, v28, v29
v_lshlrev_b32 v24, 16, v148
v_and_b32 v25, 0xffff0000, v148
v_pk_fma_f32 v[24:25], v[24:25], v[22:23], v[22:23] op_sel:[0,0,1] op_sel_hi:[1,0,1]
v_cvt_pk_f16_f32 v147, v30, v31
v_lshlrev_b32 v26, 16, v149
v_and_b32 v27, 0xffff0000, v149
v_pk_fma_f32 v[26:27], v[26:27], v[22:23], v[22:23] op_sel:[0,0,1] op_sel_hi:[1,0,1]
v_cvt_pk_f16_f32 v148, v24, v25
v_lshlrev_b32 v28, 16, v150
v_and_b32 v29, 0xffff0000, v150
v_pk_fma_f32 v[28:29], v[28:29], v[22:23], v[22:23] op_sel:[0,0,1] op_sel_hi:[1,0,1]
v_cvt_pk_f16_f32 v149, v26, v27
v_lshlrev_b32 v30, 16, v151
v_and_b32 v31, 0xffff0000, v151
v_pk_fma_f32 v[30:31], v[30:31], v[22:23], v[22:23] op_sel:[0,0,1] op_sel_hi:[1,0,1]
v_cvt_pk_f16_f32 v150, v28, v29
v_lshlrev_b32 v24, 16, v152
v_and_b32 v25, 0xffff0000, v152
v_pk_fma_f32 v[24:25], v[24:25], v[22:23], v[22:23] op_sel:[0,0,1] op_sel_hi:[1,0,1]
v_cvt_pk_f16_f32 v151, v30, v31
v_lshlrev_b32 v26, 16, v153
v_and_b32 v27, 0xffff0000, v153
v_pk_fma_f32 v[26:27], v[26:27], v[22:23], v[22:23] op_sel:[0,0,1] op_sel_hi:[1,0,1]
v_cvt_pk_f16_f32 v152, v24, v25
v_lshlrev_b32 v28, 16, v154
v_and_b32 v29, 0xffff0000, v154
v_pk_fma_f32 v[28:29], v[28:29], v[22:23], v[22:23] op_sel:[0,0,1] op_sel_hi:[1,0,1]
v_cvt_pk_f16_f32 v153, v26, v27
v_lshlrev_b32 v30, 16, v155
v_and_b32 v31, 0xffff0000, v155
v_pk_fma_f32 v[30:31], v[30:31], v[22:23], v[22:23] op_sel:[0,0,1] op_sel_hi:[1,0,1]
v_cvt_pk_f16_f32 v154, v28, v29
v_lshlrev_b32 v24, 16, v156
v_and_b32 v25, 0xffff0000, v156
v_pk_fma_f32 v[24:25], v[24:25], v[22:23], v[22:23] op_sel:[0,0,1] op_sel_hi:[1,0,1]
v_cvt_pk_f16_f32 v155, v30, v31
v_lshlrev_b32 v26, 16, v157
v_and_b32 v27, 0xffff0000, v157
v_pk_fma_f32 v[26:27], v[26:27], v[22:23], v[22:23] op_sel:[0,0,1] op_sel_hi:[1,0,1]
v_cvt_pk_f16_f32 v156, v24, v25
v_lshlrev_b32 v28, 16, v158
v_and_b32 v29, 0xffff0000, v158
v_pk_fma_f32 v[28:29], v[28:29], v[22:23], v[22:23] op_sel:[0,0,1] op_sel_hi:[1,0,1]
v_cvt_pk_f16_f32 v157, v26, v27
v_lshlrev_b32 v30, 16, v159
v_and_b32 v31, 0xffff0000, v159
v_pk_fma_f32 v[30:31], v[30:31], v[22:23], v[22:23] op_sel:[0,0,1] op_sel_hi:[1,0,1]
v_cvt_pk_f16_f32 v158, v28, v29
v_cvt_pk_f16_f32 v159, v30, v31
s_waitcnt vmcnt(11)
s_mov_b32 s55, 0x3f803f80
v_mov_b32 v20, 0
v_mov_b32 v21, 0
v_dot2c_f32_bf16 v20, s55, v160
v_dot2c_f32_bf16 v21, v160, v160
v_dot2c_f32_bf16 v20, s55, v161
v_dot2c_f32_bf16 v21, v161, v161
v_dot2c_f32_bf16 v20, s55, v162
v_dot2c_f32_bf16 v21, v162, v162
v_dot2c_f32_bf16 v20, s55, v163
v_dot2c_f32_bf16 v21, v163, v163
v_dot2c_f32_bf16 v20, s55, v164
v_dot2c_f32_bf16 v21, v164, v164
v_dot2c_f32_bf16 v20, s55, v165
v_dot2c_f32_bf16 v21, v165, v165
v_dot2c_f32_bf16 v20, s55, v166
v_dot2c_f32_bf16 v21, v166, v166
v_dot2c_f32_bf16 v20, s55, v167
v_dot2c_f32_bf16 v21, v167, v167
v_dot2c_f32_bf16 v20, s55, v168
v_dot2c_f32_bf16 v21, v168, v168
v_dot2c_f32_bf16 v20, s55, v169
v_dot2c_f32_bf16 v21, v169, v169
v_dot2c_f32_bf16 v20, s55, v170
v_dot2c_f32_bf16 v21, v170, v170
v_dot2c_f32_bf16 v20, s55, v171
v_dot2c_f32_bf16 v21, v171, v171
v_dot2c_f32_bf16 v20, s55, v172
v_dot2c_f32_bf16 v21, v172, v172
v_dot2c_f32_bf16 v20, s55, v173
v_dot2c_f32_bf16 v21, v173, v173
v_dot2c_f32_bf16 v20, s55, v174
v_dot2c_f32_bf16 v21, v174, v174
v_dot2c_f32_bf16 v20, s55, v175
v_dot2c_f32_bf16 v21, v175, v175
v_dot2c_f32_bf16 v20, s55, v176
v_dot2c_f32_bf16 v21, v176, v176
v_dot2c_f32_bf16 v20, s55, v177
v_dot2c_f32_bf16 v21, v177, v177
v_dot2c_f32_bf16 v20, s55, v178
v_dot2c_f32_bf16 v21, v178, v178
v_dot2c_f32_bf16 v20, s55, v179
v_dot2c_f32_bf16 v21, v179, v179
s_nop 1
v_add_f32_dpp v20, v20, v20 row_ror:8 row_mask:0xf bank_mask:0xf
v_add_f32_dpp v21, v21, v21 row_ror:8 row_mask:0xf bank_mask:0xf
v_lshlrev_b32 v24, 16, v160
v_add_f32_dpp v20, v20, v20 row_ror:4 row_mask:0xf bank_mask:0xf
v_add_f32_dpp v21, v21, v21 row_ror:4 row_mask:0xf bank_mask:0xf
v_lshlrev_b32 v26, 16, v161
v_add_f32_dpp v20, v20, v20 row_ror:2 row_mask:0xf bank_mask:0xf
v_add_f32_dpp v21, v21, v21 row_ror:2 row_mask:0xf bank_mask:0xf
v_lshlrev_b32 v28, 16, v162
v_add_f32_dpp v20, v20, v20 row_ror:1 row_mask:0xf bank_mask:0xf
v_add_f32_dpp v21, v21, v21 row_ror:1 row_mask:0xf bank_mask:0xf
v_mul_f32 v20, 0x3acccccd, v20
v_mul_f32 v21, 0x3acccccd, v21
v_fma_f32 v21, -v20, v20, v21
v_max_f32 v21, 0, v21
v_add_f32 v21, 0x3727c5ac, v21
v_rsq_f32 v22, v21
v_and_b32 v25, 0xffff0000, v160
v_mul_f32 v23, -v20, v22
v_pk_fma_f32 v[24:25], v[24:25], v[22:23], v[22:23] op_sel:[0,0,1] op_sel_hi:[1,0,1]
v_and_b32 v27, 0xffff0000, v161
v_pk_fma_f32 v[26:27], v[26:27], v[22:23], v[22:23] op_sel:[0,0,1] op_sel_hi:[1,0,1]
v_cvt_pk_f16_f32 v160, v24, v25
v_and_b32 v29, 0xffff0000, v162
v_pk_fma_f32 v[28:29], v[28:29], v[22:23], v[22:23] op_sel:[0,0,1] op_sel_hi:[1,0,1]
v_cvt_pk_f16_f32 v161, v26, v27
v_lshlrev_b32 v30, 16, v163
v_and_b32 v31, 0xffff0000, v163
v_pk_fma_f32 v[30:31], v[30:31], v[22:23], v[22:23] op_sel:[0,0,1] op_sel_hi:[1,0,1]
v_cvt_pk_f16_f32 v162, v28, v29
v_lshlrev_b32 v24, 16, v164
v_and_b32 v25, 0xffff0000, v164
v_pk_fma_f32 v[24:25], v[24:25], v[22:23], v[22:23] op_sel:[0,0,1] op_sel_hi:[1,0,1]
v_cvt_pk_f16_f32 v163, v30, v31
v_lshlrev_b32 v26, 16, v165
v_and_b32 v27, 0xffff0000, v165
v_pk_fma_f32 v[26:27], v[26:27], v[22:23], v[22:23] op_sel:[0,0,1] op_sel_hi:[1,0,1]
v_cvt_pk_f16_f32 v164, v24, v25
v_lshlrev_b32 v28, 16, v166
v_and_b32 v29, 0xffff0000, v166
v_pk_fma_f32 v[28:29], v[28:29], v[22:23], v[22:23] op_sel:[0,0,1] op_sel_hi:[1,0,1]
v_cvt_pk_f16_f32 v165, v26, v27
v_lshlrev_b32 v30, 16, v167
v_and_b32 v31, 0xffff0000, v167
v_pk_fma_f32 v[30:31], v[30:31], v[22:23], v[22:23] op_sel:[0,0,1] op_sel_hi:[1,0,1]
v_cvt_pk_f16_f32 v166, v28, v29
v_lshlrev_b32 v24, 16, v168
v_and_b32 v25, 0xffff0000, v168
v_pk_fma_f32 v[24:25], v[24:25], v[22:23], v[22:23] op_sel:[0,0,1] op_sel_hi:[1,0,1]
v_cvt_pk_f16_f32 v167, v30, v31
v_lshlrev_b32 v26, 16, v169
v_and_b32 v27, 0xffff0000, v169
v_pk_fma_f32 v[26:27], v[26:27], v[22:23], v[22:23] op_sel:[0,0,1] op_sel_hi:[1,0,1]
v_cvt_pk_f16_f32 v168, v24, v25
v_lshlrev_b32 v28, 16, v170
v_and_b32 v29, 0xffff0000, v170
v_pk_fma_f32 v[28:29], v[28:29], v[22:23], v[22:23] op_sel:[0,0,1] op_sel_hi:[1,0,1]
v_cvt_pk_f16_f32 v169, v26, v27
v_lshlrev_b32 v30, 16, v171
v_and_b32 v31, 0xffff0000, v171
v_pk_fma_f32 v[30:31], v[30:31], v[22:23], v[22:23] op_sel:[0,0,1] op_sel_hi:[1,0,1]
v_cvt_pk_f16_f32 v170, v28, v29
v_lshlrev_b32 v24, 16, v172
v_and_b32 v25, 0xffff0000, v172
v_pk_fma_f32 v[24:25], v[24:25], v[22:23], v[22:23] op_sel:[0,0,1] op_sel_hi:[1,0,1]
v_cvt_pk_f16_f32 v171, v30, v31
v_lshlrev_b32 v26, 16, v173
v_and_b32 v27, 0xffff0000, v173
v_pk_fma_f32 v[26:27], v[26:27], v[22:23], v[22:23] op_sel:[0,0,1] op_sel_hi:[1,0,1]
v_cvt_pk_f16_f32 v172, v24, v25
v_lshlrev_b32 v28, 16, v174
v_and_b32 v29, 0xffff0000, v174
v_pk_fma_f32 v[28:29], v[28:29], v[22:23], v[22:23] op_sel:[0,0,1] op_sel_hi:[1,0,1]
v_cvt_pk_f16_f32 v173, v26, v27
v_lshlrev_b32 v30, 16, v175
v_and_b32 v31, 0xffff0000, v175
v_pk_fma_f32 v[30:31], v[30:31], v[22:23], v[22:23] op_sel:[0,0,1] op_sel_hi:[1,0,1]
v_cvt_pk_f16_f32 v174, v28, v29
v_lshlrev_b32 v24, 16, v176
v_and_b32 v25, 0xffff0000, v176
v_pk_fma_f32 v[24:25], v[24:25], v[22:23], v[22:23] op_sel:[0,0,1] op_sel_hi:[1,0,1]
v_cvt_pk_f16_f32 v175, v30, v31
v_lshlrev_b32 v26, 16, v177
v_and_b32 v27, 0xffff0000, v177
v_pk_fma_f32 v[26:27], v[26:27], v[22:23], v[22:23] op_sel:[0,0,1] op_sel_hi:[1,0,1]
v_cvt_pk_f16_f32 v176, v24, v25
v_lshlrev_b32 v28, 16, v178
v_and_b32 v29, 0xffff0000, v178
v_pk_fma_f32 v[28:29], v[28:29], v[22:23], v[22:23] op_sel:[0,0,1] op_sel_hi:[1,0,1]
v_cvt_pk_f16_f32 v177, v26, v27
v_lshlrev_b32 v30, 16, v179
v_and_b32 v31, 0xffff0000, v179
v_pk_fma_f32 v[30:31], v[30:31], v[22:23], v[22:23] op_sel:[0,0,1] op_sel_hi:[1,0,1]
v_cvt_pk_f16_f32 v178, v28, v29
v_cvt_pk_f16_f32 v179, v30, v31
s_waitcnt vmcnt(0)
v_perm_b32 v64, v41, v40, s98
v_perm_b32 v65, v43, v42, s99
v_bitop3_b32 v66, v64, v65, s40 bitop3:0x56
v_perm_b32 v64, v45, v44, s98
v_perm_b32 v65, v47, v46, s99
v_bitop3_b32 v67, v64, v65, s40 bitop3:0x56
v_perm_b32 v64, v49, v48, s98
v_perm_b32 v65, v51, v50, s99
v_bitop3_b32 v68, v64, v65, s40 bitop3:0x56
v_or3_b32 v69, v66, v67, v68
v_perm_b32 v64, v53, v52, s98
v_perm_b32 v65, v55, v54, s99
v_bitop3_b32 v66, v64, v65, s40 bitop3:0x56
v_perm_b32 v64, v57, v56, s98
v_perm_b32 v65, v59, v58, s99
v_bitop3_b32 v67, v64, v65, s40 bitop3:0x56
v_perm_b32 v64, v61, v60, s98
v_perm_b32 v65, v63, v62, s99
v_bitop3_b32 v68, v64, v65, s40 bitop3:0x56
v_or3_b32 v70, v66, v67, v68
v_and_b32 v70, v70, v250
v_or_b32 v69, v69, v70
v_cmp_ne_u32 vcc, 0, v69
s_cbranch_vccnz L_ga_retry
L_ga_ok:
s_barrier
buffer_load_dwordx4 a[40:43], v5, s[4:7], s59 offen sc1
buffer_load_dwordx4 a[44:47], v5, s[4:7], s59 offen offset:2560 sc1
buffer_load_dwordx4 a[48:51], v5, s[4:7], s60 offen sc1
s_add_u32 s60, s60, 15360
buffer_load_dwordx4 a[52:55], v6, s[4:7], s59 offen sc1
s_add_u32 s59, s59, 15360
buffer_load_dwordx4 a[56:59], v5, s[4:7], s59 offen sc1
buffer_load_dwordx4 a[60:63], v5, s[4:7], s59 offen offset:2560 sc1
buffer_load_dwordx4 a[64:67], v5, s[4:7], s60 offen sc1
s_add_u32 s60, s60, 15360
buffer_load_dwordx4 a[68:71], v6, s[4:7], s59 offen sc1
s_add_u32 s59, s59, 15360
buffer_load_dwordx4 a[72:75], v5, s[4:7], s59 offen sc1
buffer_load_dwordx4 a[76:79], v5, s[4:7], s59 offen offset:2560 sc1
buffer_load_dwordx4 a[80:83], v5, s[4:7], s60 offen sc1
s_add_u32 s60, s60, 15360
buffer_load_dwordx4 a[84:87], v6, s[4:7], s59 offen sc1
s_add_u32 s59, s59, 15360
s_mov_b32 s55, 0xffffff00
v_and_b32 v40, s55, v40
v_and_b32 v41, s55, v41
v_and_b32 v42, s55, v42
v_and_b32 v43, s55, v43
v_and_b32 v44, s55, v44
v_and_b32 v45, s55, v45
v_and_b32 v46, s55, v46
v_and_b32 v47, s55, v47
v_and_b32 v48, s55, v48
v_and_b32 v49, s55, v49
v_and_b32 v50, s55, v50
v_and_b32 v51, s55, v51
v_pk_add_f32 v[40:41], v[40:41], v[44:45]
v_pk_add_f32 v[42:43], v[42:43], v[46:47]
v_pk_add_f32 v[40:41], v[40:41], v[48:49]
v_pk_add_f32 v[42:43], v[42:43], v[50:51]
v_cvt_pk_bf16_f32 v44, v40, v41
v_cvt_pk_bf16_f32 v45, v42, v43
v_lshlrev_b32 v40, 16, v44
v_and_b32 v41, 0xffff0000, v44
v_lshlrev_b32 v42, 16, v45
v_and_b32 v43, 0xffff0000, v45
v_pk_add_f32 v[40:41], v[40:41], v[252:253] op_sel_hi:[1,0]
v_pk_add_f32 v[42:43], v[42:43], v[252:253] op_sel_hi:[1,0]
v_cvt_pk_bf16_f32 v44, v40, v41
v_cvt_pk_bf16_f32 v45, v42, v43
v_lshlrev_b32 v40, 16, v44
v_and_b32 v41, 0xffff0000, v44
v_lshlrev_b32 v42, 16, v45
v_and_b32 v43, 0xffff0000, v45
ds_write_b128 v251, v[40:43]
v_and_b32 v52, s55, v52
v_and_b32 v53, s55, v53
v_and_b32 v54, s55, v54
v_and_b32 v55, s55, v55
v_and_b32 v56, s55, v56
v_and_b32 v57, s55, v57
v_and_b32 v58, s55, v58
v_and_b32 v59, s55, v59
v_and_b32 v60, s55, v60
v_and_b32 v61, s55, v61
v_and_b32 v62, s55, v62
v_and_b32 v63, s55, v63
v_pk_add_f32 v[52:53], v[52:53], v[56:57]
v_pk_add_f32 v[54:55], v[54:55], v[58:59]
v_pk_add_f32 v[52:53], v[52:53], v[60:61]
v_pk_add_f32 v[54:55], v[54:55], v[62:63]
v_cvt_pk_bf16_f32 v56, v52, v53
v_cvt_pk_bf16_f32 v57, v54, v55
v_lshlrev_b32 v52, 16, v56
v_and_b32 v53, 0xffff0000, v56
v_lshlrev_b32 v54, 16, v57
v_and_b32 v55, 0xffff0000, v57
v_pk_add_f32 v[52:53], v[52:53], v[252:253] op_sel_hi:[1,0]
v_pk_add_f32 v[54:55], v[54:55], v[252:253] op_sel_hi:[1,0]
v_cvt_pk_bf16_f32 v56, v52, v53
v_cvt_pk_bf16_f32 v57, v54, v55
v_lshlrev_b32 v52, 16, v56
v_and_b32 v53, 0xffff0000, v56
v_lshlrev_b32 v54, 16, v57
v_and_b32 v55, 0xffff0000, v57
s_mov_b64 exec, 0xffff
ds_write_b128 v251, v[52:55] offset:1024
s_mov_b64 exec, -1
s_mov_b32 s55, 0x3f803f80
v_mov_b32 v20, 0
v_mov_b32 v21, 0
v_dot2c_f32_bf16 v20, s55, v180
v_dot2c_f32_bf16 v21, v180, v180
v_dot2c_f32_bf16 v20, s55, v181
v_dot2c_f32_bf16 v21, v181, v181
v_dot2c_f32_bf16 v20, s55, v182
v_dot2c_f32_bf16 v21, v182, v182
v_dot2c_f32_bf16 v20, s55, v183
v_dot2c_f32_bf16 v21, v183, v183
v_dot2c_f32_bf16 v20, s55, v184
v_dot2c_f32_bf16 v21, v184, v184
v_dot2c_f32_bf16 v20, s55, v185
v_dot2c_f32_bf16 v21, v185, v185
v_dot2c_f32_bf16 v20, s55, v186
v_dot2c_f32_bf16 v21, v186, v186
v_dot2c_f32_bf16 v20, s55, v187
v_dot2c_f32_bf16 v21, v187, v187
v_dot2c_f32_bf16 v20, s55, v188
v_dot2c_f32_bf16 v21, v188, v188
v_dot2c_f32_bf16 v20, s55, v189
v_dot2c_f32_bf16 v21, v189, v189
v_dot2c_f32_bf16 v20, s55, v190
v_dot2c_f32_bf16 v21, v190, v190
v_dot2c_f32_bf16 v20, s55, v191
v_dot2c_f32_bf16 v21, v191, v191
v_dot2c_f32_bf16 v20, s55, v192
v_dot2c_f32_bf16 v21, v192, v192
v_dot2c_f32_bf16 v20, s55, v193
v_dot2c_f32_bf16 v21, v193, v193
v_dot2c_f32_bf16 v20, s55, v194
v_dot2c_f32_bf16 v21, v194, v194
v_dot2c_f32_bf16 v20, s55, v195
v_dot2c_f32_bf16 v21, v195, v195
v_dot2c_f32_bf16 v20, s55, v196
v_dot2c_f32_bf16 v21, v196, v196
v_dot2c_f32_bf16 v20, s55, v197
v_dot2c_f32_bf16 v21, v197, v197
v_dot2c_f32_bf16 v20, s55, v198
v_dot2c_f32_bf16 v21, v198, v198
v_dot2c_f32_bf16 v20, s55, v199
v_dot2c_f32_bf16 v21, v199, v199
s_nop 1
v_add_f32_dpp v20, v20, v20 row_ror:8 row_mask:0xf bank_mask:0xf
v_add_f32_dpp v21, v21, v21 row_ror:8 row_mask:0xf bank_mask:0xf
v_lshlrev_b32 v24, 16, v180
v_add_f32_dpp v20, v20, v20 row_ror:4 row_mask:0xf bank_mask:0xf
v_add_f32_dpp v21, v21, v21 row_ror:4 row_mask:0xf bank_mask:0xf
v_lshlrev_b32 v26, 16, v181
v_add_f32_dpp v20, v20, v20 row_ror:2 row_mask:0xf bank_mask:0xf
v_add_f32_dpp v21, v21, v21 row_ror:2 row_mask:0xf bank_mask:0xf
v_lshlrev_b32 v28, 16, v182
v_add_f32_dpp v20, v20, v20 row_ror:1 row_mask:0xf bank_mask:0xf
v_add_f32_dpp v21, v21, v21 row_ror:1 row_mask:0xf bank_mask:0xf
v_mul_f32 v20, 0x3acccccd, v20
v_mul_f32 v21, 0x3acccccd, v21
v_fma_f32 v21, -v20, v20, v21
v_max_f32 v21, 0, v21
v_add_f32 v21, 0x3727c5ac, v21
v_rsq_f32 v22, v21
v_and_b32 v25, 0xffff0000, v180
v_mul_f32 v23, -v20, v22
v_pk_fma_f32 v[24:25], v[24:25], v[22:23], v[22:23] op_sel:[0,0,1] op_sel_hi:[1,0,1]
v_and_b32 v27, 0xffff0000, v181
v_pk_fma_f32 v[26:27], v[26:27], v[22:23], v[22:23] op_sel:[0,0,1] op_sel_hi:[1,0,1]
v_cvt_pk_f16_f32 v180, v24, v25
v_and_b32 v29, 0xffff0000, v182
v_pk_fma_f32 v[28:29], v[28:29], v[22:23], v[22:23] op_sel:[0,0,1] op_sel_hi:[1,0,1]
v_cvt_pk_f16_f32 v181, v26, v27
v_lshlrev_b32 v30, 16, v183
v_and_b32 v31, 0xffff0000, v183
v_pk_fma_f32 v[30:31], v[30:31], v[22:23], v[22:23] op_sel:[0,0,1] op_sel_hi:[1,0,1]
v_cvt_pk_f16_f32 v182, v28, v29
v_lshlrev_b32 v24, 16, v184
v_and_b32 v25, 0xffff0000, v184
v_pk_fma_f32 v[24:25], v[24:25], v[22:23], v[22:23] op_sel:[0,0,1] op_sel_hi:[1,0,1]
v_cvt_pk_f16_f32 v183, v30, v31
v_lshlrev_b32 v26, 16, v185
v_and_b32 v27, 0xffff0000, v185
v_pk_fma_f32 v[26:27], v[26:27], v[22:23], v[22:23] op_sel:[0,0,1] op_sel_hi:[1,0,1]
v_cvt_pk_f16_f32 v184, v24, v25
v_lshlrev_b32 v28, 16, v186
v_and_b32 v29, 0xffff0000, v186
v_pk_fma_f32 v[28:29], v[28:29], v[22:23], v[22:23] op_sel:[0,0,1] op_sel_hi:[1,0,1]
v_cvt_pk_f16_f32 v185, v26, v27
v_lshlrev_b32 v30, 16, v187
v_and_b32 v31, 0xffff0000, v187
v_pk_fma_f32 v[30:31], v[30:31], v[22:23], v[22:23] op_sel:[0,0,1] op_sel_hi:[1,0,1]
v_cvt_pk_f16_f32 v186, v28, v29
v_lshlrev_b32 v24, 16, v188
v_and_b32 v25, 0xffff0000, v188
v_pk_fma_f32 v[24:25], v[24:25], v[22:23], v[22:23] op_sel:[0,0,1] op_sel_hi:[1,0,1]
v_cvt_pk_f16_f32 v187, v30, v31
v_lshlrev_b32 v26, 16, v189
v_and_b32 v27, 0xffff0000, v189
v_pk_fma_f32 v[26:27], v[26:27], v[22:23], v[22:23] op_sel:[0,0,1] op_sel_hi:[1,0,1]
v_cvt_pk_f16_f32 v188, v24, v25
v_lshlrev_b32 v28, 16, v190
v_and_b32 v29, 0xffff0000, v190
v_pk_fma_f32 v[28:29], v[28:29], v[22:23], v[22:23] op_sel:[0,0,1] op_sel_hi:[1,0,1]
v_cvt_pk_f16_f32 v189, v26, v27
v_lshlrev_b32 v30, 16, v191
v_and_b32 v31, 0xffff0000, v191
v_pk_fma_f32 v[30:31], v[30:31], v[22:23], v[22:23] op_sel:[0,0,1] op_sel_hi:[1,0,1]
v_cvt_pk_f16_f32 v190, v28, v29
v_lshlrev_b32 v24, 16, v192
v_and_b32 v25, 0xffff0000, v192
v_pk_fma_f32 v[24:25], v[24:25], v[22:23], v[22:23] op_sel:[0,0,1] op_sel_hi:[1,0,1]
v_cvt_pk_f16_f32 v191, v30, v31
v_lshlrev_b32 v26, 16, v193
v_and_b32 v27, 0xffff0000, v193
v_pk_fma_f32 v[26:27], v[26:27], v[22:23], v[22:23] op_sel:[0,0,1] op_sel_hi:[1,0,1]
v_cvt_pk_f16_f32 v192, v24, v25
v_lshlrev_b32 v28, 16, v194
v_and_b32 v29, 0xffff0000, v194
v_pk_fma_f32 v[28:29], v[28:29], v[22:23], v[22:23] op_sel:[0,0,1] op_sel_hi:[1,0,1]
v_cvt_pk_f16_f32 v193, v26, v27
v_lshlrev_b32 v30, 16, v195
v_and_b32 v31, 0xffff0000, v195
v_pk_fma_f32 v[30:31], v[30:31], v[22:23], v[22:23] op_sel:[0,0,1] op_sel_hi:[1,0,1]
v_cvt_pk_f16_f32 v194, v28, v29
v_lshlrev_b32 v24, 16, v196
v_and_b32 v25, 0xffff0000, v196
v_pk_fma_f32 v[24:25], v[24:25], v[22:23], v[22:23] op_sel:[0,0,1] op_sel_hi:[1,0,1]
v_cvt_pk_f16_f32 v195, v30, v31
v_lshlrev_b32 v26, 16, v197
v_and_b32 v27, 0xffff0000, v197
v_pk_fma_f32 v[26:27], v[26:27], v[22:23], v[22:23] op_sel:[0,0,1] op_sel_hi:[1,0,1]
v_cvt_pk_f16_f32 v196, v24, v25
v_lshlrev_b32 v28, 16, v198
v_and_b32 v29, 0xffff0000, v198
v_pk_fma_f32 v[28:29], v[28:29], v[22:23], v[22:23] op_sel:[0,0,1] op_sel_hi:[1,0,1]
v_cvt_pk_f16_f32 v197, v26, v27
v_lshlrev_b32 v30, 16, v199
v_and_b32 v31, 0xffff0000, v199
v_pk_fma_f32 v[30:31], v[30:31], v[22:23], v[22:23] op_sel:[0,0,1] op_sel_hi:[1,0,1]
v_cvt_pk_f16_f32 v198, v28, v29
v_cvt_pk_f16_f32 v199, v30, v31
s_waitcnt lgkmcnt(0)
s_barrier
ds_read_b128 v[200:203], v10 offset:2560
ds_read_b128 v[204:207], v10 offset:2576
ds_read_b128 v[208:211], v10 offset:0
ds_read_b128 v[212:215], v10 offset:16
s_waitcnt lgkmcnt(0)
v_fma_mix_f32 v216, v100, v200, v208 op_sel:[0,0,0] op_sel_hi:[1,0,0]
v_fma_mix_f32 v217, v100, v201, v209 op_sel:[1,0,0] op_sel_hi:[1,0,0]
v_cvt_pk_bf16_f32 v220, v216, v217
v_fma_mix_f32 v218, v101, v202, v210 op_sel:[0,0,0] op_sel_hi:[1,0,0]
v_fma_mix_f32 v219, v101, v203, v211 op_sel:[1,0,0] op_sel_hi:[1,0,0]
v_cvt_pk_bf16_f32 v221, v218, v219
v_fma_mix_f32 v216, v102, v204, v212 op_sel:[0,0,0] op_sel_hi:[1,0,0]
v_fma_mix_f32 v217, v102, v205, v213 op_sel:[1,0,0] op_sel_hi:[1,0,0]
v_cvt_pk_bf16_f32 v222, v216, v217
v_fma_mix_f32 v218, v103, v206, v214 op_sel:[0,0,0] op_sel_hi:[1,0,0]
v_fma_mix_f32 v219, v103, v207, v215 op_sel:[1,0,0] op_sel_hi:[1,0,0]
v_cvt_pk_bf16_f32 v223, v218, v219
ds_write_b128 v7, v[220:223] offset:0
v_fma_mix_f32 v216, v120, v200, v208 op_sel:[0,0,0] op_sel_hi:[1,0,0]
v_fma_mix_f32 v217, v120, v201, v209 op_sel:[1,0,0] op_sel_hi:[1,0,0]
v_cvt_pk_bf16_f32 v224, v216, v217
v_fma_mix_f32 v218, v121, v202, v210 op_sel:[0,0,0] op_sel_hi:[1,0,0]
v_fma_mix_f32 v219, v121, v203, v211 op_sel:[1,0,0] op_sel_hi:[1,0,0]
v_cvt_pk_bf16_f32 v225, v218, v219
v_fma_mix_f32 v216, v122, v204, v212 op_sel:[0,0,0] op_sel_hi:[1,0,0]
v_fma_mix_f32 v217, v122, v205, v213 op_sel:[1,0,0] op_sel_hi:[1,0,0]
v_cvt_pk_bf16_f32 v226, v216, v217
v_fma_mix_f32 v218, v123, v206, v214 op_sel:[0,0,0] op_sel_hi:[1,0,0]
v_fma_mix_f32 v219, v123, v207, v215 op_sel:[1,0,0] op_sel_hi:[1,0,0]
v_cvt_pk_bf16_f32 v227, v218, v219
ds_write_b128 v7, v[224:227] offset:1024
v_fma_mix_f32 v216, v140, v200, v208 op_sel:[0,0,0] op_sel_hi:[1,0,0]
v_fma_mix_f32 v217, v140, v201, v209 op_sel:[1,0,0] op_sel_hi:[1,0,0]
v_cvt_pk_bf16_f32 v220, v216, v217
v_fma_mix_f32 v218, v141, v202, v210 op_sel:[0,0,0] op_sel_hi:[1,0,0]
v_fma_mix_f32 v219, v141, v203, v211 op_sel:[1,0,0] op_sel_hi:[1,0,0]
v_cvt_pk_bf16_f32 v221, v218, v219
v_fma_mix_f32 v216, v142, v204, v212 op_sel:[0,0,0] op_sel_hi:[1,0,0]
v_fma_mix_f32 v217, v142, v205, v213 op_sel:[1,0,0] op_sel_hi:[1,0,0]
v_cvt_pk_bf16_f32 v222, v216, v217
v_fma_mix_f32 v218, v143, v206, v214 op_sel:[0,0,0] op_sel_hi:[1,0,0]
v_fma_mix_f32 v219, v143, v207, v215 op_sel:[1,0,0] op_sel_hi:[1,0,0]
v_cvt_pk_bf16_f32 v223, v218, v219
ds_write_b128 v7, v[220:223] offset:2048
v_fma_mix_f32 v216, v160, v200, v208 op_sel:[0,0,0] op_sel_hi:[1,0,0]
v_fma_mix_f32 v217, v160, v201, v209 op_sel:[1,0,0] op_sel_hi:[1,0,0]
v_cvt_pk_bf16_f32 v224, v216, v217
v_fma_mix_f32 v218, v161, v202, v210 op_sel:[0,0,0] op_sel_hi:[1,0,0]
v_fma_mix_f32 v219, v161, v203, v211 op_sel:[1,0,0] op_sel_hi:[1,0,0]
v_cvt_pk_bf16_f32 v225, v218, v219
v_fma_mix_f32 v216, v162, v204, v212 op_sel:[0,0,0] op_sel_hi:[1,0,0]
v_fma_mix_f32 v217, v162, v205, v213 op_sel:[1,0,0] op_sel_hi:[1,0,0]
v_cvt_pk_bf16_f32 v226, v216, v217
v_fma_mix_f32 v218, v163, v206, v214 op_sel:[0,0,0] op_sel_hi:[1,0,0]
v_fma_mix_f32 v219, v163, v207, v215 op_sel:[1,0,0] op_sel_hi:[1,0,0]
v_cvt_pk_bf16_f32 v227, v218, v219
ds_write_b128 v7, v[224:227] offset:3072
v_fma_mix_f32 v216, v180, v200, v208 op_sel:[0,0,0] op_sel_hi:[1,0,0]
v_fma_mix_f32 v217, v180, v201, v209 op_sel:[1,0,0] op_sel_hi:[1,0,0]
v_cvt_pk_bf16_f32 v220, v216, v217
v_fma_mix_f32 v218, v181, v202, v210 op_sel:[0,0,0] op_sel_hi:[1,0,0]
v_fma_mix_f32 v219, v181, v203, v211 op_sel:[1,0,0] op_sel_hi:[1,0,0]
v_cvt_pk_bf16_f32 v221, v218, v219
v_fma_mix_f32 v216, v182, v204, v212 op_sel:[0,0,0] op_sel_hi:[1,0,0]
v_fma_mix_f32 v217, v182, v205, v213 op_sel:[1,0,0] op_sel_hi:[1,0,0]
v_cvt_pk_bf16_f32 v222, v216, v217
v_fma_mix_f32 v218, v183, v206, v214 op_sel:[0,0,0] op_sel_hi:[1,0,0]
v_fma_mix_f32 v219, v183, v207, v215 op_sel:[1,0,0] op_sel_hi:[1,0,0]
v_cvt_pk_bf16_f32 v223, v218, v219
ds_write_b128 v7, v[220:223] offset:4096
ds_read_b128 v[200:203], v10 offset:3072
ds_read_b128 v[204:207], v10 offset:3088
ds_read_b128 v[208:211], v10 offset:512
ds_read_b128 v[212:215], v10 offset:528
s_waitcnt lgkmcnt(4)
s_barrier
ds_read_b128 a[0:3], v8 offset:0
ds_read_b128 a[4:7], v8 offset:1024
ds_read_b128 a[8:11], v8 offset:2048
ds_read_b128 a[12:15], v8 offset:3072
ds_read_b128 a[16:19], v8 offset:4096
s_cmp_eq_u32 s96, 6
s_cselect_b32 s100, 8, 12
s_cselect_b32 s101, 16, 24
s_mul_i32 s52, s96, 192
s_mul_i32 s48, s3, 20480
s_add_u32 s48, s48, s52
s_mul_i32 s49, s3, 3072
s_lshl_b32 s53, s47, 2
s_add_u32 s53, s53, s3
s_and_b32 s50, s53, 63
s_lshl_b32 s50, s50, 5
s_lshr_b32 s54, s53, 6
s_add_u32 s54, s50, s54
s_mul_i32 s50, s54, 1280
s_add_u32 s50, s50, s52
s_mul_i32 s51, s3, 2560
s_lshl_b32 s55, s52, 1
s_add_u32 s51, s51, s55
s_add_u32 s51, s51, 65536
s_mul_i32 s61, s3, 40
s_add_u32 s61, s61, 128000
s_waitcnt lgkmcnt(5)
s_waitcnt vmcnt(8) lgkmcnt(0)
v_mfma_f32_16x16x32_bf16 v[20:23], a[40:43], a[0:3], 0
ds_read_b128 a[20:23], v9 offset:5120
v_fma_mix_f32 v216, v104, v200, v208 op_sel:[0,0,0] op_sel_hi:[1,0,0]
v_mfma_f32_16x16x32_bf16 v[24:27], a[44:47], a[0:3], 0
buffer_load_dwordx4 a[88:91], v5, s[4:7], s59 offen sc1
v_fma_mix_f32 v217, v104, v201, v209 op_sel:[1,0,0] op_sel_hi:[1,0,0]
v_mfma_f32_16x16x32_bf16 v[28:31], a[0:3], a[48:51], 0
ds_read_b128 a[24:27], v9 offset:6144
v_cvt_pk_bf16_f32 v220, v216, v217
v_mfma_f32_16x16x32_bf16 v[32:35], a[52:55], a[0:3], 0
v_fma_mix_f32 v218, v105, v202, v210 op_sel:[0,0,0] op_sel_hi:[1,0,0]
v_fma_mix_f32 v219, v105, v203, v211 op_sel:[1,0,0] op_sel_hi:[1,0,0]
v_mfma_f32_16x16x32_bf16 v[36:39], a[40:43], a[4:7], 0
ds_read_b128 a[28:31], v9 offset:7168
v_cvt_pk_bf16_f32 v221, v218, v219
v_mfma_f32_16x16x32_bf16 v[40:43], a[44:47], a[4:7], 0
buffer_load_dwordx4 a[92:95], v5, s[4:7], s59 offen offset:2560 sc1
v_fma_mix_f32 v216, v106, v204, v212 op_sel:[0,0,0] op_sel_hi:[1,0,0]
v_mfma_f32_16x16x32_bf16 v[44:47], a[4:7], a[48:51], 0
ds_read_b128 a[32:35], v9 offset:8192
v_fma_mix_f32 v217, v106, v205, v213 op_sel:[1,0,0] op_sel_hi:[1,0,0]
v_mfma_f32_16x16x32_bf16 v[48:51], a[52:55], a[4:7], 0
v_cvt_pk_bf16_f32 v222, v216, v217
v_fma_mix_f32 v218, v107, v206, v214 op_sel:[0,0,0] op_sel_hi:[1,0,0]
v_mfma_f32_16x16x32_bf16 v[52:55], a[40:43], a[8:11], 0
ds_read_b128 a[36:39], v9 offset:9216
v_fma_mix_f32 v219, v107, v207, v215 op_sel:[1,0,0] op_sel_hi:[1,0,0]
v_mfma_f32_16x16x32_bf16 v[56:59], a[44:47], a[8:11], 0
buffer_load_dwordx4 a[96:99], v5, s[4:7], s60 offen sc1
s_add_u32 s60, s60, 15360
v_cvt_pk_bf16_f32 v223, v218, v219
v_mfma_f32_16x16x32_bf16 v[60:63], a[8:11], a[48:51], 0
ds_write_b128 v7, v[220:223] offset:20480
v_mfma_f32_16x16x32_bf16 v[64:67], a[52:55], a[8:11], 0
v_fma_mix_f32 v216, v124, v200, v208 op_sel:[0,0,0] op_sel_hi:[1,0,0]
v_fma_mix_f32 v217, v124, v201, v209 op_sel:[1,0,0] op_sel_hi:[1,0,0]
v_mfma_f32_16x16x32_bf16 v[68:71], a[40:43], a[12:15], 0
v_cvt_pk_bf16_f32 v224, v216, v217
v_fma_mix_f32 v218, v125, v202, v210 op_sel:[0,0,0] op_sel_hi:[1,0,0]
v_mfma_f32_16x16x32_bf16 v[72:75], a[44:47], a[12:15], 0
buffer_load_dwordx4 a[100:103], v6, s[4:7], s59 offen sc1
s_add_u32 s59, s59, 15360
v_fma_mix_f32 v219, v125, v203, v211 op_sel:[1,0,0] op_sel_hi:[1,0,0]
v_mfma_f32_16x16x32_bf16 v[76:79], a[12:15], a[48:51], 0
v_cvt_pk_bf16_f32 v225, v218, v219
v_fma_mix_f32 v216, v126, v204, v212 op_sel:[0,0,0] op_sel_hi:[1,0,0]
v_mfma_f32_16x16x32_bf16 v[80:83], a[52:55], a[12:15], 0
v_fma_mix_f32 v217, v126, v205, v213 op_sel:[1,0,0] op_sel_hi:[1,0,0]
v_cvt_pk_bf16_f32 v226, v216, v217
v_mfma_f32_16x16x32_bf16 v[84:87], a[40:43], a[16:19], 0
v_fma_mix_f32 v218, v127, v206, v214 op_sel:[0,0,0] op_sel_hi:[1,0,0]
v_fma_mix_f32 v219, v127, v207, v215 op_sel:[1,0,0] op_sel_hi:[1,0,0]
v_mfma_f32_16x16x32_bf16 v[88:91], a[44:47], a[16:19], 0
v_cvt_pk_bf16_f32 v227, v218, v219
v_mfma_f32_16x16x32_bf16 v[92:95], a[16:19], a[48:51], 0
ds_write_b128 v7, v[224:227] offset:21504
v_mfma_f32_16x16x32_bf16 v[96:99], a[52:55], a[16:19], 0
v_fma_mix_f32 v216, v144, v200, v208 op_sel:[0,0,0] op_sel_hi:[1,0,0]
v_fma_mix_f32 v217, v144, v201, v209 op_sel:[1,0,0] op_sel_hi:[1,0,0]
s_waitcnt vmcnt(8) lgkmcnt(2)
v_mfma_f32_16x16x32_bf16 v[20:23], a[56:59], a[20:23], v[20:23]
ds_read_b128 a[0:3], v8 offset:10240
v_cvt_pk_bf16_f32 v220, v216, v217
v_mfma_f32_16x16x32_bf16 v[24:27], a[60:63], a[20:23], v[24:27]
buffer_load_dwordx4 a[104:107], v5, s[4:7], s59 offen sc1
v_fma_mix_f32 v218, v145, v202, v210 op_sel:[0,0,0] op_sel_hi:[1,0,0]
v_mfma_f32_16x16x32_bf16 v[28:31], a[20:23], a[64:67], v[28:31]
ds_read_b128 a[4:7], v8 offset:11264
v_fma_mix_f32 v219, v145, v203, v211 op_sel:[1,0,0] op_sel_hi:[1,0,0]
v_mfma_f32_16x16x32_bf16 v[32:35], a[68:71], a[20:23], v[32:35]
v_cvt_pk_bf16_f32 v221, v218, v219
v_fma_mix_f32 v216, v146, v204, v212 op_sel:[0,0,0] op_sel_hi:[1,0,0]
v_mfma_f32_16x16x32_bf16 v[36:39], a[56:59], a[24:27], v[36:39]
ds_read_b128 a[8:11], v8 offset:12288
v_fma_mix_f32 v217, v146, v205, v213 op_sel:[1,0,0] op_sel_hi:[1,0,0]
v_mfma_f32_16x16x32_bf16 v[40:43], a[60:63], a[24:27], v[40:43]
buffer_load_dwordx4 a[108:111], v5, s[4:7], s59 offen offset:2560 sc1
v_cvt_pk_bf16_f32 v222, v216, v217
v_mfma_f32_16x16x32_bf16 v[44:47], a[24:27], a[64:67], v[44:47]
ds_read_b128 a[12:15], v8 offset:13312
v_fma_mix_f32 v218, v147, v206, v214 op_sel:[0,0,0] op_sel_hi:[1,0,0]
v_mfma_f32_16x16x32_bf16 v[48:51], a[68:71], a[24:27], v[48:51]
v_fma_mix_f32 v219, v147, v207, v215 op_sel:[1,0,0] op_sel_hi:[1,0,0]
v_cvt_pk_bf16_f32 v223, v218, v219
v_mfma_f32_16x16x32_bf16 v[52:55], a[56:59], a[28:31], v[52:55]
ds_read_b128 a[16:19], v8 offset:14336
v_mfma_f32_16x16x32_bf16 v[56:59], a[60:63], a[28:31], v[56:59]
buffer_load_dwordx4 a[112:115], v5, s[4:7], s60 offen sc1
s_add_u32 s60, s60, 15360
v_mfma_f32_16x16x32_bf16 v[60:63], a[28:31], a[64:67], v[60:63]
ds_write_b128 v7, v[220:223] offset:22528
v_mfma_f32_16x16x32_bf16 v[64:67], a[68:71], a[28:31], v[64:67]
v_fma_mix_f32 v216, v164, v200, v208 op_sel:[0,0,0] op_sel_hi:[1,0,0]
v_fma_mix_f32 v217, v164, v201, v209 op_sel:[1,0,0] op_sel_hi:[1,0,0]
v_mfma_f32_16x16x32_bf16 v[68:71], a[56:59], a[32:35], v[68:71]
v_cvt_pk_bf16_f32 v224, v216, v217
v_fma_mix_f32 v218, v165, v202, v210 op_sel:[0,0,0] op_sel_hi:[1,0,0]
v_mfma_f32_16x16x32_bf16 v[72:75], a[60:63], a[32:35], v[72:75]
buffer_load_dwordx4 a[116:119], v6, s[4:7], s59 offen sc1
s_add_u32 s59, s59, 15360
v_fma_mix_f32 v219, v165, v203, v211 op_sel:[1,0,0] op_sel_hi:[1,0,0]
v_mfma_f32_16x16x32_bf16 v[76:79], a[32:35], a[64:67], v[76:79]
v_cvt_pk_bf16_f32 v225, v218, v219
v_fma_mix_f32 v216, v166, v204, v212 op_sel:[0,0,0] op_sel_hi:[1,0,0]
v_mfma_f32_16x16x32_bf16 v[80:83], a[68:71], a[32:35], v[80:83]
v_fma_mix_f32 v217, v166, v205, v213 op_sel:[1,0,0] op_sel_hi:[1,0,0]
v_cvt_pk_bf16_f32 v226, v216, v217
v_mfma_f32_16x16x32_bf16 v[84:87], a[56:59], a[36:39], v[84:87]
v_fma_mix_f32 v218, v167, v206, v214 op_sel:[0,0,0] op_sel_hi:[1,0,0]
v_fma_mix_f32 v219, v167, v207, v215 op_sel:[1,0,0] op_sel_hi:[1,0,0]
v_mfma_f32_16x16x32_bf16 v[88:91], a[60:63], a[36:39], v[88:91]
v_cvt_pk_bf16_f32 v227, v218, v219
v_mfma_f32_16x16x32_bf16 v[92:95], a[36:39], a[64:67], v[92:95]
ds_write_b128 v7, v[224:227] offset:23552
v_mfma_f32_16x16x32_bf16 v[96:99], a[68:71], a[36:39], v[96:99]
v_fma_mix_f32 v216, v184, v200, v208 op_sel:[0,0,0] op_sel_hi:[1,0,0]
v_fma_mix_f32 v217, v184, v201, v209 op_sel:[1,0,0] op_sel_hi:[1,0,0]
s_waitcnt vmcnt(8) lgkmcnt(2)
v_mfma_f32_16x16x32_bf16 v[20:23], a[72:75], a[0:3], v[20:23]
ds_read_b128 a[20:23], v9 offset:15360
v_cvt_pk_bf16_f32 v220, v216, v217
v_mfma_f32_16x16x32_bf16 v[24:27], a[76:79], a[0:3], v[24:27]
buffer_load_dwordx4 a[120:123], v5, s[4:7], s59 offen sc1
v_fma_mix_f32 v218, v185, v202, v210 op_sel:[0,0,0] op_sel_hi:[1,0,0]
v_mfma_f32_16x16x32_bf16 v[28:31], a[0:3], a[80:83], v[28:31]
ds_read_b128 a[24:27], v9 offset:16384
v_fma_mix_f32 v219, v185, v203, v211 op_sel:[1,0,0] op_sel_hi:[1,0,0]
v_mfma_f32_16x16x32_bf16 v[32:35], a[84:87], a[0:3], v[32:35]
v_cvt_pk_bf16_f32 v221, v218, v219
v_fma_mix_f32 v216, v186, v204, v212 op_sel:[0,0,0] op_sel_hi:[1,0,0]
v_mfma_f32_16x16x32_bf16 v[36:39], a[72:75], a[4:7], v[36:39]
ds_read_b128 a[28:31], v9 offset:17408
v_fma_mix_f32 v217, v186, v205, v213 op_sel:[1,0,0] op_sel_hi:[1,0,0]
v_mfma_f32_16x16x32_bf16 v[40:43], a[76:79], a[4:7], v[40:43]
buffer_load_dwordx4 a[124:127], v5, s[4:7], s59 offen offset:2560 sc1
v_cvt_pk_bf16_f32 v222, v216, v217
v_mfma_f32_16x16x32_bf16 v[44:47], a[4:7], a[80:83], v[44:47]
ds_read_b128 a[32:35], v9 offset:18432
v_fma_mix_f32 v218, v187, v206, v214 op_sel:[0,0,0] op_sel_hi:[1,0,0]
v_mfma_f32_16x16x32_bf16 v[48:51], a[84:87], a[4:7], v[48:51]
v_fma_mix_f32 v219, v187, v207, v215 op_sel:[1,0,0] op_sel_hi:[1,0,0]
v_cvt_pk_bf16_f32 v223, v218, v219
v_mfma_f32_16x16x32_bf16 v[52:55], a[72:75], a[8:11], v[52:55]
ds_read_b128 a[36:39], v9 offset:19456
v_mfma_f32_16x16x32_bf16 v[56:59], a[76:79], a[8:11], v[56:59]
buffer_load_dwordx4 a[128:131], v5, s[4:7], s60 offen sc1
s_add_u32 s60, s60, 15360
v_mfma_f32_16x16x32_bf16 v[60:63], a[8:11], a[80:83], v[60:63]
ds_write_b128 v7, v[220:223] offset:24576
v_mfma_f32_16x16x32_bf16 v[64:67], a[84:87], a[8:11], v[64:67]
v_mfma_f32_16x16x32_bf16 v[68:71], a[72:75], a[12:15], v[68:71]
v_mfma_f32_16x16x32_bf16 v[72:75], a[76:79], a[12:15], v[72:75]
buffer_load_dwordx4 a[132:135], v6, s[4:7], s59 offen sc1
s_add_u32 s59, s59, 15360
v_mfma_f32_16x16x32_bf16 v[76:79], a[12:15], a[80:83], v[76:79]
v_mfma_f32_16x16x32_bf16 v[80:83], a[84:87], a[12:15], v[80:83]
v_mfma_f32_16x16x32_bf16 v[84:87], a[72:75], a[16:19], v[84:87]
v_mfma_f32_16x16x32_bf16 v[88:91], a[76:79], a[16:19], v[88:91]
v_mfma_f32_16x16x32_bf16 v[92:95], a[16:19], a[80:83], v[92:95]
v_mfma_f32_16x16x32_bf16 v[96:99], a[84:87], a[16:19], v[96:99]
s_waitcnt vmcnt(8) lgkmcnt(0)
s_barrier
v_mfma_f32_16x16x32_bf16 v[20:23], a[88:91], a[20:23], v[20:23]
ds_read_b128 a[0:3], v8 offset:20480
v_add_u32 v228, 0, v1
v_mfma_f32_16x16x32_bf16 v[24:27], a[92:95], a[20:23], v[24:27]
buffer_load_dwordx4 a[136:139], v5, s[4:7], s59 offen sc1
v_mul_u32_u24 v229, 5462, v228
v_mfma_f32_16x16x32_bf16 v[28:31], a[20:23], a[96:99], v[28:31]
ds_read_b128 a[4:7], v8 offset:21504
v_lshrrev_b32 v229, 16, v229
v_mfma_f32_16x16x32_bf16 v[32:35], a[100:103], a[20:23], v[32:35]
v_mul_u32_u24 v230, 12, v229
v_sub_u32 v228, v228, v230
v_mfma_f32_16x16x32_bf16 v[36:39], a[88:91], a[24:27], v[36:39]
ds_read_b128 a[8:11], v8 offset:22528
v_cmp_gt_u32 vcc, s100, v228
v_mfma_f32_16x16x32_bf16 v[40:43], a[92:95], a[24:27], v[40:43]
buffer_load_dwordx4 a[140:143], v5, s[4:7], s59 offen offset:2560 sc1
v_mul_u32_u24 v230, 2560, v229
v_mfma_f32_16x16x32_bf16 v[44:47], a[24:27], a[96:99], v[44:47]
ds_read_b128 a[12:15], v8 offset:23552
v_lshl_add_u32 v230, v228, 4, v230
v_mfma_f32_16x16x32_bf16 v[48:51], a[100:103], a[24:27], v[48:51]
v_cndmask_b32 v235, v255, v230, vcc
v_lshrrev_b32 v230, 3, v229
v_mfma_f32_16x16x32_bf16 v[52:55], a[88:91], a[28:31], v[52:55]
ds_read_b128 a[16:19], v8 offset:24576
v_lshlrev_b32 v230, 1, v230
v_mfma_f32_16x16x32_bf16 v[56:59], a[92:95], a[28:31], v[56:59]
buffer_load_dwordx4 a[144:147], v5, s[4:7], s60 offen sc1
s_add_u32 s60, s60, 15360
v_xor_b32 v228, v228, v230
v_mfma_f32_16x16x32_bf16 v[60:63], a[28:31], a[96:99], v[60:63]
ds_read_b128 v[200:203], v10 offset:3584
v_mul_u32_u24 v230, 1280, v229
v_mfma_f32_16x16x32_bf16 v[64:67], a[100:103], a[28:31], v[64:67]
v_lshl_add_u32 v230, v228, 4, v230
v_cndmask_b32 v232, v255, v230, vcc
v_mfma_f32_16x16x32_bf16 v[68:71], a[88:91], a[32:35], v[68:71]
ds_read_b128 v[204:207], v10 offset:3600
v_mfma_f32_16x16x32_bf16 v[72:75], a[92:95], a[32:35], v[72:75]
buffer_load_dwordx4 a[148:151], v6, s[4:7], s59 offen sc1
s_add_u32 s59, s59, 15360
v_mfma_f32_16x16x32_bf16 v[76:79], a[32:35], a[96:99], v[76:79]
ds_read_b128 v[208:211], v10 offset:1024
v_mfma_f32_16x16x32_bf16 v[80:83], a[100:103], a[32:35], v[80:83]
v_mfma_f32_16x16x32_bf16 v[84:87], a[88:91], a[36:39], v[84:87]
ds_read_b128 v[212:215], v10 offset:1040
v_mfma_f32_16x16x32_bf16 v[88:91], a[92:95], a[36:39], v[88:91]
v_mfma_f32_16x16x32_bf16 v[92:95], a[36:39], a[96:99], v[92:95]
v_mfma_f32_16x16x32_bf16 v[96:99], a[100:103], a[36:39], v[96:99]
s_waitcnt lgkmcnt(0)
s_waitcnt vmcnt(8)
v_mfma_f32_16x16x32_bf16 v[20:23], a[104:107], a[0:3], v[20:23]
ds_read_b128 a[20:23], v9 offset:25600
v_fma_mix_f32 v216, v108, v200, v208 op_sel:[0,0,0] op_sel_hi:[1,0,0]
v_mfma_f32_16x16x32_bf16 v[24:27], a[108:111], a[0:3], v[24:27]
buffer_load_dwordx4 a[152:155], v5, s[4:7], s59 offen sc1
v_fma_mix_f32 v217, v108, v201, v209 op_sel:[1,0,0] op_sel_hi:[1,0,0]
v_mfma_f32_16x16x32_bf16 v[28:31], a[0:3], a[112:115], v[28:31]
ds_read_b128 a[24:27], v9 offset:26624
v_cvt_pk_bf16_f32 v220, v216, v217
v_mfma_f32_16x16x32_bf16 v[32:35], a[116:119], a[0:3], v[32:35]
v_fma_mix_f32 v218, v109, v202, v210 op_sel:[0,0,0] op_sel_hi:[1,0,0]
v_fma_mix_f32 v219, v109, v203, v211 op_sel:[1,0,0] op_sel_hi:[1,0,0]
v_mfma_f32_16x16x32_bf16 v[36:39], a[104:107], a[4:7], v[36:39]
ds_read_b128 a[28:31], v9 offset:27648
v_cvt_pk_bf16_f32 v221, v218, v219
v_mfma_f32_16x16x32_bf16 v[40:43], a[108:111], a[4:7], v[40:43]
buffer_load_dwordx4 a[156:159], v5, s[4:7], s59 offen offset:2560 sc1
v_fma_mix_f32 v216, v110, v204, v212 op_sel:[0,0,0] op_sel_hi:[1,0,0]
v_mfma_f32_16x16x32_bf16 v[44:47], a[4:7], a[112:115], v[44:47]
ds_read_b128 a[32:35], v9 offset:28672
v_fma_mix_f32 v217, v110, v205, v213 op_sel:[1,0,0] op_sel_hi:[1,0,0]
v_mfma_f32_16x16x32_bf16 v[48:51], a[116:119], a[4:7], v[48:51]
v_cvt_pk_bf16_f32 v222, v216, v217
v_fma_mix_f32 v218, v111, v206, v214 op_sel:[0,0,0] op_sel_hi:[1,0,0]
v_mfma_f32_16x16x32_bf16 v[52:55], a[104:107], a[8:11], v[52:55]
ds_read_b128 a[36:39], v9 offset:29696
v_fma_mix_f32 v219, v111, v207, v215 op_sel:[1,0,0] op_sel_hi:[1,0,0]
v_mfma_f32_16x16x32_bf16 v[56:59], a[108:111], a[8:11], v[56:59]
buffer_load_dwordx4 a[160:163], v5, s[4:7], s60 offen sc1
s_add_u32 s60, s60, 15360
v_cvt_pk_bf16_f32 v223, v218, v219
v_mfma_f32_16x16x32_bf16 v[60:63], a[8:11], a[112:115], v[60:63]
ds_write_b128 v7, v[220:223] offset:40960
v_mfma_f32_16x16x32_bf16 v[64:67], a[116:119], a[8:11], v[64:67]
v_fma_mix_f32 v216, v128, v200, v208 op_sel:[0,0,0] op_sel_hi:[1,0,0]
v_fma_mix_f32 v217, v128, v201, v209 op_sel:[1,0,0] op_sel_hi:[1,0,0]
v_mfma_f32_16x16x32_bf16 v[68:71], a[104:107], a[12:15], v[68:71]
v_cvt_pk_bf16_f32 v224, v216, v217
v_fma_mix_f32 v218, v129, v202, v210 op_sel:[0,0,0] op_sel_hi:[1,0,0]
v_mfma_f32_16x16x32_bf16 v[72:75], a[108:111], a[12:15], v[72:75]
buffer_load_dwordx4 a[164:167], v6, s[4:7], s59 offen sc1
s_add_u32 s59, s59, 15360
v_fma_mix_f32 v219, v129, v203, v211 op_sel:[1,0,0] op_sel_hi:[1,0,0]
v_mfma_f32_16x16x32_bf16 v[76:79], a[12:15], a[112:115], v[76:79]
v_cvt_pk_bf16_f32 v225, v218, v219
v_fma_mix_f32 v216, v130, v204, v212 op_sel:[0,0,0] op_sel_hi:[1,0,0]
v_mfma_f32_16x16x32_bf16 v[80:83], a[116:119], a[12:15], v[80:83]
v_fma_mix_f32 v217, v130, v205, v213 op_sel:[1,0,0] op_sel_hi:[1,0,0]
v_cvt_pk_bf16_f32 v226, v216, v217
v_mfma_f32_16x16x32_bf16 v[84:87], a[104:107], a[16:19], v[84:87]
v_fma_mix_f32 v218, v131, v206, v214 op_sel:[0,0,0] op_sel_hi:[1,0,0]
v_fma_mix_f32 v219, v131, v207, v215 op_sel:[1,0,0] op_sel_hi:[1,0,0]
v_mfma_f32_16x16x32_bf16 v[88:91], a[108:111], a[16:19], v[88:91]
v_cvt_pk_bf16_f32 v227, v218, v219
v_mfma_f32_16x16x32_bf16 v[92:95], a[16:19], a[112:115], v[92:95]
ds_write_b128 v7, v[224:227] offset:41984
v_mfma_f32_16x16x32_bf16 v[96:99], a[116:119], a[16:19], v[96:99]
v_fma_mix_f32 v216, v148, v200, v208 op_sel:[0,0,0] op_sel_hi:[1,0,0]
v_fma_mix_f32 v217, v148, v201, v209 op_sel:[1,0,0] op_sel_hi:[1,0,0]
s_waitcnt vmcnt(8) lgkmcnt(2)
v_mfma_f32_16x16x32_bf16 v[20:23], a[120:123], a[20:23], v[20:23]
ds_read_b128 a[0:3], v8 offset:30720
v_cvt_pk_bf16_f32 v220, v216, v217
v_mfma_f32_16x16x32_bf16 v[24:27], a[124:127], a[20:23], v[24:27]
buffer_load_dwordx4 a[168:171], v5, s[4:7], s59 offen sc1
v_fma_mix_f32 v218, v149, v202, v210 op_sel:[0,0,0] op_sel_hi:[1,0,0]
v_mfma_f32_16x16x32_bf16 v[28:31], a[20:23], a[128:131], v[28:31]
ds_read_b128 a[4:7], v8 offset:31744
v_fma_mix_f32 v219, v149, v203, v211 op_sel:[1,0,0] op_sel_hi:[1,0,0]
v_mfma_f32_16x16x32_bf16 v[32:35], a[132:135], a[20:23], v[32:35]
v_cvt_pk_bf16_f32 v221, v218, v219
v_fma_mix_f32 v216, v150, v204, v212 op_sel:[0,0,0] op_sel_hi:[1,0,0]
v_mfma_f32_16x16x32_bf16 v[36:39], a[120:123], a[24:27], v[36:39]
ds_read_b128 a[8:11], v8 offset:32768
v_fma_mix_f32 v217, v150, v205, v213 op_sel:[1,0,0] op_sel_hi:[1,0,0]
v_mfma_f32_16x16x32_bf16 v[40:43], a[124:127], a[24:27], v[40:43]
buffer_load_dwordx4 a[172:175], v5, s[4:7], s59 offen offset:2560 sc1
v_cvt_pk_bf16_f32 v222, v216, v217
v_mfma_f32_16x16x32_bf16 v[44:47], a[24:27], a[128:131], v[44:47]
ds_read_b128 a[12:15], v8 offset:33792
v_fma_mix_f32 v218, v151, v206, v214 op_sel:[0,0,0] op_sel_hi:[1,0,0]
v_mfma_f32_16x16x32_bf16 v[48:51], a[132:135], a[24:27], v[48:51]
v_fma_mix_f32 v219, v151, v207, v215 op_sel:[1,0,0] op_sel_hi:[1,0,0]
v_cvt_pk_bf16_f32 v223, v218, v219
v_mfma_f32_16x16x32_bf16 v[52:55], a[120:123], a[28:31], v[52:55]
ds_read_b128 a[16:19], v8 offset:34816
v_mfma_f32_16x16x32_bf16 v[56:59], a[124:127], a[28:31], v[56:59]
buffer_load_dwordx4 a[176:179], v5, s[4:7], s60 offen sc1
s_add_u32 s60, s60, 15360
v_mfma_f32_16x16x32_bf16 v[60:63], a[28:31], a[128:131], v[60:63]
ds_write_b128 v7, v[220:223] offset:43008
v_mfma_f32_16x16x32_bf16 v[64:67], a[132:135], a[28:31], v[64:67]
v_fma_mix_f32 v216, v168, v200, v208 op_sel:[0,0,0] op_sel_hi:[1,0,0]
v_fma_mix_f32 v217, v168, v201, v209 op_sel:[1,0,0] op_sel_hi:[1,0,0]
v_mfma_f32_16x16x32_bf16 v[68:71], a[120:123], a[32:35], v[68:71]
v_cvt_pk_bf16_f32 v224, v216, v217
v_fma_mix_f32 v218, v169, v202, v210 op_sel:[0,0,0] op_sel_hi:[1,0,0]
v_mfma_f32_16x16x32_bf16 v[72:75], a[124:127], a[32:35], v[72:75]
buffer_load_dwordx4 a[180:183], v6, s[4:7], s59 offen sc1
s_add_u32 s59, s59, 15360
v_fma_mix_f32 v219, v169, v203, v211 op_sel:[1,0,0] op_sel_hi:[1,0,0]
v_mfma_f32_16x16x32_bf16 v[76:79], a[32:35], a[128:131], v[76:79]
v_cvt_pk_bf16_f32 v225, v218, v219
v_fma_mix_f32 v216, v170, v204, v212 op_sel:[0,0,0] op_sel_hi:[1,0,0]
v_mfma_f32_16x16x32_bf16 v[80:83], a[132:135], a[32:35], v[80:83]
v_fma_mix_f32 v217, v170, v205, v213 op_sel:[1,0,0] op_sel_hi:[1,0,0]
v_cvt_pk_bf16_f32 v226, v216, v217
v_mfma_f32_16x16x32_bf16 v[84:87], a[120:123], a[36:39], v[84:87]
v_fma_mix_f32 v218, v171, v206, v214 op_sel:[0,0,0] op_sel_hi:[1,0,0]
v_fma_mix_f32 v219, v171, v207, v215 op_sel:[1,0,0] op_sel_hi:[1,0,0]
v_mfma_f32_16x16x32_bf16 v[88:91], a[124:127], a[36:39], v[88:91]
v_cvt_pk_bf16_f32 v227, v218, v219
v_mfma_f32_16x16x32_bf16 v[92:95], a[36:39], a[128:131], v[92:95]
ds_write_b128 v7, v[224:227] offset:44032
v_mfma_f32_16x16x32_bf16 v[96:99], a[132:135], a[36:39], v[96:99]
v_fma_mix_f32 v216, v188, v200, v208 op_sel:[0,0,0] op_sel_hi:[1,0,0]
v_fma_mix_f32 v217, v188, v201, v209 op_sel:[1,0,0] op_sel_hi:[1,0,0]
s_waitcnt vmcnt(8) lgkmcnt(2)
v_mfma_f32_16x16x32_bf16 v[20:23], a[136:139], a[0:3], v[20:23]
ds_read_b128 a[20:23], v9 offset:35840
v_cvt_pk_bf16_f32 v220, v216, v217
v_mfma_f32_16x16x32_bf16 v[24:27], a[140:143], a[0:3], v[24:27]
buffer_load_dwordx4 a[184:187], v5, s[4:7], s59 offen sc1
v_fma_mix_f32 v218, v189, v202, v210 op_sel:[0,0,0] op_sel_hi:[1,0,0]
v_mfma_f32_16x16x32_bf16 v[28:31], a[0:3], a[144:147], v[28:31]
ds_read_b128 a[24:27], v9 offset:36864
v_fma_mix_f32 v219, v189, v203, v211 op_sel:[1,0,0] op_sel_hi:[1,0,0]
v_mfma_f32_16x16x32_bf16 v[32:35], a[148:151], a[0:3], v[32:35]
v_cvt_pk_bf16_f32 v221, v218, v219
v_fma_mix_f32 v216, v190, v204, v212 op_sel:[0,0,0] op_sel_hi:[1,0,0]
v_mfma_f32_16x16x32_bf16 v[36:39], a[136:139], a[4:7], v[36:39]
ds_read_b128 a[28:31], v9 offset:37888
v_fma_mix_f32 v217, v190, v205, v213 op_sel:[1,0,0] op_sel_hi:[1,0,0]
v_mfma_f32_16x16x32_bf16 v[40:43], a[140:143], a[4:7], v[40:43]
buffer_load_dwordx4 a[188:191], v5, s[4:7], s59 offen offset:2560 sc1
v_cvt_pk_bf16_f32 v222, v216, v217
v_mfma_f32_16x16x32_bf16 v[44:47], a[4:7], a[144:147], v[44:47]
ds_read_b128 a[32:35], v9 offset:38912
v_fma_mix_f32 v218, v191, v206, v214 op_sel:[0,0,0] op_sel_hi:[1,0,0]
v_mfma_f32_16x16x32_bf16 v[48:51], a[148:151], a[4:7], v[48:51]
v_fma_mix_f32 v219, v191, v207, v215 op_sel:[1,0,0] op_sel_hi:[1,0,0]
v_cvt_pk_bf16_f32 v223, v218, v219
v_mfma_f32_16x16x32_bf16 v[52:55], a[136:139], a[8:11], v[52:55]
ds_read_b128 a[36:39], v9 offset:39936
v_mfma_f32_16x16x32_bf16 v[56:59], a[140:143], a[8:11], v[56:59]
buffer_load_dwordx4 a[192:195], v5, s[4:7], s60 offen sc1
s_add_u32 s60, s60, 15360
v_mfma_f32_16x16x32_bf16 v[60:63], a[8:11], a[144:147], v[60:63]
ds_write_b128 v7, v[220:223] offset:45056
v_mfma_f32_16x16x32_bf16 v[64:67], a[148:151], a[8:11], v[64:67]
v_mfma_f32_16x16x32_bf16 v[68:71], a[136:139], a[12:15], v[68:71]
v_mfma_f32_16x16x32_bf16 v[72:75], a[140:143], a[12:15], v[72:75]
buffer_load_dwordx4 a[196:199], v6, s[4:7], s59 offen sc1
s_add_u32 s59, s59, 15360
v_mfma_f32_16x16x32_bf16 v[76:79], a[12:15], a[144:147], v[76:79]
v_mfma_f32_16x16x32_bf16 v[80:83], a[148:151], a[12:15], v[80:83]
v_mfma_f32_16x16x32_bf16 v[84:87], a[136:139], a[16:19], v[84:87]
v_mfma_f32_16x16x32_bf16 v[88:91], a[140:143], a[16:19], v[88:91]
v_mfma_f32_16x16x32_bf16 v[92:95], a[16:19], a[144:147], v[92:95]
v_mfma_f32_16x16x32_bf16 v[96:99], a[148:151], a[16:19], v[96:99]
s_waitcnt vmcnt(8) lgkmcnt(0)
s_barrier
v_mfma_f32_16x16x32_bf16 v[20:23], a[152:155], a[20:23], v[20:23]
ds_read_b128 a[0:3], v8 offset:40960
v_add_u32 v228, 64, v1
v_mfma_f32_16x16x32_bf16 v[24:27], a[156:159], a[20:23], v[24:27]
buffer_load_dwordx4 a[200:203], v5, s[4:7], s59 offen sc1
v_mul_u32_u24 v229, 5462, v228
v_mfma_f32_16x16x32_bf16 v[28:31], a[20:23], a[160:163], v[28:31]
ds_read_b128 a[4:7], v8 offset:41984
v_lshrrev_b32 v229, 16, v229
v_mfma_f32_16x16x32_bf16 v[32:35], a[164:167], a[20:23], v[32:35]
v_mul_u32_u24 v230, 12, v229
v_sub_u32 v228, v228, v230
v_mfma_f32_16x16x32_bf16 v[36:39], a[152:155], a[24:27], v[36:39]
ds_read_b128 a[8:11], v8 offset:43008
v_cmp_gt_u32 vcc, s100, v228
v_mfma_f32_16x16x32_bf16 v[40:43], a[156:159], a[24:27], v[40:43]
buffer_load_dwordx4 a[204:207], v5, s[4:7], s59 offen offset:2560 sc1
v_mul_u32_u24 v230, 2560, v229
v_mfma_f32_16x16x32_bf16 v[44:47], a[24:27], a[160:163], v[44:47]
ds_read_b128 a[12:15], v8 offset:44032
v_lshl_add_u32 v230, v228, 4, v230
v_mfma_f32_16x16x32_bf16 v[48:51], a[164:167], a[24:27], v[48:51]
v_cndmask_b32 v236, v255, v230, vcc
v_lshrrev_b32 v230, 3, v229
v_mfma_f32_16x16x32_bf16 v[52:55], a[152:155], a[28:31], v[52:55]
ds_read_b128 a[16:19], v8 offset:45056
v_lshlrev_b32 v230, 1, v230
v_mfma_f32_16x16x32_bf16 v[56:59], a[156:159], a[28:31], v[56:59]
buffer_load_dwordx4 a[208:211], v5, s[4:7], s60 offen sc1
s_add_u32 s60, s60, 15360
v_xor_b32 v228, v228, v230
v_mfma_f32_16x16x32_bf16 v[60:63], a[28:31], a[160:163], v[60:63]
ds_read_b128 v[200:203], v10 offset:4096
v_mul_u32_u24 v230, 1280, v229
v_mfma_f32_16x16x32_bf16 v[64:67], a[164:167], a[28:31], v[64:67]
v_lshl_add_u32 v230, v228, 4, v230
v_cndmask_b32 v233, v255, v230, vcc
v_mfma_f32_16x16x32_bf16 v[68:71], a[152:155], a[32:35], v[68:71]
ds_read_b128 v[204:207], v10 offset:4112
v_mfma_f32_16x16x32_bf16 v[72:75], a[156:159], a[32:35], v[72:75]
buffer_load_dwordx4 a[212:215], v6, s[4:7], s59 offen sc1
s_add_u32 s59, s59, 15360
v_mfma_f32_16x16x32_bf16 v[76:79], a[32:35], a[160:163], v[76:79]
ds_read_b128 v[208:211], v10 offset:1536
v_mfma_f32_16x16x32_bf16 v[80:83], a[164:167], a[32:35], v[80:83]
v_mfma_f32_16x16x32_bf16 v[84:87], a[152:155], a[36:39], v[84:87]
ds_read_b128 v[212:215], v10 offset:1552
v_mfma_f32_16x16x32_bf16 v[88:91], a[156:159], a[36:39], v[88:91]
v_mfma_f32_16x16x32_bf16 v[92:95], a[36:39], a[160:163], v[92:95]
v_mfma_f32_16x16x32_bf16 v[96:99], a[164:167], a[36:39], v[96:99]
s_waitcnt lgkmcnt(0)
s_waitcnt vmcnt(8)
v_mfma_f32_16x16x32_bf16 v[20:23], a[168:171], a[0:3], v[20:23]
ds_read_b128 a[20:23], v9 offset:46080
v_add_u32 v7, 61440, v7
v_mfma_f32_16x16x32_bf16 v[24:27], a[172:175], a[0:3], v[24:27]
buffer_load_dwordx4 a[216:219], v5, s[4:7], s59 offen sc1
v_fma_mix_f32 v216, v112, v200, v208 op_sel:[0,0,0] op_sel_hi:[1,0,0]
v_mfma_f32_16x16x32_bf16 v[28:31], a[0:3], a[176:179], v[28:31]
ds_read_b128 a[24:27], v9 offset:47104
v_fma_mix_f32 v217, v112, v201, v209 op_sel:[1,0,0] op_sel_hi:[1,0,0]
v_mfma_f32_16x16x32_bf16 v[32:35], a[180:183], a[0:3], v[32:35]
v_cvt_pk_bf16_f32 v220, v216, v217
v_fma_mix_f32 v218, v113, v202, v210 op_sel:[0,0,0] op_sel_hi:[1,0,0]
v_mfma_f32_16x16x32_bf16 v[36:39], a[168:171], a[4:7], v[36:39]
ds_read_b128 a[28:31], v9 offset:48128
v_fma_mix_f32 v219, v113, v203, v211 op_sel:[1,0,0] op_sel_hi:[1,0,0]
v_mfma_f32_16x16x32_bf16 v[40:43], a[172:175], a[4:7], v[40:43]
buffer_load_dwordx4 a[220:223], v5, s[4:7], s59 offen offset:2560 sc1
v_cvt_pk_bf16_f32 v221, v218, v219
v_mfma_f32_16x16x32_bf16 v[44:47], a[4:7], a[176:179], v[44:47]
ds_read_b128 a[32:35], v9 offset:49152
v_fma_mix_f32 v216, v114, v204, v212 op_sel:[0,0,0] op_sel_hi:[1,0,0]
v_mfma_f32_16x16x32_bf16 v[48:51], a[180:183], a[4:7], v[48:51]
v_fma_mix_f32 v217, v114, v205, v213 op_sel:[1,0,0] op_sel_hi:[1,0,0]
v_cvt_pk_bf16_f32 v222, v216, v217
v_mfma_f32_16x16x32_bf16 v[52:55], a[168:171], a[8:11], v[52:55]
ds_read_b128 a[36:39], v9 offset:50176
v_fma_mix_f32 v218, v115, v206, v214 op_sel:[0,0,0] op_sel_hi:[1,0,0]
v_mfma_f32_16x16x32_bf16 v[56:59], a[172:175], a[8:11], v[56:59]
buffer_load_dwordx4 a[224:227], v5, s[4:7], s60 offen sc1
s_add_u32 s60, s60, 15360
v_fma_mix_f32 v219, v115, v207, v215 op_sel:[1,0,0] op_sel_hi:[1,0,0]
v_mfma_f32_16x16x32_bf16 v[60:63], a[8:11], a[176:179], v[60:63]
v_cvt_pk_bf16_f32 v223, v218, v219
v_mfma_f32_16x16x32_bf16 v[64:67], a[180:183], a[8:11], v[64:67]
ds_write_b128 v7, v[220:223] offset:0
v_mfma_f32_16x16x32_bf16 v[68:71], a[168:171], a[12:15], v[68:71]
v_fma_mix_f32 v216, v132, v200, v208 op_sel:[0,0,0] op_sel_hi:[1,0,0]
v_fma_mix_f32 v217, v132, v201, v209 op_sel:[1,0,0] op_sel_hi:[1,0,0]
v_mfma_f32_16x16x32_bf16 v[72:75], a[172:175], a[12:15], v[72:75]
buffer_load_dwordx4 a[228:231], v6, s[4:7], s59 offen sc1
s_add_u32 s59, s59, 15360
v_cvt_pk_bf16_f32 v224, v216, v217
v_mfma_f32_16x16x32_bf16 v[76:79], a[12:15], a[176:179], v[76:79]
v_fma_mix_f32 v218, v133, v202, v210 op_sel:[0,0,0] op_sel_hi:[1,0,0]
v_fma_mix_f32 v219, v133, v203, v211 op_sel:[1,0,0] op_sel_hi:[1,0,0]
v_mfma_f32_16x16x32_bf16 v[80:83], a[180:183], a[12:15], v[80:83]
v_cvt_pk_bf16_f32 v225, v218, v219
v_fma_mix_f32 v216, v134, v204, v212 op_sel:[0,0,0] op_sel_hi:[1,0,0]
v_mfma_f32_16x16x32_bf16 v[84:87], a[168:171], a[16:19], v[84:87]
v_fma_mix_f32 v217, v134, v205, v213 op_sel:[1,0,0] op_sel_hi:[1,0,0]
v_cvt_pk_bf16_f32 v226, v216, v217
v_mfma_f32_16x16x32_bf16 v[88:91], a[172:175], a[16:19], v[88:91]
v_fma_mix_f32 v218, v135, v206, v214 op_sel:[0,0,0] op_sel_hi:[1,0,0]
v_fma_mix_f32 v219, v135, v207, v215 op_sel:[1,0,0] op_sel_hi:[1,0,0]
v_mfma_f32_16x16x32_bf16 v[92:95], a[16:19], a[176:179], v[92:95]
v_cvt_pk_bf16_f32 v227, v218, v219
v_mfma_f32_16x16x32_bf16 v[96:99], a[180:183], a[16:19], v[96:99]
ds_write_b128 v7, v[224:227] offset:1024
s_waitcnt vmcnt(8) lgkmcnt(2)
v_mfma_f32_16x16x32_bf16 v[20:23], a[184:187], a[20:23], v[20:23]
ds_read_b128 a[0:3], v8 offset:51200
v_fma_mix_f32 v216, v152, v200, v208 op_sel:[0,0,0] op_sel_hi:[1,0,0]
v_mfma_f32_16x16x32_bf16 v[24:27], a[188:191], a[20:23], v[24:27]
buffer_load_dwordx4 a[40:43], v5, s[4:7], s59 offen sc1
v_fma_mix_f32 v217, v152, v201, v209 op_sel:[1,0,0] op_sel_hi:[1,0,0]
v_mfma_f32_16x16x32_bf16 v[28:31], a[20:23], a[192:195], v[28:31]
ds_read_b128 a[4:7], v8 offset:52224
v_cvt_pk_bf16_f32 v220, v216, v217
v_mfma_f32_16x16x32_bf16 v[32:35], a[196:199], a[20:23], v[32:35]
v_fma_mix_f32 v218, v153, v202, v210 op_sel:[0,0,0] op_sel_hi:[1,0,0]
v_fma_mix_f32 v219, v153, v203, v211 op_sel:[1,0,0] op_sel_hi:[1,0,0]
v_mfma_f32_16x16x32_bf16 v[36:39], a[184:187], a[24:27], v[36:39]
ds_read_b128 a[8:11], v8 offset:53248
v_cvt_pk_bf16_f32 v221, v218, v219
v_mfma_f32_16x16x32_bf16 v[40:43], a[188:191], a[24:27], v[40:43]
buffer_load_dwordx4 a[44:47], v5, s[4:7], s59 offen offset:2560 sc1
v_fma_mix_f32 v216, v154, v204, v212 op_sel:[0,0,0] op_sel_hi:[1,0,0]
v_mfma_f32_16x16x32_bf16 v[44:47], a[24:27], a[192:195], v[44:47]
ds_read_b128 a[12:15], v8 offset:54272
v_fma_mix_f32 v217, v154, v205, v213 op_sel:[1,0,0] op_sel_hi:[1,0,0]
v_mfma_f32_16x16x32_bf16 v[48:51], a[196:199], a[24:27], v[48:51]
v_cvt_pk_bf16_f32 v222, v216, v217
v_fma_mix_f32 v218, v155, v206, v214 op_sel:[0,0,0] op_sel_hi:[1,0,0]
v_mfma_f32_16x16x32_bf16 v[52:55], a[184:187], a[28:31], v[52:55]
ds_read_b128 a[16:19], v8 offset:55296
v_fma_mix_f32 v219, v155, v207, v215 op_sel:[1,0,0] op_sel_hi:[1,0,0]
v_mfma_f32_16x16x32_bf16 v[56:59], a[188:191], a[28:31], v[56:59]
buffer_load_dwordx4 a[48:51], v5, s[4:7], s60 offen sc1
s_add_u32 s60, s60, 15360
v_cvt_pk_bf16_f32 v223, v218, v219
v_mfma_f32_16x16x32_bf16 v[60:63], a[28:31], a[192:195], v[60:63]
ds_write_b128 v7, v[220:223] offset:2048
v_mfma_f32_16x16x32_bf16 v[64:67], a[196:199], a[28:31], v[64:67]
v_fma_mix_f32 v216, v172, v200, v208 op_sel:[0,0,0] op_sel_hi:[1,0,0]
v_fma_mix_f32 v217, v172, v201, v209 op_sel:[1,0,0] op_sel_hi:[1,0,0]
v_mfma_f32_16x16x32_bf16 v[68:71], a[184:187], a[32:35], v[68:71]
v_cvt_pk_bf16_f32 v224, v216, v217
v_fma_mix_f32 v218, v173, v202, v210 op_sel:[0,0,0] op_sel_hi:[1,0,0]
v_mfma_f32_16x16x32_bf16 v[72:75], a[188:191], a[32:35], v[72:75]
buffer_load_dwordx4 a[52:55], v6, s[4:7], s59 offen sc1
s_add_u32 s59, s59, 15360
v_fma_mix_f32 v219, v173, v203, v211 op_sel:[1,0,0] op_sel_hi:[1,0,0]
v_mfma_f32_16x16x32_bf16 v[76:79], a[32:35], a[192:195], v[76:79]
v_cvt_pk_bf16_f32 v225, v218, v219
v_fma_mix_f32 v216, v174, v204, v212 op_sel:[0,0,0] op_sel_hi:[1,0,0]
v_mfma_f32_16x16x32_bf16 v[80:83], a[196:199], a[32:35], v[80:83]
v_fma_mix_f32 v217, v174, v205, v213 op_sel:[1,0,0] op_sel_hi:[1,0,0]
v_cvt_pk_bf16_f32 v226, v216, v217
v_mfma_f32_16x16x32_bf16 v[84:87], a[184:187], a[36:39], v[84:87]
v_fma_mix_f32 v218, v175, v206, v214 op_sel:[0,0,0] op_sel_hi:[1,0,0]
v_fma_mix_f32 v219, v175, v207, v215 op_sel:[1,0,0] op_sel_hi:[1,0,0]
v_mfma_f32_16x16x32_bf16 v[88:91], a[188:191], a[36:39], v[88:91]
v_cvt_pk_bf16_f32 v227, v218, v219
v_mfma_f32_16x16x32_bf16 v[92:95], a[36:39], a[192:195], v[92:95]
ds_write_b128 v7, v[224:227] offset:3072
v_mfma_f32_16x16x32_bf16 v[96:99], a[196:199], a[36:39], v[96:99]
v_fma_mix_f32 v216, v192, v200, v208 op_sel:[0,0,0] op_sel_hi:[1,0,0]
v_fma_mix_f32 v217, v192, v201, v209 op_sel:[1,0,0] op_sel_hi:[1,0,0]
s_waitcnt vmcnt(8) lgkmcnt(2)
v_mfma_f32_16x16x32_bf16 v[20:23], a[200:203], a[0:3], v[20:23]
ds_read_b128 a[20:23], v9 offset:56320
v_cvt_pk_bf16_f32 v220, v216, v217
v_mfma_f32_16x16x32_bf16 v[24:27], a[204:207], a[0:3], v[24:27]
buffer_load_dwordx4 a[56:59], v5, s[4:7], s59 offen sc1
v_fma_mix_f32 v218, v193, v202, v210 op_sel:[0,0,0] op_sel_hi:[1,0,0]
v_mfma_f32_16x16x32_bf16 v[28:31], a[0:3], a[208:211], v[28:31]
ds_read_b128 a[24:27], v9 offset:57344
v_fma_mix_f32 v219, v193, v203, v211 op_sel:[1,0,0] op_sel_hi:[1,0,0]
v_mfma_f32_16x16x32_bf16 v[32:35], a[212:215], a[0:3], v[32:35]
v_cvt_pk_bf16_f32 v221, v218, v219
v_fma_mix_f32 v216, v194, v204, v212 op_sel:[0,0,0] op_sel_hi:[1,0,0]
v_mfma_f32_16x16x32_bf16 v[36:39], a[200:203], a[4:7], v[36:39]
ds_read_b128 a[28:31], v9 offset:58368
v_fma_mix_f32 v217, v194, v205, v213 op_sel:[1,0,0] op_sel_hi:[1,0,0]
v_mfma_f32_16x16x32_bf16 v[40:43], a[204:207], a[4:7], v[40:43]
buffer_load_dwordx4 a[60:63], v5, s[4:7], s59 offen offset:2560 sc1
v_cvt_pk_bf16_f32 v222, v216, v217
v_mfma_f32_16x16x32_bf16 v[44:47], a[4:7], a[208:211], v[44:47]
ds_read_b128 a[32:35], v9 offset:59392
v_fma_mix_f32 v218, v195, v206, v214 op_sel:[0,0,0] op_sel_hi:[1,0,0]
v_mfma_f32_16x16x32_bf16 v[48:51], a[212:215], a[4:7], v[48:51]
v_fma_mix_f32 v219, v195, v207, v215 op_sel:[1,0,0] op_sel_hi:[1,0,0]
v_cvt_pk_bf16_f32 v223, v218, v219
v_mfma_f32_16x16x32_bf16 v[52:55], a[200:203], a[8:11], v[52:55]
ds_read_b128 a[36:39], v9 offset:60416
v_mfma_f32_16x16x32_bf16 v[56:59], a[204:207], a[8:11], v[56:59]
buffer_load_dwordx4 a[64:67], v5, s[4:7], s60 offen sc1
s_add_u32 s60, s60, 15360
v_mfma_f32_16x16x32_bf16 v[60:63], a[8:11], a[208:211], v[60:63]
ds_write_b128 v7, v[220:223] offset:4096
v_mfma_f32_16x16x32_bf16 v[64:67], a[212:215], a[8:11], v[64:67]
v_mfma_f32_16x16x32_bf16 v[68:71], a[200:203], a[12:15], v[68:71]
v_mfma_f32_16x16x32_bf16 v[72:75], a[204:207], a[12:15], v[72:75]
buffer_load_dwordx4 a[68:71], v6, s[4:7], s59 offen sc1
s_add_u32 s59, s59, 15360
v_mfma_f32_16x16x32_bf16 v[76:79], a[12:15], a[208:211], v[76:79]
v_mfma_f32_16x16x32_bf16 v[80:83], a[212:215], a[12:15], v[80:83]
v_mfma_f32_16x16x32_bf16 v[84:87], a[200:203], a[16:19], v[84:87]
v_mfma_f32_16x16x32_bf16 v[88:91], a[204:207], a[16:19], v[88:91]
v_mfma_f32_16x16x32_bf16 v[92:95], a[16:19], a[208:211], v[92:95]
v_mfma_f32_16x16x32_bf16 v[96:99], a[212:215], a[16:19], v[96:99]
s_waitcnt vmcnt(8) lgkmcnt(0)
s_barrier
v_add_u32 v8, 61440, v8
v_mfma_f32_16x16x32_bf16 v[20:23], a[216:219], a[20:23], v[20:23]
ds_read_b128 a[0:3], v8 offset:0
v_add_u32 v228, 128, v1
v_mfma_f32_16x16x32_bf16 v[24:27], a[220:223], a[20:23], v[24:27]
buffer_load_dwordx4 a[72:75], v5, s[4:7], s59 offen sc1
v_mul_u32_u24 v229, 5462, v228
v_mfma_f32_16x16x32_bf16 v[28:31], a[20:23], a[224:227], v[28:31]
ds_read_b128 a[4:7], v8 offset:1024
v_lshrrev_b32 v229, 16, v229
v_mfma_f32_16x16x32_bf16 v[32:35], a[228:231], a[20:23], v[32:35]
v_mul_u32_u24 v230, 12, v229
v_sub_u32 v228, v228, v230
v_mfma_f32_16x16x32_bf16 v[36:39], a[216:219], a[24:27], v[36:39]
ds_read_b128 a[8:11], v8 offset:2048
v_cmp_gt_u32 vcc, s100, v228
v_mfma_f32_16x16x32_bf16 v[40:43], a[220:223], a[24:27], v[40:43]
buffer_load_dwordx4 a[76:79], v5, s[4:7], s59 offen offset:2560 sc1
v_mul_u32_u24 v230, 2560, v229
v_mfma_f32_16x16x32_bf16 v[44:47], a[24:27], a[224:227], v[44:47]
ds_read_b128 a[12:15], v8 offset:3072
v_lshl_add_u32 v230, v228, 4, v230
v_mfma_f32_16x16x32_bf16 v[48:51], a[228:231], a[24:27], v[48:51]
v_cndmask_b32 v237, v255, v230, vcc
v_lshrrev_b32 v230, 3, v229
v_mfma_f32_16x16x32_bf16 v[52:55], a[216:219], a[28:31], v[52:55]
ds_read_b128 a[16:19], v8 offset:4096
v_lshlrev_b32 v230, 1, v230
v_mfma_f32_16x16x32_bf16 v[56:59], a[220:223], a[28:31], v[56:59]
buffer_load_dwordx4 a[80:83], v5, s[4:7], s60 offen sc1
s_add_u32 s60, s60, 15360
v_xor_b32 v228, v228, v230
v_mfma_f32_16x16x32_bf16 v[60:63], a[28:31], a[224:227], v[60:63]
ds_read_b128 v[200:203], v10 offset:4608
v_mul_u32_u24 v230, 1280, v229
v_mfma_f32_16x16x32_bf16 v[64:67], a[228:231], a[28:31], v[64:67]
v_lshl_add_u32 v230, v228, 4, v230
v_cndmask_b32 v234, v255, v230, vcc
v_mfma_f32_16x16x32_bf16 v[68:71], a[216:219], a[32:35], v[68:71]
ds_read_b128 v[204:207], v10 offset:4624
v_cmp_gt_u32 vcc, s101, v1
v_mfma_f32_16x16x32_bf16 v[72:75], a[220:223], a[32:35], v[72:75]
buffer_load_dwordx4 a[84:87], v6, s[4:7], s59 offen sc1
s_add_u32 s59, s59, 15360
v_lshlrev_b32 v228, 4, v1
v_mfma_f32_16x16x32_bf16 v[76:79], a[32:35], a[224:227], v[76:79]
ds_read_b128 v[208:211], v10 offset:2048
v_lshlrev_b32 v229, 3, v1
v_mfma_f32_16x16x32_bf16 v[80:83], a[228:231], a[32:35], v[80:83]
v_cndmask_b32 v238, v255, v228, vcc
v_cndmask_b32 v239, v255, v229, vcc
v_mfma_f32_16x16x32_bf16 v[84:87], a[216:219], a[36:39], v[84:87]
ds_read_b128 v[212:215], v10 offset:2064
v_cndmask_b32 v250, 0, -1, vcc
v_mfma_f32_16x16x32_bf16 v[88:91], a[220:223], a[36:39], v[88:91]
v_mfma_f32_16x16x32_bf16 v[92:95], a[36:39], a[224:227], v[92:95]
v_mfma_f32_16x16x32_bf16 v[96:99], a[228:231], a[36:39], v[96:99]
s_waitcnt lgkmcnt(0)
s_waitcnt vmcnt(8)
v_add_u32 v9, 61440, v9
v_mfma_f32_16x16x32_bf16 v[20:23], a[40:43], a[0:3], v[20:23]
ds_read_b128 a[20:23], v9 offset:5120
v_fma_mix_f32 v216, v116, v200, v208 op_sel:[0,0,0] op_sel_hi:[1,0,0]
v_mfma_f32_16x16x32_bf16 v[24:27], a[44:47], a[0:3], v[24:27]
buffer_load_dwordx4 a[88:91], v5, s[4:7], s59 offen sc1
v_fma_mix_f32 v217, v116, v201, v209 op_sel:[1,0,0] op_sel_hi:[1,0,0]
v_mfma_f32_16x16x32_bf16 v[28:31], a[0:3], a[48:51], v[28:31]
ds_read_b128 a[24:27], v9 offset:6144
v_cvt_pk_bf16_f32 v220, v216, v217
v_mfma_f32_16x16x32_bf16 v[32:35], a[52:55], a[0:3], v[32:35]
v_fma_mix_f32 v218, v117, v202, v210 op_sel:[0,0,0] op_sel_hi:[1,0,0]
v_fma_mix_f32 v219, v117, v203, v211 op_sel:[1,0,0] op_sel_hi:[1,0,0]
v_mfma_f32_16x16x32_bf16 v[36:39], a[40:43], a[4:7], v[36:39]
ds_read_b128 a[28:31], v9 offset:7168
v_cvt_pk_bf16_f32 v221, v218, v219
v_mfma_f32_16x16x32_bf16 v[40:43], a[44:47], a[4:7], v[40:43]
buffer_load_dwordx4 a[92:95], v5, s[4:7], s59 offen offset:2560 sc1
v_fma_mix_f32 v216, v118, v204, v212 op_sel:[0,0,0] op_sel_hi:[1,0,0]
v_mfma_f32_16x16x32_bf16 v[44:47], a[4:7], a[48:51], v[44:47]
ds_read_b128 a[32:35], v9 offset:8192
v_fma_mix_f32 v217, v118, v205, v213 op_sel:[1,0,0] op_sel_hi:[1,0,0]
v_mfma_f32_16x16x32_bf16 v[48:51], a[52:55], a[4:7], v[48:51]
v_cvt_pk_bf16_f32 v222, v216, v217
v_fma_mix_f32 v218, v119, v206, v214 op_sel:[0,0,0] op_sel_hi:[1,0,0]
v_mfma_f32_16x16x32_bf16 v[52:55], a[40:43], a[8:11], v[52:55]
ds_read_b128 a[36:39], v9 offset:9216
v_fma_mix_f32 v219, v119, v207, v215 op_sel:[1,0,0] op_sel_hi:[1,0,0]
v_mfma_f32_16x16x32_bf16 v[56:59], a[44:47], a[8:11], v[56:59]
buffer_load_dwordx4 a[96:99], v5, s[4:7], s60 offen sc1
s_add_u32 s60, s60, 15360
v_cvt_pk_bf16_f32 v223, v218, v219
v_mfma_f32_16x16x32_bf16 v[60:63], a[8:11], a[48:51], v[60:63]
ds_write_b128 v7, v[220:223] offset:20480
v_mfma_f32_16x16x32_bf16 v[64:67], a[52:55], a[8:11], v[64:67]
v_fma_mix_f32 v216, v136, v200, v208 op_sel:[0,0,0] op_sel_hi:[1,0,0]
v_fma_mix_f32 v217, v136, v201, v209 op_sel:[1,0,0] op_sel_hi:[1,0,0]
v_mfma_f32_16x16x32_bf16 v[68:71], a[40:43], a[12:15], v[68:71]
v_cvt_pk_bf16_f32 v224, v216, v217
v_fma_mix_f32 v218, v137, v202, v210 op_sel:[0,0,0] op_sel_hi:[1,0,0]
v_mfma_f32_16x16x32_bf16 v[72:75], a[44:47], a[12:15], v[72:75]
buffer_load_dwordx4 a[100:103], v6, s[4:7], s59 offen sc1
s_add_u32 s59, s59, 15360
v_fma_mix_f32 v219, v137, v203, v211 op_sel:[1,0,0] op_sel_hi:[1,0,0]
v_mfma_f32_16x16x32_bf16 v[76:79], a[12:15], a[48:51], v[76:79]
v_cvt_pk_bf16_f32 v225, v218, v219
v_fma_mix_f32 v216, v138, v204, v212 op_sel:[0,0,0] op_sel_hi:[1,0,0]
v_mfma_f32_16x16x32_bf16 v[80:83], a[52:55], a[12:15], v[80:83]
v_fma_mix_f32 v217, v138, v205, v213 op_sel:[1,0,0] op_sel_hi:[1,0,0]
v_cvt_pk_bf16_f32 v226, v216, v217
v_mfma_f32_16x16x32_bf16 v[84:87], a[40:43], a[16:19], v[84:87]
v_fma_mix_f32 v218, v139, v206, v214 op_sel:[0,0,0] op_sel_hi:[1,0,0]
v_fma_mix_f32 v219, v139, v207, v215 op_sel:[1,0,0] op_sel_hi:[1,0,0]
v_mfma_f32_16x16x32_bf16 v[88:91], a[44:47], a[16:19], v[88:91]
v_cvt_pk_bf16_f32 v227, v218, v219
v_mfma_f32_16x16x32_bf16 v[92:95], a[16:19], a[48:51], v[92:95]
ds_write_b128 v7, v[224:227] offset:21504
v_mfma_f32_16x16x32_bf16 v[96:99], a[52:55], a[16:19], v[96:99]
v_fma_mix_f32 v216, v156, v200, v208 op_sel:[0,0,0] op_sel_hi:[1,0,0]
v_fma_mix_f32 v217, v156, v201, v209 op_sel:[1,0,0] op_sel_hi:[1,0,0]
s_waitcnt vmcnt(8) lgkmcnt(2)
v_mfma_f32_16x16x32_bf16 v[20:23], a[56:59], a[20:23], v[20:23]
ds_read_b128 a[0:3], v8 offset:10240
v_cvt_pk_bf16_f32 v220, v216, v217
v_mfma_f32_16x16x32_bf16 v[24:27], a[60:63], a[20:23], v[24:27]
buffer_load_dwordx4 a[104:107], v5, s[4:7], s59 offen sc1
v_fma_mix_f32 v218, v157, v202, v210 op_sel:[0,0,0] op_sel_hi:[1,0,0]
v_mfma_f32_16x16x32_bf16 v[28:31], a[20:23], a[64:67], v[28:31]
ds_read_b128 a[4:7], v8 offset:11264
v_fma_mix_f32 v219, v157, v203, v211 op_sel:[1,0,0] op_sel_hi:[1,0,0]
v_mfma_f32_16x16x32_bf16 v[32:35], a[68:71], a[20:23], v[32:35]
v_cvt_pk_bf16_f32 v221, v218, v219
v_fma_mix_f32 v216, v158, v204, v212 op_sel:[0,0,0] op_sel_hi:[1,0,0]
v_mfma_f32_16x16x32_bf16 v[36:39], a[56:59], a[24:27], v[36:39]
ds_read_b128 a[8:11], v8 offset:12288
v_fma_mix_f32 v217, v158, v205, v213 op_sel:[1,0,0] op_sel_hi:[1,0,0]
v_mfma_f32_16x16x32_bf16 v[40:43], a[60:63], a[24:27], v[40:43]
buffer_load_dwordx4 a[108:111], v5, s[4:7], s59 offen offset:2560 sc1
v_cvt_pk_bf16_f32 v222, v216, v217
v_mfma_f32_16x16x32_bf16 v[44:47], a[24:27], a[64:67], v[44:47]
ds_read_b128 a[12:15], v8 offset:13312
v_fma_mix_f32 v218, v159, v206, v214 op_sel:[0,0,0] op_sel_hi:[1,0,0]
v_mfma_f32_16x16x32_bf16 v[48:51], a[68:71], a[24:27], v[48:51]
v_fma_mix_f32 v219, v159, v207, v215 op_sel:[1,0,0] op_sel_hi:[1,0,0]
v_cvt_pk_bf16_f32 v223, v218, v219
v_mfma_f32_16x16x32_bf16 v[52:55], a[56:59], a[28:31], v[52:55]
ds_read_b128 a[16:19], v8 offset:14336
v_mfma_f32_16x16x32_bf16 v[56:59], a[60:63], a[28:31], v[56:59]
buffer_load_dwordx4 a[112:115], v5, s[4:7], s60 offen sc1
s_add_u32 s60, s60, 15360
v_mfma_f32_16x16x32_bf16 v[60:63], a[28:31], a[64:67], v[60:63]
ds_write_b128 v7, v[220:223] offset:22528
v_mfma_f32_16x16x32_bf16 v[64:67], a[68:71], a[28:31], v[64:67]
v_fma_mix_f32 v216, v176, v200, v208 op_sel:[0,0,0] op_sel_hi:[1,0,0]
v_fma_mix_f32 v217, v176, v201, v209 op_sel:[1,0,0] op_sel_hi:[1,0,0]
v_mfma_f32_16x16x32_bf16 v[68:71], a[56:59], a[32:35], v[68:71]
v_cvt_pk_bf16_f32 v224, v216, v217
v_fma_mix_f32 v218, v177, v202, v210 op_sel:[0,0,0] op_sel_hi:[1,0,0]
v_mfma_f32_16x16x32_bf16 v[72:75], a[60:63], a[32:35], v[72:75]
buffer_load_dwordx4 a[116:119], v6, s[4:7], s59 offen sc1
s_add_u32 s59, s59, 15360
v_fma_mix_f32 v219, v177, v203, v211 op_sel:[1,0,0] op_sel_hi:[1,0,0]
v_mfma_f32_16x16x32_bf16 v[76:79], a[32:35], a[64:67], v[76:79]
v_cvt_pk_bf16_f32 v225, v218, v219
v_fma_mix_f32 v216, v178, v204, v212 op_sel:[0,0,0] op_sel_hi:[1,0,0]
v_mfma_f32_16x16x32_bf16 v[80:83], a[68:71], a[32:35], v[80:83]
v_fma_mix_f32 v217, v178, v205, v213 op_sel:[1,0,0] op_sel_hi:[1,0,0]
v_cvt_pk_bf16_f32 v226, v216, v217
v_mfma_f32_16x16x32_bf16 v[84:87], a[56:59], a[36:39], v[84:87]
v_fma_mix_f32 v218, v179, v206, v214 op_sel:[0,0,0] op_sel_hi:[1,0,0]
v_fma_mix_f32 v219, v179, v207, v215 op_sel:[1,0,0] op_sel_hi:[1,0,0]
v_mfma_f32_16x16x32_bf16 v[88:91], a[60:63], a[36:39], v[88:91]
v_cvt_pk_bf16_f32 v227, v218, v219
v_mfma_f32_16x16x32_bf16 v[92:95], a[36:39], a[64:67], v[92:95]
ds_write_b128 v7, v[224:227] offset:23552
v_mfma_f32_16x16x32_bf16 v[96:99], a[68:71], a[36:39], v[96:99]
v_fma_mix_f32 v216, v196, v200, v208 op_sel:[0,0,0] op_sel_hi:[1,0,0]
v_fma_mix_f32 v217, v196, v201, v209 op_sel:[1,0,0] op_sel_hi:[1,0,0]
s_waitcnt vmcnt(8) lgkmcnt(2)
v_mfma_f32_16x16x32_bf16 v[20:23], a[72:75], a[0:3], v[20:23]
ds_read_b128 a[20:23], v9 offset:15360
v_cvt_pk_bf16_f32 v220, v216, v217
v_mfma_f32_16x16x32_bf16 v[24:27], a[76:79], a[0:3], v[24:27]
buffer_load_dwordx4 a[120:123], v5, s[4:7], s59 offen sc1
v_fma_mix_f32 v218, v197, v202, v210 op_sel:[0,0,0] op_sel_hi:[1,0,0]
v_mfma_f32_16x16x32_bf16 v[28:31], a[0:3], a[80:83], v[28:31]
ds_read_b128 a[24:27], v9 offset:16384
v_fma_mix_f32 v219, v197, v203, v211 op_sel:[1,0,0] op_sel_hi:[1,0,0]
v_mfma_f32_16x16x32_bf16 v[32:35], a[84:87], a[0:3], v[32:35]
v_cvt_pk_bf16_f32 v221, v218, v219
v_fma_mix_f32 v216, v198, v204, v212 op_sel:[0,0,0] op_sel_hi:[1,0,0]
v_mfma_f32_16x16x32_bf16 v[36:39], a[72:75], a[4:7], v[36:39]
ds_read_b128 a[28:31], v9 offset:17408
v_fma_mix_f32 v217, v198, v205, v213 op_sel:[1,0,0] op_sel_hi:[1,0,0]
v_mfma_f32_16x16x32_bf16 v[40:43], a[76:79], a[4:7], v[40:43]
buffer_load_dwordx4 a[124:127], v5, s[4:7], s59 offen offset:2560 sc1
v_cvt_pk_bf16_f32 v222, v216, v217
v_mfma_f32_16x16x32_bf16 v[44:47], a[4:7], a[80:83], v[44:47]
ds_read_b128 a[32:35], v9 offset:18432
v_fma_mix_f32 v218, v199, v206, v214 op_sel:[0,0,0] op_sel_hi:[1,0,0]
v_mfma_f32_16x16x32_bf16 v[48:51], a[84:87], a[4:7], v[48:51]
v_fma_mix_f32 v219, v199, v207, v215 op_sel:[1,0,0] op_sel_hi:[1,0,0]
v_cvt_pk_bf16_f32 v223, v218, v219
v_mfma_f32_16x16x32_bf16 v[52:55], a[72:75], a[8:11], v[52:55]
ds_read_b128 a[36:39], v9 offset:19456
v_mfma_f32_16x16x32_bf16 v[56:59], a[76:79], a[8:11], v[56:59]
buffer_load_dwordx4 a[128:131], v5, s[4:7], s60 offen sc1
s_add_u32 s60, s60, 15360
v_mfma_f32_16x16x32_bf16 v[60:63], a[8:11], a[80:83], v[60:63]
ds_write_b128 v7, v[220:223] offset:24576
v_mfma_f32_16x16x32_bf16 v[64:67], a[84:87], a[8:11], v[64:67]
v_mfma_f32_16x16x32_bf16 v[68:71], a[72:75], a[12:15], v[68:71]
v_mfma_f32_16x16x32_bf16 v[72:75], a[76:79], a[12:15], v[72:75]
buffer_load_dwordx4 a[132:135], v6, s[4:7], s59 offen sc1
s_add_u32 s59, s59, 15360
v_mfma_f32_16x16x32_bf16 v[76:79], a[12:15], a[80:83], v[76:79]
v_mfma_f32_16x16x32_bf16 v[80:83], a[84:87], a[12:15], v[80:83]
v_mfma_f32_16x16x32_bf16 v[84:87], a[72:75], a[16:19], v[84:87]
v_mfma_f32_16x16x32_bf16 v[88:91], a[76:79], a[16:19], v[88:91]
v_mfma_f32_16x16x32_bf16 v[92:95], a[16:19], a[80:83], v[92:95]
v_mfma_f32_16x16x32_bf16 v[96:99], a[84:87], a[16:19], v[96:99]
s_waitcnt vmcnt(8) lgkmcnt(0)
s_barrier
v_mfma_f32_16x16x32_bf16 v[20:23], a[88:91], a[20:23], v[20:23]
ds_read_b128 a[0:3], v8 offset:20480
v_mfma_f32_16x16x32_bf16 v[24:27], a[92:95], a[20:23], v[24:27]
buffer_load_dwordx4 a[136:139], v5, s[4:7], s59 offen sc1
v_mfma_f32_16x16x32_bf16 v[28:31], a[20:23], a[96:99], v[28:31]
ds_read_b128 a[4:7], v8 offset:21504
v_mfma_f32_16x16x32_bf16 v[32:35], a[100:103], a[20:23], v[32:35]
v_mfma_f32_16x16x32_bf16 v[36:39], a[88:91], a[24:27], v[36:39]
ds_read_b128 a[8:11], v8 offset:22528
v_mfma_f32_16x16x32_bf16 v[40:43], a[92:95], a[24:27], v[40:43]
buffer_load_dwordx4 a[140:143], v5, s[4:7], s59 offen offset:2560 sc1
v_mfma_f32_16x16x32_bf16 v[44:47], a[24:27], a[96:99], v[44:47]
ds_read_b128 a[12:15], v8 offset:23552
v_mfma_f32_16x16x32_bf16 v[48:51], a[100:103], a[24:27], v[48:51]
v_mfma_f32_16x16x32_bf16 v[52:55], a[88:91], a[28:31], v[52:55]
ds_read_b128 a[16:19], v8 offset:24576
v_mfma_f32_16x16x32_bf16 v[56:59], a[92:95], a[28:31], v[56:59]
buffer_load_dwordx4 a[144:147], v5, s[4:7], s60 offen sc1
s_add_u32 s60, s60, 15360
v_mfma_f32_16x16x32_bf16 v[60:63], a[28:31], a[96:99], v[60:63]
v_mfma_f32_16x16x32_bf16 v[64:67], a[100:103], a[28:31], v[64:67]
v_mfma_f32_16x16x32_bf16 v[68:71], a[88:91], a[32:35], v[68:71]
v_mfma_f32_16x16x32_bf16 v[72:75], a[92:95], a[32:35], v[72:75]
buffer_load_dwordx4 a[148:151], v6, s[4:7], s59 offen sc1
s_add_u32 s59, s59, 15360
v_mfma_f32_16x16x32_bf16 v[76:79], a[32:35], a[96:99], v[76:79]
v_mfma_f32_16x16x32_bf16 v[80:83], a[100:103], a[32:35], v[80:83]
v_mfma_f32_16x16x32_bf16 v[84:87], a[88:91], a[36:39], v[84:87]
v_mfma_f32_16x16x32_bf16 v[88:91], a[92:95], a[36:39], v[88:91]
v_mfma_f32_16x16x32_bf16 v[92:95], a[36:39], a[96:99], v[92:95]
v_mfma_f32_16x16x32_bf16 v[96:99], a[100:103], a[36:39], v[96:99]
s_waitcnt vmcnt(8) lgkmcnt(0)
v_mfma_f32_16x16x32_bf16 v[20:23], a[104:107], a[0:3], v[20:23]
ds_read_b128 a[20:23], v9 offset:25600
v_mov_b32 v180, 4048155338
v_mfma_f32_16x16x32_bf16 v[24:27], a[108:111], a[0:3], v[24:27]
buffer_load_dwordx4 a[152:155], v5, s[4:7], s59 offen sc1
v_lshlrev_b32 v181, 2, v3
v_mfma_f32_16x16x32_bf16 v[28:31], a[0:3], a[112:115], v[28:31]
ds_read_b128 a[24:27], v9 offset:26624
v_sub_u32 v181, v2, v181
v_mfma_f32_16x16x32_bf16 v[32:35], a[116:119], a[0:3], v[32:35]
v_subrev_u32 v182, 0, v181
v_cmp_gt_u32 vcc, 8, v182
v_mfma_f32_16x16x32_bf16 v[36:39], a[104:107], a[4:7], v[36:39]
ds_read_b128 a[28:31], v9 offset:27648
v_cmp_gt_i32 s[62:63], -8, v182
v_mfma_f32_16x16x32_bf16 v[40:43], a[108:111], a[4:7], v[40:43]
buffer_load_dwordx4 a[156:159], v5, s[4:7], s59 offen offset:2560 sc1
v_mov_b32 v176, 0x3f803f80
v_mfma_f32_16x16x32_bf16 v[44:47], a[4:7], a[112:115], v[44:47]
ds_read_b128 a[32:35], v9 offset:28672
v_cndmask_b32 v164, v180, 0, vcc
v_mfma_f32_16x16x32_bf16 v[48:51], a[116:119], a[4:7], v[48:51]
v_cndmask_b32 v168, v180, 0, s[62:63]
v_cndmask_b32 v184, 0, -1, s[62:63]
v_mfma_f32_16x16x32_bf16 v[52:55], a[104:107], a[8:11], v[52:55]
ds_read_b128 a[36:39], v9 offset:29696
v_subrev_u32 v182, 1, v181
v_mfma_f32_16x16x32_bf16 v[56:59], a[108:111], a[8:11], v[56:59]
buffer_load_dwordx4 a[160:163], v5, s[4:7], s60 offen sc1
s_add_u32 s60, s60, 15360
v_cmp_gt_u32 vcc, 8, v182
v_mfma_f32_16x16x32_bf16 v[60:63], a[8:11], a[112:115], v[60:63]
v_cmp_gt_i32 s[62:63], -8, v182
v_mov_b32 v177, 0x3f803f80
v_mfma_f32_16x16x32_bf16 v[64:67], a[116:119], a[8:11], v[64:67]
v_cndmask_b32 v165, v180, 0, vcc
v_cndmask_b32 v169, v180, 0, s[62:63]
v_mfma_f32_16x16x32_bf16 v[68:71], a[104:107], a[12:15], v[68:71]
v_cndmask_b32 v185, 0, -1, s[62:63]
v_subrev_u32 v182, 2, v181
v_mfma_f32_16x16x32_bf16 v[72:75], a[108:111], a[12:15], v[72:75]
buffer_load_dwordx4 a[164:167], v6, s[4:7], s59 offen sc1
s_add_u32 s59, s59, 15360
v_cmp_gt_u32 vcc, 8, v182
v_mfma_f32_16x16x32_bf16 v[76:79], a[12:15], a[112:115], v[76:79]
v_cmp_gt_i32 s[62:63], -8, v182
v_mov_b32 v178, 0x3f803f80
v_mfma_f32_16x16x32_bf16 v[80:83], a[116:119], a[12:15], v[80:83]
v_cndmask_b32 v166, v180, 0, vcc
v_cndmask_b32 v170, v180, 0, s[62:63]
v_mfma_f32_16x16x32_bf16 v[84:87], a[104:107], a[16:19], v[84:87]
v_cndmask_b32 v186, 0, -1, s[62:63]
v_subrev_u32 v182, 3, v181
v_mfma_f32_16x16x32_bf16 v[88:91], a[108:111], a[16:19], v[88:91]
v_cmp_gt_u32 vcc, 8, v182
v_cmp_gt_i32 s[62:63], -8, v182
v_mfma_f32_16x16x32_bf16 v[92:95], a[16:19], a[112:115], v[92:95]
v_mov_b32 v179, 0x3f803f80
v_cndmask_b32 v167, v180, 0, vcc
v_mfma_f32_16x16x32_bf16 v[96:99], a[116:119], a[16:19], v[96:99]
v_cndmask_b32 v171, v180, 0, s[62:63]
v_cndmask_b32 v187, 0, -1, s[62:63]
s_waitcnt vmcnt(8) lgkmcnt(0)
v_mfma_f32_16x16x32_bf16 v[20:23], a[120:123], a[20:23], v[20:23]
ds_read_b128 a[0:3], v8 offset:30720
s_add_u32 m0, s49, 0
s_add_u32 s55, s48, 0
v_mov_b32 v182, 0xffff
v_mfma_f32_16x16x32_bf16 v[24:27], a[124:127], a[20:23], v[24:27]
buffer_load_dwordx4 v232, s[24:27], s55 offen lds
v_bfi_b32 v172, v182, v184, v185
v_mfma_f32_16x16x32_bf16 v[28:31], a[20:23], a[128:131], v[28:31]
ds_read_b128 a[4:7], v8 offset:31744
v_bfi_b32 v173, v182, v186, v187
v_mfma_f32_16x16x32_bf16 v[32:35], a[132:135], a[20:23], v[32:35]
v_and_b32 v181, 1, v1
v_lshlrev_b32 v181, 4, v181
v_mfma_f32_16x16x32_bf16 v[36:39], a[120:123], a[24:27], v[36:39]
ds_read_b128 a[8:11], v8 offset:32768
s_add_u32 m0, s49, 1024
s_add_u32 s55, s48, 0
v_mov_b32 v182, 0x3f80
v_mfma_f32_16x16x32_bf16 v[40:43], a[124:127], a[24:27], v[40:43]
buffer_load_dwordx4 v233, s[24:27], s55 offen lds
v_lshlrev_b32 v182, v181, v182
v_mfma_f32_16x16x32_bf16 v[44:47], a[24:27], a[128:131], v[44:47]
ds_read_b128 a[12:15], v8 offset:33792
v_and_b32 v181, 0x32, v1
v_mfma_f32_16x16x32_bf16 v[48:51], a[132:135], a[24:27], v[48:51]
v_cmp_eq_u32 vcc, 0x30, v181
v_cmp_eq_u32 s[62:63], 50, v181
v_mfma_f32_16x16x32_bf16 v[52:55], a[120:123], a[28:31], v[52:55]
ds_read_b128 a[16:19], v8 offset:34816
s_add_u32 m0, s49, 2048
s_add_u32 s55, s48, 0
v_mov_b32 v140, 0
v_mfma_f32_16x16x32_bf16 v[56:59], a[124:127], a[28:31], v[56:59]
buffer_load_dwordx4 v234, s[24:27], s55 offen lds
v_cndmask_b32 v174, 0, v182, vcc
v_mfma_f32_16x16x32_bf16 v[60:63], a[28:31], a[128:131], v[60:63]
v_cndmask_b32 v175, 0, v182, s[62:63]
v_mov_b32 v141, 0
v_mfma_f32_16x16x32_bf16 v[64:67], a[132:135], a[28:31], v[64:67]
v_mov_b32 v152, 0
v_mov_b32 v153, 0
v_mfma_f32_16x16x32_bf16 v[68:71], a[120:123], a[32:35], v[68:71]
s_add_u32 m0, s49, 12288
s_add_u32 s55, s48, 81920
v_mov_b32 v122, 0
v_mov_b32 v123, 0
v_mfma_f32_16x16x32_bf16 v[72:75], a[124:127], a[32:35], v[72:75]
buffer_load_dwordx4 v232, s[24:27], s55 offen lds
v_mov_b32 v126, 0
v_mfma_f32_16x16x32_bf16 v[76:79], a[32:35], a[128:131], v[76:79]
v_mov_b32 v127, 0
v_mov_b32 v130, 0
v_mfma_f32_16x16x32_bf16 v[80:83], a[132:135], a[32:35], v[80:83]
v_mov_b32 v131, 0
v_mov_b32 v134, 0
v_mfma_f32_16x16x32_bf16 v[84:87], a[120:123], a[36:39], v[84:87]
v_mov_b32 v135, 0
v_mov_b32 v138, 0
v_mfma_f32_16x16x32_bf16 v[88:91], a[124:127], a[36:39], v[88:91]
v_mov_b32 v139, 0
v_mul_u32_u24 v247, 176, v2
v_mfma_f32_16x16x32_bf16 v[92:95], a[36:39], a[128:131], v[92:95]
v_add_u32 v247, s61, v247
v_lshl_add_u32 v246, v3, 3, v247
v_mfma_f32_16x16x32_bf16 v[96:99], a[132:135], a[36:39], v[96:99]
s_waitcnt vmcnt(8) lgkmcnt(0)
v_mfma_f32_16x16x32_bf16 v[20:23], a[136:139], a[0:3], v[20:23]
ds_read_b128 a[20:23], v9 offset:35840
s_add_u32 m0, s49, 13312
s_add_u32 s55, s48, 81920
v_mfma_f32_16x16x32_bf16 v[24:27], a[140:143], a[0:3], v[24:27]
buffer_load_dwordx4 v233, s[24:27], s55 offen lds
v_mfma_f32_16x16x32_bf16 v[28:31], a[0:3], a[144:147], v[28:31]
ds_read_b128 a[24:27], v9 offset:36864
v_mfma_f32_16x16x32_bf16 v[32:35], a[148:151], a[0:3], v[32:35]
v_mfma_f32_16x16x32_bf16 v[36:39], a[136:139], a[4:7], v[36:39]
ds_read_b128 a[28:31], v9 offset:37888
s_add_u32 m0, s49, 14336
s_add_u32 s55, s48, 81920
v_mfma_f32_16x16x32_bf16 v[40:43], a[140:143], a[4:7], v[40:43]
buffer_load_dwordx4 v234, s[24:27], s55 offen lds
v_mfma_f32_16x16x32_bf16 v[44:47], a[4:7], a[144:147], v[44:47]
ds_read_b128 a[32:35], v9 offset:38912
v_mfma_f32_16x16x32_bf16 v[48:51], a[148:151], a[4:7], v[48:51]
v_mfma_f32_16x16x32_bf16 v[52:55], a[136:139], a[8:11], v[52:55]
ds_read_b128 a[36:39], v9 offset:39936
s_add_u32 m0, s49, 24576
s_add_u32 s55, s48, 163840
v_mfma_f32_16x16x32_bf16 v[56:59], a[140:143], a[8:11], v[56:59]
buffer_load_dwordx4 v232, s[24:27], s55 offen lds
v_mfma_f32_16x16x32_bf16 v[60:63], a[8:11], a[144:147], v[60:63]
v_mfma_f32_16x16x32_bf16 v[64:67], a[148:151], a[8:11], v[64:67]
v_mfma_f32_16x16x32_bf16 v[68:71], a[136:139], a[12:15], v[68:71]
s_add_u32 m0, s49, 25600
s_add_u32 s55, s48, 163840
v_mfma_f32_16x16x32_bf16 v[72:75], a[140:143], a[12:15], v[72:75]
buffer_load_dwordx4 v233, s[24:27], s55 offen lds
v_mfma_f32_16x16x32_bf16 v[76:79], a[12:15], a[144:147], v[76:79]
v_mfma_f32_16x16x32_bf16 v[80:83], a[148:151], a[12:15], v[80:83]
v_mfma_f32_16x16x32_bf16 v[84:87], a[136:139], a[16:19], v[84:87]
v_mfma_f32_16x16x32_bf16 v[88:91], a[140:143], a[16:19], v[88:91]
v_mfma_f32_16x16x32_bf16 v[92:95], a[16:19], a[144:147], v[92:95]
v_mfma_f32_16x16x32_bf16 v[96:99], a[148:151], a[16:19], v[96:99]
s_waitcnt vmcnt(8) lgkmcnt(0)
s_barrier
v_mfma_f32_16x16x32_bf16 v[20:23], a[152:155], a[20:23], v[20:23]
s_add_u32 m0, s49, 26624
s_add_u32 s55, s48, 163840
v_mfma_f32_16x16x32_bf16 v[24:27], a[156:159], a[20:23], v[24:27]
buffer_load_dwordx4 v234, s[24:27], s55 offen lds
v_mfma_f32_16x16x32_bf16 v[28:31], a[20:23], a[160:163], v[28:31]
v_mfma_f32_16x16x32_bf16 v[32:35], a[164:167], a[20:23], v[32:35]
v_mfma_f32_16x16x32_bf16 v[36:39], a[152:155], a[24:27], v[36:39]
s_add_u32 m0, s49, 36864
s_add_u32 s55, s48, 245760
v_mfma_f32_16x16x32_bf16 v[40:43], a[156:159], a[24:27], v[40:43]
buffer_load_dwordx4 v232, s[24:27], s55 offen lds
v_mfma_f32_16x16x32_bf16 v[44:47], a[24:27], a[160:163], v[44:47]
v_mfma_f32_16x16x32_bf16 v[48:51], a[164:167], a[24:27], v[48:51]
v_mfma_f32_16x16x32_bf16 v[52:55], a[152:155], a[28:31], v[52:55]
s_add_u32 m0, s49, 37888
s_add_u32 s55, s48, 245760
v_mfma_f32_16x16x32_bf16 v[56:59], a[156:159], a[28:31], v[56:59]
buffer_load_dwordx4 v233, s[24:27], s55 offen lds
v_mfma_f32_16x16x32_bf16 v[60:63], a[28:31], a[160:163], v[60:63]
v_mfma_f32_16x16x32_bf16 v[64:67], a[164:167], a[28:31], v[64:67]
v_mfma_f32_16x16x32_bf16 v[68:71], a[152:155], a[32:35], v[68:71]
s_add_u32 m0, s49, 38912
s_add_u32 s55, s48, 245760
v_mfma_f32_16x16x32_bf16 v[72:75], a[156:159], a[32:35], v[72:75]
buffer_load_dwordx4 v234, s[24:27], s55 offen lds
v_mfma_f32_16x16x32_bf16 v[76:79], a[32:35], a[160:163], v[76:79]
v_mfma_f32_16x16x32_bf16 v[80:83], a[164:167], a[32:35], v[80:83]
v_mfma_f32_16x16x32_bf16 v[84:87], a[152:155], a[36:39], v[84:87]
v_mfma_f32_16x16x32_bf16 v[88:91], a[156:159], a[36:39], v[88:91]
v_mfma_f32_16x16x32_bf16 v[92:95], a[36:39], a[160:163], v[92:95]
v_mfma_f32_16x16x32_bf16 v[96:99], a[164:167], a[36:39], v[96:99]
v_cvt_pk_bf16_f32 v102, v32, v33
v_cvt_pk_bf16_f32 v103, v34, v35
v_cvt_pk_bf16_f32 v100, v24, v25
v_cvt_pk_bf16_f32 v101, v26, v27
v_cvt_pk_bf16_f32 v120, v20, v21
v_cvt_pk_bf16_f32 v121, v22, v23
v_cvt_pk_bf16_f32 v106, v48, v49
v_cvt_pk_bf16_f32 v107, v50, v51
v_cvt_pk_bf16_f32 v104, v40, v41
v_cvt_pk_bf16_f32 v105, v42, v43
s_add_u32 m0, s49, 49152
s_add_u32 s55, s48, 327680
buffer_load_dwordx4 v232, s[24:27], s55 offen lds
v_cvt_pk_bf16_f32 v124, v36, v37
v_cvt_pk_bf16_f32 v125, v38, v39
v_cvt_pk_bf16_f32 v110, v64, v65
v_cvt_pk_bf16_f32 v111, v66, v67
v_cvt_pk_bf16_f32 v108, v56, v57
v_cvt_pk_bf16_f32 v109, v58, v59
v_cvt_pk_bf16_f32 v128, v52, v53
v_cvt_pk_bf16_f32 v129, v54, v55
v_cvt_pk_bf16_f32 v114, v80, v81
v_cvt_pk_bf16_f32 v115, v82, v83
s_add_u32 m0, s49, 50176
s_add_u32 s55, s48, 327680
buffer_load_dwordx4 v233, s[24:27], s55 offen lds
v_cvt_pk_bf16_f32 v112, v72, v73
v_cvt_pk_bf16_f32 v113, v74, v75
v_cvt_pk_bf16_f32 v132, v68, v69
v_cvt_pk_bf16_f32 v133, v70, v71
v_cvt_pk_bf16_f32 v118, v96, v97
v_cvt_pk_bf16_f32 v119, v98, v99
v_cvt_pk_bf16_f32 v116, v88, v89
v_cvt_pk_bf16_f32 v117, v90, v91
v_cvt_pk_bf16_f32 v136, v84, v85
v_cvt_pk_bf16_f32 v137, v86, v87
s_add_u32 m0, s49, 51200
s_add_u32 s55, s48, 327680
buffer_load_dwordx4 v234, s[24:27], s55 offen lds
v_permlane32_swap_b32 v122, v102
v_permlane32_swap_b32 v123, v103
v_cvt_pk_bf16_f32 v142, v28, v29
v_cvt_pk_bf16_f32 v143, v30, v31
v_permlane32_swap_b32 v126, v106
v_permlane32_swap_b32 v127, v107
v_cvt_pk_bf16_f32 v144, v44, v45
v_cvt_pk_bf16_f32 v145, v46, v47
v_permlane32_swap_b32 v130, v110
v_permlane32_swap_b32 v131, v111
s_add_u32 m0, s49, 61440
s_add_u32 s55, s48, 409600
buffer_load_dwordx4 v232, s[24:27], s55 offen lds
v_cvt_pk_bf16_f32 v146, v60, v61
v_cvt_pk_bf16_f32 v147, v62, v63
v_permlane32_swap_b32 v134, v114
v_permlane32_swap_b32 v135, v115
v_cvt_pk_bf16_f32 v148, v76, v77
v_cvt_pk_bf16_f32 v149, v78, v79
v_permlane32_swap_b32 v138, v118
v_permlane32_swap_b32 v139, v119
v_cvt_pk_bf16_f32 v150, v92, v93
v_cvt_pk_bf16_f32 v151, v94, v95
s_add_u32 m0, s49, 62464
s_add_u32 s55, s48, 409600
buffer_load_dwordx4 v233, s[24:27], s55 offen lds
v_mfma_f32_16x16x32_bf16 v[24:27], v[100:103], v[120:123], v[164:167]
v_mfma_f32_16x16x32_bf16 v[40:43], v[104:107], v[124:127], v[164:167]
v_mfma_f32_16x16x32_bf16 v[36:39], v[100:103], v[124:127], v[168:171]
v_mfma_f32_16x16x32_bf16 v[56:59], v[108:111], v[128:131], v[164:167]
v_mfma_f32_16x16x32_bf16 v[52:55], v[104:107], v[128:131], v[168:171]
v_mfma_f32_16x16x32_bf16 v[72:75], v[112:115], v[132:135], v[164:167]
v_mfma_f32_16x16x32_bf16 v[68:71], v[108:111], v[132:135], v[168:171]
v_mfma_f32_16x16x32_bf16 v[88:91], v[116:119], v[136:139], v[164:167]
v_mfma_f32_16x16x32_bf16 v[84:87], v[112:115], v[136:139], v[168:171]
v_mfma_f32_16x16x16_bf16 v[32:35], v[102:103], v[174:175], 0
s_add_u32 m0, s49, 63488
s_add_u32 s55, s48, 409600
buffer_load_dwordx4 v234, s[24:27], s55 offen lds
v_mfma_f32_16x16x16_bf16 v[48:51], v[106:107], v[174:175], 0
v_mfma_f32_16x16x16_bf16 v[64:67], v[110:111], v[174:175], 0
v_mfma_f32_16x16x16_bf16 v[80:83], v[114:115], v[174:175], 0
v_mfma_f32_16x16x16_bf16 v[96:99], v[118:119], v[174:175], 0
s_mov_b32 s62, 1051011932
v_max3_f32 v180, v24, v25, v26
v_max_f32 v180, v180, v27
v_mov_b32 v181, v180
v_max_f32 v40, v40, v36
v_max_f32 v41, v41, v37
s_add_u32 m0, s49, 110592
s_add_u32 s55, s48, 737280
buffer_load_dwordx4 v232, s[24:27], s55 offen lds
v_max_f32 v42, v42, v38
v_max_f32 v43, v43, v39
v_max3_f32 v182, v40, v41, v42
v_max_f32 v182, v182, v43
v_mov_b32 v183, v182
v_max_f32 v56, v56, v52
v_max_f32 v57, v57, v53
v_max_f32 v58, v58, v54
v_max_f32 v59, v59, v55
v_max3_f32 v184, v56, v57, v58
s_add_u32 m0, s49, 111616
s_add_u32 s55, s48, 737280
buffer_load_dwordx4 v233, s[24:27], s55 offen lds
v_max_f32 v184, v184, v59
v_mov_b32 v185, v184
v_max_f32 v72, v72, v68
v_max_f32 v73, v73, v69
v_max_f32 v74, v74, v70
v_max_f32 v75, v75, v71
v_max3_f32 v186, v72, v73, v74
v_max_f32 v186, v186, v75
v_mov_b32 v187, v186
v_max_f32 v88, v88, v84
s_add_u32 m0, s49, 112640
s_add_u32 s55, s48, 737280
buffer_load_dwordx4 v234, s[24:27], s55 offen lds
v_max_f32 v89, v89, v85
v_max_f32 v90, v90, v86
v_max_f32 v91, v91, v87
v_max3_f32 v188, v88, v89, v90
v_max_f32 v188, v188, v91
v_mov_b32 v189, v188
v_permlane32_swap_b32 v180, v181
v_permlane32_swap_b32 v182, v183
v_permlane32_swap_b32 v184, v185
v_permlane32_swap_b32 v186, v187
s_add_u32 m0, s49, 73728
s_add_u32 s55, s48, 491520
buffer_load_dwordx4 v232, s[24:27], s55 offen lds
v_permlane32_swap_b32 v188, v189
v_max_f32 v180, v180, v181
v_mov_b32 v181, v180
v_max_f32 v182, v182, v183
v_mov_b32 v183, v182
v_max_f32 v184, v184, v185
v_mov_b32 v185, v184
v_max_f32 v186, v186, v187
v_mov_b32 v187, v186
v_max_f32 v188, v188, v189
s_add_u32 m0, s49, 74752
s_add_u32 s55, s48, 491520
buffer_load_dwordx4 v233, s[24:27], s55 offen lds
v_mov_b32 v189, v188
v_permlane16_swap_b32 v180, v181
v_permlane16_swap_b32 v182, v183
v_permlane16_swap_b32 v184, v185
v_permlane16_swap_b32 v186, v187
v_permlane16_swap_b32 v188, v189
v_max_f32 v180, v180, v181
v_mul_f32 v181, s62, v180
v_mov_b32 v180, s62
v_max_f32 v182, v182, v183
s_add_u32 m0, s49, 75776
s_add_u32 s55, s48, 491520
buffer_load_dwordx4 v234, s[24:27], s55 offen lds
v_mul_f32 v183, s62, v182
v_mov_b32 v182, s62
v_max_f32 v184, v184, v185
v_mul_f32 v185, s62, v184
v_mov_b32 v184, s62
v_max_f32 v186, v186, v187
v_mul_f32 v187, s62, v186
v_mov_b32 v186, s62
v_max_f32 v188, v188, v189
v_mul_f32 v189, s62, v188
s_add_u32 m0, s49, 86016
s_add_u32 s55, s48, 573440
buffer_load_dwordx4 v232, s[24:27], s55 offen lds
v_mov_b32 v188, s62
v_cvt_pk_bf16_f32 v154, v32, v33
v_cvt_pk_bf16_f32 v155, v34, v35
v_cvt_pk_bf16_f32 v156, v48, v49
v_cvt_pk_bf16_f32 v157, v50, v51
v_cvt_pk_bf16_f32 v158, v64, v65
v_cvt_pk_bf16_f32 v159, v66, v67
v_cvt_pk_bf16_f32 v160, v80, v81
v_cvt_pk_bf16_f32 v161, v82, v83
v_cvt_pk_bf16_f32 v162, v96, v97
s_add_u32 m0, s49, 87040
s_add_u32 s55, s48, 573440
buffer_load_dwordx4 v233, s[24:27], s55 offen lds
v_cvt_pk_bf16_f32 v163, v98, v99
v_pk_fma_f32 v[24:25], v[24:25], v[180:181], v[180:181] op_sel:[0,0,1] op_sel_hi:[1,0,1] neg_lo:[0,0,1] neg_hi:[0,0,1]
v_pk_fma_f32 v[26:27], v[26:27], v[180:181], v[180:181] op_sel:[0,0,1] op_sel_hi:[1,0,1] neg_lo:[0,0,1] neg_hi:[0,0,1]
v_pk_fma_f32 v[40:41], v[40:41], v[182:183], v[182:183] op_sel:[0,0,1] op_sel_hi:[1,0,1] neg_lo:[0,0,1] neg_hi:[0,0,1]
v_pk_fma_f32 v[42:43], v[42:43], v[182:183], v[182:183] op_sel:[0,0,1] op_sel_hi:[1,0,1] neg_lo:[0,0,1] neg_hi:[0,0,1]
v_pk_fma_f32 v[56:57], v[56:57], v[184:185], v[184:185] op_sel:[0,0,1] op_sel_hi:[1,0,1] neg_lo:[0,0,1] neg_hi:[0,0,1]
v_pk_fma_f32 v[58:59], v[58:59], v[184:185], v[184:185] op_sel:[0,0,1] op_sel_hi:[1,0,1] neg_lo:[0,0,1] neg_hi:[0,0,1]
v_pk_fma_f32 v[72:73], v[72:73], v[186:187], v[186:187] op_sel:[0,0,1] op_sel_hi:[1,0,1] neg_lo:[0,0,1] neg_hi:[0,0,1]
v_pk_fma_f32 v[74:75], v[74:75], v[186:187], v[186:187] op_sel:[0,0,1] op_sel_hi:[1,0,1] neg_lo:[0,0,1] neg_hi:[0,0,1]
v_pk_fma_f32 v[88:89], v[88:89], v[188:189], v[188:189] op_sel:[0,0,1] op_sel_hi:[1,0,1] neg_lo:[0,0,1] neg_hi:[0,0,1]
s_add_u32 m0, s49, 88064
s_add_u32 s55, s48, 573440
buffer_load_dwordx4 v234, s[24:27], s55 offen lds
v_pk_fma_f32 v[90:91], v[90:91], v[188:189], v[188:189] op_sel:[0,0,1] op_sel_hi:[1,0,1] neg_lo:[0,0,1] neg_hi:[0,0,1]
v_exp_f32 v24, v24
v_exp_f32 v25, v25
v_exp_f32 v26, v26
v_exp_f32 v27, v27
v_exp_f32 v40, v40
v_exp_f32 v41, v41
v_exp_f32 v42, v42
v_exp_f32 v43, v43
v_exp_f32 v56, v56
s_add_u32 m0, s49, 98304
s_add_u32 s55, s48, 655360
buffer_load_dwordx4 v232, s[24:27], s55 offen lds
v_exp_f32 v57, v57
v_exp_f32 v58, v58
v_exp_f32 v59, v59
v_exp_f32 v72, v72
v_exp_f32 v73, v73
v_exp_f32 v74, v74
v_exp_f32 v75, v75
v_exp_f32 v88, v88
v_exp_f32 v89, v89
v_exp_f32 v90, v90
s_add_u32 m0, s49, 99328
s_add_u32 s55, s48, 655360
buffer_load_dwordx4 v233, s[24:27], s55 offen lds
v_exp_f32 v91, v91
v_cvt_pk_bf16_f32 v30, v24, v25
v_cvt_pk_bf16_f32 v31, v26, v27
v_and_b32 v28, v172, v30
v_and_b32 v29, v173, v31
v_xor_b32 v30, v28, v30
v_xor_b32 v31, v29, v31
v_cvt_pk_bf16_f32 v46, v40, v41
v_cvt_pk_bf16_f32 v47, v42, v43
v_and_b32 v44, v172, v46
s_add_u32 m0, s49, 100352
s_add_u32 s55, s48, 655360
buffer_load_dwordx4 v234, s[24:27], s55 offen lds
v_and_b32 v45, v173, v47
v_xor_b32 v46, v44, v46
v_xor_b32 v47, v45, v47
v_cvt_pk_bf16_f32 v62, v56, v57
v_cvt_pk_bf16_f32 v63, v58, v59
v_and_b32 v60, v172, v62
v_and_b32 v61, v173, v63
v_xor_b32 v62, v60, v62
v_xor_b32 v63, v61, v63
v_cvt_pk_bf16_f32 v78, v72, v73
buffer_load_dwordx4 v[240:243], v238, s[4:7], s51 offen sc1
v_cvt_pk_bf16_f32 v79, v74, v75
v_and_b32 v76, v172, v78
v_and_b32 v77, v173, v79
v_xor_b32 v78, v76, v78
v_xor_b32 v79, v77, v79
v_cvt_pk_bf16_f32 v94, v88, v89
v_cvt_pk_bf16_f32 v95, v90, v91
v_and_b32 v92, v172, v94
v_and_b32 v93, v173, v95
v_xor_b32 v94, v92, v94
buffer_load_dwordx2 v[244:245], v239, s[28:31], s52 offen
v_xor_b32 v95, v93, v95
v_mfma_f32_16x16x32_bf16 v[32:35], v[176:179], v[28:31], 0
v_mfma_f32_16x16x32_bf16 v[48:51], v[176:179], v[44:47], 0
v_mfma_f32_16x16x32_bf16 v[64:67], v[176:179], v[60:63], 0
v_mfma_f32_16x16x32_bf16 v[80:83], v[176:179], v[76:79], 0
v_mfma_f32_16x16x32_bf16 v[96:99], v[176:179], v[92:95], 0
v_mfma_f32_16x16x32_bf16 v[20:23], v[140:143], v[28:31], 0
v_mfma_f32_16x16x32_bf16 v[24:27], v[152:155], v[28:31], 0
s_nop 1
v_rcp_f32 v32, v32
v_mfma_f32_16x16x32_bf16 v[36:39], v[142:145], v[44:47], 0
s_add_u32 m0, s49, 142080
s_nop 0
buffer_load_dwordx4 v235, s[8:11], s50 offen lds
v_mfma_f32_16x16x32_bf16 v[40:43], v[154:157], v[44:47], 0
v_rcp_f32 v48, v48
v_mfma_f32_16x16x32_bf16 v[52:55], v[144:147], v[60:63], 0
v_mfma_f32_16x16x32_bf16 v[56:59], v[156:159], v[60:63], 0
v_rcp_f32 v64, v64
v_mfma_f32_16x16x32_bf16 v[68:71], v[146:149], v[76:79], 0
v_mfma_f32_16x16x32_bf16 v[72:75], v[158:161], v[76:79], 0
v_rcp_f32 v80, v80
v_mfma_f32_16x16x32_bf16 v[84:87], v[148:151], v[92:95], 0
v_mfma_f32_16x16x32_bf16 v[88:91], v[160:163], v[92:95], 0
s_add_u32 m0, s49, 143104
s_nop 0
buffer_load_dwordx4 v236, s[8:11], s50 offen lds
v_rcp_f32 v96, v96
v_pk_mul_f32 v[20:21], v[20:21], v[32:33] op_sel_hi:[1,0]
v_pk_mul_f32 v[22:23], v[22:23], v[32:33] op_sel_hi:[1,0]
v_cvt_pk_bf16_f32 v20, v20, v21
v_cvt_pk_bf16_f32 v21, v22, v23
ds_write_b64 v246, v[20:21] offset:0
v_pk_mul_f32 v[24:25], v[24:25], v[32:33] op_sel_hi:[1,0]
v_pk_mul_f32 v[26:27], v[26:27], v[32:33] op_sel_hi:[1,0]
v_cvt_pk_bf16_f32 v24, v24, v25
v_cvt_pk_bf16_f32 v25, v26, v27
s_add_u32 m0, s49, 144128
s_nop 0
buffer_load_dwordx4 v237, s[8:11], s50 offen lds
ds_write_b64 v247, v[24:25] offset:32
v_pk_mul_f32 v[36:37], v[36:37], v[48:49] op_sel_hi:[1,0]
v_pk_mul_f32 v[38:39], v[38:39], v[48:49] op_sel_hi:[1,0]
v_cvt_pk_bf16_f32 v36, v36, v37
v_cvt_pk_bf16_f32 v37, v38, v39
ds_write_b64 v246, v[36:37] offset:2816
v_pk_mul_f32 v[40:41], v[40:41], v[48:49] op_sel_hi:[1,0]
v_pk_mul_f32 v[42:43], v[42:43], v[48:49] op_sel_hi:[1,0]
v_cvt_pk_bf16_f32 v40, v40, v41
v_cvt_pk_bf16_f32 v41, v42, v43
ds_write_b64 v247, v[40:41] offset:2848
v_pk_mul_f32 v[52:53], v[52:53], v[64:65] op_sel_hi:[1,0]
v_pk_mul_f32 v[54:55], v[54:55], v[64:65] op_sel_hi:[1,0]
v_cvt_pk_bf16_f32 v52, v52, v53
v_cvt_pk_bf16_f32 v53, v54, v55
ds_write_b64 v246, v[52:53] offset:5632
v_pk_mul_f32 v[56:57], v[56:57], v[64:65] op_sel_hi:[1,0]
v_pk_mul_f32 v[58:59], v[58:59], v[64:65] op_sel_hi:[1,0]
v_cvt_pk_bf16_f32 v56, v56, v57
v_cvt_pk_bf16_f32 v57, v58, v59
ds_write_b64 v247, v[56:57] offset:5664
v_pk_mul_f32 v[68:69], v[68:69], v[80:81] op_sel_hi:[1,0]
v_pk_mul_f32 v[70:71], v[70:71], v[80:81] op_sel_hi:[1,0]
v_cvt_pk_bf16_f32 v68, v68, v69
v_cvt_pk_bf16_f32 v69, v70, v71
ds_write_b64 v246, v[68:69] offset:8448
v_pk_mul_f32 v[72:73], v[72:73], v[80:81] op_sel_hi:[1,0]
v_pk_mul_f32 v[74:75], v[74:75], v[80:81] op_sel_hi:[1,0]
v_cvt_pk_bf16_f32 v72, v72, v73
v_cvt_pk_bf16_f32 v73, v74, v75
ds_write_b64 v247, v[72:73] offset:8480
v_pk_mul_f32 v[84:85], v[84:85], v[96:97] op_sel_hi:[1,0]
v_pk_mul_f32 v[86:87], v[86:87], v[96:97] op_sel_hi:[1,0]
v_cvt_pk_bf16_f32 v84, v84, v85
v_cvt_pk_bf16_f32 v85, v86, v87
ds_write_b64 v246, v[84:85] offset:11264
v_pk_mul_f32 v[88:89], v[88:89], v[96:97] op_sel_hi:[1,0]
v_pk_mul_f32 v[90:91], v[90:91], v[96:97] op_sel_hi:[1,0]
v_cvt_pk_bf16_f32 v88, v88, v89
v_cvt_pk_bf16_f32 v89, v90, v91
ds_write_b64 v247, v[88:89] offset:11296
v_add_u32 v15, 128000, v15
v_add_u32 v16, 128000, v16
v_add_u32 v17, 128000, v17
v_add_u32 v18, 128000, v18
s_waitcnt lgkmcnt(0)
s_barrier
ds_read_b128 v[20:23], v15
ds_read_b128 v[24:27], v16
ds_read_b128 v[28:31], v17
ds_read_b128 v[32:35], v18
s_waitcnt lgkmcnt(3)
buffer_store_dwordx4 v[20:23], v11, s[4:7], s46 offen sc1
s_waitcnt lgkmcnt(2)
buffer_store_dwordx4 v[24:27], v12, s[4:7], s46 offen sc1
s_waitcnt lgkmcnt(1)
buffer_store_dwordx4 v[28:31], v13, s[4:7], s46 offen sc1
s_waitcnt lgkmcnt(0)
buffer_store_dwordx4 v[32:35], v14, s[4:7], s46 offen sc1
s_mov_b32 s55, 0x05040100
s_waitcnt vmcnt(4)
v_perm_b32 v228, v241, v240, s55
v_perm_b32 v229, v243, v242, s55
v_xor_b32 v228, s40, v228
v_xor_b32 v229, s40, v229
v_or_b32 v228, v228, v229
v_and_b32 v228, v228, v250
v_cmp_ne_u32 vcc, 0, v228
s_cbranch_vccnz L_mv_retry
L_mv_ok:
v_and_b32 v240, 0xffff0000, v240
v_and_b32 v241, 0xffff0000, v241
v_and_b32 v242, 0xffff0000, v242
v_and_b32 v243, 0xffff0000, v243
v_lshlrev_b32 v40, 16, v244
v_and_b32 v41, 0xffff0000, v244
v_lshlrev_b32 v42, 16, v245
v_and_b32 v43, 0xffff0000, v245
s_mul_i32 s55, s3, 384
s_add_u32 s55, s55, 155392
v_lshl_add_u32 v228, v1, 4, s55
v_pk_mul_f32 v[40:41], v[40:41], v[240:241]
v_pk_mul_f32 v[42:43], v[42:43], v[242:243]
s_mov_b64 exec, 0xffffff
ds_write_b128 v228, v[240:243]
ds_write_b128 v228, v[40:43] offset:1536
s_mov_b64 exec, -1
v_bfe_u32 v228, v1, 2, 2
v_lshl_add_u32 v228, v3, 3, v228
v_mul_u32_u24 v228, 192, v228
v_and_b32 v229, 3, v1
v_lshl_add_u32 v228, v229, 3, v228
v_and_b32 v229, 1, v3
v_lshl_add_u32 v4, v229, 5, v228
v_xor_b32 v229, 1, v229
v_lshl_add_u32 v5, v229, 5, v228
v_add_u32 v6, 61440, v4
v_add_u32 v7, 61440, v5
v_lshlrev_b32 v8, 4, v1
v_lshlrev_b32 v9, 4, v3
v_add_u32 v9, 155392, v9
v_mul_u32_u24 v10, 192, v2
v_lshl_add_u32 v10, v3, 3, v10
s_add_u32 s55, s49, 142080
v_add_u32 v10, s55, v10
v_add_u32 v11, s55, v8
v_lshlrev_b32 v12, 2, v1
s_mul_i32 s56, s53, 20480
s_add_u32 s56, s56, 4194304
s_add_u32 s57, s56, 4096
s_add_u32 s58, s56, 8192
s_add_u32 s59, s56, 12288
s_add_u32 s60, s56, 16384
s_waitcnt lgkmcnt(0)
s_barrier
ds_read_b64 v[20:21], v10 offset:0
ds_read_b64 v[22:23], v10 offset:32
ds_read_b64 v[24:25], v10 offset:64
ds_read_b64 v[26:27], v10 offset:96
ds_read_b64 v[28:29], v10 offset:128
ds_read_b64 v[30:31], v10 offset:160
ds_read_b128 v[204:207], v9 offset:2304
ds_read_b128 v[208:211], v9 offset:2368
ds_read_b128 v[212:215], v9 offset:2432
ds_read_b128 v[216:219], v9 offset:2496
ds_read_b128 v[220:223], v9 offset:2560
ds_read_b128 v[224:227], v9 offset:2624
ds_read_b128 v[180:183], v9 offset:0
ds_read_b128 v[184:187], v9 offset:64
ds_read_b128 v[188:191], v9 offset:128
ds_read_b128 v[192:195], v9 offset:192
ds_read_b128 v[196:199], v9 offset:256
ds_read_b128 v[200:203], v9 offset:320
ds_read_b64_tr_b16 a[0:1], v4 offset:0
ds_read_b64_tr_b16 a[2:3], v4 offset:768
ds_read_b64_tr_b16 a[4:5], v5 offset:0
ds_read_b64_tr_b16 a[6:7], v5 offset:768
ds_read_b64_tr_b16 a[8:9], v4 offset:64
ds_read_b64_tr_b16 a[10:11], v4 offset:832
ds_read_b64_tr_b16 a[12:13], v4 offset:6144
ds_read_b64_tr_b16 a[14:15], v4 offset:6912
ds_read_b64_tr_b16 a[16:17], v5 offset:6144
ds_read_b64_tr_b16 a[18:19], v5 offset:6912
ds_read_b64_tr_b16 a[20:21], v4 offset:6208
ds_read_b64_tr_b16 a[22:23], v4 offset:6976
ds_read_b64_tr_b16 a[24:25], v4 offset:12288
ds_read_b64_tr_b16 a[26:27], v4 offset:13056
ds_read_b64_tr_b16 a[28:29], v5 offset:12288
ds_read_b64_tr_b16 a[30:31], v5 offset:13056
s_waitcnt lgkmcnt(15)
v_lshlrev_b32 v68, 16, v20
v_and_b32 v69, 0xffff0000, v20
v_lshlrev_b32 v70, 16, v21
v_and_b32 v71, 0xffff0000, v21
v_lshlrev_b32 v72, 16, v22
v_and_b32 v73, 0xffff0000, v22
v_lshlrev_b32 v74, 16, v23
v_and_b32 v75, 0xffff0000, v23
v_lshlrev_b32 v76, 16, v24
v_and_b32 v77, 0xffff0000, v24
v_lshlrev_b32 v78, 16, v25
v_and_b32 v79, 0xffff0000, v25
v_lshlrev_b32 v80, 16, v26
v_and_b32 v81, 0xffff0000, v26
v_lshlrev_b32 v82, 16, v27
v_and_b32 v83, 0xffff0000, v27
v_lshlrev_b32 v84, 16, v28
v_and_b32 v85, 0xffff0000, v28
v_lshlrev_b32 v86, 16, v29
v_and_b32 v87, 0xffff0000, v29
v_lshlrev_b32 v88, 16, v30
v_and_b32 v89, 0xffff0000, v30
v_lshlrev_b32 v90, 16, v31
v_and_b32 v91, 0xffff0000, v31
v_pk_add_f32 v[94:95], v[204:205], v[206:207]
v_pk_add_f32 v[94:95], v[94:95], v[208:209]
v_pk_add_f32 v[94:95], v[94:95], v[210:211]
v_pk_add_f32 v[94:95], v[94:95], v[212:213]
v_pk_add_f32 v[94:95], v[94:95], v[214:215]
v_pk_add_f32 v[94:95], v[94:95], v[216:217]
v_pk_add_f32 v[94:95], v[94:95], v[218:219]
v_pk_add_f32 v[94:95], v[94:95], v[220:221]
v_pk_add_f32 v[94:95], v[94:95], v[222:223]
v_pk_add_f32 v[94:95], v[94:95], v[224:225]
v_pk_add_f32 v[94:95], v[94:95], v[226:227]
v_add_f32 v95, v94, v95
ds_read_b64_tr_b16 a[32:33], v4 offset:12352
ds_read_b64_tr_b16 a[34:35], v4 offset:13120
ds_read_b64_tr_b16 a[36:37], v4 offset:18432
ds_read_b64_tr_b16 a[38:39], v4 offset:19200
ds_read_b64_tr_b16 a[40:41], v5 offset:18432
ds_read_b64_tr_b16 a[42:43], v5 offset:19200
buffer_load_dwordx4 v[100:103], v8, s[4:7], s56 offen offset:0 sc1
buffer_load_dwordx4 v[104:107], v8, s[4:7], s56 offen offset:1024 sc1
buffer_load_dwordx4 v[108:111], v8, s[4:7], s56 offen offset:2048 sc1
buffer_load_dwordx4 v[112:115], v8, s[4:7], s56 offen offset:3072 sc1
buffer_load_dwordx4 v[116:119], v8, s[4:7], s57 offen offset:0 sc1
buffer_load_dwordx4 v[120:123], v8, s[4:7], s57 offen offset:1024 sc1
buffer_load_dwordx4 v[124:127], v8, s[4:7], s57 offen offset:2048 sc1
buffer_load_dwordx4 v[128:131], v8, s[4:7], s57 offen offset:3072 sc1
buffer_load_dwordx4 v[132:135], v8, s[4:7], s58 offen offset:0 sc1
buffer_load_dwordx4 v[136:139], v8, s[4:7], s58 offen offset:1024 sc1
buffer_load_dwordx4 v[140:143], v8, s[4:7], s58 offen offset:2048 sc1
buffer_load_dwordx4 v[144:147], v8, s[4:7], s58 offen offset:3072 sc1
buffer_load_dwordx4 v[148:151], v8, s[4:7], s59 offen offset:0 sc1
buffer_load_dwordx4 v[152:155], v8, s[4:7], s59 offen offset:1024 sc1
buffer_load_dwordx4 v[156:159], v8, s[4:7], s59 offen offset:2048 sc1
buffer_load_dwordx4 v[160:163], v8, s[4:7], s59 offen offset:3072 sc1
buffer_load_dwordx4 v[164:167], v8, s[4:7], s60 offen offset:0 sc1
buffer_load_dwordx4 v[168:171], v8, s[4:7], s60 offen offset:1024 sc1
buffer_load_dwordx4 v[172:175], v8, s[4:7], s60 offen offset:2048 sc1
buffer_load_dwordx4 v[176:179], v8, s[4:7], s60 offen offset:3072 sc1
ds_read_b64_tr_b16 a[44:45], v4 offset:18496
ds_read_b64_tr_b16 a[46:47], v4 offset:19264
ds_read_b64_tr_b16 a[48:49], v4 offset:24576
ds_read_b64_tr_b16 a[50:51], v4 offset:25344
ds_read_b64_tr_b16 a[52:53], v5 offset:24576
ds_read_b64_tr_b16 a[54:55], v5 offset:25344
ds_read_b64_tr_b16 a[56:57], v4 offset:24640
ds_read_b64_tr_b16 a[58:59], v4 offset:25408
ds_read_b64_tr_b16 a[60:61], v4 offset:30720
ds_read_b64_tr_b16 a[62:63], v4 offset:31488
ds_read_b64_tr_b16 a[64:65], v5 offset:30720
ds_read_b64_tr_b16 a[66:67], v5 offset:31488
ds_read_b64_tr_b16 a[68:69], v4 offset:30784
ds_read_b64_tr_b16 a[70:71], v4 offset:31552
ds_read_b64_tr_b16 a[72:73], v4 offset:36864
ds_read_b64_tr_b16 a[74:75], v4 offset:37632
ds_read_b64_tr_b16 a[76:77], v5 offset:36864
ds_read_b64_tr_b16 a[78:79], v5 offset:37632
ds_read_b64_tr_b16 a[80:81], v4 offset:36928
ds_read_b64_tr_b16 a[82:83], v4 offset:37696
ds_read_b64_tr_b16 a[84:85], v4 offset:43008
ds_read_b64_tr_b16 a[86:87], v4 offset:43776
ds_read_b64_tr_b16 a[88:89], v5 offset:43008
ds_read_b64_tr_b16 a[90:91], v5 offset:43776
ds_read_b64_tr_b16 a[92:93], v4 offset:43072
ds_read_b64_tr_b16 a[94:95], v4 offset:43840
ds_read_b64_tr_b16 a[96:97], v4 offset:49152
ds_read_b64_tr_b16 a[98:99], v4 offset:49920
ds_read_b64_tr_b16 a[100:101], v5 offset:49152
ds_read_b64_tr_b16 a[102:103], v5 offset:49920
ds_read_b64_tr_b16 a[104:105], v4 offset:49216
ds_read_b64_tr_b16 a[106:107], v4 offset:49984
ds_read_b64_tr_b16 a[108:109], v4 offset:55296
ds_read_b64_tr_b16 a[110:111], v4 offset:56064
ds_read_b64_tr_b16 a[112:113], v5 offset:55296
ds_read_b64_tr_b16 a[114:115], v5 offset:56064
ds_read_b64_tr_b16 a[116:117], v4 offset:55360
ds_read_b64_tr_b16 a[118:119], v4 offset:56128
ds_read_b64_tr_b16 a[120:121], v6 offset:0
ds_read_b64_tr_b16 a[122:123], v6 offset:768
ds_read_b64_tr_b16 a[124:125], v7 offset:0
ds_read_b64_tr_b16 a[126:127], v7 offset:768
ds_read_b64_tr_b16 a[128:129], v6 offset:64
ds_read_b64_tr_b16 a[130:131], v6 offset:832
ds_read_b64_tr_b16 a[132:133], v6 offset:6144
ds_read_b64_tr_b16 a[134:135], v6 offset:6912
ds_read_b64_tr_b16 a[136:137], v7 offset:6144
ds_read_b64_tr_b16 a[138:139], v7 offset:6912
ds_read_b64_tr_b16 a[140:141], v6 offset:6208
ds_read_b64_tr_b16 a[142:143], v6 offset:6976
ds_read_b64_tr_b16 a[144:145], v6 offset:12288
ds_read_b64_tr_b16 a[146:147], v6 offset:13056
ds_read_b64_tr_b16 a[148:149], v7 offset:12288
ds_read_b64_tr_b16 a[150:151], v7 offset:13056
ds_read_b64_tr_b16 a[152:153], v6 offset:12352
ds_read_b64_tr_b16 a[154:155], v6 offset:13120
ds_read_b64_tr_b16 a[156:157], v6 offset:18432
ds_read_b64_tr_b16 a[158:159], v6 offset:19200
ds_read_b64_tr_b16 a[160:161], v7 offset:18432
ds_read_b64_tr_b16 a[162:163], v7 offset:19200
ds_read_b64_tr_b16 a[164:165], v6 offset:18496
ds_read_b64_tr_b16 a[166:167], v6 offset:19264
ds_read_b64_tr_b16 a[168:169], v6 offset:24576
ds_read_b64_tr_b16 a[170:171], v6 offset:25344
ds_read_b64_tr_b16 a[172:173], v7 offset:24576
ds_read_b64_tr_b16 a[174:175], v7 offset:25344
ds_read_b64_tr_b16 a[176:177], v6 offset:24640
ds_read_b64_tr_b16 a[178:179], v6 offset:25408
ds_read_b64_tr_b16 a[180:181], v6 offset:30720
ds_read_b64_tr_b16 a[182:183], v6 offset:31488
ds_read_b64_tr_b16 a[184:185], v7 offset:30720
ds_read_b64_tr_b16 a[186:187], v7 offset:31488
ds_read_b64_tr_b16 a[188:189], v6 offset:30784
ds_read_b64_tr_b16 a[190:191], v6 offset:31552
ds_read_b64_tr_b16 a[192:193], v6 offset:36864
ds_read_b64_tr_b16 a[194:195], v6 offset:37632
ds_read_b64_tr_b16 a[196:197], v7 offset:36864
ds_read_b64_tr_b16 a[198:199], v7 offset:37632
ds_read_b64_tr_b16 a[200:201], v6 offset:36928
ds_read_b64_tr_b16 a[202:203], v6 offset:37696
ds_read_b64_tr_b16 a[204:205], v6 offset:43008
ds_read_b64_tr_b16 a[206:207], v6 offset:43776
ds_read_b64_tr_b16 a[208:209], v7 offset:43008
ds_read_b64_tr_b16 a[210:211], v7 offset:43776
ds_read_b64_tr_b16 a[212:213], v6 offset:43072
ds_read_b64_tr_b16 a[214:215], v6 offset:43840
ds_read_b64_tr_b16 a[216:217], v6 offset:49152
ds_read_b64_tr_b16 a[218:219], v6 offset:49920
ds_read_b64_tr_b16 a[220:221], v7 offset:49152
ds_read_b64_tr_b16 a[222:223], v7 offset:49920
ds_read_b64_tr_b16 a[224:225], v6 offset:49216
ds_read_b64_tr_b16 a[226:227], v6 offset:49984
ds_read_b64_tr_b16 a[228:229], v6 offset:55296
ds_read_b64_tr_b16 a[230:231], v6 offset:56064
ds_read_b64_tr_b16 a[232:233], v7 offset:55296
ds_read_b64_tr_b16 a[234:235], v7 offset:56064
ds_read_b64_tr_b16 a[236:237], v6 offset:55360
ds_read_b64_tr_b16 a[238:239], v6 offset:56128
ds_read_b64_tr_b16 v[44:45], v5 offset:64
ds_read_b64_tr_b16 v[46:47], v5 offset:832
ds_read_b64_tr_b16 v[48:49], v4 offset:128
ds_read_b64_tr_b16 v[50:51], v4 offset:896
ds_read_b64_tr_b16 v[52:53], v5 offset:128
ds_read_b64_tr_b16 v[54:55], v5 offset:896
s_waitcnt vmcnt(15)
v_max3_u32 v92, v100, v101, v102
v_max3_u32 v93, v103, v104, v105
v_max3_u32 v92, v92, v106, v107
v_max3_u32 v93, v93, v108, v109
v_max3_u32 v92, v92, v110, v111
v_max3_u32 v93, v93, v112, v113
v_max3_u32 v92, v92, v114, v115
v_max3_u32 v93, v93, v116, v117
v_max3_u32 v92, v92, v118, v119
v_max_u32 v92, v92, v93
v_cmp_eq_u32 vcc, -1, v92
s_cbranch_vccnz L_o0_retry
L_o0_ok:
s_waitcnt lgkmcnt(6)
v_mfma_f32_16x16x32_bf16 v[20:23], a[0:3], v[100:103], 0
ds_read_b64_tr_b16 v[56:57], v5 offset:6208
v_mfma_f32_16x16x32_bf16 v[24:27], a[4:7], v[100:103], 0
ds_read_b64_tr_b16 v[58:59], v5 offset:6976
v_mfma_f32_16x16x32_bf16 v[28:31], a[8:11], v[100:103], 0
ds_read_b64_tr_b16 v[60:61], v4 offset:6272
s_waitcnt lgkmcnt(3)
v_mfma_f32_16x16x32_bf16 v[32:35], v[44:47], v[100:103], 0
ds_read_b64_tr_b16 v[62:63], v4 offset:7040
v_mfma_f32_16x16x32_bf16 v[36:39], v[48:51], v[100:103], 0
ds_read_b64_tr_b16 v[64:65], v5 offset:6272
v_mfma_f32_16x16x32_bf16 v[40:43], v[52:55], v[100:103], 0
ds_read_b64_tr_b16 v[66:67], v5 offset:7040
v_mfma_f32_16x16x32_bf16 v[20:23], a[12:15], v[104:107], v[20:23]
ds_read_b64_tr_b16 v[44:45], v5 offset:12352
v_mfma_f32_16x16x32_bf16 v[24:27], a[16:19], v[104:107], v[24:27]
ds_read_b64_tr_b16 v[46:47], v5 offset:13120
v_mfma_f32_16x16x32_bf16 v[28:31], a[20:23], v[104:107], v[28:31]
ds_read_b64_tr_b16 v[48:49], v4 offset:12416
s_waitcnt lgkmcnt(3)
v_mfma_f32_16x16x32_bf16 v[32:35], v[56:59], v[104:107], v[32:35]
ds_read_b64_tr_b16 v[50:51], v4 offset:13184
v_mfma_f32_16x16x32_bf16 v[36:39], v[60:63], v[104:107], v[36:39]
ds_read_b64_tr_b16 v[52:53], v5 offset:12416
v_mfma_f32_16x16x32_bf16 v[40:43], v[64:67], v[104:107], v[40:43]
ds_read_b64_tr_b16 v[54:55], v5 offset:13184
v_mfma_f32_16x16x32_bf16 v[20:23], a[24:27], v[108:111], v[20:23]
ds_read_b64_tr_b16 v[56:57], v5 offset:18496
v_mfma_f32_16x16x32_bf16 v[24:27], a[28:31], v[108:111], v[24:27]
ds_read_b64_tr_b16 v[58:59], v5 offset:19264
v_mfma_f32_16x16x32_bf16 v[28:31], a[32:35], v[108:111], v[28:31]
ds_read_b64_tr_b16 v[60:61], v4 offset:18560
s_waitcnt lgkmcnt(3)
v_mfma_f32_16x16x32_bf16 v[32:35], v[44:47], v[108:111], v[32:35]
ds_read_b64_tr_b16 v[62:63], v4 offset:19328
v_mfma_f32_16x16x32_bf16 v[36:39], v[48:51], v[108:111], v[36:39]
ds_read_b64_tr_b16 v[64:65], v5 offset:18560
v_mfma_f32_16x16x32_bf16 v[40:43], v[52:55], v[108:111], v[40:43]
ds_read_b64_tr_b16 v[66:67], v5 offset:19328
v_mfma_f32_16x16x32_bf16 v[20:23], a[36:39], v[112:115], v[20:23]
ds_read_b64_tr_b16 v[44:45], v5 offset:24640
v_mfma_f32_16x16x32_bf16 v[24:27], a[40:43], v[112:115], v[24:27]
ds_read_b64_tr_b16 v[46:47], v5 offset:25408
v_mfma_f32_16x16x32_bf16 v[28:31], a[44:47], v[112:115], v[28:31]
ds_read_b64_tr_b16 v[48:49], v4 offset:24704
s_waitcnt lgkmcnt(3)
v_mfma_f32_16x16x32_bf16 v[32:35], v[56:59], v[112:115], v[32:35]
ds_read_b64_tr_b16 v[50:51], v4 offset:25472
v_mfma_f32_16x16x32_bf16 v[36:39], v[60:63], v[112:115], v[36:39]
ds_read_b64_tr_b16 v[52:53], v5 offset:24704
v_mfma_f32_16x16x32_bf16 v[40:43], v[64:67], v[112:115], v[40:43]
ds_read_b64_tr_b16 v[54:55], v5 offset:25472
v_mfma_f32_16x16x32_bf16 v[20:23], a[48:51], v[116:119], v[20:23]
ds_read_b64_tr_b16 v[56:57], v5 offset:30784
v_mfma_f32_16x16x32_bf16 v[24:27], a[52:55], v[116:119], v[24:27]
ds_read_b64_tr_b16 v[58:59], v5 offset:31552
v_mfma_f32_16x16x32_bf16 v[28:31], a[56:59], v[116:119], v[28:31]
ds_read_b64_tr_b16 v[60:61], v4 offset:30848
s_waitcnt lgkmcnt(3)
v_mfma_f32_16x16x32_bf16 v[32:35], v[44:47], v[116:119], v[32:35]
ds_read_b64_tr_b16 v[62:63], v4 offset:31616
v_mfma_f32_16x16x32_bf16 v[36:39], v[48:51], v[116:119], v[36:39]
ds_read_b64_tr_b16 v[64:65], v5 offset:30848
v_mfma_f32_16x16x32_bf16 v[40:43], v[52:55], v[116:119], v[40:43]
ds_read_b64_tr_b16 v[66:67], v5 offset:31616
s_waitcnt vmcnt(10)
v_max3_u32 v92, v120, v121, v122
v_max3_u32 v93, v123, v124, v125
v_max3_u32 v92, v92, v126, v127
v_max3_u32 v93, v93, v128, v129
v_max3_u32 v92, v92, v130, v131
v_max3_u32 v93, v93, v132, v133
v_max3_u32 v92, v92, v134, v135
v_max3_u32 v93, v93, v136, v137
v_max3_u32 v92, v92, v138, v139
v_max_u32 v92, v92, v93
v_cmp_eq_u32 vcc, -1, v92
s_cbranch_vccnz L_o1_retry
L_o1_ok:
v_mfma_f32_16x16x32_bf16 v[20:23], a[60:63], v[120:123], v[20:23]
ds_read_b64_tr_b16 v[44:45], v5 offset:36928
v_mfma_f32_16x16x32_bf16 v[24:27], a[64:67], v[120:123], v[24:27]
ds_read_b64_tr_b16 v[46:47], v5 offset:37696
v_mfma_f32_16x16x32_bf16 v[28:31], a[68:71], v[120:123], v[28:31]
ds_read_b64_tr_b16 v[48:49], v4 offset:36992
s_waitcnt lgkmcnt(3)
v_mfma_f32_16x16x32_bf16 v[32:35], v[56:59], v[120:123], v[32:35]
ds_read_b64_tr_b16 v[50:51], v4 offset:37760
v_mfma_f32_16x16x32_bf16 v[36:39], v[60:63], v[120:123], v[36:39]
ds_read_b64_tr_b16 v[52:53], v5 offset:36992
v_mfma_f32_16x16x32_bf16 v[40:43], v[64:67], v[120:123], v[40:43]
ds_read_b64_tr_b16 v[54:55], v5 offset:37760
v_mfma_f32_16x16x32_bf16 v[20:23], a[72:75], v[124:127], v[20:23]
ds_read_b64_tr_b16 v[56:57], v5 offset:43072
v_mfma_f32_16x16x32_bf16 v[24:27], a[76:79], v[124:127], v[24:27]
ds_read_b64_tr_b16 v[58:59], v5 offset:43840
v_mfma_f32_16x16x32_bf16 v[28:31], a[80:83], v[124:127], v[28:31]
ds_read_b64_tr_b16 v[60:61], v4 offset:43136
s_waitcnt lgkmcnt(3)
v_mfma_f32_16x16x32_bf16 v[32:35], v[44:47], v[124:127], v[32:35]
ds_read_b64_tr_b16 v[62:63], v4 offset:43904
v_mfma_f32_16x16x32_bf16 v[36:39], v[48:51], v[124:127], v[36:39]
ds_read_b64_tr_b16 v[64:65], v5 offset:43136
v_mfma_f32_16x16x32_bf16 v[40:43], v[52:55], v[124:127], v[40:43]
ds_read_b64_tr_b16 v[66:67], v5 offset:43904
v_mfma_f32_16x16x32_bf16 v[20:23], a[84:87], v[128:131], v[20:23]
ds_read_b64_tr_b16 v[44:45], v5 offset:49216
v_mfma_f32_16x16x32_bf16 v[24:27], a[88:91], v[128:131], v[24:27]
ds_read_b64_tr_b16 v[46:47], v5 offset:49984
v_mfma_f32_16x16x32_bf16 v[28:31], a[92:95], v[128:131], v[28:31]
ds_read_b64_tr_b16 v[48:49], v4 offset:49280
s_waitcnt lgkmcnt(3)
v_mfma_f32_16x16x32_bf16 v[32:35], v[56:59], v[128:131], v[32:35]
ds_read_b64_tr_b16 v[50:51], v4 offset:50048
v_mfma_f32_16x16x32_bf16 v[36:39], v[60:63], v[128:131], v[36:39]
ds_read_b64_tr_b16 v[52:53], v5 offset:49280
v_mfma_f32_16x16x32_bf16 v[40:43], v[64:67], v[128:131], v[40:43]
ds_read_b64_tr_b16 v[54:55], v5 offset:50048
v_mfma_f32_16x16x32_bf16 v[20:23], a[96:99], v[132:135], v[20:23]
ds_read_b64_tr_b16 v[56:57], v5 offset:55360
v_mfma_f32_16x16x32_bf16 v[24:27], a[100:103], v[132:135], v[24:27]
ds_read_b64_tr_b16 v[58:59], v5 offset:56128
v_mfma_f32_16x16x32_bf16 v[28:31], a[104:107], v[132:135], v[28:31]
ds_read_b64_tr_b16 v[60:61], v4 offset:55424
s_waitcnt lgkmcnt(3)
v_mfma_f32_16x16x32_bf16 v[32:35], v[44:47], v[132:135], v[32:35]
ds_read_b64_tr_b16 v[62:63], v4 offset:56192
v_mfma_f32_16x16x32_bf16 v[36:39], v[48:51], v[132:135], v[36:39]
ds_read_b64_tr_b16 v[64:65], v5 offset:55424
v_mfma_f32_16x16x32_bf16 v[40:43], v[52:55], v[132:135], v[40:43]
ds_read_b64_tr_b16 v[66:67], v5 offset:56192
v_mfma_f32_16x16x32_bf16 v[20:23], a[108:111], v[136:139], v[20:23]
ds_read_b64_tr_b16 v[44:45], v7 offset:64
v_mfma_f32_16x16x32_bf16 v[24:27], a[112:115], v[136:139], v[24:27]
ds_read_b64_tr_b16 v[46:47], v7 offset:832
v_mfma_f32_16x16x32_bf16 v[28:31], a[116:119], v[136:139], v[28:31]
ds_read_b64_tr_b16 v[48:49], v6 offset:128
s_waitcnt lgkmcnt(3)
v_mfma_f32_16x16x32_bf16 v[32:35], v[56:59], v[136:139], v[32:35]
ds_read_b64_tr_b16 v[50:51], v6 offset:896
v_mfma_f32_16x16x32_bf16 v[36:39], v[60:63], v[136:139], v[36:39]
ds_read_b64_tr_b16 v[52:53], v7 offset:128
v_mfma_f32_16x16x32_bf16 v[40:43], v[64:67], v[136:139], v[40:43]
ds_read_b64_tr_b16 v[54:55], v7 offset:896
s_waitcnt vmcnt(5)
v_max3_u32 v92, v140, v141, v142
v_max3_u32 v93, v143, v144, v145
v_max3_u32 v92, v92, v146, v147
v_max3_u32 v93, v93, v148, v149
v_max3_u32 v92, v92, v150, v151
v_max3_u32 v93, v93, v152, v153
v_max3_u32 v92, v92, v154, v155
v_max3_u32 v93, v93, v156, v157
v_max3_u32 v92, v92, v158, v159
v_max_u32 v92, v92, v93
v_cmp_eq_u32 vcc, -1, v92
s_cbranch_vccnz L_o2_retry
L_o2_ok:
v_mfma_f32_16x16x32_bf16 v[20:23], a[120:123], v[140:143], v[20:23]
ds_read_b64_tr_b16 v[56:57], v7 offset:6208
v_mfma_f32_16x16x32_bf16 v[24:27], a[124:127], v[140:143], v[24:27]
ds_read_b64_tr_b16 v[58:59], v7 offset:6976
v_mfma_f32_16x16x32_bf16 v[28:31], a[128:131], v[140:143], v[28:31]
ds_read_b64_tr_b16 v[60:61], v6 offset:6272
s_waitcnt lgkmcnt(3)
v_mfma_f32_16x16x32_bf16 v[32:35], v[44:47], v[140:143], v[32:35]
ds_read_b64_tr_b16 v[62:63], v6 offset:7040
v_mfma_f32_16x16x32_bf16 v[36:39], v[48:51], v[140:143], v[36:39]
ds_read_b64_tr_b16 v[64:65], v7 offset:6272
v_mfma_f32_16x16x32_bf16 v[40:43], v[52:55], v[140:143], v[40:43]
ds_read_b64_tr_b16 v[66:67], v7 offset:7040
v_mfma_f32_16x16x32_bf16 v[20:23], a[132:135], v[144:147], v[20:23]
ds_read_b64_tr_b16 v[44:45], v7 offset:12352
v_mfma_f32_16x16x32_bf16 v[24:27], a[136:139], v[144:147], v[24:27]
ds_read_b64_tr_b16 v[46:47], v7 offset:13120
v_mfma_f32_16x16x32_bf16 v[28:31], a[140:143], v[144:147], v[28:31]
ds_read_b64_tr_b16 v[48:49], v6 offset:12416
s_waitcnt lgkmcnt(3)
v_mfma_f32_16x16x32_bf16 v[32:35], v[56:59], v[144:147], v[32:35]
ds_read_b64_tr_b16 v[50:51], v6 offset:13184
v_mfma_f32_16x16x32_bf16 v[36:39], v[60:63], v[144:147], v[36:39]
ds_read_b64_tr_b16 v[52:53], v7 offset:12416
v_mfma_f32_16x16x32_bf16 v[40:43], v[64:67], v[144:147], v[40:43]
ds_read_b64_tr_b16 v[54:55], v7 offset:13184
v_mfma_f32_16x16x32_bf16 v[20:23], a[144:147], v[148:151], v[20:23]
ds_read_b64_tr_b16 v[56:57], v7 offset:18496
v_mfma_f32_16x16x32_bf16 v[24:27], a[148:151], v[148:151], v[24:27]
ds_read_b64_tr_b16 v[58:59], v7 offset:19264
v_mfma_f32_16x16x32_bf16 v[28:31], a[152:155], v[148:151], v[28:31]
ds_read_b64_tr_b16 v[60:61], v6 offset:18560
s_waitcnt lgkmcnt(3)
v_mfma_f32_16x16x32_bf16 v[32:35], v[44:47], v[148:151], v[32:35]
ds_read_b64_tr_b16 v[62:63], v6 offset:19328
v_mfma_f32_16x16x32_bf16 v[36:39], v[48:51], v[148:151], v[36:39]
ds_read_b64_tr_b16 v[64:65], v7 offset:18560
v_mfma_f32_16x16x32_bf16 v[40:43], v[52:55], v[148:151], v[40:43]
ds_read_b64_tr_b16 v[66:67], v7 offset:19328
v_mfma_f32_16x16x32_bf16 v[20:23], a[156:159], v[152:155], v[20:23]
ds_read_b64_tr_b16 v[44:45], v7 offset:24640
v_mfma_f32_16x16x32_bf16 v[24:27], a[160:163], v[152:155], v[24:27]
ds_read_b64_tr_b16 v[46:47], v7 offset:25408
v_mfma_f32_16x16x32_bf16 v[28:31], a[164:167], v[152:155], v[28:31]
ds_read_b64_tr_b16 v[48:49], v6 offset:24704
s_waitcnt lgkmcnt(3)
v_mfma_f32_16x16x32_bf16 v[32:35], v[56:59], v[152:155], v[32:35]
ds_read_b64_tr_b16 v[50:51], v6 offset:25472
v_mfma_f32_16x16x32_bf16 v[36:39], v[60:63], v[152:155], v[36:39]
ds_read_b64_tr_b16 v[52:53], v7 offset:24704
v_mfma_f32_16x16x32_bf16 v[40:43], v[64:67], v[152:155], v[40:43]
ds_read_b64_tr_b16 v[54:55], v7 offset:25472
v_mfma_f32_16x16x32_bf16 v[20:23], a[168:171], v[156:159], v[20:23]
ds_read_b64_tr_b16 v[56:57], v7 offset:30784
v_mfma_f32_16x16x32_bf16 v[24:27], a[172:175], v[156:159], v[24:27]
ds_read_b64_tr_b16 v[58:59], v7 offset:31552
v_mfma_f32_16x16x32_bf16 v[28:31], a[176:179], v[156:159], v[28:31]
ds_read_b64_tr_b16 v[60:61], v6 offset:30848
s_waitcnt lgkmcnt(3)
v_mfma_f32_16x16x32_bf16 v[32:35], v[44:47], v[156:159], v[32:35]
ds_read_b64_tr_b16 v[62:63], v6 offset:31616
v_mfma_f32_16x16x32_bf16 v[36:39], v[48:51], v[156:159], v[36:39]
ds_read_b64_tr_b16 v[64:65], v7 offset:30848
v_mfma_f32_16x16x32_bf16 v[40:43], v[52:55], v[156:159], v[40:43]
ds_read_b64_tr_b16 v[66:67], v7 offset:31616
s_waitcnt vmcnt(0)
v_max3_u32 v92, v160, v161, v162
v_max3_u32 v93, v163, v164, v165
v_max3_u32 v92, v92, v166, v167
v_max3_u32 v93, v93, v168, v169
v_max3_u32 v92, v92, v170, v171
v_max3_u32 v93, v93, v172, v173
v_max3_u32 v92, v92, v174, v175
v_max3_u32 v93, v93, v176, v177
v_max3_u32 v92, v92, v178, v179
v_max_u32 v92, v92, v93
v_cmp_eq_u32 vcc, -1, v92
s_cbranch_vccnz L_o3_retry
L_o3_ok:
v_mfma_f32_16x16x32_bf16 v[20:23], a[180:183], v[160:163], v[20:23]
ds_read_b64_tr_b16 v[44:45], v7 offset:36928
v_mfma_f32_16x16x32_bf16 v[24:27], a[184:187], v[160:163], v[24:27]
ds_read_b64_tr_b16 v[46:47], v7 offset:37696
v_mfma_f32_16x16x32_bf16 v[28:31], a[188:191], v[160:163], v[28:31]
ds_read_b64_tr_b16 v[48:49], v6 offset:36992
s_waitcnt lgkmcnt(3)
v_mfma_f32_16x16x32_bf16 v[32:35], v[56:59], v[160:163], v[32:35]
ds_read_b64_tr_b16 v[50:51], v6 offset:37760
v_mfma_f32_16x16x32_bf16 v[36:39], v[60:63], v[160:163], v[36:39]
ds_read_b64_tr_b16 v[52:53], v7 offset:36992
v_mfma_f32_16x16x32_bf16 v[40:43], v[64:67], v[160:163], v[40:43]
ds_read_b64_tr_b16 v[54:55], v7 offset:37760
v_mfma_f32_16x16x32_bf16 v[20:23], a[192:195], v[164:167], v[20:23]
ds_read_b64_tr_b16 v[56:57], v7 offset:43072
v_mfma_f32_16x16x32_bf16 v[24:27], a[196:199], v[164:167], v[24:27]
ds_read_b64_tr_b16 v[58:59], v7 offset:43840
v_mfma_f32_16x16x32_bf16 v[28:31], a[200:203], v[164:167], v[28:31]
ds_read_b64_tr_b16 v[60:61], v6 offset:43136
s_waitcnt lgkmcnt(3)
v_mfma_f32_16x16x32_bf16 v[32:35], v[44:47], v[164:167], v[32:35]
ds_read_b64_tr_b16 v[62:63], v6 offset:43904
v_mfma_f32_16x16x32_bf16 v[36:39], v[48:51], v[164:167], v[36:39]
ds_read_b64_tr_b16 v[64:65], v7 offset:43136
v_mfma_f32_16x16x32_bf16 v[40:43], v[52:55], v[164:167], v[40:43]
ds_read_b64_tr_b16 v[66:67], v7 offset:43904
v_mfma_f32_16x16x32_bf16 v[20:23], a[204:207], v[168:171], v[20:23]
ds_read_b64_tr_b16 v[44:45], v7 offset:49216
v_mfma_f32_16x16x32_bf16 v[24:27], a[208:211], v[168:171], v[24:27]
ds_read_b64_tr_b16 v[46:47], v7 offset:49984
v_mfma_f32_16x16x32_bf16 v[28:31], a[212:215], v[168:171], v[28:31]
ds_read_b64_tr_b16 v[48:49], v6 offset:49280
s_waitcnt lgkmcnt(3)
v_mfma_f32_16x16x32_bf16 v[32:35], v[56:59], v[168:171], v[32:35]
ds_read_b64_tr_b16 v[50:51], v6 offset:50048
v_mfma_f32_16x16x32_bf16 v[36:39], v[60:63], v[168:171], v[36:39]
ds_read_b64_tr_b16 v[52:53], v7 offset:49280
v_mfma_f32_16x16x32_bf16 v[40:43], v[64:67], v[168:171], v[40:43]
ds_read_b64_tr_b16 v[54:55], v7 offset:50048
v_mfma_f32_16x16x32_bf16 v[20:23], a[216:219], v[172:175], v[20:23]
ds_read_b64_tr_b16 v[56:57], v7 offset:55360
v_mfma_f32_16x16x32_bf16 v[24:27], a[220:223], v[172:175], v[24:27]
ds_read_b64_tr_b16 v[58:59], v7 offset:56128
v_mfma_f32_16x16x32_bf16 v[28:31], a[224:227], v[172:175], v[28:31]
ds_read_b64_tr_b16 v[60:61], v6 offset:55424
s_waitcnt lgkmcnt(3)
v_mfma_f32_16x16x32_bf16 v[32:35], v[44:47], v[172:175], v[32:35]
ds_read_b64_tr_b16 v[62:63], v6 offset:56192
v_mfma_f32_16x16x32_bf16 v[36:39], v[48:51], v[172:175], v[36:39]
ds_read_b64_tr_b16 v[64:65], v7 offset:55424
v_mfma_f32_16x16x32_bf16 v[40:43], v[52:55], v[172:175], v[40:43]
ds_read_b64_tr_b16 v[66:67], v7 offset:56192
v_mfma_f32_16x16x32_bf16 v[20:23], a[228:231], v[176:179], v[20:23]
v_mfma_f32_16x16x32_bf16 v[24:27], a[232:235], v[176:179], v[24:27]
v_mfma_f32_16x16x32_bf16 v[28:31], a[236:239], v[176:179], v[28:31]
s_waitcnt lgkmcnt(0)
v_mfma_f32_16x16x32_bf16 v[32:35], v[56:59], v[176:179], v[32:35]
v_mfma_f32_16x16x32_bf16 v[36:39], v[60:63], v[176:179], v[36:39]
v_mfma_f32_16x16x32_bf16 v[40:43], v[64:67], v[176:179], v[40:43]
ds_read_b128 v[100:103], v9 offset:768
ds_read_b128 v[104:107], v9 offset:832
ds_read_b128 v[108:111], v9 offset:896
ds_read_b128 v[112:115], v9 offset:960
ds_read_b128 v[116:119], v9 offset:1024
ds_read_b128 v[120:123], v9 offset:1088
ds_read_b128 v[124:127], v9 offset:384
ds_read_b128 v[128:131], v9 offset:448
ds_read_b128 v[132:135], v9 offset:512
ds_read_b128 v[136:139], v9 offset:576
ds_read_b128 v[140:143], v9 offset:640
ds_read_b128 v[144:147], v9 offset:704
ds_read_b128 v[148:151], v9 offset:1152
ds_read_b128 v[152:155], v9 offset:1216
ds_read_b128 v[156:159], v9 offset:1280
ds_read_b128 v[160:163], v9 offset:1344
ds_read_b128 v[164:167], v9 offset:1408
ds_read_b128 v[168:171], v9 offset:1472
v_pk_fma_f32 v[20:21], v[20:21], v[180:181], v[68:69]
v_pk_fma_f32 v[22:23], v[22:23], v[182:183], v[70:71]
v_pk_fma_f32 v[24:25], v[24:25], v[184:185], v[72:73]
v_pk_fma_f32 v[26:27], v[26:27], v[186:187], v[74:75]
v_pk_fma_f32 v[28:29], v[28:29], v[188:189], v[76:77]
v_pk_fma_f32 v[30:31], v[30:31], v[190:191], v[78:79]
v_pk_fma_f32 v[32:33], v[32:33], v[192:193], v[80:81]
v_pk_fma_f32 v[34:35], v[34:35], v[194:195], v[82:83]
v_pk_fma_f32 v[36:37], v[36:37], v[196:197], v[84:85]
v_pk_fma_f32 v[38:39], v[38:39], v[198:199], v[86:87]
v_pk_fma_f32 v[40:41], v[40:41], v[200:201], v[88:89]
v_pk_fma_f32 v[42:43], v[42:43], v[202:203], v[90:91]
v_pk_mul_f32 v[46:47], v[20:21], v[20:21]
v_pk_mul_f32 v[48:49], v[20:21], v[204:205]
v_pk_add_f32 v[44:45], v[20:21], v[22:23]
v_pk_fma_f32 v[46:47], v[22:23], v[22:23], v[46:47]
v_pk_fma_f32 v[48:49], v[22:23], v[206:207], v[48:49]
v_pk_fma_f32 v[46:47], v[24:25], v[24:25], v[46:47]
v_pk_fma_f32 v[48:49], v[24:25], v[208:209], v[48:49]
v_pk_add_f32 v[44:45], v[44:45], v[24:25]
v_pk_fma_f32 v[46:47], v[26:27], v[26:27], v[46:47]
v_pk_fma_f32 v[48:49], v[26:27], v[210:211], v[48:49]
v_pk_add_f32 v[44:45], v[44:45], v[26:27]
v_pk_fma_f32 v[46:47], v[28:29], v[28:29], v[46:47]
v_pk_fma_f32 v[48:49], v[28:29], v[212:213], v[48:49]
v_pk_add_f32 v[44:45], v[44:45], v[28:29]
v_pk_fma_f32 v[46:47], v[30:31], v[30:31], v[46:47]
v_pk_fma_f32 v[48:49], v[30:31], v[214:215], v[48:49]
v_pk_add_f32 v[44:45], v[44:45], v[30:31]
v_pk_fma_f32 v[46:47], v[32:33], v[32:33], v[46:47]
v_pk_fma_f32 v[48:49], v[32:33], v[216:217], v[48:49]
v_pk_add_f32 v[44:45], v[44:45], v[32:33]
v_pk_fma_f32 v[46:47], v[34:35], v[34:35], v[46:47]
v_pk_fma_f32 v[48:49], v[34:35], v[218:219], v[48:49]
v_pk_add_f32 v[44:45], v[44:45], v[34:35]
v_pk_fma_f32 v[46:47], v[36:37], v[36:37], v[46:47]
v_pk_fma_f32 v[48:49], v[36:37], v[220:221], v[48:49]
v_pk_add_f32 v[44:45], v[44:45], v[36:37]
v_pk_fma_f32 v[46:47], v[38:39], v[38:39], v[46:47]
v_pk_fma_f32 v[48:49], v[38:39], v[222:223], v[48:49]
v_pk_add_f32 v[44:45], v[44:45], v[38:39]
v_pk_fma_f32 v[46:47], v[40:41], v[40:41], v[46:47]
v_pk_fma_f32 v[48:49], v[40:41], v[224:225], v[48:49]
v_pk_add_f32 v[44:45], v[44:45], v[40:41]
v_pk_fma_f32 v[46:47], v[42:43], v[42:43], v[46:47]
v_pk_fma_f32 v[48:49], v[42:43], v[226:227], v[48:49]
v_pk_add_f32 v[44:45], v[44:45], v[42:43]
v_add_f32 v44, v44, v45
v_add_f32 v46, v46, v47
v_add_f32 v48, v48, v49
s_lshl_b32 s56, s53, 11
s_add_u32 s56, s56, 131072
s_lshl_b32 s57, s96, 8
s_add_u32 s57, s57, s56
v_permlane32_swap_b32 v44, v46
v_permlane32_swap_b32 v48, v95
v_add_f32 v44, v44, v46
v_add_f32 v48, v48, v95
s_mov_b32 s55, 0xffffff00
s_nop 0
v_permlane16_swap_b32 v44, v48
v_add_f32 v44, v44, v48
v_and_or_b32 v44, v44, s55, v19
buffer_store_dword v44, v12, s[4:7], s57 offen sc1
L_st_poll:
buffer_load_dword v44, v12, s[4:7], s56 offen offset:0 sc1
buffer_load_dword v45, v12, s[4:7], s56 offen offset:256 sc1
buffer_load_dword v46, v12, s[4:7], s56 offen offset:512 sc1
buffer_load_dword v47, v12, s[4:7], s56 offen offset:768 sc1
buffer_load_dword v48, v12, s[4:7], s56 offen offset:1024 sc1
buffer_load_dword v49, v12, s[4:7], s56 offen offset:1280 sc1
buffer_load_dword v50, v12, s[4:7], s56 offen offset:1536 sc1
s_waitcnt vmcnt(0)
v_xor_b32 v52, v44, v19
v_bitop3_b32 v52, v52, v45, v19 bitop3:0xf6
v_bitop3_b32 v52, v52, v46, v19 bitop3:0xf6
v_bitop3_b32 v52, v52, v47, v19 bitop3:0xf6
v_bitop3_b32 v52, v52, v48, v19 bitop3:0xf6
v_bitop3_b32 v52, v52, v49, v19 bitop3:0xf6
v_bitop3_b32 v52, v52, v50, v19 bitop3:0xf6
v_and_b32 v52, 0xff, v52
v_cmp_ne_u32 vcc, 0, v52
s_add_u32 s97, s97, 1
s_cmp_gt_u32 s97, 65536
s_cbranch_scc1 L_st_ok
s_cbranch_vccnz L_st_poll
L_st_ok:
v_and_b32 v44, s55, v44
v_and_b32 v45, s55, v45
v_and_b32 v46, s55, v46
v_and_b32 v47, s55, v47
v_and_b32 v48, s55, v48
v_and_b32 v49, s55, v49
v_and_b32 v50, s55, v50
v_add_f32 v44, v44, v45
v_add_f32 v46, v46, v47
v_add_f32 v48, v48, v49
v_add_f32 v44, v44, v50
v_add_f32 v46, v46, v48
v_add_f32 v44, v44, v46
v_mov_b32 v46, v44
s_nop 1
v_permlane32_swap_b32 v44, v46
v_mov_b32 v45, v44
v_mov_b32 v47, v46
s_nop 0
v_permlane16_swap_b32 v44, v45
v_permlane16_swap_b32 v46, v47
v_mul_f32 v44, 0x3acccccd, v44
v_mul_f32 v46, 0x3acccccd, v46
v_fma_f32 v46, -v44, v44, v46
v_max_f32 v46, 0, v46
v_add_f32 v46, 0x3727c5ac, v46
v_rsq_f32 v48, v46
v_fma_f32 v45, -v44, v47, v45
v_mul_f32 v45, v45, v48
v_mul_f32 v49, -v44, v48
s_lshl_b32 s57, s3, 2
s_add_u32 s57, s57, 158464
v_max_f32_dpp v46, v45, v45 row_ror:8 row_mask:0xf bank_mask:0xf
v_mov_b32 v50, s57
v_and_b32 v51, 12, v12
v_max_f32_dpp v46, v46, v46 row_ror:4 row_mask:0xf bank_mask:0xf
v_add_u32 v51, 158464, v51
s_nop 0
v_max_f32_dpp v46, v46, v46 row_ror:2 row_mask:0xf bank_mask:0xf
s_nop 1
v_max_f32_dpp v46, v46, v46 row_ror:1 row_mask:0xf bank_mask:0xf
ds_write_b32 v50, v46
v_pk_fma_f32 v[68:69], v[20:21], v[48:49], v[48:49] op_sel:[0,0,1] op_sel_hi:[1,0,1]
v_pk_fma_f32 v[70:71], v[22:23], v[48:49], v[48:49] op_sel:[0,0,1] op_sel_hi:[1,0,1]
v_pk_fma_f32 v[72:73], v[24:25], v[48:49], v[48:49] op_sel:[0,0,1] op_sel_hi:[1,0,1]
v_pk_fma_f32 v[74:75], v[26:27], v[48:49], v[48:49] op_sel:[0,0,1] op_sel_hi:[1,0,1]
v_pk_fma_f32 v[76:77], v[28:29], v[48:49], v[48:49] op_sel:[0,0,1] op_sel_hi:[1,0,1]
v_pk_fma_f32 v[78:79], v[30:31], v[48:49], v[48:49] op_sel:[0,0,1] op_sel_hi:[1,0,1]
v_pk_fma_f32 v[80:81], v[32:33], v[48:49], v[48:49] op_sel:[0,0,1] op_sel_hi:[1,0,1]
v_pk_fma_f32 v[82:83], v[34:35], v[48:49], v[48:49] op_sel:[0,0,1] op_sel_hi:[1,0,1]
v_pk_fma_f32 v[84:85], v[36:37], v[48:49], v[48:49] op_sel:[0,0,1] op_sel_hi:[1,0,1]
v_pk_fma_f32 v[86:87], v[38:39], v[48:49], v[48:49] op_sel:[0,0,1] op_sel_hi:[1,0,1]
v_pk_fma_f32 v[88:89], v[40:41], v[48:49], v[48:49] op_sel:[0,0,1] op_sel_hi:[1,0,1]
v_pk_fma_f32 v[90:91], v[42:43], v[48:49], v[48:49] op_sel:[0,0,1] op_sel_hi:[1,0,1]
s_waitcnt lgkmcnt(0)
s_barrier
ds_read_b32 v52, v51
v_pk_fma_f32 v[68:69], v[68:69], v[100:101], v[124:125]
v_pk_fma_f32 v[70:71], v[70:71], v[102:103], v[126:127]
v_pk_fma_f32 v[72:73], v[72:73], v[104:105], v[128:129]
v_pk_fma_f32 v[74:75], v[74:75], v[106:107], v[130:131]
v_pk_fma_f32 v[76:77], v[76:77], v[108:109], v[132:133]
v_pk_fma_f32 v[78:79], v[78:79], v[110:111], v[134:135]
v_pk_fma_f32 v[80:81], v[80:81], v[112:113], v[136:137]
v_pk_fma_f32 v[82:83], v[82:83], v[114:115], v[138:139]
v_pk_fma_f32 v[84:85], v[84:85], v[116:117], v[140:141]
v_pk_fma_f32 v[86:87], v[86:87], v[118:119], v[142:143]
v_pk_fma_f32 v[88:89], v[88:89], v[120:121], v[144:145]
v_pk_fma_f32 v[90:91], v[90:91], v[122:123], v[146:147]
s_waitcnt lgkmcnt(0)
v_max_f32_dpp v53, v52, v52 quad_perm:[1,0,3,2] row_mask:0xf bank_mask:0xf
s_nop 1
v_max_f32_dpp v53, v53, v53 quad_perm:[2,3,0,1] row_mask:0xf bank_mask:0xf
v_cmp_eq_f32 vcc, v53, v52
v_cmp_eq_f32 s[58:59], v53, v45
s_ff1_i32_b64 s57, vcc
s_and_b32 s57, s57, 3
s_cmp_eq_u32 s57, s3
s_cbranch_scc0 L_nowin
s_ff1_i32_b64 s57, s[58:59]
s_and_b32 s57, s57, 15
s_cmp_eq_u32 s96, 0
s_cbranch_scc0 L_nocand
s_lshl_b32 s58, s57, 1
s_add_u32 s58, s58, s54
v_mov_b32 v56, v53
v_mov_b32 v57, s58
v_mov_b32 v58, s40
v_mov_b32 v59, s53
s_lshl_b32 s58, s47, 7
s_add_u32 s58, s58, 393216
s_mov_b64 exec, 0xff
buffer_store_dwordx4 v[56:59], v8, s[4:7], s58 offen sc1
L_nocand:
s_mov_b32 s58, 0x00010001
s_lshl_b32 exec_lo, s58, s57
s_lshl_b32 exec_hi, s58, s57
s_lshl_b32 s58, s47, 11
s_lshl_b32 s59, s96, 8
s_add_u32 s58, s58, s59
s_lshl_b32 s59, s58, 1
s_add_u32 s58, s58, 458752
s_add_u32 s59, s59, 524288
v_lshlrev_b32 v54, 3, v3
v_lshlrev_b32 v55, 4, v3
v_cvt_pk_bf16_f32 v172, v68, v69
v_cvt_pk_bf16_f32 v173, v70, v71
buffer_store_dwordx2 v[172:173], v54, s[4:7], s58 offen offset:0 sc1
v_cvt_pk_bf16_f32 v174, v72, v73
v_cvt_pk_bf16_f32 v175, v74, v75
buffer_store_dwordx2 v[174:175], v54, s[4:7], s58 offen offset:32 sc1
v_cvt_pk_bf16_f32 v176, v76, v77
v_cvt_pk_bf16_f32 v177, v78, v79
buffer_store_dwordx2 v[176:177], v54, s[4:7], s58 offen offset:64 sc1
v_cvt_pk_bf16_f32 v178, v80, v81
v_cvt_pk_bf16_f32 v179, v82, v83
buffer_store_dwordx2 v[178:179], v54, s[4:7], s58 offen offset:96 sc1
v_cvt_pk_bf16_f32 v172, v84, v85
v_cvt_pk_bf16_f32 v173, v86, v87
buffer_store_dwordx2 v[172:173], v54, s[4:7], s58 offen offset:128 sc1
v_cvt_pk_bf16_f32 v174, v88, v89
v_cvt_pk_bf16_f32 v175, v90, v91
buffer_store_dwordx2 v[174:175], v54, s[4:7], s58 offen offset:160 sc1
s_and_b32 s60, s40, 0xff
s_bfe_u32 s61, s40, 0x80008
s_bfe_u32 s62, s40, 0x80010
s_lshr_b32 s63, s40, 24
v_mov_b32 v60, s55
v_pk_fma_f32 v[100:101], v[68:69], v[148:149], v[20:21]
v_pk_fma_f32 v[102:103], v[70:71], v[150:151], v[22:23]
v_and_or_b32 v100, v100, v60, s60
v_and_or_b32 v101, v101, v60, s61
v_and_or_b32 v102, v102, v60, s62
v_and_or_b32 v103, v103, v60, s63
buffer_store_dwordx4 v[100:103], v55, s[4:7], s59 offen offset:0 sc1
v_pk_fma_f32 v[104:105], v[72:73], v[152:153], v[24:25]
v_pk_fma_f32 v[106:107], v[74:75], v[154:155], v[26:27]
v_and_or_b32 v104, v104, v60, s60
v_and_or_b32 v105, v105, v60, s61
v_and_or_b32 v106, v106, v60, s62
v_and_or_b32 v107, v107, v60, s63
buffer_store_dwordx4 v[104:107], v55, s[4:7], s59 offen offset:64 sc1
v_pk_fma_f32 v[108:109], v[76:77], v[156:157], v[28:29]
v_pk_fma_f32 v[110:111], v[78:79], v[158:159], v[30:31]
v_and_or_b32 v108, v108, v60, s60
v_and_or_b32 v109, v109, v60, s61
v_and_or_b32 v110, v110, v60, s62
v_and_or_b32 v111, v111, v60, s63
buffer_store_dwordx4 v[108:111], v55, s[4:7], s59 offen offset:128 sc1
v_pk_fma_f32 v[112:113], v[80:81], v[160:161], v[32:33]
v_pk_fma_f32 v[114:115], v[82:83], v[162:163], v[34:35]
v_and_or_b32 v112, v112, v60, s60
v_and_or_b32 v113, v113, v60, s61
v_and_or_b32 v114, v114, v60, s62
v_and_or_b32 v115, v115, v60, s63
buffer_store_dwordx4 v[112:115], v55, s[4:7], s59 offen offset:192 sc1
v_pk_fma_f32 v[116:117], v[84:85], v[164:165], v[36:37]
v_pk_fma_f32 v[118:119], v[86:87], v[166:167], v[38:39]
v_and_or_b32 v116, v116, v60, s60
v_and_or_b32 v117, v117, v60, s61
v_and_or_b32 v118, v118, v60, s62
v_and_or_b32 v119, v119, v60, s63
buffer_store_dwordx4 v[116:119], v55, s[4:7], s59 offen offset:256 sc1
v_pk_fma_f32 v[120:121], v[88:89], v[168:169], v[40:41]
v_pk_fma_f32 v[122:123], v[90:91], v[170:171], v[42:43]
v_and_or_b32 v120, v120, v60, s60
v_and_or_b32 v121, v121, v60, s61
v_and_or_b32 v122, v122, v60, s62
v_and_or_b32 v123, v123, v60, s63
buffer_store_dwordx4 v[120:123], v55, s[4:7], s59 offen offset:320 sc1
s_mov_b64 exec, -1
L_nowin:
v_pk_fma_f32 v[20:21], v[68:69], v[148:149], v[20:21]
v_pk_fma_f32 v[22:23], v[70:71], v[150:151], v[22:23]
v_cvt_pk_bf16_f32 v20, v20, v21
v_cvt_pk_bf16_f32 v21, v22, v23
ds_write_b64 v10, v[20:21] offset:0
v_pk_fma_f32 v[24:25], v[72:73], v[152:153], v[24:25]
v_pk_fma_f32 v[26:27], v[74:75], v[154:155], v[26:27]
v_cvt_pk_bf16_f32 v24, v24, v25
v_cvt_pk_bf16_f32 v25, v26, v27
ds_write_b64 v10, v[24:25] offset:32
v_pk_fma_f32 v[28:29], v[76:77], v[156:157], v[28:29]
v_pk_fma_f32 v[30:31], v[78:79], v[158:159], v[30:31]
v_cvt_pk_bf16_f32 v28, v28, v29
v_cvt_pk_bf16_f32 v29, v30, v31
ds_write_b64 v10, v[28:29] offset:64
v_pk_fma_f32 v[32:33], v[80:81], v[160:161], v[32:33]
v_pk_fma_f32 v[34:35], v[82:83], v[162:163], v[34:35]
v_cvt_pk_bf16_f32 v32, v32, v33
v_cvt_pk_bf16_f32 v33, v34, v35
ds_write_b64 v10, v[32:33] offset:96
v_pk_fma_f32 v[36:37], v[84:85], v[164:165], v[36:37]
v_pk_fma_f32 v[38:39], v[86:87], v[166:167], v[38:39]
v_cvt_pk_bf16_f32 v36, v36, v37
v_cvt_pk_bf16_f32 v37, v38, v39
ds_write_b64 v10, v[36:37] offset:128
v_pk_fma_f32 v[40:41], v[88:89], v[168:169], v[40:41]
v_pk_fma_f32 v[42:43], v[90:91], v[170:171], v[42:43]
v_cvt_pk_bf16_f32 v40, v40, v41
v_cvt_pk_bf16_f32 v41, v42, v43
ds_write_b64 v10, v[40:41] offset:160
s_waitcnt lgkmcnt(0)
ds_read_b128 v[44:47], v11 offset:0
ds_read_b128 v[48:51], v11 offset:1024
ds_read_b128 v[52:55], v11 offset:2048
s_waitcnt lgkmcnt(2)
buffer_store_dwordx4 v[44:47], v235, s[32:35], s50 offen sc1
s_waitcnt lgkmcnt(1)
buffer_store_dwordx4 v[48:51], v236, s[32:35], s50 offen sc1
s_waitcnt lgkmcnt(0)
buffer_store_dwordx4 v[52:55], v237, s[32:35], s50 offen sc1
s_lshl_b32 s56, s53, 3
s_add_u32 s56, s56, s96
s_lshl_b32 s56, s56, 4
s_add_u32 s56, s56, 655360
v_mov_b32 v20, s40
s_mov_b64 exec, 1
s_waitcnt vmcnt(0)
buffer_store_dword v20, v12, s[4:7], s56 offen sc1
s_mov_b64 exec, -1
s_branch L_fin
L_ga_retry:
buffer_load_dwordx4 v[40:43], v248, s[4:7], s56 offen sc1
buffer_load_dwordx4 v[44:47], v248, s[4:7], s57 offen sc1
buffer_load_dwordx4 v[48:51], v248, s[4:7], s58 offen sc1
buffer_load_dwordx4 v[52:55], v249, s[4:7], s56 offen sc1
buffer_load_dwordx4 v[56:59], v249, s[4:7], s57 offen sc1
buffer_load_dwordx4 v[60:63], v249, s[4:7], s58 offen sc1
s_waitcnt vmcnt(0)
v_perm_b32 v64, v41, v40, s98
v_perm_b32 v65, v43, v42, s99
v_bitop3_b32 v66, v64, v65, s40 bitop3:0x56
v_perm_b32 v64, v45, v44, s98
v_perm_b32 v65, v47, v46, s99
v_bitop3_b32 v67, v64, v65, s40 bitop3:0x56
v_perm_b32 v64, v49, v48, s98
v_perm_b32 v65, v51, v50, s99
v_bitop3_b32 v68, v64, v65, s40 bitop3:0x56
v_or3_b32 v69, v66, v67, v68
v_perm_b32 v64, v53, v52, s98
v_perm_b32 v65, v55, v54, s99
v_bitop3_b32 v66, v64, v65, s40 bitop3:0x56
v_perm_b32 v64, v57, v56, s98
v_perm_b32 v65, v59, v58, s99
v_bitop3_b32 v67, v64, v65, s40 bitop3:0x56
v_perm_b32 v64, v61, v60, s98
v_perm_b32 v65, v63, v62, s99
v_bitop3_b32 v68, v64, v65, s40 bitop3:0x56
v_or3_b32 v70, v66, v67, v68
v_and_b32 v70, v70, v250
v_or_b32 v69, v69, v70
v_cmp_ne_u32 vcc, 0, v69
s_add_u32 s97, s97, 1
s_cmp_gt_u32 s97, 65536
s_cbranch_scc1 L_ga_ok
s_cbranch_vccnz L_ga_retry
s_branch L_ga_ok
L_mv_retry:
buffer_load_dwordx4 v[240:243], v238, s[4:7], s51 offen sc1
s_waitcnt vmcnt(0)
v_perm_b32 v228, v241, v240, s55
v_perm_b32 v229, v243, v242, s55
v_xor_b32 v228, s40, v228
v_xor_b32 v229, s40, v229
v_or_b32 v228, v228, v229
v_and_b32 v228, v228, v250
v_cmp_ne_u32 vcc, 0, v228
s_add_u32 s97, s97, 1
s_cmp_gt_u32 s97, 65536
s_cbranch_scc1 L_mv_ok
s_cbranch_vccnz L_mv_retry
s_branch L_mv_ok
L_o0_retry:
buffer_load_dwordx4 v[100:103], v8, s[4:7], s56 offen offset:0 sc1
buffer_load_dwordx4 v[104:107], v8, s[4:7], s56 offen offset:1024 sc1
buffer_load_dwordx4 v[108:111], v8, s[4:7], s56 offen offset:2048 sc1
buffer_load_dwordx4 v[112:115], v8, s[4:7], s56 offen offset:3072 sc1
buffer_load_dwordx4 v[116:119], v8, s[4:7], s57 offen offset:0 sc1
s_waitcnt vmcnt(0)
v_max3_u32 v92, v100, v101, v102
v_max3_u32 v93, v103, v104, v105
v_max3_u32 v92, v92, v106, v107
v_max3_u32 v93, v93, v108, v109
v_max3_u32 v92, v92, v110, v111
v_max3_u32 v93, v93, v112, v113
v_max3_u32 v92, v92, v114, v115
v_max3_u32 v93, v93, v116, v117
v_max3_u32 v92, v92, v118, v119
v_max_u32 v92, v92, v93
v_cmp_eq_u32 vcc, -1, v92
s_add_u32 s97, s97, 1
s_cmp_gt_u32 s97, 65536
s_cbranch_scc1 L_o0_ok
s_cbranch_vccnz L_o0_retry
s_branch L_o0_ok
L_o1_retry:
buffer_load_dwordx4 v[120:123], v8, s[4:7], s57 offen offset:1024 sc1
buffer_load_dwordx4 v[124:127], v8, s[4:7], s57 offen offset:2048 sc1
buffer_load_dwordx4 v[128:131], v8, s[4:7], s57 offen offset:3072 sc1
buffer_load_dwordx4 v[132:135], v8, s[4:7], s58 offen offset:0 sc1
buffer_load_dwordx4 v[136:139], v8, s[4:7], s58 offen offset:1024 sc1
s_waitcnt vmcnt(0)
v_max3_u32 v92, v120, v121, v122
v_max3_u32 v93, v123, v124, v125
v_max3_u32 v92, v92, v126, v127
v_max3_u32 v93, v93, v128, v129
v_max3_u32 v92, v92, v130, v131
v_max3_u32 v93, v93, v132, v133
v_max3_u32 v92, v92, v134, v135
v_max3_u32 v93, v93, v136, v137
v_max3_u32 v92, v92, v138, v139
v_max_u32 v92, v92, v93
v_cmp_eq_u32 vcc, -1, v92
s_add_u32 s97, s97, 1
s_cmp_gt_u32 s97, 65536
s_cbranch_scc1 L_o1_ok
s_cbranch_vccnz L_o1_retry
s_branch L_o1_ok
L_o2_retry:
buffer_load_dwordx4 v[140:143], v8, s[4:7], s58 offen offset:2048 sc1
buffer_load_dwordx4 v[144:147], v8, s[4:7], s58 offen offset:3072 sc1
buffer_load_dwordx4 v[148:151], v8, s[4:7], s59 offen offset:0 sc1
buffer_load_dwordx4 v[152:155], v8, s[4:7], s59 offen offset:1024 sc1
buffer_load_dwordx4 v[156:159], v8, s[4:7], s59 offen offset:2048 sc1
s_waitcnt vmcnt(0)
v_max3_u32 v92, v140, v141, v142
v_max3_u32 v93, v143, v144, v145
v_max3_u32 v92, v92, v146, v147
v_max3_u32 v93, v93, v148, v149
v_max3_u32 v92, v92, v150, v151
v_max3_u32 v93, v93, v152, v153
v_max3_u32 v92, v92, v154, v155
v_max3_u32 v93, v93, v156, v157
v_max3_u32 v92, v92, v158, v159
v_max_u32 v92, v92, v93
v_cmp_eq_u32 vcc, -1, v92
s_add_u32 s97, s97, 1
s_cmp_gt_u32 s97, 65536
s_cbranch_scc1 L_o2_ok
s_cbranch_vccnz L_o2_retry
s_branch L_o2_ok
L_o3_retry:
buffer_load_dwordx4 v[160:163], v8, s[4:7], s59 offen offset:3072 sc1
buffer_load_dwordx4 v[164:167], v8, s[4:7], s60 offen offset:0 sc1
buffer_load_dwordx4 v[168:171], v8, s[4:7], s60 offen offset:1024 sc1
buffer_load_dwordx4 v[172:175], v8, s[4:7], s60 offen offset:2048 sc1
buffer_load_dwordx4 v[176:179], v8, s[4:7], s60 offen offset:3072 sc1
s_waitcnt vmcnt(0)
v_max3_u32 v92, v160, v161, v162
v_max3_u32 v93, v163, v164, v165
v_max3_u32 v92, v92, v166, v167
v_max3_u32 v93, v93, v168, v169
v_max3_u32 v92, v92, v170, v171
v_max3_u32 v93, v93, v172, v173
v_max3_u32 v92, v92, v174, v175
v_max3_u32 v93, v93, v176, v177
v_max3_u32 v92, v92, v178, v179
v_max_u32 v92, v92, v93
v_cmp_eq_u32 vcc, -1, v92
s_add_u32 s97, s97, 1
s_cmp_gt_u32 s97, 65536
s_cbranch_scc1 L_o3_ok
s_cbranch_vccnz L_o3_retry
s_branch L_o3_ok
L_svc0:
buffer_load_dword v42, v29, s[4:7], 0 offen sc1
s_waitcnt vmcnt(0)
v_readfirstlane_b32 s41, v42
v_and_b32 v31, 3, v1
s_mul_i32 s40, s41, 0x9E3779B1
s_add_u32 s40, s40, 0x85EBCA6B
v_lshlrev_b32 v30, 3, v31
v_lshrrev_b32 v19, v30, s40
v_and_b32 v19, 0xff, v19
L_svc1:
s_load_dwordx2 s[8:9], s[0:1], 40
s_load_dwordx2 s[12:13], s[0:1], 48
s_load_dwordx2 s[36:37], s[0:1], 56
v_lshlrev_b32 v28, 3, v0
buffer_load_dwordx2 v[40:41], v28, s[20:23], 0 offen
s_sub_u32 s44, s2, 224
v_lshrrev_b32 v30, 3, v1
v_and_b32 v31, 7, v1
v_lshlrev_b32 v31, 4, v31
v_mad_u32_u24 v4, v30, 60, 0
v_lshl_add_u32 v4, v4, 7, v31
v_mad_u32_u24 v5, v30, 27, 0
v_lshl_add_u32 v5, v5, 7, v31
v_lshlrev_b32 v8, 4, v1
v_lshlrev_b32 v12, 2, v1
v_bfe_u32 v30, v1, 2, 2
v_lshl_add_u32 v30, v3, 3, v30
v_and_b32 v31, 3, v1
v_lshlrev_b32 v31, 3, v31
s_lshl_b32 s55, s3, 5
v_lshlrev_b32 v32, 7, v30
v_add3_u32 v6, v32, v31, s55
v_add_u32 v7, 40960, v6
v_add_u32 v9, 81920, v6
v_add_u32 v10, 81920+40960, v6
s_mul_i32 s55, s3, 320
s_add_u32 s55, s55, 81920
v_mul_u32_u24 v32, 1280, v30
v_add3_u32 v11, v32, v31, s55
v_and_b32 v30, 1, v1
v_lshlrev_b32 v30, 4, v30
v_lshrrev_b32 v13, v30, s40
v_and_b32 v13, 0xffff, v13
v_mov_b32 v255, 1073741824
s_lshl_b32 s49, s3, 10
s_waitcnt vmcnt(0) lgkmcnt(0)
s_mov_b32 s10, 2211840
s_mov_b32 s14, 2211840
s_mov_b32 s38, 2211840
v_lshlrev_b32 v44, 16, v40
v_and_b32 v45, 0xffff0000, v40
v_lshlrev_b32 v46, 16, v41
v_and_b32 v47, 0xffff0000, v41
v_mul_f32 v48, 0xbfb8aa3b, v44
v_exp_f32 v48, v48
s_nop 0
v_add_f32 v48, 1.0, v48
v_rcp_f32 v48, v48
s_nop 0
v_mul_f32 v44, v44, v48
v_mul_f32 v48, 0xbfb8aa3b, v45
v_exp_f32 v48, v48
s_nop 0
v_add_f32 v48, 1.0, v48
v_rcp_f32 v48, v48
s_nop 0
v_mul_f32 v45, v45, v48
v_mul_f32 v48, 0xbfb8aa3b, v46
v_exp_f32 v48, v48
s_nop 0
v_add_f32 v48, 1.0, v48
v_rcp_f32 v48, v48
s_nop 0
v_mul_f32 v46, v46, v48
v_mul_f32 v48, 0xbfb8aa3b, v47
v_exp_f32 v48, v48
s_nop 0
v_add_f32 v48, 1.0, v48
v_rcp_f32 v48, v48
s_nop 0
v_mul_f32 v47, v47, v48
v_cvt_pk_bf16_f32 v40, v44, v45
v_cvt_pk_bf16_f32 v41, v46, v47
v_add_u32 v28, 100000-160, v28
ds_write_b64 v28, v[40:41]
v_lshlrev_b32 v28, 4, v3
v_add_u32 v28, 100000-160, v28
s_waitcnt lgkmcnt(0)
s_barrier
ds_read_b128 v[100:103], v28 offset:0
ds_read_b128 v[104:107], v28 offset:64
ds_read_b128 v[108:111], v28 offset:128
ds_read_b128 v[112:115], v28 offset:192
ds_read_b128 v[116:119], v28 offset:256
ds_read_b128 v[120:123], v28 offset:320
ds_read_b128 v[124:127], v28 offset:384
ds_read_b128 v[128:131], v28 offset:448
ds_read_b128 v[132:135], v28 offset:512
ds_read_b128 v[136:139], v28 offset:576
ds_read_b128 v[140:143], v28 offset:640
ds_read_b128 v[144:147], v28 offset:704
ds_read_b128 v[148:151], v28 offset:768
ds_read_b128 v[152:155], v28 offset:832
ds_read_b128 v[156:159], v28 offset:896
ds_read_b128 v[160:163], v28 offset:960
ds_read_b128 v[164:167], v28 offset:1024
ds_read_b128 v[168:171], v28 offset:1088
ds_read_b128 v[172:175], v28 offset:1152
ds_read_b128 v[176:179], v28 offset:1216
s_waitcnt lgkmcnt(0)
s_barrier
s_cmp_ge_u32 s44, 27
s_cbranch_scc1 L_fz
s_lshl_b32 s50, s44, 7
s_mul_i32 s55, s3, 61440
s_add_u32 s50, s50, s55
s_add_u32 s50, s50, 2560
s_add_u32 m0, s49, 0
s_nop 0
buffer_load_dwordx4 v4, s[16:19], s50 offen nt lds
s_add_u32 m0, m0, 4096
s_add_u32 s50, s50, 245760
buffer_load_dwordx4 v4, s[16:19], s50 offen nt lds
s_add_u32 m0, m0, 4096
s_add_u32 s50, s50, 245760
buffer_load_dwordx4 v4, s[16:19], s50 offen nt lds
s_add_u32 m0, m0, 4096
s_add_u32 s50, s50, 245760
buffer_load_dwordx4 v4, s[16:19], s50 offen nt lds
s_add_u32 m0, m0, 4096
s_add_u32 s50, s50, 245760
buffer_load_dwordx4 v4, s[16:19], s50 offen nt lds
s_add_u32 m0, m0, 4096
s_add_u32 s50, s50, 245760
buffer_load_dwordx4 v4, s[16:19], s50 offen nt lds
s_add_u32 m0, m0, 4096
s_add_u32 s50, s50, 245760
buffer_load_dwordx4 v4, s[16:19], s50 offen nt lds
s_add_u32 m0, m0, 4096
s_add_u32 s50, s50, 245760
buffer_load_dwordx4 v4, s[16:19], s50 offen nt lds
s_add_u32 m0, m0, 4096
s_add_u32 s50, s50, 245760
buffer_load_dwordx4 v4, s[16:19], s50 offen nt lds
s_add_u32 m0, m0, 4096
s_add_u32 s50, s50, 245760
buffer_load_dwordx4 v4, s[16:19], s50 offen nt lds
s_add_u32 m0, m0, 4096
s_add_u32 s50, s50, 245760
buffer_load_dwordx4 v4, s[16:19], s50 offen nt lds
s_add_u32 m0, m0, 4096
s_add_u32 s50, s50, 245760
buffer_load_dwordx4 v4, s[16:19], s50 offen nt lds
s_add_u32 m0, m0, 4096
s_add_u32 s50, s50, 245760
buffer_load_dwordx4 v4, s[16:19], s50 offen nt lds
s_add_u32 m0, m0, 4096
s_add_u32 s50, s50, 245760
buffer_load_dwordx4 v4, s[16:19], s50 offen nt lds
s_add_u32 m0, m0, 4096
s_add_u32 s50, s50, 245760
buffer_load_dwordx4 v4, s[16:19], s50 offen nt lds
s_add_u32 m0, m0, 4096
s_add_u32 s50, s50, 245760
buffer_load_dwordx4 v4, s[16:19], s50 offen nt lds
s_add_u32 m0, m0, 4096
s_add_u32 s50, s50, 245760
buffer_load_dwordx4 v4, s[16:19], s50 offen nt lds
s_add_u32 m0, m0, 4096
s_add_u32 s50, s50, 245760
buffer_load_dwordx4 v4, s[16:19], s50 offen nt lds
s_add_u32 m0, m0, 4096
s_add_u32 s50, s50, 245760
buffer_load_dwordx4 v4, s[16:19], s50 offen nt lds
s_add_u32 m0, m0, 4096
s_add_u32 s50, s50, 245760
buffer_load_dwordx4 v4, s[16:19], s50 offen nt lds
s_lshl_b32 s51, s44, 7
s_mul_i32 s55, s3, 27648
s_add_u32 s51, s51, s55
s_mov_b32 s52, s51
s_sub_u32 s55, s43, 28
s_lshl_b32 s55, s55, 2
s_add_u32 s55, s55, s3
s_mul_i32 s55, s55, 57344
v_lshlrev_b32 v30, 7, v1
buffer_load_dword v184, v30, s[24:27], s55 offen
s_add_u32 s55, s55, 8192
buffer_load_dword v185, v30, s[24:27], s55 offen
s_add_u32 s55, s55, 8192
buffer_load_dword v186, v30, s[24:27], s55 offen
s_add_u32 s55, s55, 8192
buffer_load_dword v187, v30, s[24:27], s55 offen
s_add_u32 s55, s55, 8192
buffer_load_dword v188, v30, s[24:27], s55 offen
s_add_u32 s55, s55, 8192
buffer_load_dword v189, v30, s[24:27], s55 offen
s_add_u32 s55, s55, 8192
buffer_load_dword v190, v30, s[24:27], s55 offen
s_add_u32 s55, s55, 8192
s_add_u32 m0, s49, 81920
s_nop 0
buffer_load_dwordx4 v5, s[8:11], s51 offen nt lds
s_add_u32 m0, m0, 4096
s_add_u32 s51, s51, 110592
buffer_load_dwordx4 v5, s[8:11], s51 offen nt lds
s_add_u32 m0, m0, 4096
s_add_u32 s51, s51, 110592
buffer_load_dwordx4 v5, s[8:11], s51 offen nt lds
s_add_u32 m0, m0, 4096
s_add_u32 s51, s51, 110592
buffer_load_dwordx4 v5, s[8:11], s51 offen nt lds
s_add_u32 m0, m0, 4096
s_add_u32 s51, s51, 110592
buffer_load_dwordx4 v5, s[8:11], s51 offen nt lds
s_add_u32 m0, m0, 4096
s_add_u32 s51, s51, 110592
buffer_load_dwordx4 v5, s[8:11], s51 offen nt lds
s_add_u32 m0, m0, 4096
s_add_u32 s51, s51, 110592
buffer_load_dwordx4 v5, s[8:11], s51 offen nt lds
s_add_u32 m0, m0, 4096
s_add_u32 s51, s51, 110592
buffer_load_dwordx4 v5, s[8:11], s51 offen nt lds
s_add_u32 m0, m0, 4096
s_add_u32 s51, s51, 110592
buffer_load_dwordx4 v5, s[8:11], s51 offen nt lds
s_add_u32 m0, m0, 4096
s_add_u32 s51, s51, 110592
buffer_load_dwordx4 v5, s[8:11], s51 offen nt lds
s_add_u32 m0, m0, 4096
s_add_u32 s51, s51, 110592
buffer_load_dwordx4 v5, s[8:11], s51 offen nt lds
s_add_u32 m0, m0, 4096
s_add_u32 s51, s51, 110592
buffer_load_dwordx4 v5, s[8:11], s51 offen nt lds
s_add_u32 m0, m0, 4096
s_add_u32 s51, s51, 110592
buffer_load_dwordx4 v5, s[8:11], s51 offen nt lds
s_add_u32 m0, m0, 4096
s_add_u32 s51, s51, 110592
buffer_load_dwordx4 v5, s[8:11], s51 offen nt lds
s_add_u32 m0, m0, 4096
s_add_u32 s51, s51, 110592
buffer_load_dwordx4 v5, s[8:11], s51 offen nt lds
s_add_u32 m0, m0, 4096
s_add_u32 s51, s51, 110592
buffer_load_dwordx4 v5, s[8:11], s51 offen nt lds
s_add_u32 m0, m0, 4096
s_add_u32 s51, s51, 110592
buffer_load_dwordx4 v5, s[8:11], s51 offen nt lds
s_add_u32 m0, m0, 4096
s_add_u32 s51, s51, 110592
buffer_load_dwordx4 v5, s[8:11], s51 offen nt lds
s_add_u32 m0, m0, 4096
s_add_u32 s51, s51, 110592
buffer_load_dwordx4 v5, s[8:11], s51 offen nt lds
s_add_u32 m0, m0, 4096
s_add_u32 s51, s51, 110592
buffer_load_dwordx4 v5, s[8:11], s51 offen nt lds
s_waitcnt vmcnt(27)
s_barrier
ds_read_b64_tr_b16 v[20:21], v6 offset:0
ds_read_b64_tr_b16 v[22:23], v6 offset:512
ds_read_b64_tr_b16 v[24:25], v6 offset:4096
ds_read_b64_tr_b16 v[26:27], v6 offset:4608
ds_read_b64_tr_b16 v[28:29], v6 offset:8192
ds_read_b64_tr_b16 v[30:31], v6 offset:8704
ds_read_b64_tr_b16 v[32:33], v6 offset:12288
ds_read_b64_tr_b16 v[34:35], v6 offset:12800
ds_read_b64_tr_b16 v[36:37], v6 offset:16384
ds_read_b64_tr_b16 v[38:39], v6 offset:16896
ds_read_b64_tr_b16 v[40:41], v6 offset:20480
ds_read_b64_tr_b16 v[42:43], v6 offset:20992
ds_read_b64_tr_b16 v[44:45], v6 offset:24576
ds_read_b64_tr_b16 v[46:47], v6 offset:25088
ds_read_b64_tr_b16 v[48:49], v6 offset:28672
ds_read_b64_tr_b16 v[50:51], v6 offset:29184
ds_read_b64_tr_b16 v[52:53], v6 offset:32768
ds_read_b64_tr_b16 v[54:55], v6 offset:33280
ds_read_b64_tr_b16 v[56:57], v6 offset:36864
ds_read_b64_tr_b16 v[58:59], v6 offset:37376
ds_read_b64_tr_b16 v[60:61], v7 offset:0
ds_read_b64_tr_b16 v[62:63], v7 offset:512
ds_read_b64_tr_b16 v[64:65], v7 offset:4096
ds_read_b64_tr_b16 v[66:67], v7 offset:4608
ds_read_b64_tr_b16 v[68:69], v7 offset:8192
ds_read_b64_tr_b16 v[70:71], v7 offset:8704
ds_read_b64_tr_b16 v[72:73], v7 offset:12288
ds_read_b64_tr_b16 v[74:75], v7 offset:12800
ds_read_b64_tr_b16 v[76:77], v7 offset:16384
ds_read_b64_tr_b16 v[78:79], v7 offset:16896
ds_read_b64_tr_b16 v[80:81], v7 offset:20480
ds_read_b64_tr_b16 v[82:83], v7 offset:20992
ds_read_b64_tr_b16 v[84:85], v7 offset:24576
ds_read_b64_tr_b16 v[86:87], v7 offset:25088
ds_read_b64_tr_b16 v[88:89], v7 offset:28672
ds_read_b64_tr_b16 v[90:91], v7 offset:29184
ds_read_b64_tr_b16 v[92:93], v7 offset:32768
ds_read_b64_tr_b16 v[94:95], v7 offset:33280
ds_read_b64_tr_b16 v[96:97], v7 offset:36864
ds_read_b64_tr_b16 v[98:99], v7 offset:37376
s_waitcnt lgkmcnt(0)
s_barrier
v_mfma_f32_16x16x32_bf16 v[180:183], v[100:103], v[20:23], 0
v_mfma_f32_16x16x32_bf16 v[180:183], v[104:107], v[24:27], v[180:183]
v_mfma_f32_16x16x32_bf16 v[180:183], v[108:111], v[28:31], v[180:183]
v_mfma_f32_16x16x32_bf16 v[180:183], v[112:115], v[32:35], v[180:183]
v_mfma_f32_16x16x32_bf16 v[180:183], v[116:119], v[36:39], v[180:183]
v_mfma_f32_16x16x32_bf16 v[180:183], v[120:123], v[40:43], v[180:183]
v_mfma_f32_16x16x32_bf16 v[180:183], v[124:127], v[44:47], v[180:183]
v_mfma_f32_16x16x32_bf16 v[180:183], v[128:131], v[48:51], v[180:183]
v_mfma_f32_16x16x32_bf16 v[180:183], v[132:135], v[52:55], v[180:183]
v_mfma_f32_16x16x32_bf16 v[180:183], v[136:139], v[56:59], v[180:183]
v_mfma_f32_16x16x32_bf16 v[180:183], v[140:143], v[60:63], v[180:183]
v_mfma_f32_16x16x32_bf16 v[180:183], v[144:147], v[64:67], v[180:183]
v_mfma_f32_16x16x32_bf16 v[180:183], v[148:151], v[68:71], v[180:183]
v_mfma_f32_16x16x32_bf16 v[180:183], v[152:155], v[72:75], v[180:183]
v_mfma_f32_16x16x32_bf16 v[180:183], v[156:159], v[76:79], v[180:183]
v_mfma_f32_16x16x32_bf16 v[180:183], v[160:163], v[80:83], v[180:183]
v_mfma_f32_16x16x32_bf16 v[180:183], v[164:167], v[84:87], v[180:183]
v_mfma_f32_16x16x32_bf16 v[180:183], v[168:171], v[88:91], v[180:183]
v_mfma_f32_16x16x32_bf16 v[180:183], v[172:175], v[92:95], v[180:183]
v_mfma_f32_16x16x32_bf16 v[180:183], v[176:179], v[96:99], v[180:183]
s_sub_u32 s55, s44, 20
s_cmp_lt_u32 s55, 10
s_cselect_b32 s55, 1.0, 0
s_lshl_b32 s56, s44, 8
s_lshl_b32 s57, s3, 6
s_add_u32 s56, s56, s57
s_add_u32 s56, s56, 65536
s_nop 0
v_cvt_pk_bf16_f32 v180, v180, v180
v_lshlrev_b32 v180, 16, v180
v_add_f32 v180, s55, v180
v_cvt_pk_bf16_f32 v180, v180, v180
v_lshl_or_b32 v180, v180, 16, v13
s_mov_b64 exec, 0xffff
buffer_store_dword v180, v12, s[4:7], s56 offen sc1
s_mov_b64 exec, -1
s_add_u32 m0, s49, 0
s_nop 0
buffer_load_dwordx4 v5, s[12:15], s52 offen nt lds
s_add_u32 m0, m0, 4096
s_add_u32 s52, s52, 110592
buffer_load_dwordx4 v5, s[12:15], s52 offen nt lds
s_add_u32 m0, m0, 4096
s_add_u32 s52, s52, 110592
buffer_load_dwordx4 v5, s[12:15], s52 offen nt lds
s_add_u32 m0, m0, 4096
s_add_u32 s52, s52, 110592
buffer_load_dwordx4 v5, s[12:15], s52 offen nt lds
s_add_u32 m0, m0, 4096
s_add_u32 s52, s52, 110592
buffer_load_dwordx4 v5, s[12:15], s52 offen nt lds
s_add_u32 m0, m0, 4096
s_add_u32 s52, s52, 110592
buffer_load_dwordx4 v5, s[12:15], s52 offen nt lds
s_add_u32 m0, m0, 4096
s_add_u32 s52, s52, 110592
buffer_load_dwordx4 v5, s[12:15], s52 offen nt lds
s_add_u32 m0, m0, 4096
s_add_u32 s52, s52, 110592
buffer_load_dwordx4 v5, s[12:15], s52 offen nt lds
s_add_u32 m0, m0, 4096
s_add_u32 s52, s52, 110592
buffer_load_dwordx4 v5, s[12:15], s52 offen nt lds
s_add_u32 m0, m0, 4096
s_add_u32 s52, s52, 110592
buffer_load_dwordx4 v5, s[12:15], s52 offen nt lds
s_add_u32 m0, m0, 4096
s_add_u32 s52, s52, 110592
buffer_load_dwordx4 v5, s[12:15], s52 offen nt lds
s_add_u32 m0, m0, 4096
s_add_u32 s52, s52, 110592
buffer_load_dwordx4 v5, s[12:15], s52 offen nt lds
s_add_u32 m0, m0, 4096
s_add_u32 s52, s52, 110592
buffer_load_dwordx4 v5, s[12:15], s52 offen nt lds
s_add_u32 m0, m0, 4096
s_add_u32 s52, s52, 110592
buffer_load_dwordx4 v5, s[12:15], s52 offen nt lds
s_add_u32 m0, m0, 4096
s_add_u32 s52, s52, 110592
buffer_load_dwordx4 v5, s[12:15], s52 offen nt lds
s_add_u32 m0, m0, 4096
s_add_u32 s52, s52, 110592
buffer_load_dwordx4 v5, s[12:15], s52 offen nt lds
s_add_u32 m0, m0, 4096
s_add_u32 s52, s52, 110592
buffer_load_dwordx4 v5, s[12:15], s52 offen nt lds
s_add_u32 m0, m0, 4096
s_add_u32 s52, s52, 110592
buffer_load_dwordx4 v5, s[12:15], s52 offen nt lds
s_add_u32 m0, m0, 4096
s_add_u32 s52, s52, 110592
buffer_load_dwordx4 v5, s[12:15], s52 offen nt lds
s_add_u32 m0, m0, 4096
s_add_u32 s52, s52, 110592
buffer_load_dwordx4 v5, s[12:15], s52 offen nt lds
s_waitcnt vmcnt(21)
s_barrier
ds_read_b64_tr_b16 a[0:1], v9 offset:0
ds_read_b64_tr_b16 a[2:3], v9 offset:512
ds_read_b64_tr_b16 a[4:5], v9 offset:4096
ds_read_b64_tr_b16 a[6:7], v9 offset:4608
ds_read_b64_tr_b16 a[8:9], v9 offset:8192
ds_read_b64_tr_b16 a[10:11], v9 offset:8704
ds_read_b64_tr_b16 a[12:13], v9 offset:12288
ds_read_b64_tr_b16 a[14:15], v9 offset:12800
ds_read_b64_tr_b16 a[16:17], v9 offset:16384
ds_read_b64_tr_b16 a[18:19], v9 offset:16896
ds_read_b64_tr_b16 a[20:21], v9 offset:20480
ds_read_b64_tr_b16 a[22:23], v9 offset:20992
ds_read_b64_tr_b16 a[24:25], v9 offset:24576
ds_read_b64_tr_b16 a[26:27], v9 offset:25088
ds_read_b64_tr_b16 a[28:29], v9 offset:28672
ds_read_b64_tr_b16 a[30:31], v9 offset:29184
ds_read_b64_tr_b16 a[32:33], v9 offset:32768
ds_read_b64_tr_b16 a[34:35], v9 offset:33280
ds_read_b64_tr_b16 a[36:37], v9 offset:36864
ds_read_b64_tr_b16 a[38:39], v9 offset:37376
ds_read_b64_tr_b16 a[40:41], v10 offset:0
ds_read_b64_tr_b16 a[42:43], v10 offset:512
ds_read_b64_tr_b16 a[44:45], v10 offset:4096
ds_read_b64_tr_b16 a[46:47], v10 offset:4608
ds_read_b64_tr_b16 a[48:49], v10 offset:8192
ds_read_b64_tr_b16 a[50:51], v10 offset:8704
ds_read_b64_tr_b16 a[52:53], v10 offset:12288
ds_read_b64_tr_b16 a[54:55], v10 offset:12800
ds_read_b64_tr_b16 a[56:57], v10 offset:16384
ds_read_b64_tr_b16 a[58:59], v10 offset:16896
ds_read_b64_tr_b16 a[60:61], v10 offset:20480
ds_read_b64_tr_b16 a[62:63], v10 offset:20992
ds_read_b64_tr_b16 a[64:65], v10 offset:24576
ds_read_b64_tr_b16 a[66:67], v10 offset:25088
ds_read_b64_tr_b16 a[68:69], v10 offset:28672
ds_read_b64_tr_b16 a[70:71], v10 offset:29184
ds_read_b64_tr_b16 a[72:73], v10 offset:32768
ds_read_b64_tr_b16 a[74:75], v10 offset:33280
ds_read_b64_tr_b16 a[76:77], v10 offset:36864
ds_read_b64_tr_b16 a[78:79], v10 offset:37376
s_waitcnt lgkmcnt(0)
s_barrier
s_mul_i32 s51, s44, 81920
s_add_u32 s51, s51, s49
s_add_u32 m0, s49, 81920
s_nop 0
buffer_load_dwordx4 v8, s[36:39], s51 offen nt lds
s_add_u32 m0, m0, 4096
s_add_u32 s51, s51, 4096
buffer_load_dwordx4 v8, s[36:39], s51 offen nt lds
s_add_u32 m0, m0, 4096
s_add_u32 s51, s51, 4096
buffer_load_dwordx4 v8, s[36:39], s51 offen nt lds
s_add_u32 m0, m0, 4096
s_add_u32 s51, s51, 4096
buffer_load_dwordx4 v8, s[36:39], s51 offen nt lds
s_add_u32 m0, m0, 4096
s_add_u32 s51, s51, 4096
buffer_load_dwordx4 v8, s[36:39], s51 offen nt lds
s_add_u32 m0, m0, 4096
s_add_u32 s51, s51, 4096
buffer_load_dwordx4 v8, s[36:39], s51 offen nt lds
s_add_u32 m0, m0, 4096
s_add_u32 s51, s51, 4096
buffer_load_dwordx4 v8, s[36:39], s51 offen nt lds
s_add_u32 m0, m0, 4096
s_add_u32 s51, s51, 4096
buffer_load_dwordx4 v8, s[36:39], s51 offen nt lds
s_add_u32 m0, m0, 4096
s_add_u32 s51, s51, 4096
buffer_load_dwordx4 v8, s[36:39], s51 offen nt lds
s_add_u32 m0, m0, 4096
s_add_u32 s51, s51, 4096
buffer_load_dwordx4 v8, s[36:39], s51 offen nt lds
s_add_u32 m0, m0, 4096
s_add_u32 s51, s51, 4096
buffer_load_dwordx4 v8, s[36:39], s51 offen nt lds
s_add_u32 m0, m0, 4096
s_add_u32 s51, s51, 4096
buffer_load_dwordx4 v8, s[36:39], s51 offen nt lds
s_add_u32 m0, m0, 4096
s_add_u32 s51, s51, 4096
buffer_load_dwordx4 v8, s[36:39], s51 offen nt lds
s_add_u32 m0, m0, 4096
s_add_u32 s51, s51, 4096
buffer_load_dwordx4 v8, s[36:39], s51 offen nt lds
s_add_u32 m0, m0, 4096
s_add_u32 s51, s51, 4096
buffer_load_dwordx4 v8, s[36:39], s51 offen nt lds
s_add_u32 m0, m0, 4096
s_add_u32 s51, s51, 4096
buffer_load_dwordx4 v8, s[36:39], s51 offen nt lds
s_add_u32 m0, m0, 4096
s_add_u32 s51, s51, 4096
buffer_load_dwordx4 v8, s[36:39], s51 offen nt lds
s_add_u32 m0, m0, 4096
s_add_u32 s51, s51, 4096
buffer_load_dwordx4 v8, s[36:39], s51 offen nt lds
s_add_u32 m0, m0, 4096
s_add_u32 s51, s51, 4096
buffer_load_dwordx4 v8, s[36:39], s51 offen nt lds
s_add_u32 m0, m0, 4096
s_add_u32 s51, s51, 4096
buffer_load_dwordx4 v8, s[36:39], s51 offen nt lds
s_waitcnt vmcnt(20)
s_barrier
ds_read_b64_tr_b16 a[80:81], v6 offset:0
ds_read_b64_tr_b16 a[82:83], v6 offset:512
ds_read_b64_tr_b16 a[84:85], v6 offset:4096
ds_read_b64_tr_b16 a[86:87], v6 offset:4608
ds_read_b64_tr_b16 a[88:89], v6 offset:8192
ds_read_b64_tr_b16 a[90:91], v6 offset:8704
ds_read_b64_tr_b16 a[92:93], v6 offset:12288
ds_read_b64_tr_b16 a[94:95], v6 offset:12800
ds_read_b64_tr_b16 a[96:97], v6 offset:16384
ds_read_b64_tr_b16 a[98:99], v6 offset:16896
ds_read_b64_tr_b16 a[100:101], v6 offset:20480
ds_read_b64_tr_b16 a[102:103], v6 offset:20992
ds_read_b64_tr_b16 a[104:105], v6 offset:24576
ds_read_b64_tr_b16 a[106:107], v6 offset:25088
ds_read_b64_tr_b16 a[108:109], v6 offset:28672
ds_read_b64_tr_b16 a[110:111], v6 offset:29184
ds_read_b64_tr_b16 a[112:113], v6 offset:32768
ds_read_b64_tr_b16 a[114:115], v6 offset:33280
ds_read_b64_tr_b16 a[116:117], v6 offset:36864
ds_read_b64_tr_b16 a[118:119], v6 offset:37376
ds_read_b64_tr_b16 a[120:121], v7 offset:0
ds_read_b64_tr_b16 a[122:123], v7 offset:512
ds_read_b64_tr_b16 a[124:125], v7 offset:4096
ds_read_b64_tr_b16 a[126:127], v7 offset:4608
ds_read_b64_tr_b16 a[128:129], v7 offset:8192
ds_read_b64_tr_b16 a[130:131], v7 offset:8704
ds_read_b64_tr_b16 a[132:133], v7 offset:12288
ds_read_b64_tr_b16 a[134:135], v7 offset:12800
ds_read_b64_tr_b16 a[136:137], v7 offset:16384
ds_read_b64_tr_b16 a[138:139], v7 offset:16896
ds_read_b64_tr_b16 a[140:141], v7 offset:20480
ds_read_b64_tr_b16 a[142:143], v7 offset:20992
ds_read_b64_tr_b16 a[144:145], v7 offset:24576
ds_read_b64_tr_b16 a[146:147], v7 offset:25088
ds_read_b64_tr_b16 a[148:149], v7 offset:28672
ds_read_b64_tr_b16 a[150:151], v7 offset:29184
ds_read_b64_tr_b16 a[152:153], v7 offset:32768
ds_read_b64_tr_b16 a[154:155], v7 offset:33280
ds_read_b64_tr_b16 a[156:157], v7 offset:36864
ds_read_b64_tr_b16 a[158:159], v7 offset:37376
s_waitcnt vmcnt(0) lgkmcnt(0)
s_barrier
ds_read_b64_tr_b16 a[160:161], v11 offset:0
ds_read_b64_tr_b16 a[162:163], v11 offset:5120
ds_read_b64_tr_b16 a[164:165], v11 offset:40960
ds_read_b64_tr_b16 a[166:167], v11 offset:46080
ds_read_b64_tr_b16 a[168:169], v11 offset:32
ds_read_b64_tr_b16 a[170:171], v11 offset:5152
ds_read_b64_tr_b16 a[172:173], v11 offset:40992
ds_read_b64_tr_b16 a[174:175], v11 offset:46112
ds_read_b64_tr_b16 a[176:177], v11 offset:64
ds_read_b64_tr_b16 a[178:179], v11 offset:5184
ds_read_b64_tr_b16 a[180:181], v11 offset:41024
ds_read_b64_tr_b16 a[182:183], v11 offset:46144
ds_read_b64_tr_b16 a[184:185], v11 offset:96
ds_read_b64_tr_b16 a[186:187], v11 offset:5216
ds_read_b64_tr_b16 a[188:189], v11 offset:41056
ds_read_b64_tr_b16 a[190:191], v11 offset:46176
ds_read_b64_tr_b16 a[192:193], v11 offset:128
ds_read_b64_tr_b16 a[194:195], v11 offset:5248
ds_read_b64_tr_b16 a[196:197], v11 offset:41088
ds_read_b64_tr_b16 a[198:199], v11 offset:46208
ds_read_b64_tr_b16 a[200:201], v11 offset:160
ds_read_b64_tr_b16 a[202:203], v11 offset:5280
ds_read_b64_tr_b16 a[204:205], v11 offset:41120
ds_read_b64_tr_b16 a[206:207], v11 offset:46240
ds_read_b64_tr_b16 a[208:209], v11 offset:192
ds_read_b64_tr_b16 a[210:211], v11 offset:5312
ds_read_b64_tr_b16 a[212:213], v11 offset:41152
ds_read_b64_tr_b16 a[214:215], v11 offset:46272
ds_read_b64_tr_b16 a[216:217], v11 offset:224
ds_read_b64_tr_b16 a[218:219], v11 offset:5344
ds_read_b64_tr_b16 a[220:221], v11 offset:41184
ds_read_b64_tr_b16 a[222:223], v11 offset:46304
ds_read_b64_tr_b16 a[224:225], v11 offset:256
ds_read_b64_tr_b16 a[226:227], v11 offset:5376
ds_read_b64_tr_b16 a[228:229], v11 offset:41216
ds_read_b64_tr_b16 a[230:231], v11 offset:46336
ds_read_b64_tr_b16 a[232:233], v11 offset:288
ds_read_b64_tr_b16 a[234:235], v11 offset:5408
ds_read_b64_tr_b16 a[236:237], v11 offset:41248
ds_read_b64_tr_b16 a[238:239], v11 offset:46368
s_waitcnt lgkmcnt(0)
v_mov_b32 v20, 0
ds_write_b32 v12, v20 offset:8192
v_mul_u32_u24 v30, 5462, v1
v_lshrrev_b32 v30, 16, v30
v_lshl_add_u32 v14, v30, 6, v8
v_add_u32 v31, 64, v1
v_mul_u32_u24 v30, 5462, v31
v_lshrrev_b32 v30, 16, v30
v_lshlrev_b32 v31, 4, v31
v_lshl_add_u32 v15, v30, 6, v31
v_cmp_gt_u32 vcc, 16, v1
s_lshl_b32 s55, s3, 11
v_add_u32 v16, s55, v8
v_cndmask_b32 v15, v255, v15, vcc
v_lshl_add_u32 v17, v3, 4, s55
s_lshl_b32 s55, s3, 5
v_lshl_add_u32 v18, v2, 1, s55
v_lshrrev_b32 v30, 2, v2
v_lshlrev_b32 v31, 4, v3
v_add_u32 v32, 128, v31
v_cmp_eq_u32 vcc, 0, v30
s_nop 1
v_cndmask_b32 v232, v32, v31, vcc
v_cmp_eq_u32 vcc, 1, v30
s_nop 1
v_cndmask_b32 v233, v32, v31, vcc
v_cmp_eq_u32 vcc, 2, v30
s_nop 1
v_cndmask_b32 v234, v32, v31, vcc
v_cmp_eq_u32 vcc, 3, v30
s_nop 1
v_cndmask_b32 v235, v32, v31, vcc
v_lshrrev_b32 v30, 5, v1
v_and_b32 v31, 31, v1
v_lshlrev_b32 v31, 2, v31
v_lshl_add_u32 v236, v30, 12, v31
v_cmp_gt_u32 vcc, 32, v1
s_mul_i32 s46, s3, 20480
s_lshl_b32 s55, s44, 7
s_add_u32 s46, s46, s55
s_add_u32 s46, s46, 720896
v_cndmask_b32 v237, v255, v236, vcc
s_add_u32 s47, s46, 8192
s_add_u32 s48, s46, 16384
s_mov_b32 s54, 0xffffff00
s_waitcnt lgkmcnt(0)
s_barrier
v_and_b32 v30, 31, v1
v_lshlrev_b32 v30, 7, v30
s_mov_b32 s55, 393216
L_m_cp:
buffer_load_dwordx4 v[20:23], v30, s[4:7], s55 offen sc1
s_waitcnt vmcnt(0)
v_cmp_ne_u32 vcc, s40, v22
s_add_u32 s97, s97, 1
s_cmp_gt_u32 s97, 65536
s_cbranch_scc1 L_m_cok
s_cbranch_vccnz L_m_cp
L_m_cok:
v_max_f32_dpp v24, v20, v20 row_ror:8 row_mask:0xf bank_mask:0xf
s_nop 1
v_max_f32_dpp v24, v24, v24 row_ror:4 row_mask:0xf bank_mask:0xf
s_nop 1
v_max_f32_dpp v24, v24, v24 row_ror:2 row_mask:0xf bank_mask:0xf
s_nop 1
v_max_f32_dpp v24, v24, v24 row_ror:1 row_mask:0xf bank_mask:0xf
v_mov_b32 v25, v24
s_nop 1
v_permlane16_swap_b32 v24, v25
v_max_f32 v24, v24, v25
v_cmp_eq_f32 vcc, v24, v20
s_ff1_i32_b64 s45, vcc
s_and_b32 s45, s45, 31
s_lshl_b32 s55, s45, 11
s_add_u32 s55, s55, 458752
L_m_rp:
buffer_load_dwordx4 v[20:23], v14, s[4:7], s55 offen sc1
buffer_load_dwordx4 v[24:27], v15, s[4:7], s55 offen sc1
s_waitcnt vmcnt(0)
ds_write_b128 v16, v[20:23]
ds_write_b128 v16, v[24:27] offset:1024
v_max3_u32 v28, v20, v21, v22
v_max3_u32 v29, v23, v24, v25
v_max3_u32 v28, v28, v26, v27
v_max_u32 v28, v28, v29
v_cmp_eq_u32 vcc, -1, v28
s_add_u32 s97, s97, 1
s_cmp_gt_u32 s97, 65536
s_cbranch_scc1 L_m_rok
s_cbranch_vccnz L_m_rp
L_m_rok:
ds_read_b128 v[100:103], v17 offset:0
ds_read_b128 v[104:107], v17 offset:64
ds_read_b128 v[108:111], v17 offset:128
ds_read_b128 v[112:115], v17 offset:192
ds_read_b128 v[116:119], v17 offset:256
ds_read_b128 v[120:123], v17 offset:320
s_waitcnt lgkmcnt(5)
v_mfma_f32_16x16x32_bf16 v[32:35], v[100:103], a[0:3], 0
ds_read_b128 v[124:127], v17 offset:384
v_mfma_f32_16x16x32_bf16 v[36:39], v[100:103], a[80:83], 0
s_waitcnt lgkmcnt(5)
v_mfma_f32_16x16x32_bf16 v[32:35], v[104:107], a[4:7], v[32:35]
ds_read_b128 v[128:131], v17 offset:448
v_mfma_f32_16x16x32_bf16 v[36:39], v[104:107], a[84:87], v[36:39]
s_waitcnt lgkmcnt(5)
v_mfma_f32_16x16x32_bf16 v[32:35], v[108:111], a[8:11], v[32:35]
ds_read_b128 v[132:135], v17 offset:512
v_mfma_f32_16x16x32_bf16 v[36:39], v[108:111], a[88:91], v[36:39]
s_waitcnt lgkmcnt(5)
v_mfma_f32_16x16x32_bf16 v[32:35], v[112:115], a[12:15], v[32:35]
ds_read_b128 v[136:139], v17 offset:576
v_mfma_f32_16x16x32_bf16 v[36:39], v[112:115], a[92:95], v[36:39]
s_waitcnt lgkmcnt(5)
v_mfma_f32_16x16x32_bf16 v[32:35], v[116:119], a[16:19], v[32:35]
ds_read_b128 v[140:143], v17 offset:640
v_mfma_f32_16x16x32_bf16 v[36:39], v[116:119], a[96:99], v[36:39]
s_waitcnt lgkmcnt(5)
v_mfma_f32_16x16x32_bf16 v[32:35], v[120:123], a[20:23], v[32:35]
ds_read_b128 v[144:147], v17 offset:704
v_mfma_f32_16x16x32_bf16 v[36:39], v[120:123], a[100:103], v[36:39]
s_waitcnt lgkmcnt(5)
v_mfma_f32_16x16x32_bf16 v[32:35], v[124:127], a[24:27], v[32:35]
ds_read_b128 v[148:151], v17 offset:768
v_mfma_f32_16x16x32_bf16 v[36:39], v[124:127], a[104:107], v[36:39]
s_waitcnt lgkmcnt(5)
v_mfma_f32_16x16x32_bf16 v[32:35], v[128:131], a[28:31], v[32:35]
ds_read_b128 v[152:155], v17 offset:832
v_mfma_f32_16x16x32_bf16 v[36:39], v[128:131], a[108:111], v[36:39]
s_waitcnt lgkmcnt(5)
v_mfma_f32_16x16x32_bf16 v[32:35], v[132:135], a[32:35], v[32:35]
ds_read_b128 v[156:159], v17 offset:896
v_mfma_f32_16x16x32_bf16 v[36:39], v[132:135], a[112:115], v[36:39]
s_waitcnt lgkmcnt(5)
v_mfma_f32_16x16x32_bf16 v[32:35], v[136:139], a[36:39], v[32:35]
ds_read_b128 v[160:163], v17 offset:960
v_mfma_f32_16x16x32_bf16 v[36:39], v[136:139], a[116:119], v[36:39]
s_waitcnt lgkmcnt(5)
v_mfma_f32_16x16x32_bf16 v[32:35], v[140:143], a[40:43], v[32:35]
ds_read_b128 v[164:167], v17 offset:1024
v_mfma_f32_16x16x32_bf16 v[36:39], v[140:143], a[120:123], v[36:39]
s_waitcnt lgkmcnt(5)
v_mfma_f32_16x16x32_bf16 v[32:35], v[144:147], a[44:47], v[32:35]
ds_read_b128 v[168:171], v17 offset:1088
v_mfma_f32_16x16x32_bf16 v[36:39], v[144:147], a[124:127], v[36:39]
s_waitcnt lgkmcnt(5)
v_mfma_f32_16x16x32_bf16 v[32:35], v[148:151], a[48:51], v[32:35]
ds_read_b128 v[172:175], v17 offset:1152
v_mfma_f32_16x16x32_bf16 v[36:39], v[148:151], a[128:131], v[36:39]
s_waitcnt lgkmcnt(5)
v_mfma_f32_16x16x32_bf16 v[32:35], v[152:155], a[52:55], v[32:35]
ds_read_b128 v[176:179], v17 offset:1216
v_mfma_f32_16x16x32_bf16 v[36:39], v[152:155], a[132:135], v[36:39]
s_waitcnt lgkmcnt(5)
v_mfma_f32_16x16x32_bf16 v[32:35], v[156:159], a[56:59], v[32:35]
v_mfma_f32_16x16x32_bf16 v[36:39], v[156:159], a[136:139], v[36:39]
s_waitcnt lgkmcnt(4)
v_mfma_f32_16x16x32_bf16 v[32:35], v[160:163], a[60:63], v[32:35]
v_mfma_f32_16x16x32_bf16 v[36:39], v[160:163], a[140:143], v[36:39]
s_waitcnt lgkmcnt(3)
v_mfma_f32_16x16x32_bf16 v[32:35], v[164:167], a[64:67], v[32:35]
v_mfma_f32_16x16x32_bf16 v[36:39], v[164:167], a[144:147], v[36:39]
s_waitcnt lgkmcnt(2)
v_mfma_f32_16x16x32_bf16 v[32:35], v[168:171], a[68:71], v[32:35]
v_mfma_f32_16x16x32_bf16 v[36:39], v[168:171], a[148:151], v[36:39]
s_waitcnt lgkmcnt(1)
v_mfma_f32_16x16x32_bf16 v[32:35], v[172:175], a[72:75], v[32:35]
v_mfma_f32_16x16x32_bf16 v[36:39], v[172:175], a[152:155], v[36:39]
s_waitcnt lgkmcnt(0)
v_mfma_f32_16x16x32_bf16 v[32:35], v[176:179], a[76:79], v[32:35]
v_mfma_f32_16x16x32_bf16 v[36:39], v[176:179], a[156:159], v[36:39]
s_nop 6
v_mul_f32 v33, 0xbfb8aa3b, v32
v_exp_f32 v33, v33
s_nop 0
v_add_f32 v33, 1.0, v33
v_rcp_f32 v33, v33
s_nop 0
v_mul_f32 v32, v32, v33
v_mul_f32 v32, v32, v36
v_cvt_pk_bf16_f32 v32, v32, v32
ds_write_b16 v18, v32 offset:8192
s_waitcnt lgkmcnt(0)
s_barrier
ds_read_b128 v[40:43], v232 offset:8192
ds_read_b128 v[44:47], v232 offset:8256
ds_read_b128 v[48:51], v233 offset:8192
ds_read_b128 v[52:55], v233 offset:8256
ds_read_b128 v[56:59], v234 offset:8192
ds_read_b128 v[60:63], v234 offset:8256
ds_read_b128 v[64:67], v235 offset:8192
ds_read_b128 v[68:71], v235 offset:8256
s_waitcnt lgkmcnt(6)
v_mfma_f32_16x16x32_bf16 v[20:23], v[40:43], a[160:163], 0
v_mfma_f32_16x16x32_bf16 v[20:23], v[44:47], a[164:167], v[20:23]
s_waitcnt lgkmcnt(4)
v_mfma_f32_16x16x32_bf16 v[20:23], v[48:51], a[168:171], v[20:23]
v_mfma_f32_16x16x32_bf16 v[20:23], v[52:55], a[172:175], v[20:23]
s_waitcnt lgkmcnt(2)
v_mfma_f32_16x16x32_bf16 v[20:23], v[56:59], a[176:179], v[20:23]
v_mfma_f32_16x16x32_bf16 v[20:23], v[60:63], a[180:183], v[20:23]
s_waitcnt lgkmcnt(0)
v_mfma_f32_16x16x32_bf16 v[20:23], v[64:67], a[184:187], v[20:23]
v_mfma_f32_16x16x32_bf16 v[20:23], v[68:71], a[188:191], v[20:23]
v_mfma_f32_16x16x32_bf16 v[24:27], v[40:43], a[192:195], 0
v_mfma_f32_16x16x32_bf16 v[24:27], v[44:47], a[196:199], v[24:27]
v_mfma_f32_16x16x32_bf16 v[24:27], v[48:51], a[200:203], v[24:27]
v_mfma_f32_16x16x32_bf16 v[24:27], v[52:55], a[204:207], v[24:27]
v_mfma_f32_16x16x32_bf16 v[24:27], v[56:59], a[208:211], v[24:27]
v_mfma_f32_16x16x32_bf16 v[24:27], v[60:63], a[212:215], v[24:27]
v_mfma_f32_16x16x32_bf16 v[24:27], v[64:67], a[216:219], v[24:27]
v_mfma_f32_16x16x32_bf16 v[24:27], v[68:71], a[220:223], v[24:27]
v_mfma_f32_16x16x32_bf16 v[28:31], v[40:43], a[224:227], 0
v_mfma_f32_16x16x32_bf16 v[28:31], v[44:47], a[228:231], v[28:31]
v_mfma_f32_16x16x32_bf16 v[28:31], v[48:51], a[232:235], v[28:31]
v_mfma_f32_16x16x32_bf16 v[28:31], v[52:55], a[236:239], v[28:31]
v_and_or_b32 v20, v20, s54, v19
buffer_store_dword v20, v236, s[4:7], s46 offen sc1
s_nop 1
v_and_or_b32 v24, v24, s54, v19
buffer_store_dword v24, v236, s[4:7], s47 offen sc1
s_nop 1
v_and_or_b32 v28, v28, s54, v19
buffer_store_dword v28, v237, s[4:7], s48 offen sc1
s_branch L_fin
L_fz:
s_sub_u32 s55, s43, 28
s_lshl_b32 s55, s55, 2
s_add_u32 s55, s55, s3
s_mul_i32 s55, s55, 57344
v_lshlrev_b32 v30, 7, v1
buffer_load_dword v184, v30, s[24:27], s55 offen
s_add_u32 s55, s55, 8192
buffer_load_dword v185, v30, s[24:27], s55 offen
s_add_u32 s55, s55, 8192
buffer_load_dword v186, v30, s[24:27], s55 offen
s_add_u32 s55, s55, 8192
buffer_load_dword v187, v30, s[24:27], s55 offen
s_add_u32 s55, s55, 8192
buffer_load_dword v188, v30, s[24:27], s55 offen
s_add_u32 s55, s55, 8192
buffer_load_dword v189, v30, s[24:27], s55 offen
s_add_u32 s55, s55, 8192
buffer_load_dword v190, v30, s[24:27], s55 offen
s_add_u32 s55, s55, 8192
s_mov_b32 s46, s44
buffer_load_dword v191, v12, s[32:35], 0 offen
s_mov_b32 s55, 2621184
buffer_load_dword v192, v12, s[32:35], s55 offen
L_fz_u:
s_lshl_b32 s50, s46, 7
s_mul_i32 s55, s3, 61440
s_add_u32 s50, s50, s55
s_add_u32 s50, s50, 2560
s_add_u32 m0, s49, 0
s_nop 0
buffer_load_dwordx4 v4, s[16:19], s50 offen nt lds
s_add_u32 m0, m0, 4096
s_add_u32 s50, s50, 245760
buffer_load_dwordx4 v4, s[16:19], s50 offen nt lds
s_add_u32 m0, m0, 4096
s_add_u32 s50, s50, 245760
buffer_load_dwordx4 v4, s[16:19], s50 offen nt lds
s_add_u32 m0, m0, 4096
s_add_u32 s50, s50, 245760
buffer_load_dwordx4 v4, s[16:19], s50 offen nt lds
s_add_u32 m0, m0, 4096
s_add_u32 s50, s50, 245760
buffer_load_dwordx4 v4, s[16:19], s50 offen nt lds
s_add_u32 m0, m0, 4096
s_add_u32 s50, s50, 245760
buffer_load_dwordx4 v4, s[16:19], s50 offen nt lds
s_add_u32 m0, m0, 4096
s_add_u32 s50, s50, 245760
buffer_load_dwordx4 v4, s[16:19], s50 offen nt lds
s_add_u32 m0, m0, 4096
s_add_u32 s50, s50, 245760
buffer_load_dwordx4 v4, s[16:19], s50 offen nt lds
s_add_u32 m0, m0, 4096
s_add_u32 s50, s50, 245760
buffer_load_dwordx4 v4, s[16:19], s50 offen nt lds
s_add_u32 m0, m0, 4096
s_add_u32 s50, s50, 245760
buffer_load_dwordx4 v4, s[16:19], s50 offen nt lds
s_add_u32 m0, m0, 4096
s_add_u32 s50, s50, 245760
buffer_load_dwordx4 v4, s[16:19], s50 offen nt lds
s_add_u32 m0, m0, 4096
s_add_u32 s50, s50, 245760
buffer_load_dwordx4 v4, s[16:19], s50 offen nt lds
s_add_u32 m0, m0, 4096
s_add_u32 s50, s50, 245760
buffer_load_dwordx4 v4, s[16:19], s50 offen nt lds
s_add_u32 m0, m0, 4096
s_add_u32 s50, s50, 245760
buffer_load_dwordx4 v4, s[16:19], s50 offen nt lds
s_add_u32 m0, m0, 4096
s_add_u32 s50, s50, 245760
buffer_load_dwordx4 v4, s[16:19], s50 offen nt lds
s_add_u32 m0, m0, 4096
s_add_u32 s50, s50, 245760
buffer_load_dwordx4 v4, s[16:19], s50 offen nt lds
s_add_u32 m0, m0, 4096
s_add_u32 s50, s50, 245760
buffer_load_dwordx4 v4, s[16:19], s50 offen nt lds
s_add_u32 m0, m0, 4096
s_add_u32 s50, s50, 245760
buffer_load_dwordx4 v4, s[16:19], s50 offen nt lds
s_add_u32 m0, m0, 4096
s_add_u32 s50, s50, 245760
buffer_load_dwordx4 v4, s[16:19], s50 offen nt lds
s_add_u32 m0, m0, 4096
s_add_u32 s50, s50, 245760
buffer_load_dwordx4 v4, s[16:19], s50 offen nt lds
s_waitcnt vmcnt(0)
s_barrier
ds_read_b64_tr_b16 v[20:21], v6 offset:0
ds_read_b64_tr_b16 v[22:23], v6 offset:512
ds_read_b64_tr_b16 v[24:25], v6 offset:4096
ds_read_b64_tr_b16 v[26:27], v6 offset:4608
ds_read_b64_tr_b16 v[28:29], v6 offset:8192
ds_read_b64_tr_b16 v[30:31], v6 offset:8704
ds_read_b64_tr_b16 v[32:33], v6 offset:12288
ds_read_b64_tr_b16 v[34:35], v6 offset:12800
ds_read_b64_tr_b16 v[36:37], v6 offset:16384
ds_read_b64_tr_b16 v[38:39], v6 offset:16896
ds_read_b64_tr_b16 v[40:41], v6 offset:20480
ds_read_b64_tr_b16 v[42:43], v6 offset:20992
ds_read_b64_tr_b16 v[44:45], v6 offset:24576
ds_read_b64_tr_b16 v[46:47], v6 offset:25088
ds_read_b64_tr_b16 v[48:49], v6 offset:28672
ds_read_b64_tr_b16 v[50:51], v6 offset:29184
ds_read_b64_tr_b16 v[52:53], v6 offset:32768
ds_read_b64_tr_b16 v[54:55], v6 offset:33280
ds_read_b64_tr_b16 v[56:57], v6 offset:36864
ds_read_b64_tr_b16 v[58:59], v6 offset:37376
ds_read_b64_tr_b16 v[60:61], v7 offset:0
ds_read_b64_tr_b16 v[62:63], v7 offset:512
ds_read_b64_tr_b16 v[64:65], v7 offset:4096
ds_read_b64_tr_b16 v[66:67], v7 offset:4608
ds_read_b64_tr_b16 v[68:69], v7 offset:8192
ds_read_b64_tr_b16 v[70:71], v7 offset:8704
ds_read_b64_tr_b16 v[72:73], v7 offset:12288
ds_read_b64_tr_b16 v[74:75], v7 offset:12800
ds_read_b64_tr_b16 v[76:77], v7 offset:16384
ds_read_b64_tr_b16 v[78:79], v7 offset:16896
ds_read_b64_tr_b16 v[80:81], v7 offset:20480
ds_read_b64_tr_b16 v[82:83], v7 offset:20992
ds_read_b64_tr_b16 v[84:85], v7 offset:24576
ds_read_b64_tr_b16 v[86:87], v7 offset:25088
ds_read_b64_tr_b16 v[88:89], v7 offset:28672
ds_read_b64_tr_b16 v[90:91], v7 offset:29184
ds_read_b64_tr_b16 v[92:93], v7 offset:32768
ds_read_b64_tr_b16 v[94:95], v7 offset:33280
ds_read_b64_tr_b16 v[96:97], v7 offset:36864
ds_read_b64_tr_b16 v[98:99], v7 offset:37376
s_waitcnt lgkmcnt(0)
s_barrier
v_mfma_f32_16x16x32_bf16 v[180:183], v[100:103], v[20:23], 0
v_mfma_f32_16x16x32_bf16 v[180:183], v[104:107], v[24:27], v[180:183]
v_mfma_f32_16x16x32_bf16 v[180:183], v[108:111], v[28:31], v[180:183]
v_mfma_f32_16x16x32_bf16 v[180:183], v[112:115], v[32:35], v[180:183]
v_mfma_f32_16x16x32_bf16 v[180:183], v[116:119], v[36:39], v[180:183]
v_mfma_f32_16x16x32_bf16 v[180:183], v[120:123], v[40:43], v[180:183]
v_mfma_f32_16x16x32_bf16 v[180:183], v[124:127], v[44:47], v[180:183]
v_mfma_f32_16x16x32_bf16 v[180:183], v[128:131], v[48:51], v[180:183]
v_mfma_f32_16x16x32_bf16 v[180:183], v[132:135], v[52:55], v[180:183]
v_mfma_f32_16x16x32_bf16 v[180:183], v[136:139], v[56:59], v[180:183]
v_mfma_f32_16x16x32_bf16 v[180:183], v[140:143], v[60:63], v[180:183]
v_mfma_f32_16x16x32_bf16 v[180:183], v[144:147], v[64:67], v[180:183]
v_mfma_f32_16x16x32_bf16 v[180:183], v[148:151], v[68:71], v[180:183]
v_mfma_f32_16x16x32_bf16 v[180:183], v[152:155], v[72:75], v[180:183]
v_mfma_f32_16x16x32_bf16 v[180:183], v[156:159], v[76:79], v[180:183]
v_mfma_f32_16x16x32_bf16 v[180:183], v[160:163], v[80:83], v[180:183]
v_mfma_f32_16x16x32_bf16 v[180:183], v[164:167], v[84:87], v[180:183]
v_mfma_f32_16x16x32_bf16 v[180:183], v[168:171], v[88:91], v[180:183]
v_mfma_f32_16x16x32_bf16 v[180:183], v[172:175], v[92:95], v[180:183]
v_mfma_f32_16x16x32_bf16 v[180:183], v[176:179], v[96:99], v[180:183]
s_sub_u32 s55, s46, 20
s_cmp_lt_u32 s55, 10
s_cselect_b32 s55, 1.0, 0
s_lshl_b32 s56, s46, 8
s_lshl_b32 s57, s3, 6
s_add_u32 s56, s56, s57
s_add_u32 s56, s56, 65536
s_nop 0
v_cvt_pk_bf16_f32 v180, v180, v180
v_lshlrev_b32 v180, 16, v180
v_add_f32 v180, s55, v180
v_cvt_pk_bf16_f32 v180, v180, v180
v_lshl_or_b32 v180, v180, 16, v13
s_mov_b64 exec, 0xffff
buffer_store_dword v180, v12, s[4:7], s56 offen sc1
s_mov_b64 exec, -1
s_add_u32 s46, s46, 5
s_cmp_lt_u32 s46, 40
s_cbranch_scc1 L_fz_u
s_sub_u32 s46, s44, 27
s_lshl_b32 s46, s46, 2
s_add_u32 s46, s46, s3
v_cmp_gt_u32 vcc, 32, v1
v_lshlrev_b32 v14, 3, v1
v_and_b32 v15, 7, v1
v_cndmask_b32 v16, v255, v8, vcc
v_cndmask_b32 v250, 0, -1, vcc
v_lshlrev_b32 v15, 4, v15
s_mov_b32 s55, 68096
s_lshl_b32 s56, s46, 7
s_add_u32 s56, s56, 73216
s_mov_b32 s57, 0x05040100
buffer_load_dwordx2 v[44:45], v14, s[28:31], 0 offen
buffer_load_dwordx2 v[46:47], v14, s[28:31], 0 offen offset:512
buffer_load_dwordx2 v[48:49], v14, s[28:31], 0 offen offset:1024
L_fz_mp:
buffer_load_dwordx4 v[20:23], v8, s[4:7], s55 offen sc1
buffer_load_dwordx4 v[24:27], v8, s[4:7], s55 offen offset:1024 sc1
buffer_load_dwordx4 v[28:31], v16, s[4:7], s55 offen offset:2048 sc1
buffer_load_dwordx4 v[56:59], v15, s[4:7], s56 offen sc1
s_waitcnt vmcnt(0)
v_perm_b32 v32, v29, v28, s57
v_perm_b32 v33, v31, v30, s57
v_xor_b32 v32, s40, v32
v_xor_b32 v33, s40, v33
v_or_b32 v34, v32, v33
v_and_b32 v34, v34, v250
v_perm_b32 v32, v21, v20, s57
v_perm_b32 v33, v23, v22, s57
v_xor_b32 v32, s40, v32
v_xor_b32 v33, s40, v33
v_or3_b32 v34, v34, v32, v33
v_perm_b32 v32, v25, v24, s57
v_perm_b32 v33, v27, v26, s57
v_xor_b32 v32, s40, v32
v_xor_b32 v33, s40, v33
v_or3_b32 v34, v34, v32, v33
v_perm_b32 v32, v57, v56, s57
v_perm_b32 v33, v59, v58, s57
v_xor_b32 v32, s40, v32
v_xor_b32 v33, s40, v33
v_or3_b32 v34, v34, v32, v33
v_cmp_ne_u32 vcc, 0, v34
s_sleep 4
s_add_u32 s97, s97, 1
s_cmp_gt_u32 s97, 65536
s_cbranch_scc1 L_fz_mok
s_cbranch_vccnz L_fz_mp
L_fz_mok:
v_mov_b32 v60, 0
v_and_b32 v56, 0xffff0000, v56
v_and_b32 v57, 0xffff0000, v57
v_and_b32 v58, 0xffff0000, v58
v_and_b32 v59, 0xffff0000, v59
v_and_b32 v20, 0xffff0000, v20
v_lshlrev_b32 v32, 16, v44
v_fmac_f32 v60, v20, v32
v_and_b32 v21, 0xffff0000, v21
v_and_b32 v32, 0xffff0000, v44
v_fmac_f32 v60, v21, v32
v_and_b32 v22, 0xffff0000, v22
v_lshlrev_b32 v32, 16, v45
v_fmac_f32 v60, v22, v32
v_and_b32 v23, 0xffff0000, v23
v_and_b32 v32, 0xffff0000, v45
v_fmac_f32 v60, v23, v32
v_and_b32 v24, 0xffff0000, v24
v_lshlrev_b32 v32, 16, v46
v_fmac_f32 v60, v24, v32
v_and_b32 v25, 0xffff0000, v25
v_and_b32 v32, 0xffff0000, v46
v_fmac_f32 v60, v25, v32
v_and_b32 v26, 0xffff0000, v26
v_lshlrev_b32 v32, 16, v47
v_fmac_f32 v60, v26, v32
v_and_b32 v27, 0xffff0000, v27
v_and_b32 v32, 0xffff0000, v47
v_fmac_f32 v60, v27, v32
v_and_b32 v28, 0xffff0000, v28
v_lshlrev_b32 v32, 16, v48
v_fmac_f32 v60, v28, v32
v_and_b32 v29, 0xffff0000, v29
v_and_b32 v32, 0xffff0000, v48
v_fmac_f32 v60, v29, v32
v_and_b32 v30, 0xffff0000, v30
v_lshlrev_b32 v32, 16, v49
v_fmac_f32 v60, v30, v32
v_and_b32 v31, 0xffff0000, v31
v_and_b32 v32, 0xffff0000, v49
v_fmac_f32 v60, v31, v32
s_nop 1
v_add_f32_dpp v60, v60, v60 row_ror:8 row_mask:0xf bank_mask:0xf
s_nop 1
v_add_f32_dpp v60, v60, v60 row_ror:4 row_mask:0xf bank_mask:0xf
s_nop 1
v_add_f32_dpp v60, v60, v60 row_ror:2 row_mask:0xf bank_mask:0xf
s_nop 1
v_add_f32_dpp v60, v60, v60 row_ror:1 row_mask:0xf bank_mask:0xf
v_mov_b32 v61, v60
s_nop 1
v_permlane16_swap_b32 v60, v61
v_add_f32 v60, v60, v61
v_mov_b32 v61, v60
s_nop 1
v_permlane32_swap_b32 v60, v61
v_add_f32 v60, v60, v61
v_cmp_gt_u32 vcc, 24, v1
s_mul_i32 s47, s46, 86
s_lshr_b32 s47, s47, 8
v_cndmask_b32 v17, v255, v8, vcc
v_cndmask_b32 v250, 0, -1, vcc
s_lshl_b32 s48, s46, 12
s_add_u32 s48, s48, 720896
v_mov_b32 v18, 0
v_and_b32 v30, 31, v1
v_lshlrev_b32 v30, 7, v30
s_mov_b32 s55, 393216
L_f_cp:
buffer_load_dwordx4 v[20:23], v30, s[4:7], s55 offen sc1
s_waitcnt vmcnt(0)
v_cmp_ne_u32 vcc, s40, v22
s_add_u32 s97, s97, 1
s_cmp_gt_u32 s97, 65536
s_cbranch_scc1 L_f_cok
s_cbranch_vccnz L_f_cp
L_f_cok:
v_max_f32_dpp v24, v20, v20 row_ror:8 row_mask:0xf bank_mask:0xf
s_nop 1
v_max_f32_dpp v24, v24, v24 row_ror:4 row_mask:0xf bank_mask:0xf
s_nop 1
v_max_f32_dpp v24, v24, v24 row_ror:2 row_mask:0xf bank_mask:0xf
s_nop 1
v_max_f32_dpp v24, v24, v24 row_ror:1 row_mask:0xf bank_mask:0xf
v_mov_b32 v25, v24
s_nop 1
v_permlane16_swap_b32 v24, v25
v_max_f32 v24, v24, v25
v_cmp_eq_f32 vcc, v24, v20
s_ff1_i32_b64 s45, vcc
s_and_b32 s45, s45, 31
v_readlane_b32 s50, v21, s45
v_readlane_b32 s51, v23, s45
v_add_f32 v60, v60, v24
v_cvt_pk_bf16_f32 v60, v60, v60
v_lshlrev_b32 v60, 16, v60
v_mul_f32 v60, 0xbfb8aa3b, v60
v_exp_f32 v60, v60
s_lshl_b32 s55, s45, 12
s_add_u32 s56, s46, s47
s_lshl_b32 s56, s56, 7
s_add_u32 s55, s55, s56
s_add_u32 s55, s55, 524288
s_and_b32 s51, s51, 127
s_lshl_b32 s56, s51, 3
s_add_u32 s56, s56, s47
s_lshl_b32 s56, s56, 4
s_add_u32 s56, s56, 655360
v_add_f32 v60, 1.0, v60
v_rcp_f32 v60, v60
s_and_b32 s50, s50, 2047
s_mul_i32 s50, s50, 1280
s_lshl_b32 s57, s46, 6
s_add_u32 s50, s50, s57
v_mul_f32 v56, v56, v60
v_mul_f32 v57, v57, v60
v_mul_f32 v58, v58, v60
v_mul_f32 v59, v59, v60
L_fz_bp:
buffer_load_dwordx4 v[52:55], v15, s[4:7], s55 offen sc1
buffer_load_dword v62, v18, s[4:7], s56 offen sc1
s_waitcnt vmcnt(0)
v_perm_b32 v32, v53, v52, s98
v_perm_b32 v33, v55, v54, s99
v_bitop3_b32 v32, v32, v33, s40 bitop3:0x56
v_xor_b32 v33, s40, v62
v_or_b32 v32, v32, v33
v_cmp_ne_u32 vcc, 0, v32
s_add_u32 s97, s97, 1
s_cmp_gt_u32 s97, 65536
s_cbranch_scc1 L_fz_bok
s_cbranch_vccnz L_fz_bp
L_fz_bok:
s_mov_b32 s55, 0xffffff00
v_and_b32 v52, s55, v52
v_and_b32 v53, s55, v53
v_and_b32 v54, s55, v54
v_and_b32 v55, s55, v55
L_fz_yp:
buffer_load_dwordx4 v[20:23], v8, s[4:7], s48 offen offset:0 sc1
buffer_load_dwordx4 v[24:27], v8, s[4:7], s48 offen offset:1024 sc1
buffer_load_dwordx4 v[28:31], v8, s[4:7], s48 offen offset:2048 sc1
buffer_load_dwordx4 v[32:35], v17, s[4:7], s48 offen offset:3072 sc1
s_waitcnt vmcnt(0)
v_perm_b32 v36, v21, v20, s98
v_perm_b32 v37, v23, v22, s99
v_bitop3_b32 v38, v36, v37, s40 bitop3:0x56
v_perm_b32 v36, v25, v24, s98
v_perm_b32 v37, v27, v26, s99
v_bitop3_b32 v39, v36, v37, s40 bitop3:0x56
v_perm_b32 v36, v29, v28, s98
v_perm_b32 v37, v31, v30, s99
v_bitop3_b32 v40, v36, v37, s40 bitop3:0x56
v_perm_b32 v36, v33, v32, s98
v_perm_b32 v37, v35, v34, s99
v_bitop3_b32 v41, v36, v37, s40 bitop3:0x56
v_and_b32 v41, v41, v250
v_or3_b32 v38, v38, v39, v40
v_or_b32 v38, v38, v41
v_cmp_ne_u32 vcc, 0, v38
s_add_u32 s97, s97, 1
s_cmp_gt_u32 s97, 65536
s_cbranch_scc1 L_fz_yok
s_cbranch_vccnz L_fz_yp
L_fz_yok:
v_and_b32 v20, s55, v20
v_and_b32 v21, s55, v21
v_and_b32 v22, s55, v22
v_and_b32 v23, s55, v23
v_and_b32 v24, s55, v24
v_and_b32 v25, s55, v25
v_and_b32 v26, s55, v26
v_and_b32 v27, s55, v27
v_and_b32 v28, s55, v28
v_and_b32 v29, s55, v29
v_and_b32 v30, s55, v30
v_and_b32 v31, s55, v31
v_and_b32 v32, s55, v32
v_and_b32 v33, s55, v33
v_and_b32 v34, s55, v34
v_and_b32 v35, s55, v35
v_pk_add_f32 v[20:21], v[20:21], v[24:25]
v_pk_add_f32 v[22:23], v[22:23], v[26:27]
v_pk_add_f32 v[28:29], v[28:29], v[32:33]
v_pk_add_f32 v[30:31], v[30:31], v[34:35]
v_pk_add_f32 v[20:21], v[20:21], v[28:29]
v_pk_add_f32 v[22:23], v[22:23], v[30:31]
s_nop 0
v_add_f32_dpp v20, v20, v20 row_ror:8 row_mask:0xf bank_mask:0xf
v_add_f32_dpp v21, v21, v21 row_ror:8 row_mask:0xf bank_mask:0xf
v_add_f32_dpp v22, v22, v22 row_ror:8 row_mask:0xf bank_mask:0xf
v_add_f32_dpp v23, v23, v23 row_ror:8 row_mask:0xf bank_mask:0xf
v_mov_b32 v24, v20
v_mov_b32 v25, v21
v_mov_b32 v26, v22
v_mov_b32 v27, v23
v_permlane16_swap_b32 v20, v24
v_permlane16_swap_b32 v21, v25
v_permlane16_swap_b32 v22, v26
v_permlane16_swap_b32 v23, v27
v_pk_add_f32 v[20:21], v[20:21], v[24:25]
v_pk_add_f32 v[22:23], v[22:23], v[26:27]
v_mov_b32 v24, v20
v_mov_b32 v25, v21
v_mov_b32 v26, v22
v_mov_b32 v27, v23
v_permlane32_swap_b32 v20, v24
v_permlane32_swap_b32 v21, v25
v_permlane32_swap_b32 v22, v26
v_permlane32_swap_b32 v23, v27
v_pk_add_f32 v[20:21], v[20:21], v[24:25]
v_pk_add_f32 v[22:23], v[22:23], v[26:27]
v_pk_fma_f32 v[20:21], v[20:21], v[56:57], v[52:53]
v_pk_fma_f32 v[22:23], v[22:23], v[58:59], v[54:55]
v_cvt_pk_bf16_f32 v20, v20, v21
v_cvt_pk_bf16_f32 v21, v22, v23
s_mov_b64 exec, 0xff
buffer_store_dwordx2 v[20:21], v14, s[32:35], s50 offen sc1
s_cmp_eq_u32 s46, 0
s_cbranch_scc0 L_fz_e
s_add_u32 s55, s41, 1
v_mov_b32 v22, s55
s_mov_b64 exec, 1
buffer_store_dword v22, v18, s[4:7], 0 offen sc1
L_fz_e:
s_mov_b64 exec, -1
L_fin:
L_end:
s_endpgm
.fill (adaLN_cond__sliding_local_dilated__moe_arch_mod__prompt_kernel + 49664 - .) / 4, 4, 0xbf800000
.section .rodata,"a"
.p2align 6
.amdhsa_kernel adaLN_cond__sliding_local_dilated__moe_arch_mod__prompt_kernel
  .amdhsa_next_free_vgpr 512
  .amdhsa_next_free_sgpr 102
  .amdhsa_accum_offset 256
  .amdhsa_group_segment_fixed_size 0
  .amdhsa_kernarg_size 104
  .amdhsa_user_sgpr_count 2
  .amdhsa_user_sgpr_kernarg_segment_ptr 1
  .amdhsa_system_sgpr_workgroup_id_x 1
  .amdhsa_float_denorm_mode_32 3
  .amdhsa_float_denorm_mode_16_64 3
.end_amdhsa_kernel
```

```asm
; @launch grid=(256,1,1) block=(256,1,1) lds=163840
.amdgcn_target "amdgcn-amd-amdhsa--gfx950"
.text
.globl adaLN_cond__sliding_local_dilated__moe_arch_mod__prompt_kernel
.p2align 12
.type adaLN_cond__sliding_local_dilated__moe_arch_mod__prompt_kernel,@function
adaLN_cond__sliding_local_dilated__moe_arch_mod__prompt_kernel:
s_cmp_ge_u32 s2, 256
s_cbranch_scc1 L_end
s_load_dwordx4 s[8:11], s[0:1], 0
s_load_dwordx4 s[20:23], s[0:1], 64
s_load_dwordx2 s[4:5], s[0:1], 96
s_getpc_b64 s[48:49]
v_lshrrev_b32 v4, 6, v0
v_and_b32 v1, 63, v0
s_lshr_b32 s43, s2, 3
v_readfirstlane_b32 s3, v4
v_mad_u32_u24 v5, v4, 3, v1
s_mul_i32 s50, s43, 1536
v_lshl_add_u32 v5, v5, 7, s50
s_mov_b64 exec, 7
global_load_dword v19, v5, s[48:49]
s_mov_b64 exec, -1
s_and_b32 s42, s2, 7
v_and_b32 v2, 15, v1
v_lshrrev_b32 v3, 4, v1
v_mov_b32 v29, 0
s_mov_b32 s6, 8388608
s_mov_b32 s7, 0x20000
s_lshl_b32 s49, s3, 10
s_cmp_ge_u32 s2, 224
s_cbranch_scc1 L_svc
s_mov_b32 m0, s49
s_mov_b32 s15, 0x20000
s_cmp_lt_u32 s2, 160
s_cbranch_scc1 L_roleW
s_sub_u32 s50, s2, 160
s_mul_i32 s52, s50, 13
s_lshr_b32 s52, s52, 8
s_mul_i32 s53, s52, 20
s_sub_u32 s53, s50, s53
s_mul_i32 s51, s52, 28
s_add_u32 s51, s51, s3
s_mul_i32 s51, s51, 61440
s_lshl_b32 s54, s53, 7
s_add_u32 s51, s51, s54
s_mul_i32 s54, s52, 448
s_and_b32 s55, s3, 1
s_lshl_b32 s55, s55, 2
v_and_b32 v20, 1, v3
v_lshl_or_b32 v20, v20, 1, s55
v_and_b32 v21, 7, v1
v_xor_b32 v20, v20, v21
v_lshrrev_b32 v21, 3, v1
v_mul_u32_u24 v21, 480, v21
v_add_lshl_u32 v20, v20, v21, 4
v_lshlrev_b32 v28, 3, v1
s_mov_b32 s14, 4915200
s_mov_b32 s38, 0
s_waitcnt lgkmcnt(0)
s_mov_b32 s12, s22
s_mov_b32 s13, s23
s_mov_b32 s22, 1280
s_mov_b32 s23, 0x20000
buffer_load_dwordx2 v[40:41], v28, s[20:23], s54 offen
buffer_load_dwordx4 v20, s[12:15], s51 offen nt lds
s_add_u32 m0, m0, 4096
s_add_u32 s51, s51, 245760
buffer_load_dwordx4 v20, s[12:15], s51 offen nt lds
s_add_u32 m0, m0, 4096
s_add_u32 s51, s51, 245760
buffer_load_dwordx4 v20, s[12:15], s51 offen nt lds
s_add_u32 m0, m0, 4096
s_add_u32 s51, s51, 245760
buffer_load_dwordx4 v20, s[12:15], s51 offen nt lds
s_add_u32 m0, m0, 4096
s_add_u32 s51, s51, 245760
buffer_load_dwordx4 v20, s[12:15], s51 offen nt lds
s_add_u32 m0, m0, 4096
s_add_u32 s51, s51, 245760
buffer_load_dwordx4 v20, s[12:15], s51 offen nt lds
s_add_u32 m0, m0, 4096
s_add_u32 s51, s51, 245760
buffer_load_dwordx4 v20, s[12:15], s51 offen nt lds
s_lshl_b32 s22, s50, 8
s_lshl_b32 s23, s3, 6
s_add_u32 s22, s22, s23
s_add_u32 s22, s22, 4096
s_branch L_rolej
L_roleW:
s_mov_b32 s55, 640
v_lshlrev_b32 v24, 4, v0
v_mul_u32_u24 v26, 1639, v0
v_lshrrev_b32 v26, 16, v26
v_mad_u32_u24 v20, v26, s55, v24
v_add_u32 v25, 256, v0
v_add_u32 v24, 4096, v24
v_mul_u32_u24 v26, 1639, v25
v_lshrrev_b32 v26, 16, v26
v_mad_u32_u24 v21, v26, s55, v24
v_add_u32 v25, 512, v0
v_add_u32 v24, 4096, v24
v_mul_u32_u24 v26, 1639, v25
v_lshrrev_b32 v26, 16, v26
v_mad_u32_u24 v22, v26, s55, v24
v_add_u32 v25, 768, v0
v_add_u32 v24, 4096, v24
v_mul_u32_u24 v26, 1639, v25
v_lshrrev_b32 v26, 16, v26
v_mad_u32_u24 v23, v26, s55, v24
s_lshr_b32 s50, s2, 1
s_and_b32 s52, s2, 1
s_mul_i32 s51, s50, 30720
s_mul_i32 s53, s52, 640
s_add_u32 s51, s51, s53
s_mov_b32 s14, 2457600
s_mov_b32 s38, 8388608
s_waitcnt lgkmcnt(0)
s_mov_b32 s12, s10
s_mov_b32 s13, s11
buffer_load_dwordx4 v20, s[12:15], s51 offen nt lds
s_add_u32 m0, m0, 4096
s_nop 0
buffer_load_dwordx4 v21, s[12:15], s51 offen nt lds
s_add_u32 m0, m0, 4096
s_nop 0
buffer_load_dwordx4 v22, s[12:15], s51 offen nt lds
s_add_u32 m0, m0, 4096
s_nop 0
buffer_load_dwordx4 v23, s[12:15], s51 offen nt lds
L_rolej:
buffer_load_dword v42, v29, s[4:7], 0 offen sc1
s_mov_b32 s10, 2621440
s_mov_b32 s11, 0x20000
s_lshr_b32 s55, s42, 2
s_bfe_u32 s56, s42, 0x10001
s_mul_i32 s56, s56, 7
s_lshr_b32 s57, s43, 2
s_add_u32 s56, s56, s57
s_mul_i32 s57, s56, 73
s_lshl_b32 s45, s57, 1
s_add_u32 s45, s45, s55
s_mul_i32 s45, s45, 1280
s_and_b32 s63, s43, 1
s_mul_i32 s62, s63, 122880
s_add_u32 s61, s45, s62
v_lshrrev_b32 v5, 4, v0
v_mul_u32_u24 v4, 2560, v5
v_lshl_add_u32 v4, v2, 4, v4
s_load_dwordx2 s[24:25], s[0:1], 16
s_load_dwordx2 s[28:29], s[0:1], 32
s_load_dwordx2 s[32:33], s[0:1], 80
s_mov_b32 s26, 819200
s_mov_b32 s27, 0x20000
s_mov_b32 s30, 1280
s_mov_b32 s31, 0x20000
s_mov_b32 s34, 2621440
s_mov_b32 s35, 0x20000
s_mov_b32 s36, s4
s_mov_b32 s37, s5
s_mov_b32 s39, 0x20000
s_mov_b32 s97, 0
s_mov_b32 s98, 0x0c0c0400
s_mov_b32 s99, 0x04000c0c
v_mov_b32 v255, 1073741824
v_bfe_u32 v30, v1, 2, 2
v_and_b32 v31, 3, v1
v_max_u32 v32, 1, v31
v_add_u32 v32, -1, v32
v_cmp_eq_u32 vcc, 3, v3
v_lshlrev_b32 v33, 3, v31
v_mul_u32_u24 v30, 3, v30
v_cndmask_b32 v32, v3, v32, vcc
v_cndmask_b32 v33, v33, 32, vcc
v_add_u32 v30, v30, v32
v_mul_u32_u24 v30, 640, v30
s_mul_i32 s58, s3, 160
v_add3_u32 v20, v30, v33, s58
buffer_load_dwordx4 v[100:103], v4, s[8:11], s61 offen offset:0
v_lshlrev_b32 v22, 4, v1
s_lshl_b32 s52, s52, 2
s_add_u32 s52, s52, s3
s_mul_i32 s52, s52, 80
s_add_u32 s52, s52, s50
s_lshl_b32 s51, s52, 12
s_add_u32 s51, s51, 1048576
s_lshl_b32 s53, s52, 6
s_add_u32 s53, s53, 851968
s_and_b32 s44, s42, 1
s_lshl_b32 s44, s44, 2
s_and_b32 s58, s43, 3
s_add_u32 s44, s44, s58
s_mul_i32 s58, s43, 37
s_lshr_b32 s58, s58, 8
s_mul_i32 s60, s58, 7
s_sub_u32 s96, s43, s60
s_lshl_b32 s47, s42, 2
s_add_u32 s47, s47, s58
s_mul_i32 s58, s55, 14
s_add_u32 s100, s58, s56
s_lshl_b32 s100, s100, 3
s_add_u32 s100, s100, s44
buffer_load_dwordx4 v[104:107], v4, s[8:11], s61 offen offset:256
s_lshl_b32 s100, s100, 6
s_add_u32 s100, s100, 917504
s_and_b32 s60, s47, 15
s_lshl_b32 s60, s60, 6
s_max_u32 s60, s60, 7
s_sub_u32 s60, s60, 7
s_mul_i32 s60, s60, 899
s_lshr_b32 s60, s60, 16
s_min_u32 s60, s60, 12
s_add_u32 s60, s60, s58
s_lshl_b32 s101, s60, 3
s_bfe_u32 s60, s42, 0x10001
s_mul_i32 s60, s60, 7
s_add_u32 s60, s60, s58
s_lshl_b32 s60, s60, 1
s_and_b32 s58, s42, 1
s_add_u32 s60, s60, s58
s_lshl_b32 s21, s60, 2
s_sub_u32 s20, s43, s96
s_getreg_b32 s19, hwreg(HW_REG_XCC_ID, 0, 4)
s_cmp_eq_u32 s56, 0
s_cselect_b32 s58, 0, 7
s_add_u32 s58, s58, s57
s_add_u32 s60, s57, 80
buffer_load_dwordx4 v[108:111], v4, s[8:11], s61 offen offset:512
s_min_u32 s60, s60, 1024
s_sub_u32 s60, s60, s58
s_andn2_b32 s59, s58, 15
s_lshl_b32 s54, s55, 10
s_add_u32 s54, s54, s59
s_mul_i32 s46, s54, 1280
s_mul_i32 s54, s44, 2560
s_add_u32 s46, s46, s54
s_add_u32 s46, s46, 4194304
s_sub_u32 s54, s59, s58
s_sub_u32 s59, s58, s57
s_mov_b32 s58, 138240
v_add_u32 v30, 0, v0
v_mul_u32_u24 v31, 410, v30
v_lshrrev_b32 v31, 16, v31
v_mul_u32_u24 v32, 17920, v31
v_lshl_add_u32 v32, v30, 4, v32
v_lshl_add_u32 v33, v31, 4, v2
v_add_u32 v33, s54, v33
v_cmp_gt_u32 vcc, s60, v33
v_add_u32 v33, s59, v33
v_mul_u32_u24 v34, 160, v31
v_cndmask_b32 v11, v255, v32, vcc
buffer_load_dwordx4 v[112:115], v4, s[8:11], s61 offen offset:768
v_cndmask_b32 v33, 0, v33, vcc
v_sub_u32 v34, v30, v34
v_and_b32 v34, 0xf0, v34
v_mul_u32_u24 v33, 176, v33
v_add3_u32 v15, v33, v34, s58
v_add_u32 v30, 256, v0
v_mul_u32_u24 v31, 410, v30
v_lshrrev_b32 v31, 16, v31
v_mul_u32_u24 v32, 17920, v31
v_lshl_add_u32 v32, v30, 4, v32
v_lshl_add_u32 v33, v31, 4, v2
v_add_u32 v33, s54, v33
v_cmp_gt_u32 vcc, s60, v33
v_add_u32 v33, s59, v33
v_mul_u32_u24 v34, 160, v31
v_cndmask_b32 v12, v255, v32, vcc
v_cndmask_b32 v33, 0, v33, vcc
v_sub_u32 v34, v30, v34
v_and_b32 v34, 0xf0, v34
v_mul_u32_u24 v33, 176, v33
v_add3_u32 v16, v33, v34, s58
v_add_u32 v30, 512, v0
v_mul_u32_u24 v31, 410, v30
v_lshrrev_b32 v31, 16, v31
buffer_load_dwordx4 v[116:119], v4, s[8:11], s61 offen offset:1024
s_add_u32 s61, s61, 40960
v_mul_u32_u24 v32, 17920, v31
v_lshl_add_u32 v32, v30, 4, v32
v_lshl_add_u32 v33, v31, 4, v2
v_add_u32 v33, s54, v33
v_cmp_gt_u32 vcc, s60, v33
v_add_u32 v33, s59, v33
v_mul_u32_u24 v34, 160, v31
v_cndmask_b32 v13, v255, v32, vcc
v_cndmask_b32 v33, 0, v33, vcc
v_sub_u32 v34, v30, v34
v_and_b32 v34, 0xf0, v34
v_mul_u32_u24 v33, 176, v33
v_add3_u32 v17, v33, v34, s58
v_add_u32 v30, 768, v0
v_mul_u32_u24 v31, 410, v30
v_lshrrev_b32 v31, 16, v31
v_mul_u32_u24 v32, 17920, v31
v_lshl_add_u32 v32, v30, 4, v32
v_lshl_add_u32 v33, v31, 4, v2
v_add_u32 v33, s54, v33
v_cmp_gt_u32 vcc, s60, v33
v_add_u32 v33, s59, v33
v_mul_u32_u24 v34, 160, v31
v_cndmask_b32 v14, v255, v32, vcc
buffer_load_dwordx4 v[120:123], v4, s[8:11], s61 offen offset:0
v_cndmask_b32 v33, 0, v33, vcc
v_sub_u32 v34, v30, v34
v_and_b32 v34, 0xf0, v34
v_mul_u32_u24 v33, 176, v33
v_add3_u32 v18, v33, v34, s58
s_mul_i32 s58, s3, 80
v_add_u32 v30, s58, v1
v_cmp_gt_u32 vcc, 16, v1
v_lshlrev_b32 v248, 4, v30
v_add_u32 v249, 1024, v248
v_add_u32 v251, 158720, v248
v_cndmask_b32 v249, v255, v249, vcc
v_cndmask_b32 v250, 0, -1, vcc
v_cmp_le_u32 vcc, 160, v30
v_min_u32 v247, 19, v1
v_lshlrev_b32 v247, 6, v247
v_cndmask_b32 v252, 0, 1.0, vcc
v_cmp_gt_u32 vcc, 4, v1
s_mov_b32 s56, 4096
s_mov_b32 s57, 9216
v_cndmask_b32 v246, v255, v22, vcc
s_mul_i32 s60, s44, 5120
s_mul_i32 s58, s3, 1280
buffer_load_dwordx4 v[124:127], v4, s[8:11], s61 offen offset:256
s_add_u32 s60, s60, s58
s_add_u32 s60, s60, 851968
s_mov_b32 s58, 14336
v_lshlrev_b32 v30, 12, v3
v_lshl_add_u32 v30, v2, 4, v30
v_add_u32 v5, s49, v30
v_lshrrev_b32 v32, 2, v2
v_cmp_ne_u32 vcc, 1, v32
v_lshrrev_b32 v30, 4, v0
v_and_b32 v31, 7, v2
v_cndmask_b32 v6, v255, v5, vcc
v_xor_b32 v30, v30, v31
v_lshlrev_b32 v30, 4, v30
v_and_b32 v33, 3, v2
v_lshl_add_u32 v30, v33, 8, v30
v_mul_u32_u24 v32, 5120, v32
s_mov_b32 s54, 56320
v_add3_u32 v253, v30, v32, s54
s_mul_i32 s63, s63, 3072
v_add_u32 v7, s63, v253
v_subrev_u32 v254, s63, v253
v_xor_b32 v30, v2, v3
v_lshlrev_b32 v30, 4, v30
v_lshl_add_u32 v8, v3, 8, v30
buffer_load_dwordx4 v[128:131], v4, s[8:11], s61 offen offset:512
v_xor_b32 v9, 64, v8
v_add_u32 v8, s54, v8
v_add_u32 v9, s54, v9
v_lshlrev_b32 v10, 5, v2
v_add_u32 v10, 158720, v10
s_mul_i32 s59, s44, 327680
s_add_u32 s59, s59, 1048576
s_cmp_eq_u32 s96, 6
s_cselect_b32 s16, 8, 12
s_cselect_b32 s17, 16, 24
s_lshl_b32 s18, s47, 11
s_lshl_b32 s23, s96, 8
s_add_u32 s18, s18, s23
s_lshl_b32 s23, s3, 6
s_add_u32 s18, s18, s23
s_add_u32 s18, s18, 458752
v_accvgpr_write_b32 a232, -1
v_accvgpr_write_b32 a233, -1
v_accvgpr_write_b32 a234, -1
v_accvgpr_write_b32 a235, -1
v_add_u32 v228, 0, v1
v_mul_u32_u24 v229, 5462, v228
v_lshrrev_b32 v229, 16, v229
buffer_load_dwordx4 v[132:135], v4, s[8:11], s61 offen offset:768
v_mul_u32_u24 v230, 12, v229
v_sub_u32 v228, v228, v230
v_cmp_gt_u32 vcc, s16, v228
v_mul_u32_u24 v230, 2560, v229
v_lshl_add_u32 v230, v228, 4, v230
v_subrev_u32 v230, 0, v230
v_cndmask_b32 v235, v255, v230, vcc
v_lshrrev_b32 v230, 3, v229
v_lshlrev_b32 v230, 1, v230
v_xor_b32 v228, v228, v230
v_mul_u32_u24 v230, 1280, v229
v_lshl_add_u32 v230, v228, 4, v230
v_subrev_u32 v230, 0, v230
v_cndmask_b32 v232, v255, v230, vcc
v_add_u32 v228, 64, v1
v_mul_u32_u24 v229, 5462, v228
v_lshrrev_b32 v229, 16, v229
v_mul_u32_u24 v230, 12, v229
v_sub_u32 v228, v228, v230
v_cmp_gt_u32 vcc, s16, v228
v_mul_u32_u24 v230, 2560, v229
v_lshl_add_u32 v230, v228, 4, v230
v_subrev_u32 v230, 1024, v230
v_cndmask_b32 v236, v255, v230, vcc
buffer_load_dwordx4 v[136:139], v4, s[8:11], s61 offen offset:1024
s_add_u32 s61, s45, 81920
v_lshrrev_b32 v230, 3, v229
v_lshlrev_b32 v230, 1, v230
v_xor_b32 v228, v228, v230
v_mul_u32_u24 v230, 1280, v229
v_lshl_add_u32 v230, v228, 4, v230
v_subrev_u32 v230, 1024, v230
v_cndmask_b32 v233, v255, v230, vcc
v_add_u32 v228, 128, v1
v_mul_u32_u24 v229, 5462, v228
v_lshrrev_b32 v229, 16, v229
v_mul_u32_u24 v230, 12, v229
v_sub_u32 v228, v228, v230
v_cmp_gt_u32 vcc, s16, v228
v_mul_u32_u24 v230, 2560, v229
v_lshl_add_u32 v230, v228, 4, v230
v_subrev_u32 v230, 2048, v230
v_cndmask_b32 v237, v255, v230, vcc
v_lshrrev_b32 v230, 3, v229
v_lshlrev_b32 v230, 1, v230
v_xor_b32 v228, v228, v230
v_mul_u32_u24 v230, 1280, v229
v_lshl_add_u32 v230, v228, 4, v230
v_subrev_u32 v230, 2048, v230
v_cndmask_b32 v234, v255, v230, vcc
s_cmp_lt_u32 s2, 160
s_cbranch_scc1 L_procW
v_bfe_u32 v32, v1, 2, 2
v_lshrrev_b32 v33, 1, v32
v_and_b32 v34, 1, v3
v_lshl_or_b32 v33, v34, 1, v33
v_xor_b32 v33, s3, v33
v_and_b32 v34, 3, v1
v_lshlrev_b32 v34, 3, v34
v_lshl_add_u32 v33, v33, 5, v34
v_lshl_add_u32 v32, v3, 3, v32
v_lshl_add_u32 v20, v32, 7, v33
s_lshl_b32 s55, s3, 9
s_add_u32 s55, s55, 28672
v_add_u32 v28, s55, v28
v_lshl_add_u32 v21, v3, 4, s55
v_lshlrev_b32 v23, 2, v1
s_cmp_lt_u32 s2, 220
s_cselect_b32 s55, 16, 0
v_cmp_gt_u32 vcc, s55, v1
s_mov_b32 s54, 0xffffff00
s_waitcnt vmcnt(18)
v_cndmask_b32 v23, v255, v23, vcc
v_lshlrev_b32 v44, 16, v40
v_and_b32 v45, 0xffff0000, v40
v_lshlrev_b32 v46, 16, v41
v_and_b32 v47, 0xffff0000, v41
v_mul_f32 v48, 0xbfb8aa3b, v44
v_mul_f32 v49, 0xbfb8aa3b, v45
v_mul_f32 v50, 0xbfb8aa3b, v46
v_mul_f32 v51, 0xbfb8aa3b, v47
v_exp_f32 v48, v48
v_exp_f32 v49, v49
v_exp_f32 v50, v50
v_exp_f32 v51, v51
v_add_f32 v48, 1.0, v48
v_add_f32 v49, 1.0, v49
v_add_f32 v50, 1.0, v50
v_add_f32 v51, 1.0, v51
v_rcp_f32 v48, v48
v_rcp_f32 v49, v49
v_rcp_f32 v50, v50
v_rcp_f32 v51, v51
v_mul_f32 v44, v44, v48
v_mul_f32 v45, v45, v49
v_mul_f32 v46, v46, v50
v_mul_f32 v47, v47, v51
v_cvt_pk_bf16_f32 v40, v44, v45
v_cvt_pk_bf16_f32 v41, v46, v47
ds_write_b64 v28, v[40:41]
s_waitcnt lgkmcnt(0)
ds_read_b128 v[200:203], v21 offset:0
ds_read_b128 v[204:207], v21 offset:64
ds_read_b128 v[208:211], v21 offset:128
ds_read_b128 v[212:215], v21 offset:192
ds_read_b128 v[216:219], v21 offset:256
ds_read_b128 v[220:223], v21 offset:320
ds_read_b128 v[224:227], v21 offset:384
s_waitcnt vmcnt(10)
v_readfirstlane_b32 s41, v42
s_barrier
ds_read_b64_tr_b16 v[60:61], v20 offset:0
ds_read_b64_tr_b16 v[62:63], v20 offset:512
ds_read_b64_tr_b16 v[64:65], v20 offset:4096
ds_read_b64_tr_b16 v[66:67], v20 offset:4608
ds_read_b64_tr_b16 v[68:69], v20 offset:8192
ds_read_b64_tr_b16 v[70:71], v20 offset:8704
ds_read_b64_tr_b16 v[72:73], v20 offset:12288
ds_read_b64_tr_b16 v[74:75], v20 offset:12800
ds_read_b64_tr_b16 v[76:77], v20 offset:16384
ds_read_b64_tr_b16 v[78:79], v20 offset:16896
ds_read_b64_tr_b16 v[80:81], v20 offset:20480
ds_read_b64_tr_b16 v[82:83], v20 offset:20992
ds_read_b64_tr_b16 v[84:85], v20 offset:24576
ds_read_b64_tr_b16 v[86:87], v20 offset:25088
s_mul_i32 s40, s41, 0x9E3779B1
s_add_u32 s40, s40, 0x85EBCA6B
v_and_b32 v31, 3, v1
v_lshlrev_b32 v30, 3, v31
v_lshrrev_b32 v19, v30, s40
v_and_b32 v19, 0xff, v19
v_mov_b32 v240, s40
v_mov_b32 v241, s40
v_mov_b32 v242, s40
v_mov_b32 v243, s40
s_waitcnt lgkmcnt(12)
v_mfma_f32_16x16x32_bf16 v[56:59], v[200:203], v[60:63], 0
s_waitcnt lgkmcnt(10)
v_mfma_f32_16x16x32_bf16 v[56:59], v[204:207], v[64:67], v[56:59]
s_waitcnt lgkmcnt(8)
v_mfma_f32_16x16x32_bf16 v[56:59], v[208:211], v[68:71], v[56:59]
s_waitcnt lgkmcnt(6)
v_mfma_f32_16x16x32_bf16 v[56:59], v[212:215], v[72:75], v[56:59]
s_waitcnt lgkmcnt(4)
v_mfma_f32_16x16x32_bf16 v[56:59], v[216:219], v[76:79], v[56:59]
s_waitcnt lgkmcnt(2)
v_mfma_f32_16x16x32_bf16 v[56:59], v[220:223], v[80:83], v[56:59]
s_waitcnt lgkmcnt(0)
v_mfma_f32_16x16x32_bf16 v[56:59], v[224:227], v[84:87], v[56:59]
s_nop 7
v_and_or_b32 v56, v56, s54, v19
buffer_store_dword v56, v23, s[4:7], s22 offen sc1
buffer_store_dword v56, v23, s[36:39], 0 offen
buffer_store_dword v56, v23, s[36:39], 0 offen
buffer_store_dword v56, v23, s[36:39], 0 offen
s_branch L_procj
L_procW:
s_waitcnt vmcnt(10)
v_readfirstlane_b32 s41, v42
s_waitcnt lgkmcnt(0)
s_barrier
ds_read_b64_tr_b16 v[44:45], v20 offset:0
ds_read_b64_tr_b16 v[46:47], v20 offset:7680
ds_read_b64_tr_b16 v[48:49], v20 offset:40
ds_read_b64_tr_b16 v[50:51], v20 offset:7720
ds_read_b64_tr_b16 v[52:53], v20 offset:80
ds_read_b64_tr_b16 v[54:55], v20 offset:7760
ds_read_b64_tr_b16 v[56:57], v20 offset:120
ds_read_b64_tr_b16 v[58:59], v20 offset:7800
s_mul_i32 s40, s41, 0x9E3779B1
s_add_u32 s40, s40, 0x85EBCA6B
v_and_b32 v31, 3, v1
v_lshlrev_b32 v30, 3, v31
v_lshrrev_b32 v19, v30, s40
v_and_b32 v19, 0xff, v19
v_mov_b32 v240, s40
v_mov_b32 v241, s40
v_mov_b32 v242, s40
v_mov_b32 v243, s40
s_waitcnt lgkmcnt(6)
buffer_store_dwordx4 v[44:47], v22, s[36:39], s51 offen offset:0 sc1
s_waitcnt lgkmcnt(4)
buffer_store_dwordx4 v[48:51], v22, s[36:39], s51 offen offset:1024 sc1
s_waitcnt lgkmcnt(2)
buffer_store_dwordx4 v[52:55], v22, s[36:39], s51 offen offset:2048 sc1
s_waitcnt lgkmcnt(0)
buffer_store_dwordx4 v[56:59], v22, s[36:39], s51 offen offset:3072 sc1
L_procj:
buffer_load_dwordx4 v[140:143], v4, s[8:11], s61 offen offset:0
s_waitcnt vmcnt(10)
s_mov_b32 s55, 0x3f803f80
v_mov_b32 v20, 0
v_mov_b32 v21, 0
v_dot2c_f32_bf16 v20, s55, v100
v_dot2c_f32_bf16 v21, v100, v100
v_dot2c_f32_bf16 v20, s55, v101
v_dot2c_f32_bf16 v21, v101, v101
v_dot2c_f32_bf16 v20, s55, v102
v_dot2c_f32_bf16 v21, v102, v102
v_dot2c_f32_bf16 v20, s55, v103
v_dot2c_f32_bf16 v21, v103, v103
v_dot2c_f32_bf16 v20, s55, v104
v_dot2c_f32_bf16 v21, v104, v104
v_dot2c_f32_bf16 v20, s55, v105
v_dot2c_f32_bf16 v21, v105, v105
buffer_load_dwordx4 v[144:147], v4, s[8:11], s61 offen offset:256
v_dot2c_f32_bf16 v20, s55, v106
v_dot2c_f32_bf16 v21, v106, v106
v_dot2c_f32_bf16 v20, s55, v107
v_dot2c_f32_bf16 v21, v107, v107
v_dot2c_f32_bf16 v20, s55, v108
v_dot2c_f32_bf16 v21, v108, v108
v_dot2c_f32_bf16 v20, s55, v109
v_dot2c_f32_bf16 v21, v109, v109
v_dot2c_f32_bf16 v20, s55, v110
v_dot2c_f32_bf16 v21, v110, v110
v_dot2c_f32_bf16 v20, s55, v111
v_dot2c_f32_bf16 v21, v111, v111
v_dot2c_f32_bf16 v20, s55, v112
v_dot2c_f32_bf16 v21, v112, v112
v_dot2c_f32_bf16 v20, s55, v113
v_dot2c_f32_bf16 v21, v113, v113
v_dot2c_f32_bf16 v20, s55, v114
buffer_load_dwordx4 v[148:151], v4, s[8:11], s61 offen offset:512
v_dot2c_f32_bf16 v21, v114, v114
v_dot2c_f32_bf16 v20, s55, v115
v_dot2c_f32_bf16 v21, v115, v115
v_dot2c_f32_bf16 v20, s55, v116
v_dot2c_f32_bf16 v21, v116, v116
v_dot2c_f32_bf16 v20, s55, v117
v_dot2c_f32_bf16 v21, v117, v117
v_dot2c_f32_bf16 v20, s55, v118
v_dot2c_f32_bf16 v21, v118, v118
v_dot2c_f32_bf16 v20, s55, v119
v_dot2c_f32_bf16 v21, v119, v119
v_and_b32 v25, 0xffff0000, v100
v_and_b32 v27, 0xffff0000, v101
v_add_f32_dpp v20, v20, v20 row_ror:8 row_mask:0xf bank_mask:0xf
v_add_f32_dpp v21, v21, v21 row_ror:8 row_mask:0xf bank_mask:0xf
v_lshlrev_b32 v24, 16, v100
v_add_f32_dpp v20, v20, v20 row_ror:4 row_mask:0xf bank_mask:0xf
buffer_load_dwordx4 v[152:155], v4, s[8:11], s61 offen offset:768
v_add_f32_dpp v21, v21, v21 row_ror:4 row_mask:0xf bank_mask:0xf
v_lshlrev_b32 v26, 16, v101
v_add_f32_dpp v20, v20, v20 row_ror:2 row_mask:0xf bank_mask:0xf
v_add_f32_dpp v21, v21, v21 row_ror:2 row_mask:0xf bank_mask:0xf
v_lshlrev_b32 v28, 16, v102
v_add_f32_dpp v20, v20, v20 row_ror:1 row_mask:0xf bank_mask:0xf
v_add_f32_dpp v21, v21, v21 row_ror:1 row_mask:0xf bank_mask:0xf
v_mul_f32 v20, 0x3acccccd, v20
v_mul_f32 v21, 0x3acccccd, v21
v_fma_f32 v21, -v20, v20, v21
v_max_f32 v21, 0, v21
v_add_f32 v21, 0x3727c5ac, v21
v_rsq_f32 v22, v21
v_and_b32 v29, 0xffff0000, v102
v_mul_f32 v23, -v20, v22
v_pk_fma_f32 v[24:25], v[24:25], v[22:23], v[22:23] op_sel:[0,0,1] op_sel_hi:[1,0,1]
buffer_load_dwordx4 v[156:159], v4, s[8:11], s61 offen offset:1024
s_sub_u32 s61, s45, s62
s_add_u32 s61, s61, 122880
v_pk_fma_f32 v[26:27], v[26:27], v[22:23], v[22:23] op_sel:[0,0,1] op_sel_hi:[1,0,1]
v_cvt_pk_f16_f32 v100, v24, v25
v_pk_fma_f32 v[28:29], v[28:29], v[22:23], v[22:23] op_sel:[0,0,1] op_sel_hi:[1,0,1]
v_cvt_pk_f16_f32 v101, v26, v27
v_lshlrev_b32 v30, 16, v103
v_and_b32 v31, 0xffff0000, v103
v_pk_fma_f32 v[30:31], v[30:31], v[22:23], v[22:23] op_sel:[0,0,1] op_sel_hi:[1,0,1]
v_cvt_pk_f16_f32 v102, v28, v29
v_lshlrev_b32 v24, 16, v104
v_and_b32 v25, 0xffff0000, v104
v_pk_fma_f32 v[24:25], v[24:25], v[22:23], v[22:23] op_sel:[0,0,1] op_sel_hi:[1,0,1]
v_cvt_pk_f16_f32 v103, v30, v31
v_lshlrev_b32 v26, 16, v105
v_and_b32 v27, 0xffff0000, v105
v_pk_fma_f32 v[26:27], v[26:27], v[22:23], v[22:23] op_sel:[0,0,1] op_sel_hi:[1,0,1]
v_cvt_pk_f16_f32 v104, v24, v25
v_lshlrev_b32 v28, 16, v106
v_and_b32 v29, 0xffff0000, v106
v_pk_fma_f32 v[28:29], v[28:29], v[22:23], v[22:23] op_sel:[0,0,1] op_sel_hi:[1,0,1]
v_cvt_pk_f16_f32 v105, v26, v27
v_lshlrev_b32 v30, 16, v107
v_and_b32 v31, 0xffff0000, v107
v_pk_fma_f32 v[30:31], v[30:31], v[22:23], v[22:23] op_sel:[0,0,1] op_sel_hi:[1,0,1]
v_cvt_pk_f16_f32 v106, v28, v29
v_lshlrev_b32 v24, 16, v108
v_and_b32 v25, 0xffff0000, v108
v_pk_fma_f32 v[24:25], v[24:25], v[22:23], v[22:23] op_sel:[0,0,1] op_sel_hi:[1,0,1]
v_cvt_pk_f16_f32 v107, v30, v31
v_lshlrev_b32 v26, 16, v109
v_and_b32 v27, 0xffff0000, v109
v_pk_fma_f32 v[26:27], v[26:27], v[22:23], v[22:23] op_sel:[0,0,1] op_sel_hi:[1,0,1]
v_cvt_pk_f16_f32 v108, v24, v25
v_lshlrev_b32 v28, 16, v110
v_and_b32 v29, 0xffff0000, v110
v_pk_fma_f32 v[28:29], v[28:29], v[22:23], v[22:23] op_sel:[0,0,1] op_sel_hi:[1,0,1]
v_cvt_pk_f16_f32 v109, v26, v27
v_lshlrev_b32 v30, 16, v111
v_and_b32 v31, 0xffff0000, v111
v_pk_fma_f32 v[30:31], v[30:31], v[22:23], v[22:23] op_sel:[0,0,1] op_sel_hi:[1,0,1]
v_cvt_pk_f16_f32 v110, v28, v29
v_lshlrev_b32 v24, 16, v112
v_and_b32 v25, 0xffff0000, v112
v_pk_fma_f32 v[24:25], v[24:25], v[22:23], v[22:23] op_sel:[0,0,1] op_sel_hi:[1,0,1]
v_cvt_pk_f16_f32 v111, v30, v31
v_lshlrev_b32 v26, 16, v113
v_and_b32 v27, 0xffff0000, v113
v_pk_fma_f32 v[26:27], v[26:27], v[22:23], v[22:23] op_sel:[0,0,1] op_sel_hi:[1,0,1]
v_cvt_pk_f16_f32 v112, v24, v25
v_lshlrev_b32 v28, 16, v114
v_and_b32 v29, 0xffff0000, v114
v_pk_fma_f32 v[28:29], v[28:29], v[22:23], v[22:23] op_sel:[0,0,1] op_sel_hi:[1,0,1]
v_cvt_pk_f16_f32 v113, v26, v27
v_lshlrev_b32 v30, 16, v115
v_and_b32 v31, 0xffff0000, v115
v_pk_fma_f32 v[30:31], v[30:31], v[22:23], v[22:23] op_sel:[0,0,1] op_sel_hi:[1,0,1]
v_cvt_pk_f16_f32 v114, v28, v29
v_lshlrev_b32 v24, 16, v116
v_and_b32 v25, 0xffff0000, v116
v_pk_fma_f32 v[24:25], v[24:25], v[22:23], v[22:23] op_sel:[0,0,1] op_sel_hi:[1,0,1]
v_cvt_pk_f16_f32 v115, v30, v31
v_lshlrev_b32 v26, 16, v117
v_and_b32 v27, 0xffff0000, v117
v_pk_fma_f32 v[26:27], v[26:27], v[22:23], v[22:23] op_sel:[0,0,1] op_sel_hi:[1,0,1]
v_cvt_pk_f16_f32 v116, v24, v25
v_lshlrev_b32 v28, 16, v118
v_and_b32 v29, 0xffff0000, v118
v_pk_fma_f32 v[28:29], v[28:29], v[22:23], v[22:23] op_sel:[0,0,1] op_sel_hi:[1,0,1]
v_cvt_pk_f16_f32 v117, v26, v27
v_lshlrev_b32 v30, 16, v119
v_and_b32 v31, 0xffff0000, v119
v_pk_fma_f32 v[30:31], v[30:31], v[22:23], v[22:23] op_sel:[0,0,1] op_sel_hi:[1,0,1]
v_cvt_pk_f16_f32 v118, v28, v29
v_cvt_pk_f16_f32 v119, v30, v31
s_waitcnt vmcnt(9)
s_mov_b32 s55, 0x3f803f80
v_mov_b32 v20, 0
v_mov_b32 v21, 0
v_dot2c_f32_bf16 v20, s55, v120
v_dot2c_f32_bf16 v21, v120, v120
v_dot2c_f32_bf16 v20, s55, v121
v_dot2c_f32_bf16 v21, v121, v121
v_dot2c_f32_bf16 v20, s55, v122
v_dot2c_f32_bf16 v21, v122, v122
v_dot2c_f32_bf16 v20, s55, v123
v_dot2c_f32_bf16 v21, v123, v123
v_dot2c_f32_bf16 v20, s55, v124
v_dot2c_f32_bf16 v21, v124, v124
v_dot2c_f32_bf16 v20, s55, v125
v_dot2c_f32_bf16 v21, v125, v125
v_dot2c_f32_bf16 v20, s55, v126
v_dot2c_f32_bf16 v21, v126, v126
v_dot2c_f32_bf16 v20, s55, v127
v_dot2c_f32_bf16 v21, v127, v127
v_dot2c_f32_bf16 v20, s55, v128
v_dot2c_f32_bf16 v21, v128, v128
v_dot2c_f32_bf16 v20, s55, v129
v_dot2c_f32_bf16 v21, v129, v129
v_dot2c_f32_bf16 v20, s55, v130
v_dot2c_f32_bf16 v21, v130, v130
v_dot2c_f32_bf16 v20, s55, v131
v_dot2c_f32_bf16 v21, v131, v131
v_dot2c_f32_bf16 v20, s55, v132
v_dot2c_f32_bf16 v21, v132, v132
v_dot2c_f32_bf16 v20, s55, v133
v_dot2c_f32_bf16 v21, v133, v133
v_dot2c_f32_bf16 v20, s55, v134
v_dot2c_f32_bf16 v21, v134, v134
v_dot2c_f32_bf16 v20, s55, v135
v_dot2c_f32_bf16 v21, v135, v135
v_dot2c_f32_bf16 v20, s55, v136
v_dot2c_f32_bf16 v21, v136, v136
v_dot2c_f32_bf16 v20, s55, v137
v_dot2c_f32_bf16 v21, v137, v137
v_dot2c_f32_bf16 v20, s55, v138
v_dot2c_f32_bf16 v21, v138, v138
v_dot2c_f32_bf16 v20, s55, v139
v_dot2c_f32_bf16 v21, v139, v139
v_and_b32 v25, 0xffff0000, v120
v_and_b32 v27, 0xffff0000, v121
v_add_f32_dpp v20, v20, v20 row_ror:8 row_mask:0xf bank_mask:0xf
v_add_f32_dpp v21, v21, v21 row_ror:8 row_mask:0xf bank_mask:0xf
v_lshlrev_b32 v24, 16, v120
v_add_f32_dpp v20, v20, v20 row_ror:4 row_mask:0xf bank_mask:0xf
v_add_f32_dpp v21, v21, v21 row_ror:4 row_mask:0xf bank_mask:0xf
v_lshlrev_b32 v26, 16, v121
v_add_f32_dpp v20, v20, v20 row_ror:2 row_mask:0xf bank_mask:0xf
v_add_f32_dpp v21, v21, v21 row_ror:2 row_mask:0xf bank_mask:0xf
v_lshlrev_b32 v28, 16, v122
v_add_f32_dpp v20, v20, v20 row_ror:1 row_mask:0xf bank_mask:0xf
v_add_f32_dpp v21, v21, v21 row_ror:1 row_mask:0xf bank_mask:0xf
v_mul_f32 v20, 0x3acccccd, v20
v_mul_f32 v21, 0x3acccccd, v21
v_fma_f32 v21, -v20, v20, v21
v_max_f32 v21, 0, v21
v_add_f32 v21, 0x3727c5ac, v21
v_rsq_f32 v22, v21
v_and_b32 v29, 0xffff0000, v122
v_mul_f32 v23, -v20, v22
v_pk_fma_f32 v[24:25], v[24:25], v[22:23], v[22:23] op_sel:[0,0,1] op_sel_hi:[1,0,1]
v_pk_fma_f32 v[26:27], v[26:27], v[22:23], v[22:23] op_sel:[0,0,1] op_sel_hi:[1,0,1]
v_cvt_pk_f16_f32 v120, v24, v25
v_pk_fma_f32 v[28:29], v[28:29], v[22:23], v[22:23] op_sel:[0,0,1] op_sel_hi:[1,0,1]
s_waitcnt vmcnt(5)
buffer_store_dwordx4 v[240:243], v246, s[36:39], s53 offen sc1
buffer_load_dwordx4 v[160:163], v4, s[8:11], s61 offen offset:0
v_cvt_pk_f16_f32 v121, v26, v27
v_lshlrev_b32 v30, 16, v123
v_and_b32 v31, 0xffff0000, v123
v_pk_fma_f32 v[30:31], v[30:31], v[22:23], v[22:23] op_sel:[0,0,1] op_sel_hi:[1,0,1]
v_cvt_pk_f16_f32 v122, v28, v29
v_lshlrev_b32 v24, 16, v124
v_and_b32 v25, 0xffff0000, v124
v_pk_fma_f32 v[24:25], v[24:25], v[22:23], v[22:23] op_sel:[0,0,1] op_sel_hi:[1,0,1]
v_cvt_pk_f16_f32 v123, v30, v31
v_lshlrev_b32 v26, 16, v125
v_and_b32 v27, 0xffff0000, v125
v_pk_fma_f32 v[26:27], v[26:27], v[22:23], v[22:23] op_sel:[0,0,1] op_sel_hi:[1,0,1]
v_cvt_pk_f16_f32 v124, v24, v25
v_lshlrev_b32 v28, 16, v126
buffer_load_dwordx4 v[164:167], v4, s[8:11], s61 offen offset:256
v_and_b32 v29, 0xffff0000, v126
v_pk_fma_f32 v[28:29], v[28:29], v[22:23], v[22:23] op_sel:[0,0,1] op_sel_hi:[1,0,1]
v_cvt_pk_f16_f32 v125, v26, v27
v_lshlrev_b32 v30, 16, v127
v_and_b32 v31, 0xffff0000, v127
v_pk_fma_f32 v[30:31], v[30:31], v[22:23], v[22:23] op_sel:[0,0,1] op_sel_hi:[1,0,1]
v_cvt_pk_f16_f32 v126, v28, v29
v_lshlrev_b32 v24, 16, v128
v_and_b32 v25, 0xffff0000, v128
v_pk_fma_f32 v[24:25], v[24:25], v[22:23], v[22:23] op_sel:[0,0,1] op_sel_hi:[1,0,1]
v_cvt_pk_f16_f32 v127, v30, v31
v_lshlrev_b32 v26, 16, v129
v_and_b32 v27, 0xffff0000, v129
v_pk_fma_f32 v[26:27], v[26:27], v[22:23], v[22:23] op_sel:[0,0,1] op_sel_hi:[1,0,1]
buffer_load_dwordx4 v[168:171], v4, s[8:11], s61 offen offset:512
v_cvt_pk_f16_f32 v128, v24, v25
v_lshlrev_b32 v28, 16, v130
v_and_b32 v29, 0xffff0000, v130
v_pk_fma_f32 v[28:29], v[28:29], v[22:23], v[22:23] op_sel:[0,0,1] op_sel_hi:[1,0,1]
v_cvt_pk_f16_f32 v129, v26, v27
v_lshlrev_b32 v30, 16, v131
v_and_b32 v31, 0xffff0000, v131
v_pk_fma_f32 v[30:31], v[30:31], v[22:23], v[22:23] op_sel:[0,0,1] op_sel_hi:[1,0,1]
v_cvt_pk_f16_f32 v130, v28, v29
v_lshlrev_b32 v24, 16, v132
v_and_b32 v25, 0xffff0000, v132
v_pk_fma_f32 v[24:25], v[24:25], v[22:23], v[22:23] op_sel:[0,0,1] op_sel_hi:[1,0,1]
v_cvt_pk_f16_f32 v131, v30, v31
v_lshlrev_b32 v26, 16, v133
buffer_load_dwordx4 v[172:175], v4, s[8:11], s61 offen offset:768
v_and_b32 v27, 0xffff0000, v133
v_pk_fma_f32 v[26:27], v[26:27], v[22:23], v[22:23] op_sel:[0,0,1] op_sel_hi:[1,0,1]
v_cvt_pk_f16_f32 v132, v24, v25
v_lshlrev_b32 v28, 16, v134
v_and_b32 v29, 0xffff0000, v134
v_pk_fma_f32 v[28:29], v[28:29], v[22:23], v[22:23] op_sel:[0,0,1] op_sel_hi:[1,0,1]
v_cvt_pk_f16_f32 v133, v26, v27
v_lshlrev_b32 v30, 16, v135
v_and_b32 v31, 0xffff0000, v135
v_pk_fma_f32 v[30:31], v[30:31], v[22:23], v[22:23] op_sel:[0,0,1] op_sel_hi:[1,0,1]
v_cvt_pk_f16_f32 v134, v28, v29
v_lshlrev_b32 v24, 16, v136
v_and_b32 v25, 0xffff0000, v136
v_pk_fma_f32 v[24:25], v[24:25], v[22:23], v[22:23] op_sel:[0,0,1] op_sel_hi:[1,0,1]
buffer_load_dwordx4 v[176:179], v4, s[8:11], s61 offen offset:1024
s_add_u32 s61, s61, 40960
v_cvt_pk_f16_f32 v135, v30, v31
v_lshlrev_b32 v26, 16, v137
v_and_b32 v27, 0xffff0000, v137
v_pk_fma_f32 v[26:27], v[26:27], v[22:23], v[22:23] op_sel:[0,0,1] op_sel_hi:[1,0,1]
v_cvt_pk_f16_f32 v136, v24, v25
v_lshlrev_b32 v28, 16, v138
v_and_b32 v29, 0xffff0000, v138
v_pk_fma_f32 v[28:29], v[28:29], v[22:23], v[22:23] op_sel:[0,0,1] op_sel_hi:[1,0,1]
v_cvt_pk_f16_f32 v137, v26, v27
v_lshlrev_b32 v30, 16, v139
v_and_b32 v31, 0xffff0000, v139
v_pk_fma_f32 v[30:31], v[30:31], v[22:23], v[22:23] op_sel:[0,0,1] op_sel_hi:[1,0,1]
v_cvt_pk_f16_f32 v138, v28, v29
v_cvt_pk_f16_f32 v139, v30, v31
s_waitcnt vmcnt(6)
s_mov_b32 s55, 0x3f803f80
buffer_load_dwordx4 v[180:183], v4, s[8:11], s61 offen offset:0
v_mov_b32 v20, 0
v_mov_b32 v21, 0
v_dot2c_f32_bf16 v20, s55, v140
v_dot2c_f32_bf16 v21, v140, v140
v_dot2c_f32_bf16 v20, s55, v141
v_dot2c_f32_bf16 v21, v141, v141
v_dot2c_f32_bf16 v20, s55, v142
v_dot2c_f32_bf16 v21, v142, v142
v_dot2c_f32_bf16 v20, s55, v143
v_dot2c_f32_bf16 v21, v143, v143
v_dot2c_f32_bf16 v20, s55, v144
v_dot2c_f32_bf16 v21, v144, v144
v_dot2c_f32_bf16 v20, s55, v145
v_dot2c_f32_bf16 v21, v145, v145
v_dot2c_f32_bf16 v20, s55, v146
v_dot2c_f32_bf16 v21, v146, v146
buffer_load_dwordx4 v[184:187], v4, s[8:11], s61 offen offset:256
v_dot2c_f32_bf16 v20, s55, v147
v_dot2c_f32_bf16 v21, v147, v147
v_dot2c_f32_bf16 v20, s55, v148
v_dot2c_f32_bf16 v21, v148, v148
v_dot2c_f32_bf16 v20, s55, v149
v_dot2c_f32_bf16 v21, v149, v149
v_dot2c_f32_bf16 v20, s55, v150
v_dot2c_f32_bf16 v21, v150, v150
v_dot2c_f32_bf16 v20, s55, v151
v_dot2c_f32_bf16 v21, v151, v151
v_dot2c_f32_bf16 v20, s55, v152
v_dot2c_f32_bf16 v21, v152, v152
v_dot2c_f32_bf16 v20, s55, v153
v_dot2c_f32_bf16 v21, v153, v153
v_dot2c_f32_bf16 v20, s55, v154
v_dot2c_f32_bf16 v21, v154, v154
v_dot2c_f32_bf16 v20, s55, v155
buffer_load_dwordx4 v[188:191], v4, s[8:11], s61 offen offset:512
v_dot2c_f32_bf16 v21, v155, v155
v_dot2c_f32_bf16 v20, s55, v156
v_dot2c_f32_bf16 v21, v156, v156
v_dot2c_f32_bf16 v20, s55, v157
v_dot2c_f32_bf16 v21, v157, v157
v_dot2c_f32_bf16 v20, s55, v158
v_dot2c_f32_bf16 v21, v158, v158
v_dot2c_f32_bf16 v20, s55, v159
v_dot2c_f32_bf16 v21, v159, v159
v_and_b32 v25, 0xffff0000, v140
v_and_b32 v27, 0xffff0000, v141
v_add_f32_dpp v20, v20, v20 row_ror:8 row_mask:0xf bank_mask:0xf
v_add_f32_dpp v21, v21, v21 row_ror:8 row_mask:0xf bank_mask:0xf
v_lshlrev_b32 v24, 16, v140
v_add_f32_dpp v20, v20, v20 row_ror:4 row_mask:0xf bank_mask:0xf
v_add_f32_dpp v21, v21, v21 row_ror:4 row_mask:0xf bank_mask:0xf
buffer_load_dwordx4 v[192:195], v4, s[8:11], s61 offen offset:768
v_lshlrev_b32 v26, 16, v141
v_add_f32_dpp v20, v20, v20 row_ror:2 row_mask:0xf bank_mask:0xf
v_add_f32_dpp v21, v21, v21 row_ror:2 row_mask:0xf bank_mask:0xf
v_lshlrev_b32 v28, 16, v142
v_add_f32_dpp v20, v20, v20 row_ror:1 row_mask:0xf bank_mask:0xf
v_add_f32_dpp v21, v21, v21 row_ror:1 row_mask:0xf bank_mask:0xf
v_mul_f32 v20, 0x3acccccd, v20
v_mul_f32 v21, 0x3acccccd, v21
v_fma_f32 v21, -v20, v20, v21
v_max_f32 v21, 0, v21
v_add_f32 v21, 0x3727c5ac, v21
v_rsq_f32 v22, v21
v_and_b32 v29, 0xffff0000, v142
v_mul_f32 v23, -v20, v22
v_pk_fma_f32 v[24:25], v[24:25], v[22:23], v[22:23] op_sel:[0,0,1] op_sel_hi:[1,0,1]
v_pk_fma_f32 v[26:27], v[26:27], v[22:23], v[22:23] op_sel:[0,0,1] op_sel_hi:[1,0,1]
buffer_load_dwordx4 v[196:199], v4, s[8:11], s61 offen offset:1024
v_cvt_pk_f16_f32 v140, v24, v25
v_pk_fma_f32 v[28:29], v[28:29], v[22:23], v[22:23] op_sel:[0,0,1] op_sel_hi:[1,0,1]
v_cvt_pk_f16_f32 v141, v26, v27
v_lshlrev_b32 v30, 16, v143
v_and_b32 v31, 0xffff0000, v143
v_pk_fma_f32 v[30:31], v[30:31], v[22:23], v[22:23] op_sel:[0,0,1] op_sel_hi:[1,0,1]
v_cvt_pk_f16_f32 v142, v28, v29
v_lshlrev_b32 v24, 16, v144
v_and_b32 v25, 0xffff0000, v144
v_pk_fma_f32 v[24:25], v[24:25], v[22:23], v[22:23] op_sel:[0,0,1] op_sel_hi:[1,0,1]
v_cvt_pk_f16_f32 v143, v30, v31
v_lshlrev_b32 v26, 16, v145
v_and_b32 v27, 0xffff0000, v145
v_pk_fma_f32 v[26:27], v[26:27], v[22:23], v[22:23] op_sel:[0,0,1] op_sel_hi:[1,0,1]
v_cvt_pk_f16_f32 v144, v24, v25
v_lshlrev_b32 v28, 16, v146
v_and_b32 v29, 0xffff0000, v146
v_pk_fma_f32 v[28:29], v[28:29], v[22:23], v[22:23] op_sel:[0,0,1] op_sel_hi:[1,0,1]
v_cvt_pk_f16_f32 v145, v26, v27
v_lshlrev_b32 v30, 16, v147
v_and_b32 v31, 0xffff0000, v147
v_pk_fma_f32 v[30:31], v[30:31], v[22:23], v[22:23] op_sel:[0,0,1] op_sel_hi:[1,0,1]
v_cvt_pk_f16_f32 v146, v28, v29
v_lshlrev_b32 v24, 16, v148
v_and_b32 v25, 0xffff0000, v148
v_pk_fma_f32 v[24:25], v[24:25], v[22:23], v[22:23] op_sel:[0,0,1] op_sel_hi:[1,0,1]
v_cvt_pk_f16_f32 v147, v30, v31
v_lshlrev_b32 v26, 16, v149
v_and_b32 v27, 0xffff0000, v149
v_pk_fma_f32 v[26:27], v[26:27], v[22:23], v[22:23] op_sel:[0,0,1] op_sel_hi:[1,0,1]
v_cvt_pk_f16_f32 v148, v24, v25
v_lshlrev_b32 v28, 16, v150
v_and_b32 v29, 0xffff0000, v150
v_pk_fma_f32 v[28:29], v[28:29], v[22:23], v[22:23] op_sel:[0,0,1] op_sel_hi:[1,0,1]
v_cvt_pk_f16_f32 v149, v26, v27
v_lshlrev_b32 v30, 16, v151
v_and_b32 v31, 0xffff0000, v151
v_pk_fma_f32 v[30:31], v[30:31], v[22:23], v[22:23] op_sel:[0,0,1] op_sel_hi:[1,0,1]
v_cvt_pk_f16_f32 v150, v28, v29
v_lshlrev_b32 v24, 16, v152
v_and_b32 v25, 0xffff0000, v152
v_pk_fma_f32 v[24:25], v[24:25], v[22:23], v[22:23] op_sel:[0,0,1] op_sel_hi:[1,0,1]
v_cvt_pk_f16_f32 v151, v30, v31
v_lshlrev_b32 v26, 16, v153
v_and_b32 v27, 0xffff0000, v153
v_pk_fma_f32 v[26:27], v[26:27], v[22:23], v[22:23] op_sel:[0,0,1] op_sel_hi:[1,0,1]
v_cvt_pk_f16_f32 v152, v24, v25
v_lshlrev_b32 v28, 16, v154
v_and_b32 v29, 0xffff0000, v154
v_pk_fma_f32 v[28:29], v[28:29], v[22:23], v[22:23] op_sel:[0,0,1] op_sel_hi:[1,0,1]
v_cvt_pk_f16_f32 v153, v26, v27
v_lshlrev_b32 v30, 16, v155
v_and_b32 v31, 0xffff0000, v155
v_pk_fma_f32 v[30:31], v[30:31], v[22:23], v[22:23] op_sel:[0,0,1] op_sel_hi:[1,0,1]
v_cvt_pk_f16_f32 v154, v28, v29
v_lshlrev_b32 v24, 16, v156
v_and_b32 v25, 0xffff0000, v156
v_pk_fma_f32 v[24:25], v[24:25], v[22:23], v[22:23] op_sel:[0,0,1] op_sel_hi:[1,0,1]
v_cvt_pk_f16_f32 v155, v30, v31
v_lshlrev_b32 v26, 16, v157
v_and_b32 v27, 0xffff0000, v157
v_pk_fma_f32 v[26:27], v[26:27], v[22:23], v[22:23] op_sel:[0,0,1] op_sel_hi:[1,0,1]
v_cvt_pk_f16_f32 v156, v24, v25
v_lshlrev_b32 v28, 16, v158
v_and_b32 v29, 0xffff0000, v158
v_pk_fma_f32 v[28:29], v[28:29], v[22:23], v[22:23] op_sel:[0,0,1] op_sel_hi:[1,0,1]
v_cvt_pk_f16_f32 v157, v26, v27
v_lshlrev_b32 v30, 16, v159
v_and_b32 v31, 0xffff0000, v159
v_pk_fma_f32 v[30:31], v[30:31], v[22:23], v[22:23] op_sel:[0,0,1] op_sel_hi:[1,0,1]
v_cvt_pk_f16_f32 v158, v28, v29
v_cvt_pk_f16_f32 v159, v30, v31
s_waitcnt vmcnt(5)
s_mov_b32 s55, 0x3f803f80
buffer_load_dword v71, v247, s[4:7], s60 offen sc1
v_mov_b32 v20, 0
v_mov_b32 v21, 0
v_dot2c_f32_bf16 v20, s55, v160
v_dot2c_f32_bf16 v21, v160, v160
v_dot2c_f32_bf16 v20, s55, v161
v_dot2c_f32_bf16 v21, v161, v161
buffer_load_dwordx4 v[40:43], v248, s[4:7], s56 offen sc1
v_dot2c_f32_bf16 v20, s55, v162
v_dot2c_f32_bf16 v21, v162, v162
v_dot2c_f32_bf16 v20, s55, v163
v_dot2c_f32_bf16 v21, v163, v163
v_dot2c_f32_bf16 v20, s55, v164
buffer_load_dwordx4 v[44:47], v248, s[4:7], s57 offen sc1
v_dot2c_f32_bf16 v21, v164, v164
v_dot2c_f32_bf16 v20, s55, v165
v_dot2c_f32_bf16 v21, v165, v165
v_dot2c_f32_bf16 v20, s55, v166
v_dot2c_f32_bf16 v21, v166, v166
v_dot2c_f32_bf16 v20, s55, v167
buffer_load_dwordx4 v[48:51], v248, s[4:7], s58 offen sc1
v_dot2c_f32_bf16 v21, v167, v167
v_dot2c_f32_bf16 v20, s55, v168
v_dot2c_f32_bf16 v21, v168, v168
v_dot2c_f32_bf16 v20, s55, v169
v_dot2c_f32_bf16 v21, v169, v169
v_dot2c_f32_bf16 v20, s55, v170
buffer_load_dwordx4 v[52:55], v249, s[4:7], s56 offen sc1
v_dot2c_f32_bf16 v21, v170, v170
v_dot2c_f32_bf16 v20, s55, v171
v_dot2c_f32_bf16 v21, v171, v171
v_dot2c_f32_bf16 v20, s55, v172
v_dot2c_f32_bf16 v21, v172, v172
buffer_load_dwordx4 v[56:59], v249, s[4:7], s57 offen sc1
v_dot2c_f32_bf16 v20, s55, v173
v_dot2c_f32_bf16 v21, v173, v173
v_dot2c_f32_bf16 v20, s55, v174
v_dot2c_f32_bf16 v21, v174, v174
v_dot2c_f32_bf16 v20, s55, v175
v_dot2c_f32_bf16 v21, v175, v175
buffer_load_dwordx4 v[60:63], v249, s[4:7], s58 offen sc1
v_dot2c_f32_bf16 v20, s55, v176
v_dot2c_f32_bf16 v21, v176, v176
v_dot2c_f32_bf16 v20, s55, v177
v_dot2c_f32_bf16 v21, v177, v177
v_dot2c_f32_bf16 v20, s55, v178
v_dot2c_f32_bf16 v21, v178, v178
v_dot2c_f32_bf16 v20, s55, v179
v_dot2c_f32_bf16 v21, v179, v179
v_and_b32 v25, 0xffff0000, v160
v_and_b32 v27, 0xffff0000, v161
v_add_f32_dpp v20, v20, v20 row_ror:8 row_mask:0xf bank_mask:0xf
v_add_f32_dpp v21, v21, v21 row_ror:8 row_mask:0xf bank_mask:0xf
v_lshlrev_b32 v24, 16, v160
v_add_f32_dpp v20, v20, v20 row_ror:4 row_mask:0xf bank_mask:0xf
v_add_f32_dpp v21, v21, v21 row_ror:4 row_mask:0xf bank_mask:0xf
v_lshlrev_b32 v26, 16, v161
v_add_f32_dpp v20, v20, v20 row_ror:2 row_mask:0xf bank_mask:0xf
v_add_f32_dpp v21, v21, v21 row_ror:2 row_mask:0xf bank_mask:0xf
v_lshlrev_b32 v28, 16, v162
v_add_f32_dpp v20, v20, v20 row_ror:1 row_mask:0xf bank_mask:0xf
v_add_f32_dpp v21, v21, v21 row_ror:1 row_mask:0xf bank_mask:0xf
v_mul_f32 v20, 0x3acccccd, v20
v_mul_f32 v21, 0x3acccccd, v21
v_fma_f32 v21, -v20, v20, v21
v_max_f32 v21, 0, v21
v_add_f32 v21, 0x3727c5ac, v21
v_rsq_f32 v22, v21
v_and_b32 v29, 0xffff0000, v162
v_mul_f32 v23, -v20, v22
v_pk_fma_f32 v[24:25], v[24:25], v[22:23], v[22:23] op_sel:[0,0,1] op_sel_hi:[1,0,1]
v_pk_fma_f32 v[26:27], v[26:27], v[22:23], v[22:23] op_sel:[0,0,1] op_sel_hi:[1,0,1]
v_cvt_pk_f16_f32 v160, v24, v25
v_pk_fma_f32 v[28:29], v[28:29], v[22:23], v[22:23] op_sel:[0,0,1] op_sel_hi:[1,0,1]
v_cvt_pk_f16_f32 v161, v26, v27
v_lshlrev_b32 v30, 16, v163
v_and_b32 v31, 0xffff0000, v163
v_pk_fma_f32 v[30:31], v[30:31], v[22:23], v[22:23] op_sel:[0,0,1] op_sel_hi:[1,0,1]
v_cvt_pk_f16_f32 v162, v28, v29
v_lshlrev_b32 v24, 16, v164
v_and_b32 v25, 0xffff0000, v164
v_pk_fma_f32 v[24:25], v[24:25], v[22:23], v[22:23] op_sel:[0,0,1] op_sel_hi:[1,0,1]
v_cvt_pk_f16_f32 v163, v30, v31
v_lshlrev_b32 v26, 16, v165
v_and_b32 v27, 0xffff0000, v165
v_pk_fma_f32 v[26:27], v[26:27], v[22:23], v[22:23] op_sel:[0,0,1] op_sel_hi:[1,0,1]
v_cvt_pk_f16_f32 v164, v24, v25
v_lshlrev_b32 v28, 16, v166
v_and_b32 v29, 0xffff0000, v166
v_pk_fma_f32 v[28:29], v[28:29], v[22:23], v[22:23] op_sel:[0,0,1] op_sel_hi:[1,0,1]
v_cvt_pk_f16_f32 v165, v26, v27
v_lshlrev_b32 v30, 16, v167
v_and_b32 v31, 0xffff0000, v167
v_pk_fma_f32 v[30:31], v[30:31], v[22:23], v[22:23] op_sel:[0,0,1] op_sel_hi:[1,0,1]
v_cvt_pk_f16_f32 v166, v28, v29
v_lshlrev_b32 v24, 16, v168
v_and_b32 v25, 0xffff0000, v168
v_pk_fma_f32 v[24:25], v[24:25], v[22:23], v[22:23] op_sel:[0,0,1] op_sel_hi:[1,0,1]
v_cvt_pk_f16_f32 v167, v30, v31
v_lshlrev_b32 v26, 16, v169
v_and_b32 v27, 0xffff0000, v169
v_pk_fma_f32 v[26:27], v[26:27], v[22:23], v[22:23] op_sel:[0,0,1] op_sel_hi:[1,0,1]
v_cvt_pk_f16_f32 v168, v24, v25
v_lshlrev_b32 v28, 16, v170
v_and_b32 v29, 0xffff0000, v170
v_pk_fma_f32 v[28:29], v[28:29], v[22:23], v[22:23] op_sel:[0,0,1] op_sel_hi:[1,0,1]
v_cvt_pk_f16_f32 v169, v26, v27
v_lshlrev_b32 v30, 16, v171
v_and_b32 v31, 0xffff0000, v171
v_pk_fma_f32 v[30:31], v[30:31], v[22:23], v[22:23] op_sel:[0,0,1] op_sel_hi:[1,0,1]
v_cvt_pk_f16_f32 v170, v28, v29
v_lshlrev_b32 v24, 16, v172
v_and_b32 v25, 0xffff0000, v172
v_pk_fma_f32 v[24:25], v[24:25], v[22:23], v[22:23] op_sel:[0,0,1] op_sel_hi:[1,0,1]
v_cvt_pk_f16_f32 v171, v30, v31
v_lshlrev_b32 v26, 16, v173
v_and_b32 v27, 0xffff0000, v173
v_pk_fma_f32 v[26:27], v[26:27], v[22:23], v[22:23] op_sel:[0,0,1] op_sel_hi:[1,0,1]
v_cvt_pk_f16_f32 v172, v24, v25
v_lshlrev_b32 v28, 16, v174
v_and_b32 v29, 0xffff0000, v174
v_pk_fma_f32 v[28:29], v[28:29], v[22:23], v[22:23] op_sel:[0,0,1] op_sel_hi:[1,0,1]
v_cvt_pk_f16_f32 v173, v26, v27
v_lshlrev_b32 v30, 16, v175
v_and_b32 v31, 0xffff0000, v175
v_pk_fma_f32 v[30:31], v[30:31], v[22:23], v[22:23] op_sel:[0,0,1] op_sel_hi:[1,0,1]
v_cvt_pk_f16_f32 v174, v28, v29
v_lshlrev_b32 v24, 16, v176
v_and_b32 v25, 0xffff0000, v176
v_pk_fma_f32 v[24:25], v[24:25], v[22:23], v[22:23] op_sel:[0,0,1] op_sel_hi:[1,0,1]
v_cvt_pk_f16_f32 v175, v30, v31
v_lshlrev_b32 v26, 16, v177
v_and_b32 v27, 0xffff0000, v177
v_pk_fma_f32 v[26:27], v[26:27], v[22:23], v[22:23] op_sel:[0,0,1] op_sel_hi:[1,0,1]
v_cvt_pk_f16_f32 v176, v24, v25
v_lshlrev_b32 v28, 16, v178
v_and_b32 v29, 0xffff0000, v178
v_pk_fma_f32 v[28:29], v[28:29], v[22:23], v[22:23] op_sel:[0,0,1] op_sel_hi:[1,0,1]
v_cvt_pk_f16_f32 v177, v26, v27
v_lshlrev_b32 v30, 16, v179
v_and_b32 v31, 0xffff0000, v179
v_pk_fma_f32 v[30:31], v[30:31], v[22:23], v[22:23] op_sel:[0,0,1] op_sel_hi:[1,0,1]
v_cvt_pk_f16_f32 v178, v28, v29
v_cvt_pk_f16_f32 v179, v30, v31
s_mul_i32 s52, s96, 192
s_mul_i32 s48, s3, 20480
s_add_u32 s48, s48, s52
s_mul_i32 s49, s3, 3072
s_lshl_b32 s53, s47, 2
s_add_u32 s53, s53, s3
s_and_b32 s50, s53, 63
s_lshl_b32 s50, s50, 5
s_lshr_b32 s54, s53, 6
s_add_u32 s54, s50, s54
s_mul_i32 s50, s54, 1280
s_add_u32 s50, s50, s52
s_lshl_b32 s51, s52, 1
s_add_u32 s51, s51, 65536
s_add_u32 s22, s51, 5120
s_mov_b32 s23, 917504
s_mul_i32 s12, s3, 2304
s_add_u32 s12, s12, 152320
s_add_u32 s13, s49, 122880
s_lshl_b32 s14, s53, 11
s_add_u32 s14, s14, 131072
s_mul_i32 s61, s3, 40
s_add_u32 s61, s61, 138240
s_waitcnt vmcnt(0)
v_perm_b32 v64, v41, v40, s98
v_perm_b32 v65, v43, v42, s99
v_bitop3_b32 v66, v64, v65, s40 bitop3:0x56
v_perm_b32 v64, v45, v44, s98
v_perm_b32 v65, v47, v46, s99
v_bitop3_b32 v67, v64, v65, s40 bitop3:0x56
v_perm_b32 v64, v49, v48, s98
v_perm_b32 v65, v51, v50, s99
v_bitop3_b32 v68, v64, v65, s40 bitop3:0x56
v_or3_b32 v69, v66, v67, v68
v_perm_b32 v64, v53, v52, s98
v_perm_b32 v65, v55, v54, s99
v_bitop3_b32 v66, v64, v65, s40 bitop3:0x56
v_perm_b32 v64, v57, v56, s98
v_perm_b32 v65, v59, v58, s99
v_bitop3_b32 v67, v64, v65, s40 bitop3:0x56
v_perm_b32 v64, v61, v60, s98
v_perm_b32 v65, v63, v62, s99
v_bitop3_b32 v68, v64, v65, s40 bitop3:0x56
v_or3_b32 v70, v66, v67, v68
v_and_b32 v70, v70, v250
v_xor_b32 v71, s40, v71
v_or3_b32 v69, v69, v70, v71
v_cmp_ne_u32 vcc, 0, v69
s_cbranch_vccnz L_ga_retry
L_ga_ok:
s_barrier
buffer_load_dwordx4 a[40:43], v5, s[4:7], s59 offen offset:0 sc1
s_mov_b32 s55, 0xffffff00
v_and_b32 v40, s55, v40
v_and_b32 v41, s55, v41
v_and_b32 v42, s55, v42
v_and_b32 v43, s55, v43
v_and_b32 v44, s55, v44
v_and_b32 v45, s55, v45
v_and_b32 v46, s55, v46
v_and_b32 v47, s55, v47
buffer_load_dwordx4 a[44:47], v5, s[4:7], s59 offen offset:256 sc1
v_and_b32 v48, s55, v48
v_and_b32 v49, s55, v49
v_and_b32 v50, s55, v50
v_and_b32 v51, s55, v51
v_pk_add_f32 v[40:41], v[40:41], v[44:45]
v_pk_add_f32 v[42:43], v[42:43], v[46:47]
v_pk_add_f32 v[40:41], v[40:41], v[48:49]
v_pk_add_f32 v[42:43], v[42:43], v[50:51]
v_cvt_pk_bf16_f32 v44, v40, v41
v_cvt_pk_bf16_f32 v45, v42, v43
buffer_load_dwordx4 a[48:51], v5, s[4:7], s59 offen offset:512 sc1
v_lshlrev_b32 v40, 16, v44
v_and_b32 v41, 0xffff0000, v44
v_lshlrev_b32 v42, 16, v45
v_and_b32 v43, 0xffff0000, v45
v_pk_add_f32 v[40:41], v[40:41], v[252:253] op_sel_hi:[1,0]
v_pk_add_f32 v[42:43], v[42:43], v[252:253] op_sel_hi:[1,0]
v_cvt_pk_bf16_f32 v44, v40, v41
v_cvt_pk_bf16_f32 v45, v42, v43
v_lshlrev_b32 v40, 16, v44
buffer_load_dwordx4 a[52:55], v6, s[4:7], s59 offen offset:768 sc1
s_add_u32 s59, s59, 16384
v_and_b32 v41, 0xffff0000, v44
v_lshlrev_b32 v42, 16, v45
v_and_b32 v43, 0xffff0000, v45
ds_write_b128 v251, v[40:43]
v_and_b32 v52, s55, v52
v_and_b32 v53, s55, v53
v_and_b32 v54, s55, v54
v_and_b32 v55, s55, v55
v_and_b32 v56, s55, v56
v_and_b32 v57, s55, v57
buffer_load_dwordx4 a[56:59], v5, s[4:7], s59 offen offset:0 sc1
v_and_b32 v58, s55, v58
v_and_b32 v59, s55, v59
v_and_b32 v60, s55, v60
v_and_b32 v61, s55, v61
v_and_b32 v62, s55, v62
v_and_b32 v63, s55, v63
v_pk_add_f32 v[52:53], v[52:53], v[56:57]
v_pk_add_f32 v[54:55], v[54:55], v[58:59]
v_pk_add_f32 v[52:53], v[52:53], v[60:61]
buffer_load_dwordx4 a[60:63], v5, s[4:7], s59 offen offset:256 sc1
v_pk_add_f32 v[54:55], v[54:55], v[62:63]
v_cvt_pk_bf16_f32 v56, v52, v53
v_cvt_pk_bf16_f32 v57, v54, v55
v_lshlrev_b32 v52, 16, v56
v_and_b32 v53, 0xffff0000, v56
v_lshlrev_b32 v54, 16, v57
v_and_b32 v55, 0xffff0000, v57
v_pk_add_f32 v[52:53], v[52:53], v[252:253] op_sel_hi:[1,0]
v_pk_add_f32 v[54:55], v[54:55], v[252:253] op_sel_hi:[1,0]
v_cvt_pk_bf16_f32 v56, v52, v53
buffer_load_dwordx4 a[64:67], v5, s[4:7], s59 offen offset:512 sc1
v_cvt_pk_bf16_f32 v57, v54, v55
v_lshlrev_b32 v52, 16, v56
v_and_b32 v53, 0xffff0000, v56
v_lshlrev_b32 v54, 16, v57
v_and_b32 v55, 0xffff0000, v57
s_mov_b64 exec, 0xffff
ds_write_b128 v251, v[52:55] offset:1024
s_mov_b64 exec, -1
s_mov_b32 s55, 0x3f803f80
v_mov_b32 v20, 0
v_mov_b32 v21, 0
buffer_load_dwordx4 a[68:71], v6, s[4:7], s59 offen offset:768 sc1
s_add_u32 s59, s59, 16384
v_dot2c_f32_bf16 v20, s55, v180
v_dot2c_f32_bf16 v21, v180, v180
v_dot2c_f32_bf16 v20, s55, v181
v_dot2c_f32_bf16 v21, v181, v181
v_dot2c_f32_bf16 v20, s55, v182
v_dot2c_f32_bf16 v21, v182, v182
v_dot2c_f32_bf16 v20, s55, v183
v_dot2c_f32_bf16 v21, v183, v183
v_dot2c_f32_bf16 v20, s55, v184
buffer_load_dwordx4 a[72:75], v5, s[4:7], s59 offen offset:0 sc1
v_dot2c_f32_bf16 v21, v184, v184
v_dot2c_f32_bf16 v20, s55, v185
v_dot2c_f32_bf16 v21, v185, v185
v_dot2c_f32_bf16 v20, s55, v186
v_dot2c_f32_bf16 v21, v186, v186
v_dot2c_f32_bf16 v20, s55, v187
v_dot2c_f32_bf16 v21, v187, v187
v_dot2c_f32_bf16 v20, s55, v188
v_dot2c_f32_bf16 v21, v188, v188
v_dot2c_f32_bf16 v20, s55, v189
buffer_load_dwordx4 a[76:79], v5, s[4:7], s59 offen offset:256 sc1
v_dot2c_f32_bf16 v21, v189, v189
v_dot2c_f32_bf16 v20, s55, v190
v_dot2c_f32_bf16 v21, v190, v190
v_dot2c_f32_bf16 v20, s55, v191
v_dot2c_f32_bf16 v21, v191, v191
v_dot2c_f32_bf16 v20, s55, v192
v_dot2c_f32_bf16 v21, v192, v192
v_dot2c_f32_bf16 v20, s55, v193
v_dot2c_f32_bf16 v21, v193, v193
buffer_load_dwordx4 a[80:83], v5, s[4:7], s59 offen offset:512 sc1
v_dot2c_f32_bf16 v20, s55, v194
v_dot2c_f32_bf16 v21, v194, v194
v_dot2c_f32_bf16 v20, s55, v195
v_dot2c_f32_bf16 v21, v195, v195
v_dot2c_f32_bf16 v20, s55, v196
v_dot2c_f32_bf16 v21, v196, v196
v_dot2c_f32_bf16 v20, s55, v197
v_dot2c_f32_bf16 v21, v197, v197
v_dot2c_f32_bf16 v20, s55, v198
v_dot2c_f32_bf16 v21, v198, v198
buffer_load_dwordx4 a[84:87], v6, s[4:7], s59 offen offset:768 sc1
s_add_u32 s59, s59, 16384
v_dot2c_f32_bf16 v20, s55, v199
v_dot2c_f32_bf16 v21, v199, v199
v_and_b32 v25, 0xffff0000, v180
v_and_b32 v27, 0xffff0000, v181
v_add_f32_dpp v20, v20, v20 row_ror:8 row_mask:0xf bank_mask:0xf
v_add_f32_dpp v21, v21, v21 row_ror:8 row_mask:0xf bank_mask:0xf
v_lshlrev_b32 v24, 16, v180
v_add_f32_dpp v20, v20, v20 row_ror:4 row_mask:0xf bank_mask:0xf
v_add_f32_dpp v21, v21, v21 row_ror:4 row_mask:0xf bank_mask:0xf
v_lshlrev_b32 v26, 16, v181
buffer_load_dwordx4 a[88:91], v5, s[4:7], s59 offen offset:0 sc1
v_add_f32_dpp v20, v20, v20 row_ror:2 row_mask:0xf bank_mask:0xf
v_add_f32_dpp v21, v21, v21 row_ror:2 row_mask:0xf bank_mask:0xf
v_lshlrev_b32 v28, 16, v182
v_add_f32_dpp v20, v20, v20 row_ror:1 row_mask:0xf bank_mask:0xf
v_add_f32_dpp v21, v21, v21 row_ror:1 row_mask:0xf bank_mask:0xf
v_mul_f32 v20, 0x3acccccd, v20
v_mul_f32 v21, 0x3acccccd, v21
v_fma_f32 v21, -v20, v20, v21
v_max_f32 v21, 0, v21
buffer_load_dwordx4 a[92:95], v5, s[4:7], s59 offen offset:256 sc1
v_add_f32 v21, 0x3727c5ac, v21
v_rsq_f32 v22, v21
v_and_b32 v29, 0xffff0000, v182
v_mul_f32 v23, -v20, v22
v_pk_fma_f32 v[24:25], v[24:25], v[22:23], v[22:23] op_sel:[0,0,1] op_sel_hi:[1,0,1]
v_pk_fma_f32 v[26:27], v[26:27], v[22:23], v[22:23] op_sel:[0,0,1] op_sel_hi:[1,0,1]
v_cvt_pk_f16_f32 v180, v24, v25
v_pk_fma_f32 v[28:29], v[28:29], v[22:23], v[22:23] op_sel:[0,0,1] op_sel_hi:[1,0,1]
v_cvt_pk_f16_f32 v181, v26, v27
v_lshlrev_b32 v30, 16, v183
buffer_load_dwordx4 a[96:99], v5, s[4:7], s59 offen offset:512 sc1
v_and_b32 v31, 0xffff0000, v183
v_pk_fma_f32 v[30:31], v[30:31], v[22:23], v[22:23] op_sel:[0,0,1] op_sel_hi:[1,0,1]
v_cvt_pk_f16_f32 v182, v28, v29
v_lshlrev_b32 v24, 16, v184
v_and_b32 v25, 0xffff0000, v184
v_pk_fma_f32 v[24:25], v[24:25], v[22:23], v[22:23] op_sel:[0,0,1] op_sel_hi:[1,0,1]
v_cvt_pk_f16_f32 v183, v30, v31
v_lshlrev_b32 v26, 16, v185
v_and_b32 v27, 0xffff0000, v185
buffer_load_dwordx4 a[100:103], v6, s[4:7], s59 offen offset:768 sc1
s_add_u32 s59, s59, 16384
v_pk_fma_f32 v[26:27], v[26:27], v[22:23], v[22:23] op_sel:[0,0,1] op_sel_hi:[1,0,1]
v_cvt_pk_f16_f32 v184, v24, v25
v_lshlrev_b32 v28, 16, v186
v_and_b32 v29, 0xffff0000, v186
v_pk_fma_f32 v[28:29], v[28:29], v[22:23], v[22:23] op_sel:[0,0,1] op_sel_hi:[1,0,1]
v_cvt_pk_f16_f32 v185, v26, v27
v_lshlrev_b32 v30, 16, v187
v_and_b32 v31, 0xffff0000, v187
v_pk_fma_f32 v[30:31], v[30:31], v[22:23], v[22:23] op_sel:[0,0,1] op_sel_hi:[1,0,1]
v_cvt_pk_f16_f32 v186, v28, v29
buffer_load_dwordx4 a[104:107], v5, s[4:7], s59 offen offset:0 sc1
v_lshlrev_b32 v24, 16, v188
v_and_b32 v25, 0xffff0000, v188
v_pk_fma_f32 v[24:25], v[24:25], v[22:23], v[22:23] op_sel:[0,0,1] op_sel_hi:[1,0,1]
v_cvt_pk_f16_f32 v187, v30, v31
v_lshlrev_b32 v26, 16, v189
v_and_b32 v27, 0xffff0000, v189
v_pk_fma_f32 v[26:27], v[26:27], v[22:23], v[22:23] op_sel:[0,0,1] op_sel_hi:[1,0,1]
v_cvt_pk_f16_f32 v188, v24, v25
v_lshlrev_b32 v28, 16, v190
v_and_b32 v29, 0xffff0000, v190
buffer_load_dwordx4 a[108:111], v5, s[4:7], s59 offen offset:256 sc1
v_pk_fma_f32 v[28:29], v[28:29], v[22:23], v[22:23] op_sel:[0,0,1] op_sel_hi:[1,0,1]
v_cvt_pk_f16_f32 v189, v26, v27
v_lshlrev_b32 v30, 16, v191
v_and_b32 v31, 0xffff0000, v191
v_pk_fma_f32 v[30:31], v[30:31], v[22:23], v[22:23] op_sel:[0,0,1] op_sel_hi:[1,0,1]
v_cvt_pk_f16_f32 v190, v28, v29
v_lshlrev_b32 v24, 16, v192
v_and_b32 v25, 0xffff0000, v192
v_pk_fma_f32 v[24:25], v[24:25], v[22:23], v[22:23] op_sel:[0,0,1] op_sel_hi:[1,0,1]
buffer_load_dwordx4 a[112:115], v5, s[4:7], s59 offen offset:512 sc1
v_cvt_pk_f16_f32 v191, v30, v31
v_lshlrev_b32 v26, 16, v193
v_and_b32 v27, 0xffff0000, v193
v_pk_fma_f32 v[26:27], v[26:27], v[22:23], v[22:23] op_sel:[0,0,1] op_sel_hi:[1,0,1]
v_cvt_pk_f16_f32 v192, v24, v25
v_lshlrev_b32 v28, 16, v194
v_and_b32 v29, 0xffff0000, v194
v_pk_fma_f32 v[28:29], v[28:29], v[22:23], v[22:23] op_sel:[0,0,1] op_sel_hi:[1,0,1]
v_cvt_pk_f16_f32 v193, v26, v27
v_lshlrev_b32 v30, 16, v195
buffer_load_dwordx4 a[116:119], v6, s[4:7], s59 offen offset:768 sc1
s_add_u32 s59, s59, 16384
v_and_b32 v31, 0xffff0000, v195
v_pk_fma_f32 v[30:31], v[30:31], v[22:23], v[22:23] op_sel:[0,0,1] op_sel_hi:[1,0,1]
v_cvt_pk_f16_f32 v194, v28, v29
v_lshlrev_b32 v24, 16, v196
v_and_b32 v25, 0xffff0000, v196
v_pk_fma_f32 v[24:25], v[24:25], v[22:23], v[22:23] op_sel:[0,0,1] op_sel_hi:[1,0,1]
v_cvt_pk_f16_f32 v195, v30, v31
v_lshlrev_b32 v26, 16, v197
v_and_b32 v27, 0xffff0000, v197
v_pk_fma_f32 v[26:27], v[26:27], v[22:23], v[22:23] op_sel:[0,0,1] op_sel_hi:[1,0,1]
v_cvt_pk_f16_f32 v196, v24, v25
v_lshlrev_b32 v28, 16, v198
v_and_b32 v29, 0xffff0000, v198
v_pk_fma_f32 v[28:29], v[28:29], v[22:23], v[22:23] op_sel:[0,0,1] op_sel_hi:[1,0,1]
v_cvt_pk_f16_f32 v197, v26, v27
v_lshlrev_b32 v30, 16, v199
v_and_b32 v31, 0xffff0000, v199
v_pk_fma_f32 v[30:31], v[30:31], v[22:23], v[22:23] op_sel:[0,0,1] op_sel_hi:[1,0,1]
v_cvt_pk_f16_f32 v198, v28, v29
v_cvt_pk_f16_f32 v199, v30, v31
s_waitcnt lgkmcnt(0)
s_barrier
ds_read_b128 v[200:203], v10 offset:2560
ds_read_b128 v[204:207], v10 offset:2576
ds_read_b128 v[208:211], v10 offset:0
ds_read_b128 v[212:215], v10 offset:16
s_waitcnt lgkmcnt(0)
v_fma_mix_f32 v216, v100, v200, v208 op_sel:[0,0,0] op_sel_hi:[1,0,0]
v_fma_mix_f32 v217, v100, v201, v209 op_sel:[1,0,0] op_sel_hi:[1,0,0]
v_cvt_pk_bf16_f32 v220, v216, v217
v_fma_mix_f32 v218, v101, v202, v210 op_sel:[0,0,0] op_sel_hi:[1,0,0]
v_fma_mix_f32 v219, v101, v203, v211 op_sel:[1,0,0] op_sel_hi:[1,0,0]
v_cvt_pk_bf16_f32 v221, v218, v219
v_fma_mix_f32 v216, v102, v204, v212 op_sel:[0,0,0] op_sel_hi:[1,0,0]
v_fma_mix_f32 v217, v102, v205, v213 op_sel:[1,0,0] op_sel_hi:[1,0,0]
v_cvt_pk_bf16_f32 v222, v216, v217
v_fma_mix_f32 v218, v103, v206, v214 op_sel:[0,0,0] op_sel_hi:[1,0,0]
v_fma_mix_f32 v219, v103, v207, v215 op_sel:[1,0,0] op_sel_hi:[1,0,0]
v_cvt_pk_bf16_f32 v223, v218, v219
ds_write_b128 v7, v[220:223] offset:0
v_fma_mix_f32 v216, v120, v200, v208 op_sel:[0,0,0] op_sel_hi:[1,0,0]
v_fma_mix_f32 v217, v120, v201, v209 op_sel:[1,0,0] op_sel_hi:[1,0,0]
v_cvt_pk_bf16_f32 v224, v216, v217
v_fma_mix_f32 v218, v121, v202, v210 op_sel:[0,0,0] op_sel_hi:[1,0,0]
v_fma_mix_f32 v219, v121, v203, v211 op_sel:[1,0,0] op_sel_hi:[1,0,0]
v_cvt_pk_bf16_f32 v225, v218, v219
v_fma_mix_f32 v216, v122, v204, v212 op_sel:[0,0,0] op_sel_hi:[1,0,0]
v_fma_mix_f32 v217, v122, v205, v213 op_sel:[1,0,0] op_sel_hi:[1,0,0]
v_cvt_pk_bf16_f32 v226, v216, v217
v_fma_mix_f32 v218, v123, v206, v214 op_sel:[0,0,0] op_sel_hi:[1,0,0]
v_fma_mix_f32 v219, v123, v207, v215 op_sel:[1,0,0] op_sel_hi:[1,0,0]
v_cvt_pk_bf16_f32 v227, v218, v219
ds_write_b128 v7, v[224:227] offset:1024
v_fma_mix_f32 v216, v140, v200, v208 op_sel:[0,0,0] op_sel_hi:[1,0,0]
v_fma_mix_f32 v217, v140, v201, v209 op_sel:[1,0,0] op_sel_hi:[1,0,0]
v_cvt_pk_bf16_f32 v220, v216, v217
v_fma_mix_f32 v218, v141, v202, v210 op_sel:[0,0,0] op_sel_hi:[1,0,0]
v_fma_mix_f32 v219, v141, v203, v211 op_sel:[1,0,0] op_sel_hi:[1,0,0]
v_cvt_pk_bf16_f32 v221, v218, v219
v_fma_mix_f32 v216, v142, v204, v212 op_sel:[0,0,0] op_sel_hi:[1,0,0]
v_fma_mix_f32 v217, v142, v205, v213 op_sel:[1,0,0] op_sel_hi:[1,0,0]
v_cvt_pk_bf16_f32 v222, v216, v217
v_fma_mix_f32 v218, v143, v206, v214 op_sel:[0,0,0] op_sel_hi:[1,0,0]
v_fma_mix_f32 v219, v143, v207, v215 op_sel:[1,0,0] op_sel_hi:[1,0,0]
v_cvt_pk_bf16_f32 v223, v218, v219
ds_write_b128 v253, v[220:223] offset:2048
v_fma_mix_f32 v216, v160, v200, v208 op_sel:[0,0,0] op_sel_hi:[1,0,0]
v_fma_mix_f32 v217, v160, v201, v209 op_sel:[1,0,0] op_sel_hi:[1,0,0]
v_cvt_pk_bf16_f32 v224, v216, v217
v_fma_mix_f32 v218, v161, v202, v210 op_sel:[0,0,0] op_sel_hi:[1,0,0]
v_fma_mix_f32 v219, v161, v203, v211 op_sel:[1,0,0] op_sel_hi:[1,0,0]
v_cvt_pk_bf16_f32 v225, v218, v219
v_fma_mix_f32 v216, v162, v204, v212 op_sel:[0,0,0] op_sel_hi:[1,0,0]
v_fma_mix_f32 v217, v162, v205, v213 op_sel:[1,0,0] op_sel_hi:[1,0,0]
v_cvt_pk_bf16_f32 v226, v216, v217
v_fma_mix_f32 v218, v163, v206, v214 op_sel:[0,0,0] op_sel_hi:[1,0,0]
v_fma_mix_f32 v219, v163, v207, v215 op_sel:[1,0,0] op_sel_hi:[1,0,0]
v_cvt_pk_bf16_f32 v227, v218, v219
ds_write_b128 v254, v[224:227] offset:3072
v_fma_mix_f32 v216, v180, v200, v208 op_sel:[0,0,0] op_sel_hi:[1,0,0]
v_fma_mix_f32 v217, v180, v201, v209 op_sel:[1,0,0] op_sel_hi:[1,0,0]
v_cvt_pk_bf16_f32 v220, v216, v217
v_fma_mix_f32 v218, v181, v202, v210 op_sel:[0,0,0] op_sel_hi:[1,0,0]
v_fma_mix_f32 v219, v181, v203, v211 op_sel:[1,0,0] op_sel_hi:[1,0,0]
v_cvt_pk_bf16_f32 v221, v218, v219
v_fma_mix_f32 v216, v182, v204, v212 op_sel:[0,0,0] op_sel_hi:[1,0,0]
v_fma_mix_f32 v217, v182, v205, v213 op_sel:[1,0,0] op_sel_hi:[1,0,0]
v_cvt_pk_bf16_f32 v222, v216, v217
v_fma_mix_f32 v218, v183, v206, v214 op_sel:[0,0,0] op_sel_hi:[1,0,0]
v_fma_mix_f32 v219, v183, v207, v215 op_sel:[1,0,0] op_sel_hi:[1,0,0]
v_cvt_pk_bf16_f32 v223, v218, v219
ds_write_b128 v254, v[220:223] offset:4096
ds_read_b128 v[200:203], v10 offset:3072
ds_read_b128 v[204:207], v10 offset:3088
ds_read_b128 v[208:211], v10 offset:512
ds_read_b128 v[212:215], v10 offset:528
s_waitcnt lgkmcnt(4)
s_barrier
ds_read_b128 a[0:3], v8 offset:0
ds_read_b128 a[4:7], v8 offset:1024
ds_read_b128 a[8:11], v8 offset:2048
ds_read_b128 a[12:15], v8 offset:3072
ds_read_b128 a[16:19], v8 offset:4096
s_waitcnt vmcnt(16) lgkmcnt(0)
v_mfma_f32_16x16x32_bf16 v[20:23], a[40:43], a[0:3], 0
ds_read_b128 a[20:23], v9 offset:5120
v_fma_mix_f32 v216, v104, v200, v208 op_sel:[0,0,0] op_sel_hi:[1,0,0]
v_mfma_f32_16x16x32_bf16 v[24:27], a[44:47], a[0:3], 0
buffer_load_dwordx4 a[120:123], v5, s[4:7], s59 offen offset:0 sc1
v_fma_mix_f32 v217, v104, v201, v209 op_sel:[1,0,0] op_sel_hi:[1,0,0]
v_mfma_f32_16x16x32_bf16 v[28:31], a[0:3], a[48:51], 0
ds_read_b128 a[24:27], v9 offset:6144
v_cvt_pk_bf16_f32 v220, v216, v217
v_mfma_f32_16x16x32_bf16 v[32:35], a[52:55], a[0:3], 0
ds_read_b128 a[28:31], v9 offset:7168
v_fma_mix_f32 v218, v105, v202, v210 op_sel:[0,0,0] op_sel_hi:[1,0,0]
v_mfma_f32_16x16x32_bf16 v[36:39], a[40:43], a[4:7], 0
ds_read_b128 a[32:35], v9 offset:8192
v_fma_mix_f32 v219, v105, v203, v211 op_sel:[1,0,0] op_sel_hi:[1,0,0]
v_mfma_f32_16x16x32_bf16 v[40:43], a[44:47], a[4:7], 0
buffer_load_dwordx4 a[124:127], v5, s[4:7], s59 offen offset:256 sc1
v_cvt_pk_bf16_f32 v221, v218, v219
v_mfma_f32_16x16x32_bf16 v[44:47], a[4:7], a[48:51], 0
ds_read_b128 a[36:39], v9 offset:9216
v_fma_mix_f32 v216, v106, v204, v212 op_sel:[0,0,0] op_sel_hi:[1,0,0]
v_mfma_f32_16x16x32_bf16 v[48:51], a[52:55], a[4:7], 0
ds_write_b64 v7, v[220:221] offset:20480
v_mfma_f32_16x16x32_bf16 v[52:55], a[40:43], a[8:11], 0
v_fma_mix_f32 v217, v106, v205, v213 op_sel:[1,0,0] op_sel_hi:[1,0,0]
v_cvt_pk_bf16_f32 v222, v216, v217
v_mfma_f32_16x16x32_bf16 v[56:59], a[44:47], a[8:11], 0
buffer_load_dwordx4 a[128:131], v5, s[4:7], s59 offen offset:512 sc1
v_fma_mix_f32 v218, v107, v206, v214 op_sel:[0,0,0] op_sel_hi:[1,0,0]
v_mfma_f32_16x16x32_bf16 v[60:63], a[8:11], a[48:51], 0
v_fma_mix_f32 v219, v107, v207, v215 op_sel:[1,0,0] op_sel_hi:[1,0,0]
v_cvt_pk_bf16_f32 v223, v218, v219
v_mfma_f32_16x16x32_bf16 v[64:67], a[52:55], a[8:11], 0
v_fma_mix_f32 v216, v124, v200, v208 op_sel:[0,0,0] op_sel_hi:[1,0,0]
v_fma_mix_f32 v217, v124, v201, v209 op_sel:[1,0,0] op_sel_hi:[1,0,0]
v_mfma_f32_16x16x32_bf16 v[68:71], a[40:43], a[12:15], 0
ds_write_b64 v7, v[222:223] offset:20488
v_mfma_f32_16x16x32_bf16 v[72:75], a[44:47], a[12:15], 0
buffer_load_dwordx4 a[132:135], v6, s[4:7], s59 offen offset:768 sc1
s_add_u32 s59, s59, 16384
v_mfma_f32_16x16x32_bf16 v[76:79], a[12:15], a[48:51], 0
v_cvt_pk_bf16_f32 v224, v216, v217
v_fma_mix_f32 v218, v125, v202, v210 op_sel:[0,0,0] op_sel_hi:[1,0,0]
v_mfma_f32_16x16x32_bf16 v[80:83], a[52:55], a[12:15], 0
v_fma_mix_f32 v219, v125, v203, v211 op_sel:[1,0,0] op_sel_hi:[1,0,0]
v_cvt_pk_bf16_f32 v225, v218, v219
v_mfma_f32_16x16x32_bf16 v[84:87], a[40:43], a[16:19], 0
v_fma_mix_f32 v216, v126, v204, v212 op_sel:[0,0,0] op_sel_hi:[1,0,0]
v_fma_mix_f32 v217, v126, v205, v213 op_sel:[1,0,0] op_sel_hi:[1,0,0]
v_mfma_f32_16x16x32_bf16 v[88:91], a[44:47], a[16:19], 0
ds_write_b64 v7, v[224:225] offset:21504
v_mfma_f32_16x16x32_bf16 v[92:95], a[16:19], a[48:51], 0
v_cvt_pk_bf16_f32 v226, v216, v217
v_fma_mix_f32 v218, v127, v206, v214 op_sel:[0,0,0] op_sel_hi:[1,0,0]
v_mfma_f32_16x16x32_bf16 v[96:99], a[52:55], a[16:19], 0
s_waitcnt vmcnt(16) lgkmcnt(3)
v_fma_mix_f32 v219, v127, v207, v215 op_sel:[1,0,0] op_sel_hi:[1,0,0]
v_cvt_pk_bf16_f32 v227, v218, v219
v_mfma_f32_16x16x32_bf16 v[20:23], a[56:59], a[20:23], v[20:23]
ds_read_b128 a[0:3], v8 offset:10240
v_fma_mix_f32 v216, v144, v200, v208 op_sel:[0,0,0] op_sel_hi:[1,0,0]
v_mfma_f32_16x16x32_bf16 v[24:27], a[60:63], a[20:23], v[24:27]
buffer_load_dwordx4 a[136:139], v5, s[4:7], s59 offen offset:0 sc1
v_fma_mix_f32 v217, v144, v201, v209 op_sel:[1,0,0] op_sel_hi:[1,0,0]
v_mfma_f32_16x16x32_bf16 v[28:31], a[20:23], a[64:67], v[28:31]
ds_read_b128 a[4:7], v8 offset:11264
v_cvt_pk_bf16_f32 v220, v216, v217
v_mfma_f32_16x16x32_bf16 v[32:35], a[68:71], a[20:23], v[32:35]
ds_read_b128 a[8:11], v8 offset:12288
v_fma_mix_f32 v218, v145, v202, v210 op_sel:[0,0,0] op_sel_hi:[1,0,0]
v_mfma_f32_16x16x32_bf16 v[36:39], a[56:59], a[24:27], v[36:39]
ds_read_b128 a[12:15], v8 offset:13312
v_fma_mix_f32 v219, v145, v203, v211 op_sel:[1,0,0] op_sel_hi:[1,0,0]
v_mfma_f32_16x16x32_bf16 v[40:43], a[60:63], a[24:27], v[40:43]
buffer_load_dwordx4 a[140:143], v5, s[4:7], s59 offen offset:256 sc1
v_cvt_pk_bf16_f32 v221, v218, v219
v_mfma_f32_16x16x32_bf16 v[44:47], a[24:27], a[64:67], v[44:47]
ds_read_b128 a[16:19], v8 offset:14336
v_fma_mix_f32 v216, v146, v204, v212 op_sel:[0,0,0] op_sel_hi:[1,0,0]
v_mfma_f32_16x16x32_bf16 v[48:51], a[68:71], a[24:27], v[48:51]
ds_write_b64 v7, v[226:227] offset:21512
v_mfma_f32_16x16x32_bf16 v[52:55], a[56:59], a[28:31], v[52:55]
v_fma_mix_f32 v217, v146, v205, v213 op_sel:[1,0,0] op_sel_hi:[1,0,0]
v_cvt_pk_bf16_f32 v222, v216, v217
v_mfma_f32_16x16x32_bf16 v[56:59], a[60:63], a[28:31], v[56:59]
buffer_load_dwordx4 a[144:147], v5, s[4:7], s59 offen offset:512 sc1
v_fma_mix_f32 v218, v147, v206, v214 op_sel:[0,0,0] op_sel_hi:[1,0,0]
v_mfma_f32_16x16x32_bf16 v[60:63], a[28:31], a[64:67], v[60:63]
ds_write_b64 v253, v[220:221] offset:22528
v_mfma_f32_16x16x32_bf16 v[64:67], a[68:71], a[28:31], v[64:67]
v_fma_mix_f32 v219, v147, v207, v215 op_sel:[1,0,0] op_sel_hi:[1,0,0]
v_cvt_pk_bf16_f32 v223, v218, v219
v_mfma_f32_16x16x32_bf16 v[68:71], a[56:59], a[32:35], v[68:71]
v_fma_mix_f32 v216, v164, v200, v208 op_sel:[0,0,0] op_sel_hi:[1,0,0]
v_fma_mix_f32 v217, v164, v201, v209 op_sel:[1,0,0] op_sel_hi:[1,0,0]
v_mfma_f32_16x16x32_bf16 v[72:75], a[60:63], a[32:35], v[72:75]
buffer_load_dwordx4 a[148:151], v6, s[4:7], s59 offen offset:768 sc1
s_add_u32 s59, s59, 16384
v_mfma_f32_16x16x32_bf16 v[76:79], a[32:35], a[64:67], v[76:79]
ds_write_b64 v253, v[222:223] offset:22536
v_mfma_f32_16x16x32_bf16 v[80:83], a[68:71], a[32:35], v[80:83]
v_cvt_pk_bf16_f32 v224, v216, v217
v_fma_mix_f32 v218, v165, v202, v210 op_sel:[0,0,0] op_sel_hi:[1,0,0]
v_mfma_f32_16x16x32_bf16 v[84:87], a[56:59], a[36:39], v[84:87]
v_fma_mix_f32 v219, v165, v203, v211 op_sel:[1,0,0] op_sel_hi:[1,0,0]
v_cvt_pk_bf16_f32 v225, v218, v219
v_mfma_f32_16x16x32_bf16 v[88:91], a[60:63], a[36:39], v[88:91]
buffer_load_dwordx4 a[152:155], v5, s[4:7], s59 offen offset:0 sc1
v_fma_mix_f32 v216, v166, v204, v212 op_sel:[0,0,0] op_sel_hi:[1,0,0]
v_mfma_f32_16x16x32_bf16 v[92:95], a[36:39], a[64:67], v[92:95]
ds_write_b64 v254, v[224:225] offset:23552
v_mfma_f32_16x16x32_bf16 v[96:99], a[68:71], a[36:39], v[96:99]
s_waitcnt vmcnt(17) lgkmcnt(4)
v_fma_mix_f32 v217, v166, v205, v213 op_sel:[1,0,0] op_sel_hi:[1,0,0]
v_cvt_pk_bf16_f32 v226, v216, v217
v_mfma_f32_16x16x32_bf16 v[20:23], a[72:75], a[0:3], v[20:23]
ds_read_b128 a[20:23], v9 offset:15360
v_fma_mix_f32 v218, v167, v206, v214 op_sel:[0,0,0] op_sel_hi:[1,0,0]
v_mfma_f32_16x16x32_bf16 v[24:27], a[76:79], a[0:3], v[24:27]
buffer_load_dwordx4 a[156:159], v5, s[4:7], s59 offen offset:256 sc1
v_fma_mix_f32 v219, v167, v207, v215 op_sel:[1,0,0] op_sel_hi:[1,0,0]
v_mfma_f32_16x16x32_bf16 v[28:31], a[0:3], a[80:83], v[28:31]
ds_read_b128 a[24:27], v9 offset:16384
v_cvt_pk_bf16_f32 v227, v218, v219
v_mfma_f32_16x16x32_bf16 v[32:35], a[84:87], a[0:3], v[32:35]
ds_read_b128 a[28:31], v9 offset:17408
v_fma_mix_f32 v216, v184, v200, v208 op_sel:[0,0,0] op_sel_hi:[1,0,0]
v_mfma_f32_16x16x32_bf16 v[36:39], a[72:75], a[4:7], v[36:39]
ds_read_b128 a[32:35], v9 offset:18432
v_fma_mix_f32 v217, v184, v201, v209 op_sel:[1,0,0] op_sel_hi:[1,0,0]
v_mfma_f32_16x16x32_bf16 v[40:43], a[76:79], a[4:7], v[40:43]
buffer_load_dwordx4 a[160:163], v5, s[4:7], s59 offen offset:512 sc1
v_cvt_pk_bf16_f32 v220, v216, v217
v_mfma_f32_16x16x32_bf16 v[44:47], a[4:7], a[80:83], v[44:47]
ds_read_b128 a[36:39], v9 offset:19456
v_fma_mix_f32 v218, v185, v202, v210 op_sel:[0,0,0] op_sel_hi:[1,0,0]
v_mfma_f32_16x16x32_bf16 v[48:51], a[84:87], a[4:7], v[48:51]
ds_write_b64 v254, v[226:227] offset:23560
v_mfma_f32_16x16x32_bf16 v[52:55], a[72:75], a[8:11], v[52:55]
v_fma_mix_f32 v219, v185, v203, v211 op_sel:[1,0,0] op_sel_hi:[1,0,0]
v_cvt_pk_bf16_f32 v221, v218, v219
v_mfma_f32_16x16x32_bf16 v[56:59], a[76:79], a[8:11], v[56:59]
buffer_load_dwordx4 a[164:167], v6, s[4:7], s59 offen offset:768 sc1
s_add_u32 s59, s59, 16384
v_mfma_f32_16x16x32_bf16 v[60:63], a[8:11], a[80:83], v[60:63]
ds_write_b64 v254, v[220:221] offset:24576
v_mfma_f32_16x16x32_bf16 v[64:67], a[84:87], a[8:11], v[64:67]
v_fma_mix_f32 v216, v186, v204, v212 op_sel:[0,0,0] op_sel_hi:[1,0,0]
v_fma_mix_f32 v217, v186, v205, v213 op_sel:[1,0,0] op_sel_hi:[1,0,0]
v_mfma_f32_16x16x32_bf16 v[68:71], a[72:75], a[12:15], v[68:71]
v_cvt_pk_bf16_f32 v222, v216, v217
v_fma_mix_f32 v218, v187, v206, v214 op_sel:[0,0,0] op_sel_hi:[1,0,0]
v_mfma_f32_16x16x32_bf16 v[72:75], a[76:79], a[12:15], v[72:75]
buffer_load_dwordx4 a[168:171], v5, s[4:7], s59 offen offset:0 sc1
v_fma_mix_f32 v219, v187, v207, v215 op_sel:[1,0,0] op_sel_hi:[1,0,0]
v_mfma_f32_16x16x32_bf16 v[76:79], a[12:15], a[80:83], v[76:79]
v_cvt_pk_bf16_f32 v223, v218, v219
v_cmp_le_u32 vcc, 24, v1
v_mfma_f32_16x16x32_bf16 v[80:83], a[84:87], a[12:15], v[80:83]
v_subrev_u32 v228, 24, v1
v_mov_b32 v230, 0xa00
v_mfma_f32_16x16x32_bf16 v[84:87], a[72:75], a[16:19], v[84:87]
ds_write_b64 v254, v[222:223] offset:24584
v_mfma_f32_16x16x32_bf16 v[88:91], a[76:79], a[16:19], v[88:91]
buffer_load_dwordx4 a[172:175], v5, s[4:7], s59 offen offset:256 sc1
v_cndmask_b32 v228, v1, v228, vcc
v_mfma_f32_16x16x32_bf16 v[92:95], a[16:19], a[80:83], v[92:95]
ds_read_b128 v[200:203], v10 offset:3584
v_cndmask_b32 v230, 0, v230, vcc
v_mfma_f32_16x16x32_bf16 v[96:99], a[84:87], a[16:19], v[96:99]
s_waitcnt vmcnt(18) lgkmcnt(1)
s_barrier
v_cmp_gt_u32 vcc, s17, v228
v_mfma_f32_16x16x32_bf16 v[20:23], a[88:91], a[20:23], v[20:23]
ds_read_b128 a[0:3], v8 offset:20480
v_lshl_add_u32 v230, v228, 4, v230
v_mfma_f32_16x16x32_bf16 v[24:27], a[92:95], a[20:23], v[24:27]
buffer_load_dwordx4 a[176:179], v5, s[4:7], s59 offen offset:512 sc1
v_lshlrev_b32 v229, 3, v228
v_mfma_f32_16x16x32_bf16 v[28:31], a[20:23], a[96:99], v[28:31]
ds_read_b128 a[4:7], v8 offset:21504
v_cndmask_b32 v238, v255, v230, vcc
v_mfma_f32_16x16x32_bf16 v[32:35], a[100:103], a[20:23], v[32:35]
ds_read_b128 a[8:11], v8 offset:22528
v_cndmask_b32 v239, v255, v229, vcc
v_mfma_f32_16x16x32_bf16 v[36:39], a[88:91], a[24:27], v[36:39]
ds_read_b128 a[12:15], v8 offset:23552
v_cndmask_b32 v250, 0, -1, vcc
v_mfma_f32_16x16x32_bf16 v[40:43], a[92:95], a[24:27], v[40:43]
buffer_load_dwordx4 a[180:183], v6, s[4:7], s59 offen offset:768 sc1
s_add_u32 s59, s59, 16384
v_mfma_f32_16x16x32_bf16 v[44:47], a[24:27], a[96:99], v[44:47]
ds_read_b128 a[16:19], v8 offset:24576
v_min_u32 v228, 6, v2
v_mfma_f32_16x16x32_bf16 v[48:51], a[100:103], a[24:27], v[48:51]
ds_read_b128 v[204:207], v10 offset:3600
v_add_u32 v228, s20, v228
v_mfma_f32_16x16x32_bf16 v[52:55], a[88:91], a[28:31], v[52:55]
ds_read_b128 v[208:211], v10 offset:1024
v_and_b32 v229, 3, v228
v_mfma_f32_16x16x32_bf16 v[56:59], a[92:95], a[28:31], v[56:59]
buffer_load_dwordx4 a[184:187], v5, s[4:7], s59 offen offset:0 sc1
v_lshrrev_b32 v228, 2, v228
v_mfma_f32_16x16x32_bf16 v[60:63], a[28:31], a[96:99], v[60:63]
ds_read_b128 v[212:215], v10 offset:1040
v_lshl_add_u32 v228, v228, 3, v229
v_mfma_f32_16x16x32_bf16 v[64:67], a[100:103], a[28:31], v[64:67]
v_cmp_gt_u32 vcc, 16, v1
v_add_u32 v228, s21, v228
v_mfma_f32_16x16x32_bf16 v[68:71], a[88:91], a[32:35], v[68:71]
v_add_u32 v229, s101, v1
v_cndmask_b32 v228, v228, v229, vcc
v_mfma_f32_16x16x32_bf16 v[72:75], a[92:95], a[32:35], v[72:75]
buffer_load_dwordx4 a[188:191], v5, s[4:7], s59 offen offset:256 sc1
v_lshlrev_b32 v248, 6, v228
v_mfma_f32_16x16x32_bf16 v[76:79], a[32:35], a[96:99], v[76:79]
v_mov_b32 v241, s19
v_add_u32 v4, 61440, v8
v_mfma_f32_16x16x32_bf16 v[80:83], a[100:103], a[32:35], v[80:83]
v_add_u32 v251, 61440, v9
v_mfma_f32_16x16x32_bf16 v[84:87], a[88:91], a[36:39], v[84:87]
v_mfma_f32_16x16x32_bf16 v[88:91], a[92:95], a[36:39], v[88:91]
buffer_load_dwordx4 a[192:195], v5, s[4:7], s59 offen offset:512 sc1
v_mfma_f32_16x16x32_bf16 v[92:95], a[36:39], a[96:99], v[92:95]
v_mfma_f32_16x16x32_bf16 v[96:99], a[100:103], a[36:39], v[96:99]
s_waitcnt vmcnt(19) lgkmcnt(3)
s_waitcnt lgkmcnt(0)
v_fma_mix_f32 v216, v108, v200, v208 op_sel:[0,0,0] op_sel_hi:[1,0,0]
v_mfma_f32_16x16x32_bf16 v[20:23], a[104:107], a[0:3], v[20:23]
ds_read_b128 a[20:23], v9 offset:25600
v_fma_mix_f32 v217, v108, v201, v209 op_sel:[1,0,0] op_sel_hi:[1,0,0]
v_mfma_f32_16x16x32_bf16 v[24:27], a[108:111], a[0:3], v[24:27]
buffer_load_dwordx4 a[196:199], v6, s[4:7], s59 offen offset:768 sc1
s_add_u32 s59, s59, 16384
v_mfma_f32_16x16x32_bf16 v[28:31], a[0:3], a[112:115], v[28:31]
ds_read_b128 a[24:27], v9 offset:26624
v_cvt_pk_bf16_f32 v220, v216, v217
v_mfma_f32_16x16x32_bf16 v[32:35], a[116:119], a[0:3], v[32:35]
ds_read_b128 a[28:31], v9 offset:27648
v_fma_mix_f32 v218, v109, v202, v210 op_sel:[0,0,0] op_sel_hi:[1,0,0]
v_mfma_f32_16x16x32_bf16 v[36:39], a[104:107], a[4:7], v[36:39]
ds_read_b128 a[32:35], v9 offset:28672
v_fma_mix_f32 v219, v109, v203, v211 op_sel:[1,0,0] op_sel_hi:[1,0,0]
v_mfma_f32_16x16x32_bf16 v[40:43], a[108:111], a[4:7], v[40:43]
buffer_load_dwordx4 a[200:203], v5, s[4:7], s59 offen offset:0 sc1
v_cvt_pk_bf16_f32 v221, v218, v219
v_mfma_f32_16x16x32_bf16 v[44:47], a[4:7], a[112:115], v[44:47]
ds_read_b128 a[36:39], v9 offset:29696
v_fma_mix_f32 v216, v110, v204, v212 op_sel:[0,0,0] op_sel_hi:[1,0,0]
v_mfma_f32_16x16x32_bf16 v[48:51], a[116:119], a[4:7], v[48:51]
ds_write_b64 v7, v[220:221] offset:40960
v_mfma_f32_16x16x32_bf16 v[52:55], a[104:107], a[8:11], v[52:55]
v_fma_mix_f32 v217, v110, v205, v213 op_sel:[1,0,0] op_sel_hi:[1,0,0]
v_cvt_pk_bf16_f32 v222, v216, v217
v_mfma_f32_16x16x32_bf16 v[56:59], a[108:111], a[8:11], v[56:59]
buffer_load_dwordx4 a[204:207], v5, s[4:7], s59 offen offset:256 sc1
v_fma_mix_f32 v218, v111, v206, v214 op_sel:[0,0,0] op_sel_hi:[1,0,0]
v_mfma_f32_16x16x32_bf16 v[60:63], a[8:11], a[112:115], v[60:63]
v_fma_mix_f32 v219, v111, v207, v215 op_sel:[1,0,0] op_sel_hi:[1,0,0]
v_cvt_pk_bf16_f32 v223, v218, v219
v_mfma_f32_16x16x32_bf16 v[64:67], a[116:119], a[8:11], v[64:67]
v_fma_mix_f32 v216, v128, v200, v208 op_sel:[0,0,0] op_sel_hi:[1,0,0]
v_fma_mix_f32 v217, v128, v201, v209 op_sel:[1,0,0] op_sel_hi:[1,0,0]
v_mfma_f32_16x16x32_bf16 v[68:71], a[104:107], a[12:15], v[68:71]
ds_write_b64 v7, v[222:223] offset:40968
v_mfma_f32_16x16x32_bf16 v[72:75], a[108:111], a[12:15], v[72:75]
buffer_load_dwordx4 a[208:211], v5, s[4:7], s59 offen offset:512 sc1
v_cvt_pk_bf16_f32 v224, v216, v217
v_mfma_f32_16x16x32_bf16 v[76:79], a[12:15], a[112:115], v[76:79]
v_fma_mix_f32 v218, v129, v202, v210 op_sel:[0,0,0] op_sel_hi:[1,0,0]
v_fma_mix_f32 v219, v129, v203, v211 op_sel:[1,0,0] op_sel_hi:[1,0,0]
v_mfma_f32_16x16x32_bf16 v[80:83], a[116:119], a[12:15], v[80:83]
v_cvt_pk_bf16_f32 v225, v218, v219
v_fma_mix_f32 v216, v130, v204, v212 op_sel:[0,0,0] op_sel_hi:[1,0,0]
v_mfma_f32_16x16x32_bf16 v[84:87], a[104:107], a[16:19], v[84:87]
v_fma_mix_f32 v217, v130, v205, v213 op_sel:[1,0,0] op_sel_hi:[1,0,0]
v_cvt_pk_bf16_f32 v226, v216, v217
v_mfma_f32_16x16x32_bf16 v[88:91], a[108:111], a[16:19], v[88:91]
buffer_load_dwordx4 a[212:215], v6, s[4:7], s59 offen offset:768 sc1
s_add_u32 s59, s59, 16384
v_mfma_f32_16x16x32_bf16 v[92:95], a[16:19], a[112:115], v[92:95]
ds_write_b64 v7, v[224:225] offset:41984
v_mfma_f32_16x16x32_bf16 v[96:99], a[116:119], a[16:19], v[96:99]
s_waitcnt vmcnt(20) lgkmcnt(3)
v_fma_mix_f32 v218, v131, v206, v214 op_sel:[0,0,0] op_sel_hi:[1,0,0]
v_fma_mix_f32 v219, v131, v207, v215 op_sel:[1,0,0] op_sel_hi:[1,0,0]
v_mfma_f32_16x16x32_bf16 v[20:23], a[120:123], a[20:23], v[20:23]
ds_read_b128 a[0:3], v8 offset:30720
v_cvt_pk_bf16_f32 v227, v218, v219
v_mfma_f32_16x16x32_bf16 v[24:27], a[124:127], a[20:23], v[24:27]
buffer_load_dwordx4 a[216:219], v5, s[4:7], s59 offen offset:0 sc1
v_fma_mix_f32 v216, v148, v200, v208 op_sel:[0,0,0] op_sel_hi:[1,0,0]
v_mfma_f32_16x16x32_bf16 v[28:31], a[20:23], a[128:131], v[28:31]
ds_read_b128 a[4:7], v8 offset:31744
v_fma_mix_f32 v217, v148, v201, v209 op_sel:[1,0,0] op_sel_hi:[1,0,0]
v_mfma_f32_16x16x32_bf16 v[32:35], a[132:135], a[20:23], v[32:35]
ds_read_b128 a[8:11], v8 offset:32768
v_cvt_pk_bf16_f32 v220, v216, v217
v_mfma_f32_16x16x32_bf16 v[36:39], a[120:123], a[24:27], v[36:39]
ds_read_b128 a[12:15], v8 offset:33792
v_fma_mix_f32 v218, v149, v202, v210 op_sel:[0,0,0] op_sel_hi:[1,0,0]
v_mfma_f32_16x16x32_bf16 v[40:43], a[124:127], a[24:27], v[40:43]
buffer_load_dwordx4 a[220:223], v5, s[4:7], s59 offen offset:256 sc1
v_fma_mix_f32 v219, v149, v203, v211 op_sel:[1,0,0] op_sel_hi:[1,0,0]
v_mfma_f32_16x16x32_bf16 v[44:47], a[24:27], a[128:131], v[44:47]
ds_read_b128 a[16:19], v8 offset:34816
v_cvt_pk_bf16_f32 v221, v218, v219
v_mfma_f32_16x16x32_bf16 v[48:51], a[132:135], a[24:27], v[48:51]
ds_write_b64 v7, v[226:227] offset:41992
v_mfma_f32_16x16x32_bf16 v[52:55], a[120:123], a[28:31], v[52:55]
v_fma_mix_f32 v216, v150, v204, v212 op_sel:[0,0,0] op_sel_hi:[1,0,0]
v_fma_mix_f32 v217, v150, v205, v213 op_sel:[1,0,0] op_sel_hi:[1,0,0]
v_mfma_f32_16x16x32_bf16 v[56:59], a[124:127], a[28:31], v[56:59]
buffer_load_dwordx4 a[224:227], v5, s[4:7], s59 offen offset:512 sc1
v_cvt_pk_bf16_f32 v222, v216, v217
v_mfma_f32_16x16x32_bf16 v[60:63], a[28:31], a[128:131], v[60:63]
ds_write_b64 v253, v[220:221] offset:43008
v_mfma_f32_16x16x32_bf16 v[64:67], a[132:135], a[28:31], v[64:67]
v_fma_mix_f32 v218, v151, v206, v214 op_sel:[0,0,0] op_sel_hi:[1,0,0]
v_fma_mix_f32 v219, v151, v207, v215 op_sel:[1,0,0] op_sel_hi:[1,0,0]
v_mfma_f32_16x16x32_bf16 v[68:71], a[120:123], a[32:35], v[68:71]
v_cvt_pk_bf16_f32 v223, v218, v219
v_fma_mix_f32 v216, v168, v200, v208 op_sel:[0,0,0] op_sel_hi:[1,0,0]
v_mfma_f32_16x16x32_bf16 v[72:75], a[124:127], a[32:35], v[72:75]
buffer_load_dwordx4 a[228:231], v6, s[4:7], s59 offen offset:768 sc1
s_add_u32 s59, s59, 16384
v_mfma_f32_16x16x32_bf16 v[76:79], a[32:35], a[128:131], v[76:79]
ds_write_b64 v253, v[222:223] offset:43016
v_mfma_f32_16x16x32_bf16 v[80:83], a[132:135], a[32:35], v[80:83]
v_fma_mix_f32 v217, v168, v201, v209 op_sel:[1,0,0] op_sel_hi:[1,0,0]
v_cvt_pk_bf16_f32 v224, v216, v217
v_mfma_f32_16x16x32_bf16 v[84:87], a[120:123], a[36:39], v[84:87]
v_fma_mix_f32 v218, v169, v202, v210 op_sel:[0,0,0] op_sel_hi:[1,0,0]
v_fma_mix_f32 v219, v169, v203, v211 op_sel:[1,0,0] op_sel_hi:[1,0,0]
v_mfma_f32_16x16x32_bf16 v[88:91], a[124:127], a[36:39], v[88:91]
v_cvt_pk_bf16_f32 v225, v218, v219
v_fma_mix_f32 v216, v170, v204, v212 op_sel:[0,0,0] op_sel_hi:[1,0,0]
v_mfma_f32_16x16x32_bf16 v[92:95], a[36:39], a[128:131], v[92:95]
v_fma_mix_f32 v217, v170, v205, v213 op_sel:[1,0,0] op_sel_hi:[1,0,0]
v_cvt_pk_bf16_f32 v226, v216, v217
v_mfma_f32_16x16x32_bf16 v[96:99], a[132:135], a[36:39], v[96:99]
s_waitcnt vmcnt(20) lgkmcnt(3)
v_fma_mix_f32 v218, v171, v206, v214 op_sel:[0,0,0] op_sel_hi:[1,0,0]
v_fma_mix_f32 v219, v171, v207, v215 op_sel:[1,0,0] op_sel_hi:[1,0,0]
v_mfma_f32_16x16x32_bf16 v[20:23], a[136:139], a[0:3], v[20:23]
ds_read_b128 a[20:23], v9 offset:35840
v_cvt_pk_bf16_f32 v227, v218, v219
v_mfma_f32_16x16x32_bf16 v[24:27], a[140:143], a[0:3], v[24:27]
buffer_load_dwordx4 a[40:43], v5, s[4:7], s59 offen offset:0 sc1
v_fma_mix_f32 v216, v188, v200, v208 op_sel:[0,0,0] op_sel_hi:[1,0,0]
v_mfma_f32_16x16x32_bf16 v[28:31], a[0:3], a[144:147], v[28:31]
ds_read_b128 a[24:27], v9 offset:36864
v_fma_mix_f32 v217, v188, v201, v209 op_sel:[1,0,0] op_sel_hi:[1,0,0]
v_mfma_f32_16x16x32_bf16 v[32:35], a[148:151], a[0:3], v[32:35]
ds_read_b128 a[28:31], v9 offset:37888
v_cvt_pk_bf16_f32 v220, v216, v217
v_mfma_f32_16x16x32_bf16 v[36:39], a[136:139], a[4:7], v[36:39]
ds_read_b128 a[32:35], v9 offset:38912
v_fma_mix_f32 v218, v189, v202, v210 op_sel:[0,0,0] op_sel_hi:[1,0,0]
v_mfma_f32_16x16x32_bf16 v[40:43], a[140:143], a[4:7], v[40:43]
buffer_load_dwordx4 a[44:47], v5, s[4:7], s59 offen offset:256 sc1
v_fma_mix_f32 v219, v189, v203, v211 op_sel:[1,0,0] op_sel_hi:[1,0,0]
v_mfma_f32_16x16x32_bf16 v[44:47], a[4:7], a[144:147], v[44:47]
ds_read_b128 a[36:39], v9 offset:39936
v_cvt_pk_bf16_f32 v221, v218, v219
v_mfma_f32_16x16x32_bf16 v[48:51], a[148:151], a[4:7], v[48:51]
ds_write_b64 v254, v[224:225] offset:44032
v_mfma_f32_16x16x32_bf16 v[52:55], a[136:139], a[8:11], v[52:55]
v_fma_mix_f32 v216, v190, v204, v212 op_sel:[0,0,0] op_sel_hi:[1,0,0]
v_fma_mix_f32 v217, v190, v205, v213 op_sel:[1,0,0] op_sel_hi:[1,0,0]
v_mfma_f32_16x16x32_bf16 v[56:59], a[140:143], a[8:11], v[56:59]
buffer_store_dwordx4 a[232:235], v11, s[4:7], s46 offen sc1
v_mfma_f32_16x16x32_bf16 v[60:63], a[8:11], a[144:147], v[60:63]
ds_write_b64 v254, v[226:227] offset:44040
v_mfma_f32_16x16x32_bf16 v[64:67], a[148:151], a[8:11], v[64:67]
v_cvt_pk_bf16_f32 v222, v216, v217
v_fma_mix_f32 v218, v191, v206, v214 op_sel:[0,0,0] op_sel_hi:[1,0,0]
v_mfma_f32_16x16x32_bf16 v[68:71], a[136:139], a[12:15], v[68:71]
ds_write_b64 v254, v[220:221] offset:45056
v_mfma_f32_16x16x32_bf16 v[72:75], a[140:143], a[12:15], v[72:75]
buffer_load_dwordx4 a[48:51], v5, s[4:7], s59 offen offset:512 sc1
v_fma_mix_f32 v219, v191, v207, v215 op_sel:[1,0,0] op_sel_hi:[1,0,0]
v_mfma_f32_16x16x32_bf16 v[76:79], a[12:15], a[144:147], v[76:79]
v_cvt_pk_bf16_f32 v223, v218, v219
v_add_u32 v7, 61440, v7
v_mfma_f32_16x16x32_bf16 v[80:83], a[148:151], a[12:15], v[80:83]
v_add_u32 v253, 61440, v253
v_mfma_f32_16x16x32_bf16 v[84:87], a[136:139], a[16:19], v[84:87]
ds_write_b64 v254, v[222:223] offset:45064
v_mfma_f32_16x16x32_bf16 v[88:91], a[140:143], a[16:19], v[88:91]
buffer_load_dwordx4 a[52:55], v6, s[4:7], s59 offen offset:768 sc1
s_add_u32 s59, s59, 16384
v_mfma_f32_16x16x32_bf16 v[92:95], a[16:19], a[144:147], v[92:95]
ds_read_b128 v[200:203], v10 offset:4096
v_add_u32 v254, 61440, v254
v_mfma_f32_16x16x32_bf16 v[96:99], a[148:151], a[16:19], v[96:99]
s_waitcnt vmcnt(21) lgkmcnt(1)
s_barrier
v_mfma_f32_16x16x32_bf16 v[20:23], a[152:155], a[20:23], v[20:23]
ds_read_b128 a[0:3], v8 offset:40960
v_mfma_f32_16x16x32_bf16 v[24:27], a[156:159], a[20:23], v[24:27]
buffer_load_dwordx4 a[56:59], v5, s[4:7], s59 offen offset:0 sc1
v_mfma_f32_16x16x32_bf16 v[28:31], a[20:23], a[160:163], v[28:31]
ds_read_b128 a[4:7], v8 offset:41984
v_mfma_f32_16x16x32_bf16 v[32:35], a[164:167], a[20:23], v[32:35]
ds_read_b128 a[8:11], v8 offset:43008
v_mfma_f32_16x16x32_bf16 v[36:39], a[152:155], a[24:27], v[36:39]
ds_read_b128 a[12:15], v8 offset:44032
v_mfma_f32_16x16x32_bf16 v[40:43], a[156:159], a[24:27], v[40:43]
buffer_load_dwordx4 a[60:63], v5, s[4:7], s59 offen offset:256 sc1
v_mfma_f32_16x16x32_bf16 v[44:47], a[24:27], a[160:163], v[44:47]
ds_read_b128 a[16:19], v8 offset:45056
v_mfma_f32_16x16x32_bf16 v[48:51], a[164:167], a[24:27], v[48:51]
ds_read_b128 v[204:207], v10 offset:4112
v_mfma_f32_16x16x32_bf16 v[52:55], a[152:155], a[28:31], v[52:55]
ds_read_b128 v[208:211], v10 offset:1536
v_mfma_f32_16x16x32_bf16 v[56:59], a[156:159], a[28:31], v[56:59]
buffer_store_dwordx4 a[232:235], v12, s[4:7], s46 offen sc1
v_mfma_f32_16x16x32_bf16 v[60:63], a[28:31], a[160:163], v[60:63]
ds_read_b128 v[212:215], v10 offset:1552
v_mfma_f32_16x16x32_bf16 v[64:67], a[164:167], a[28:31], v[64:67]
v_mfma_f32_16x16x32_bf16 v[68:71], a[152:155], a[32:35], v[68:71]
v_mfma_f32_16x16x32_bf16 v[72:75], a[156:159], a[32:35], v[72:75]
buffer_load_dwordx4 a[64:67], v5, s[4:7], s59 offen offset:512 sc1
v_mfma_f32_16x16x32_bf16 v[76:79], a[32:35], a[160:163], v[76:79]
s_waitcnt lgkmcnt(0)
v_fma_mix_f32 v216, v112, v200, v208 op_sel:[0,0,0] op_sel_hi:[1,0,0]
v_fma_mix_f32 v217, v112, v201, v209 op_sel:[1,0,0] op_sel_hi:[1,0,0]
v_mfma_f32_16x16x32_bf16 v[80:83], a[164:167], a[32:35], v[80:83]
v_cvt_pk_bf16_f32 v220, v216, v217
v_fma_mix_f32 v218, v113, v202, v210 op_sel:[0,0,0] op_sel_hi:[1,0,0]
v_mfma_f32_16x16x32_bf16 v[84:87], a[152:155], a[36:39], v[84:87]
v_fma_mix_f32 v219, v113, v203, v211 op_sel:[1,0,0] op_sel_hi:[1,0,0]
v_cvt_pk_bf16_f32 v221, v218, v219
v_mfma_f32_16x16x32_bf16 v[88:91], a[156:159], a[36:39], v[88:91]
buffer_load_dwordx4 a[68:71], v6, s[4:7], s59 offen offset:768 sc1
s_add_u32 s59, s59, 16384
v_mfma_f32_16x16x32_bf16 v[92:95], a[36:39], a[160:163], v[92:95]
ds_write_b64 v7, v[220:221] offset:0
v_mfma_f32_16x16x32_bf16 v[96:99], a[164:167], a[36:39], v[96:99]
s_waitcnt vmcnt(22)
v_fma_mix_f32 v216, v114, v204, v212 op_sel:[0,0,0] op_sel_hi:[1,0,0]
v_fma_mix_f32 v217, v114, v205, v213 op_sel:[1,0,0] op_sel_hi:[1,0,0]
v_mfma_f32_16x16x32_bf16 v[20:23], a[168:171], a[0:3], v[20:23]
ds_read_b128 a[20:23], v9 offset:46080
v_cvt_pk_bf16_f32 v222, v216, v217
v_mfma_f32_16x16x32_bf16 v[24:27], a[172:175], a[0:3], v[24:27]
buffer_load_dwordx4 a[72:75], v5, s[4:7], s59 offen offset:0 sc1
v_fma_mix_f32 v218, v115, v206, v214 op_sel:[0,0,0] op_sel_hi:[1,0,0]
v_mfma_f32_16x16x32_bf16 v[28:31], a[0:3], a[176:179], v[28:31]
ds_read_b128 a[24:27], v9 offset:47104
v_fma_mix_f32 v219, v115, v207, v215 op_sel:[1,0,0] op_sel_hi:[1,0,0]
v_mfma_f32_16x16x32_bf16 v[32:35], a[180:183], a[0:3], v[32:35]
ds_read_b128 a[28:31], v9 offset:48128
v_cvt_pk_bf16_f32 v223, v218, v219
v_mfma_f32_16x16x32_bf16 v[36:39], a[168:171], a[4:7], v[36:39]
ds_read_b128 a[32:35], v9 offset:49152
v_fma_mix_f32 v216, v132, v200, v208 op_sel:[0,0,0] op_sel_hi:[1,0,0]
v_mfma_f32_16x16x32_bf16 v[40:43], a[172:175], a[4:7], v[40:43]
buffer_load_dwordx4 a[76:79], v5, s[4:7], s59 offen offset:256 sc1
v_fma_mix_f32 v217, v132, v201, v209 op_sel:[1,0,0] op_sel_hi:[1,0,0]
v_mfma_f32_16x16x32_bf16 v[44:47], a[4:7], a[176:179], v[44:47]
ds_read_b128 a[36:39], v9 offset:50176
v_cvt_pk_bf16_f32 v224, v216, v217
v_mfma_f32_16x16x32_bf16 v[48:51], a[180:183], a[4:7], v[48:51]
ds_write_b64 v7, v[222:223] offset:8
v_mfma_f32_16x16x32_bf16 v[52:55], a[168:171], a[8:11], v[52:55]
v_fma_mix_f32 v218, v133, v202, v210 op_sel:[0,0,0] op_sel_hi:[1,0,0]
v_fma_mix_f32 v219, v133, v203, v211 op_sel:[1,0,0] op_sel_hi:[1,0,0]
v_mfma_f32_16x16x32_bf16 v[56:59], a[172:175], a[8:11], v[56:59]
buffer_store_dwordx4 a[232:235], v13, s[4:7], s46 offen sc1
v_mfma_f32_16x16x32_bf16 v[60:63], a[8:11], a[176:179], v[60:63]
v_cvt_pk_bf16_f32 v225, v218, v219
v_fma_mix_f32 v216, v134, v204, v212 op_sel:[0,0,0] op_sel_hi:[1,0,0]
v_mfma_f32_16x16x32_bf16 v[64:67], a[180:183], a[8:11], v[64:67]
v_fma_mix_f32 v217, v134, v205, v213 op_sel:[1,0,0] op_sel_hi:[1,0,0]
v_cvt_pk_bf16_f32 v226, v216, v217
v_mfma_f32_16x16x32_bf16 v[68:71], a[168:171], a[12:15], v[68:71]
ds_write_b64 v7, v[224:225] offset:1024
v_mfma_f32_16x16x32_bf16 v[72:75], a[172:175], a[12:15], v[72:75]
buffer_load_dwordx4 a[80:83], v5, s[4:7], s59 offen offset:512 sc1
v_fma_mix_f32 v218, v135, v206, v214 op_sel:[0,0,0] op_sel_hi:[1,0,0]
v_mfma_f32_16x16x32_bf16 v[76:79], a[12:15], a[176:179], v[76:79]
v_fma_mix_f32 v219, v135, v207, v215 op_sel:[1,0,0] op_sel_hi:[1,0,0]
v_cvt_pk_bf16_f32 v227, v218, v219
v_mfma_f32_16x16x32_bf16 v[80:83], a[180:183], a[12:15], v[80:83]
v_fma_mix_f32 v216, v152, v200, v208 op_sel:[0,0,0] op_sel_hi:[1,0,0]
v_fma_mix_f32 v217, v152, v201, v209 op_sel:[1,0,0] op_sel_hi:[1,0,0]
v_mfma_f32_16x16x32_bf16 v[84:87], a[168:171], a[16:19], v[84:87]
ds_write_b64 v7, v[226:227] offset:1032
v_mfma_f32_16x16x32_bf16 v[88:91], a[172:175], a[16:19], v[88:91]
buffer_load_dwordx4 a[84:87], v6, s[4:7], s59 offen offset:768 sc1
s_add_u32 s59, s59, 16384
v_mfma_f32_16x16x32_bf16 v[92:95], a[16:19], a[176:179], v[92:95]
v_cvt_pk_bf16_f32 v220, v216, v217
v_fma_mix_f32 v218, v153, v202, v210 op_sel:[0,0,0] op_sel_hi:[1,0,0]
v_mfma_f32_16x16x32_bf16 v[96:99], a[180:183], a[16:19], v[96:99]
s_waitcnt vmcnt(23) lgkmcnt(3)
v_fma_mix_f32 v219, v153, v203, v211 op_sel:[1,0,0] op_sel_hi:[1,0,0]
v_cvt_pk_bf16_f32 v221, v218, v219
v_mfma_f32_16x16x32_bf16 v[20:23], a[184:187], a[20:23], v[20:23]
ds_read_b128 a[0:3], v8 offset:51200
v_fma_mix_f32 v216, v154, v204, v212 op_sel:[0,0,0] op_sel_hi:[1,0,0]
v_mfma_f32_16x16x32_bf16 v[24:27], a[188:191], a[20:23], v[24:27]
buffer_load_dwordx4 a[88:91], v5, s[4:7], s59 offen offset:0 sc1
v_fma_mix_f32 v217, v154, v205, v213 op_sel:[1,0,0] op_sel_hi:[1,0,0]
v_mfma_f32_16x16x32_bf16 v[28:31], a[20:23], a[192:195], v[28:31]
ds_read_b128 a[4:7], v8 offset:52224
v_cvt_pk_bf16_f32 v222, v216, v217
v_mfma_f32_16x16x32_bf16 v[32:35], a[196:199], a[20:23], v[32:35]
ds_read_b128 a[8:11], v8 offset:53248
v_fma_mix_f32 v218, v155, v206, v214 op_sel:[0,0,0] op_sel_hi:[1,0,0]
v_mfma_f32_16x16x32_bf16 v[36:39], a[184:187], a[24:27], v[36:39]
ds_read_b128 a[12:15], v8 offset:54272
v_fma_mix_f32 v219, v155, v207, v215 op_sel:[1,0,0] op_sel_hi:[1,0,0]
v_mfma_f32_16x16x32_bf16 v[40:43], a[188:191], a[24:27], v[40:43]
buffer_load_dwordx4 a[92:95], v5, s[4:7], s59 offen offset:256 sc1
v_cvt_pk_bf16_f32 v223, v218, v219
v_mfma_f32_16x16x32_bf16 v[44:47], a[24:27], a[192:195], v[44:47]
ds_read_b128 a[16:19], v8 offset:55296
v_fma_mix_f32 v216, v172, v200, v208 op_sel:[0,0,0] op_sel_hi:[1,0,0]
v_mfma_f32_16x16x32_bf16 v[48:51], a[196:199], a[24:27], v[48:51]
ds_write_b64 v253, v[220:221] offset:2048
v_mfma_f32_16x16x32_bf16 v[52:55], a[184:187], a[28:31], v[52:55]
v_fma_mix_f32 v217, v172, v201, v209 op_sel:[1,0,0] op_sel_hi:[1,0,0]
v_cvt_pk_bf16_f32 v224, v216, v217
v_mfma_f32_16x16x32_bf16 v[56:59], a[188:191], a[28:31], v[56:59]
buffer_store_dwordx4 a[232:235], v14, s[4:7], s46 offen sc1
v_mfma_f32_16x16x32_bf16 v[60:63], a[28:31], a[192:195], v[60:63]
ds_write_b64 v253, v[222:223] offset:2056
v_mfma_f32_16x16x32_bf16 v[64:67], a[196:199], a[28:31], v[64:67]
v_fma_mix_f32 v218, v173, v202, v210 op_sel:[0,0,0] op_sel_hi:[1,0,0]
v_fma_mix_f32 v219, v173, v203, v211 op_sel:[1,0,0] op_sel_hi:[1,0,0]
v_mfma_f32_16x16x32_bf16 v[68:71], a[184:187], a[32:35], v[68:71]
v_cvt_pk_bf16_f32 v225, v218, v219
v_fma_mix_f32 v216, v174, v204, v212 op_sel:[0,0,0] op_sel_hi:[1,0,0]
v_mfma_f32_16x16x32_bf16 v[72:75], a[188:191], a[32:35], v[72:75]
buffer_load_dwordx4 a[96:99], v5, s[4:7], s59 offen offset:512 sc1
v_fma_mix_f32 v217, v174, v205, v213 op_sel:[1,0,0] op_sel_hi:[1,0,0]
v_mfma_f32_16x16x32_bf16 v[76:79], a[32:35], a[192:195], v[76:79]
ds_write_b64 v254, v[224:225] offset:3072
v_mfma_f32_16x16x32_bf16 v[80:83], a[196:199], a[32:35], v[80:83]
v_cvt_pk_bf16_f32 v226, v216, v217
v_fma_mix_f32 v218, v175, v206, v214 op_sel:[0,0,0] op_sel_hi:[1,0,0]
v_mfma_f32_16x16x32_bf16 v[84:87], a[184:187], a[36:39], v[84:87]
v_fma_mix_f32 v219, v175, v207, v215 op_sel:[1,0,0] op_sel_hi:[1,0,0]
v_cvt_pk_bf16_f32 v227, v218, v219
v_mfma_f32_16x16x32_bf16 v[88:91], a[188:191], a[36:39], v[88:91]
buffer_load_dwordx4 a[100:103], v6, s[4:7], s59 offen offset:768 sc1
s_add_u32 s59, s59, 16384
v_mfma_f32_16x16x32_bf16 v[92:95], a[36:39], a[192:195], v[92:95]
ds_write_b64 v254, v[226:227] offset:3080
v_mfma_f32_16x16x32_bf16 v[96:99], a[196:199], a[36:39], v[96:99]
s_waitcnt vmcnt(24) lgkmcnt(4)
v_fma_mix_f32 v216, v192, v200, v208 op_sel:[0,0,0] op_sel_hi:[1,0,0]
v_fma_mix_f32 v217, v192, v201, v209 op_sel:[1,0,0] op_sel_hi:[1,0,0]
v_mfma_f32_16x16x32_bf16 v[20:23], a[200:203], a[0:3], v[20:23]
ds_read_b128 a[20:23], v9 offset:56320
v_cvt_pk_bf16_f32 v220, v216, v217
v_mfma_f32_16x16x32_bf16 v[24:27], a[204:207], a[0:3], v[24:27]
buffer_load_dwordx4 a[104:107], v5, s[4:7], s59 offen offset:0 sc1
v_fma_mix_f32 v218, v193, v202, v210 op_sel:[0,0,0] op_sel_hi:[1,0,0]
v_mfma_f32_16x16x32_bf16 v[28:31], a[0:3], a[208:211], v[28:31]
ds_read_b128 a[24:27], v9 offset:57344
v_fma_mix_f32 v219, v193, v203, v211 op_sel:[1,0,0] op_sel_hi:[1,0,0]
v_mfma_f32_16x16x32_bf16 v[32:35], a[212:215], a[0:3], v[32:35]
ds_read_b128 a[28:31], v9 offset:58368
v_cvt_pk_bf16_f32 v221, v218, v219
v_mfma_f32_16x16x32_bf16 v[36:39], a[200:203], a[4:7], v[36:39]
ds_read_b128 a[32:35], v9 offset:59392
v_fma_mix_f32 v216, v194, v204, v212 op_sel:[0,0,0] op_sel_hi:[1,0,0]
v_mfma_f32_16x16x32_bf16 v[40:43], a[204:207], a[4:7], v[40:43]
buffer_load_dwordx4 a[108:111], v5, s[4:7], s59 offen offset:256 sc1
v_fma_mix_f32 v217, v194, v205, v213 op_sel:[1,0,0] op_sel_hi:[1,0,0]
v_mfma_f32_16x16x32_bf16 v[44:47], a[4:7], a[208:211], v[44:47]
ds_read_b128 a[36:39], v9 offset:60416
v_cvt_pk_bf16_f32 v222, v216, v217
v_mfma_f32_16x16x32_bf16 v[48:51], a[212:215], a[4:7], v[48:51]
ds_write_b64 v254, v[220:221] offset:4096
v_mfma_f32_16x16x32_bf16 v[52:55], a[200:203], a[8:11], v[52:55]
v_fma_mix_f32 v218, v195, v206, v214 op_sel:[0,0,0] op_sel_hi:[1,0,0]
v_fma_mix_f32 v219, v195, v207, v215 op_sel:[1,0,0] op_sel_hi:[1,0,0]
v_mfma_f32_16x16x32_bf16 v[56:59], a[204:207], a[8:11], v[56:59]
buffer_store_dwordx4 a[232:235], v246, s[4:7], s18 offen sc1
v_mfma_f32_16x16x32_bf16 v[60:63], a[8:11], a[208:211], v[60:63]
v_cvt_pk_bf16_f32 v223, v218, v219
v_mfma_f32_16x16x32_bf16 v[64:67], a[212:215], a[8:11], v[64:67]
v_mfma_f32_16x16x32_bf16 v[68:71], a[200:203], a[12:15], v[68:71]
ds_write_b64 v254, v[222:223] offset:4104
v_mfma_f32_16x16x32_bf16 v[72:75], a[204:207], a[12:15], v[72:75]
buffer_load_dwordx4 a[112:115], v5, s[4:7], s59 offen offset:512 sc1
v_mfma_f32_16x16x32_bf16 v[76:79], a[12:15], a[208:211], v[76:79]
ds_read_b128 v[200:203], v10 offset:4608
v_mfma_f32_16x16x32_bf16 v[80:83], a[212:215], a[12:15], v[80:83]
ds_read_b128 v[204:207], v10 offset:4624
v_mfma_f32_16x16x32_bf16 v[84:87], a[200:203], a[16:19], v[84:87]
ds_read_b128 v[208:211], v10 offset:2048
v_mfma_f32_16x16x32_bf16 v[88:91], a[204:207], a[16:19], v[88:91]
ds_read_b128 v[212:215], v10 offset:2064
v_mfma_f32_16x16x32_bf16 v[92:95], a[16:19], a[208:211], v[92:95]
v_mfma_f32_16x16x32_bf16 v[96:99], a[212:215], a[16:19], v[96:99]
s_waitcnt vmcnt(24) lgkmcnt(4)
s_barrier
v_mfma_f32_16x16x32_bf16 v[20:23], a[216:219], a[20:23], v[20:23]
ds_read_b128 a[0:3], v4 offset:0
v_mfma_f32_16x16x32_bf16 v[24:27], a[220:223], a[20:23], v[24:27]
buffer_load_dwordx4 a[116:119], v6, s[4:7], s59 offen offset:768 sc1
s_add_u32 s59, s59, 16384
v_mfma_f32_16x16x32_bf16 v[28:31], a[20:23], a[224:227], v[28:31]
ds_read_b128 a[4:7], v4 offset:1024
v_mfma_f32_16x16x32_bf16 v[32:35], a[228:231], a[20:23], v[32:35]
ds_read_b128 a[8:11], v4 offset:2048
v_mfma_f32_16x16x32_bf16 v[36:39], a[216:219], a[24:27], v[36:39]
ds_read_b128 a[12:15], v4 offset:3072
v_mfma_f32_16x16x32_bf16 v[40:43], a[220:223], a[24:27], v[40:43]
buffer_load_dwordx4 a[120:123], v5, s[4:7], s59 offen offset:0 sc1
s_waitcnt lgkmcnt(4)
v_mfma_f32_16x16x32_bf16 v[44:47], a[24:27], a[224:227], v[44:47]
ds_read_b128 a[16:19], v4 offset:4096
v_fma_mix_f32 v216, v116, v200, v208 op_sel:[0,0,0] op_sel_hi:[1,0,0]
v_mfma_f32_16x16x32_bf16 v[48:51], a[228:231], a[24:27], v[48:51]
v_fma_mix_f32 v217, v116, v201, v209 op_sel:[1,0,0] op_sel_hi:[1,0,0]
v_cvt_pk_bf16_f32 v220, v216, v217
v_mfma_f32_16x16x32_bf16 v[52:55], a[216:219], a[28:31], v[52:55]
v_fma_mix_f32 v218, v117, v202, v210 op_sel:[0,0,0] op_sel_hi:[1,0,0]
v_fma_mix_f32 v219, v117, v203, v211 op_sel:[1,0,0] op_sel_hi:[1,0,0]
v_mfma_f32_16x16x32_bf16 v[56:59], a[220:223], a[28:31], v[56:59]
buffer_load_dwordx4 a[124:127], v5, s[4:7], s59 offen offset:256 sc1
v_cvt_pk_bf16_f32 v221, v218, v219
v_mfma_f32_16x16x32_bf16 v[60:63], a[28:31], a[224:227], v[60:63]
v_fma_mix_f32 v216, v118, v204, v212 op_sel:[0,0,0] op_sel_hi:[1,0,0]
v_fma_mix_f32 v217, v118, v205, v213 op_sel:[1,0,0] op_sel_hi:[1,0,0]
v_mfma_f32_16x16x32_bf16 v[64:67], a[228:231], a[28:31], v[64:67]
ds_write_b64 v7, v[220:221] offset:20480
v_mfma_f32_16x16x32_bf16 v[68:71], a[216:219], a[32:35], v[68:71]
v_cvt_pk_bf16_f32 v222, v216, v217
v_fma_mix_f32 v218, v119, v206, v214 op_sel:[0,0,0] op_sel_hi:[1,0,0]
v_mfma_f32_16x16x32_bf16 v[72:75], a[220:223], a[32:35], v[72:75]
buffer_load_dwordx4 a[128:131], v5, s[4:7], s59 offen offset:512 sc1
v_fma_mix_f32 v219, v119, v207, v215 op_sel:[1,0,0] op_sel_hi:[1,0,0]
v_mfma_f32_16x16x32_bf16 v[76:79], a[32:35], a[224:227], v[76:79]
v_cvt_pk_bf16_f32 v223, v218, v219
v_fma_mix_f32 v216, v136, v200, v208 op_sel:[0,0,0] op_sel_hi:[1,0,0]
v_mfma_f32_16x16x32_bf16 v[80:83], a[228:231], a[32:35], v[80:83]
v_fma_mix_f32 v217, v136, v201, v209 op_sel:[1,0,0] op_sel_hi:[1,0,0]
v_cvt_pk_bf16_f32 v224, v216, v217
v_mfma_f32_16x16x32_bf16 v[84:87], a[216:219], a[36:39], v[84:87]
ds_write_b64 v7, v[222:223] offset:20488
v_mfma_f32_16x16x32_bf16 v[88:91], a[220:223], a[36:39], v[88:91]
buffer_load_dwordx4 a[132:135], v6, s[4:7], s59 offen offset:768 sc1
s_add_u32 s59, s59, 16384
v_mfma_f32_16x16x32_bf16 v[92:95], a[36:39], a[224:227], v[92:95]
v_fma_mix_f32 v218, v137, v202, v210 op_sel:[0,0,0] op_sel_hi:[1,0,0]
v_fma_mix_f32 v219, v137, v203, v211 op_sel:[1,0,0] op_sel_hi:[1,0,0]
v_mfma_f32_16x16x32_bf16 v[96:99], a[228:231], a[36:39], v[96:99]
s_waitcnt vmcnt(24) lgkmcnt(2)
v_cvt_pk_bf16_f32 v225, v218, v219
v_fma_mix_f32 v216, v138, v204, v212 op_sel:[0,0,0] op_sel_hi:[1,0,0]
v_mfma_f32_16x16x32_bf16 v[20:23], a[40:43], a[0:3], v[20:23]
ds_read_b128 a[20:23], v251 offset:5120
v_fma_mix_f32 v217, v138, v205, v213 op_sel:[1,0,0] op_sel_hi:[1,0,0]
v_mfma_f32_16x16x32_bf16 v[24:27], a[44:47], a[0:3], v[24:27]
buffer_load_dwordx4 a[136:139], v5, s[4:7], s59 offen offset:0 sc1
v_cvt_pk_bf16_f32 v226, v216, v217
v_mfma_f32_16x16x32_bf16 v[28:31], a[0:3], a[48:51], v[28:31]
ds_read_b128 a[24:27], v251 offset:6144
v_fma_mix_f32 v218, v139, v206, v214 op_sel:[0,0,0] op_sel_hi:[1,0,0]
v_mfma_f32_16x16x32_bf16 v[32:35], a[52:55], a[0:3], v[32:35]
ds_read_b128 a[28:31], v251 offset:7168
v_fma_mix_f32 v219, v139, v207, v215 op_sel:[1,0,0] op_sel_hi:[1,0,0]
v_mfma_f32_16x16x32_bf16 v[36:39], a[40:43], a[4:7], v[36:39]
ds_read_b128 a[32:35], v251 offset:8192
v_cvt_pk_bf16_f32 v227, v218, v219
v_mfma_f32_16x16x32_bf16 v[40:43], a[44:47], a[4:7], v[40:43]
buffer_load_dwordx4 a[140:143], v5, s[4:7], s59 offen offset:256 sc1
v_fma_mix_f32 v216, v156, v200, v208 op_sel:[0,0,0] op_sel_hi:[1,0,0]
v_mfma_f32_16x16x32_bf16 v[44:47], a[4:7], a[48:51], v[44:47]
ds_read_b128 a[36:39], v251 offset:9216
v_fma_mix_f32 v217, v156, v201, v209 op_sel:[1,0,0] op_sel_hi:[1,0,0]
v_mfma_f32_16x16x32_bf16 v[48:51], a[52:55], a[4:7], v[48:51]
ds_write_b64 v7, v[224:225] offset:21504
v_mfma_f32_16x16x32_bf16 v[52:55], a[40:43], a[8:11], v[52:55]
v_cvt_pk_bf16_f32 v220, v216, v217
v_fma_mix_f32 v218, v157, v202, v210 op_sel:[0,0,0] op_sel_hi:[1,0,0]
v_mfma_f32_16x16x32_bf16 v[56:59], a[44:47], a[8:11], v[56:59]
buffer_load_dwordx4 a[144:147], v5, s[4:7], s59 offen offset:512 sc1
v_fma_mix_f32 v219, v157, v203, v211 op_sel:[1,0,0] op_sel_hi:[1,0,0]
v_mfma_f32_16x16x32_bf16 v[60:63], a[8:11], a[48:51], v[60:63]
ds_write_b64 v7, v[226:227] offset:21512
v_mfma_f32_16x16x32_bf16 v[64:67], a[52:55], a[8:11], v[64:67]
v_cvt_pk_bf16_f32 v221, v218, v219
v_fma_mix_f32 v216, v158, v204, v212 op_sel:[0,0,0] op_sel_hi:[1,0,0]
v_mfma_f32_16x16x32_bf16 v[68:71], a[40:43], a[12:15], v[68:71]
v_fma_mix_f32 v217, v158, v205, v213 op_sel:[1,0,0] op_sel_hi:[1,0,0]
v_cvt_pk_bf16_f32 v222, v216, v217
v_mfma_f32_16x16x32_bf16 v[72:75], a[44:47], a[12:15], v[72:75]
buffer_load_dwordx4 a[148:151], v6, s[4:7], s59 offen offset:768 sc1
s_add_u32 s59, s59, 16384
v_mfma_f32_16x16x32_bf16 v[76:79], a[12:15], a[48:51], v[76:79]
ds_write_b64 v253, v[220:221] offset:22528
v_mfma_f32_16x16x32_bf16 v[80:83], a[52:55], a[12:15], v[80:83]
v_fma_mix_f32 v218, v159, v206, v214 op_sel:[0,0,0] op_sel_hi:[1,0,0]
v_fma_mix_f32 v219, v159, v207, v215 op_sel:[1,0,0] op_sel_hi:[1,0,0]
v_mfma_f32_16x16x32_bf16 v[84:87], a[40:43], a[16:19], v[84:87]
s_add_u32 m0, s49, 0
v_cvt_pk_bf16_f32 v223, v218, v219
v_fma_mix_f32 v216, v176, v200, v208 op_sel:[0,0,0] op_sel_hi:[1,0,0]
v_mfma_f32_16x16x32_bf16 v[88:91], a[44:47], a[16:19], v[88:91]
buffer_load_dwordx4 v232, s[24:27], s48 offen offset:0 lds
v_fma_mix_f32 v217, v176, v201, v209 op_sel:[1,0,0] op_sel_hi:[1,0,0]
v_mfma_f32_16x16x32_bf16 v[92:95], a[16:19], a[48:51], v[92:95]
ds_write_b64 v253, v[222:223] offset:22536
v_mfma_f32_16x16x32_bf16 v[96:99], a[52:55], a[16:19], v[96:99]
s_waitcnt vmcnt(24) lgkmcnt(4)
v_cvt_pk_bf16_f32 v224, v216, v217
v_fma_mix_f32 v218, v177, v202, v210 op_sel:[0,0,0] op_sel_hi:[1,0,0]
v_mfma_f32_16x16x32_bf16 v[20:23], a[56:59], a[20:23], v[20:23]
ds_read_b128 a[0:3], v4 offset:10240
v_fma_mix_f32 v219, v177, v203, v211 op_sel:[1,0,0] op_sel_hi:[1,0,0]
v_mfma_f32_16x16x32_bf16 v[24:27], a[60:63], a[20:23], v[24:27]
buffer_load_dwordx4 a[152:155], v5, s[4:7], s59 offen offset:0 sc1
v_cvt_pk_bf16_f32 v225, v218, v219
v_mfma_f32_16x16x32_bf16 v[28:31], a[20:23], a[64:67], v[28:31]
ds_read_b128 a[4:7], v4 offset:11264
v_fma_mix_f32 v216, v178, v204, v212 op_sel:[0,0,0] op_sel_hi:[1,0,0]
v_mfma_f32_16x16x32_bf16 v[32:35], a[68:71], a[20:23], v[32:35]
ds_read_b128 a[8:11], v4 offset:12288
v_fma_mix_f32 v217, v178, v205, v213 op_sel:[1,0,0] op_sel_hi:[1,0,0]
v_mfma_f32_16x16x32_bf16 v[36:39], a[56:59], a[24:27], v[36:39]
ds_read_b128 a[12:15], v4 offset:13312
v_cvt_pk_bf16_f32 v226, v216, v217
v_mfma_f32_16x16x32_bf16 v[40:43], a[60:63], a[24:27], v[40:43]
buffer_load_dwordx4 a[156:159], v5, s[4:7], s59 offen offset:256 sc1
v_fma_mix_f32 v218, v179, v206, v214 op_sel:[0,0,0] op_sel_hi:[1,0,0]
v_mfma_f32_16x16x32_bf16 v[44:47], a[24:27], a[64:67], v[44:47]
ds_read_b128 a[16:19], v4 offset:14336
v_fma_mix_f32 v219, v179, v207, v215 op_sel:[1,0,0] op_sel_hi:[1,0,0]
v_mfma_f32_16x16x32_bf16 v[48:51], a[68:71], a[24:27], v[48:51]
ds_write_b64 v254, v[224:225] offset:23552
v_mfma_f32_16x16x32_bf16 v[52:55], a[56:59], a[28:31], v[52:55]
v_cvt_pk_bf16_f32 v227, v218, v219
v_fma_mix_f32 v216, v196, v200, v208 op_sel:[0,0,0] op_sel_hi:[1,0,0]
v_mfma_f32_16x16x32_bf16 v[56:59], a[60:63], a[28:31], v[56:59]
buffer_load_dwordx4 a[160:163], v5, s[4:7], s59 offen offset:512 sc1
v_fma_mix_f32 v217, v196, v201, v209 op_sel:[1,0,0] op_sel_hi:[1,0,0]
v_mfma_f32_16x16x32_bf16 v[60:63], a[28:31], a[64:67], v[60:63]
ds_write_b64 v254, v[226:227] offset:23560
v_mfma_f32_16x16x32_bf16 v[64:67], a[68:71], a[28:31], v[64:67]
v_cvt_pk_bf16_f32 v220, v216, v217
v_fma_mix_f32 v218, v197, v202, v210 op_sel:[0,0,0] op_sel_hi:[1,0,0]
v_mfma_f32_16x16x32_bf16 v[68:71], a[56:59], a[32:35], v[68:71]
v_fma_mix_f32 v219, v197, v203, v211 op_sel:[1,0,0] op_sel_hi:[1,0,0]
v_cvt_pk_bf16_f32 v221, v218, v219
v_mfma_f32_16x16x32_bf16 v[72:75], a[60:63], a[32:35], v[72:75]
buffer_load_dwordx4 a[164:167], v6, s[4:7], s59 offen offset:768 sc1
s_add_u32 s59, s59, 16384
v_mfma_f32_16x16x32_bf16 v[76:79], a[32:35], a[64:67], v[76:79]
ds_write_b64 v254, v[220:221] offset:24576
v_mfma_f32_16x16x32_bf16 v[80:83], a[68:71], a[32:35], v[80:83]
v_fma_mix_f32 v216, v198, v204, v212 op_sel:[0,0,0] op_sel_hi:[1,0,0]
v_fma_mix_f32 v217, v198, v205, v213 op_sel:[1,0,0] op_sel_hi:[1,0,0]
v_mfma_f32_16x16x32_bf16 v[84:87], a[56:59], a[36:39], v[84:87]
v_cvt_pk_bf16_f32 v222, v216, v217
v_fma_mix_f32 v218, v199, v206, v214 op_sel:[0,0,0] op_sel_hi:[1,0,0]
v_mfma_f32_16x16x32_bf16 v[88:91], a[60:63], a[36:39], v[88:91]
buffer_load_dwordx4 v233, s[24:27], s48 offen offset:1024 lds
v_fma_mix_f32 v219, v199, v207, v215 op_sel:[1,0,0] op_sel_hi:[1,0,0]
v_mfma_f32_16x16x32_bf16 v[92:95], a[36:39], a[64:67], v[92:95]
v_cvt_pk_bf16_f32 v223, v218, v219
v_mov_b32 v180, 4048155338
v_mfma_f32_16x16x32_bf16 v[96:99], a[68:71], a[36:39], v[96:99]
s_waitcnt vmcnt(24) lgkmcnt(3)
v_lshlrev_b32 v181, 2, v3
v_sub_u32 v181, v2, v181
v_mfma_f32_16x16x32_bf16 v[20:23], a[72:75], a[0:3], v[20:23]
ds_read_b128 a[20:23], v251 offset:15360
v_subrev_u32 v182, 0, v181
v_mfma_f32_16x16x32_bf16 v[24:27], a[76:79], a[0:3], v[24:27]
buffer_load_dwordx4 v234, s[24:27], s48 offen offset:2048 lds
s_add_u32 s48, s48, 81920
v_mfma_f32_16x16x32_bf16 v[28:31], a[0:3], a[80:83], v[28:31]
ds_read_b128 a[24:27], v251 offset:16384
v_cmp_gt_u32 vcc, 8, v182
v_mfma_f32_16x16x32_bf16 v[32:35], a[84:87], a[0:3], v[32:35]
ds_read_b128 a[28:31], v251 offset:17408
v_cmp_gt_i32 s[62:63], -8, v182
v_mfma_f32_16x16x32_bf16 v[36:39], a[72:75], a[4:7], v[36:39]
ds_read_b128 a[32:35], v251 offset:18432
s_add_u32 m0, s49, 12288
v_mfma_f32_16x16x32_bf16 v[40:43], a[76:79], a[4:7], v[40:43]
buffer_load_dwordx4 v232, s[24:27], s48 offen offset:0 lds
v_mov_b32 v176, 0x3f803f80
v_mfma_f32_16x16x32_bf16 v[44:47], a[4:7], a[80:83], v[44:47]
ds_read_b128 a[36:39], v251 offset:19456
v_cndmask_b32 v164, v180, 0, vcc
v_mfma_f32_16x16x32_bf16 v[48:51], a[84:87], a[4:7], v[48:51]
ds_write_b64 v254, v[222:223] offset:24584
v_mfma_f32_16x16x32_bf16 v[52:55], a[72:75], a[8:11], v[52:55]
v_cndmask_b32 v168, v180, 0, s[62:63]
v_cndmask_b32 v184, 0, -1, s[62:63]
v_mfma_f32_16x16x32_bf16 v[56:59], a[76:79], a[8:11], v[56:59]
buffer_load_dwordx4 v233, s[24:27], s48 offen offset:1024 lds
v_subrev_u32 v182, 1, v181
v_mfma_f32_16x16x32_bf16 v[60:63], a[8:11], a[80:83], v[60:63]
v_cmp_gt_u32 vcc, 8, v182
v_cmp_gt_i32 s[62:63], -8, v182
v_mfma_f32_16x16x32_bf16 v[64:67], a[84:87], a[8:11], v[64:67]
v_mov_b32 v177, 0x3f803f80
v_cndmask_b32 v165, v180, 0, vcc
v_mfma_f32_16x16x32_bf16 v[68:71], a[72:75], a[12:15], v[68:71]
v_cndmask_b32 v169, v180, 0, s[62:63]
v_cndmask_b32 v185, 0, -1, s[62:63]
v_mfma_f32_16x16x32_bf16 v[72:75], a[76:79], a[12:15], v[72:75]
buffer_load_dwordx4 v234, s[24:27], s48 offen offset:2048 lds
s_add_u32 s48, s48, 81920
v_mfma_f32_16x16x32_bf16 v[76:79], a[12:15], a[80:83], v[76:79]
v_subrev_u32 v182, 2, v181
v_cmp_gt_u32 vcc, 8, v182
v_mfma_f32_16x16x32_bf16 v[80:83], a[84:87], a[12:15], v[80:83]
v_cmp_gt_i32 s[62:63], -8, v182
v_mov_b32 v178, 0x3f803f80
v_mfma_f32_16x16x32_bf16 v[84:87], a[72:75], a[16:19], v[84:87]
s_add_u32 m0, s49, 24576
v_cndmask_b32 v166, v180, 0, vcc
v_cndmask_b32 v170, v180, 0, s[62:63]
v_mfma_f32_16x16x32_bf16 v[88:91], a[76:79], a[16:19], v[88:91]
buffer_load_dwordx4 v232, s[24:27], s48 offen offset:0 lds
v_cndmask_b32 v186, 0, -1, s[62:63]
v_mfma_f32_16x16x32_bf16 v[92:95], a[16:19], a[80:83], v[92:95]
v_subrev_u32 v182, 3, v181
v_cmp_gt_u32 vcc, 8, v182
v_mfma_f32_16x16x32_bf16 v[96:99], a[84:87], a[16:19], v[96:99]
s_waitcnt vmcnt(21) lgkmcnt(0)
s_barrier
v_cmp_gt_i32 s[62:63], -8, v182
v_mfma_f32_16x16x32_bf16 v[20:23], a[88:91], a[20:23], v[20:23]
ds_read_b128 a[0:3], v4 offset:20480
v_mov_b32 v179, 0x3f803f80
v_mfma_f32_16x16x32_bf16 v[24:27], a[92:95], a[20:23], v[24:27]
buffer_load_dwordx4 v233, s[24:27], s48 offen offset:1024 lds
v_cndmask_b32 v167, v180, 0, vcc
v_mfma_f32_16x16x32_bf16 v[28:31], a[20:23], a[96:99], v[28:31]
ds_read_b128 a[4:7], v4 offset:21504
v_cndmask_b32 v171, v180, 0, s[62:63]
v_mfma_f32_16x16x32_bf16 v[32:35], a[100:103], a[20:23], v[32:35]
ds_read_b128 a[8:11], v4 offset:22528
v_cndmask_b32 v187, 0, -1, s[62:63]
v_mfma_f32_16x16x32_bf16 v[36:39], a[88:91], a[24:27], v[36:39]
ds_read_b128 a[12:15], v4 offset:23552
v_mov_b32 v182, 0xffff
v_mfma_f32_16x16x32_bf16 v[40:43], a[92:95], a[24:27], v[40:43]
buffer_load_dwordx4 v234, s[24:27], s48 offen offset:2048 lds
s_add_u32 s48, s48, 81920
v_mfma_f32_16x16x32_bf16 v[44:47], a[24:27], a[96:99], v[44:47]
ds_read_b128 a[16:19], v4 offset:24576
v_bfi_b32 v172, v182, v184, v185
v_mfma_f32_16x16x32_bf16 v[48:51], a[100:103], a[24:27], v[48:51]
v_bfi_b32 v173, v182, v186, v187
v_and_b32 v181, 1, v1
v_mfma_f32_16x16x32_bf16 v[52:55], a[88:91], a[28:31], v[52:55]
v_lshlrev_b32 v181, 4, v181
v_mov_b32 v182, 0x3f80
v_mfma_f32_16x16x32_bf16 v[56:59], a[92:95], a[28:31], v[56:59]
buffer_store_dwordx4 v[240:243], v246, s[4:7], s100 offen sc1
v_mfma_f32_16x16x32_bf16 v[60:63], a[28:31], a[96:99], v[60:63]
v_lshlrev_b32 v182, v181, v182
v_and_b32 v181, 0x32, v1
v_mfma_f32_16x16x32_bf16 v[64:67], a[100:103], a[28:31], v[64:67]
v_cmp_eq_u32 vcc, 0x30, v181
v_cmp_eq_u32 s[62:63], 50, v181
v_mfma_f32_16x16x32_bf16 v[68:71], a[88:91], a[32:35], v[68:71]
s_add_u32 m0, s49, 36864
v_mov_b32 v140, 0
v_cndmask_b32 v174, 0, v182, vcc
v_mfma_f32_16x16x32_bf16 v[72:75], a[92:95], a[32:35], v[72:75]
buffer_load_dwordx4 v232, s[24:27], s48 offen offset:0 lds
v_cndmask_b32 v175, 0, v182, s[62:63]
v_mfma_f32_16x16x32_bf16 v[76:79], a[32:35], a[96:99], v[76:79]
v_mov_b32 v141, 0
v_mov_b32 v152, 0
v_mfma_f32_16x16x32_bf16 v[80:83], a[100:103], a[32:35], v[80:83]
v_mov_b32 v153, 0
v_mov_b32 v122, 0
v_mfma_f32_16x16x32_bf16 v[84:87], a[88:91], a[36:39], v[84:87]
v_mov_b32 v123, 0
v_mov_b32 v126, 0
v_mfma_f32_16x16x32_bf16 v[88:91], a[92:95], a[36:39], v[88:91]
v_mov_b32 v127, 0
v_mov_b32 v130, 0
v_mfma_f32_16x16x32_bf16 v[92:95], a[36:39], a[96:99], v[92:95]
v_mov_b32 v131, 0
v_mov_b32 v134, 0
v_mfma_f32_16x16x32_bf16 v[96:99], a[100:103], a[36:39], v[96:99]
s_waitcnt vmcnt(23) lgkmcnt(0)
v_mov_b32 v135, 0
v_mov_b32 v138, 0
v_mfma_f32_16x16x32_bf16 v[20:23], a[104:107], a[0:3], v[20:23]
ds_read_b128 a[20:23], v251 offset:25600
v_mov_b32 v139, 0
v_mfma_f32_16x16x32_bf16 v[24:27], a[108:111], a[0:3], v[24:27]
buffer_load_dwordx4 v233, s[24:27], s48 offen offset:1024 lds
v_mul_u32_u24 v229, 176, v2
v_mfma_f32_16x16x32_bf16 v[28:31], a[0:3], a[112:115], v[28:31]
ds_read_b128 a[24:27], v251 offset:26624
v_add_u32 v229, s61, v229
v_mfma_f32_16x16x32_bf16 v[32:35], a[116:119], a[0:3], v[32:35]
ds_read_b128 a[28:31], v251 offset:27648
v_lshl_add_u32 v228, v3, 3, v229
v_mfma_f32_16x16x32_bf16 v[36:39], a[104:107], a[4:7], v[36:39]
ds_read_b128 a[32:35], v251 offset:28672
v_bfe_u32 v200, v1, 2, 2
v_mfma_f32_16x16x32_bf16 v[40:43], a[108:111], a[4:7], v[40:43]
buffer_load_dwordx4 v234, s[24:27], s48 offen offset:2048 lds
s_add_u32 s48, s48, 81920
v_mfma_f32_16x16x32_bf16 v[44:47], a[4:7], a[112:115], v[44:47]
ds_read_b128 a[36:39], v251 offset:29696
v_lshl_add_u32 v200, v3, 3, v200
v_mfma_f32_16x16x32_bf16 v[48:51], a[116:119], a[4:7], v[48:51]
v_mul_u32_u24 v200, 192, v200
v_and_b32 v201, 3, v1
v_mfma_f32_16x16x32_bf16 v[52:55], a[104:107], a[8:11], v[52:55]
s_add_u32 m0, s49, 49152
v_lshl_add_u32 v200, v201, 3, v200
v_and_b32 v201, 1, v3
v_mfma_f32_16x16x32_bf16 v[56:59], a[108:111], a[8:11], v[56:59]
buffer_load_dwordx4 v232, s[24:27], s48 offen offset:0 lds
v_lshl_add_u32 v7, v201, 5, v200
v_mfma_f32_16x16x32_bf16 v[60:63], a[8:11], a[112:115], v[60:63]
v_xor_b32 v201, 1, v201
v_lshl_add_u32 v10, v201, 5, v200
v_mfma_f32_16x16x32_bf16 v[64:67], a[116:119], a[8:11], v[64:67]
v_add_u32 v253, 61440, v7
v_add_u32 v254, 61440, v10
v_mfma_f32_16x16x32_bf16 v[68:71], a[104:107], a[12:15], v[68:71]
v_lshlrev_b32 v252, 4, v1
v_lshl_add_u32 v247, v3, 4, s12
v_mfma_f32_16x16x32_bf16 v[72:75], a[108:111], a[12:15], v[72:75]
buffer_load_dwordx4 v233, s[24:27], s48 offen offset:1024 lds
v_mul_u32_u24 v200, 192, v2
v_mfma_f32_16x16x32_bf16 v[76:79], a[12:15], a[112:115], v[76:79]
v_lshl_add_u32 v200, v3, 3, v200
v_add_u32 v230, s13, v200
v_mfma_f32_16x16x32_bf16 v[80:83], a[116:119], a[12:15], v[80:83]
v_add_u32 v231, s13, v252
v_lshlrev_b32 v0, 2, v1
v_mfma_f32_16x16x32_bf16 v[84:87], a[104:107], a[16:19], v[84:87]
v_add_u32 v198, s12, v252
v_min_u32 v197, 13, v1
v_mfma_f32_16x16x32_bf16 v[88:91], a[108:111], a[16:19], v[88:91]
buffer_load_dwordx4 v234, s[24:27], s48 offen offset:2048 lds
s_add_u32 s48, s48, 81920
v_mfma_f32_16x16x32_bf16 v[92:95], a[16:19], a[112:115], v[92:95]
v_lshlrev_b32 v197, 7, v197
v_mfma_f32_16x16x32_bf16 v[96:99], a[116:119], a[16:19], v[96:99]
s_waitcnt vmcnt(24) lgkmcnt(0)
v_mfma_f32_16x16x32_bf16 v[20:23], a[120:123], a[20:23], v[20:23]
ds_read_b128 a[0:3], v4 offset:30720
s_add_u32 m0, s49, 61440
v_mfma_f32_16x16x32_bf16 v[24:27], a[124:127], a[20:23], v[24:27]
buffer_load_dwordx4 v232, s[24:27], s48 offen offset:0 lds
v_mfma_f32_16x16x32_bf16 v[28:31], a[20:23], a[128:131], v[28:31]
ds_read_b128 a[4:7], v4 offset:31744
v_mfma_f32_16x16x32_bf16 v[32:35], a[132:135], a[20:23], v[32:35]
ds_read_b128 a[8:11], v4 offset:32768
v_mfma_f32_16x16x32_bf16 v[36:39], a[120:123], a[24:27], v[36:39]
ds_read_b128 a[12:15], v4 offset:33792
v_mfma_f32_16x16x32_bf16 v[40:43], a[124:127], a[24:27], v[40:43]
buffer_load_dwordx4 v233, s[24:27], s48 offen offset:1024 lds
v_mfma_f32_16x16x32_bf16 v[44:47], a[24:27], a[128:131], v[44:47]
ds_read_b128 a[16:19], v4 offset:34816
v_mfma_f32_16x16x32_bf16 v[48:51], a[132:135], a[24:27], v[48:51]
v_mfma_f32_16x16x32_bf16 v[52:55], a[120:123], a[28:31], v[52:55]
v_mfma_f32_16x16x32_bf16 v[56:59], a[124:127], a[28:31], v[56:59]
buffer_load_dwordx4 v234, s[24:27], s48 offen offset:2048 lds
s_add_u32 s48, s48, 81920
v_mfma_f32_16x16x32_bf16 v[60:63], a[28:31], a[128:131], v[60:63]
v_mfma_f32_16x16x32_bf16 v[64:67], a[132:135], a[28:31], v[64:67]
v_mfma_f32_16x16x32_bf16 v[68:71], a[120:123], a[32:35], v[68:71]
s_add_u32 m0, s49, 73728
v_mfma_f32_16x16x32_bf16 v[72:75], a[124:127], a[32:35], v[72:75]
buffer_load_dwordx4 v232, s[24:27], s48 offen offset:0 lds
v_mfma_f32_16x16x32_bf16 v[76:79], a[32:35], a[128:131], v[76:79]
v_mfma_f32_16x16x32_bf16 v[80:83], a[132:135], a[32:35], v[80:83]
v_mfma_f32_16x16x32_bf16 v[84:87], a[120:123], a[36:39], v[84:87]
v_mfma_f32_16x16x32_bf16 v[88:91], a[124:127], a[36:39], v[88:91]
buffer_load_dwordx4 v233, s[24:27], s48 offen offset:1024 lds
v_mfma_f32_16x16x32_bf16 v[92:95], a[36:39], a[128:131], v[92:95]
v_mfma_f32_16x16x32_bf16 v[96:99], a[132:135], a[36:39], v[96:99]
s_waitcnt vmcnt(25) lgkmcnt(0)
v_mfma_f32_16x16x32_bf16 v[20:23], a[136:139], a[0:3], v[20:23]
ds_read_b128 a[20:23], v251 offset:35840
v_mfma_f32_16x16x32_bf16 v[24:27], a[140:143], a[0:3], v[24:27]
buffer_load_dwordx4 v234, s[24:27], s48 offen offset:2048 lds
s_add_u32 s48, s48, 81920
v_mfma_f32_16x16x32_bf16 v[28:31], a[0:3], a[144:147], v[28:31]
ds_read_b128 a[24:27], v251 offset:36864
v_mfma_f32_16x16x32_bf16 v[32:35], a[148:151], a[0:3], v[32:35]
ds_read_b128 a[28:31], v251 offset:37888
v_mfma_f32_16x16x32_bf16 v[36:39], a[136:139], a[4:7], v[36:39]
ds_read_b128 a[32:35], v251 offset:38912
s_add_u32 m0, s49, 86016
v_mfma_f32_16x16x32_bf16 v[40:43], a[140:143], a[4:7], v[40:43]
buffer_load_dwordx4 v232, s[24:27], s48 offen offset:0 lds
v_mfma_f32_16x16x32_bf16 v[44:47], a[4:7], a[144:147], v[44:47]
ds_read_b128 a[36:39], v251 offset:39936
v_mfma_f32_16x16x32_bf16 v[48:51], a[148:151], a[4:7], v[48:51]
v_mfma_f32_16x16x32_bf16 v[52:55], a[136:139], a[8:11], v[52:55]
v_mfma_f32_16x16x32_bf16 v[56:59], a[140:143], a[8:11], v[56:59]
buffer_load_dwordx4 v233, s[24:27], s48 offen offset:1024 lds
v_mfma_f32_16x16x32_bf16 v[60:63], a[8:11], a[144:147], v[60:63]
v_mfma_f32_16x16x32_bf16 v[64:67], a[148:151], a[8:11], v[64:67]
v_mfma_f32_16x16x32_bf16 v[68:71], a[136:139], a[12:15], v[68:71]
v_mfma_f32_16x16x32_bf16 v[72:75], a[140:143], a[12:15], v[72:75]
buffer_load_dwordx4 v234, s[24:27], s48 offen offset:2048 lds
s_add_u32 s48, s48, 81920
v_mfma_f32_16x16x32_bf16 v[76:79], a[12:15], a[144:147], v[76:79]
v_mfma_f32_16x16x32_bf16 v[80:83], a[148:151], a[12:15], v[80:83]
v_mfma_f32_16x16x32_bf16 v[84:87], a[136:139], a[16:19], v[84:87]
s_add_u32 m0, s49, 98304
v_mfma_f32_16x16x32_bf16 v[88:91], a[140:143], a[16:19], v[88:91]
buffer_load_dwordx4 v232, s[24:27], s48 offen offset:0 lds
v_mfma_f32_16x16x32_bf16 v[92:95], a[16:19], a[144:147], v[92:95]
v_mfma_f32_16x16x32_bf16 v[96:99], a[148:151], a[16:19], v[96:99]
s_waitcnt vmcnt(25) lgkmcnt(0)
s_barrier
s_mov_b32 s62, 1051011932
s_mov_b32 s63, 1051011932
v_mfma_f32_16x16x32_bf16 v[32:35], a[164:167], a[20:23], v[32:35]
buffer_load_dwordx4 v233, s[24:27], s48 offen offset:1024 lds
v_mfma_f32_16x16x32_bf16 v[48:51], a[164:167], a[24:27], v[48:51]
v_mfma_f32_16x16x32_bf16 v[64:67], a[164:167], a[28:31], v[64:67]
v_mfma_f32_16x16x32_bf16 v[80:83], a[164:167], a[32:35], v[80:83]
v_mfma_f32_16x16x32_bf16 v[24:27], a[156:159], a[20:23], v[24:27]
buffer_load_dwordx4 v234, s[24:27], s48 offen offset:2048 lds
s_add_u32 s48, s48, 81920
v_mfma_f32_16x16x32_bf16 v[36:39], a[152:155], a[24:27], v[36:39]
v_mfma_f32_16x16x32_bf16 v[40:43], a[156:159], a[24:27], v[40:43]
v_cvt_pk_bf16_f32 v102, v32, v33
s_add_u32 m0, s49, 110592
v_mfma_f32_16x16x32_bf16 v[52:55], a[152:155], a[28:31], v[52:55]
buffer_load_dwordx4 v232, s[24:27], s48 offen offset:0 lds
v_cvt_pk_bf16_f32 v103, v34, v35
v_cvt_pk_bf16_f32 v106, v48, v49
v_mfma_f32_16x16x32_bf16 v[56:59], a[156:159], a[28:31], v[56:59]
v_cvt_pk_bf16_f32 v107, v50, v51
v_cvt_pk_bf16_f32 v110, v64, v65
v_mfma_f32_16x16x32_bf16 v[68:71], a[152:155], a[32:35], v[68:71]
buffer_load_dwordx4 v233, s[24:27], s48 offen offset:1024 lds
v_cvt_pk_bf16_f32 v111, v66, v67
v_cvt_pk_bf16_f32 v114, v80, v81
v_mfma_f32_16x16x32_bf16 v[72:75], a[156:159], a[32:35], v[72:75]
v_cvt_pk_bf16_f32 v115, v82, v83
v_permlane32_swap_b32 v122, v102
v_mfma_f32_16x16x32_bf16 v[20:23], a[152:155], a[20:23], v[20:23]
buffer_load_dwordx4 v234, s[24:27], s48 offen offset:2048 lds
s_add_u32 s48, s48, 81920
v_permlane32_swap_b32 v123, v103
v_permlane32_swap_b32 v126, v106
v_permlane32_swap_b32 v127, v107
v_permlane32_swap_b32 v130, v110
v_permlane32_swap_b32 v131, v111
v_permlane32_swap_b32 v134, v114
v_permlane32_swap_b32 v135, v115
v_cvt_pk_bf16_f32 v100, v24, v25
v_cvt_pk_bf16_f32 v101, v26, v27
s_add_u32 m0, s49, 122880
v_cvt_pk_bf16_f32 v104, v40, v41
buffer_load_dwordx4 v235, s[8:11], s50 offen offset:0 lds
v_cvt_pk_bf16_f32 v105, v42, v43
v_cvt_pk_bf16_f32 v124, v36, v37
v_cvt_pk_bf16_f32 v125, v38, v39
v_cvt_pk_bf16_f32 v108, v56, v57
v_cvt_pk_bf16_f32 v109, v58, v59
v_cvt_pk_bf16_f32 v128, v52, v53
v_cvt_pk_bf16_f32 v129, v54, v55
v_cvt_pk_bf16_f32 v112, v72, v73
v_cvt_pk_bf16_f32 v113, v74, v75
v_cvt_pk_bf16_f32 v132, v68, v69
v_cvt_pk_bf16_f32 v133, v70, v71
v_cvt_pk_bf16_f32 v120, v20, v21
v_cvt_pk_bf16_f32 v121, v22, v23
v_mfma_f32_16x16x32_bf16 v[40:43], v[104:107], v[124:127], v[164:167]
buffer_load_dwordx4 v236, s[8:11], s50 offen offset:1024 lds
v_mfma_f32_16x16x32_bf16 v[36:39], v[100:103], v[124:127], v[168:171]
v_mfma_f32_16x16x32_bf16 v[56:59], v[108:111], v[128:131], v[164:167]
v_mfma_f32_16x16x32_bf16 v[52:55], v[104:107], v[128:131], v[168:171]
v_mfma_f32_16x16x32_bf16 v[72:75], v[112:115], v[132:135], v[164:167]
v_mfma_f32_16x16x32_bf16 v[68:71], v[108:111], v[132:135], v[168:171]
v_mfma_f32_16x16x32_bf16 v[24:27], v[100:103], v[120:123], v[164:167]
s_nop 2
v_max_f32 v40, v40, v36
v_max_f32 v41, v41, v37
v_max_f32 v42, v42, v38
v_max_f32 v56, v56, v52
v_max_f32 v57, v57, v53
v_max_f32 v58, v58, v54
v_max_f32 v72, v72, v68
v_max_f32 v73, v73, v69
v_max_f32 v74, v74, v70
v_max3_f32 v180, v24, v25, v26
v_max_f32 v43, v43, v39
v_max3_f32 v181, v40, v41, v42
v_max_f32 v59, v59, v55
v_max3_f32 v182, v56, v57, v58
buffer_load_dwordx4 v237, s[8:11], s50 offen offset:2048 lds
v_max_f32 v75, v75, v71
v_max3_f32 v183, v72, v73, v74
v_max_f32 v180, v180, v27
v_max_f32 v181, v181, v43
v_max_f32 v182, v182, v59
v_max_f32 v183, v183, v75
v_mfma_f32_16x16x32_bf16 v[96:99], a[164:167], a[36:39], v[96:99]
v_permlane32_swap_b32 v180, v182
v_permlane32_swap_b32 v181, v183
v_max_f32 v180, v180, v182
v_max_f32 v181, v181, v183
v_mfma_f32_16x16x32_bf16 v[84:87], a[152:155], a[36:39], v[84:87]
s_nop 0
v_permlane16_swap_b32 v180, v181
v_max_f32 v181, v180, v181
v_mul_f32 v180, s62, v181
v_mul_f32 v182, s62, v181
v_mfma_f32_16x16x32_bf16 v[88:91], a[156:159], a[36:39], v[88:91]
buffer_load_dwordx2 v[194:195], v248, s[4:7], s23 offen sc1
v_permlane32_swap_b32 v180, v182
v_mfma_f32_16x16x32_bf16 v[28:31], a[20:23], a[160:163], v[28:31]
v_mov_b32 v181, v180
v_cvt_pk_bf16_f32 v118, v96, v97
v_mfma_f32_16x16x16_bf16 v[32:35], v[102:103], v[174:175], 0
v_cvt_pk_bf16_f32 v119, v98, v99
v_permlane16_swap_b32 v180, v181
v_mfma_f32_16x16x32_bf16 v[44:47], a[24:27], a[160:163], v[44:47]
v_permlane32_swap_b32 v138, v118
v_permlane32_swap_b32 v139, v119
v_cvt_pk_bf16_f32 v116, v88, v89
v_pk_fma_f32 v[24:25], v[24:25], s[62:63], v[180:181] op_sel:[0,0,0] op_sel_hi:[1,0,0] neg_lo:[0,0,1] neg_hi:[0,0,1]
v_pk_fma_f32 v[26:27], v[26:27], s[62:63], v[180:181] op_sel:[0,0,0] op_sel_hi:[1,0,0] neg_lo:[0,0,1] neg_hi:[0,0,1]
v_cvt_pk_bf16_f32 v117, v90, v91
v_cvt_pk_bf16_f32 v136, v84, v85
v_cvt_pk_bf16_f32 v137, v86, v87
v_exp_f32 v24, v24
v_exp_f32 v25, v25
v_exp_f32 v26, v26
v_exp_f32 v27, v27
buffer_load_dwordx4 v[240:243], v238, s[4:7], s51 offen sc1
v_cvt_pk_bf16_f32 v143, v30, v31
v_mfma_f32_16x16x16_bf16 v[48:51], v[106:107], v[174:175], 0
v_cvt_pk_bf16_f32 v30, v24, v25
v_cvt_pk_bf16_f32 v31, v26, v27
v_mfma_f32_16x16x32_bf16 v[88:91], v[116:119], v[136:139], v[164:167]
v_cvt_pk_bf16_f32 v154, v32, v33
v_cvt_pk_bf16_f32 v155, v34, v35
v_mfma_f32_16x16x32_bf16 v[84:87], v[112:115], v[136:139], v[168:171]
v_cvt_pk_bf16_f32 v142, v28, v29
v_cvt_pk_bf16_f32 v145, v46, v47
v_mfma_f32_16x16x32_bf16 v[60:63], a[28:31], a[160:163], v[60:63]
v_mov_b32 v183, v182
v_cvt_pk_bf16_f32 v144, v44, v45
v_mfma_f32_16x16x16_bf16 v[32:35], v[176:177], v[30:31], 0
buffer_load_dwordx4 v[190:193], v238, s[4:7], s22 offen sc1
v_permlane16_swap_b32 v182, v183
v_mfma_f32_16x16x16_bf16 v[20:23], v[142:143], v[30:31], 0
v_cvt_pk_bf16_f32 v156, v48, v49
v_cvt_pk_bf16_f32 v157, v50, v51
v_mfma_f32_16x16x16_bf16 v[64:67], v[110:111], v[174:175], 0
v_max_f32 v88, v88, v84
v_max_f32 v89, v89, v85
v_max_f32 v90, v90, v86
v_mfma_f32_16x16x16_bf16 v[24:27], v[154:155], v[30:31], 0
v_max_f32 v91, v91, v87
v_max3_f32 v184, v88, v89, v90
v_mfma_f32_16x16x32_bf16 v[76:79], a[32:35], a[160:163], v[76:79]
v_max_f32 v184, v184, v91
v_cvt_pk_bf16_f32 v147, v62, v63
v_mov_b32 v185, v184
v_rcp_f32 v32, v32
v_pk_fma_f32 v[40:41], v[40:41], s[62:63], v[180:181] op_sel:[0,0,1] op_sel_hi:[1,0,1] neg_lo:[0,0,1] neg_hi:[0,0,1]
v_pk_fma_f32 v[42:43], v[42:43], s[62:63], v[180:181] op_sel:[0,0,1] op_sel_hi:[1,0,1] neg_lo:[0,0,1] neg_hi:[0,0,1]
v_exp_f32 v40, v40
v_exp_f32 v41, v41
buffer_load_dwordx2 v[244:245], v239, s[28:31], s52 offen
v_exp_f32 v42, v42
v_exp_f32 v43, v43
v_cvt_pk_bf16_f32 v46, v40, v41
v_cvt_pk_bf16_f32 v47, v42, v43
v_and_b32 v44, v172, v46
v_and_b32 v45, v173, v47
v_xor_b32 v46, v44, v46
v_xor_b32 v47, v45, v47
v_pk_fma_f32 v[56:57], v[56:57], s[62:63], v[182:183] op_sel:[0,0,0] op_sel_hi:[1,0,0] neg_lo:[0,0,1] neg_hi:[0,0,1]
v_pk_fma_f32 v[58:59], v[58:59], s[62:63], v[182:183] op_sel:[0,0,0] op_sel_hi:[1,0,0] neg_lo:[0,0,1] neg_hi:[0,0,1]
v_mfma_f32_16x16x32_bf16 v[48:51], v[176:179], v[44:47], 0
v_exp_f32 v56, v56
v_exp_f32 v57, v57
v_exp_f32 v58, v58
v_exp_f32 v59, v59
v_cvt_pk_bf16_f32 v146, v60, v61
v_mfma_f32_16x16x32_bf16 v[36:39], v[142:145], v[44:47], 0
buffer_load_dword v196, v197, s[4:7], s14 offen sc1
v_cvt_pk_bf16_f32 v62, v56, v57
v_cvt_pk_bf16_f32 v63, v58, v59
v_and_b32 v60, v172, v62
v_and_b32 v61, v173, v63
v_mfma_f32_16x16x16_bf16 v[80:83], v[114:115], v[174:175], 0
v_permlane32_swap_b32 v184, v185
v_xor_b32 v62, v60, v62
v_xor_b32 v63, v61, v63
v_cvt_pk_bf16_f32 v158, v64, v65
v_pk_mul_f32 v[20:21], v[20:21], v[32:33] op_sel_hi:[1,0]
v_pk_mul_f32 v[22:23], v[22:23], v[32:33] op_sel_hi:[1,0]
v_cvt_pk_bf16_f32 v20, v20, v21
v_cvt_pk_bf16_f32 v159, v66, v67
v_max_f32 v184, v184, v185
v_cvt_pk_bf16_f32 v21, v22, v23
v_mfma_f32_16x16x32_bf16 v[40:43], v[154:157], v[44:47], 0
ds_write_b64 v228, v[20:21] offset:0
v_mfma_f32_16x16x32_bf16 v[92:95], a[36:39], a[160:163], v[92:95]
v_mov_b32 v185, v184
v_cvt_pk_bf16_f32 v149, v78, v79
v_mfma_f32_16x16x32_bf16 v[64:67], v[176:179], v[60:63], 0
v_rcp_f32 v48, v48
v_cvt_pk_bf16_f32 v148, v76, v77
v_permlane16_swap_b32 v184, v185
v_pk_fma_f32 v[72:73], v[72:73], s[62:63], v[182:183] op_sel:[0,0,1] op_sel_hi:[1,0,1] neg_lo:[0,0,1] neg_hi:[0,0,1]
v_pk_fma_f32 v[74:75], v[74:75], s[62:63], v[182:183] op_sel:[0,0,1] op_sel_hi:[1,0,1] neg_lo:[0,0,1] neg_hi:[0,0,1]
v_exp_f32 v72, v72
v_exp_f32 v73, v73
v_exp_f32 v74, v74
v_exp_f32 v75, v75
v_pk_mul_f32 v[24:25], v[24:25], v[32:33] op_sel_hi:[1,0]
v_pk_mul_f32 v[26:27], v[26:27], v[32:33] op_sel_hi:[1,0]
v_cvt_pk_bf16_f32 v24, v24, v25
v_cvt_pk_bf16_f32 v25, v26, v27
v_mfma_f32_16x16x32_bf16 v[52:55], v[144:147], v[60:63], 0
ds_write_b64 v229, v[24:25] offset:32
v_cvt_pk_bf16_f32 v78, v72, v73
v_cvt_pk_bf16_f32 v79, v74, v75
v_and_b32 v76, v172, v78
v_and_b32 v77, v173, v79
v_mfma_f32_16x16x16_bf16 v[96:99], v[118:119], v[174:175], 0
v_max_f32 v184, v184, v185
v_xor_b32 v78, v76, v78
v_xor_b32 v79, v77, v79
v_mul_f32 v184, s62, v184
v_cvt_pk_bf16_f32 v160, v80, v81
v_pk_mul_f32 v[36:37], v[36:37], v[48:49] op_sel_hi:[1,0]
v_pk_mul_f32 v[38:39], v[38:39], v[48:49] op_sel_hi:[1,0]
v_cvt_pk_bf16_f32 v36, v36, v37
v_cvt_pk_bf16_f32 v161, v82, v83
v_cvt_pk_bf16_f32 v37, v38, v39
v_mfma_f32_16x16x32_bf16 v[56:59], v[156:159], v[60:63], 0
ds_write_b64 v228, v[36:37] offset:2816
v_mfma_f32_16x16x32_bf16 v[80:83], v[176:179], v[76:79], 0
v_cvt_pk_bf16_f32 v151, v94, v95
v_rcp_f32 v64, v64
v_cvt_pk_bf16_f32 v150, v92, v93
v_mfma_f32_16x16x32_bf16 v[68:71], v[146:149], v[76:79], 0
v_cvt_pk_bf16_f32 v162, v96, v97
v_cvt_pk_bf16_f32 v163, v98, v99
v_mfma_f32_16x16x32_bf16 v[72:75], v[158:161], v[76:79], 0
s_nop 0
v_rcp_f32 v80, v80
v_pk_fma_f32 v[88:89], v[88:89], s[62:63], v[184:185] op_sel:[0,0,0] op_sel_hi:[1,0,0] neg_lo:[0,0,1] neg_hi:[0,0,1]
v_pk_fma_f32 v[90:91], v[90:91], s[62:63], v[184:185] op_sel:[0,0,0] op_sel_hi:[1,0,0] neg_lo:[0,0,1] neg_hi:[0,0,1]
v_exp_f32 v88, v88
v_exp_f32 v89, v89
v_exp_f32 v90, v90
v_exp_f32 v91, v91
v_pk_mul_f32 v[40:41], v[40:41], v[48:49] op_sel_hi:[1,0]
v_pk_mul_f32 v[42:43], v[42:43], v[48:49] op_sel_hi:[1,0]
v_cvt_pk_bf16_f32 v40, v40, v41
v_cvt_pk_bf16_f32 v41, v42, v43
v_cvt_pk_bf16_f32 v94, v88, v89
v_cvt_pk_bf16_f32 v95, v90, v91
ds_write_b64 v229, v[40:41] offset:2848
v_and_b32 v92, v172, v94
v_and_b32 v93, v173, v95
v_pk_mul_f32 v[52:53], v[52:53], v[64:65] op_sel_hi:[1,0]
v_xor_b32 v94, v92, v94
v_xor_b32 v95, v93, v95
v_pk_mul_f32 v[54:55], v[54:55], v[64:65] op_sel_hi:[1,0]
v_cvt_pk_bf16_f32 v52, v52, v53
v_cvt_pk_bf16_f32 v53, v54, v55
ds_write_b64 v228, v[52:53] offset:5632
v_mfma_f32_16x16x32_bf16 v[96:99], v[176:179], v[92:95], 0
v_mfma_f32_16x16x32_bf16 v[84:87], v[148:151], v[92:95], 0
v_mfma_f32_16x16x32_bf16 v[88:91], v[160:163], v[92:95], 0
v_pk_mul_f32 v[56:57], v[56:57], v[64:65] op_sel_hi:[1,0]
v_pk_mul_f32 v[58:59], v[58:59], v[64:65] op_sel_hi:[1,0]
v_cvt_pk_bf16_f32 v56, v56, v57
v_cvt_pk_bf16_f32 v57, v58, v59
ds_write_b64 v229, v[56:57] offset:5664
v_pk_mul_f32 v[68:69], v[68:69], v[80:81] op_sel_hi:[1,0]
v_pk_mul_f32 v[70:71], v[70:71], v[80:81] op_sel_hi:[1,0]
v_cvt_pk_bf16_f32 v68, v68, v69
v_cvt_pk_bf16_f32 v69, v70, v71
ds_write_b64 v228, v[68:69] offset:8448
v_pk_mul_f32 v[72:73], v[72:73], v[80:81] op_sel_hi:[1,0]
v_pk_mul_f32 v[74:75], v[74:75], v[80:81] op_sel_hi:[1,0]
v_cvt_pk_bf16_f32 v72, v72, v73
v_rcp_f32 v96, v96
v_cvt_pk_bf16_f32 v73, v74, v75
ds_write_b64 v229, v[72:73] offset:8480
v_pk_mul_f32 v[84:85], v[84:85], v[96:97] op_sel_hi:[1,0]
v_pk_mul_f32 v[86:87], v[86:87], v[96:97] op_sel_hi:[1,0]
v_cvt_pk_bf16_f32 v84, v84, v85
v_cvt_pk_bf16_f32 v85, v86, v87
ds_write_b64 v228, v[84:85] offset:11264
v_pk_mul_f32 v[88:89], v[88:89], v[96:97] op_sel_hi:[1,0]
v_pk_mul_f32 v[90:91], v[90:91], v[96:97] op_sel_hi:[1,0]
v_cvt_pk_bf16_f32 v88, v88, v89
v_cvt_pk_bf16_f32 v89, v90, v91
ds_write_b64 v229, v[88:89] offset:11296
s_waitcnt lgkmcnt(0)
s_barrier
ds_read_b128 v[20:23], v15
ds_read_b128 v[24:27], v16
ds_read_b128 v[28:31], v17
ds_read_b128 v[32:35], v18
s_mul_i32 s56, s53, 20480
s_add_u32 s56, s56, 4194304
s_add_u32 s57, s56, 4096
s_add_u32 s58, s56, 8192
s_add_u32 s59, s56, 12288
s_add_u32 s60, s56, 16384
s_mov_b32 s55, 0x05040100
s_waitcnt lgkmcnt(3)
buffer_store_dwordx4 v[20:23], v11, s[4:7], s46 offen sc1
s_waitcnt lgkmcnt(2)
buffer_store_dwordx4 v[24:27], v12, s[4:7], s46 offen sc1
s_waitcnt lgkmcnt(1)
buffer_store_dwordx4 v[28:31], v13, s[4:7], s46 offen sc1
s_waitcnt lgkmcnt(0)
buffer_store_dwordx4 v[32:35], v14, s[4:7], s46 offen sc1
s_waitcnt vmcnt(4)
s_barrier
ds_read_b64 v[20:21], v230 offset:0
ds_read_b64 v[22:23], v230 offset:32
ds_read_b64 v[24:25], v230 offset:64
ds_read_b64 v[26:27], v230 offset:96
ds_read_b64 v[28:29], v230 offset:128
ds_read_b64 v[30:31], v230 offset:160
v_perm_b32 v36, v241, v240, s55
v_perm_b32 v37, v243, v242, s55
v_xor_b32 v36, s40, v36
v_xor_b32 v37, s40, v37
v_or_b32 v38, v36, v37
v_perm_b32 v36, v191, v190, s55
v_perm_b32 v37, v193, v192, s55
v_xor_b32 v36, s40, v36
v_xor_b32 v37, s40, v37
v_or3_b32 v38, v38, v36, v37
v_and_b32 v38, v38, v250
v_xor_b32 v37, s40, v194
v_or_b32 v38, v38, v37
v_cmp_ne_u32 vcc, 0, v38
s_cbranch_vccnz L_mv_retry
L_mv_ok:
v_cmp_ne_u32 vcc, s19, v195
v_and_b32 v240, 0xffff0000, v240
v_and_b32 v241, 0xffff0000, v241
v_and_b32 v242, 0xffff0000, v242
v_and_b32 v243, 0xffff0000, v243
v_and_b32 v190, 0xffff0000, v190
v_and_b32 v191, 0xffff0000, v191
v_and_b32 v192, 0xffff0000, v192
v_and_b32 v193, 0xffff0000, v193
s_lshr_b32 s15, vcc_lo, 16
v_lshlrev_b32 v40, 16, v244
v_and_b32 v41, 0xffff0000, v244
v_lshlrev_b32 v42, 16, v245
v_and_b32 v43, 0xffff0000, v245
v_pk_mul_f32 v[40:41], v[40:41], v[190:191]
v_pk_mul_f32 v[42:43], v[42:43], v[192:193]
s_mov_b32 exec_hi, 0xffff
ds_write_b128 v198, v[240:243]
ds_write_b128 v198, v[190:193] offset:768
ds_write_b128 v198, v[40:43] offset:1536
s_mov_b32 exec_hi, -1
s_waitcnt lgkmcnt(3)
v_lshlrev_b32 v68, 16, v20
v_and_b32 v69, 0xffff0000, v20
v_lshlrev_b32 v70, 16, v21
v_and_b32 v71, 0xffff0000, v21
v_lshlrev_b32 v72, 16, v22
v_and_b32 v73, 0xffff0000, v22
v_lshlrev_b32 v74, 16, v23
v_and_b32 v75, 0xffff0000, v23
v_lshlrev_b32 v76, 16, v24
v_and_b32 v77, 0xffff0000, v24
v_lshlrev_b32 v78, 16, v25
v_and_b32 v79, 0xffff0000, v25
v_lshlrev_b32 v80, 16, v26
v_and_b32 v81, 0xffff0000, v26
v_lshlrev_b32 v82, 16, v27
v_and_b32 v83, 0xffff0000, v27
v_lshlrev_b32 v84, 16, v28
v_and_b32 v85, 0xffff0000, v28
v_lshlrev_b32 v86, 16, v29
v_and_b32 v87, 0xffff0000, v29
v_lshlrev_b32 v88, 16, v30
v_and_b32 v89, 0xffff0000, v30
v_lshlrev_b32 v90, 16, v31
v_and_b32 v91, 0xffff0000, v31
ds_read_b128 v[204:207], v247 offset:1536
ds_read_b128 v[208:211], v247 offset:1600
ds_read_b128 v[212:215], v247 offset:1664
ds_read_b128 v[216:219], v247 offset:1728
ds_read_b128 v[220:223], v247 offset:1792
ds_read_b128 v[224:227], v247 offset:1856
ds_read_b128 v[180:183], v247 offset:0
ds_read_b128 v[184:187], v247 offset:64
ds_read_b128 v[188:191], v247 offset:128
ds_read_b128 v[192:195], v247 offset:192
ds_read_b128 v[196:199], v247 offset:256
ds_read_b128 v[200:203], v247 offset:320
ds_read_b64_tr_b16 a[0:1], v7 offset:0
ds_read_b64_tr_b16 a[2:3], v7 offset:768
ds_read_b64_tr_b16 a[4:5], v10 offset:0
ds_read_b64_tr_b16 a[6:7], v10 offset:768
ds_read_b64_tr_b16 a[8:9], v7 offset:64
ds_read_b64_tr_b16 a[10:11], v7 offset:832
ds_read_b64_tr_b16 a[12:13], v7 offset:6144
ds_read_b64_tr_b16 a[14:15], v7 offset:6912
ds_read_b64_tr_b16 a[16:17], v10 offset:6144
ds_read_b64_tr_b16 a[18:19], v10 offset:6912
ds_read_b64_tr_b16 a[20:21], v7 offset:6208
ds_read_b64_tr_b16 a[22:23], v7 offset:6976
ds_read_b64_tr_b16 a[24:25], v7 offset:12288
ds_read_b64_tr_b16 a[26:27], v7 offset:13056
ds_read_b64_tr_b16 a[28:29], v10 offset:12288
ds_read_b64_tr_b16 a[30:31], v10 offset:13056
ds_read_b64_tr_b16 a[32:33], v7 offset:12352
ds_read_b64_tr_b16 a[34:35], v7 offset:13120
ds_read_b64_tr_b16 a[36:37], v7 offset:18432
ds_read_b64_tr_b16 a[38:39], v7 offset:19200
ds_read_b64_tr_b16 a[40:41], v10 offset:18432
ds_read_b64_tr_b16 a[42:43], v10 offset:19200
ds_read_b64_tr_b16 a[44:45], v7 offset:18496
ds_read_b64_tr_b16 a[46:47], v7 offset:19264
ds_read_b64_tr_b16 a[48:49], v7 offset:24576
ds_read_b64_tr_b16 a[50:51], v7 offset:25344
ds_read_b64_tr_b16 a[52:53], v10 offset:24576
ds_read_b64_tr_b16 a[54:55], v10 offset:25344
ds_read_b64_tr_b16 a[56:57], v7 offset:24640
ds_read_b64_tr_b16 a[58:59], v7 offset:25408
ds_read_b64_tr_b16 a[60:61], v7 offset:30720
ds_read_b64_tr_b16 a[62:63], v7 offset:31488
ds_read_b64_tr_b16 a[64:65], v10 offset:30720
ds_read_b64_tr_b16 a[66:67], v10 offset:31488
ds_read_b64_tr_b16 a[68:69], v7 offset:30784
ds_read_b64_tr_b16 a[70:71], v7 offset:31552
ds_read_b64_tr_b16 a[72:73], v7 offset:36864
ds_read_b64_tr_b16 a[74:75], v7 offset:37632
buffer_load_dwordx4 v[100:103], v252, s[4:7], s56 offen offset:0 sc1
ds_read_b64_tr_b16 a[76:77], v10 offset:36864
ds_read_b64_tr_b16 a[78:79], v10 offset:37632
ds_read_b64_tr_b16 a[80:81], v7 offset:36928
ds_read_b64_tr_b16 a[82:83], v7 offset:37696
ds_read_b64_tr_b16 a[84:85], v7 offset:43008
ds_read_b64_tr_b16 a[86:87], v7 offset:43776
buffer_load_dwordx4 v[104:107], v252, s[4:7], s56 offen offset:1024 sc1
ds_read_b64_tr_b16 a[88:89], v10 offset:43008
ds_read_b64_tr_b16 a[90:91], v10 offset:43776
ds_read_b64_tr_b16 a[92:93], v7 offset:43072
ds_read_b64_tr_b16 a[94:95], v7 offset:43840
ds_read_b64_tr_b16 a[96:97], v7 offset:49152
ds_read_b64_tr_b16 a[98:99], v7 offset:49920
buffer_load_dwordx4 v[108:111], v252, s[4:7], s56 offen offset:2048 sc1
ds_read_b64_tr_b16 a[100:101], v10 offset:49152
ds_read_b64_tr_b16 a[102:103], v10 offset:49920
ds_read_b64_tr_b16 a[104:105], v7 offset:49216
ds_read_b64_tr_b16 a[106:107], v7 offset:49984
ds_read_b64_tr_b16 a[108:109], v7 offset:55296
ds_read_b64_tr_b16 a[110:111], v7 offset:56064
buffer_load_dwordx4 v[112:115], v252, s[4:7], s56 offen offset:3072 sc1
ds_read_b64_tr_b16 a[112:113], v10 offset:55296
ds_read_b64_tr_b16 a[114:115], v10 offset:56064
ds_read_b64_tr_b16 a[116:117], v7 offset:55360
ds_read_b64_tr_b16 a[118:119], v7 offset:56128
ds_read_b64_tr_b16 a[120:121], v253 offset:0
ds_read_b64_tr_b16 a[122:123], v253 offset:768
buffer_load_dwordx4 v[116:119], v252, s[4:7], s57 offen offset:0 sc1
ds_read_b64_tr_b16 a[124:125], v254 offset:0
ds_read_b64_tr_b16 a[126:127], v254 offset:768
ds_read_b64_tr_b16 a[128:129], v253 offset:64
ds_read_b64_tr_b16 a[130:131], v253 offset:832
ds_read_b64_tr_b16 a[132:133], v253 offset:6144
ds_read_b64_tr_b16 a[134:135], v253 offset:6912
buffer_load_dwordx4 v[120:123], v252, s[4:7], s57 offen offset:1024 sc1
ds_read_b64_tr_b16 a[136:137], v254 offset:6144
ds_read_b64_tr_b16 a[138:139], v254 offset:6912
ds_read_b64_tr_b16 a[140:141], v253 offset:6208
ds_read_b64_tr_b16 a[142:143], v253 offset:6976
ds_read_b64_tr_b16 a[144:145], v253 offset:12288
ds_read_b64_tr_b16 a[146:147], v253 offset:13056
buffer_load_dwordx4 v[124:127], v252, s[4:7], s57 offen offset:2048 sc1
ds_read_b64_tr_b16 a[148:149], v254 offset:12288
ds_read_b64_tr_b16 a[150:151], v254 offset:13056
ds_read_b64_tr_b16 a[152:153], v253 offset:12352
ds_read_b64_tr_b16 a[154:155], v253 offset:13120
ds_read_b64_tr_b16 a[156:157], v253 offset:18432
ds_read_b64_tr_b16 a[158:159], v253 offset:19200
buffer_load_dwordx4 v[128:131], v252, s[4:7], s57 offen offset:3072 sc1
ds_read_b64_tr_b16 a[160:161], v254 offset:18432
ds_read_b64_tr_b16 a[162:163], v254 offset:19200
ds_read_b64_tr_b16 a[164:165], v253 offset:18496
ds_read_b64_tr_b16 a[166:167], v253 offset:19264
ds_read_b64_tr_b16 a[168:169], v253 offset:24576
ds_read_b64_tr_b16 a[170:171], v253 offset:25344
buffer_load_dwordx4 v[132:135], v252, s[4:7], s58 offen offset:0 sc1
ds_read_b64_tr_b16 a[172:173], v254 offset:24576
ds_read_b64_tr_b16 a[174:175], v254 offset:25344
ds_read_b64_tr_b16 a[176:177], v253 offset:24640
ds_read_b64_tr_b16 a[178:179], v253 offset:25408
ds_read_b64_tr_b16 a[180:181], v253 offset:30720
ds_read_b64_tr_b16 a[182:183], v253 offset:31488
buffer_load_dwordx4 v[136:139], v252, s[4:7], s58 offen offset:1024 sc1
ds_read_b64_tr_b16 a[184:185], v254 offset:30720
ds_read_b64_tr_b16 a[186:187], v254 offset:31488
ds_read_b64_tr_b16 a[188:189], v253 offset:30784
ds_read_b64_tr_b16 a[190:191], v253 offset:31552
ds_read_b64_tr_b16 a[192:193], v253 offset:36864
ds_read_b64_tr_b16 a[194:195], v253 offset:37632
buffer_load_dwordx4 v[140:143], v252, s[4:7], s58 offen offset:2048 sc1
ds_read_b64_tr_b16 a[196:197], v254 offset:36864
ds_read_b64_tr_b16 a[198:199], v254 offset:37632
ds_read_b64_tr_b16 a[200:201], v253 offset:36928
ds_read_b64_tr_b16 a[202:203], v253 offset:37696
ds_read_b64_tr_b16 a[204:205], v253 offset:43008
ds_read_b64_tr_b16 a[206:207], v253 offset:43776
buffer_load_dwordx4 v[144:147], v252, s[4:7], s58 offen offset:3072 sc1
ds_read_b64_tr_b16 a[208:209], v254 offset:43008
ds_read_b64_tr_b16 a[210:211], v254 offset:43776
ds_read_b64_tr_b16 a[212:213], v253 offset:43072
ds_read_b64_tr_b16 a[214:215], v253 offset:43840
ds_read_b64_tr_b16 a[216:217], v253 offset:49152
ds_read_b64_tr_b16 a[218:219], v253 offset:49920
ds_read_b64_tr_b16 a[220:221], v254 offset:49152
ds_read_b64_tr_b16 a[222:223], v254 offset:49920
ds_read_b64_tr_b16 a[224:225], v253 offset:49216
ds_read_b64_tr_b16 a[226:227], v253 offset:49984
ds_read_b64_tr_b16 a[228:229], v253 offset:55296
ds_read_b64_tr_b16 a[230:231], v253 offset:56064
ds_read_b64_tr_b16 a[232:233], v254 offset:55296
ds_read_b64_tr_b16 a[234:235], v254 offset:56064
ds_read_b64_tr_b16 a[236:237], v253 offset:55360
ds_read_b64_tr_b16 a[238:239], v253 offset:56128
ds_read_b64_tr_b16 v[44:45], v10 offset:64
ds_read_b64_tr_b16 v[46:47], v10 offset:832
ds_read_b64_tr_b16 v[48:49], v7 offset:128
ds_read_b64_tr_b16 v[50:51], v7 offset:896
ds_read_b64_tr_b16 v[52:53], v10 offset:128
ds_read_b64_tr_b16 v[54:55], v10 offset:896
s_waitcnt lgkmcnt(15)
v_pk_add_f32 v[94:95], v[204:205], v[206:207]
v_pk_add_f32 v[94:95], v[94:95], v[208:209]
v_pk_add_f32 v[94:95], v[94:95], v[210:211]
v_pk_add_f32 v[94:95], v[94:95], v[212:213]
v_pk_add_f32 v[94:95], v[94:95], v[214:215]
v_pk_add_f32 v[94:95], v[94:95], v[216:217]
v_pk_add_f32 v[94:95], v[94:95], v[218:219]
v_pk_add_f32 v[94:95], v[94:95], v[220:221]
v_pk_add_f32 v[94:95], v[94:95], v[222:223]
v_pk_add_f32 v[94:95], v[94:95], v[224:225]
v_pk_add_f32 v[94:95], v[94:95], v[226:227]
v_add_f32 v95, v94, v95
s_waitcnt vmcnt(10) lgkmcnt(6)
v_max3_u32 v92, v100, v101, v102
v_max3_u32 v93, v103, v104, v105
v_max3_u32 v92, v92, v106, v107
v_max_u32 v92, v92, v93
v_cmp_eq_u32 vcc, -1, v92
s_cbranch_vccnz L_o0_retry
L_o0_ok:
v_mfma_f32_16x16x32_bf16 v[20:23], a[0:3], v[100:103], 0
ds_read_b64_tr_b16 v[56:57], v10 offset:6208
buffer_load_dwordx4 v[148:151], v252, s[4:7], s59 offen offset:0 sc1
v_mfma_f32_16x16x32_bf16 v[24:27], a[4:7], v[100:103], 0
ds_read_b64_tr_b16 v[58:59], v10 offset:6976
buffer_load_dwordx4 v[152:155], v252, s[4:7], s59 offen offset:1024 sc1
v_mfma_f32_16x16x32_bf16 v[28:31], a[8:11], v[100:103], 0
ds_read_b64_tr_b16 v[60:61], v7 offset:6272
s_waitcnt lgkmcnt(3)
v_mfma_f32_16x16x32_bf16 v[32:35], v[44:47], v[100:103], 0
ds_read_b64_tr_b16 v[62:63], v7 offset:7040
s_waitcnt vmcnt(10)
v_mfma_f32_16x16x32_bf16 v[36:39], v[48:51], v[100:103], 0
ds_read_b64_tr_b16 v[64:65], v10 offset:6272
v_max3_u32 v92, v108, v109, v110
v_mfma_f32_16x16x32_bf16 v[40:43], v[52:55], v[100:103], 0
ds_read_b64_tr_b16 v[66:67], v10 offset:7040
v_max3_u32 v93, v111, v112, v113
v_mfma_f32_16x16x32_bf16 v[20:23], a[12:15], v[104:107], v[20:23]
ds_read_b64_tr_b16 v[44:45], v10 offset:12352
v_max3_u32 v92, v92, v114, v115
v_mfma_f32_16x16x32_bf16 v[24:27], a[16:19], v[104:107], v[24:27]
ds_read_b64_tr_b16 v[46:47], v10 offset:13120
v_max_u32 v92, v92, v93
v_mfma_f32_16x16x32_bf16 v[28:31], a[20:23], v[104:107], v[28:31]
ds_read_b64_tr_b16 v[48:49], v7 offset:12416
s_waitcnt lgkmcnt(3)
v_mfma_f32_16x16x32_bf16 v[32:35], v[56:59], v[104:107], v[32:35]
ds_read_b64_tr_b16 v[50:51], v7 offset:13184
v_cmp_eq_u32 vcc, -1, v92
v_mfma_f32_16x16x32_bf16 v[36:39], v[60:63], v[104:107], v[36:39]
ds_read_b64_tr_b16 v[52:53], v10 offset:12416
v_mfma_f32_16x16x32_bf16 v[40:43], v[64:67], v[104:107], v[40:43]
ds_read_b64_tr_b16 v[54:55], v10 offset:13184
s_cbranch_vccnz L_o1_retry
L_o1_ok:
v_mfma_f32_16x16x32_bf16 v[20:23], a[24:27], v[108:111], v[20:23]
ds_read_b64_tr_b16 v[56:57], v10 offset:18496
buffer_load_dwordx4 v[156:159], v252, s[4:7], s59 offen offset:2048 sc1
v_mfma_f32_16x16x32_bf16 v[24:27], a[28:31], v[108:111], v[24:27]
ds_read_b64_tr_b16 v[58:59], v10 offset:19264
buffer_load_dwordx4 v[160:163], v252, s[4:7], s59 offen offset:3072 sc1
v_mfma_f32_16x16x32_bf16 v[28:31], a[32:35], v[108:111], v[28:31]
ds_read_b64_tr_b16 v[60:61], v7 offset:18560
s_waitcnt lgkmcnt(3)
v_mfma_f32_16x16x32_bf16 v[32:35], v[44:47], v[108:111], v[32:35]
ds_read_b64_tr_b16 v[62:63], v7 offset:19328
s_waitcnt vmcnt(10)
v_mfma_f32_16x16x32_bf16 v[36:39], v[48:51], v[108:111], v[36:39]
ds_read_b64_tr_b16 v[64:65], v10 offset:18560
v_max3_u32 v92, v116, v117, v118
v_mfma_f32_16x16x32_bf16 v[40:43], v[52:55], v[108:111], v[40:43]
ds_read_b64_tr_b16 v[66:67], v10 offset:19328
v_max3_u32 v93, v119, v120, v121
v_mfma_f32_16x16x32_bf16 v[20:23], a[36:39], v[112:115], v[20:23]
ds_read_b64_tr_b16 v[44:45], v10 offset:24640
v_max3_u32 v92, v92, v122, v123
v_mfma_f32_16x16x32_bf16 v[24:27], a[40:43], v[112:115], v[24:27]
ds_read_b64_tr_b16 v[46:47], v10 offset:25408
v_max_u32 v92, v92, v93
v_mfma_f32_16x16x32_bf16 v[28:31], a[44:47], v[112:115], v[28:31]
ds_read_b64_tr_b16 v[48:49], v7 offset:24704
s_waitcnt lgkmcnt(3)
v_mfma_f32_16x16x32_bf16 v[32:35], v[56:59], v[112:115], v[32:35]
ds_read_b64_tr_b16 v[50:51], v7 offset:25472
v_cmp_eq_u32 vcc, -1, v92
v_mfma_f32_16x16x32_bf16 v[36:39], v[60:63], v[112:115], v[36:39]
ds_read_b64_tr_b16 v[52:53], v10 offset:24704
v_mfma_f32_16x16x32_bf16 v[40:43], v[64:67], v[112:115], v[40:43]
ds_read_b64_tr_b16 v[54:55], v10 offset:25472
s_cbranch_vccnz L_o2_retry
L_o2_ok:
v_mfma_f32_16x16x32_bf16 v[20:23], a[48:51], v[116:119], v[20:23]
ds_read_b64_tr_b16 v[56:57], v10 offset:30784
buffer_load_dwordx4 v[164:167], v252, s[4:7], s60 offen offset:0 sc1
v_mfma_f32_16x16x32_bf16 v[24:27], a[52:55], v[116:119], v[24:27]
ds_read_b64_tr_b16 v[58:59], v10 offset:31552
buffer_load_dwordx4 v[168:171], v252, s[4:7], s60 offen offset:1024 sc1
v_mfma_f32_16x16x32_bf16 v[28:31], a[56:59], v[116:119], v[28:31]
ds_read_b64_tr_b16 v[60:61], v7 offset:30848
s_waitcnt lgkmcnt(3)
v_mfma_f32_16x16x32_bf16 v[32:35], v[44:47], v[116:119], v[32:35]
ds_read_b64_tr_b16 v[62:63], v7 offset:31616
s_waitcnt vmcnt(10)
v_mfma_f32_16x16x32_bf16 v[36:39], v[48:51], v[116:119], v[36:39]
ds_read_b64_tr_b16 v[64:65], v10 offset:30848
v_max3_u32 v92, v124, v125, v126
v_mfma_f32_16x16x32_bf16 v[40:43], v[52:55], v[116:119], v[40:43]
ds_read_b64_tr_b16 v[66:67], v10 offset:31616
v_max3_u32 v93, v127, v128, v129
v_mfma_f32_16x16x32_bf16 v[20:23], a[60:63], v[120:123], v[20:23]
ds_read_b64_tr_b16 v[44:45], v10 offset:36928
v_max3_u32 v92, v92, v130, v131
v_mfma_f32_16x16x32_bf16 v[24:27], a[64:67], v[120:123], v[24:27]
ds_read_b64_tr_b16 v[46:47], v10 offset:37696
v_max_u32 v92, v92, v93
v_mfma_f32_16x16x32_bf16 v[28:31], a[68:71], v[120:123], v[28:31]
ds_read_b64_tr_b16 v[48:49], v7 offset:36992
s_waitcnt lgkmcnt(3)
v_mfma_f32_16x16x32_bf16 v[32:35], v[56:59], v[120:123], v[32:35]
ds_read_b64_tr_b16 v[50:51], v7 offset:37760
v_cmp_eq_u32 vcc, -1, v92
v_mfma_f32_16x16x32_bf16 v[36:39], v[60:63], v[120:123], v[36:39]
ds_read_b64_tr_b16 v[52:53], v10 offset:36992
v_mfma_f32_16x16x32_bf16 v[40:43], v[64:67], v[120:123], v[40:43]
ds_read_b64_tr_b16 v[54:55], v10 offset:37760
s_cbranch_vccnz L_o3_retry
L_o3_ok:
v_mfma_f32_16x16x32_bf16 v[20:23], a[72:75], v[124:127], v[20:23]
ds_read_b64_tr_b16 v[56:57], v10 offset:43072
buffer_load_dwordx4 v[172:175], v252, s[4:7], s60 offen offset:2048 sc1
v_mfma_f32_16x16x32_bf16 v[24:27], a[76:79], v[124:127], v[24:27]
ds_read_b64_tr_b16 v[58:59], v10 offset:43840
buffer_load_dwordx4 v[176:179], v252, s[4:7], s60 offen offset:3072 sc1
v_mfma_f32_16x16x32_bf16 v[28:31], a[80:83], v[124:127], v[28:31]
ds_read_b64_tr_b16 v[60:61], v7 offset:43136
s_waitcnt lgkmcnt(3)
v_mfma_f32_16x16x32_bf16 v[32:35], v[44:47], v[124:127], v[32:35]
ds_read_b64_tr_b16 v[62:63], v7 offset:43904
s_waitcnt vmcnt(10)
v_mfma_f32_16x16x32_bf16 v[36:39], v[48:51], v[124:127], v[36:39]
ds_read_b64_tr_b16 v[64:65], v10 offset:43136
v_max3_u32 v92, v132, v133, v134
v_mfma_f32_16x16x32_bf16 v[40:43], v[52:55], v[124:127], v[40:43]
ds_read_b64_tr_b16 v[66:67], v10 offset:43904
v_max3_u32 v93, v135, v136, v137
v_mfma_f32_16x16x32_bf16 v[20:23], a[84:87], v[128:131], v[20:23]
ds_read_b64_tr_b16 v[44:45], v10 offset:49216
v_max3_u32 v92, v92, v138, v139
v_mfma_f32_16x16x32_bf16 v[24:27], a[88:91], v[128:131], v[24:27]
ds_read_b64_tr_b16 v[46:47], v10 offset:49984
v_max_u32 v92, v92, v93
v_mfma_f32_16x16x32_bf16 v[28:31], a[92:95], v[128:131], v[28:31]
ds_read_b64_tr_b16 v[48:49], v7 offset:49280
s_waitcnt lgkmcnt(3)
v_mfma_f32_16x16x32_bf16 v[32:35], v[56:59], v[128:131], v[32:35]
ds_read_b64_tr_b16 v[50:51], v7 offset:50048
v_cmp_eq_u32 vcc, -1, v92
v_mfma_f32_16x16x32_bf16 v[36:39], v[60:63], v[128:131], v[36:39]
ds_read_b64_tr_b16 v[52:53], v10 offset:49280
v_mfma_f32_16x16x32_bf16 v[40:43], v[64:67], v[128:131], v[40:43]
ds_read_b64_tr_b16 v[54:55], v10 offset:50048
s_cbranch_vccnz L_o4_retry
L_o4_ok:
v_mfma_f32_16x16x32_bf16 v[20:23], a[96:99], v[132:135], v[20:23]
ds_read_b64_tr_b16 v[56:57], v10 offset:55360
v_mfma_f32_16x16x32_bf16 v[24:27], a[100:103], v[132:135], v[24:27]
ds_read_b64_tr_b16 v[58:59], v10 offset:56128
v_mfma_f32_16x16x32_bf16 v[28:31], a[104:107], v[132:135], v[28:31]
ds_read_b64_tr_b16 v[60:61], v7 offset:55424
s_waitcnt lgkmcnt(3)
v_mfma_f32_16x16x32_bf16 v[32:35], v[44:47], v[132:135], v[32:35]
ds_read_b64_tr_b16 v[62:63], v7 offset:56192
s_waitcnt vmcnt(8)
v_mfma_f32_16x16x32_bf16 v[36:39], v[48:51], v[132:135], v[36:39]
ds_read_b64_tr_b16 v[64:65], v10 offset:55424
v_max3_u32 v92, v140, v141, v142
v_mfma_f32_16x16x32_bf16 v[40:43], v[52:55], v[132:135], v[40:43]
ds_read_b64_tr_b16 v[66:67], v10 offset:56192
v_max3_u32 v93, v143, v144, v145
v_mfma_f32_16x16x32_bf16 v[20:23], a[108:111], v[136:139], v[20:23]
ds_read_b64_tr_b16 v[44:45], v254 offset:64
v_max3_u32 v92, v92, v146, v147
v_mfma_f32_16x16x32_bf16 v[24:27], a[112:115], v[136:139], v[24:27]
ds_read_b64_tr_b16 v[46:47], v254 offset:832
v_max_u32 v92, v92, v93
v_mfma_f32_16x16x32_bf16 v[28:31], a[116:119], v[136:139], v[28:31]
ds_read_b64_tr_b16 v[48:49], v253 offset:128
s_waitcnt lgkmcnt(3)
v_mfma_f32_16x16x32_bf16 v[32:35], v[56:59], v[136:139], v[32:35]
ds_read_b64_tr_b16 v[50:51], v253 offset:896
v_cmp_eq_u32 vcc, -1, v92
v_mfma_f32_16x16x32_bf16 v[36:39], v[60:63], v[136:139], v[36:39]
ds_read_b64_tr_b16 v[52:53], v254 offset:128
v_mfma_f32_16x16x32_bf16 v[40:43], v[64:67], v[136:139], v[40:43]
ds_read_b64_tr_b16 v[54:55], v254 offset:896
s_cbranch_vccnz L_o5_retry
L_o5_ok:
v_mfma_f32_16x16x32_bf16 v[20:23], a[120:123], v[140:143], v[20:23]
ds_read_b64_tr_b16 v[56:57], v254 offset:6208
v_mfma_f32_16x16x32_bf16 v[24:27], a[124:127], v[140:143], v[24:27]
ds_read_b64_tr_b16 v[58:59], v254 offset:6976
v_mfma_f32_16x16x32_bf16 v[28:31], a[128:131], v[140:143], v[28:31]
ds_read_b64_tr_b16 v[60:61], v253 offset:6272
s_waitcnt lgkmcnt(3)
v_mfma_f32_16x16x32_bf16 v[32:35], v[44:47], v[140:143], v[32:35]
ds_read_b64_tr_b16 v[62:63], v253 offset:7040
s_waitcnt vmcnt(6)
v_mfma_f32_16x16x32_bf16 v[36:39], v[48:51], v[140:143], v[36:39]
ds_read_b64_tr_b16 v[64:65], v254 offset:6272
v_max3_u32 v92, v148, v149, v150
v_mfma_f32_16x16x32_bf16 v[40:43], v[52:55], v[140:143], v[40:43]
ds_read_b64_tr_b16 v[66:67], v254 offset:7040
v_max3_u32 v93, v151, v152, v153
v_mfma_f32_16x16x32_bf16 v[20:23], a[132:135], v[144:147], v[20:23]
ds_read_b64_tr_b16 v[44:45], v254 offset:12352
v_max3_u32 v92, v92, v154, v155
v_mfma_f32_16x16x32_bf16 v[24:27], a[136:139], v[144:147], v[24:27]
ds_read_b64_tr_b16 v[46:47], v254 offset:13120
v_max_u32 v92, v92, v93
v_mfma_f32_16x16x32_bf16 v[28:31], a[140:143], v[144:147], v[28:31]
ds_read_b64_tr_b16 v[48:49], v253 offset:12416
s_waitcnt lgkmcnt(3)
v_mfma_f32_16x16x32_bf16 v[32:35], v[56:59], v[144:147], v[32:35]
ds_read_b64_tr_b16 v[50:51], v253 offset:13184
v_cmp_eq_u32 vcc, -1, v92
v_mfma_f32_16x16x32_bf16 v[36:39], v[60:63], v[144:147], v[36:39]
ds_read_b64_tr_b16 v[52:53], v254 offset:12416
v_mfma_f32_16x16x32_bf16 v[40:43], v[64:67], v[144:147], v[40:43]
ds_read_b64_tr_b16 v[54:55], v254 offset:13184
s_cbranch_vccnz L_o6_retry
L_o6_ok:
v_mfma_f32_16x16x32_bf16 v[20:23], a[144:147], v[148:151], v[20:23]
ds_read_b64_tr_b16 v[56:57], v254 offset:18496
v_mfma_f32_16x16x32_bf16 v[24:27], a[148:151], v[148:151], v[24:27]
ds_read_b64_tr_b16 v[58:59], v254 offset:19264
v_mfma_f32_16x16x32_bf16 v[28:31], a[152:155], v[148:151], v[28:31]
ds_read_b64_tr_b16 v[60:61], v253 offset:18560
s_waitcnt lgkmcnt(3)
v_mfma_f32_16x16x32_bf16 v[32:35], v[44:47], v[148:151], v[32:35]
ds_read_b64_tr_b16 v[62:63], v253 offset:19328
s_waitcnt vmcnt(4)
v_mfma_f32_16x16x32_bf16 v[36:39], v[48:51], v[148:151], v[36:39]
ds_read_b64_tr_b16 v[64:65], v254 offset:18560
v_max3_u32 v92, v156, v157, v158
v_mfma_f32_16x16x32_bf16 v[40:43], v[52:55], v[148:151], v[40:43]
ds_read_b64_tr_b16 v[66:67], v254 offset:19328
v_max3_u32 v93, v159, v160, v161
v_mfma_f32_16x16x32_bf16 v[20:23], a[156:159], v[152:155], v[20:23]
ds_read_b64_tr_b16 v[44:45], v254 offset:24640
v_max3_u32 v92, v92, v162, v163
v_mfma_f32_16x16x32_bf16 v[24:27], a[160:163], v[152:155], v[24:27]
ds_read_b64_tr_b16 v[46:47], v254 offset:25408
v_max_u32 v92, v92, v93
v_mfma_f32_16x16x32_bf16 v[28:31], a[164:167], v[152:155], v[28:31]
ds_read_b64_tr_b16 v[48:49], v253 offset:24704
s_waitcnt lgkmcnt(3)
v_mfma_f32_16x16x32_bf16 v[32:35], v[56:59], v[152:155], v[32:35]
ds_read_b64_tr_b16 v[50:51], v253 offset:25472
v_cmp_eq_u32 vcc, -1, v92
v_mfma_f32_16x16x32_bf16 v[36:39], v[60:63], v[152:155], v[36:39]
ds_read_b64_tr_b16 v[52:53], v254 offset:24704
v_mfma_f32_16x16x32_bf16 v[40:43], v[64:67], v[152:155], v[40:43]
ds_read_b64_tr_b16 v[54:55], v254 offset:25472
s_cbranch_vccnz L_o7_retry
L_o7_ok:
v_mfma_f32_16x16x32_bf16 v[20:23], a[168:171], v[156:159], v[20:23]
ds_read_b64_tr_b16 v[56:57], v254 offset:30784
v_mfma_f32_16x16x32_bf16 v[24:27], a[172:175], v[156:159], v[24:27]
ds_read_b64_tr_b16 v[58:59], v254 offset:31552
v_mfma_f32_16x16x32_bf16 v[28:31], a[176:179], v[156:159], v[28:31]
ds_read_b64_tr_b16 v[60:61], v253 offset:30848
s_waitcnt lgkmcnt(3)
v_mfma_f32_16x16x32_bf16 v[32:35], v[44:47], v[156:159], v[32:35]
ds_read_b64_tr_b16 v[62:63], v253 offset:31616
s_waitcnt vmcnt(2)
v_mfma_f32_16x16x32_bf16 v[36:39], v[48:51], v[156:159], v[36:39]
ds_read_b64_tr_b16 v[64:65], v254 offset:30848
v_max3_u32 v92, v164, v165, v166
v_mfma_f32_16x16x32_bf16 v[40:43], v[52:55], v[156:159], v[40:43]
ds_read_b64_tr_b16 v[66:67], v254 offset:31616
v_max3_u32 v93, v167, v168, v169
v_mfma_f32_16x16x32_bf16 v[20:23], a[180:183], v[160:163], v[20:23]
ds_read_b64_tr_b16 v[44:45], v254 offset:36928
v_max3_u32 v92, v92, v170, v171
v_mfma_f32_16x16x32_bf16 v[24:27], a[184:187], v[160:163], v[24:27]
ds_read_b64_tr_b16 v[46:47], v254 offset:37696
v_max_u32 v92, v92, v93
v_mfma_f32_16x16x32_bf16 v[28:31], a[188:191], v[160:163], v[28:31]
ds_read_b64_tr_b16 v[48:49], v253 offset:36992
s_waitcnt lgkmcnt(3)
v_mfma_f32_16x16x32_bf16 v[32:35], v[56:59], v[160:163], v[32:35]
ds_read_b64_tr_b16 v[50:51], v253 offset:37760
v_cmp_eq_u32 vcc, -1, v92
v_mfma_f32_16x16x32_bf16 v[36:39], v[60:63], v[160:163], v[36:39]
ds_read_b64_tr_b16 v[52:53], v254 offset:36992
v_mfma_f32_16x16x32_bf16 v[40:43], v[64:67], v[160:163], v[40:43]
ds_read_b64_tr_b16 v[54:55], v254 offset:37760
s_cbranch_vccnz L_o8_retry
L_o8_ok:
v_mfma_f32_16x16x32_bf16 v[20:23], a[192:195], v[164:167], v[20:23]
ds_read_b64_tr_b16 v[56:57], v254 offset:43072
v_mfma_f32_16x16x32_bf16 v[24:27], a[196:199], v[164:167], v[24:27]
ds_read_b64_tr_b16 v[58:59], v254 offset:43840
v_mfma_f32_16x16x32_bf16 v[28:31], a[200:203], v[164:167], v[28:31]
ds_read_b64_tr_b16 v[60:61], v253 offset:43136
s_waitcnt lgkmcnt(3)
v_mfma_f32_16x16x32_bf16 v[32:35], v[44:47], v[164:167], v[32:35]
ds_read_b64_tr_b16 v[62:63], v253 offset:43904
s_waitcnt vmcnt(0)
v_mfma_f32_16x16x32_bf16 v[36:39], v[48:51], v[164:167], v[36:39]
ds_read_b64_tr_b16 v[64:65], v254 offset:43136
v_max3_u32 v92, v172, v173, v174
v_mfma_f32_16x16x32_bf16 v[40:43], v[52:55], v[164:167], v[40:43]
ds_read_b64_tr_b16 v[66:67], v254 offset:43904
v_max3_u32 v93, v175, v176, v177
v_mfma_f32_16x16x32_bf16 v[20:23], a[204:207], v[168:171], v[20:23]
ds_read_b64_tr_b16 v[44:45], v254 offset:49216
v_max3_u32 v92, v92, v178, v179
v_mfma_f32_16x16x32_bf16 v[24:27], a[208:211], v[168:171], v[24:27]
ds_read_b64_tr_b16 v[46:47], v254 offset:49984
v_max_u32 v92, v92, v93
v_mfma_f32_16x16x32_bf16 v[28:31], a[212:215], v[168:171], v[28:31]
ds_read_b64_tr_b16 v[48:49], v253 offset:49280
s_waitcnt lgkmcnt(3)
v_mfma_f32_16x16x32_bf16 v[32:35], v[56:59], v[168:171], v[32:35]
ds_read_b64_tr_b16 v[50:51], v253 offset:50048
v_cmp_eq_u32 vcc, -1, v92
v_mfma_f32_16x16x32_bf16 v[36:39], v[60:63], v[168:171], v[36:39]
ds_read_b64_tr_b16 v[52:53], v254 offset:49280
v_mfma_f32_16x16x32_bf16 v[40:43], v[64:67], v[168:171], v[40:43]
ds_read_b64_tr_b16 v[54:55], v254 offset:50048
s_cbranch_vccnz L_o9_retry
L_o9_ok:
v_mfma_f32_16x16x32_bf16 v[20:23], a[216:219], v[172:175], v[20:23]
ds_read_b64_tr_b16 v[56:57], v254 offset:55360
v_mfma_f32_16x16x32_bf16 v[24:27], a[220:223], v[172:175], v[24:27]
ds_read_b64_tr_b16 v[58:59], v254 offset:56128
v_mfma_f32_16x16x32_bf16 v[28:31], a[224:227], v[172:175], v[28:31]
ds_read_b64_tr_b16 v[60:61], v253 offset:55424
s_waitcnt lgkmcnt(3)
v_mfma_f32_16x16x32_bf16 v[32:35], v[44:47], v[172:175], v[32:35]
ds_read_b64_tr_b16 v[62:63], v253 offset:56192
v_mfma_f32_16x16x32_bf16 v[36:39], v[48:51], v[172:175], v[36:39]
ds_read_b64_tr_b16 v[64:65], v254 offset:55424
v_mfma_f32_16x16x32_bf16 v[40:43], v[52:55], v[172:175], v[40:43]
ds_read_b64_tr_b16 v[66:67], v254 offset:56192
v_mfma_f32_16x16x32_bf16 v[20:23], a[228:231], v[176:179], v[20:23]
v_mfma_f32_16x16x32_bf16 v[24:27], a[232:235], v[176:179], v[24:27]
v_mfma_f32_16x16x32_bf16 v[28:31], a[236:239], v[176:179], v[28:31]
s_waitcnt lgkmcnt(0)
v_mfma_f32_16x16x32_bf16 v[32:35], v[56:59], v[176:179], v[32:35]
v_mfma_f32_16x16x32_bf16 v[36:39], v[60:63], v[176:179], v[36:39]
v_mfma_f32_16x16x32_bf16 v[40:43], v[64:67], v[176:179], v[40:43]
ds_read_b128 v[100:103], v247 offset:768
ds_read_b128 v[104:107], v247 offset:832
ds_read_b128 v[108:111], v247 offset:896
ds_read_b128 v[112:115], v247 offset:960
ds_read_b128 v[116:119], v247 offset:1024
ds_read_b128 v[120:123], v247 offset:1088
ds_read_b128 v[124:127], v247 offset:384
ds_read_b128 v[128:131], v247 offset:448
ds_read_b128 v[132:135], v247 offset:512
ds_read_b128 v[136:139], v247 offset:576
ds_read_b128 v[140:143], v247 offset:640
ds_read_b128 v[144:147], v247 offset:704
ds_read_b128 v[148:151], v247 offset:1152
ds_read_b128 v[152:155], v247 offset:1216
ds_read_b128 v[156:159], v247 offset:1280
ds_read_b128 v[160:163], v247 offset:1344
ds_read_b128 v[164:167], v247 offset:1408
ds_read_b128 v[168:171], v247 offset:1472
v_pk_fma_f32 v[20:21], v[20:21], v[180:181], v[68:69]
v_pk_fma_f32 v[22:23], v[22:23], v[182:183], v[70:71]
v_pk_fma_f32 v[24:25], v[24:25], v[184:185], v[72:73]
v_pk_fma_f32 v[26:27], v[26:27], v[186:187], v[74:75]
v_pk_fma_f32 v[28:29], v[28:29], v[188:189], v[76:77]
v_pk_fma_f32 v[30:31], v[30:31], v[190:191], v[78:79]
v_pk_fma_f32 v[32:33], v[32:33], v[192:193], v[80:81]
v_pk_fma_f32 v[34:35], v[34:35], v[194:195], v[82:83]
v_pk_fma_f32 v[36:37], v[36:37], v[196:197], v[84:85]
v_pk_fma_f32 v[38:39], v[38:39], v[198:199], v[86:87]
v_pk_fma_f32 v[40:41], v[40:41], v[200:201], v[88:89]
v_pk_fma_f32 v[42:43], v[42:43], v[202:203], v[90:91]
v_pk_mul_f32 v[46:47], v[20:21], v[20:21]
v_pk_mul_f32 v[48:49], v[20:21], v[204:205]
v_pk_add_f32 v[44:45], v[20:21], v[22:23]
v_pk_fma_f32 v[46:47], v[22:23], v[22:23], v[46:47]
v_pk_fma_f32 v[48:49], v[22:23], v[206:207], v[48:49]
v_pk_fma_f32 v[46:47], v[24:25], v[24:25], v[46:47]
v_pk_fma_f32 v[48:49], v[24:25], v[208:209], v[48:49]
v_pk_add_f32 v[44:45], v[44:45], v[24:25]
v_pk_fma_f32 v[46:47], v[26:27], v[26:27], v[46:47]
v_pk_fma_f32 v[48:49], v[26:27], v[210:211], v[48:49]
v_pk_add_f32 v[44:45], v[44:45], v[26:27]
v_pk_fma_f32 v[46:47], v[28:29], v[28:29], v[46:47]
v_pk_fma_f32 v[48:49], v[28:29], v[212:213], v[48:49]
v_pk_add_f32 v[44:45], v[44:45], v[28:29]
v_pk_fma_f32 v[46:47], v[30:31], v[30:31], v[46:47]
v_pk_fma_f32 v[48:49], v[30:31], v[214:215], v[48:49]
v_pk_add_f32 v[44:45], v[44:45], v[30:31]
v_pk_fma_f32 v[46:47], v[32:33], v[32:33], v[46:47]
v_pk_fma_f32 v[48:49], v[32:33], v[216:217], v[48:49]
v_pk_add_f32 v[44:45], v[44:45], v[32:33]
v_pk_fma_f32 v[46:47], v[34:35], v[34:35], v[46:47]
v_pk_fma_f32 v[48:49], v[34:35], v[218:219], v[48:49]
v_pk_add_f32 v[44:45], v[44:45], v[34:35]
v_pk_fma_f32 v[46:47], v[36:37], v[36:37], v[46:47]
v_pk_fma_f32 v[48:49], v[36:37], v[220:221], v[48:49]
v_pk_add_f32 v[44:45], v[44:45], v[36:37]
v_pk_fma_f32 v[46:47], v[38:39], v[38:39], v[46:47]
v_pk_fma_f32 v[48:49], v[38:39], v[222:223], v[48:49]
v_pk_add_f32 v[44:45], v[44:45], v[38:39]
v_pk_fma_f32 v[46:47], v[40:41], v[40:41], v[46:47]
v_pk_fma_f32 v[48:49], v[40:41], v[224:225], v[48:49]
v_pk_add_f32 v[44:45], v[44:45], v[40:41]
v_pk_fma_f32 v[46:47], v[42:43], v[42:43], v[46:47]
v_pk_fma_f32 v[48:49], v[42:43], v[226:227], v[48:49]
v_pk_add_f32 v[44:45], v[44:45], v[42:43]
v_add_f32 v44, v44, v45
v_add_f32 v46, v46, v47
v_add_f32 v48, v48, v49
s_mov_b32 s56, s14
s_lshl_b32 s57, s96, 8
s_add_u32 s57, s57, s56
v_permlane32_swap_b32 v44, v46
v_permlane32_swap_b32 v48, v95
v_add_f32 v44, v44, v46
v_add_f32 v48, v48, v95
s_mov_b32 s55, 0xffffff00
s_nop 0
v_permlane16_swap_b32 v44, v48
v_add_f32 v44, v44, v48
s_cmp_eq_u32 s15, 0
v_and_or_b32 v44, v44, s55, v19
s_cbranch_scc0 L_st_slow
buffer_store_dword v44, v0, s[4:7], s57 offen
L_st_j:
L_st_poll:
buffer_load_dword v44, v0, s[4:7], s56 offen offset:0 sc1
buffer_load_dword v45, v0, s[4:7], s56 offen offset:256 sc1
buffer_load_dword v46, v0, s[4:7], s56 offen offset:512 sc1
buffer_load_dword v47, v0, s[4:7], s56 offen offset:768 sc1
buffer_load_dword v48, v0, s[4:7], s56 offen offset:1024 sc1
buffer_load_dword v49, v0, s[4:7], s56 offen offset:1280 sc1
buffer_load_dword v50, v0, s[4:7], s56 offen offset:1536 sc1
s_waitcnt vmcnt(0)
v_xor_b32 v52, v44, v19
v_bitop3_b32 v52, v52, v45, v19 bitop3:0xf6
v_bitop3_b32 v52, v52, v46, v19 bitop3:0xf6
v_bitop3_b32 v52, v52, v47, v19 bitop3:0xf6
v_bitop3_b32 v52, v52, v48, v19 bitop3:0xf6
v_bitop3_b32 v52, v52, v49, v19 bitop3:0xf6
v_bitop3_b32 v52, v52, v50, v19 bitop3:0xf6
v_and_b32 v52, 0xff, v52
v_cmp_ne_u32 vcc, 0, v52
s_add_u32 s97, s97, 1
s_cmp_gt_u32 s97, 65536
s_cbranch_scc1 L_st_ok
s_cbranch_vccnz L_st_poll
L_st_ok:
v_and_b32 v44, s55, v44
v_and_b32 v45, s55, v45
v_and_b32 v46, s55, v46
v_and_b32 v47, s55, v47
v_and_b32 v48, s55, v48
v_and_b32 v49, s55, v49
v_and_b32 v50, s55, v50
v_add_f32 v44, v44, v45
v_add_f32 v46, v46, v47
v_add_f32 v48, v48, v49
v_add_f32 v44, v44, v50
v_add_f32 v46, v46, v48
v_add_f32 v44, v44, v46
v_mov_b32 v46, v44
s_nop 1
v_permlane32_swap_b32 v44, v46
v_mov_b32 v45, v44
v_mov_b32 v47, v46
s_nop 0
v_permlane16_swap_b32 v44, v45
v_permlane16_swap_b32 v46, v47
v_mul_f32 v44, 0x3acccccd, v44
v_mul_f32 v46, 0x3acccccd, v46
v_fma_f32 v46, -v44, v44, v46
v_max_f32 v46, 0, v46
v_add_f32 v46, 0x3727c5ac, v46
v_rsq_f32 v48, v46
v_fma_f32 v45, -v44, v47, v45
v_mul_f32 v45, v45, v48
v_mul_f32 v49, -v44, v48
s_lshl_b32 s57, s3, 2
s_add_u32 s57, s57, 135168
v_max_f32_dpp v46, v45, v45 row_ror:8 row_mask:0xf bank_mask:0xf
v_mov_b32 v50, s57
v_and_b32 v51, 12, v0
v_max_f32_dpp v46, v46, v46 row_ror:4 row_mask:0xf bank_mask:0xf
v_add_u32 v51, 135168, v51
s_nop 0
v_max_f32_dpp v46, v46, v46 row_ror:2 row_mask:0xf bank_mask:0xf
s_nop 1
v_max_f32_dpp v46, v46, v46 row_ror:1 row_mask:0xf bank_mask:0xf
ds_write_b32 v50, v46
v_pk_fma_f32 v[68:69], v[20:21], v[48:49], v[48:49] op_sel:[0,0,1] op_sel_hi:[1,0,1]
v_pk_fma_f32 v[70:71], v[22:23], v[48:49], v[48:49] op_sel:[0,0,1] op_sel_hi:[1,0,1]
v_pk_fma_f32 v[72:73], v[24:25], v[48:49], v[48:49] op_sel:[0,0,1] op_sel_hi:[1,0,1]
v_pk_fma_f32 v[74:75], v[26:27], v[48:49], v[48:49] op_sel:[0,0,1] op_sel_hi:[1,0,1]
v_pk_fma_f32 v[76:77], v[28:29], v[48:49], v[48:49] op_sel:[0,0,1] op_sel_hi:[1,0,1]
v_pk_fma_f32 v[78:79], v[30:31], v[48:49], v[48:49] op_sel:[0,0,1] op_sel_hi:[1,0,1]
v_pk_fma_f32 v[80:81], v[32:33], v[48:49], v[48:49] op_sel:[0,0,1] op_sel_hi:[1,0,1]
v_pk_fma_f32 v[82:83], v[34:35], v[48:49], v[48:49] op_sel:[0,0,1] op_sel_hi:[1,0,1]
v_pk_fma_f32 v[84:85], v[36:37], v[48:49], v[48:49] op_sel:[0,0,1] op_sel_hi:[1,0,1]
v_pk_fma_f32 v[86:87], v[38:39], v[48:49], v[48:49] op_sel:[0,0,1] op_sel_hi:[1,0,1]
v_pk_fma_f32 v[88:89], v[40:41], v[48:49], v[48:49] op_sel:[0,0,1] op_sel_hi:[1,0,1]
v_pk_fma_f32 v[90:91], v[42:43], v[48:49], v[48:49] op_sel:[0,0,1] op_sel_hi:[1,0,1]
s_waitcnt lgkmcnt(0)
s_barrier
ds_read_b32 v52, v51
v_pk_fma_f32 v[68:69], v[68:69], v[100:101], v[124:125]
v_pk_fma_f32 v[70:71], v[70:71], v[102:103], v[126:127]
v_pk_fma_f32 v[72:73], v[72:73], v[104:105], v[128:129]
v_pk_fma_f32 v[74:75], v[74:75], v[106:107], v[130:131]
v_pk_fma_f32 v[76:77], v[76:77], v[108:109], v[132:133]
v_pk_fma_f32 v[78:79], v[78:79], v[110:111], v[134:135]
v_pk_fma_f32 v[80:81], v[80:81], v[112:113], v[136:137]
v_pk_fma_f32 v[82:83], v[82:83], v[114:115], v[138:139]
v_pk_fma_f32 v[84:85], v[84:85], v[116:117], v[140:141]
v_pk_fma_f32 v[86:87], v[86:87], v[118:119], v[142:143]
v_pk_fma_f32 v[88:89], v[88:89], v[120:121], v[144:145]
v_pk_fma_f32 v[90:91], v[90:91], v[122:123], v[146:147]
s_waitcnt lgkmcnt(0)
v_max_f32_dpp v53, v52, v52 quad_perm:[1,0,3,2] row_mask:0xf bank_mask:0xf
s_nop 1
v_max_f32_dpp v53, v53, v53 quad_perm:[2,3,0,1] row_mask:0xf bank_mask:0xf
v_cmp_eq_f32 vcc, v53, v52
v_cmp_eq_f32 s[58:59], v53, v45
s_ff1_i32_b64 s57, vcc
s_and_b32 s57, s57, 3
s_cmp_eq_u32 s57, s3
s_cbranch_scc0 L_nowin
s_ff1_i32_b64 s57, s[58:59]
s_and_b32 s57, s57, 15
s_cmp_eq_u32 s96, 0
s_cbranch_scc0 L_nocand
s_lshl_b32 s58, s57, 1
s_add_u32 s58, s58, s54
v_mov_b32 v56, v53
v_mov_b32 v57, s58
v_mov_b32 v58, s40
v_mov_b32 v59, s53
s_lshl_b32 s58, s47, 7
s_add_u32 s58, s58, 393216
s_mov_b64 exec, 0xff
buffer_store_dwordx4 v[56:59], v252, s[4:7], s58 offen sc1
L_nocand:
s_mov_b32 s58, 0x00010001
s_lshl_b32 exec_lo, s58, s57
s_lshl_b32 exec_hi, s58, s57
s_lshl_b32 s58, s47, 11
s_lshl_b32 s59, s96, 8
s_add_u32 s58, s58, s59
s_lshl_b32 s59, s58, 1
s_add_u32 s58, s58, 458752
s_add_u32 s59, s59, 524288
v_lshlrev_b32 v54, 3, v3
v_lshlrev_b32 v55, 4, v3
v_cvt_pk_bf16_f32 v172, v68, v69
v_cvt_pk_bf16_f32 v173, v70, v71
buffer_store_dwordx2 v[172:173], v54, s[4:7], s58 offen offset:0 sc1
v_cvt_pk_bf16_f32 v174, v72, v73
v_cvt_pk_bf16_f32 v175, v74, v75
buffer_store_dwordx2 v[174:175], v54, s[4:7], s58 offen offset:32 sc1
v_cvt_pk_bf16_f32 v176, v76, v77
v_cvt_pk_bf16_f32 v177, v78, v79
buffer_store_dwordx2 v[176:177], v54, s[4:7], s58 offen offset:64 sc1
v_cvt_pk_bf16_f32 v178, v80, v81
v_cvt_pk_bf16_f32 v179, v82, v83
buffer_store_dwordx2 v[178:179], v54, s[4:7], s58 offen offset:96 sc1
v_cvt_pk_bf16_f32 v172, v84, v85
v_cvt_pk_bf16_f32 v173, v86, v87
buffer_store_dwordx2 v[172:173], v54, s[4:7], s58 offen offset:128 sc1
v_cvt_pk_bf16_f32 v174, v88, v89
v_cvt_pk_bf16_f32 v175, v90, v91
buffer_store_dwordx2 v[174:175], v54, s[4:7], s58 offen offset:160 sc1
s_and_b32 s60, s40, 0xff
s_bfe_u32 s61, s40, 0x80008
s_bfe_u32 s62, s40, 0x80010
s_lshr_b32 s63, s40, 24
v_mov_b32 v60, s55
v_pk_fma_f32 v[100:101], v[68:69], v[148:149], v[20:21]
v_pk_fma_f32 v[102:103], v[70:71], v[150:151], v[22:23]
v_and_or_b32 v100, v100, v60, s60
v_and_or_b32 v101, v101, v60, s61
v_and_or_b32 v102, v102, v60, s62
v_and_or_b32 v103, v103, v60, s63
buffer_store_dwordx4 v[100:103], v55, s[4:7], s59 offen offset:0 sc1
v_pk_fma_f32 v[104:105], v[72:73], v[152:153], v[24:25]
v_pk_fma_f32 v[106:107], v[74:75], v[154:155], v[26:27]
v_and_or_b32 v104, v104, v60, s60
v_and_or_b32 v105, v105, v60, s61
v_and_or_b32 v106, v106, v60, s62
v_and_or_b32 v107, v107, v60, s63
buffer_store_dwordx4 v[104:107], v55, s[4:7], s59 offen offset:64 sc1
v_pk_fma_f32 v[108:109], v[76:77], v[156:157], v[28:29]
v_pk_fma_f32 v[110:111], v[78:79], v[158:159], v[30:31]
v_and_or_b32 v108, v108, v60, s60
v_and_or_b32 v109, v109, v60, s61
v_and_or_b32 v110, v110, v60, s62
v_and_or_b32 v111, v111, v60, s63
buffer_store_dwordx4 v[108:111], v55, s[4:7], s59 offen offset:128 sc1
v_pk_fma_f32 v[112:113], v[80:81], v[160:161], v[32:33]
v_pk_fma_f32 v[114:115], v[82:83], v[162:163], v[34:35]
v_and_or_b32 v112, v112, v60, s60
v_and_or_b32 v113, v113, v60, s61
v_and_or_b32 v114, v114, v60, s62
v_and_or_b32 v115, v115, v60, s63
buffer_store_dwordx4 v[112:115], v55, s[4:7], s59 offen offset:192 sc1
v_pk_fma_f32 v[116:117], v[84:85], v[164:165], v[36:37]
v_pk_fma_f32 v[118:119], v[86:87], v[166:167], v[38:39]
v_and_or_b32 v116, v116, v60, s60
v_and_or_b32 v117, v117, v60, s61
v_and_or_b32 v118, v118, v60, s62
v_and_or_b32 v119, v119, v60, s63
buffer_store_dwordx4 v[116:119], v55, s[4:7], s59 offen offset:256 sc1
v_pk_fma_f32 v[120:121], v[88:89], v[168:169], v[40:41]
v_pk_fma_f32 v[122:123], v[90:91], v[170:171], v[42:43]
v_and_or_b32 v120, v120, v60, s60
v_and_or_b32 v121, v121, v60, s61
v_and_or_b32 v122, v122, v60, s62
v_and_or_b32 v123, v123, v60, s63
buffer_store_dwordx4 v[120:123], v55, s[4:7], s59 offen offset:320 sc1
s_mov_b64 exec, -1
L_nowin:
v_pk_fma_f32 v[20:21], v[68:69], v[148:149], v[20:21]
v_pk_fma_f32 v[22:23], v[70:71], v[150:151], v[22:23]
v_cvt_pk_bf16_f32 v20, v20, v21
v_cvt_pk_bf16_f32 v21, v22, v23
ds_write_b64 v230, v[20:21] offset:0
v_pk_fma_f32 v[24:25], v[72:73], v[152:153], v[24:25]
v_pk_fma_f32 v[26:27], v[74:75], v[154:155], v[26:27]
v_cvt_pk_bf16_f32 v24, v24, v25
v_cvt_pk_bf16_f32 v25, v26, v27
ds_write_b64 v230, v[24:25] offset:32
v_pk_fma_f32 v[28:29], v[76:77], v[156:157], v[28:29]
v_pk_fma_f32 v[30:31], v[78:79], v[158:159], v[30:31]
v_cvt_pk_bf16_f32 v28, v28, v29
v_cvt_pk_bf16_f32 v29, v30, v31
ds_write_b64 v230, v[28:29] offset:64
v_pk_fma_f32 v[32:33], v[80:81], v[160:161], v[32:33]
v_pk_fma_f32 v[34:35], v[82:83], v[162:163], v[34:35]
v_cvt_pk_bf16_f32 v32, v32, v33
v_cvt_pk_bf16_f32 v33, v34, v35
ds_write_b64 v230, v[32:33] offset:96
v_pk_fma_f32 v[36:37], v[84:85], v[164:165], v[36:37]
v_pk_fma_f32 v[38:39], v[86:87], v[166:167], v[38:39]
v_cvt_pk_bf16_f32 v36, v36, v37
v_cvt_pk_bf16_f32 v37, v38, v39
ds_write_b64 v230, v[36:37] offset:128
v_pk_fma_f32 v[40:41], v[88:89], v[168:169], v[40:41]
v_pk_fma_f32 v[42:43], v[90:91], v[170:171], v[42:43]
v_cvt_pk_bf16_f32 v40, v40, v41
v_cvt_pk_bf16_f32 v41, v42, v43
ds_write_b64 v230, v[40:41] offset:160
s_waitcnt lgkmcnt(0)
ds_read_b128 v[44:47], v231 offset:0
ds_read_b128 v[48:51], v231 offset:1024
ds_read_b128 v[52:55], v231 offset:2048
s_waitcnt lgkmcnt(2)
buffer_store_dwordx4 v[44:47], v235, s[32:35], s50 offen offset:0 sc1
s_waitcnt lgkmcnt(1)
buffer_store_dwordx4 v[48:51], v236, s[32:35], s50 offen offset:1024 sc1
s_waitcnt lgkmcnt(0)
buffer_store_dwordx4 v[52:55], v237, s[32:35], s50 offen offset:2048 sc1
s_lshl_b32 s56, s53, 3
s_add_u32 s56, s56, s96
s_lshl_b32 s56, s56, 4
s_add_u32 s56, s56, 655360
v_mov_b32 v20, s40
s_mov_b64 exec, 1
s_waitcnt vmcnt(0)
buffer_store_dword v20, v0, s[4:7], s56 offen sc1
s_mov_b64 exec, -1
s_branch L_fin
L_ga_retry:
buffer_load_dword v71, v247, s[4:7], s60 offen sc1
buffer_load_dwordx4 v[40:43], v248, s[4:7], s56 offen sc1
buffer_load_dwordx4 v[44:47], v248, s[4:7], s57 offen sc1
buffer_load_dwordx4 v[48:51], v248, s[4:7], s58 offen sc1
buffer_load_dwordx4 v[52:55], v249, s[4:7], s56 offen sc1
buffer_load_dwordx4 v[56:59], v249, s[4:7], s57 offen sc1
buffer_load_dwordx4 v[60:63], v249, s[4:7], s58 offen sc1
s_waitcnt vmcnt(0)
v_perm_b32 v64, v41, v40, s98
v_perm_b32 v65, v43, v42, s99
v_bitop3_b32 v66, v64, v65, s40 bitop3:0x56
v_perm_b32 v64, v45, v44, s98
v_perm_b32 v65, v47, v46, s99
v_bitop3_b32 v67, v64, v65, s40 bitop3:0x56
v_perm_b32 v64, v49, v48, s98
v_perm_b32 v65, v51, v50, s99
v_bitop3_b32 v68, v64, v65, s40 bitop3:0x56
v_or3_b32 v69, v66, v67, v68
v_perm_b32 v64, v53, v52, s98
v_perm_b32 v65, v55, v54, s99
v_bitop3_b32 v66, v64, v65, s40 bitop3:0x56
v_perm_b32 v64, v57, v56, s98
v_perm_b32 v65, v59, v58, s99
v_bitop3_b32 v67, v64, v65, s40 bitop3:0x56
v_perm_b32 v64, v61, v60, s98
v_perm_b32 v65, v63, v62, s99
v_bitop3_b32 v68, v64, v65, s40 bitop3:0x56
v_or3_b32 v70, v66, v67, v68
v_and_b32 v70, v70, v250
v_xor_b32 v71, s40, v71
v_or3_b32 v69, v69, v70, v71
v_cmp_ne_u32 vcc, 0, v69
s_add_u32 s97, s97, 1
s_cmp_gt_u32 s97, 65536
s_cbranch_scc1 L_ga_ok
s_cbranch_vccnz L_ga_retry
s_branch L_ga_ok
L_mv_retry:
buffer_load_dwordx2 v[194:195], v248, s[4:7], s23 offen sc1
buffer_load_dwordx4 v[240:243], v238, s[4:7], s51 offen sc1
buffer_load_dwordx4 v[190:193], v238, s[4:7], s22 offen sc1
s_waitcnt vmcnt(0)
v_perm_b32 v36, v241, v240, s55
v_perm_b32 v37, v243, v242, s55
v_xor_b32 v36, s40, v36
v_xor_b32 v37, s40, v37
v_or_b32 v38, v36, v37
v_perm_b32 v36, v191, v190, s55
v_perm_b32 v37, v193, v192, s55
v_xor_b32 v36, s40, v36
v_xor_b32 v37, s40, v37
v_or3_b32 v38, v38, v36, v37
v_and_b32 v38, v38, v250
v_xor_b32 v37, s40, v194
v_or_b32 v38, v38, v37
v_cmp_ne_u32 vcc, 0, v38
s_add_u32 s97, s97, 1
s_cmp_gt_u32 s97, 65536
s_cbranch_scc1 L_mv_ok
s_cbranch_vccnz L_mv_retry
s_branch L_mv_ok
L_o0_retry:
buffer_load_dwordx4 v[100:103], v252, s[4:7], s56 offen offset:0 sc1
buffer_load_dwordx4 v[104:107], v252, s[4:7], s56 offen offset:1024 sc1
s_waitcnt vmcnt(0)
v_max3_u32 v92, v100, v101, v102
v_max3_u32 v93, v103, v104, v105
v_max3_u32 v92, v92, v106, v107
v_max_u32 v92, v92, v93
v_cmp_eq_u32 vcc, -1, v92
s_add_u32 s97, s97, 1
s_cmp_gt_u32 s97, 65536
s_cbranch_scc1 L_o0_ok
s_cbranch_vccnz L_o0_retry
s_branch L_o0_ok
L_o1_retry:
buffer_load_dwordx4 v[108:111], v252, s[4:7], s56 offen offset:2048 sc1
buffer_load_dwordx4 v[112:115], v252, s[4:7], s56 offen offset:3072 sc1
s_waitcnt vmcnt(0)
v_max3_u32 v92, v108, v109, v110
v_max3_u32 v93, v111, v112, v113
v_max3_u32 v92, v92, v114, v115
v_max_u32 v92, v92, v93
v_cmp_eq_u32 vcc, -1, v92
s_add_u32 s97, s97, 1
s_cmp_gt_u32 s97, 65536
s_cbranch_scc1 L_o1_ok
s_cbranch_vccnz L_o1_retry
s_branch L_o1_ok
L_o2_retry:
buffer_load_dwordx4 v[116:119], v252, s[4:7], s57 offen offset:0 sc1
buffer_load_dwordx4 v[120:123], v252, s[4:7], s57 offen offset:1024 sc1
s_waitcnt vmcnt(0)
v_max3_u32 v92, v116, v117, v118
v_max3_u32 v93, v119, v120, v121
v_max3_u32 v92, v92, v122, v123
v_max_u32 v92, v92, v93
v_cmp_eq_u32 vcc, -1, v92
s_add_u32 s97, s97, 1
s_cmp_gt_u32 s97, 65536
s_cbranch_scc1 L_o2_ok
s_cbranch_vccnz L_o2_retry
s_branch L_o2_ok
L_o3_retry:
buffer_load_dwordx4 v[124:127], v252, s[4:7], s57 offen offset:2048 sc1
buffer_load_dwordx4 v[128:131], v252, s[4:7], s57 offen offset:3072 sc1
s_waitcnt vmcnt(0)
v_max3_u32 v92, v124, v125, v126
v_max3_u32 v93, v127, v128, v129
v_max3_u32 v92, v92, v130, v131
v_max_u32 v92, v92, v93
v_cmp_eq_u32 vcc, -1, v92
s_add_u32 s97, s97, 1
s_cmp_gt_u32 s97, 65536
s_cbranch_scc1 L_o3_ok
s_cbranch_vccnz L_o3_retry
s_branch L_o3_ok
L_o4_retry:
buffer_load_dwordx4 v[132:135], v252, s[4:7], s58 offen offset:0 sc1
buffer_load_dwordx4 v[136:139], v252, s[4:7], s58 offen offset:1024 sc1
s_waitcnt vmcnt(0)
v_max3_u32 v92, v132, v133, v134
v_max3_u32 v93, v135, v136, v137
v_max3_u32 v92, v92, v138, v139
v_max_u32 v92, v92, v93
v_cmp_eq_u32 vcc, -1, v92
s_add_u32 s97, s97, 1
s_cmp_gt_u32 s97, 65536
s_cbranch_scc1 L_o4_ok
s_cbranch_vccnz L_o4_retry
s_branch L_o4_ok
L_o5_retry:
buffer_load_dwordx4 v[140:143], v252, s[4:7], s58 offen offset:2048 sc1
buffer_load_dwordx4 v[144:147], v252, s[4:7], s58 offen offset:3072 sc1
s_waitcnt vmcnt(0)
v_max3_u32 v92, v140, v141, v142
v_max3_u32 v93, v143, v144, v145
v_max3_u32 v92, v92, v146, v147
v_max_u32 v92, v92, v93
v_cmp_eq_u32 vcc, -1, v92
s_add_u32 s97, s97, 1
s_cmp_gt_u32 s97, 65536
s_cbranch_scc1 L_o5_ok
s_cbranch_vccnz L_o5_retry
s_branch L_o5_ok
L_o6_retry:
buffer_load_dwordx4 v[148:151], v252, s[4:7], s59 offen offset:0 sc1
buffer_load_dwordx4 v[152:155], v252, s[4:7], s59 offen offset:1024 sc1
s_waitcnt vmcnt(0)
v_max3_u32 v92, v148, v149, v150
v_max3_u32 v93, v151, v152, v153
v_max3_u32 v92, v92, v154, v155
v_max_u32 v92, v92, v93
v_cmp_eq_u32 vcc, -1, v92
s_add_u32 s97, s97, 1
s_cmp_gt_u32 s97, 65536
s_cbranch_scc1 L_o6_ok
s_cbranch_vccnz L_o6_retry
s_branch L_o6_ok
L_o7_retry:
buffer_load_dwordx4 v[156:159], v252, s[4:7], s59 offen offset:2048 sc1
buffer_load_dwordx4 v[160:163], v252, s[4:7], s59 offen offset:3072 sc1
s_waitcnt vmcnt(0)
v_max3_u32 v92, v156, v157, v158
v_max3_u32 v93, v159, v160, v161
v_max3_u32 v92, v92, v162, v163
v_max_u32 v92, v92, v93
v_cmp_eq_u32 vcc, -1, v92
s_add_u32 s97, s97, 1
s_cmp_gt_u32 s97, 65536
s_cbranch_scc1 L_o7_ok
s_cbranch_vccnz L_o7_retry
s_branch L_o7_ok
L_o8_retry:
buffer_load_dwordx4 v[164:167], v252, s[4:7], s60 offen offset:0 sc1
buffer_load_dwordx4 v[168:171], v252, s[4:7], s60 offen offset:1024 sc1
s_waitcnt vmcnt(0)
v_max3_u32 v92, v164, v165, v166
v_max3_u32 v93, v167, v168, v169
v_max3_u32 v92, v92, v170, v171
v_max_u32 v92, v92, v93
v_cmp_eq_u32 vcc, -1, v92
s_add_u32 s97, s97, 1
s_cmp_gt_u32 s97, 65536
s_cbranch_scc1 L_o8_ok
s_cbranch_vccnz L_o8_retry
s_branch L_o8_ok
L_o9_retry:
buffer_load_dwordx4 v[172:175], v252, s[4:7], s60 offen offset:2048 sc1
buffer_load_dwordx4 v[176:179], v252, s[4:7], s60 offen offset:3072 sc1
s_waitcnt vmcnt(0)
v_max3_u32 v92, v172, v173, v174
v_max3_u32 v93, v175, v176, v177
v_max3_u32 v92, v92, v178, v179
v_max_u32 v92, v92, v93
v_cmp_eq_u32 vcc, -1, v92
s_add_u32 s97, s97, 1
s_cmp_gt_u32 s97, 65536
s_cbranch_scc1 L_o9_ok
s_cbranch_vccnz L_o9_retry
s_branch L_o9_ok
L_st_slow:
buffer_store_dword v44, v0, s[4:7], s57 offen sc1
s_branch L_st_j
L_svc:
s_sub_u32 s44, s2, 224
v_lshlrev_b32 v28, 3, v0
s_waitcnt lgkmcnt(0)
s_mov_b32 s16, s22
s_mov_b32 s17, s23
s_mov_b32 s22, 1280
s_mov_b32 s23, 0x20000
buffer_load_dwordx2 v[40:41], v28, s[20:23], 0 offen
buffer_load_dword v42, v29, s[4:7], 0 offen sc1
s_load_dwordx2 s[8:9], s[0:1], 40
s_load_dwordx2 s[12:13], s[0:1], 48
s_load_dwordx2 s[36:37], s[0:1], 56
s_load_dwordx2 s[24:25], s[0:1], 16
s_load_dwordx2 s[28:29], s[0:1], 32
s_load_dwordx2 s[32:33], s[0:1], 80
s_mov_b32 s18, 4915200
s_mov_b32 s19, 0x20000
s_mov_b32 s26, 819200
s_mov_b32 s27, 0x20000
s_mov_b32 s30, 1280
s_mov_b32 s31, 0x20000
s_mov_b32 s34, 2621440
s_mov_b32 s35, 0x20000
s_mov_b32 s10, 2211840
s_mov_b32 s11, 0x20000
s_mov_b32 s14, 2211840
s_mov_b32 s15, 0x20000
s_mov_b32 s38, 2211840
s_mov_b32 s39, 0x20000
v_bfe_u32 v32, v1, 2, 2
v_lshrrev_b32 v33, 1, v32
v_and_b32 v34, 1, v3
v_lshl_or_b32 v33, v34, 1, v33
v_xor_b32 v33, s3, v33
v_and_b32 v34, 3, v1
v_lshlrev_b32 v34, 3, v34
v_lshl_add_u32 v33, v33, 5, v34
v_lshl_add_u32 v32, v3, 3, v32
v_lshl_add_u32 v6, v32, 7, v33
s_mov_b32 s97, 0
s_mov_b32 s98, 0x0c0c0400
s_mov_b32 s99, 0x04000c0c
v_add_u32 v7, 40960, v6
v_add_u32 v9, 81920, v6
v_add_u32 v10, 81920+40960, v6
s_mul_i32 s55, s3, 320
s_add_u32 s55, s55, 81920
v_mul_u32_u24 v32, 1280, v32
v_add3_u32 v11, v32, v34, s55
s_and_b32 s55, s3, 1
s_lshl_b32 s55, s55, 2
v_and_b32 v30, 1, v3
v_lshl_or_b32 v30, v30, 1, s55
v_and_b32 v31, 7, v1
v_xor_b32 v31, v30, v31
v_lshlrev_b32 v31, 4, v31
v_lshrrev_b32 v30, 3, v1
v_mad_u32_u24 v4, v30, 60, 0
v_lshl_add_u32 v4, v4, 7, v31
v_mad_u32_u24 v5, v30, 27, 0
v_lshl_add_u32 v5, v5, 7, v31
v_lshlrev_b32 v8, 4, v1
v_lshlrev_b32 v12, 2, v1
v_mov_b32 v255, 1073741824
s_waitcnt lgkmcnt(0)
s_cmp_ge_u32 s44, 27
s_cbranch_scc1 L_fz
s_lshl_b32 s55, s44, 2
s_add_u32 s55, s55, s3
s_mul_i32 s55, s55, 7680
v_lshlrev_b32 v33, 7, v1
s_mov_b32 exec_hi, 0xfffffff
buffer_load_dword v184, v33, s[24:27], s55 offen
s_mov_b32 exec_hi, -1
s_lshl_b32 s50, s44, 7
s_mul_i32 s55, s3, 61440
s_add_u32 s50, s50, s55
s_add_u32 s50, s50, 2560
s_add_u32 m0, s49, 0
s_nop 0
buffer_load_dwordx4 v4, s[16:19], s50 offen nt lds
s_add_u32 m0, m0, 4096
s_add_u32 s50, s50, 245760
buffer_load_dwordx4 v4, s[16:19], s50 offen nt lds
s_add_u32 m0, m0, 4096
s_add_u32 s50, s50, 245760
buffer_load_dwordx4 v4, s[16:19], s50 offen nt lds
s_add_u32 m0, m0, 4096
s_add_u32 s50, s50, 245760
buffer_load_dwordx4 v4, s[16:19], s50 offen nt lds
s_add_u32 m0, m0, 4096
s_add_u32 s50, s50, 245760
buffer_load_dwordx4 v4, s[16:19], s50 offen nt lds
s_add_u32 m0, m0, 4096
s_add_u32 s50, s50, 245760
buffer_load_dwordx4 v4, s[16:19], s50 offen nt lds
s_add_u32 m0, m0, 4096
s_add_u32 s50, s50, 245760
buffer_load_dwordx4 v4, s[16:19], s50 offen nt lds
s_add_u32 m0, m0, 4096
s_add_u32 s50, s50, 245760
buffer_load_dwordx4 v4, s[16:19], s50 offen nt lds
s_add_u32 m0, m0, 4096
s_add_u32 s50, s50, 245760
buffer_load_dwordx4 v4, s[16:19], s50 offen nt lds
s_add_u32 m0, m0, 4096
s_add_u32 s50, s50, 245760
buffer_load_dwordx4 v4, s[16:19], s50 offen nt lds
s_add_u32 m0, m0, 4096
s_add_u32 s50, s50, 245760
buffer_load_dwordx4 v4, s[16:19], s50 offen nt lds
s_add_u32 m0, m0, 4096
s_add_u32 s50, s50, 245760
buffer_load_dwordx4 v4, s[16:19], s50 offen nt lds
s_add_u32 m0, m0, 4096
s_add_u32 s50, s50, 245760
buffer_load_dwordx4 v4, s[16:19], s50 offen nt lds
s_add_u32 m0, m0, 4096
s_add_u32 s50, s50, 245760
buffer_load_dwordx4 v4, s[16:19], s50 offen nt lds
s_add_u32 m0, m0, 4096
s_add_u32 s50, s50, 245760
buffer_load_dwordx4 v4, s[16:19], s50 offen nt lds
s_add_u32 m0, m0, 4096
s_add_u32 s50, s50, 245760
buffer_load_dwordx4 v4, s[16:19], s50 offen nt lds
s_add_u32 m0, m0, 4096
s_add_u32 s50, s50, 245760
buffer_load_dwordx4 v4, s[16:19], s50 offen nt lds
s_add_u32 m0, m0, 4096
s_add_u32 s50, s50, 245760
buffer_load_dwordx4 v4, s[16:19], s50 offen nt lds
s_add_u32 m0, m0, 4096
s_add_u32 s50, s50, 245760
buffer_load_dwordx4 v4, s[16:19], s50 offen nt lds
s_add_u32 m0, m0, 4096
s_add_u32 s50, s50, 245760
buffer_load_dwordx4 v4, s[16:19], s50 offen nt lds
s_waitcnt vmcnt(21)
v_readfirstlane_b32 s41, v42
v_lshlrev_b32 v44, 16, v40
v_and_b32 v45, 0xffff0000, v40
v_lshlrev_b32 v46, 16, v41
v_and_b32 v47, 0xffff0000, v41
v_mul_f32 v48, 0xbfb8aa3b, v44
v_mul_f32 v49, 0xbfb8aa3b, v45
v_mul_f32 v50, 0xbfb8aa3b, v46
v_mul_f32 v51, 0xbfb8aa3b, v47
v_exp_f32 v48, v48
v_exp_f32 v49, v49
v_exp_f32 v50, v50
v_exp_f32 v51, v51
v_add_f32 v48, 1.0, v48
v_add_f32 v49, 1.0, v49
v_add_f32 v50, 1.0, v50
v_add_f32 v51, 1.0, v51
v_rcp_f32 v48, v48
v_rcp_f32 v49, v49
v_rcp_f32 v50, v50
v_rcp_f32 v51, v51
v_mul_f32 v44, v44, v48
v_mul_f32 v45, v45, v49
v_mul_f32 v46, v46, v50
v_mul_f32 v47, v47, v51
v_cvt_pk_bf16_f32 v40, v44, v45
v_cvt_pk_bf16_f32 v41, v46, v47
v_add_u32 v28, 99840, v28
ds_write_b64 v28, v[40:41]
v_lshlrev_b32 v28, 4, v3
v_add_u32 v28, 99840, v28
s_mul_i32 s40, s41, 0x9E3779B1
s_add_u32 s40, s40, 0x85EBCA6B
v_and_b32 v31, 3, v1
v_lshlrev_b32 v30, 3, v31
v_lshrrev_b32 v19, v30, s40
v_and_b32 v19, 0xff, v19
v_mov_b32 v240, s40
v_mov_b32 v241, s40
v_mov_b32 v242, s40
v_mov_b32 v243, s40
v_and_b32 v30, 1, v1
v_lshlrev_b32 v30, 4, v30
v_lshrrev_b32 v13, v30, s40
v_and_b32 v13, 0xffff, v13
s_waitcnt lgkmcnt(0)
s_barrier
ds_read_b128 v[100:103], v28 offset:0
ds_read_b128 v[104:107], v28 offset:64
ds_read_b128 v[108:111], v28 offset:128
ds_read_b128 v[112:115], v28 offset:192
ds_read_b128 v[116:119], v28 offset:256
ds_read_b128 v[120:123], v28 offset:320
ds_read_b128 v[124:127], v28 offset:384
ds_read_b128 v[128:131], v28 offset:448
ds_read_b128 v[132:135], v28 offset:512
ds_read_b128 v[136:139], v28 offset:576
ds_read_b128 v[140:143], v28 offset:640
ds_read_b128 v[144:147], v28 offset:704
ds_read_b128 v[148:151], v28 offset:768
ds_read_b128 v[152:155], v28 offset:832
ds_read_b128 v[156:159], v28 offset:896
ds_read_b128 v[160:163], v28 offset:960
ds_read_b128 v[164:167], v28 offset:1024
ds_read_b128 v[168:171], v28 offset:1088
ds_read_b128 v[172:175], v28 offset:1152
ds_read_b128 v[176:179], v28 offset:1216
s_waitcnt lgkmcnt(0)
s_barrier
s_lshl_b32 s51, s44, 7
s_mul_i32 s55, s3, 27648
s_add_u32 s51, s51, s55
s_mov_b32 s52, s51
s_add_u32 m0, s49, 81920
s_nop 0
buffer_load_dwordx4 v5, s[8:11], s51 offen nt lds
s_add_u32 m0, m0, 4096
s_add_u32 s51, s51, 110592
buffer_load_dwordx4 v5, s[8:11], s51 offen nt lds
s_add_u32 m0, m0, 4096
s_add_u32 s51, s51, 110592
buffer_load_dwordx4 v5, s[8:11], s51 offen nt lds
s_add_u32 m0, m0, 4096
s_add_u32 s51, s51, 110592
buffer_load_dwordx4 v5, s[8:11], s51 offen nt lds
s_add_u32 m0, m0, 4096
s_add_u32 s51, s51, 110592
buffer_load_dwordx4 v5, s[8:11], s51 offen nt lds
s_add_u32 m0, m0, 4096
s_add_u32 s51, s51, 110592
buffer_load_dwordx4 v5, s[8:11], s51 offen nt lds
s_add_u32 m0, m0, 4096
s_add_u32 s51, s51, 110592
buffer_load_dwordx4 v5, s[8:11], s51 offen nt lds
s_add_u32 m0, m0, 4096
s_add_u32 s51, s51, 110592
buffer_load_dwordx4 v5, s[8:11], s51 offen nt lds
s_add_u32 m0, m0, 4096
s_add_u32 s51, s51, 110592
buffer_load_dwordx4 v5, s[8:11], s51 offen nt lds
s_add_u32 m0, m0, 4096
s_add_u32 s51, s51, 110592
buffer_load_dwordx4 v5, s[8:11], s51 offen nt lds
s_add_u32 m0, m0, 4096
s_add_u32 s51, s51, 110592
buffer_load_dwordx4 v5, s[8:11], s51 offen nt lds
s_add_u32 m0, m0, 4096
s_add_u32 s51, s51, 110592
buffer_load_dwordx4 v5, s[8:11], s51 offen nt lds
s_add_u32 m0, m0, 4096
s_add_u32 s51, s51, 110592
buffer_load_dwordx4 v5, s[8:11], s51 offen nt lds
s_add_u32 m0, m0, 4096
s_add_u32 s51, s51, 110592
buffer_load_dwordx4 v5, s[8:11], s51 offen nt lds
s_add_u32 m0, m0, 4096
s_add_u32 s51, s51, 110592
buffer_load_dwordx4 v5, s[8:11], s51 offen nt lds
s_add_u32 m0, m0, 4096
s_add_u32 s51, s51, 110592
buffer_load_dwordx4 v5, s[8:11], s51 offen nt lds
s_add_u32 m0, m0, 4096
s_add_u32 s51, s51, 110592
buffer_load_dwordx4 v5, s[8:11], s51 offen nt lds
s_add_u32 m0, m0, 4096
s_add_u32 s51, s51, 110592
buffer_load_dwordx4 v5, s[8:11], s51 offen nt lds
s_add_u32 m0, m0, 4096
s_add_u32 s51, s51, 110592
buffer_load_dwordx4 v5, s[8:11], s51 offen nt lds
s_add_u32 m0, m0, 4096
s_add_u32 s51, s51, 110592
buffer_load_dwordx4 v5, s[8:11], s51 offen nt lds
s_waitcnt vmcnt(20)
s_barrier
ds_read_b64_tr_b16 v[20:21], v6 offset:0
ds_read_b64_tr_b16 v[22:23], v6 offset:512
ds_read_b64_tr_b16 v[24:25], v6 offset:4096
ds_read_b64_tr_b16 v[26:27], v6 offset:4608
ds_read_b64_tr_b16 v[28:29], v6 offset:8192
ds_read_b64_tr_b16 v[30:31], v6 offset:8704
ds_read_b64_tr_b16 v[32:33], v6 offset:12288
ds_read_b64_tr_b16 v[34:35], v6 offset:12800
ds_read_b64_tr_b16 v[36:37], v6 offset:16384
ds_read_b64_tr_b16 v[38:39], v6 offset:16896
ds_read_b64_tr_b16 v[40:41], v6 offset:20480
ds_read_b64_tr_b16 v[42:43], v6 offset:20992
ds_read_b64_tr_b16 v[44:45], v6 offset:24576
ds_read_b64_tr_b16 v[46:47], v6 offset:25088
ds_read_b64_tr_b16 v[48:49], v6 offset:28672
ds_read_b64_tr_b16 v[50:51], v6 offset:29184
ds_read_b64_tr_b16 v[52:53], v6 offset:32768
ds_read_b64_tr_b16 v[54:55], v6 offset:33280
ds_read_b64_tr_b16 v[56:57], v6 offset:36864
ds_read_b64_tr_b16 v[58:59], v6 offset:37376
ds_read_b64_tr_b16 v[60:61], v7 offset:0
ds_read_b64_tr_b16 v[62:63], v7 offset:512
ds_read_b64_tr_b16 v[64:65], v7 offset:4096
ds_read_b64_tr_b16 v[66:67], v7 offset:4608
ds_read_b64_tr_b16 v[68:69], v7 offset:8192
ds_read_b64_tr_b16 v[70:71], v7 offset:8704
ds_read_b64_tr_b16 v[72:73], v7 offset:12288
ds_read_b64_tr_b16 v[74:75], v7 offset:12800
ds_read_b64_tr_b16 v[76:77], v7 offset:16384
ds_read_b64_tr_b16 v[78:79], v7 offset:16896
ds_read_b64_tr_b16 v[80:81], v7 offset:20480
ds_read_b64_tr_b16 v[82:83], v7 offset:20992
ds_read_b64_tr_b16 v[84:85], v7 offset:24576
ds_read_b64_tr_b16 v[86:87], v7 offset:25088
ds_read_b64_tr_b16 v[88:89], v7 offset:28672
ds_read_b64_tr_b16 v[90:91], v7 offset:29184
ds_read_b64_tr_b16 v[92:93], v7 offset:32768
ds_read_b64_tr_b16 v[94:95], v7 offset:33280
ds_read_b64_tr_b16 v[96:97], v7 offset:36864
ds_read_b64_tr_b16 v[98:99], v7 offset:37376
s_waitcnt lgkmcnt(0)
s_barrier
v_mfma_f32_16x16x32_bf16 v[180:183], v[100:103], v[20:23], 0
v_mfma_f32_16x16x32_bf16 v[180:183], v[104:107], v[24:27], v[180:183]
v_mfma_f32_16x16x32_bf16 v[180:183], v[108:111], v[28:31], v[180:183]
v_mfma_f32_16x16x32_bf16 v[180:183], v[112:115], v[32:35], v[180:183]
v_mfma_f32_16x16x32_bf16 v[180:183], v[116:119], v[36:39], v[180:183]
v_mfma_f32_16x16x32_bf16 v[180:183], v[120:123], v[40:43], v[180:183]
v_mfma_f32_16x16x32_bf16 v[180:183], v[124:127], v[44:47], v[180:183]
v_mfma_f32_16x16x32_bf16 v[180:183], v[128:131], v[48:51], v[180:183]
v_mfma_f32_16x16x32_bf16 v[180:183], v[132:135], v[52:55], v[180:183]
v_mfma_f32_16x16x32_bf16 v[180:183], v[136:139], v[56:59], v[180:183]
v_mfma_f32_16x16x32_bf16 v[180:183], v[140:143], v[60:63], v[180:183]
v_mfma_f32_16x16x32_bf16 v[180:183], v[144:147], v[64:67], v[180:183]
v_mfma_f32_16x16x32_bf16 v[180:183], v[148:151], v[68:71], v[180:183]
v_mfma_f32_16x16x32_bf16 v[180:183], v[152:155], v[72:75], v[180:183]
v_mfma_f32_16x16x32_bf16 v[180:183], v[156:159], v[76:79], v[180:183]
v_mfma_f32_16x16x32_bf16 v[180:183], v[160:163], v[80:83], v[180:183]
v_mfma_f32_16x16x32_bf16 v[180:183], v[164:167], v[84:87], v[180:183]
v_mfma_f32_16x16x32_bf16 v[180:183], v[168:171], v[88:91], v[180:183]
v_mfma_f32_16x16x32_bf16 v[180:183], v[172:175], v[92:95], v[180:183]
v_mfma_f32_16x16x32_bf16 v[180:183], v[176:179], v[96:99], v[180:183]
s_sub_u32 s55, s44, 20
s_cmp_lt_u32 s55, 10
s_cselect_b32 s55, 1.0, 0
s_lshl_b32 s56, s44, 8
s_lshl_b32 s57, s3, 6
s_add_u32 s56, s56, s57
s_add_u32 s56, s56, 65536
s_nop 0
v_cvt_pk_bf16_f32 v180, v180, v180
v_lshlrev_b32 v180, 16, v180
v_add_f32 v180, s55, v180
v_cvt_pk_bf16_f32 v180, v180, v180
v_lshl_or_b32 v180, v180, 16, v13
s_mov_b64 exec, 0xffff
buffer_store_dword v180, v12, s[4:7], s56 offen sc1
s_mov_b64 exec, -1
s_add_u32 m0, s49, 0
s_nop 0
buffer_load_dwordx4 v5, s[12:15], s52 offen nt lds
s_add_u32 m0, m0, 4096
s_add_u32 s52, s52, 110592
buffer_load_dwordx4 v5, s[12:15], s52 offen nt lds
s_add_u32 m0, m0, 4096
s_add_u32 s52, s52, 110592
buffer_load_dwordx4 v5, s[12:15], s52 offen nt lds
s_add_u32 m0, m0, 4096
s_add_u32 s52, s52, 110592
buffer_load_dwordx4 v5, s[12:15], s52 offen nt lds
s_add_u32 m0, m0, 4096
s_add_u32 s52, s52, 110592
buffer_load_dwordx4 v5, s[12:15], s52 offen nt lds
s_add_u32 m0, m0, 4096
s_add_u32 s52, s52, 110592
buffer_load_dwordx4 v5, s[12:15], s52 offen nt lds
s_add_u32 m0, m0, 4096
s_add_u32 s52, s52, 110592
buffer_load_dwordx4 v5, s[12:15], s52 offen nt lds
s_add_u32 m0, m0, 4096
s_add_u32 s52, s52, 110592
buffer_load_dwordx4 v5, s[12:15], s52 offen nt lds
s_add_u32 m0, m0, 4096
s_add_u32 s52, s52, 110592
buffer_load_dwordx4 v5, s[12:15], s52 offen nt lds
s_add_u32 m0, m0, 4096
s_add_u32 s52, s52, 110592
buffer_load_dwordx4 v5, s[12:15], s52 offen nt lds
s_add_u32 m0, m0, 4096
s_add_u32 s52, s52, 110592
buffer_load_dwordx4 v5, s[12:15], s52 offen nt lds
s_add_u32 m0, m0, 4096
s_add_u32 s52, s52, 110592
buffer_load_dwordx4 v5, s[12:15], s52 offen nt lds
s_add_u32 m0, m0, 4096
s_add_u32 s52, s52, 110592
buffer_load_dwordx4 v5, s[12:15], s52 offen nt lds
s_add_u32 m0, m0, 4096
s_add_u32 s52, s52, 110592
buffer_load_dwordx4 v5, s[12:15], s52 offen nt lds
s_add_u32 m0, m0, 4096
s_add_u32 s52, s52, 110592
buffer_load_dwordx4 v5, s[12:15], s52 offen nt lds
s_add_u32 m0, m0, 4096
s_add_u32 s52, s52, 110592
buffer_load_dwordx4 v5, s[12:15], s52 offen nt lds
s_add_u32 m0, m0, 4096
s_add_u32 s52, s52, 110592
buffer_load_dwordx4 v5, s[12:15], s52 offen nt lds
s_add_u32 m0, m0, 4096
s_add_u32 s52, s52, 110592
buffer_load_dwordx4 v5, s[12:15], s52 offen nt lds
s_add_u32 m0, m0, 4096
s_add_u32 s52, s52, 110592
buffer_load_dwordx4 v5, s[12:15], s52 offen nt lds
s_add_u32 m0, m0, 4096
s_add_u32 s52, s52, 110592
buffer_load_dwordx4 v5, s[12:15], s52 offen nt lds
s_waitcnt vmcnt(21)
s_barrier
ds_read_b64_tr_b16 a[0:1], v9 offset:0
ds_read_b64_tr_b16 a[2:3], v9 offset:512
ds_read_b64_tr_b16 a[4:5], v9 offset:4096
ds_read_b64_tr_b16 a[6:7], v9 offset:4608
ds_read_b64_tr_b16 a[8:9], v9 offset:8192
ds_read_b64_tr_b16 a[10:11], v9 offset:8704
ds_read_b64_tr_b16 a[12:13], v9 offset:12288
ds_read_b64_tr_b16 a[14:15], v9 offset:12800
ds_read_b64_tr_b16 a[16:17], v9 offset:16384
ds_read_b64_tr_b16 a[18:19], v9 offset:16896
ds_read_b64_tr_b16 a[20:21], v9 offset:20480
ds_read_b64_tr_b16 a[22:23], v9 offset:20992
ds_read_b64_tr_b16 a[24:25], v9 offset:24576
ds_read_b64_tr_b16 a[26:27], v9 offset:25088
ds_read_b64_tr_b16 a[28:29], v9 offset:28672
ds_read_b64_tr_b16 a[30:31], v9 offset:29184
ds_read_b64_tr_b16 a[32:33], v9 offset:32768
ds_read_b64_tr_b16 a[34:35], v9 offset:33280
ds_read_b64_tr_b16 a[36:37], v9 offset:36864
ds_read_b64_tr_b16 a[38:39], v9 offset:37376
ds_read_b64_tr_b16 a[40:41], v10 offset:0
ds_read_b64_tr_b16 a[42:43], v10 offset:512
ds_read_b64_tr_b16 a[44:45], v10 offset:4096
ds_read_b64_tr_b16 a[46:47], v10 offset:4608
ds_read_b64_tr_b16 a[48:49], v10 offset:8192
ds_read_b64_tr_b16 a[50:51], v10 offset:8704
ds_read_b64_tr_b16 a[52:53], v10 offset:12288
ds_read_b64_tr_b16 a[54:55], v10 offset:12800
ds_read_b64_tr_b16 a[56:57], v10 offset:16384
ds_read_b64_tr_b16 a[58:59], v10 offset:16896
ds_read_b64_tr_b16 a[60:61], v10 offset:20480
ds_read_b64_tr_b16 a[62:63], v10 offset:20992
ds_read_b64_tr_b16 a[64:65], v10 offset:24576
ds_read_b64_tr_b16 a[66:67], v10 offset:25088
ds_read_b64_tr_b16 a[68:69], v10 offset:28672
ds_read_b64_tr_b16 a[70:71], v10 offset:29184
ds_read_b64_tr_b16 a[72:73], v10 offset:32768
ds_read_b64_tr_b16 a[74:75], v10 offset:33280
ds_read_b64_tr_b16 a[76:77], v10 offset:36864
ds_read_b64_tr_b16 a[78:79], v10 offset:37376
s_waitcnt lgkmcnt(0)
s_barrier
s_mul_i32 s51, s44, 81920
s_add_u32 s51, s51, s49
s_add_u32 m0, s49, 81920
s_nop 0
buffer_load_dwordx4 v8, s[36:39], s51 offen nt lds
s_add_u32 m0, m0, 4096
s_add_u32 s51, s51, 4096
buffer_load_dwordx4 v8, s[36:39], s51 offen nt lds
s_add_u32 m0, m0, 4096
s_add_u32 s51, s51, 4096
buffer_load_dwordx4 v8, s[36:39], s51 offen nt lds
s_add_u32 m0, m0, 4096
s_add_u32 s51, s51, 4096
buffer_load_dwordx4 v8, s[36:39], s51 offen nt lds
s_add_u32 m0, m0, 4096
s_add_u32 s51, s51, 4096
buffer_load_dwordx4 v8, s[36:39], s51 offen nt lds
s_add_u32 m0, m0, 4096
s_add_u32 s51, s51, 4096
buffer_load_dwordx4 v8, s[36:39], s51 offen nt lds
s_add_u32 m0, m0, 4096
s_add_u32 s51, s51, 4096
buffer_load_dwordx4 v8, s[36:39], s51 offen nt lds
s_add_u32 m0, m0, 4096
s_add_u32 s51, s51, 4096
buffer_load_dwordx4 v8, s[36:39], s51 offen nt lds
s_add_u32 m0, m0, 4096
s_add_u32 s51, s51, 4096
buffer_load_dwordx4 v8, s[36:39], s51 offen nt lds
s_add_u32 m0, m0, 4096
s_add_u32 s51, s51, 4096
buffer_load_dwordx4 v8, s[36:39], s51 offen nt lds
s_add_u32 m0, m0, 4096
s_add_u32 s51, s51, 4096
buffer_load_dwordx4 v8, s[36:39], s51 offen nt lds
s_add_u32 m0, m0, 4096
s_add_u32 s51, s51, 4096
buffer_load_dwordx4 v8, s[36:39], s51 offen nt lds
s_add_u32 m0, m0, 4096
s_add_u32 s51, s51, 4096
buffer_load_dwordx4 v8, s[36:39], s51 offen nt lds
s_add_u32 m0, m0, 4096
s_add_u32 s51, s51, 4096
buffer_load_dwordx4 v8, s[36:39], s51 offen nt lds
s_add_u32 m0, m0, 4096
s_add_u32 s51, s51, 4096
buffer_load_dwordx4 v8, s[36:39], s51 offen nt lds
s_add_u32 m0, m0, 4096
s_add_u32 s51, s51, 4096
buffer_load_dwordx4 v8, s[36:39], s51 offen nt lds
s_add_u32 m0, m0, 4096
s_add_u32 s51, s51, 4096
buffer_load_dwordx4 v8, s[36:39], s51 offen nt lds
s_add_u32 m0, m0, 4096
s_add_u32 s51, s51, 4096
buffer_load_dwordx4 v8, s[36:39], s51 offen nt lds
s_add_u32 m0, m0, 4096
s_add_u32 s51, s51, 4096
buffer_load_dwordx4 v8, s[36:39], s51 offen nt lds
s_add_u32 m0, m0, 4096
s_add_u32 s51, s51, 4096
buffer_load_dwordx4 v8, s[36:39], s51 offen nt lds
s_waitcnt vmcnt(20)
s_barrier
ds_read_b64_tr_b16 a[80:81], v6 offset:0
ds_read_b64_tr_b16 a[82:83], v6 offset:512
ds_read_b64_tr_b16 a[84:85], v6 offset:4096
ds_read_b64_tr_b16 a[86:87], v6 offset:4608
ds_read_b64_tr_b16 a[88:89], v6 offset:8192
ds_read_b64_tr_b16 a[90:91], v6 offset:8704
ds_read_b64_tr_b16 a[92:93], v6 offset:12288
ds_read_b64_tr_b16 a[94:95], v6 offset:12800
ds_read_b64_tr_b16 a[96:97], v6 offset:16384
ds_read_b64_tr_b16 a[98:99], v6 offset:16896
ds_read_b64_tr_b16 a[100:101], v6 offset:20480
ds_read_b64_tr_b16 a[102:103], v6 offset:20992
ds_read_b64_tr_b16 a[104:105], v6 offset:24576
ds_read_b64_tr_b16 a[106:107], v6 offset:25088
ds_read_b64_tr_b16 a[108:109], v6 offset:28672
ds_read_b64_tr_b16 a[110:111], v6 offset:29184
ds_read_b64_tr_b16 a[112:113], v6 offset:32768
ds_read_b64_tr_b16 a[114:115], v6 offset:33280
ds_read_b64_tr_b16 a[116:117], v6 offset:36864
ds_read_b64_tr_b16 a[118:119], v6 offset:37376
ds_read_b64_tr_b16 a[120:121], v7 offset:0
ds_read_b64_tr_b16 a[122:123], v7 offset:512
ds_read_b64_tr_b16 a[124:125], v7 offset:4096
ds_read_b64_tr_b16 a[126:127], v7 offset:4608
ds_read_b64_tr_b16 a[128:129], v7 offset:8192
ds_read_b64_tr_b16 a[130:131], v7 offset:8704
ds_read_b64_tr_b16 a[132:133], v7 offset:12288
ds_read_b64_tr_b16 a[134:135], v7 offset:12800
ds_read_b64_tr_b16 a[136:137], v7 offset:16384
ds_read_b64_tr_b16 a[138:139], v7 offset:16896
ds_read_b64_tr_b16 a[140:141], v7 offset:20480
ds_read_b64_tr_b16 a[142:143], v7 offset:20992
ds_read_b64_tr_b16 a[144:145], v7 offset:24576
ds_read_b64_tr_b16 a[146:147], v7 offset:25088
ds_read_b64_tr_b16 a[148:149], v7 offset:28672
ds_read_b64_tr_b16 a[150:151], v7 offset:29184
ds_read_b64_tr_b16 a[152:153], v7 offset:32768
ds_read_b64_tr_b16 a[154:155], v7 offset:33280
ds_read_b64_tr_b16 a[156:157], v7 offset:36864
ds_read_b64_tr_b16 a[158:159], v7 offset:37376
s_waitcnt vmcnt(0) lgkmcnt(0)
s_barrier
ds_read_b64_tr_b16 a[160:161], v11 offset:0
ds_read_b64_tr_b16 a[162:163], v11 offset:5120
ds_read_b64_tr_b16 a[164:165], v11 offset:40960
ds_read_b64_tr_b16 a[166:167], v11 offset:46080
ds_read_b64_tr_b16 a[168:169], v11 offset:32
ds_read_b64_tr_b16 a[170:171], v11 offset:5152
ds_read_b64_tr_b16 a[172:173], v11 offset:40992
ds_read_b64_tr_b16 a[174:175], v11 offset:46112
ds_read_b64_tr_b16 a[176:177], v11 offset:64
ds_read_b64_tr_b16 a[178:179], v11 offset:5184
ds_read_b64_tr_b16 a[180:181], v11 offset:41024
ds_read_b64_tr_b16 a[182:183], v11 offset:46144
ds_read_b64_tr_b16 a[184:185], v11 offset:96
ds_read_b64_tr_b16 a[186:187], v11 offset:5216
ds_read_b64_tr_b16 a[188:189], v11 offset:41056
ds_read_b64_tr_b16 a[190:191], v11 offset:46176
ds_read_b64_tr_b16 a[192:193], v11 offset:128
ds_read_b64_tr_b16 a[194:195], v11 offset:5248
ds_read_b64_tr_b16 a[196:197], v11 offset:41088
ds_read_b64_tr_b16 a[198:199], v11 offset:46208
ds_read_b64_tr_b16 a[200:201], v11 offset:160
ds_read_b64_tr_b16 a[202:203], v11 offset:5280
ds_read_b64_tr_b16 a[204:205], v11 offset:41120
ds_read_b64_tr_b16 a[206:207], v11 offset:46240
ds_read_b64_tr_b16 a[208:209], v11 offset:192
ds_read_b64_tr_b16 a[210:211], v11 offset:5312
ds_read_b64_tr_b16 a[212:213], v11 offset:41152
ds_read_b64_tr_b16 a[214:215], v11 offset:46272
ds_read_b64_tr_b16 a[216:217], v11 offset:224
ds_read_b64_tr_b16 a[218:219], v11 offset:5344
ds_read_b64_tr_b16 a[220:221], v11 offset:41184
ds_read_b64_tr_b16 a[222:223], v11 offset:46304
ds_read_b64_tr_b16 a[224:225], v11 offset:256
ds_read_b64_tr_b16 a[226:227], v11 offset:5376
ds_read_b64_tr_b16 a[228:229], v11 offset:41216
ds_read_b64_tr_b16 a[230:231], v11 offset:46336
ds_read_b64_tr_b16 a[232:233], v11 offset:288
ds_read_b64_tr_b16 a[234:235], v11 offset:5408
ds_read_b64_tr_b16 a[236:237], v11 offset:41248
ds_read_b64_tr_b16 a[238:239], v11 offset:46368
s_waitcnt lgkmcnt(0)
v_mov_b32 v20, 0
ds_write_b32 v12, v20 offset:8192
v_mul_u32_u24 v30, 5462, v1
v_lshrrev_b32 v30, 16, v30
v_lshl_add_u32 v14, v30, 6, v8
v_add_u32 v31, 64, v1
v_mul_u32_u24 v30, 5462, v31
v_lshrrev_b32 v30, 16, v30
v_lshlrev_b32 v31, 4, v31
v_lshl_add_u32 v15, v30, 6, v31
v_cmp_gt_u32 vcc, 16, v1
s_lshl_b32 s55, s3, 11
v_add_u32 v16, s55, v8
v_cndmask_b32 v15, v255, v15, vcc
v_lshl_add_u32 v17, v3, 4, s55
s_lshl_b32 s55, s3, 5
v_lshl_add_u32 v18, v2, 1, s55
v_lshrrev_b32 v30, 2, v2
v_lshlrev_b32 v31, 4, v3
v_add_u32 v32, 128, v31
v_cmp_eq_u32 vcc, 0, v30
s_nop 1
v_cndmask_b32 v232, v32, v31, vcc
v_cmp_eq_u32 vcc, 1, v30
s_nop 1
v_cndmask_b32 v233, v32, v31, vcc
v_cmp_eq_u32 vcc, 2, v30
s_nop 1
v_cndmask_b32 v234, v32, v31, vcc
v_cmp_eq_u32 vcc, 3, v30
s_nop 1
v_cndmask_b32 v235, v32, v31, vcc
v_lshrrev_b32 v30, 5, v1
v_and_b32 v31, 31, v1
v_lshlrev_b32 v31, 2, v31
v_lshl_add_u32 v236, v30, 12, v31
v_cmp_gt_u32 vcc, 32, v1
s_mul_i32 s46, s3, 20480
s_lshl_b32 s55, s44, 7
s_add_u32 s46, s46, s55
s_add_u32 s46, s46, 720896
v_cndmask_b32 v237, v255, v236, vcc
s_add_u32 s47, s46, 8192
s_add_u32 s48, s46, 16384
s_mov_b32 s54, 0xffffff00
s_waitcnt lgkmcnt(0)
s_barrier
v_and_b32 v30, 31, v1
v_lshlrev_b32 v30, 7, v30
s_mov_b32 s55, 393216
L_m_cp:
buffer_load_dwordx4 v[20:23], v30, s[4:7], s55 offen sc1
s_waitcnt vmcnt(0)
v_cmp_ne_u32 vcc, s40, v22
s_add_u32 s97, s97, 1
s_cmp_gt_u32 s97, 65536
s_cbranch_scc1 L_m_cok
s_cbranch_vccnz L_m_cp
L_m_cok:
v_max_f32_dpp v24, v20, v20 row_ror:8 row_mask:0xf bank_mask:0xf
s_nop 1
v_max_f32_dpp v24, v24, v24 row_ror:4 row_mask:0xf bank_mask:0xf
s_nop 1
v_max_f32_dpp v24, v24, v24 row_ror:2 row_mask:0xf bank_mask:0xf
s_nop 1
v_max_f32_dpp v24, v24, v24 row_ror:1 row_mask:0xf bank_mask:0xf
v_mov_b32 v25, v24
s_nop 1
v_permlane16_swap_b32 v24, v25
v_max_f32 v24, v24, v25
v_cmp_eq_f32 vcc, v24, v20
s_ff1_i32_b64 s45, vcc
s_and_b32 s45, s45, 31
s_lshl_b32 s55, s45, 11
s_add_u32 s55, s55, 458752
L_m_rp:
buffer_load_dwordx4 v[20:23], v14, s[4:7], s55 offen sc1
buffer_load_dwordx4 v[24:27], v15, s[4:7], s55 offen sc1
s_waitcnt vmcnt(0)
ds_write_b128 v16, v[20:23]
ds_write_b128 v16, v[24:27] offset:1024
v_max3_u32 v28, v20, v21, v22
v_max3_u32 v29, v23, v24, v25
v_max3_u32 v28, v28, v26, v27
v_max_u32 v28, v28, v29
v_cmp_eq_u32 vcc, -1, v28
s_add_u32 s97, s97, 1
s_cmp_gt_u32 s97, 65536
s_cbranch_scc1 L_m_rok
s_cbranch_vccnz L_m_rp
L_m_rok:
ds_read_b128 v[100:103], v17 offset:0
ds_read_b128 v[104:107], v17 offset:64
ds_read_b128 v[108:111], v17 offset:128
ds_read_b128 v[112:115], v17 offset:192
ds_read_b128 v[116:119], v17 offset:256
ds_read_b128 v[120:123], v17 offset:320
s_waitcnt lgkmcnt(5)
v_mfma_f32_16x16x32_bf16 v[32:35], v[100:103], a[0:3], 0
ds_read_b128 v[124:127], v17 offset:384
v_mfma_f32_16x16x32_bf16 v[36:39], v[100:103], a[80:83], 0
s_waitcnt lgkmcnt(5)
v_mfma_f32_16x16x32_bf16 v[32:35], v[104:107], a[4:7], v[32:35]
ds_read_b128 v[128:131], v17 offset:448
v_mfma_f32_16x16x32_bf16 v[36:39], v[104:107], a[84:87], v[36:39]
s_waitcnt lgkmcnt(5)
v_mfma_f32_16x16x32_bf16 v[32:35], v[108:111], a[8:11], v[32:35]
ds_read_b128 v[132:135], v17 offset:512
v_mfma_f32_16x16x32_bf16 v[36:39], v[108:111], a[88:91], v[36:39]
s_waitcnt lgkmcnt(5)
v_mfma_f32_16x16x32_bf16 v[32:35], v[112:115], a[12:15], v[32:35]
ds_read_b128 v[136:139], v17 offset:576
v_mfma_f32_16x16x32_bf16 v[36:39], v[112:115], a[92:95], v[36:39]
s_waitcnt lgkmcnt(5)
v_mfma_f32_16x16x32_bf16 v[32:35], v[116:119], a[16:19], v[32:35]
ds_read_b128 v[140:143], v17 offset:640
v_mfma_f32_16x16x32_bf16 v[36:39], v[116:119], a[96:99], v[36:39]
s_waitcnt lgkmcnt(5)
v_mfma_f32_16x16x32_bf16 v[32:35], v[120:123], a[20:23], v[32:35]
ds_read_b128 v[144:147], v17 offset:704
v_mfma_f32_16x16x32_bf16 v[36:39], v[120:123], a[100:103], v[36:39]
s_waitcnt lgkmcnt(5)
v_mfma_f32_16x16x32_bf16 v[32:35], v[124:127], a[24:27], v[32:35]
ds_read_b128 v[148:151], v17 offset:768
v_mfma_f32_16x16x32_bf16 v[36:39], v[124:127], a[104:107], v[36:39]
s_waitcnt lgkmcnt(5)
v_mfma_f32_16x16x32_bf16 v[32:35], v[128:131], a[28:31], v[32:35]
ds_read_b128 v[152:155], v17 offset:832
v_mfma_f32_16x16x32_bf16 v[36:39], v[128:131], a[108:111], v[36:39]
s_waitcnt lgkmcnt(5)
v_mfma_f32_16x16x32_bf16 v[32:35], v[132:135], a[32:35], v[32:35]
ds_read_b128 v[156:159], v17 offset:896
v_mfma_f32_16x16x32_bf16 v[36:39], v[132:135], a[112:115], v[36:39]
s_waitcnt lgkmcnt(5)
v_mfma_f32_16x16x32_bf16 v[32:35], v[136:139], a[36:39], v[32:35]
ds_read_b128 v[160:163], v17 offset:960
v_mfma_f32_16x16x32_bf16 v[36:39], v[136:139], a[116:119], v[36:39]
s_waitcnt lgkmcnt(5)
v_mfma_f32_16x16x32_bf16 v[32:35], v[140:143], a[40:43], v[32:35]
ds_read_b128 v[164:167], v17 offset:1024
v_mfma_f32_16x16x32_bf16 v[36:39], v[140:143], a[120:123], v[36:39]
s_waitcnt lgkmcnt(5)
v_mfma_f32_16x16x32_bf16 v[32:35], v[144:147], a[44:47], v[32:35]
ds_read_b128 v[168:171], v17 offset:1088
v_mfma_f32_16x16x32_bf16 v[36:39], v[144:147], a[124:127], v[36:39]
s_waitcnt lgkmcnt(5)
v_mfma_f32_16x16x32_bf16 v[32:35], v[148:151], a[48:51], v[32:35]
ds_read_b128 v[172:175], v17 offset:1152
v_mfma_f32_16x16x32_bf16 v[36:39], v[148:151], a[128:131], v[36:39]
s_waitcnt lgkmcnt(5)
v_mfma_f32_16x16x32_bf16 v[32:35], v[152:155], a[52:55], v[32:35]
ds_read_b128 v[176:179], v17 offset:1216
v_mfma_f32_16x16x32_bf16 v[36:39], v[152:155], a[132:135], v[36:39]
s_waitcnt lgkmcnt(5)
v_mfma_f32_16x16x32_bf16 v[32:35], v[156:159], a[56:59], v[32:35]
v_mfma_f32_16x16x32_bf16 v[36:39], v[156:159], a[136:139], v[36:39]
s_waitcnt lgkmcnt(4)
v_mfma_f32_16x16x32_bf16 v[32:35], v[160:163], a[60:63], v[32:35]
v_mfma_f32_16x16x32_bf16 v[36:39], v[160:163], a[140:143], v[36:39]
s_waitcnt lgkmcnt(3)
v_mfma_f32_16x16x32_bf16 v[32:35], v[164:167], a[64:67], v[32:35]
v_mfma_f32_16x16x32_bf16 v[36:39], v[164:167], a[144:147], v[36:39]
s_waitcnt lgkmcnt(2)
v_mfma_f32_16x16x32_bf16 v[32:35], v[168:171], a[68:71], v[32:35]
v_mfma_f32_16x16x32_bf16 v[36:39], v[168:171], a[148:151], v[36:39]
s_waitcnt lgkmcnt(1)
v_mfma_f32_16x16x32_bf16 v[32:35], v[172:175], a[72:75], v[32:35]
v_mfma_f32_16x16x32_bf16 v[36:39], v[172:175], a[152:155], v[36:39]
s_waitcnt lgkmcnt(0)
v_mfma_f32_16x16x32_bf16 v[32:35], v[176:179], a[76:79], v[32:35]
v_mfma_f32_16x16x32_bf16 v[36:39], v[176:179], a[156:159], v[36:39]
s_nop 6
v_mul_f32 v33, 0xbfb8aa3b, v32
v_exp_f32 v33, v33
s_nop 0
v_add_f32 v33, 1.0, v33
v_rcp_f32 v33, v33
s_nop 0
v_mul_f32 v32, v32, v33
v_mul_f32 v32, v32, v36
v_cvt_pk_bf16_f32 v32, v32, v32
ds_write_b16 v18, v32 offset:8192
s_waitcnt lgkmcnt(0)
s_barrier
ds_read_b128 v[40:43], v232 offset:8192
ds_read_b128 v[44:47], v232 offset:8256
ds_read_b128 v[48:51], v233 offset:8192
ds_read_b128 v[52:55], v233 offset:8256
ds_read_b128 v[56:59], v234 offset:8192
ds_read_b128 v[60:63], v234 offset:8256
ds_read_b128 v[64:67], v235 offset:8192
ds_read_b128 v[68:71], v235 offset:8256
s_waitcnt lgkmcnt(6)
v_mfma_f32_16x16x32_bf16 v[20:23], v[40:43], a[160:163], 0
v_mfma_f32_16x16x32_bf16 v[20:23], v[44:47], a[164:167], v[20:23]
s_waitcnt lgkmcnt(4)
v_mfma_f32_16x16x32_bf16 v[20:23], v[48:51], a[168:171], v[20:23]
v_mfma_f32_16x16x32_bf16 v[20:23], v[52:55], a[172:175], v[20:23]
s_waitcnt lgkmcnt(2)
v_mfma_f32_16x16x32_bf16 v[20:23], v[56:59], a[176:179], v[20:23]
v_mfma_f32_16x16x32_bf16 v[20:23], v[60:63], a[180:183], v[20:23]
s_waitcnt lgkmcnt(0)
v_mfma_f32_16x16x32_bf16 v[20:23], v[64:67], a[184:187], v[20:23]
v_mfma_f32_16x16x32_bf16 v[20:23], v[68:71], a[188:191], v[20:23]
v_mfma_f32_16x16x32_bf16 v[24:27], v[40:43], a[192:195], 0
v_mfma_f32_16x16x32_bf16 v[24:27], v[44:47], a[196:199], v[24:27]
v_mfma_f32_16x16x32_bf16 v[24:27], v[48:51], a[200:203], v[24:27]
v_mfma_f32_16x16x32_bf16 v[24:27], v[52:55], a[204:207], v[24:27]
v_mfma_f32_16x16x32_bf16 v[24:27], v[56:59], a[208:211], v[24:27]
v_mfma_f32_16x16x32_bf16 v[24:27], v[60:63], a[212:215], v[24:27]
v_mfma_f32_16x16x32_bf16 v[24:27], v[64:67], a[216:219], v[24:27]
v_mfma_f32_16x16x32_bf16 v[24:27], v[68:71], a[220:223], v[24:27]
v_mfma_f32_16x16x32_bf16 v[28:31], v[40:43], a[224:227], 0
v_mfma_f32_16x16x32_bf16 v[28:31], v[44:47], a[228:231], v[28:31]
v_mfma_f32_16x16x32_bf16 v[28:31], v[48:51], a[232:235], v[28:31]
v_mfma_f32_16x16x32_bf16 v[28:31], v[52:55], a[236:239], v[28:31]
v_and_or_b32 v20, v20, s54, v19
buffer_store_dword v20, v236, s[4:7], s46 offen sc1
s_nop 1
v_and_or_b32 v24, v24, s54, v19
buffer_store_dword v24, v236, s[4:7], s47 offen sc1
s_nop 1
v_and_or_b32 v28, v28, s54, v19
buffer_store_dword v28, v237, s[4:7], s48 offen sc1
s_branch L_fin
L_fz:
s_add_u32 s46, s44, 5
s_add_u32 s47, s44, 10
s_lshl_b32 s50, s44, 7
s_mul_i32 s55, s3, 61440
s_add_u32 s50, s50, s55
s_add_u32 s50, s50, 2560
s_add_u32 m0, s49, 0
s_nop 0
buffer_load_dwordx4 v4, s[16:19], s50 offen nt lds
s_add_u32 m0, m0, 4096
s_add_u32 s50, s50, 245760
buffer_load_dwordx4 v4, s[16:19], s50 offen nt lds
s_add_u32 m0, m0, 4096
s_add_u32 s50, s50, 245760
buffer_load_dwordx4 v4, s[16:19], s50 offen nt lds
s_add_u32 m0, m0, 4096
s_add_u32 s50, s50, 245760
buffer_load_dwordx4 v4, s[16:19], s50 offen nt lds
s_add_u32 m0, m0, 4096
s_add_u32 s50, s50, 245760
buffer_load_dwordx4 v4, s[16:19], s50 offen nt lds
s_add_u32 m0, m0, 4096
s_add_u32 s50, s50, 245760
buffer_load_dwordx4 v4, s[16:19], s50 offen nt lds
s_add_u32 m0, m0, 4096
s_add_u32 s50, s50, 245760
buffer_load_dwordx4 v4, s[16:19], s50 offen nt lds
s_add_u32 m0, m0, 4096
s_add_u32 s50, s50, 245760
buffer_load_dwordx4 v4, s[16:19], s50 offen nt lds
s_add_u32 m0, m0, 4096
s_add_u32 s50, s50, 245760
buffer_load_dwordx4 v4, s[16:19], s50 offen nt lds
s_add_u32 m0, m0, 4096
s_add_u32 s50, s50, 245760
buffer_load_dwordx4 v4, s[16:19], s50 offen nt lds
s_add_u32 m0, m0, 4096
s_add_u32 s50, s50, 245760
buffer_load_dwordx4 v4, s[16:19], s50 offen nt lds
s_add_u32 m0, m0, 4096
s_add_u32 s50, s50, 245760
buffer_load_dwordx4 v4, s[16:19], s50 offen nt lds
s_add_u32 m0, m0, 4096
s_add_u32 s50, s50, 245760
buffer_load_dwordx4 v4, s[16:19], s50 offen nt lds
s_add_u32 m0, m0, 4096
s_add_u32 s50, s50, 245760
buffer_load_dwordx4 v4, s[16:19], s50 offen nt lds
s_add_u32 m0, m0, 4096
s_add_u32 s50, s50, 245760
buffer_load_dwordx4 v4, s[16:19], s50 offen nt lds
s_add_u32 m0, m0, 4096
s_add_u32 s50, s50, 245760
buffer_load_dwordx4 v4, s[16:19], s50 offen nt lds
s_add_u32 m0, m0, 4096
s_add_u32 s50, s50, 245760
buffer_load_dwordx4 v4, s[16:19], s50 offen nt lds
s_add_u32 m0, m0, 4096
s_add_u32 s50, s50, 245760
buffer_load_dwordx4 v4, s[16:19], s50 offen nt lds
s_add_u32 m0, m0, 4096
s_add_u32 s50, s50, 245760
buffer_load_dwordx4 v4, s[16:19], s50 offen nt lds
s_add_u32 m0, m0, 4096
s_add_u32 s50, s50, 245760
buffer_load_dwordx4 v4, s[16:19], s50 offen nt lds
s_waitcnt vmcnt(20)
v_readfirstlane_b32 s41, v42
v_lshlrev_b32 v44, 16, v40
v_and_b32 v45, 0xffff0000, v40
v_lshlrev_b32 v46, 16, v41
v_and_b32 v47, 0xffff0000, v41
v_mul_f32 v48, 0xbfb8aa3b, v44
v_mul_f32 v49, 0xbfb8aa3b, v45
v_mul_f32 v50, 0xbfb8aa3b, v46
v_mul_f32 v51, 0xbfb8aa3b, v47
v_exp_f32 v48, v48
v_exp_f32 v49, v49
v_exp_f32 v50, v50
v_exp_f32 v51, v51
v_add_f32 v48, 1.0, v48
v_add_f32 v49, 1.0, v49
v_add_f32 v50, 1.0, v50
v_add_f32 v51, 1.0, v51
v_rcp_f32 v48, v48
v_rcp_f32 v49, v49
v_rcp_f32 v50, v50
v_rcp_f32 v51, v51
v_mul_f32 v44, v44, v48
v_mul_f32 v45, v45, v49
v_mul_f32 v46, v46, v50
v_mul_f32 v47, v47, v51
v_cvt_pk_bf16_f32 v40, v44, v45
v_cvt_pk_bf16_f32 v41, v46, v47
v_add_u32 v28, 99840, v28
ds_write_b64 v28, v[40:41]
v_lshlrev_b32 v28, 4, v3
v_add_u32 v28, 99840, v28
s_mul_i32 s40, s41, 0x9E3779B1
s_add_u32 s40, s40, 0x85EBCA6B
v_and_b32 v31, 3, v1
v_lshlrev_b32 v30, 3, v31
v_lshrrev_b32 v19, v30, s40
v_and_b32 v19, 0xff, v19
v_mov_b32 v240, s40
v_mov_b32 v241, s40
v_mov_b32 v242, s40
v_mov_b32 v243, s40
v_and_b32 v30, 1, v1
v_lshlrev_b32 v30, 4, v30
v_lshrrev_b32 v13, v30, s40
v_and_b32 v13, 0xffff, v13
s_waitcnt lgkmcnt(0)
s_barrier
ds_read_b128 v[100:103], v28 offset:0
ds_read_b128 v[104:107], v28 offset:64
ds_read_b128 v[108:111], v28 offset:128
ds_read_b128 v[112:115], v28 offset:192
ds_read_b128 v[116:119], v28 offset:256
ds_read_b128 v[120:123], v28 offset:320
ds_read_b128 v[124:127], v28 offset:384
ds_read_b128 v[128:131], v28 offset:448
ds_read_b128 v[132:135], v28 offset:512
ds_read_b128 v[136:139], v28 offset:576
ds_read_b128 v[140:143], v28 offset:640
ds_read_b128 v[144:147], v28 offset:704
ds_read_b128 v[148:151], v28 offset:768
ds_read_b128 v[152:155], v28 offset:832
ds_read_b128 v[156:159], v28 offset:896
ds_read_b128 v[160:163], v28 offset:960
ds_read_b128 v[164:167], v28 offset:1024
ds_read_b128 v[168:171], v28 offset:1088
ds_read_b128 v[172:175], v28 offset:1152
ds_read_b128 v[176:179], v28 offset:1216
s_waitcnt lgkmcnt(0)
s_barrier
s_lshl_b32 s50, s46, 7
s_mul_i32 s55, s3, 61440
s_add_u32 s50, s50, s55
s_add_u32 s50, s50, 2560
s_add_u32 m0, s49, 81920
s_nop 0
buffer_load_dwordx4 v4, s[16:19], s50 offen nt lds
s_add_u32 m0, m0, 4096
s_add_u32 s50, s50, 245760
buffer_load_dwordx4 v4, s[16:19], s50 offen nt lds
s_add_u32 m0, m0, 4096
s_add_u32 s50, s50, 245760
buffer_load_dwordx4 v4, s[16:19], s50 offen nt lds
s_add_u32 m0, m0, 4096
s_add_u32 s50, s50, 245760
buffer_load_dwordx4 v4, s[16:19], s50 offen nt lds
s_add_u32 m0, m0, 4096
s_add_u32 s50, s50, 245760
buffer_load_dwordx4 v4, s[16:19], s50 offen nt lds
s_add_u32 m0, m0, 4096
s_add_u32 s50, s50, 245760
buffer_load_dwordx4 v4, s[16:19], s50 offen nt lds
s_add_u32 m0, m0, 4096
s_add_u32 s50, s50, 245760
buffer_load_dwordx4 v4, s[16:19], s50 offen nt lds
s_add_u32 m0, m0, 4096
s_add_u32 s50, s50, 245760
buffer_load_dwordx4 v4, s[16:19], s50 offen nt lds
s_add_u32 m0, m0, 4096
s_add_u32 s50, s50, 245760
buffer_load_dwordx4 v4, s[16:19], s50 offen nt lds
s_add_u32 m0, m0, 4096
s_add_u32 s50, s50, 245760
buffer_load_dwordx4 v4, s[16:19], s50 offen nt lds
s_add_u32 m0, m0, 4096
s_add_u32 s50, s50, 245760
buffer_load_dwordx4 v4, s[16:19], s50 offen nt lds
s_add_u32 m0, m0, 4096
s_add_u32 s50, s50, 245760
buffer_load_dwordx4 v4, s[16:19], s50 offen nt lds
s_add_u32 m0, m0, 4096
s_add_u32 s50, s50, 245760
buffer_load_dwordx4 v4, s[16:19], s50 offen nt lds
s_add_u32 m0, m0, 4096
s_add_u32 s50, s50, 245760
buffer_load_dwordx4 v4, s[16:19], s50 offen nt lds
s_add_u32 m0, m0, 4096
s_add_u32 s50, s50, 245760
buffer_load_dwordx4 v4, s[16:19], s50 offen nt lds
s_add_u32 m0, m0, 4096
s_add_u32 s50, s50, 245760
buffer_load_dwordx4 v4, s[16:19], s50 offen nt lds
s_add_u32 m0, m0, 4096
s_add_u32 s50, s50, 245760
buffer_load_dwordx4 v4, s[16:19], s50 offen nt lds
s_add_u32 m0, m0, 4096
s_add_u32 s50, s50, 245760
buffer_load_dwordx4 v4, s[16:19], s50 offen nt lds
s_add_u32 m0, m0, 4096
s_add_u32 s50, s50, 245760
buffer_load_dwordx4 v4, s[16:19], s50 offen nt lds
s_add_u32 m0, m0, 4096
s_add_u32 s50, s50, 245760
buffer_load_dwordx4 v4, s[16:19], s50 offen nt lds
s_waitcnt vmcnt(20)
s_barrier
ds_read_b64_tr_b16 v[20:21], v6 offset:0
ds_read_b64_tr_b16 v[22:23], v6 offset:512
ds_read_b64_tr_b16 v[24:25], v6 offset:4096
ds_read_b64_tr_b16 v[26:27], v6 offset:4608
ds_read_b64_tr_b16 v[28:29], v6 offset:8192
ds_read_b64_tr_b16 v[30:31], v6 offset:8704
ds_read_b64_tr_b16 v[32:33], v6 offset:12288
ds_read_b64_tr_b16 v[34:35], v6 offset:12800
ds_read_b64_tr_b16 v[36:37], v6 offset:16384
ds_read_b64_tr_b16 v[38:39], v6 offset:16896
ds_read_b64_tr_b16 v[40:41], v6 offset:20480
ds_read_b64_tr_b16 v[42:43], v6 offset:20992
ds_read_b64_tr_b16 v[44:45], v6 offset:24576
ds_read_b64_tr_b16 v[46:47], v6 offset:25088
ds_read_b64_tr_b16 v[48:49], v6 offset:28672
ds_read_b64_tr_b16 v[50:51], v6 offset:29184
ds_read_b64_tr_b16 v[52:53], v6 offset:32768
ds_read_b64_tr_b16 v[54:55], v6 offset:33280
ds_read_b64_tr_b16 v[56:57], v6 offset:36864
ds_read_b64_tr_b16 v[58:59], v6 offset:37376
ds_read_b64_tr_b16 v[60:61], v7 offset:0
ds_read_b64_tr_b16 v[62:63], v7 offset:512
ds_read_b64_tr_b16 v[64:65], v7 offset:4096
ds_read_b64_tr_b16 v[66:67], v7 offset:4608
ds_read_b64_tr_b16 v[68:69], v7 offset:8192
ds_read_b64_tr_b16 v[70:71], v7 offset:8704
ds_read_b64_tr_b16 v[72:73], v7 offset:12288
ds_read_b64_tr_b16 v[74:75], v7 offset:12800
ds_read_b64_tr_b16 v[76:77], v7 offset:16384
ds_read_b64_tr_b16 v[78:79], v7 offset:16896
ds_read_b64_tr_b16 v[80:81], v7 offset:20480
ds_read_b64_tr_b16 v[82:83], v7 offset:20992
ds_read_b64_tr_b16 v[84:85], v7 offset:24576
ds_read_b64_tr_b16 v[86:87], v7 offset:25088
ds_read_b64_tr_b16 v[88:89], v7 offset:28672
ds_read_b64_tr_b16 v[90:91], v7 offset:29184
ds_read_b64_tr_b16 v[92:93], v7 offset:32768
ds_read_b64_tr_b16 v[94:95], v7 offset:33280
ds_read_b64_tr_b16 v[96:97], v7 offset:36864
ds_read_b64_tr_b16 v[98:99], v7 offset:37376
s_waitcnt lgkmcnt(0)
s_barrier
v_mfma_f32_16x16x32_bf16 v[180:183], v[100:103], v[20:23], 0
v_mfma_f32_16x16x32_bf16 v[180:183], v[104:107], v[24:27], v[180:183]
v_mfma_f32_16x16x32_bf16 v[180:183], v[108:111], v[28:31], v[180:183]
v_mfma_f32_16x16x32_bf16 v[180:183], v[112:115], v[32:35], v[180:183]
v_mfma_f32_16x16x32_bf16 v[180:183], v[116:119], v[36:39], v[180:183]
v_mfma_f32_16x16x32_bf16 v[180:183], v[120:123], v[40:43], v[180:183]
v_mfma_f32_16x16x32_bf16 v[180:183], v[124:127], v[44:47], v[180:183]
v_mfma_f32_16x16x32_bf16 v[180:183], v[128:131], v[48:51], v[180:183]
v_mfma_f32_16x16x32_bf16 v[180:183], v[132:135], v[52:55], v[180:183]
v_mfma_f32_16x16x32_bf16 v[180:183], v[136:139], v[56:59], v[180:183]
v_mfma_f32_16x16x32_bf16 v[180:183], v[140:143], v[60:63], v[180:183]
v_mfma_f32_16x16x32_bf16 v[180:183], v[144:147], v[64:67], v[180:183]
v_mfma_f32_16x16x32_bf16 v[180:183], v[148:151], v[68:71], v[180:183]
v_mfma_f32_16x16x32_bf16 v[180:183], v[152:155], v[72:75], v[180:183]
v_mfma_f32_16x16x32_bf16 v[180:183], v[156:159], v[76:79], v[180:183]
v_mfma_f32_16x16x32_bf16 v[180:183], v[160:163], v[80:83], v[180:183]
v_mfma_f32_16x16x32_bf16 v[180:183], v[164:167], v[84:87], v[180:183]
v_mfma_f32_16x16x32_bf16 v[180:183], v[168:171], v[88:91], v[180:183]
v_mfma_f32_16x16x32_bf16 v[180:183], v[172:175], v[92:95], v[180:183]
v_mfma_f32_16x16x32_bf16 v[180:183], v[176:179], v[96:99], v[180:183]
s_sub_u32 s55, s44, 20
s_cmp_lt_u32 s55, 10
s_cselect_b32 s55, 1.0, 0
s_lshl_b32 s56, s44, 8
s_lshl_b32 s57, s3, 6
s_add_u32 s56, s56, s57
s_add_u32 s56, s56, 65536
s_nop 0
v_cvt_pk_bf16_f32 v180, v180, v180
v_lshlrev_b32 v180, 16, v180
v_add_f32 v180, s55, v180
v_cvt_pk_bf16_f32 v180, v180, v180
v_lshl_or_b32 v180, v180, 16, v13
s_mov_b64 exec, 0xffff
buffer_store_dword v180, v12, s[4:7], s56 offen sc1
s_mov_b64 exec, -1
s_cmp_lt_u32 s47, 40
s_cselect_b32 s18, s18, 0
s_lshl_b32 s50, s47, 7
s_mul_i32 s55, s3, 61440
s_add_u32 s50, s50, s55
s_add_u32 s50, s50, 2560
s_add_u32 m0, s49, 0
s_nop 0
buffer_load_dwordx4 v4, s[16:19], s50 offen nt lds
s_add_u32 m0, m0, 4096
s_add_u32 s50, s50, 245760
buffer_load_dwordx4 v4, s[16:19], s50 offen nt lds
s_add_u32 m0, m0, 4096
s_add_u32 s50, s50, 245760
buffer_load_dwordx4 v4, s[16:19], s50 offen nt lds
s_add_u32 m0, m0, 4096
s_add_u32 s50, s50, 245760
buffer_load_dwordx4 v4, s[16:19], s50 offen nt lds
s_add_u32 m0, m0, 4096
s_add_u32 s50, s50, 245760
buffer_load_dwordx4 v4, s[16:19], s50 offen nt lds
s_add_u32 m0, m0, 4096
s_add_u32 s50, s50, 245760
buffer_load_dwordx4 v4, s[16:19], s50 offen nt lds
s_add_u32 m0, m0, 4096
s_add_u32 s50, s50, 245760
buffer_load_dwordx4 v4, s[16:19], s50 offen nt lds
s_add_u32 m0, m0, 4096
s_add_u32 s50, s50, 245760
buffer_load_dwordx4 v4, s[16:19], s50 offen nt lds
s_add_u32 m0, m0, 4096
s_add_u32 s50, s50, 245760
buffer_load_dwordx4 v4, s[16:19], s50 offen nt lds
s_add_u32 m0, m0, 4096
s_add_u32 s50, s50, 245760
buffer_load_dwordx4 v4, s[16:19], s50 offen nt lds
s_add_u32 m0, m0, 4096
s_add_u32 s50, s50, 245760
buffer_load_dwordx4 v4, s[16:19], s50 offen nt lds
s_add_u32 m0, m0, 4096
s_add_u32 s50, s50, 245760
buffer_load_dwordx4 v4, s[16:19], s50 offen nt lds
s_add_u32 m0, m0, 4096
s_add_u32 s50, s50, 245760
buffer_load_dwordx4 v4, s[16:19], s50 offen nt lds
s_add_u32 m0, m0, 4096
s_add_u32 s50, s50, 245760
buffer_load_dwordx4 v4, s[16:19], s50 offen nt lds
s_add_u32 m0, m0, 4096
s_add_u32 s50, s50, 245760
buffer_load_dwordx4 v4, s[16:19], s50 offen nt lds
s_add_u32 m0, m0, 4096
s_add_u32 s50, s50, 245760
buffer_load_dwordx4 v4, s[16:19], s50 offen nt lds
s_add_u32 m0, m0, 4096
s_add_u32 s50, s50, 245760
buffer_load_dwordx4 v4, s[16:19], s50 offen nt lds
s_add_u32 m0, m0, 4096
s_add_u32 s50, s50, 245760
buffer_load_dwordx4 v4, s[16:19], s50 offen nt lds
s_add_u32 m0, m0, 4096
s_add_u32 s50, s50, 245760
buffer_load_dwordx4 v4, s[16:19], s50 offen nt lds
s_add_u32 m0, m0, 4096
s_add_u32 s50, s50, 245760
buffer_load_dwordx4 v4, s[16:19], s50 offen nt lds
s_waitcnt vmcnt(21)
s_barrier
ds_read_b64_tr_b16 v[20:21], v9 offset:0
ds_read_b64_tr_b16 v[22:23], v9 offset:512
ds_read_b64_tr_b16 v[24:25], v9 offset:4096
ds_read_b64_tr_b16 v[26:27], v9 offset:4608
ds_read_b64_tr_b16 v[28:29], v9 offset:8192
ds_read_b64_tr_b16 v[30:31], v9 offset:8704
ds_read_b64_tr_b16 v[32:33], v9 offset:12288
ds_read_b64_tr_b16 v[34:35], v9 offset:12800
ds_read_b64_tr_b16 v[36:37], v9 offset:16384
ds_read_b64_tr_b16 v[38:39], v9 offset:16896
ds_read_b64_tr_b16 v[40:41], v9 offset:20480
ds_read_b64_tr_b16 v[42:43], v9 offset:20992
ds_read_b64_tr_b16 v[44:45], v9 offset:24576
ds_read_b64_tr_b16 v[46:47], v9 offset:25088
ds_read_b64_tr_b16 v[48:49], v9 offset:28672
ds_read_b64_tr_b16 v[50:51], v9 offset:29184
ds_read_b64_tr_b16 v[52:53], v9 offset:32768
ds_read_b64_tr_b16 v[54:55], v9 offset:33280
ds_read_b64_tr_b16 v[56:57], v9 offset:36864
ds_read_b64_tr_b16 v[58:59], v9 offset:37376
ds_read_b64_tr_b16 v[60:61], v10 offset:0
ds_read_b64_tr_b16 v[62:63], v10 offset:512
ds_read_b64_tr_b16 v[64:65], v10 offset:4096
ds_read_b64_tr_b16 v[66:67], v10 offset:4608
ds_read_b64_tr_b16 v[68:69], v10 offset:8192
ds_read_b64_tr_b16 v[70:71], v10 offset:8704
ds_read_b64_tr_b16 v[72:73], v10 offset:12288
ds_read_b64_tr_b16 v[74:75], v10 offset:12800
ds_read_b64_tr_b16 v[76:77], v10 offset:16384
ds_read_b64_tr_b16 v[78:79], v10 offset:16896
ds_read_b64_tr_b16 v[80:81], v10 offset:20480
ds_read_b64_tr_b16 v[82:83], v10 offset:20992
ds_read_b64_tr_b16 v[84:85], v10 offset:24576
ds_read_b64_tr_b16 v[86:87], v10 offset:25088
ds_read_b64_tr_b16 v[88:89], v10 offset:28672
ds_read_b64_tr_b16 v[90:91], v10 offset:29184
ds_read_b64_tr_b16 v[92:93], v10 offset:32768
ds_read_b64_tr_b16 v[94:95], v10 offset:33280
ds_read_b64_tr_b16 v[96:97], v10 offset:36864
ds_read_b64_tr_b16 v[98:99], v10 offset:37376
s_waitcnt lgkmcnt(0)
s_barrier
v_mfma_f32_16x16x32_bf16 v[180:183], v[100:103], v[20:23], 0
v_mfma_f32_16x16x32_bf16 v[180:183], v[104:107], v[24:27], v[180:183]
v_mfma_f32_16x16x32_bf16 v[180:183], v[108:111], v[28:31], v[180:183]
v_mfma_f32_16x16x32_bf16 v[180:183], v[112:115], v[32:35], v[180:183]
v_mfma_f32_16x16x32_bf16 v[180:183], v[116:119], v[36:39], v[180:183]
v_mfma_f32_16x16x32_bf16 v[180:183], v[120:123], v[40:43], v[180:183]
v_mfma_f32_16x16x32_bf16 v[180:183], v[124:127], v[44:47], v[180:183]
v_mfma_f32_16x16x32_bf16 v[180:183], v[128:131], v[48:51], v[180:183]
v_mfma_f32_16x16x32_bf16 v[180:183], v[132:135], v[52:55], v[180:183]
v_mfma_f32_16x16x32_bf16 v[180:183], v[136:139], v[56:59], v[180:183]
v_mfma_f32_16x16x32_bf16 v[180:183], v[140:143], v[60:63], v[180:183]
v_mfma_f32_16x16x32_bf16 v[180:183], v[144:147], v[64:67], v[180:183]
v_mfma_f32_16x16x32_bf16 v[180:183], v[148:151], v[68:71], v[180:183]
v_mfma_f32_16x16x32_bf16 v[180:183], v[152:155], v[72:75], v[180:183]
v_mfma_f32_16x16x32_bf16 v[180:183], v[156:159], v[76:79], v[180:183]
v_mfma_f32_16x16x32_bf16 v[180:183], v[160:163], v[80:83], v[180:183]
v_mfma_f32_16x16x32_bf16 v[180:183], v[164:167], v[84:87], v[180:183]
v_mfma_f32_16x16x32_bf16 v[180:183], v[168:171], v[88:91], v[180:183]
v_mfma_f32_16x16x32_bf16 v[180:183], v[172:175], v[92:95], v[180:183]
v_mfma_f32_16x16x32_bf16 v[180:183], v[176:179], v[96:99], v[180:183]
s_sub_u32 s55, s46, 20
s_cmp_lt_u32 s55, 10
s_cselect_b32 s55, 1.0, 0
s_lshl_b32 s56, s46, 8
s_lshl_b32 s57, s3, 6
s_add_u32 s56, s56, s57
s_add_u32 s56, s56, 65536
s_nop 0
v_cvt_pk_bf16_f32 v180, v180, v180
v_lshlrev_b32 v180, 16, v180
v_add_f32 v180, s55, v180
v_cvt_pk_bf16_f32 v180, v180, v180
v_lshl_or_b32 v180, v180, 16, v13
s_mov_b64 exec, 0xffff
buffer_store_dword v180, v12, s[4:7], s56 offen sc1
s_mov_b64 exec, -1
s_cmp_lt_u32 s47, 40
s_cbranch_scc0 L_fz_u
s_waitcnt vmcnt(1)
s_barrier
ds_read_b64_tr_b16 v[20:21], v6 offset:0
ds_read_b64_tr_b16 v[22:23], v6 offset:512
ds_read_b64_tr_b16 v[24:25], v6 offset:4096
ds_read_b64_tr_b16 v[26:27], v6 offset:4608
ds_read_b64_tr_b16 v[28:29], v6 offset:8192
ds_read_b64_tr_b16 v[30:31], v6 offset:8704
ds_read_b64_tr_b16 v[32:33], v6 offset:12288
ds_read_b64_tr_b16 v[34:35], v6 offset:12800
ds_read_b64_tr_b16 v[36:37], v6 offset:16384
ds_read_b64_tr_b16 v[38:39], v6 offset:16896
ds_read_b64_tr_b16 v[40:41], v6 offset:20480
ds_read_b64_tr_b16 v[42:43], v6 offset:20992
ds_read_b64_tr_b16 v[44:45], v6 offset:24576
ds_read_b64_tr_b16 v[46:47], v6 offset:25088
ds_read_b64_tr_b16 v[48:49], v6 offset:28672
ds_read_b64_tr_b16 v[50:51], v6 offset:29184
ds_read_b64_tr_b16 v[52:53], v6 offset:32768
ds_read_b64_tr_b16 v[54:55], v6 offset:33280
ds_read_b64_tr_b16 v[56:57], v6 offset:36864
ds_read_b64_tr_b16 v[58:59], v6 offset:37376
ds_read_b64_tr_b16 v[60:61], v7 offset:0
ds_read_b64_tr_b16 v[62:63], v7 offset:512
ds_read_b64_tr_b16 v[64:65], v7 offset:4096
ds_read_b64_tr_b16 v[66:67], v7 offset:4608
ds_read_b64_tr_b16 v[68:69], v7 offset:8192
ds_read_b64_tr_b16 v[70:71], v7 offset:8704
ds_read_b64_tr_b16 v[72:73], v7 offset:12288
ds_read_b64_tr_b16 v[74:75], v7 offset:12800
ds_read_b64_tr_b16 v[76:77], v7 offset:16384
ds_read_b64_tr_b16 v[78:79], v7 offset:16896
ds_read_b64_tr_b16 v[80:81], v7 offset:20480
ds_read_b64_tr_b16 v[82:83], v7 offset:20992
ds_read_b64_tr_b16 v[84:85], v7 offset:24576
ds_read_b64_tr_b16 v[86:87], v7 offset:25088
ds_read_b64_tr_b16 v[88:89], v7 offset:28672
ds_read_b64_tr_b16 v[90:91], v7 offset:29184
ds_read_b64_tr_b16 v[92:93], v7 offset:32768
ds_read_b64_tr_b16 v[94:95], v7 offset:33280
ds_read_b64_tr_b16 v[96:97], v7 offset:36864
ds_read_b64_tr_b16 v[98:99], v7 offset:37376
s_waitcnt lgkmcnt(0)
s_barrier
v_mfma_f32_16x16x32_bf16 v[180:183], v[100:103], v[20:23], 0
v_mfma_f32_16x16x32_bf16 v[180:183], v[104:107], v[24:27], v[180:183]
v_mfma_f32_16x16x32_bf16 v[180:183], v[108:111], v[28:31], v[180:183]
v_mfma_f32_16x16x32_bf16 v[180:183], v[112:115], v[32:35], v[180:183]
v_mfma_f32_16x16x32_bf16 v[180:183], v[116:119], v[36:39], v[180:183]
v_mfma_f32_16x16x32_bf16 v[180:183], v[120:123], v[40:43], v[180:183]
v_mfma_f32_16x16x32_bf16 v[180:183], v[124:127], v[44:47], v[180:183]
v_mfma_f32_16x16x32_bf16 v[180:183], v[128:131], v[48:51], v[180:183]
v_mfma_f32_16x16x32_bf16 v[180:183], v[132:135], v[52:55], v[180:183]
v_mfma_f32_16x16x32_bf16 v[180:183], v[136:139], v[56:59], v[180:183]
v_mfma_f32_16x16x32_bf16 v[180:183], v[140:143], v[60:63], v[180:183]
v_mfma_f32_16x16x32_bf16 v[180:183], v[144:147], v[64:67], v[180:183]
v_mfma_f32_16x16x32_bf16 v[180:183], v[148:151], v[68:71], v[180:183]
v_mfma_f32_16x16x32_bf16 v[180:183], v[152:155], v[72:75], v[180:183]
v_mfma_f32_16x16x32_bf16 v[180:183], v[156:159], v[76:79], v[180:183]
v_mfma_f32_16x16x32_bf16 v[180:183], v[160:163], v[80:83], v[180:183]
v_mfma_f32_16x16x32_bf16 v[180:183], v[164:167], v[84:87], v[180:183]
v_mfma_f32_16x16x32_bf16 v[180:183], v[168:171], v[88:91], v[180:183]
v_mfma_f32_16x16x32_bf16 v[180:183], v[172:175], v[92:95], v[180:183]
v_mfma_f32_16x16x32_bf16 v[180:183], v[176:179], v[96:99], v[180:183]
s_sub_u32 s55, s47, 20
s_cmp_lt_u32 s55, 10
s_cselect_b32 s55, 1.0, 0
s_lshl_b32 s56, s47, 8
s_lshl_b32 s57, s3, 6
s_add_u32 s56, s56, s57
s_add_u32 s56, s56, 65536
s_nop 0
v_cvt_pk_bf16_f32 v180, v180, v180
v_lshlrev_b32 v180, 16, v180
v_add_f32 v180, s55, v180
v_cvt_pk_bf16_f32 v180, v180, v180
v_lshl_or_b32 v180, v180, 16, v13
s_mov_b64 exec, 0xffff
buffer_store_dword v180, v12, s[4:7], s56 offen sc1
s_mov_b64 exec, -1
L_fz_u:
buffer_load_dword v191, v12, s[32:35], 0 offen
s_mov_b32 s55, 2621184
buffer_load_dword v192, v12, s[32:35], s55 offen
s_sub_u32 s46, s44, 27
s_lshl_b32 s46, s46, 2
s_add_u32 s46, s46, s3
v_cmp_gt_u32 vcc, 32, v1
v_lshlrev_b32 v14, 3, v1
v_and_b32 v15, 7, v1
v_cndmask_b32 v16, v255, v8, vcc
v_cndmask_b32 v250, 0, -1, vcc
v_lshlrev_b32 v15, 4, v15
s_mov_b32 s55, 68096
s_lshl_b32 s56, s46, 7
s_add_u32 s56, s56, 73216
s_mov_b32 s57, 0x05040100
buffer_load_dwordx2 v[44:45], v14, s[28:31], 0 offen
buffer_load_dwordx2 v[46:47], v14, s[28:31], 0 offen offset:512
buffer_load_dwordx2 v[48:49], v14, s[28:31], 0 offen offset:1024
L_fz_mp:
buffer_load_dwordx4 v[20:23], v8, s[4:7], s55 offen sc1
buffer_load_dwordx4 v[24:27], v8, s[4:7], s55 offen offset:1024 sc1
buffer_load_dwordx4 v[28:31], v16, s[4:7], s55 offen offset:2048 sc1
buffer_load_dwordx4 v[56:59], v15, s[4:7], s56 offen sc1
s_waitcnt vmcnt(0)
v_perm_b32 v32, v29, v28, s57
v_perm_b32 v33, v31, v30, s57
v_xor_b32 v32, s40, v32
v_xor_b32 v33, s40, v33
v_or_b32 v34, v32, v33
v_and_b32 v34, v34, v250
v_perm_b32 v32, v21, v20, s57
v_perm_b32 v33, v23, v22, s57
v_xor_b32 v32, s40, v32
v_xor_b32 v33, s40, v33
v_or3_b32 v34, v34, v32, v33
v_perm_b32 v32, v25, v24, s57
v_perm_b32 v33, v27, v26, s57
v_xor_b32 v32, s40, v32
v_xor_b32 v33, s40, v33
v_or3_b32 v34, v34, v32, v33
v_perm_b32 v32, v57, v56, s57
v_perm_b32 v33, v59, v58, s57
v_xor_b32 v32, s40, v32
v_xor_b32 v33, s40, v33
v_or3_b32 v34, v34, v32, v33
v_cmp_ne_u32 vcc, 0, v34
s_sleep 4
s_add_u32 s97, s97, 1
s_cmp_gt_u32 s97, 65536
s_cbranch_scc1 L_fz_mok
s_cbranch_vccnz L_fz_mp
L_fz_mok:
v_mov_b32 v60, 0
v_and_b32 v56, 0xffff0000, v56
v_and_b32 v57, 0xffff0000, v57
v_and_b32 v58, 0xffff0000, v58
v_and_b32 v59, 0xffff0000, v59
v_and_b32 v20, 0xffff0000, v20
v_lshlrev_b32 v32, 16, v44
v_fmac_f32 v60, v20, v32
v_and_b32 v21, 0xffff0000, v21
v_and_b32 v32, 0xffff0000, v44
v_fmac_f32 v60, v21, v32
v_and_b32 v22, 0xffff0000, v22
v_lshlrev_b32 v32, 16, v45
v_fmac_f32 v60, v22, v32
v_and_b32 v23, 0xffff0000, v23
v_and_b32 v32, 0xffff0000, v45
v_fmac_f32 v60, v23, v32
v_and_b32 v24, 0xffff0000, v24
v_lshlrev_b32 v32, 16, v46
v_fmac_f32 v60, v24, v32
v_and_b32 v25, 0xffff0000, v25
v_and_b32 v32, 0xffff0000, v46
v_fmac_f32 v60, v25, v32
v_and_b32 v26, 0xffff0000, v26
v_lshlrev_b32 v32, 16, v47
v_fmac_f32 v60, v26, v32
v_and_b32 v27, 0xffff0000, v27
v_and_b32 v32, 0xffff0000, v47
v_fmac_f32 v60, v27, v32
v_and_b32 v28, 0xffff0000, v28
v_lshlrev_b32 v32, 16, v48
v_fmac_f32 v60, v28, v32
v_and_b32 v29, 0xffff0000, v29
v_and_b32 v32, 0xffff0000, v48
v_fmac_f32 v60, v29, v32
v_and_b32 v30, 0xffff0000, v30
v_lshlrev_b32 v32, 16, v49
v_fmac_f32 v60, v30, v32
v_and_b32 v31, 0xffff0000, v31
v_and_b32 v32, 0xffff0000, v49
v_fmac_f32 v60, v31, v32
s_nop 1
v_add_f32_dpp v60, v60, v60 row_ror:8 row_mask:0xf bank_mask:0xf
s_nop 1
v_add_f32_dpp v60, v60, v60 row_ror:4 row_mask:0xf bank_mask:0xf
s_nop 1
v_add_f32_dpp v60, v60, v60 row_ror:2 row_mask:0xf bank_mask:0xf
s_nop 1
v_add_f32_dpp v60, v60, v60 row_ror:1 row_mask:0xf bank_mask:0xf
v_mov_b32 v61, v60
s_nop 1
v_permlane16_swap_b32 v60, v61
v_add_f32 v60, v60, v61
v_mov_b32 v61, v60
s_nop 1
v_permlane32_swap_b32 v60, v61
v_add_f32 v60, v60, v61
v_cmp_gt_u32 vcc, 24, v1
s_mul_i32 s47, s46, 86
s_lshr_b32 s47, s47, 8
v_cndmask_b32 v17, v255, v8, vcc
v_cndmask_b32 v250, 0, -1, vcc
s_lshl_b32 s48, s46, 12
s_add_u32 s48, s48, 720896
v_mov_b32 v18, 0
v_and_b32 v30, 31, v1
v_lshlrev_b32 v30, 7, v30
s_mov_b32 s55, 393216
L_f_cp:
buffer_load_dwordx4 v[20:23], v30, s[4:7], s55 offen sc1
s_waitcnt vmcnt(0)
v_cmp_ne_u32 vcc, s40, v22
s_add_u32 s97, s97, 1
s_cmp_gt_u32 s97, 65536
s_cbranch_scc1 L_f_cok
s_cbranch_vccnz L_f_cp
L_f_cok:
v_max_f32_dpp v24, v20, v20 row_ror:8 row_mask:0xf bank_mask:0xf
s_nop 1
v_max_f32_dpp v24, v24, v24 row_ror:4 row_mask:0xf bank_mask:0xf
s_nop 1
v_max_f32_dpp v24, v24, v24 row_ror:2 row_mask:0xf bank_mask:0xf
s_nop 1
v_max_f32_dpp v24, v24, v24 row_ror:1 row_mask:0xf bank_mask:0xf
v_mov_b32 v25, v24
s_nop 1
v_permlane16_swap_b32 v24, v25
v_max_f32 v24, v24, v25
v_cmp_eq_f32 vcc, v24, v20
s_ff1_i32_b64 s45, vcc
s_and_b32 s45, s45, 31
v_readlane_b32 s50, v21, s45
v_readlane_b32 s51, v23, s45
v_add_f32 v60, v60, v24
v_cvt_pk_bf16_f32 v60, v60, v60
v_lshlrev_b32 v60, 16, v60
v_mul_f32 v60, 0xbfb8aa3b, v60
v_exp_f32 v60, v60
s_lshl_b32 s55, s45, 12
s_add_u32 s56, s46, s47
s_lshl_b32 s56, s56, 7
s_add_u32 s55, s55, s56
s_add_u32 s55, s55, 524288
s_and_b32 s51, s51, 127
s_lshl_b32 s56, s51, 3
s_add_u32 s56, s56, s47
s_lshl_b32 s56, s56, 4
s_add_u32 s56, s56, 655360
v_add_f32 v60, 1.0, v60
v_rcp_f32 v60, v60
s_and_b32 s50, s50, 2047
s_mul_i32 s50, s50, 1280
s_lshl_b32 s57, s46, 6
s_add_u32 s50, s50, s57
v_mul_f32 v56, v56, v60
v_mul_f32 v57, v57, v60
v_mul_f32 v58, v58, v60
v_mul_f32 v59, v59, v60
L_fz_bp:
buffer_load_dwordx4 v[52:55], v15, s[4:7], s55 offen sc1
buffer_load_dword v62, v18, s[4:7], s56 offen sc1
s_waitcnt vmcnt(0)
v_perm_b32 v32, v53, v52, s98
v_perm_b32 v33, v55, v54, s99
v_bitop3_b32 v32, v32, v33, s40 bitop3:0x56
v_xor_b32 v33, s40, v62
v_or_b32 v32, v32, v33
v_cmp_ne_u32 vcc, 0, v32
s_add_u32 s97, s97, 1
s_cmp_gt_u32 s97, 65536
s_cbranch_scc1 L_fz_bok
s_cbranch_vccnz L_fz_bp
L_fz_bok:
s_mov_b32 s55, 0xffffff00
v_and_b32 v52, s55, v52
v_and_b32 v53, s55, v53
v_and_b32 v54, s55, v54
v_and_b32 v55, s55, v55
L_fz_yp:
buffer_load_dwordx4 v[20:23], v8, s[4:7], s48 offen offset:0 sc1
buffer_load_dwordx4 v[24:27], v8, s[4:7], s48 offen offset:1024 sc1
buffer_load_dwordx4 v[28:31], v8, s[4:7], s48 offen offset:2048 sc1
buffer_load_dwordx4 v[32:35], v17, s[4:7], s48 offen offset:3072 sc1
s_waitcnt vmcnt(0)
v_perm_b32 v36, v21, v20, s98
v_perm_b32 v37, v23, v22, s99
v_bitop3_b32 v38, v36, v37, s40 bitop3:0x56
v_perm_b32 v36, v25, v24, s98
v_perm_b32 v37, v27, v26, s99
v_bitop3_b32 v39, v36, v37, s40 bitop3:0x56
v_perm_b32 v36, v29, v28, s98
v_perm_b32 v37, v31, v30, s99
v_bitop3_b32 v40, v36, v37, s40 bitop3:0x56
v_perm_b32 v36, v33, v32, s98
v_perm_b32 v37, v35, v34, s99
v_bitop3_b32 v41, v36, v37, s40 bitop3:0x56
v_and_b32 v41, v41, v250
v_or3_b32 v38, v38, v39, v40
v_or_b32 v38, v38, v41
v_cmp_ne_u32 vcc, 0, v38
s_add_u32 s97, s97, 1
s_cmp_gt_u32 s97, 65536
s_cbranch_scc1 L_fz_yok
s_cbranch_vccnz L_fz_yp
L_fz_yok:
v_and_b32 v20, s55, v20
v_and_b32 v21, s55, v21
v_and_b32 v22, s55, v22
v_and_b32 v23, s55, v23
v_and_b32 v24, s55, v24
v_and_b32 v25, s55, v25
v_and_b32 v26, s55, v26
v_and_b32 v27, s55, v27
v_and_b32 v28, s55, v28
v_and_b32 v29, s55, v29
v_and_b32 v30, s55, v30
v_and_b32 v31, s55, v31
v_and_b32 v32, s55, v32
v_and_b32 v33, s55, v33
v_and_b32 v34, s55, v34
v_and_b32 v35, s55, v35
v_pk_add_f32 v[20:21], v[20:21], v[24:25]
v_pk_add_f32 v[22:23], v[22:23], v[26:27]
v_pk_add_f32 v[28:29], v[28:29], v[32:33]
v_pk_add_f32 v[30:31], v[30:31], v[34:35]
v_pk_add_f32 v[20:21], v[20:21], v[28:29]
v_pk_add_f32 v[22:23], v[22:23], v[30:31]
s_nop 0
v_add_f32_dpp v20, v20, v20 row_ror:8 row_mask:0xf bank_mask:0xf
v_add_f32_dpp v21, v21, v21 row_ror:8 row_mask:0xf bank_mask:0xf
v_add_f32_dpp v22, v22, v22 row_ror:8 row_mask:0xf bank_mask:0xf
v_add_f32_dpp v23, v23, v23 row_ror:8 row_mask:0xf bank_mask:0xf
v_mov_b32 v24, v20
v_mov_b32 v25, v21
v_mov_b32 v26, v22
v_mov_b32 v27, v23
v_permlane16_swap_b32 v20, v24
v_permlane16_swap_b32 v21, v25
v_permlane16_swap_b32 v22, v26
v_permlane16_swap_b32 v23, v27
v_pk_add_f32 v[20:21], v[20:21], v[24:25]
v_pk_add_f32 v[22:23], v[22:23], v[26:27]
v_mov_b32 v24, v20
v_mov_b32 v25, v21
v_mov_b32 v26, v22
v_mov_b32 v27, v23
v_permlane32_swap_b32 v20, v24
v_permlane32_swap_b32 v21, v25
v_permlane32_swap_b32 v22, v26
v_permlane32_swap_b32 v23, v27
v_pk_add_f32 v[20:21], v[20:21], v[24:25]
v_pk_add_f32 v[22:23], v[22:23], v[26:27]
v_pk_fma_f32 v[20:21], v[20:21], v[56:57], v[52:53]
v_pk_fma_f32 v[22:23], v[22:23], v[58:59], v[54:55]
v_cvt_pk_bf16_f32 v20, v20, v21
v_cvt_pk_bf16_f32 v21, v22, v23
s_mov_b64 exec, 0xff
buffer_store_dwordx2 v[20:21], v14, s[32:35], s50 offen sc1
s_cmp_eq_u32 s46, 0
s_cbranch_scc0 L_fz_e
s_add_u32 s55, s41, 1
v_mov_b32 v22, s55
s_mov_b64 exec, 1
buffer_store_dword v22, v18, s[4:7], 0 offen sc1
L_fz_e:
s_mov_b64 exec, -1
L_fin:
L_end:
s_endpgm
.fill (adaLN_cond__sliding_local_dilated__moe_arch_mod__prompt_kernel + 49664 - .) / 4, 4, 0xbf800000
.section .rodata,"a"
.p2align 6
.amdhsa_kernel adaLN_cond__sliding_local_dilated__moe_arch_mod__prompt_kernel
  .amdhsa_next_free_vgpr 512
  .amdhsa_next_free_sgpr 102
  .amdhsa_accum_offset 256
  .amdhsa_group_segment_fixed_size 0
  .amdhsa_kernarg_size 104
  .amdhsa_user_sgpr_count 2
  .amdhsa_user_sgpr_kernarg_segment_ptr 1
  .amdhsa_system_sgpr_workgroup_id_x 1
  .amdhsa_float_denorm_mode_32 3
  .amdhsa_float_denorm_mode_16_64 3
.end_amdhsa_kernel
```

```asm
; @launch grid=(256,1,1) block=(256,1,1) lds=163840
.amdgcn_target "amdgcn-amd-amdhsa--gfx950"
.text
.globl adaLN_cond__sliding_local_dilated__moe_arch_mod__prompt_kernel
.p2align 12
.type adaLN_cond__sliding_local_dilated__moe_arch_mod__prompt_kernel,@function
adaLN_cond__sliding_local_dilated__moe_arch_mod__prompt_kernel:
s_cmp_ge_u32 s2, 256
s_cbranch_scc1 L_end
s_load_dwordx4 s[8:11], s[0:1], 0
s_load_dwordx4 s[20:23], s[0:1], 64
s_load_dwordx2 s[4:5], s[0:1], 96
s_getpc_b64 s[48:49]
v_lshrrev_b32 v4, 6, v0
v_and_b32 v1, 63, v0
s_lshr_b32 s43, s2, 3
v_readfirstlane_b32 s3, v4
v_mad_u32_u24 v5, v4, 3, v1
s_mul_i32 s50, s43, 1536
v_lshl_add_u32 v5, v5, 7, s50
s_mov_b64 exec, 7
global_load_dword v19, v5, s[48:49]
s_mov_b64 exec, -1
s_and_b32 s42, s2, 7
v_and_b32 v2, 15, v1
v_lshrrev_b32 v3, 4, v1
v_mov_b32 v29, 0
s_mov_b32 s6, 8388608
s_mov_b32 s7, 0x20000
s_lshl_b32 s49, s3, 10
s_cmp_ge_u32 s2, 224
s_cbranch_scc1 L_svc
s_mov_b32 m0, s49
s_mov_b32 s15, 0x20000
s_lshr_b32 s55, s42, 2
s_bfe_u32 s56, s42, 0x10001
s_mul_i32 s56, s56, 7
s_and_b32 s57, s42, 1
s_mul_i32 s57, s57, 28
s_add_u32 s57, s57, s43
s_and_b32 s44, s57, 7
s_lshr_b32 s57, s57, 3
s_add_u32 s56, s56, s57
s_mul_i32 s57, s56, 73
s_lshl_b32 s45, s57, 1
s_add_u32 s45, s45, s55
s_mul_i32 s45, s45, 1280
s_mul_i32 s58, s43, 37
s_lshr_b32 s58, s58, 8
s_mul_i32 s60, s58, 7
s_sub_u32 s96, s43, s60
s_lshl_b32 s47, s42, 2
s_add_u32 s47, s47, s58
s_lshl_b32 s60, s96, 2
s_lshr_b32 s60, 0x4932180, s60
s_and_b32 s60, s60, 15
s_cmp_ge_u32 s60, 8
s_cselect_b32 s61, 2, 5
s_cselect_b32 s63, 12, 0
s_mul_i32 s58, s58, s61
s_add_u32 s58, s58, s60
s_add_u32 s58, s58, s63
s_lshl_b32 s58, s58, 3
s_add_u32 s98, s58, s42
s_and_b32 s60, s60, 3
s_lshl_b32 s60, s60, 2
s_lshr_b32 s62, 0x3214321, s60
s_lshl_b32 s62, s62, 4
s_bfe_u32 s61, s62, 262144
s_mul_i32 s61, s61, 40960
s_add_u32 s61, s61, s45
v_lshrrev_b32 v5, 4, v0
v_mul_u32_u24 v4, 2560, v5
v_lshl_add_u32 v4, v2, 4, v4
s_cmp_lt_u32 s98, 160
s_cbranch_scc1 L_roleW
s_sub_u32 s50, s98, 160
s_mul_i32 s52, s50, 13
s_lshr_b32 s52, s52, 8
s_mul_i32 s53, s52, 20
s_sub_u32 s53, s50, s53
s_mul_i32 s51, s52, 28
s_add_u32 s51, s51, s3
s_mul_i32 s51, s51, 61440
s_lshl_b32 s54, s53, 7
s_add_u32 s51, s51, s54
s_mul_i32 s54, s52, 448
s_and_b32 s58, s3, 1
s_lshl_b32 s58, s58, 2
v_and_b32 v20, 1, v3
v_lshl_or_b32 v20, v20, 1, s58
v_and_b32 v21, 7, v1
v_xor_b32 v20, v20, v21
v_lshrrev_b32 v21, 3, v1
v_mul_u32_u24 v21, 480, v21
v_add_lshl_u32 v20, v20, v21, 4
v_lshlrev_b32 v39, 3, v1
s_mov_b32 s14, 4915200
s_waitcnt lgkmcnt(0)
s_mov_b32 s12, s22
s_mov_b32 s13, s23
s_mov_b32 s22, 1280
s_mov_b32 s23, 0x20000
s_mov_b32 s10, 2621440
s_mov_b32 s11, 0x20000
buffer_load_dword v42, v29, s[4:7], 0 offen sc1
buffer_load_dwordx2 v[40:41], v39, s[20:23], s54 offen
buffer_load_dwordx4 v[100:103], v4, s[8:11], s61 offen offset:0
buffer_load_dwordx4 v[104:107], v4, s[8:11], s61 offen offset:256
buffer_load_dwordx4 v[108:111], v4, s[8:11], s61 offen offset:512
buffer_load_dwordx4 v[112:115], v4, s[8:11], s61 offen offset:768
buffer_load_dwordx4 v[116:119], v4, s[8:11], s61 offen offset:1024
s_bfe_u32 s61, s62, 262148
s_mul_i32 s61, s61, 40960
s_add_u32 s61, s61, s45
buffer_load_dwordx4 v20, s[12:15], s51 offen nt lds
s_add_u32 m0, m0, 4096
s_add_u32 s51, s51, 245760
buffer_load_dwordx4 v20, s[12:15], s51 offen nt lds
s_add_u32 m0, m0, 4096
s_add_u32 s51, s51, 245760
buffer_load_dwordx4 v20, s[12:15], s51 offen nt lds
s_add_u32 m0, m0, 4096
s_add_u32 s51, s51, 245760
buffer_load_dwordx4 v20, s[12:15], s51 offen nt lds
s_add_u32 m0, m0, 4096
s_add_u32 s51, s51, 245760
buffer_load_dwordx4 v20, s[12:15], s51 offen nt lds
s_add_u32 m0, m0, 4096
s_add_u32 s51, s51, 245760
buffer_load_dwordx4 v20, s[12:15], s51 offen nt lds
s_add_u32 m0, m0, 4096
s_add_u32 s51, s51, 245760
buffer_load_dwordx4 v20, s[12:15], s51 offen nt lds
s_branch L_rolej
L_roleW:
s_mov_b32 s58, 640
v_lshlrev_b32 v24, 4, v0
v_mul_u32_u24 v26, 1639, v0
v_lshrrev_b32 v26, 16, v26
v_mad_u32_u24 v20, v26, s58, v24
v_add_u32 v25, 256, v0
v_add_u32 v24, 4096, v24
v_mul_u32_u24 v26, 1639, v25
v_lshrrev_b32 v26, 16, v26
v_mad_u32_u24 v21, v26, s58, v24
v_add_u32 v25, 512, v0
v_add_u32 v24, 4096, v24
v_mul_u32_u24 v26, 1639, v25
v_lshrrev_b32 v26, 16, v26
v_mad_u32_u24 v22, v26, s58, v24
v_add_u32 v25, 768, v0
v_add_u32 v24, 4096, v24
v_mul_u32_u24 v26, 1639, v25
v_lshrrev_b32 v26, 16, v26
v_mad_u32_u24 v23, v26, s58, v24
s_lshr_b32 s50, s98, 1
s_and_b32 s52, s98, 1
s_mul_i32 s51, s50, 30720
s_mul_i32 s53, s52, 640
s_add_u32 s51, s51, s53
s_cmp_eq_u32 s3, 3
s_cselect_b32 s53, 1073741824, s51
s_mov_b32 s14, 2457600
s_waitcnt lgkmcnt(0)
s_mov_b32 s12, s10
s_mov_b32 s13, s11
s_mov_b32 s10, 2621440
s_mov_b32 s11, 0x20000
buffer_load_dword v42, v29, s[4:7], 0 offen sc1
buffer_load_dwordx4 v20, s[12:15], s51 offen nt lds
s_add_u32 m0, m0, 4096
s_nop 0
buffer_load_dwordx4 v21, s[12:15], s51 offen nt lds
s_add_u32 m0, m0, 4096
s_nop 0
buffer_load_dwordx4 v22, s[12:15], s51 offen nt lds
s_add_u32 m0, m0, 4096
s_nop 0
buffer_load_dwordx4 v23, s[12:15], s53 offen nt lds
buffer_load_dwordx4 v[100:103], v4, s[8:11], s61 offen offset:0
buffer_load_dwordx4 v[104:107], v4, s[8:11], s61 offen offset:256
buffer_load_dwordx4 v[108:111], v4, s[8:11], s61 offen offset:512
buffer_load_dwordx4 v[112:115], v4, s[8:11], s61 offen offset:768
buffer_load_dwordx4 v[116:119], v4, s[8:11], s61 offen offset:1024
s_bfe_u32 s61, s62, 262148
s_mul_i32 s61, s61, 40960
s_add_u32 s61, s61, s45
L_rolej:
s_load_dwordx2 s[24:25], s[0:1], 16
s_load_dwordx2 s[28:29], s[0:1], 32
s_load_dwordx2 s[32:33], s[0:1], 80
s_mov_b32 s26, 819200
s_mov_b32 s27, 0x20000
s_mov_b32 s30, 1280
s_mov_b32 s31, 0x20000
s_mov_b32 s34, 2621440
s_mov_b32 s35, 0x20000
s_mov_b32 s97, 0
v_mov_b32 v255, 1073741824
v_lshlrev_b32 v36, 4, v1
s_mul_i32 s36, s55, 14
s_add_u32 s100, s36, s56
s_cmp_eq_u32 s56, 0
s_cselect_b32 s58, 0, 7
s_add_u32 s58, s58, s57
s_add_u32 s60, s57, 80
s_min_u32 s60, s60, 1024
s_sub_u32 s60, s60, s58
s_andn2_b32 s59, s58, 15
s_lshl_b32 s54, s55, 10
s_add_u32 s54, s54, s59
s_lshl_b32 s46, s44, 1
s_add_u32 s46, s46, s54
s_mul_i32 s46, s46, 1280
s_add_u32 s46, s46, 4194304
s_sub_u32 s54, s59, s58
s_sub_u32 s59, s59, s57
s_mul_i32 s59, s59, 176
s_add_u32 s59, s59, 138240
v_add_u32 v33, s54, v2
v_mul_u32_u24 v34, 175, v2
v_add3_u32 v34, v34, v0, s59
s_mov_b32 s54, 2656
s_mov_b32 s58, 1120
v_mul_u32_u24 v31, 410, v0
v_lshrrev_b32 v31, 16, v31
v_lshl_add_u32 v32, v31, 4, v33
v_cmp_gt_u32 vcc, s60, v32
v_mad_u32_u24 v32, v31, s58, v0
v_mad_u32_u24 v15, v31, s54, v34
v_lshlrev_b32 v32, 4, v32
v_cndmask_b32 v11, v255, v32, vcc
v_add_u32 v30, 256, v0
v_mul_u32_u24 v31, 410, v30
v_lshrrev_b32 v31, 16, v31
v_lshl_add_u32 v32, v31, 4, v33
v_cmp_gt_u32 vcc, s60, v32
v_mad_u32_u24 v32, v31, s58, v30
v_mad_u32_u24 v16, v31, s54, v34
v_lshlrev_b32 v32, 4, v32
v_cndmask_b32 v12, v255, v32, vcc
v_add_u32 v30, 512, v0
v_mul_u32_u24 v31, 410, v30
v_lshrrev_b32 v31, 16, v31
v_lshl_add_u32 v32, v31, 4, v33
v_cmp_gt_u32 vcc, s60, v32
v_mad_u32_u24 v32, v31, s58, v30
v_mad_u32_u24 v17, v31, s54, v34
v_lshlrev_b32 v32, 4, v32
v_cndmask_b32 v13, v255, v32, vcc
v_add_u32 v30, 768, v0
v_mul_u32_u24 v31, 410, v30
v_lshrrev_b32 v31, 16, v31
v_lshl_add_u32 v32, v31, 4, v33
v_cmp_gt_u32 vcc, s60, v32
v_mad_u32_u24 v32, v31, s58, v30
v_mad_u32_u24 v18, v31, s54, v34
v_lshlrev_b32 v32, 4, v32
v_cndmask_b32 v14, v255, v32, vcc
s_mul_i32 s58, s3, 80
v_add_u32 v30, s58, v1
s_mul_i32 s58, s3, 1280
s_add_u32 s58, s58, 1024
v_lshlrev_b32 v248, 4, v30
v_lshl_add_u32 v249, v1, 2, s58
v_add_u32 v251, 158720, v248
v_add_u32 v250, 158720, v249
v_cmp_le_u32 vcc, 160, v30
v_min_u32 v247, 19, v1
v_lshlrev_b32 v247, 6, v247
v_cndmask_b32 v252, 0, 1.0, vcc
v_cmp_gt_u32 vcc, 4, v1
s_mov_b32 s56, 4096
s_mov_b32 s57, 9216
v_cndmask_b32 v246, v255, v36, vcc
s_mul_i32 s60, s44, 5120
s_mul_i32 s58, s3, 1280
s_add_u32 s60, s60, s58
s_add_u32 s60, s60, 851968
s_mov_b32 s58, 14336
v_lshlrev_b32 v30, 12, v3
v_lshl_add_u32 v30, v2, 4, v30
v_add_u32 v5, s49, v30
v_lshrrev_b32 v32, 2, v2
v_cmp_ne_u32 vcc, 1, v32
v_lshrrev_b32 v30, 4, v0
v_and_b32 v31, 7, v2
v_cndmask_b32 v6, v255, v5, vcc
v_xor_b32 v30, v30, v31
v_lshlrev_b32 v30, 4, v30
v_and_b32 v33, 3, v2
v_lshl_add_u32 v30, v33, 8, v30
v_mul_u32_u24 v32, 5120, v32
s_mov_b32 s54, 56320
v_add3_u32 v30, v30, v32, s54
s_bfe_u32 s63, s62, 262144
s_lshl_b32 s63, s63, 10
v_add_u32 v7, s63, v30
s_bfe_u32 s63, s62, 262148
s_lshl_b32 s63, s63, 10
v_add_u32 v253, s63, v30
s_bfe_u32 s63, s62, 262152
s_lshl_b32 s63, s63, 10
v_add_u32 v254, s63, v30
s_bfe_u32 s63, s62, 262156
s_lshl_b32 s63, s63, 10
v_add_u32 v244, s63, v30
s_bfe_u32 s63, s62, 262160
s_lshl_b32 s63, s63, 10
v_add_u32 v245, s63, v30
v_xor_b32 v30, v2, v3
v_lshlrev_b32 v30, 4, v30
v_lshl_add_u32 v8, v3, 8, v30
v_xor_b32 v9, 64, v8
v_add_u32 v8, s54, v8
v_add_u32 v9, s54, v9
v_lshlrev_b32 v10, 5, v2
v_add_u32 v10, 158720, v10
s_mul_i32 s59, s44, 327680
s_add_u32 s59, s59, 1048576
s_cmp_eq_u32 s96, 6
s_cselect_b32 s16, 0x80, 0
s_cselect_b32 s17, 16, 24
s_mov_b32 s37, 2368
s_mov_b32 s38, 1088
v_mul_u32_u24 v31, 5462, v1
v_lshrrev_b32 v31, 16, v31
v_mad_u32_u24 v32, v31, s37, v36
v_mad_u32_u24 v33, v31, s38, v36
v_lshlrev_b32 v31, 2, v31
v_and_b32 v34, s16, v32
v_bitop3_b32 v33, v33, v31, 32 bitop3:0x78
v_lshl_or_b32 v235, v34, 23, v32
v_lshl_or_b32 v232, v34, 23, v33
v_add_u32 v30, 64, v1
v_mul_u32_u24 v31, 5462, v30
v_lshrrev_b32 v31, 16, v31
v_mad_u32_u24 v32, v31, s37, v36
v_mad_u32_u24 v33, v31, s38, v36
v_lshlrev_b32 v31, 2, v31
v_and_b32 v34, s16, v32
v_bitop3_b32 v33, v33, v31, 32 bitop3:0x78
v_lshl_or_b32 v236, v34, 23, v32
v_lshl_or_b32 v233, v34, 23, v33
v_add_u32 v30, 128, v1
v_mul_u32_u24 v31, 5462, v30
v_lshrrev_b32 v31, 16, v31
v_mad_u32_u24 v32, v31, s37, v36
v_mad_u32_u24 v33, v31, s38, v36
v_lshlrev_b32 v31, 2, v31
v_and_b32 v34, s16, v32
v_bitop3_b32 v33, v33, v31, 32 bitop3:0x78
v_lshl_or_b32 v237, v34, 23, v32
v_lshl_or_b32 v234, v34, 23, v33
s_lshl_b32 s100, s100, 3
s_add_u32 s100, s100, s44
s_lshl_b32 s100, s100, 6
s_add_u32 s100, s100, 917504
s_and_b32 s37, s47, 15
s_lshl_b32 s37, s37, 6
s_max_u32 s37, s37, 7
s_sub_u32 s37, s37, 7
s_mul_i32 s37, s37, 899
s_lshr_b32 s37, s37, 16
s_min_u32 s37, s37, 12
s_add_u32 s37, s37, s36
s_lshl_b32 s101, s37, 3
s_bfe_u32 s37, s42, 0x10001
s_mul_i32 s37, s37, 7
s_add_u32 s37, s37, s36
s_lshl_b32 s37, s37, 3
s_and_b32 s38, s42, 1
s_mul_i32 s38, s38, 28
s_add_u32 s21, s37, s38
s_sub_u32 s20, s43, s96
s_getreg_b32 s19, hwreg(HW_REG_XCC_ID, 0, 4)
v_cmp_le_u32 vcc, 24, v1
v_subrev_u32 v30, 24, v1
v_mov_b32 v32, 0xa00
v_cndmask_b32 v30, v1, v30, vcc
v_cndmask_b32 v32, 0, v32, vcc
v_cmp_gt_u32 vcc, s17, v30
v_lshl_add_u32 v32, v30, 4, v32
v_lshlrev_b32 v31, 3, v30
v_cndmask_b32 v238, v255, v32, vcc
v_cndmask_b32 v239, v255, v31, vcc
v_cndmask_b32 v230, 0, -1, vcc
v_min_u32 v30, 6, v2
v_add_u32 v30, s20, v30
v_cmp_gt_u32 vcc, 16, v1
v_add_u32 v30, s21, v30
v_add_u32 v31, s101, v1
v_cndmask_b32 v30, v30, v31, vcc
v_lshlrev_b32 v231, 6, v30
s_mul_i32 s37, s96, 192
s_mul_i32 s48, s3, 20480
s_add_u32 s48, s48, s37
s_mul_i32 s39, s3, 3072
s_lshl_b32 s18, s47, 11
s_lshl_b32 s37, s96, 8
s_add_u32 s18, s18, s37
s_lshl_b32 s37, s3, 6
s_add_u32 s18, s18, s37
s_add_u32 s18, s18, 458752
v_accvgpr_write_b32 a232, -1
v_accvgpr_write_b32 a233, -1
v_accvgpr_write_b32 a234, -1
v_accvgpr_write_b32 a235, -1
s_cmp_ge_u32 s98, 160
s_cbranch_scc1 L_bodyM
v_bfe_u32 v30, v1, 2, 2
v_and_b32 v31, 3, v1
v_max_u32 v32, 1, v31
v_add_u32 v32, -1, v32
v_cmp_eq_u32 vcc, 3, v3
v_lshlrev_b32 v33, 3, v31
v_mul_u32_u24 v30, 3, v30
v_cndmask_b32 v32, v3, v32, vcc
v_cndmask_b32 v33, v33, 32, vcc
v_add_u32 v30, v30, v32
v_mul_u32_u24 v30, 640, v30
s_mul_i32 s54, s3, 160
v_add3_u32 v35, v30, v33, s54
s_lshl_b32 s52, s52, 2
s_add_u32 s52, s52, s3
s_mul_i32 s52, s52, 80
s_add_u32 s52, s52, s50
s_lshl_b32 s51, s52, 12
s_add_u32 s51, s51, 1048576
s_lshl_b32 s53, s52, 6
s_add_u32 s53, s53, 851968
buffer_load_dwordx4 v[120:123], v4, s[8:11], s61 offen offset:0
buffer_load_dwordx4 v[124:127], v4, s[8:11], s61 offen offset:256
buffer_load_dwordx4 v[128:131], v4, s[8:11], s61 offen offset:512
buffer_load_dwordx4 v[132:135], v4, s[8:11], s61 offen offset:768
buffer_load_dwordx4 v[136:139], v4, s[8:11], s61 offen offset:1024
s_bfe_u32 s61, s62, 262152
s_mul_i32 s61, s61, 40960
s_add_u32 s61, s61, s45
s_waitcnt vmcnt(10)
v_readfirstlane_b32 s41, v42
s_waitcnt lgkmcnt(0)
s_barrier
ds_read_b64_tr_b16 v[44:45], v35 offset:0
ds_read_b64_tr_b16 v[46:47], v35 offset:7680
ds_read_b64_tr_b16 v[48:49], v35 offset:40
ds_read_b64_tr_b16 v[50:51], v35 offset:7720
ds_read_b64_tr_b16 v[52:53], v35 offset:80
ds_read_b64_tr_b16 v[54:55], v35 offset:7760
ds_read_b64_tr_b16 v[56:57], v35 offset:120
ds_read_b64_tr_b16 v[58:59], v35 offset:7800
s_mul_i32 s40, s41, 0x9E3779B1
s_add_u32 s40, s40, 0x85EBCA6B
v_and_b32 v33, 3, v1
v_lshlrev_b32 v33, 3, v33
v_lshrrev_b32 v19, v33, s40
v_and_b32 v19, 0xff, v19
v_mov_b32 v240, s40
v_mov_b32 v241, s19
v_mov_b32 v242, s40
v_mov_b32 v243, s40
s_waitcnt lgkmcnt(6)
buffer_store_dwordx4 v[44:47], v36, s[4:7], s51 offen offset:0 sc1
s_waitcnt lgkmcnt(4)
buffer_store_dwordx4 v[48:51], v36, s[4:7], s51 offen offset:1024 sc1
s_waitcnt lgkmcnt(2)
buffer_store_dwordx4 v[52:55], v36, s[4:7], s51 offen offset:2048 sc1
s_waitcnt lgkmcnt(0)
buffer_store_dwordx4 v[56:59], v36, s[4:7], s51 offen offset:3072 sc1
buffer_load_dwordx4 v[140:143], v4, s[8:11], s61 offen offset:0
buffer_load_dwordx4 v[144:147], v4, s[8:11], s61 offen offset:256
buffer_load_dwordx4 v[148:151], v4, s[8:11], s61 offen offset:512
s_waitcnt vmcnt(12)
s_mov_b32 s55, 0x3f803f80
buffer_load_dwordx4 v[152:155], v4, s[8:11], s61 offen offset:768
v_mov_b32 v20, 0
v_mov_b32 v21, 0
v_dot2c_f32_bf16 v20, s55, v100
v_dot2c_f32_bf16 v21, v100, v100
v_dot2c_f32_bf16 v20, s55, v101
v_dot2c_f32_bf16 v21, v101, v101
v_dot2c_f32_bf16 v20, s55, v102
v_dot2c_f32_bf16 v21, v102, v102
v_dot2c_f32_bf16 v20, s55, v103
v_dot2c_f32_bf16 v21, v103, v103
v_dot2c_f32_bf16 v20, s55, v104
v_dot2c_f32_bf16 v21, v104, v104
v_dot2c_f32_bf16 v20, s55, v105
v_dot2c_f32_bf16 v21, v105, v105
v_dot2c_f32_bf16 v20, s55, v106
v_dot2c_f32_bf16 v21, v106, v106
v_dot2c_f32_bf16 v20, s55, v107
v_dot2c_f32_bf16 v21, v107, v107
v_dot2c_f32_bf16 v20, s55, v108
v_dot2c_f32_bf16 v21, v108, v108
v_dot2c_f32_bf16 v20, s55, v109
v_dot2c_f32_bf16 v21, v109, v109
v_dot2c_f32_bf16 v20, s55, v110
v_dot2c_f32_bf16 v21, v110, v110
v_dot2c_f32_bf16 v20, s55, v111
v_dot2c_f32_bf16 v21, v111, v111
v_dot2c_f32_bf16 v20, s55, v112
v_dot2c_f32_bf16 v21, v112, v112
v_dot2c_f32_bf16 v20, s55, v113
v_dot2c_f32_bf16 v21, v113, v113
v_dot2c_f32_bf16 v20, s55, v114
v_dot2c_f32_bf16 v21, v114, v114
v_dot2c_f32_bf16 v20, s55, v115
v_dot2c_f32_bf16 v21, v115, v115
v_dot2c_f32_bf16 v20, s55, v116
v_dot2c_f32_bf16 v21, v116, v116
v_dot2c_f32_bf16 v20, s55, v117
v_dot2c_f32_bf16 v21, v117, v117
v_dot2c_f32_bf16 v20, s55, v118
v_dot2c_f32_bf16 v21, v118, v118
v_dot2c_f32_bf16 v20, s55, v119
v_dot2c_f32_bf16 v21, v119, v119
v_and_b32 v25, 0xffff0000, v100
v_and_b32 v27, 0xffff0000, v101
v_add_f32_dpp v20, v20, v20 row_ror:8 row_mask:0xf bank_mask:0xf
v_add_f32_dpp v21, v21, v21 row_ror:8 row_mask:0xf bank_mask:0xf
v_lshlrev_b32 v24, 16, v100
v_add_f32_dpp v20, v20, v20 row_ror:4 row_mask:0xf bank_mask:0xf
v_add_f32_dpp v21, v21, v21 row_ror:4 row_mask:0xf bank_mask:0xf
v_lshlrev_b32 v26, 16, v101
v_add_f32_dpp v20, v20, v20 row_ror:2 row_mask:0xf bank_mask:0xf
v_add_f32_dpp v21, v21, v21 row_ror:2 row_mask:0xf bank_mask:0xf
v_lshlrev_b32 v28, 16, v102
v_add_f32_dpp v20, v20, v20 row_ror:1 row_mask:0xf bank_mask:0xf
v_add_f32_dpp v21, v21, v21 row_ror:1 row_mask:0xf bank_mask:0xf
v_mul_f32 v20, 0x3acccccd, v20
v_mul_f32 v21, 0x3acccccd, v21
v_fma_f32 v21, -v20, v20, v21
v_max_f32 v21, 0, v21
v_add_f32 v21, 0x3727c5ac, v21
v_rsq_f32 v22, v21
v_and_b32 v29, 0xffff0000, v102
v_mul_f32 v23, -v20, v22
v_pk_fma_f32 v[24:25], v[24:25], v[22:23], v[22:23] op_sel:[0,0,1] op_sel_hi:[1,0,1]
v_pk_fma_f32 v[26:27], v[26:27], v[22:23], v[22:23] op_sel:[0,0,1] op_sel_hi:[1,0,1]
v_cvt_pk_f16_f32 v100, v24, v25
v_pk_fma_f32 v[28:29], v[28:29], v[22:23], v[22:23] op_sel:[0,0,1] op_sel_hi:[1,0,1]
v_cvt_pk_f16_f32 v101, v26, v27
buffer_load_dwordx4 v[156:159], v4, s[8:11], s61 offen offset:1024
s_bfe_u32 s61, s62, 262156
s_mul_i32 s61, s61, 40960
s_add_u32 s61, s61, s45
v_lshlrev_b32 v30, 16, v103
v_and_b32 v31, 0xffff0000, v103
v_pk_fma_f32 v[30:31], v[30:31], v[22:23], v[22:23] op_sel:[0,0,1] op_sel_hi:[1,0,1]
v_cvt_pk_f16_f32 v102, v28, v29
v_lshlrev_b32 v24, 16, v104
v_and_b32 v25, 0xffff0000, v104
v_pk_fma_f32 v[24:25], v[24:25], v[22:23], v[22:23] op_sel:[0,0,1] op_sel_hi:[1,0,1]
v_cvt_pk_f16_f32 v103, v30, v31
v_lshlrev_b32 v26, 16, v105
v_and_b32 v27, 0xffff0000, v105
v_pk_fma_f32 v[26:27], v[26:27], v[22:23], v[22:23] op_sel:[0,0,1] op_sel_hi:[1,0,1]
v_cvt_pk_f16_f32 v104, v24, v25
v_lshlrev_b32 v28, 16, v106
v_and_b32 v29, 0xffff0000, v106
v_pk_fma_f32 v[28:29], v[28:29], v[22:23], v[22:23] op_sel:[0,0,1] op_sel_hi:[1,0,1]
v_cvt_pk_f16_f32 v105, v26, v27
v_lshlrev_b32 v30, 16, v107
v_and_b32 v31, 0xffff0000, v107
v_pk_fma_f32 v[30:31], v[30:31], v[22:23], v[22:23] op_sel:[0,0,1] op_sel_hi:[1,0,1]
v_cvt_pk_f16_f32 v106, v28, v29
v_lshlrev_b32 v24, 16, v108
v_and_b32 v25, 0xffff0000, v108
v_pk_fma_f32 v[24:25], v[24:25], v[22:23], v[22:23] op_sel:[0,0,1] op_sel_hi:[1,0,1]
v_cvt_pk_f16_f32 v107, v30, v31
v_lshlrev_b32 v26, 16, v109
v_and_b32 v27, 0xffff0000, v109
v_pk_fma_f32 v[26:27], v[26:27], v[22:23], v[22:23] op_sel:[0,0,1] op_sel_hi:[1,0,1]
v_cvt_pk_f16_f32 v108, v24, v25
v_lshlrev_b32 v28, 16, v110
v_and_b32 v29, 0xffff0000, v110
v_pk_fma_f32 v[28:29], v[28:29], v[22:23], v[22:23] op_sel:[0,0,1] op_sel_hi:[1,0,1]
v_cvt_pk_f16_f32 v109, v26, v27
v_lshlrev_b32 v30, 16, v111
v_and_b32 v31, 0xffff0000, v111
v_pk_fma_f32 v[30:31], v[30:31], v[22:23], v[22:23] op_sel:[0,0,1] op_sel_hi:[1,0,1]
v_cvt_pk_f16_f32 v110, v28, v29
v_lshlrev_b32 v24, 16, v112
v_and_b32 v25, 0xffff0000, v112
v_pk_fma_f32 v[24:25], v[24:25], v[22:23], v[22:23] op_sel:[0,0,1] op_sel_hi:[1,0,1]
v_cvt_pk_f16_f32 v111, v30, v31
v_lshlrev_b32 v26, 16, v113
v_and_b32 v27, 0xffff0000, v113
v_pk_fma_f32 v[26:27], v[26:27], v[22:23], v[22:23] op_sel:[0,0,1] op_sel_hi:[1,0,1]
v_cvt_pk_f16_f32 v112, v24, v25
v_lshlrev_b32 v28, 16, v114
v_and_b32 v29, 0xffff0000, v114
v_pk_fma_f32 v[28:29], v[28:29], v[22:23], v[22:23] op_sel:[0,0,1] op_sel_hi:[1,0,1]
v_cvt_pk_f16_f32 v113, v26, v27
v_lshlrev_b32 v30, 16, v115
v_and_b32 v31, 0xffff0000, v115
v_pk_fma_f32 v[30:31], v[30:31], v[22:23], v[22:23] op_sel:[0,0,1] op_sel_hi:[1,0,1]
v_cvt_pk_f16_f32 v114, v28, v29
v_lshlrev_b32 v24, 16, v116
v_and_b32 v25, 0xffff0000, v116
v_pk_fma_f32 v[24:25], v[24:25], v[22:23], v[22:23] op_sel:[0,0,1] op_sel_hi:[1,0,1]
v_cvt_pk_f16_f32 v115, v30, v31
v_lshlrev_b32 v26, 16, v117
v_and_b32 v27, 0xffff0000, v117
v_pk_fma_f32 v[26:27], v[26:27], v[22:23], v[22:23] op_sel:[0,0,1] op_sel_hi:[1,0,1]
v_cvt_pk_f16_f32 v116, v24, v25
v_lshlrev_b32 v28, 16, v118
v_and_b32 v29, 0xffff0000, v118
v_pk_fma_f32 v[28:29], v[28:29], v[22:23], v[22:23] op_sel:[0,0,1] op_sel_hi:[1,0,1]
v_cvt_pk_f16_f32 v117, v26, v27
v_lshlrev_b32 v30, 16, v119
v_and_b32 v31, 0xffff0000, v119
v_pk_fma_f32 v[30:31], v[30:31], v[22:23], v[22:23] op_sel:[0,0,1] op_sel_hi:[1,0,1]
v_cvt_pk_f16_f32 v118, v28, v29
v_cvt_pk_f16_f32 v119, v30, v31
s_waitcnt vmcnt(9)
s_mov_b32 s55, 0x3f803f80
v_mov_b32 v20, 0
v_mov_b32 v21, 0
v_dot2c_f32_bf16 v20, s55, v120
v_dot2c_f32_bf16 v21, v120, v120
v_dot2c_f32_bf16 v20, s55, v121
v_dot2c_f32_bf16 v21, v121, v121
v_dot2c_f32_bf16 v20, s55, v122
v_dot2c_f32_bf16 v21, v122, v122
v_dot2c_f32_bf16 v20, s55, v123
v_dot2c_f32_bf16 v21, v123, v123
v_dot2c_f32_bf16 v20, s55, v124
v_dot2c_f32_bf16 v21, v124, v124
v_dot2c_f32_bf16 v20, s55, v125
v_dot2c_f32_bf16 v21, v125, v125
v_dot2c_f32_bf16 v20, s55, v126
v_dot2c_f32_bf16 v21, v126, v126
v_dot2c_f32_bf16 v20, s55, v127
v_dot2c_f32_bf16 v21, v127, v127
v_dot2c_f32_bf16 v20, s55, v128
v_dot2c_f32_bf16 v21, v128, v128
v_dot2c_f32_bf16 v20, s55, v129
v_dot2c_f32_bf16 v21, v129, v129
v_dot2c_f32_bf16 v20, s55, v130
v_dot2c_f32_bf16 v21, v130, v130
v_dot2c_f32_bf16 v20, s55, v131
v_dot2c_f32_bf16 v21, v131, v131
v_dot2c_f32_bf16 v20, s55, v132
v_dot2c_f32_bf16 v21, v132, v132
v_dot2c_f32_bf16 v20, s55, v133
v_dot2c_f32_bf16 v21, v133, v133
v_dot2c_f32_bf16 v20, s55, v134
v_dot2c_f32_bf16 v21, v134, v134
v_dot2c_f32_bf16 v20, s55, v135
v_dot2c_f32_bf16 v21, v135, v135
v_dot2c_f32_bf16 v20, s55, v136
v_dot2c_f32_bf16 v21, v136, v136
v_dot2c_f32_bf16 v20, s55, v137
v_dot2c_f32_bf16 v21, v137, v137
v_dot2c_f32_bf16 v20, s55, v138
v_dot2c_f32_bf16 v21, v138, v138
v_dot2c_f32_bf16 v20, s55, v139
v_dot2c_f32_bf16 v21, v139, v139
v_and_b32 v25, 0xffff0000, v120
v_and_b32 v27, 0xffff0000, v121
v_add_f32_dpp v20, v20, v20 row_ror:8 row_mask:0xf bank_mask:0xf
v_add_f32_dpp v21, v21, v21 row_ror:8 row_mask:0xf bank_mask:0xf
v_lshlrev_b32 v24, 16, v120
v_add_f32_dpp v20, v20, v20 row_ror:4 row_mask:0xf bank_mask:0xf
v_add_f32_dpp v21, v21, v21 row_ror:4 row_mask:0xf bank_mask:0xf
v_lshlrev_b32 v26, 16, v121
v_add_f32_dpp v20, v20, v20 row_ror:2 row_mask:0xf bank_mask:0xf
v_add_f32_dpp v21, v21, v21 row_ror:2 row_mask:0xf bank_mask:0xf
v_lshlrev_b32 v28, 16, v122
v_add_f32_dpp v20, v20, v20 row_ror:1 row_mask:0xf bank_mask:0xf
v_add_f32_dpp v21, v21, v21 row_ror:1 row_mask:0xf bank_mask:0xf
v_mul_f32 v20, 0x3acccccd, v20
v_mul_f32 v21, 0x3acccccd, v21
v_fma_f32 v21, -v20, v20, v21
v_max_f32 v21, 0, v21
v_add_f32 v21, 0x3727c5ac, v21
v_rsq_f32 v22, v21
v_and_b32 v29, 0xffff0000, v122
v_mul_f32 v23, -v20, v22
v_pk_fma_f32 v[24:25], v[24:25], v[22:23], v[22:23] op_sel:[0,0,1] op_sel_hi:[1,0,1]
v_pk_fma_f32 v[26:27], v[26:27], v[22:23], v[22:23] op_sel:[0,0,1] op_sel_hi:[1,0,1]
v_cvt_pk_f16_f32 v120, v24, v25
v_pk_fma_f32 v[28:29], v[28:29], v[22:23], v[22:23] op_sel:[0,0,1] op_sel_hi:[1,0,1]
v_cvt_pk_f16_f32 v121, v26, v27
v_lshlrev_b32 v30, 16, v123
v_and_b32 v31, 0xffff0000, v123
v_pk_fma_f32 v[30:31], v[30:31], v[22:23], v[22:23] op_sel:[0,0,1] op_sel_hi:[1,0,1]
v_cvt_pk_f16_f32 v122, v28, v29
v_lshlrev_b32 v24, 16, v124
v_and_b32 v25, 0xffff0000, v124
v_pk_fma_f32 v[24:25], v[24:25], v[22:23], v[22:23] op_sel:[0,0,1] op_sel_hi:[1,0,1]
v_cvt_pk_f16_f32 v123, v30, v31
v_lshlrev_b32 v26, 16, v125
v_and_b32 v27, 0xffff0000, v125
v_pk_fma_f32 v[26:27], v[26:27], v[22:23], v[22:23] op_sel:[0,0,1] op_sel_hi:[1,0,1]
v_cvt_pk_f16_f32 v124, v24, v25
v_lshlrev_b32 v28, 16, v126
v_and_b32 v29, 0xffff0000, v126
v_pk_fma_f32 v[28:29], v[28:29], v[22:23], v[22:23] op_sel:[0,0,1] op_sel_hi:[1,0,1]
v_cvt_pk_f16_f32 v125, v26, v27
v_lshlrev_b32 v30, 16, v127
v_and_b32 v31, 0xffff0000, v127
v_pk_fma_f32 v[30:31], v[30:31], v[22:23], v[22:23] op_sel:[0,0,1] op_sel_hi:[1,0,1]
v_cvt_pk_f16_f32 v126, v28, v29
v_lshlrev_b32 v24, 16, v128
v_and_b32 v25, 0xffff0000, v128
v_pk_fma_f32 v[24:25], v[24:25], v[22:23], v[22:23] op_sel:[0,0,1] op_sel_hi:[1,0,1]
v_cvt_pk_f16_f32 v127, v30, v31
v_lshlrev_b32 v26, 16, v129
v_and_b32 v27, 0xffff0000, v129
v_pk_fma_f32 v[26:27], v[26:27], v[22:23], v[22:23] op_sel:[0,0,1] op_sel_hi:[1,0,1]
v_cvt_pk_f16_f32 v128, v24, v25
v_lshlrev_b32 v28, 16, v130
v_and_b32 v29, 0xffff0000, v130
v_pk_fma_f32 v[28:29], v[28:29], v[22:23], v[22:23] op_sel:[0,0,1] op_sel_hi:[1,0,1]
v_cvt_pk_f16_f32 v129, v26, v27
v_lshlrev_b32 v30, 16, v131
v_and_b32 v31, 0xffff0000, v131
v_pk_fma_f32 v[30:31], v[30:31], v[22:23], v[22:23] op_sel:[0,0,1] op_sel_hi:[1,0,1]
v_cvt_pk_f16_f32 v130, v28, v29
v_lshlrev_b32 v24, 16, v132
v_and_b32 v25, 0xffff0000, v132
v_pk_fma_f32 v[24:25], v[24:25], v[22:23], v[22:23] op_sel:[0,0,1] op_sel_hi:[1,0,1]
v_cvt_pk_f16_f32 v131, v30, v31
v_lshlrev_b32 v26, 16, v133
v_and_b32 v27, 0xffff0000, v133
v_pk_fma_f32 v[26:27], v[26:27], v[22:23], v[22:23] op_sel:[0,0,1] op_sel_hi:[1,0,1]
v_cvt_pk_f16_f32 v132, v24, v25
v_lshlrev_b32 v28, 16, v134
v_and_b32 v29, 0xffff0000, v134
v_pk_fma_f32 v[28:29], v[28:29], v[22:23], v[22:23] op_sel:[0,0,1] op_sel_hi:[1,0,1]
v_cvt_pk_f16_f32 v133, v26, v27
v_lshlrev_b32 v30, 16, v135
v_and_b32 v31, 0xffff0000, v135
v_pk_fma_f32 v[30:31], v[30:31], v[22:23], v[22:23] op_sel:[0,0,1] op_sel_hi:[1,0,1]
v_cvt_pk_f16_f32 v134, v28, v29
v_lshlrev_b32 v24, 16, v136
v_and_b32 v25, 0xffff0000, v136
v_pk_fma_f32 v[24:25], v[24:25], v[22:23], v[22:23] op_sel:[0,0,1] op_sel_hi:[1,0,1]
v_cvt_pk_f16_f32 v135, v30, v31
v_lshlrev_b32 v26, 16, v137
v_and_b32 v27, 0xffff0000, v137
v_pk_fma_f32 v[26:27], v[26:27], v[22:23], v[22:23] op_sel:[0,0,1] op_sel_hi:[1,0,1]
v_cvt_pk_f16_f32 v136, v24, v25
v_lshlrev_b32 v28, 16, v138
v_and_b32 v29, 0xffff0000, v138
v_pk_fma_f32 v[28:29], v[28:29], v[22:23], v[22:23] op_sel:[0,0,1] op_sel_hi:[1,0,1]
v_cvt_pk_f16_f32 v137, v26, v27
v_lshlrev_b32 v30, 16, v139
v_and_b32 v31, 0xffff0000, v139
v_pk_fma_f32 v[30:31], v[30:31], v[22:23], v[22:23] op_sel:[0,0,1] op_sel_hi:[1,0,1]
v_cvt_pk_f16_f32 v138, v28, v29
v_cvt_pk_f16_f32 v139, v30, v31
s_waitcnt vmcnt(5)
buffer_store_dwordx4 v[240:243], v246, s[4:7], s53 offen sc1
buffer_load_dwordx4 v[160:163], v4, s[8:11], s61 offen offset:0
buffer_load_dwordx4 v[164:167], v4, s[8:11], s61 offen offset:256
buffer_load_dwordx4 v[168:171], v4, s[8:11], s61 offen offset:512
buffer_load_dwordx4 v[172:175], v4, s[8:11], s61 offen offset:768
buffer_load_dwordx4 v[176:179], v4, s[8:11], s61 offen offset:1024
s_bfe_u32 s61, s62, 262160
s_mul_i32 s61, s61, 40960
s_add_u32 s61, s61, s45
s_barrier
s_waitcnt vmcnt(6)
s_mov_b32 s55, 0x3f803f80
buffer_load_dwordx4 v[180:183], v4, s[8:11], s61 offen offset:0
v_mov_b32 v20, 0
v_mov_b32 v21, 0
v_dot2c_f32_bf16 v20, s55, v140
v_dot2c_f32_bf16 v21, v140, v140
v_dot2c_f32_bf16 v20, s55, v141
v_dot2c_f32_bf16 v21, v141, v141
v_dot2c_f32_bf16 v20, s55, v142
v_dot2c_f32_bf16 v21, v142, v142
v_dot2c_f32_bf16 v20, s55, v143
v_dot2c_f32_bf16 v21, v143, v143
v_dot2c_f32_bf16 v20, s55, v144
v_dot2c_f32_bf16 v21, v144, v144
v_dot2c_f32_bf16 v20, s55, v145
v_dot2c_f32_bf16 v21, v145, v145
buffer_load_dwordx4 v[184:187], v4, s[8:11], s61 offen offset:256
v_dot2c_f32_bf16 v20, s55, v146
v_dot2c_f32_bf16 v21, v146, v146
v_dot2c_f32_bf16 v20, s55, v147
v_dot2c_f32_bf16 v21, v147, v147
v_dot2c_f32_bf16 v20, s55, v148
v_dot2c_f32_bf16 v21, v148, v148
v_dot2c_f32_bf16 v20, s55, v149
v_dot2c_f32_bf16 v21, v149, v149
v_dot2c_f32_bf16 v20, s55, v150
v_dot2c_f32_bf16 v21, v150, v150
v_dot2c_f32_bf16 v20, s55, v151
v_dot2c_f32_bf16 v21, v151, v151
v_dot2c_f32_bf16 v20, s55, v152
v_dot2c_f32_bf16 v21, v152, v152
buffer_load_dwordx4 v[188:191], v4, s[8:11], s61 offen offset:512
v_dot2c_f32_bf16 v20, s55, v153
v_dot2c_f32_bf16 v21, v153, v153
v_dot2c_f32_bf16 v20, s55, v154
v_dot2c_f32_bf16 v21, v154, v154
v_dot2c_f32_bf16 v20, s55, v155
v_dot2c_f32_bf16 v21, v155, v155
v_dot2c_f32_bf16 v20, s55, v156
v_dot2c_f32_bf16 v21, v156, v156
v_dot2c_f32_bf16 v20, s55, v157
v_dot2c_f32_bf16 v21, v157, v157
v_dot2c_f32_bf16 v20, s55, v158
v_dot2c_f32_bf16 v21, v158, v158
v_dot2c_f32_bf16 v20, s55, v159
buffer_load_dwordx4 v[192:195], v4, s[8:11], s61 offen offset:768
v_dot2c_f32_bf16 v21, v159, v159
v_and_b32 v25, 0xffff0000, v140
v_and_b32 v27, 0xffff0000, v141
v_add_f32_dpp v20, v20, v20 row_ror:8 row_mask:0xf bank_mask:0xf
v_add_f32_dpp v21, v21, v21 row_ror:8 row_mask:0xf bank_mask:0xf
v_lshlrev_b32 v24, 16, v140
v_add_f32_dpp v20, v20, v20 row_ror:4 row_mask:0xf bank_mask:0xf
v_add_f32_dpp v21, v21, v21 row_ror:4 row_mask:0xf bank_mask:0xf
v_lshlrev_b32 v26, 16, v141
v_add_f32_dpp v20, v20, v20 row_ror:2 row_mask:0xf bank_mask:0xf
v_add_f32_dpp v21, v21, v21 row_ror:2 row_mask:0xf bank_mask:0xf
v_lshlrev_b32 v28, 16, v142
v_add_f32_dpp v20, v20, v20 row_ror:1 row_mask:0xf bank_mask:0xf
v_add_f32_dpp v21, v21, v21 row_ror:1 row_mask:0xf bank_mask:0xf
buffer_load_dwordx4 v[196:199], v4, s[8:11], s61 offen offset:1024
v_mul_f32 v20, 0x3acccccd, v20
v_mul_f32 v21, 0x3acccccd, v21
v_fma_f32 v21, -v20, v20, v21
v_max_f32 v21, 0, v21
v_add_f32 v21, 0x3727c5ac, v21
v_rsq_f32 v22, v21
v_and_b32 v29, 0xffff0000, v142
v_mul_f32 v23, -v20, v22
v_pk_fma_f32 v[24:25], v[24:25], v[22:23], v[22:23] op_sel:[0,0,1] op_sel_hi:[1,0,1]
v_pk_fma_f32 v[26:27], v[26:27], v[22:23], v[22:23] op_sel:[0,0,1] op_sel_hi:[1,0,1]
v_cvt_pk_f16_f32 v140, v24, v25
v_pk_fma_f32 v[28:29], v[28:29], v[22:23], v[22:23] op_sel:[0,0,1] op_sel_hi:[1,0,1]
v_cvt_pk_f16_f32 v141, v26, v27
buffer_store_dwordx4 a[232:235], v11, s[4:7], s46 offen sc1
v_lshlrev_b32 v30, 16, v143
v_and_b32 v31, 0xffff0000, v143
v_pk_fma_f32 v[30:31], v[30:31], v[22:23], v[22:23] op_sel:[0,0,1] op_sel_hi:[1,0,1]
v_cvt_pk_f16_f32 v142, v28, v29
v_lshlrev_b32 v24, 16, v144
v_and_b32 v25, 0xffff0000, v144
v_pk_fma_f32 v[24:25], v[24:25], v[22:23], v[22:23] op_sel:[0,0,1] op_sel_hi:[1,0,1]
v_cvt_pk_f16_f32 v143, v30, v31
v_lshlrev_b32 v26, 16, v145
v_and_b32 v27, 0xffff0000, v145
v_pk_fma_f32 v[26:27], v[26:27], v[22:23], v[22:23] op_sel:[0,0,1] op_sel_hi:[1,0,1]
v_cvt_pk_f16_f32 v144, v24, v25
v_lshlrev_b32 v28, 16, v146
v_and_b32 v29, 0xffff0000, v146
buffer_store_dwordx4 a[232:235], v12, s[4:7], s46 offen sc1
v_pk_fma_f32 v[28:29], v[28:29], v[22:23], v[22:23] op_sel:[0,0,1] op_sel_hi:[1,0,1]
v_cvt_pk_f16_f32 v145, v26, v27
v_lshlrev_b32 v30, 16, v147
v_and_b32 v31, 0xffff0000, v147
v_pk_fma_f32 v[30:31], v[30:31], v[22:23], v[22:23] op_sel:[0,0,1] op_sel_hi:[1,0,1]
v_cvt_pk_f16_f32 v146, v28, v29
v_lshlrev_b32 v24, 16, v148
v_and_b32 v25, 0xffff0000, v148
v_pk_fma_f32 v[24:25], v[24:25], v[22:23], v[22:23] op_sel:[0,0,1] op_sel_hi:[1,0,1]
v_cvt_pk_f16_f32 v147, v30, v31
v_lshlrev_b32 v26, 16, v149
v_and_b32 v27, 0xffff0000, v149
v_pk_fma_f32 v[26:27], v[26:27], v[22:23], v[22:23] op_sel:[0,0,1] op_sel_hi:[1,0,1]
v_cvt_pk_f16_f32 v148, v24, v25
buffer_store_dwordx4 a[232:235], v13, s[4:7], s46 offen sc1
v_lshlrev_b32 v28, 16, v150
v_and_b32 v29, 0xffff0000, v150
v_pk_fma_f32 v[28:29], v[28:29], v[22:23], v[22:23] op_sel:[0,0,1] op_sel_hi:[1,0,1]
v_cvt_pk_f16_f32 v149, v26, v27
v_lshlrev_b32 v30, 16, v151
v_and_b32 v31, 0xffff0000, v151
v_pk_fma_f32 v[30:31], v[30:31], v[22:23], v[22:23] op_sel:[0,0,1] op_sel_hi:[1,0,1]
v_cvt_pk_f16_f32 v150, v28, v29
v_lshlrev_b32 v24, 16, v152
v_and_b32 v25, 0xffff0000, v152
v_pk_fma_f32 v[24:25], v[24:25], v[22:23], v[22:23] op_sel:[0,0,1] op_sel_hi:[1,0,1]
v_cvt_pk_f16_f32 v151, v30, v31
v_lshlrev_b32 v26, 16, v153
buffer_store_dwordx4 a[232:235], v14, s[4:7], s46 offen sc1
v_and_b32 v27, 0xffff0000, v153
v_pk_fma_f32 v[26:27], v[26:27], v[22:23], v[22:23] op_sel:[0,0,1] op_sel_hi:[1,0,1]
v_cvt_pk_f16_f32 v152, v24, v25
v_lshlrev_b32 v28, 16, v154
v_and_b32 v29, 0xffff0000, v154
v_pk_fma_f32 v[28:29], v[28:29], v[22:23], v[22:23] op_sel:[0,0,1] op_sel_hi:[1,0,1]
v_cvt_pk_f16_f32 v153, v26, v27
v_lshlrev_b32 v30, 16, v155
v_and_b32 v31, 0xffff0000, v155
v_pk_fma_f32 v[30:31], v[30:31], v[22:23], v[22:23] op_sel:[0,0,1] op_sel_hi:[1,0,1]
v_cvt_pk_f16_f32 v154, v28, v29
v_lshlrev_b32 v24, 16, v156
v_and_b32 v25, 0xffff0000, v156
v_pk_fma_f32 v[24:25], v[24:25], v[22:23], v[22:23] op_sel:[0,0,1] op_sel_hi:[1,0,1]
buffer_store_dwordx4 a[232:235], v246, s[4:7], s18 offen sc1
v_cvt_pk_f16_f32 v155, v30, v31
v_lshlrev_b32 v26, 16, v157
v_and_b32 v27, 0xffff0000, v157
v_pk_fma_f32 v[26:27], v[26:27], v[22:23], v[22:23] op_sel:[0,0,1] op_sel_hi:[1,0,1]
v_cvt_pk_f16_f32 v156, v24, v25
v_lshlrev_b32 v28, 16, v158
v_and_b32 v29, 0xffff0000, v158
v_pk_fma_f32 v[28:29], v[28:29], v[22:23], v[22:23] op_sel:[0,0,1] op_sel_hi:[1,0,1]
v_cvt_pk_f16_f32 v157, v26, v27
v_lshlrev_b32 v30, 16, v159
v_and_b32 v31, 0xffff0000, v159
v_pk_fma_f32 v[30:31], v[30:31], v[22:23], v[22:23] op_sel:[0,0,1] op_sel_hi:[1,0,1]
v_cvt_pk_f16_f32 v158, v28, v29
v_cvt_pk_f16_f32 v159, v30, v31
s_waitcnt vmcnt(10)
s_mov_b32 s55, 0x3f803f80
s_add_u32 m0, s39, 0
s_nop 0
buffer_load_dwordx4 v232, s[24:27], s48 offen offset:0 lds
v_mov_b32 v20, 0
v_mov_b32 v21, 0
v_dot2c_f32_bf16 v20, s55, v160
v_dot2c_f32_bf16 v21, v160, v160
v_dot2c_f32_bf16 v20, s55, v161
v_dot2c_f32_bf16 v21, v161, v161
v_dot2c_f32_bf16 v20, s55, v162
v_dot2c_f32_bf16 v21, v162, v162
v_dot2c_f32_bf16 v20, s55, v163
v_dot2c_f32_bf16 v21, v163, v163
v_dot2c_f32_bf16 v20, s55, v164
v_dot2c_f32_bf16 v21, v164, v164
v_dot2c_f32_bf16 v20, s55, v165
v_dot2c_f32_bf16 v21, v165, v165
v_dot2c_f32_bf16 v20, s55, v166
v_dot2c_f32_bf16 v21, v166, v166
v_dot2c_f32_bf16 v20, s55, v167
v_dot2c_f32_bf16 v21, v167, v167
v_dot2c_f32_bf16 v20, s55, v168
v_dot2c_f32_bf16 v21, v168, v168
v_dot2c_f32_bf16 v20, s55, v169
v_dot2c_f32_bf16 v21, v169, v169
v_dot2c_f32_bf16 v20, s55, v170
buffer_load_dwordx4 v233, s[24:27], s48 offen offset:1024 lds
v_dot2c_f32_bf16 v21, v170, v170
v_dot2c_f32_bf16 v20, s55, v171
v_dot2c_f32_bf16 v21, v171, v171
v_dot2c_f32_bf16 v20, s55, v172
v_dot2c_f32_bf16 v21, v172, v172
v_dot2c_f32_bf16 v20, s55, v173
v_dot2c_f32_bf16 v21, v173, v173
v_dot2c_f32_bf16 v20, s55, v174
v_dot2c_f32_bf16 v21, v174, v174
v_dot2c_f32_bf16 v20, s55, v175
v_dot2c_f32_bf16 v21, v175, v175
v_dot2c_f32_bf16 v20, s55, v176
v_dot2c_f32_bf16 v21, v176, v176
v_dot2c_f32_bf16 v20, s55, v177
v_dot2c_f32_bf16 v21, v177, v177
v_dot2c_f32_bf16 v20, s55, v178
v_dot2c_f32_bf16 v21, v178, v178
v_dot2c_f32_bf16 v20, s55, v179
v_dot2c_f32_bf16 v21, v179, v179
v_and_b32 v25, 0xffff0000, v160
v_and_b32 v27, 0xffff0000, v161
v_add_f32_dpp v20, v20, v20 row_ror:8 row_mask:0xf bank_mask:0xf
v_add_f32_dpp v21, v21, v21 row_ror:8 row_mask:0xf bank_mask:0xf
buffer_load_dwordx4 v234, s[24:27], s48 offen offset:2048 lds
s_add_u32 s48, s48, 81920
v_lshlrev_b32 v24, 16, v160
v_add_f32_dpp v20, v20, v20 row_ror:4 row_mask:0xf bank_mask:0xf
v_add_f32_dpp v21, v21, v21 row_ror:4 row_mask:0xf bank_mask:0xf
v_lshlrev_b32 v26, 16, v161
v_add_f32_dpp v20, v20, v20 row_ror:2 row_mask:0xf bank_mask:0xf
v_add_f32_dpp v21, v21, v21 row_ror:2 row_mask:0xf bank_mask:0xf
v_lshlrev_b32 v28, 16, v162
v_add_f32_dpp v20, v20, v20 row_ror:1 row_mask:0xf bank_mask:0xf
v_add_f32_dpp v21, v21, v21 row_ror:1 row_mask:0xf bank_mask:0xf
v_mul_f32 v20, 0x3acccccd, v20
v_mul_f32 v21, 0x3acccccd, v21
v_fma_f32 v21, -v20, v20, v21
v_max_f32 v21, 0, v21
v_add_f32 v21, 0x3727c5ac, v21
v_rsq_f32 v22, v21
v_and_b32 v29, 0xffff0000, v162
v_mul_f32 v23, -v20, v22
v_pk_fma_f32 v[24:25], v[24:25], v[22:23], v[22:23] op_sel:[0,0,1] op_sel_hi:[1,0,1]
v_pk_fma_f32 v[26:27], v[26:27], v[22:23], v[22:23] op_sel:[0,0,1] op_sel_hi:[1,0,1]
v_cvt_pk_f16_f32 v160, v24, v25
v_pk_fma_f32 v[28:29], v[28:29], v[22:23], v[22:23] op_sel:[0,0,1] op_sel_hi:[1,0,1]
v_cvt_pk_f16_f32 v161, v26, v27
s_add_u32 m0, s39, 12288
s_nop 0
buffer_load_dwordx4 v232, s[24:27], s48 offen offset:0 lds
v_lshlrev_b32 v30, 16, v163
v_and_b32 v31, 0xffff0000, v163
v_pk_fma_f32 v[30:31], v[30:31], v[22:23], v[22:23] op_sel:[0,0,1] op_sel_hi:[1,0,1]
v_cvt_pk_f16_f32 v162, v28, v29
v_lshlrev_b32 v24, 16, v164
v_and_b32 v25, 0xffff0000, v164
v_pk_fma_f32 v[24:25], v[24:25], v[22:23], v[22:23] op_sel:[0,0,1] op_sel_hi:[1,0,1]
v_cvt_pk_f16_f32 v163, v30, v31
v_lshlrev_b32 v26, 16, v165
v_and_b32 v27, 0xffff0000, v165
v_pk_fma_f32 v[26:27], v[26:27], v[22:23], v[22:23] op_sel:[0,0,1] op_sel_hi:[1,0,1]
v_cvt_pk_f16_f32 v164, v24, v25
v_lshlrev_b32 v28, 16, v166
v_and_b32 v29, 0xffff0000, v166
v_pk_fma_f32 v[28:29], v[28:29], v[22:23], v[22:23] op_sel:[0,0,1] op_sel_hi:[1,0,1]
v_cvt_pk_f16_f32 v165, v26, v27
v_lshlrev_b32 v30, 16, v167
v_and_b32 v31, 0xffff0000, v167
v_pk_fma_f32 v[30:31], v[30:31], v[22:23], v[22:23] op_sel:[0,0,1] op_sel_hi:[1,0,1]
v_cvt_pk_f16_f32 v166, v28, v29
v_lshlrev_b32 v24, 16, v168
v_and_b32 v25, 0xffff0000, v168
v_pk_fma_f32 v[24:25], v[24:25], v[22:23], v[22:23] op_sel:[0,0,1] op_sel_hi:[1,0,1]
buffer_load_dwordx4 v233, s[24:27], s48 offen offset:1024 lds
v_cvt_pk_f16_f32 v167, v30, v31
v_lshlrev_b32 v26, 16, v169
v_and_b32 v27, 0xffff0000, v169
v_pk_fma_f32 v[26:27], v[26:27], v[22:23], v[22:23] op_sel:[0,0,1] op_sel_hi:[1,0,1]
v_cvt_pk_f16_f32 v168, v24, v25
v_lshlrev_b32 v28, 16, v170
v_and_b32 v29, 0xffff0000, v170
v_pk_fma_f32 v[28:29], v[28:29], v[22:23], v[22:23] op_sel:[0,0,1] op_sel_hi:[1,0,1]
v_cvt_pk_f16_f32 v169, v26, v27
v_lshlrev_b32 v30, 16, v171
v_and_b32 v31, 0xffff0000, v171
v_pk_fma_f32 v[30:31], v[30:31], v[22:23], v[22:23] op_sel:[0,0,1] op_sel_hi:[1,0,1]
v_cvt_pk_f16_f32 v170, v28, v29
v_lshlrev_b32 v24, 16, v172
v_and_b32 v25, 0xffff0000, v172
v_pk_fma_f32 v[24:25], v[24:25], v[22:23], v[22:23] op_sel:[0,0,1] op_sel_hi:[1,0,1]
v_cvt_pk_f16_f32 v171, v30, v31
v_lshlrev_b32 v26, 16, v173
v_and_b32 v27, 0xffff0000, v173
v_pk_fma_f32 v[26:27], v[26:27], v[22:23], v[22:23] op_sel:[0,0,1] op_sel_hi:[1,0,1]
v_cvt_pk_f16_f32 v172, v24, v25
v_lshlrev_b32 v28, 16, v174
v_and_b32 v29, 0xffff0000, v174
buffer_load_dwordx4 v234, s[24:27], s48 offen offset:2048 lds
s_add_u32 s48, s48, 81920
v_pk_fma_f32 v[28:29], v[28:29], v[22:23], v[22:23] op_sel:[0,0,1] op_sel_hi:[1,0,1]
v_cvt_pk_f16_f32 v173, v26, v27
v_lshlrev_b32 v30, 16, v175
v_and_b32 v31, 0xffff0000, v175
v_pk_fma_f32 v[30:31], v[30:31], v[22:23], v[22:23] op_sel:[0,0,1] op_sel_hi:[1,0,1]
v_cvt_pk_f16_f32 v174, v28, v29
v_lshlrev_b32 v24, 16, v176
v_and_b32 v25, 0xffff0000, v176
v_pk_fma_f32 v[24:25], v[24:25], v[22:23], v[22:23] op_sel:[0,0,1] op_sel_hi:[1,0,1]
v_cvt_pk_f16_f32 v175, v30, v31
v_lshlrev_b32 v26, 16, v177
v_and_b32 v27, 0xffff0000, v177
v_pk_fma_f32 v[26:27], v[26:27], v[22:23], v[22:23] op_sel:[0,0,1] op_sel_hi:[1,0,1]
v_cvt_pk_f16_f32 v176, v24, v25
v_lshlrev_b32 v28, 16, v178
v_and_b32 v29, 0xffff0000, v178
v_pk_fma_f32 v[28:29], v[28:29], v[22:23], v[22:23] op_sel:[0,0,1] op_sel_hi:[1,0,1]
v_cvt_pk_f16_f32 v177, v26, v27
v_lshlrev_b32 v30, 16, v179
v_and_b32 v31, 0xffff0000, v179
v_pk_fma_f32 v[30:31], v[30:31], v[22:23], v[22:23] op_sel:[0,0,1] op_sel_hi:[1,0,1]
v_cvt_pk_f16_f32 v178, v28, v29
v_cvt_pk_f16_f32 v179, v30, v31
buffer_load_dwordx4 v[40:43], v248, s[4:7], s56 offen sc1
s_waitcnt vmcnt(12)
s_mov_b32 s55, 0x3f803f80
v_mov_b32 v20, 0
v_mov_b32 v21, 0
v_dot2c_f32_bf16 v20, s55, v180
v_dot2c_f32_bf16 v21, v180, v180
v_dot2c_f32_bf16 v20, s55, v181
v_dot2c_f32_bf16 v21, v181, v181
v_dot2c_f32_bf16 v20, s55, v182
v_dot2c_f32_bf16 v21, v182, v182
buffer_load_dwordx4 v[44:47], v248, s[4:7], s57 offen sc1
v_dot2c_f32_bf16 v20, s55, v183
v_dot2c_f32_bf16 v21, v183, v183
v_dot2c_f32_bf16 v20, s55, v184
v_dot2c_f32_bf16 v21, v184, v184
v_dot2c_f32_bf16 v20, s55, v185
v_dot2c_f32_bf16 v21, v185, v185
v_dot2c_f32_bf16 v20, s55, v186
v_dot2c_f32_bf16 v21, v186, v186
v_dot2c_f32_bf16 v20, s55, v187
v_dot2c_f32_bf16 v21, v187, v187
v_dot2c_f32_bf16 v20, s55, v188
buffer_load_dwordx4 v[48:51], v248, s[4:7], s58 offen sc1
v_dot2c_f32_bf16 v21, v188, v188
v_dot2c_f32_bf16 v20, s55, v189
v_dot2c_f32_bf16 v21, v189, v189
v_dot2c_f32_bf16 v20, s55, v190
v_dot2c_f32_bf16 v21, v190, v190
v_dot2c_f32_bf16 v20, s55, v191
v_dot2c_f32_bf16 v21, v191, v191
v_dot2c_f32_bf16 v20, s55, v192
v_dot2c_f32_bf16 v21, v192, v192
v_dot2c_f32_bf16 v20, s55, v193
v_dot2c_f32_bf16 v21, v193, v193
buffer_load_dword v52, v249, s[4:7], s56 offen sc1
v_dot2c_f32_bf16 v20, s55, v194
v_dot2c_f32_bf16 v21, v194, v194
v_dot2c_f32_bf16 v20, s55, v195
v_dot2c_f32_bf16 v21, v195, v195
v_dot2c_f32_bf16 v20, s55, v196
v_dot2c_f32_bf16 v21, v196, v196
v_dot2c_f32_bf16 v20, s55, v197
v_dot2c_f32_bf16 v21, v197, v197
v_dot2c_f32_bf16 v20, s55, v198
v_dot2c_f32_bf16 v21, v198, v198
buffer_load_dword v53, v249, s[4:7], s57 offen sc1
v_dot2c_f32_bf16 v20, s55, v199
v_dot2c_f32_bf16 v21, v199, v199
v_and_b32 v25, 0xffff0000, v180
v_and_b32 v27, 0xffff0000, v181
v_add_f32_dpp v20, v20, v20 row_ror:8 row_mask:0xf bank_mask:0xf
v_add_f32_dpp v21, v21, v21 row_ror:8 row_mask:0xf bank_mask:0xf
v_lshlrev_b32 v24, 16, v180
v_add_f32_dpp v20, v20, v20 row_ror:4 row_mask:0xf bank_mask:0xf
v_add_f32_dpp v21, v21, v21 row_ror:4 row_mask:0xf bank_mask:0xf
v_lshlrev_b32 v26, 16, v181
v_add_f32_dpp v20, v20, v20 row_ror:2 row_mask:0xf bank_mask:0xf
buffer_load_dword v54, v249, s[4:7], s58 offen sc1
v_add_f32_dpp v21, v21, v21 row_ror:2 row_mask:0xf bank_mask:0xf
v_lshlrev_b32 v28, 16, v182
v_add_f32_dpp v20, v20, v20 row_ror:1 row_mask:0xf bank_mask:0xf
v_add_f32_dpp v21, v21, v21 row_ror:1 row_mask:0xf bank_mask:0xf
v_mul_f32 v20, 0x3acccccd, v20
v_mul_f32 v21, 0x3acccccd, v21
v_fma_f32 v21, -v20, v20, v21
v_max_f32 v21, 0, v21
v_add_f32 v21, 0x3727c5ac, v21
v_rsq_f32 v22, v21
v_and_b32 v29, 0xffff0000, v182
buffer_load_dword v71, v247, s[4:7], s60 offen sc1
v_mul_f32 v23, -v20, v22
v_pk_fma_f32 v[24:25], v[24:25], v[22:23], v[22:23] op_sel:[0,0,1] op_sel_hi:[1,0,1]
v_pk_fma_f32 v[26:27], v[26:27], v[22:23], v[22:23] op_sel:[0,0,1] op_sel_hi:[1,0,1]
v_cvt_pk_f16_f32 v180, v24, v25
v_pk_fma_f32 v[28:29], v[28:29], v[22:23], v[22:23] op_sel:[0,0,1] op_sel_hi:[1,0,1]
v_cvt_pk_f16_f32 v181, v26, v27
v_lshlrev_b32 v30, 16, v183
v_and_b32 v31, 0xffff0000, v183
v_pk_fma_f32 v[30:31], v[30:31], v[22:23], v[22:23] op_sel:[0,0,1] op_sel_hi:[1,0,1]
v_cvt_pk_f16_f32 v182, v28, v29
s_add_u32 m0, s39, 24576
s_nop 0
buffer_load_dwordx4 v232, s[24:27], s48 offen offset:0 lds
v_lshlrev_b32 v24, 16, v184
v_and_b32 v25, 0xffff0000, v184
v_pk_fma_f32 v[24:25], v[24:25], v[22:23], v[22:23] op_sel:[0,0,1] op_sel_hi:[1,0,1]
v_cvt_pk_f16_f32 v183, v30, v31
v_lshlrev_b32 v26, 16, v185
v_and_b32 v27, 0xffff0000, v185
v_pk_fma_f32 v[26:27], v[26:27], v[22:23], v[22:23] op_sel:[0,0,1] op_sel_hi:[1,0,1]
v_cvt_pk_f16_f32 v184, v24, v25
v_lshlrev_b32 v28, 16, v186
v_and_b32 v29, 0xffff0000, v186
v_pk_fma_f32 v[28:29], v[28:29], v[22:23], v[22:23] op_sel:[0,0,1] op_sel_hi:[1,0,1]
buffer_load_dwordx4 v233, s[24:27], s48 offen offset:1024 lds
v_cvt_pk_f16_f32 v185, v26, v27
v_lshlrev_b32 v30, 16, v187
v_and_b32 v31, 0xffff0000, v187
v_pk_fma_f32 v[30:31], v[30:31], v[22:23], v[22:23] op_sel:[0,0,1] op_sel_hi:[1,0,1]
v_cvt_pk_f16_f32 v186, v28, v29
v_lshlrev_b32 v24, 16, v188
v_and_b32 v25, 0xffff0000, v188
v_pk_fma_f32 v[24:25], v[24:25], v[22:23], v[22:23] op_sel:[0,0,1] op_sel_hi:[1,0,1]
v_cvt_pk_f16_f32 v187, v30, v31
v_lshlrev_b32 v26, 16, v189
v_and_b32 v27, 0xffff0000, v189
buffer_load_dwordx4 v234, s[24:27], s48 offen offset:2048 lds
s_add_u32 s48, s48, 81920
v_pk_fma_f32 v[26:27], v[26:27], v[22:23], v[22:23] op_sel:[0,0,1] op_sel_hi:[1,0,1]
v_cvt_pk_f16_f32 v188, v24, v25
v_lshlrev_b32 v28, 16, v190
v_and_b32 v29, 0xffff0000, v190
v_pk_fma_f32 v[28:29], v[28:29], v[22:23], v[22:23] op_sel:[0,0,1] op_sel_hi:[1,0,1]
v_cvt_pk_f16_f32 v189, v26, v27
v_lshlrev_b32 v30, 16, v191
v_and_b32 v31, 0xffff0000, v191
v_pk_fma_f32 v[30:31], v[30:31], v[22:23], v[22:23] op_sel:[0,0,1] op_sel_hi:[1,0,1]
v_cvt_pk_f16_f32 v190, v28, v29
s_add_u32 m0, s39, 36864
s_nop 0
buffer_load_dwordx4 v232, s[24:27], s48 offen offset:0 lds
v_lshlrev_b32 v24, 16, v192
v_and_b32 v25, 0xffff0000, v192
v_pk_fma_f32 v[24:25], v[24:25], v[22:23], v[22:23] op_sel:[0,0,1] op_sel_hi:[1,0,1]
v_cvt_pk_f16_f32 v191, v30, v31
v_lshlrev_b32 v26, 16, v193
v_and_b32 v27, 0xffff0000, v193
v_pk_fma_f32 v[26:27], v[26:27], v[22:23], v[22:23] op_sel:[0,0,1] op_sel_hi:[1,0,1]
v_cvt_pk_f16_f32 v192, v24, v25
v_lshlrev_b32 v28, 16, v194
v_and_b32 v29, 0xffff0000, v194
v_pk_fma_f32 v[28:29], v[28:29], v[22:23], v[22:23] op_sel:[0,0,1] op_sel_hi:[1,0,1]
buffer_load_dwordx4 v233, s[24:27], s48 offen offset:1024 lds
v_cvt_pk_f16_f32 v193, v26, v27
v_lshlrev_b32 v30, 16, v195
v_and_b32 v31, 0xffff0000, v195
v_pk_fma_f32 v[30:31], v[30:31], v[22:23], v[22:23] op_sel:[0,0,1] op_sel_hi:[1,0,1]
v_cvt_pk_f16_f32 v194, v28, v29
v_lshlrev_b32 v24, 16, v196
v_and_b32 v25, 0xffff0000, v196
v_pk_fma_f32 v[24:25], v[24:25], v[22:23], v[22:23] op_sel:[0,0,1] op_sel_hi:[1,0,1]
v_cvt_pk_f16_f32 v195, v30, v31
v_lshlrev_b32 v26, 16, v197
v_and_b32 v27, 0xffff0000, v197
buffer_load_dwordx4 v234, s[24:27], s48 offen offset:2048 lds
s_add_u32 s48, s48, 81920
v_pk_fma_f32 v[26:27], v[26:27], v[22:23], v[22:23] op_sel:[0,0,1] op_sel_hi:[1,0,1]
v_cvt_pk_f16_f32 v196, v24, v25
v_lshlrev_b32 v28, 16, v198
v_and_b32 v29, 0xffff0000, v198
v_pk_fma_f32 v[28:29], v[28:29], v[22:23], v[22:23] op_sel:[0,0,1] op_sel_hi:[1,0,1]
v_cvt_pk_f16_f32 v197, v26, v27
v_lshlrev_b32 v30, 16, v199
v_and_b32 v31, 0xffff0000, v199
v_pk_fma_f32 v[30:31], v[30:31], v[22:23], v[22:23] op_sel:[0,0,1] op_sel_hi:[1,0,1]
v_cvt_pk_f16_f32 v198, v28, v29
v_cvt_pk_f16_f32 v199, v30, v31
L_bodyj:
s_and_b32 s12, s40, 0xff
s_bfe_u32 s13, s40, 0x80008
s_bfe_u32 s14, s40, 0x80010
s_lshr_b32 s15, s40, 24
s_waitcnt vmcnt(7)
v_xor_b32 v40, s12, v40
v_xor_b32 v41, s13, v41
v_xor_b32 v42, s14, v42
v_xor_b32 v43, s15, v43
v_xor_b32 v44, s12, v44
v_xor_b32 v45, s13, v45
v_xor_b32 v46, s14, v46
v_xor_b32 v47, s15, v47
v_xor_b32 v48, s12, v48
v_xor_b32 v49, s13, v49
v_xor_b32 v50, s14, v50
v_xor_b32 v51, s15, v51
v_xor_b32 v52, v19, v52
v_xor_b32 v53, v19, v53
v_xor_b32 v54, v19, v54
v_or3_b32 v64, v40, v41, v42
v_or3_b32 v65, v43, v44, v45
v_or3_b32 v64, v64, v46, v47
v_or3_b32 v65, v65, v48, v49
v_or3_b32 v64, v64, v50, v51
v_or3_b32 v65, v65, v52, v53
v_or3_b32 v64, v64, v65, v54
v_and_b32 v64, 0xff, v64
v_cmp_ne_u32 vcc, 0, v64
s_cbranch_vccnz L_ga_retry
L_ga_ok:
v_pk_add_f32 v[40:41], v[40:41], v[44:45]
v_pk_add_f32 v[42:43], v[42:43], v[46:47]
v_add_f32 v52, v52, v53
v_pk_add_f32 v[40:41], v[40:41], v[48:49]
v_pk_add_f32 v[42:43], v[42:43], v[50:51]
v_add_f32 v52, v52, v54
v_cvt_pk_bf16_f32 v44, v40, v41
v_cvt_pk_bf16_f32 v45, v42, v43
v_cvt_pk_bf16_f32 v52, v52, v52
v_lshlrev_b32 v40, 16, v44
v_and_b32 v41, 0xffff0000, v44
v_lshlrev_b32 v42, 16, v45
v_and_b32 v43, 0xffff0000, v45
v_lshlrev_b32 v52, 16, v52
v_pk_add_f32 v[40:41], v[40:41], v[252:253] op_sel_hi:[1,0]
v_pk_add_f32 v[42:43], v[42:43], v[252:253] op_sel_hi:[1,0]
v_add_f32 v52, v52, v252
v_cvt_pk_bf16_f32 v44, v40, v41
v_cvt_pk_bf16_f32 v45, v42, v43
v_cvt_pk_bf16_f32 v52, v52, v52
v_lshlrev_b32 v40, 16, v44
v_and_b32 v41, 0xffff0000, v44
v_lshlrev_b32 v42, 16, v45
v_and_b32 v43, 0xffff0000, v45
v_lshlrev_b32 v52, 16, v52
ds_write_b128 v251, v[40:43]
ds_write_b32 v250, v52
s_waitcnt vmcnt(6)
v_cmp_ne_u32 vcc, s40, v71
s_cbranch_vccnz L_fg_retry
L_fg_ok:
s_waitcnt lgkmcnt(0)
s_barrier
buffer_load_dwordx4 a[40:43], v5, s[4:7], s59 offen offset:0 sc1
ds_read_b128 v[200:203], v10 offset:2560
ds_read_b128 v[204:207], v10 offset:2576
ds_read_b128 v[208:211], v10 offset:0
ds_read_b128 v[212:215], v10 offset:16
s_mul_i32 s52, s96, 192
s_mul_i32 s49, s3, 3072
s_lshl_b32 s53, s47, 2
buffer_load_dwordx4 a[44:47], v5, s[4:7], s59 offen offset:256 sc1
s_add_u32 s53, s53, s3
s_and_b32 s50, s53, 63
s_waitcnt lgkmcnt(0)
v_fma_mix_f32 v216, v100, v200, v208 op_sel:[0,0,0] op_sel_hi:[1,0,0]
v_fma_mix_f32 v217, v100, v201, v209 op_sel:[1,0,0] op_sel_hi:[1,0,0]
v_cvt_pk_bf16_f32 v220, v216, v217
v_fma_mix_f32 v218, v101, v202, v210 op_sel:[0,0,0] op_sel_hi:[1,0,0]
v_fma_mix_f32 v219, v101, v203, v211 op_sel:[1,0,0] op_sel_hi:[1,0,0]
buffer_load_dwordx4 a[48:51], v5, s[4:7], s59 offen offset:512 sc1
v_cvt_pk_bf16_f32 v221, v218, v219
v_fma_mix_f32 v216, v102, v204, v212 op_sel:[0,0,0] op_sel_hi:[1,0,0]
v_fma_mix_f32 v217, v102, v205, v213 op_sel:[1,0,0] op_sel_hi:[1,0,0]
v_cvt_pk_bf16_f32 v222, v216, v217
v_fma_mix_f32 v218, v103, v206, v214 op_sel:[0,0,0] op_sel_hi:[1,0,0]
v_fma_mix_f32 v219, v103, v207, v215 op_sel:[1,0,0] op_sel_hi:[1,0,0]
v_cvt_pk_bf16_f32 v223, v218, v219
ds_write_b128 v7, v[220:223] offset:0
buffer_load_dwordx4 a[52:55], v6, s[4:7], s59 offen offset:768 sc1
s_add_u32 s59, s59, 16384
v_fma_mix_f32 v216, v120, v200, v208 op_sel:[0,0,0] op_sel_hi:[1,0,0]
v_fma_mix_f32 v217, v120, v201, v209 op_sel:[1,0,0] op_sel_hi:[1,0,0]
v_cvt_pk_bf16_f32 v224, v216, v217
v_fma_mix_f32 v218, v121, v202, v210 op_sel:[0,0,0] op_sel_hi:[1,0,0]
v_fma_mix_f32 v219, v121, v203, v211 op_sel:[1,0,0] op_sel_hi:[1,0,0]
v_cvt_pk_bf16_f32 v225, v218, v219
v_fma_mix_f32 v216, v122, v204, v212 op_sel:[0,0,0] op_sel_hi:[1,0,0]
v_fma_mix_f32 v217, v122, v205, v213 op_sel:[1,0,0] op_sel_hi:[1,0,0]
buffer_load_dwordx4 a[56:59], v5, s[4:7], s59 offen offset:0 sc1
v_cvt_pk_bf16_f32 v226, v216, v217
v_fma_mix_f32 v218, v123, v206, v214 op_sel:[0,0,0] op_sel_hi:[1,0,0]
v_fma_mix_f32 v219, v123, v207, v215 op_sel:[1,0,0] op_sel_hi:[1,0,0]
v_cvt_pk_bf16_f32 v227, v218, v219
ds_write_b128 v253, v[224:227] offset:0
v_fma_mix_f32 v216, v140, v200, v208 op_sel:[0,0,0] op_sel_hi:[1,0,0]
v_fma_mix_f32 v217, v140, v201, v209 op_sel:[1,0,0] op_sel_hi:[1,0,0]
v_cvt_pk_bf16_f32 v220, v216, v217
buffer_load_dwordx4 a[60:63], v5, s[4:7], s59 offen offset:256 sc1
v_fma_mix_f32 v218, v141, v202, v210 op_sel:[0,0,0] op_sel_hi:[1,0,0]
v_fma_mix_f32 v219, v141, v203, v211 op_sel:[1,0,0] op_sel_hi:[1,0,0]
v_cvt_pk_bf16_f32 v221, v218, v219
v_fma_mix_f32 v216, v142, v204, v212 op_sel:[0,0,0] op_sel_hi:[1,0,0]
v_fma_mix_f32 v217, v142, v205, v213 op_sel:[1,0,0] op_sel_hi:[1,0,0]
v_cvt_pk_bf16_f32 v222, v216, v217
v_fma_mix_f32 v218, v143, v206, v214 op_sel:[0,0,0] op_sel_hi:[1,0,0]
v_fma_mix_f32 v219, v143, v207, v215 op_sel:[1,0,0] op_sel_hi:[1,0,0]
buffer_load_dwordx4 a[64:67], v5, s[4:7], s59 offen offset:512 sc1
v_cvt_pk_bf16_f32 v223, v218, v219
ds_write_b128 v254, v[220:223] offset:0
v_fma_mix_f32 v216, v160, v200, v208 op_sel:[0,0,0] op_sel_hi:[1,0,0]
v_fma_mix_f32 v217, v160, v201, v209 op_sel:[1,0,0] op_sel_hi:[1,0,0]
v_cvt_pk_bf16_f32 v224, v216, v217
v_fma_mix_f32 v218, v161, v202, v210 op_sel:[0,0,0] op_sel_hi:[1,0,0]
v_fma_mix_f32 v219, v161, v203, v211 op_sel:[1,0,0] op_sel_hi:[1,0,0]
v_cvt_pk_bf16_f32 v225, v218, v219
buffer_load_dwordx4 a[68:71], v6, s[4:7], s59 offen offset:768 sc1
s_add_u32 s59, s59, 16384
v_fma_mix_f32 v216, v162, v204, v212 op_sel:[0,0,0] op_sel_hi:[1,0,0]
v_fma_mix_f32 v217, v162, v205, v213 op_sel:[1,0,0] op_sel_hi:[1,0,0]
v_cvt_pk_bf16_f32 v226, v216, v217
v_fma_mix_f32 v218, v163, v206, v214 op_sel:[0,0,0] op_sel_hi:[1,0,0]
v_fma_mix_f32 v219, v163, v207, v215 op_sel:[1,0,0] op_sel_hi:[1,0,0]
v_cvt_pk_bf16_f32 v227, v218, v219
ds_write_b128 v244, v[224:227] offset:0
v_fma_mix_f32 v216, v180, v200, v208 op_sel:[0,0,0] op_sel_hi:[1,0,0]
buffer_load_dwordx4 a[72:75], v5, s[4:7], s59 offen offset:0 sc1
v_fma_mix_f32 v217, v180, v201, v209 op_sel:[1,0,0] op_sel_hi:[1,0,0]
v_cvt_pk_bf16_f32 v220, v216, v217
v_fma_mix_f32 v218, v181, v202, v210 op_sel:[0,0,0] op_sel_hi:[1,0,0]
v_fma_mix_f32 v219, v181, v203, v211 op_sel:[1,0,0] op_sel_hi:[1,0,0]
v_cvt_pk_bf16_f32 v221, v218, v219
v_fma_mix_f32 v216, v182, v204, v212 op_sel:[0,0,0] op_sel_hi:[1,0,0]
v_fma_mix_f32 v217, v182, v205, v213 op_sel:[1,0,0] op_sel_hi:[1,0,0]
v_cvt_pk_bf16_f32 v222, v216, v217
buffer_load_dwordx4 a[76:79], v5, s[4:7], s59 offen offset:256 sc1
v_fma_mix_f32 v218, v183, v206, v214 op_sel:[0,0,0] op_sel_hi:[1,0,0]
v_fma_mix_f32 v219, v183, v207, v215 op_sel:[1,0,0] op_sel_hi:[1,0,0]
v_cvt_pk_bf16_f32 v223, v218, v219
ds_write_b128 v245, v[220:223] offset:0
ds_read_b128 v[200:203], v10 offset:3072
ds_read_b128 v[204:207], v10 offset:3088
ds_read_b128 v[208:211], v10 offset:512
ds_read_b128 v[212:215], v10 offset:528
s_lshl_b32 s50, s50, 5
s_lshr_b32 s54, s53, 6
s_add_u32 s54, s50, s54
s_mul_i32 s50, s54, 1280
s_add_u32 s50, s50, s52
s_lshl_b32 s51, s52, 1
s_add_u32 s51, s51, 65536
s_add_u32 s22, s51, 5120
s_mov_b32 s23, 917504
s_mul_i32 s12, s3, 2304
s_add_u32 s12, s12, 152320
s_add_u32 s13, s49, 122880
s_waitcnt lgkmcnt(4)
s_barrier
ds_read_b128 a[0:3], v8 offset:0
ds_read_b128 a[4:7], v8 offset:1024
ds_read_b128 a[8:11], v8 offset:2048
ds_read_b128 a[12:15], v8 offset:3072
ds_read_b128 a[16:19], v8 offset:4096
s_lshl_b32 s14, s53, 11
s_add_u32 s14, s14, 131072
s_mul_i32 s61, s3, 40
s_add_u32 s61, s61, 138240
s_waitcnt vmcnt(6) lgkmcnt(0)
v_mfma_f32_16x16x32_bf16 v[20:23], a[40:43], a[0:3], 0
ds_read_b128 a[20:23], v9 offset:5120
v_fma_mix_f32 v216, v104, v200, v208 op_sel:[0,0,0] op_sel_hi:[1,0,0]
v_mfma_f32_16x16x32_bf16 v[24:27], a[44:47], a[0:3], 0
buffer_load_dwordx4 a[80:83], v5, s[4:7], s59 offen offset:512 sc1
v_fma_mix_f32 v217, v104, v201, v209 op_sel:[1,0,0] op_sel_hi:[1,0,0]
v_mfma_f32_16x16x32_bf16 v[28:31], a[0:3], a[48:51], 0
ds_read_b128 a[24:27], v9 offset:6144
v_cvt_pk_bf16_f32 v220, v216, v217
v_mfma_f32_16x16x32_bf16 v[32:35], a[52:55], a[0:3], 0
ds_read_b128 a[28:31], v9 offset:7168
v_fma_mix_f32 v218, v105, v202, v210 op_sel:[0,0,0] op_sel_hi:[1,0,0]
v_mfma_f32_16x16x32_bf16 v[36:39], a[40:43], a[4:7], 0
ds_read_b128 a[32:35], v9 offset:8192
v_fma_mix_f32 v219, v105, v203, v211 op_sel:[1,0,0] op_sel_hi:[1,0,0]
v_mfma_f32_16x16x32_bf16 v[40:43], a[44:47], a[4:7], 0
buffer_load_dwordx4 a[84:87], v6, s[4:7], s59 offen offset:768 sc1
s_add_u32 s59, s59, 16384
v_mfma_f32_16x16x32_bf16 v[44:47], a[4:7], a[48:51], 0
ds_read_b128 a[36:39], v9 offset:9216
v_cvt_pk_bf16_f32 v221, v218, v219
v_mfma_f32_16x16x32_bf16 v[48:51], a[52:55], a[4:7], 0
v_fma_mix_f32 v216, v106, v204, v212 op_sel:[0,0,0] op_sel_hi:[1,0,0]
v_fma_mix_f32 v217, v106, v205, v213 op_sel:[1,0,0] op_sel_hi:[1,0,0]
v_mfma_f32_16x16x32_bf16 v[52:55], a[40:43], a[8:11], 0
ds_write_b64 v7, v[220:221] offset:20480
v_mfma_f32_16x16x32_bf16 v[56:59], a[44:47], a[8:11], 0
buffer_load_dwordx4 a[88:91], v5, s[4:7], s59 offen offset:0 sc1
v_cvt_pk_bf16_f32 v222, v216, v217
v_mfma_f32_16x16x32_bf16 v[60:63], a[8:11], a[48:51], 0
v_fma_mix_f32 v218, v107, v206, v214 op_sel:[0,0,0] op_sel_hi:[1,0,0]
v_fma_mix_f32 v219, v107, v207, v215 op_sel:[1,0,0] op_sel_hi:[1,0,0]
v_mfma_f32_16x16x32_bf16 v[64:67], a[52:55], a[8:11], 0
v_cvt_pk_bf16_f32 v223, v218, v219
v_fma_mix_f32 v216, v124, v200, v208 op_sel:[0,0,0] op_sel_hi:[1,0,0]
v_mfma_f32_16x16x32_bf16 v[68:71], a[40:43], a[12:15], 0
v_fma_mix_f32 v217, v124, v201, v209 op_sel:[1,0,0] op_sel_hi:[1,0,0]
v_cvt_pk_bf16_f32 v224, v216, v217
v_mfma_f32_16x16x32_bf16 v[72:75], a[44:47], a[12:15], 0
buffer_load_dwordx4 a[92:95], v5, s[4:7], s59 offen offset:256 sc1
v_fma_mix_f32 v218, v125, v202, v210 op_sel:[0,0,0] op_sel_hi:[1,0,0]
v_mfma_f32_16x16x32_bf16 v[76:79], a[12:15], a[48:51], 0
ds_write_b64 v7, v[222:223] offset:20488
v_mfma_f32_16x16x32_bf16 v[80:83], a[52:55], a[12:15], 0
v_fma_mix_f32 v219, v125, v203, v211 op_sel:[1,0,0] op_sel_hi:[1,0,0]
v_cvt_pk_bf16_f32 v225, v218, v219
v_mfma_f32_16x16x32_bf16 v[84:87], a[40:43], a[16:19], 0
v_fma_mix_f32 v216, v126, v204, v212 op_sel:[0,0,0] op_sel_hi:[1,0,0]
v_fma_mix_f32 v217, v126, v205, v213 op_sel:[1,0,0] op_sel_hi:[1,0,0]
v_mfma_f32_16x16x32_bf16 v[88:91], a[44:47], a[16:19], 0
ds_write_b64 v253, v[224:225] offset:20480
v_mfma_f32_16x16x32_bf16 v[92:95], a[16:19], a[48:51], 0
v_cvt_pk_bf16_f32 v226, v216, v217
v_fma_mix_f32 v218, v127, v206, v214 op_sel:[0,0,0] op_sel_hi:[1,0,0]
v_mfma_f32_16x16x32_bf16 v[96:99], a[52:55], a[16:19], 0
s_waitcnt vmcnt(6) lgkmcnt(3)
v_fma_mix_f32 v219, v127, v207, v215 op_sel:[1,0,0] op_sel_hi:[1,0,0]
v_cvt_pk_bf16_f32 v227, v218, v219
v_mfma_f32_16x16x32_bf16 v[20:23], a[56:59], a[20:23], v[20:23]
ds_read_b128 a[0:3], v8 offset:10240
v_fma_mix_f32 v216, v144, v200, v208 op_sel:[0,0,0] op_sel_hi:[1,0,0]
v_mfma_f32_16x16x32_bf16 v[24:27], a[60:63], a[20:23], v[24:27]
buffer_load_dwordx4 a[96:99], v5, s[4:7], s59 offen offset:512 sc1
v_fma_mix_f32 v217, v144, v201, v209 op_sel:[1,0,0] op_sel_hi:[1,0,0]
v_mfma_f32_16x16x32_bf16 v[28:31], a[20:23], a[64:67], v[28:31]
ds_read_b128 a[4:7], v8 offset:11264
v_cvt_pk_bf16_f32 v220, v216, v217
v_mfma_f32_16x16x32_bf16 v[32:35], a[68:71], a[20:23], v[32:35]
ds_read_b128 a[8:11], v8 offset:12288
v_fma_mix_f32 v218, v145, v202, v210 op_sel:[0,0,0] op_sel_hi:[1,0,0]
v_mfma_f32_16x16x32_bf16 v[36:39], a[56:59], a[24:27], v[36:39]
ds_read_b128 a[12:15], v8 offset:13312
v_fma_mix_f32 v219, v145, v203, v211 op_sel:[1,0,0] op_sel_hi:[1,0,0]
v_mfma_f32_16x16x32_bf16 v[40:43], a[60:63], a[24:27], v[40:43]
buffer_load_dwordx4 a[100:103], v6, s[4:7], s59 offen offset:768 sc1
s_add_u32 s59, s59, 16384
v_mfma_f32_16x16x32_bf16 v[44:47], a[24:27], a[64:67], v[44:47]
ds_read_b128 a[16:19], v8 offset:14336
v_cvt_pk_bf16_f32 v221, v218, v219
v_mfma_f32_16x16x32_bf16 v[48:51], a[68:71], a[24:27], v[48:51]
ds_write_b64 v253, v[226:227] offset:20488
v_mfma_f32_16x16x32_bf16 v[52:55], a[56:59], a[28:31], v[52:55]
v_fma_mix_f32 v216, v146, v204, v212 op_sel:[0,0,0] op_sel_hi:[1,0,0]
v_fma_mix_f32 v217, v146, v205, v213 op_sel:[1,0,0] op_sel_hi:[1,0,0]
v_mfma_f32_16x16x32_bf16 v[56:59], a[60:63], a[28:31], v[56:59]
buffer_load_dwordx4 a[104:107], v5, s[4:7], s59 offen offset:0 sc1
v_cvt_pk_bf16_f32 v222, v216, v217
v_mfma_f32_16x16x32_bf16 v[60:63], a[28:31], a[64:67], v[60:63]
ds_write_b64 v254, v[220:221] offset:20480
v_mfma_f32_16x16x32_bf16 v[64:67], a[68:71], a[28:31], v[64:67]
v_fma_mix_f32 v218, v147, v206, v214 op_sel:[0,0,0] op_sel_hi:[1,0,0]
v_fma_mix_f32 v219, v147, v207, v215 op_sel:[1,0,0] op_sel_hi:[1,0,0]
v_mfma_f32_16x16x32_bf16 v[68:71], a[56:59], a[32:35], v[68:71]
v_cvt_pk_bf16_f32 v223, v218, v219
v_fma_mix_f32 v216, v164, v200, v208 op_sel:[0,0,0] op_sel_hi:[1,0,0]
v_mfma_f32_16x16x32_bf16 v[72:75], a[60:63], a[32:35], v[72:75]
buffer_load_dwordx4 a[108:111], v5, s[4:7], s59 offen offset:256 sc1
v_fma_mix_f32 v217, v164, v201, v209 op_sel:[1,0,0] op_sel_hi:[1,0,0]
v_mfma_f32_16x16x32_bf16 v[76:79], a[32:35], a[64:67], v[76:79]
ds_write_b64 v254, v[222:223] offset:20488
v_mfma_f32_16x16x32_bf16 v[80:83], a[68:71], a[32:35], v[80:83]
v_cvt_pk_bf16_f32 v224, v216, v217
v_fma_mix_f32 v218, v165, v202, v210 op_sel:[0,0,0] op_sel_hi:[1,0,0]
v_mfma_f32_16x16x32_bf16 v[84:87], a[56:59], a[36:39], v[84:87]
v_fma_mix_f32 v219, v165, v203, v211 op_sel:[1,0,0] op_sel_hi:[1,0,0]
v_cvt_pk_bf16_f32 v225, v218, v219
v_mfma_f32_16x16x32_bf16 v[88:91], a[60:63], a[36:39], v[88:91]
buffer_load_dwordx4 a[112:115], v5, s[4:7], s59 offen offset:512 sc1
v_fma_mix_f32 v216, v166, v204, v212 op_sel:[0,0,0] op_sel_hi:[1,0,0]
v_mfma_f32_16x16x32_bf16 v[92:95], a[36:39], a[64:67], v[92:95]
ds_write_b64 v244, v[224:225] offset:20480
v_mfma_f32_16x16x32_bf16 v[96:99], a[68:71], a[36:39], v[96:99]
s_waitcnt vmcnt(7) lgkmcnt(4)
v_fma_mix_f32 v217, v166, v205, v213 op_sel:[1,0,0] op_sel_hi:[1,0,0]
v_cvt_pk_bf16_f32 v226, v216, v217
v_mfma_f32_16x16x32_bf16 v[20:23], a[72:75], a[0:3], v[20:23]
ds_read_b128 a[20:23], v9 offset:15360
v_fma_mix_f32 v218, v167, v206, v214 op_sel:[0,0,0] op_sel_hi:[1,0,0]
v_mfma_f32_16x16x32_bf16 v[24:27], a[76:79], a[0:3], v[24:27]
buffer_load_dwordx4 a[116:119], v6, s[4:7], s59 offen offset:768 sc1
s_add_u32 s59, s59, 16384
v_mfma_f32_16x16x32_bf16 v[28:31], a[0:3], a[80:83], v[28:31]
ds_read_b128 a[24:27], v9 offset:16384
v_fma_mix_f32 v219, v167, v207, v215 op_sel:[1,0,0] op_sel_hi:[1,0,0]
v_mfma_f32_16x16x32_bf16 v[32:35], a[84:87], a[0:3], v[32:35]
ds_read_b128 a[28:31], v9 offset:17408
v_cvt_pk_bf16_f32 v227, v218, v219
v_mfma_f32_16x16x32_bf16 v[36:39], a[72:75], a[4:7], v[36:39]
ds_read_b128 a[32:35], v9 offset:18432
v_fma_mix_f32 v216, v184, v200, v208 op_sel:[0,0,0] op_sel_hi:[1,0,0]
v_mfma_f32_16x16x32_bf16 v[40:43], a[76:79], a[4:7], v[40:43]
buffer_load_dwordx4 a[120:123], v5, s[4:7], s59 offen offset:0 sc1
v_fma_mix_f32 v217, v184, v201, v209 op_sel:[1,0,0] op_sel_hi:[1,0,0]
v_mfma_f32_16x16x32_bf16 v[44:47], a[4:7], a[80:83], v[44:47]
ds_read_b128 a[36:39], v9 offset:19456
v_cvt_pk_bf16_f32 v220, v216, v217
v_mfma_f32_16x16x32_bf16 v[48:51], a[84:87], a[4:7], v[48:51]
ds_write_b64 v244, v[226:227] offset:20488
v_mfma_f32_16x16x32_bf16 v[52:55], a[72:75], a[8:11], v[52:55]
v_fma_mix_f32 v218, v185, v202, v210 op_sel:[0,0,0] op_sel_hi:[1,0,0]
v_fma_mix_f32 v219, v185, v203, v211 op_sel:[1,0,0] op_sel_hi:[1,0,0]
v_mfma_f32_16x16x32_bf16 v[56:59], a[76:79], a[8:11], v[56:59]
buffer_load_dwordx4 a[124:127], v5, s[4:7], s59 offen offset:256 sc1
v_cvt_pk_bf16_f32 v221, v218, v219
v_mfma_f32_16x16x32_bf16 v[60:63], a[8:11], a[80:83], v[60:63]
v_fma_mix_f32 v216, v186, v204, v212 op_sel:[0,0,0] op_sel_hi:[1,0,0]
v_fma_mix_f32 v217, v186, v205, v213 op_sel:[1,0,0] op_sel_hi:[1,0,0]
v_mfma_f32_16x16x32_bf16 v[64:67], a[84:87], a[8:11], v[64:67]
ds_write_b64 v245, v[220:221] offset:20480
v_mfma_f32_16x16x32_bf16 v[68:71], a[72:75], a[12:15], v[68:71]
v_cvt_pk_bf16_f32 v222, v216, v217
v_fma_mix_f32 v218, v187, v206, v214 op_sel:[0,0,0] op_sel_hi:[1,0,0]
v_mfma_f32_16x16x32_bf16 v[72:75], a[76:79], a[12:15], v[72:75]
buffer_load_dwordx4 a[128:131], v5, s[4:7], s59 offen offset:512 sc1
v_fma_mix_f32 v219, v187, v207, v215 op_sel:[1,0,0] op_sel_hi:[1,0,0]
v_mfma_f32_16x16x32_bf16 v[76:79], a[12:15], a[80:83], v[76:79]
v_cvt_pk_bf16_f32 v223, v218, v219
v_bfe_u32 v228, v1, 2, 2
v_mfma_f32_16x16x32_bf16 v[80:83], a[84:87], a[12:15], v[80:83]
v_lshl_add_u32 v228, v3, 3, v228
v_mul_u32_u24 v228, 192, v228
v_mfma_f32_16x16x32_bf16 v[84:87], a[72:75], a[16:19], v[84:87]
ds_write_b64 v245, v[222:223] offset:20488
v_mfma_f32_16x16x32_bf16 v[88:91], a[76:79], a[16:19], v[88:91]
buffer_load_dwordx4 a[132:135], v6, s[4:7], s59 offen offset:768 sc1
s_add_u32 s59, s59, 16384
v_mfma_f32_16x16x32_bf16 v[92:95], a[16:19], a[80:83], v[92:95]
ds_read_b128 v[200:203], v10 offset:3584
v_and_b32 v229, 3, v1
v_mfma_f32_16x16x32_bf16 v[96:99], a[84:87], a[16:19], v[96:99]
s_waitcnt vmcnt(8) lgkmcnt(1)
s_barrier
v_lshl_add_u32 v228, v229, 3, v228
v_mfma_f32_16x16x32_bf16 v[20:23], a[88:91], a[20:23], v[20:23]
ds_read_b128 a[0:3], v8 offset:20480
v_and_b32 v229, 1, v3
v_mfma_f32_16x16x32_bf16 v[24:27], a[92:95], a[20:23], v[24:27]
buffer_load_dwordx4 a[136:139], v5, s[4:7], s59 offen offset:0 sc1
v_lshl_add_u32 v249, v229, 5, v228
v_mfma_f32_16x16x32_bf16 v[28:31], a[20:23], a[96:99], v[28:31]
ds_read_b128 a[4:7], v8 offset:21504
v_xor_b32 v229, 1, v229
v_mfma_f32_16x16x32_bf16 v[32:35], a[100:103], a[20:23], v[32:35]
ds_read_b128 a[8:11], v8 offset:22528
v_lshl_add_u32 v252, v229, 5, v228
v_mfma_f32_16x16x32_bf16 v[36:39], a[88:91], a[24:27], v[36:39]
ds_read_b128 a[12:15], v8 offset:23552
v_add_u32 v4, 61440, v8
v_mfma_f32_16x16x32_bf16 v[40:43], a[92:95], a[24:27], v[40:43]
buffer_load_dwordx4 a[140:143], v5, s[4:7], s59 offen offset:256 sc1
v_add_u32 v251, 61440, v9
v_mfma_f32_16x16x32_bf16 v[44:47], a[24:27], a[96:99], v[44:47]
ds_read_b128 a[16:19], v8 offset:24576
v_mfma_f32_16x16x32_bf16 v[48:51], a[100:103], a[24:27], v[48:51]
ds_read_b128 v[204:207], v10 offset:3600
v_mfma_f32_16x16x32_bf16 v[52:55], a[88:91], a[28:31], v[52:55]
ds_read_b128 v[208:211], v10 offset:1024
v_mfma_f32_16x16x32_bf16 v[56:59], a[92:95], a[28:31], v[56:59]
buffer_store_dwordx4 v[240:243], v246, s[4:7], s100 offen sc1
v_mfma_f32_16x16x32_bf16 v[60:63], a[28:31], a[96:99], v[60:63]
ds_read_b128 v[212:215], v10 offset:1040
v_mfma_f32_16x16x32_bf16 v[64:67], a[100:103], a[28:31], v[64:67]
v_mfma_f32_16x16x32_bf16 v[68:71], a[88:91], a[32:35], v[68:71]
v_mfma_f32_16x16x32_bf16 v[72:75], a[92:95], a[32:35], v[72:75]
buffer_load_dwordx4 a[144:147], v5, s[4:7], s59 offen offset:512 sc1
v_mfma_f32_16x16x32_bf16 v[76:79], a[32:35], a[96:99], v[76:79]
s_waitcnt lgkmcnt(0)
v_fma_mix_f32 v216, v108, v200, v208 op_sel:[0,0,0] op_sel_hi:[1,0,0]
v_fma_mix_f32 v217, v108, v201, v209 op_sel:[1,0,0] op_sel_hi:[1,0,0]
v_mfma_f32_16x16x32_bf16 v[80:83], a[100:103], a[32:35], v[80:83]
v_cvt_pk_bf16_f32 v220, v216, v217
v_fma_mix_f32 v218, v109, v202, v210 op_sel:[0,0,0] op_sel_hi:[1,0,0]
v_mfma_f32_16x16x32_bf16 v[84:87], a[88:91], a[36:39], v[84:87]
v_fma_mix_f32 v219, v109, v203, v211 op_sel:[1,0,0] op_sel_hi:[1,0,0]
v_cvt_pk_bf16_f32 v221, v218, v219
v_mfma_f32_16x16x32_bf16 v[88:91], a[92:95], a[36:39], v[88:91]
buffer_load_dwordx4 a[148:151], v6, s[4:7], s59 offen offset:768 sc1
s_add_u32 s59, s59, 16384
v_mfma_f32_16x16x32_bf16 v[92:95], a[36:39], a[96:99], v[92:95]
ds_write_b64 v7, v[220:221] offset:40960
v_mfma_f32_16x16x32_bf16 v[96:99], a[100:103], a[36:39], v[96:99]
s_waitcnt vmcnt(9)
v_fma_mix_f32 v216, v110, v204, v212 op_sel:[0,0,0] op_sel_hi:[1,0,0]
v_fma_mix_f32 v217, v110, v205, v213 op_sel:[1,0,0] op_sel_hi:[1,0,0]
v_mfma_f32_16x16x32_bf16 v[20:23], a[104:107], a[0:3], v[20:23]
ds_read_b128 a[20:23], v9 offset:25600
v_cvt_pk_bf16_f32 v222, v216, v217
v_mfma_f32_16x16x32_bf16 v[24:27], a[108:111], a[0:3], v[24:27]
buffer_load_dwordx4 a[152:155], v5, s[4:7], s59 offen offset:0 sc1
v_fma_mix_f32 v218, v111, v206, v214 op_sel:[0,0,0] op_sel_hi:[1,0,0]
v_mfma_f32_16x16x32_bf16 v[28:31], a[0:3], a[112:115], v[28:31]
ds_read_b128 a[24:27], v9 offset:26624
v_fma_mix_f32 v219, v111, v207, v215 op_sel:[1,0,0] op_sel_hi:[1,0,0]
v_mfma_f32_16x16x32_bf16 v[32:35], a[116:119], a[0:3], v[32:35]
ds_read_b128 a[28:31], v9 offset:27648
v_cvt_pk_bf16_f32 v223, v218, v219
v_mfma_f32_16x16x32_bf16 v[36:39], a[104:107], a[4:7], v[36:39]
ds_read_b128 a[32:35], v9 offset:28672
v_fma_mix_f32 v216, v128, v200, v208 op_sel:[0,0,0] op_sel_hi:[1,0,0]
v_mfma_f32_16x16x32_bf16 v[40:43], a[108:111], a[4:7], v[40:43]
buffer_load_dwordx4 a[156:159], v5, s[4:7], s59 offen offset:256 sc1
v_fma_mix_f32 v217, v128, v201, v209 op_sel:[1,0,0] op_sel_hi:[1,0,0]
v_mfma_f32_16x16x32_bf16 v[44:47], a[4:7], a[112:115], v[44:47]
ds_read_b128 a[36:39], v9 offset:29696
v_cvt_pk_bf16_f32 v224, v216, v217
v_mfma_f32_16x16x32_bf16 v[48:51], a[116:119], a[4:7], v[48:51]
ds_write_b64 v7, v[222:223] offset:40968
v_mfma_f32_16x16x32_bf16 v[52:55], a[104:107], a[8:11], v[52:55]
v_fma_mix_f32 v218, v129, v202, v210 op_sel:[0,0,0] op_sel_hi:[1,0,0]
v_fma_mix_f32 v219, v129, v203, v211 op_sel:[1,0,0] op_sel_hi:[1,0,0]
v_mfma_f32_16x16x32_bf16 v[56:59], a[108:111], a[8:11], v[56:59]
buffer_load_dwordx4 a[160:163], v5, s[4:7], s59 offen offset:512 sc1
v_cvt_pk_bf16_f32 v225, v218, v219
v_mfma_f32_16x16x32_bf16 v[60:63], a[8:11], a[112:115], v[60:63]
v_fma_mix_f32 v216, v130, v204, v212 op_sel:[0,0,0] op_sel_hi:[1,0,0]
v_fma_mix_f32 v217, v130, v205, v213 op_sel:[1,0,0] op_sel_hi:[1,0,0]
v_mfma_f32_16x16x32_bf16 v[64:67], a[116:119], a[8:11], v[64:67]
ds_write_b64 v253, v[224:225] offset:40960
v_mfma_f32_16x16x32_bf16 v[68:71], a[104:107], a[12:15], v[68:71]
v_cvt_pk_bf16_f32 v226, v216, v217
v_fma_mix_f32 v218, v131, v206, v214 op_sel:[0,0,0] op_sel_hi:[1,0,0]
v_mfma_f32_16x16x32_bf16 v[72:75], a[108:111], a[12:15], v[72:75]
buffer_load_dwordx4 a[164:167], v6, s[4:7], s59 offen offset:768 sc1
s_add_u32 s59, s59, 16384
v_mfma_f32_16x16x32_bf16 v[76:79], a[12:15], a[112:115], v[76:79]
v_fma_mix_f32 v219, v131, v207, v215 op_sel:[1,0,0] op_sel_hi:[1,0,0]
v_cvt_pk_bf16_f32 v227, v218, v219
v_mfma_f32_16x16x32_bf16 v[80:83], a[116:119], a[12:15], v[80:83]
v_fma_mix_f32 v216, v148, v200, v208 op_sel:[0,0,0] op_sel_hi:[1,0,0]
v_fma_mix_f32 v217, v148, v201, v209 op_sel:[1,0,0] op_sel_hi:[1,0,0]
v_mfma_f32_16x16x32_bf16 v[84:87], a[104:107], a[16:19], v[84:87]
ds_write_b64 v253, v[226:227] offset:40968
v_mfma_f32_16x16x32_bf16 v[88:91], a[108:111], a[16:19], v[88:91]
buffer_load_dwordx4 a[168:171], v5, s[4:7], s59 offen offset:0 sc1
v_cvt_pk_bf16_f32 v220, v216, v217
v_mfma_f32_16x16x32_bf16 v[92:95], a[16:19], a[112:115], v[92:95]
v_fma_mix_f32 v218, v149, v202, v210 op_sel:[0,0,0] op_sel_hi:[1,0,0]
v_fma_mix_f32 v219, v149, v203, v211 op_sel:[1,0,0] op_sel_hi:[1,0,0]
v_mfma_f32_16x16x32_bf16 v[96:99], a[116:119], a[16:19], v[96:99]
s_waitcnt vmcnt(10) lgkmcnt(3)
v_cvt_pk_bf16_f32 v221, v218, v219
v_fma_mix_f32 v216, v150, v204, v212 op_sel:[0,0,0] op_sel_hi:[1,0,0]
v_mfma_f32_16x16x32_bf16 v[20:23], a[120:123], a[20:23], v[20:23]
ds_read_b128 a[0:3], v8 offset:30720
v_fma_mix_f32 v217, v150, v205, v213 op_sel:[1,0,0] op_sel_hi:[1,0,0]
v_mfma_f32_16x16x32_bf16 v[24:27], a[124:127], a[20:23], v[24:27]
buffer_load_dwordx4 a[172:175], v5, s[4:7], s59 offen offset:256 sc1
v_cvt_pk_bf16_f32 v222, v216, v217
v_mfma_f32_16x16x32_bf16 v[28:31], a[20:23], a[128:131], v[28:31]
ds_read_b128 a[4:7], v8 offset:31744
v_fma_mix_f32 v218, v151, v206, v214 op_sel:[0,0,0] op_sel_hi:[1,0,0]
v_mfma_f32_16x16x32_bf16 v[32:35], a[132:135], a[20:23], v[32:35]
ds_read_b128 a[8:11], v8 offset:32768
v_fma_mix_f32 v219, v151, v207, v215 op_sel:[1,0,0] op_sel_hi:[1,0,0]
v_mfma_f32_16x16x32_bf16 v[36:39], a[120:123], a[24:27], v[36:39]
ds_read_b128 a[12:15], v8 offset:33792
v_cvt_pk_bf16_f32 v223, v218, v219
v_mfma_f32_16x16x32_bf16 v[40:43], a[124:127], a[24:27], v[40:43]
buffer_load_dwordx4 a[176:179], v5, s[4:7], s59 offen offset:512 sc1
v_fma_mix_f32 v216, v168, v200, v208 op_sel:[0,0,0] op_sel_hi:[1,0,0]
v_mfma_f32_16x16x32_bf16 v[44:47], a[24:27], a[128:131], v[44:47]
ds_read_b128 a[16:19], v8 offset:34816
v_fma_mix_f32 v217, v168, v201, v209 op_sel:[1,0,0] op_sel_hi:[1,0,0]
v_mfma_f32_16x16x32_bf16 v[48:51], a[132:135], a[24:27], v[48:51]
ds_write_b64 v254, v[220:221] offset:40960
v_mfma_f32_16x16x32_bf16 v[52:55], a[120:123], a[28:31], v[52:55]
v_cvt_pk_bf16_f32 v224, v216, v217
v_fma_mix_f32 v218, v169, v202, v210 op_sel:[0,0,0] op_sel_hi:[1,0,0]
v_mfma_f32_16x16x32_bf16 v[56:59], a[124:127], a[28:31], v[56:59]
buffer_load_dwordx4 a[180:183], v6, s[4:7], s59 offen offset:768 sc1
s_add_u32 s59, s59, 16384
v_mfma_f32_16x16x32_bf16 v[60:63], a[28:31], a[128:131], v[60:63]
ds_write_b64 v254, v[222:223] offset:40968
v_mfma_f32_16x16x32_bf16 v[64:67], a[132:135], a[28:31], v[64:67]
v_fma_mix_f32 v219, v169, v203, v211 op_sel:[1,0,0] op_sel_hi:[1,0,0]
v_cvt_pk_bf16_f32 v225, v218, v219
v_mfma_f32_16x16x32_bf16 v[68:71], a[120:123], a[32:35], v[68:71]
v_fma_mix_f32 v216, v170, v204, v212 op_sel:[0,0,0] op_sel_hi:[1,0,0]
v_fma_mix_f32 v217, v170, v205, v213 op_sel:[1,0,0] op_sel_hi:[1,0,0]
v_mfma_f32_16x16x32_bf16 v[72:75], a[124:127], a[32:35], v[72:75]
buffer_load_dwordx4 a[184:187], v5, s[4:7], s59 offen offset:0 sc1
v_cvt_pk_bf16_f32 v226, v216, v217
v_mfma_f32_16x16x32_bf16 v[76:79], a[32:35], a[128:131], v[76:79]
ds_write_b64 v244, v[224:225] offset:40960
v_mfma_f32_16x16x32_bf16 v[80:83], a[132:135], a[32:35], v[80:83]
v_fma_mix_f32 v218, v171, v206, v214 op_sel:[0,0,0] op_sel_hi:[1,0,0]
v_fma_mix_f32 v219, v171, v207, v215 op_sel:[1,0,0] op_sel_hi:[1,0,0]
v_mfma_f32_16x16x32_bf16 v[84:87], a[120:123], a[36:39], v[84:87]
v_cvt_pk_bf16_f32 v227, v218, v219
v_fma_mix_f32 v216, v188, v200, v208 op_sel:[0,0,0] op_sel_hi:[1,0,0]
v_mfma_f32_16x16x32_bf16 v[88:91], a[124:127], a[36:39], v[88:91]
v_fma_mix_f32 v217, v188, v201, v209 op_sel:[1,0,0] op_sel_hi:[1,0,0]
v_cvt_pk_bf16_f32 v220, v216, v217
v_mfma_f32_16x16x32_bf16 v[92:95], a[36:39], a[128:131], v[92:95]
ds_write_b64 v244, v[226:227] offset:40968
v_mfma_f32_16x16x32_bf16 v[96:99], a[132:135], a[36:39], v[96:99]
s_waitcnt vmcnt(9) lgkmcnt(4)
v_fma_mix_f32 v218, v189, v202, v210 op_sel:[0,0,0] op_sel_hi:[1,0,0]
v_fma_mix_f32 v219, v189, v203, v211 op_sel:[1,0,0] op_sel_hi:[1,0,0]
v_mfma_f32_16x16x32_bf16 v[20:23], a[136:139], a[0:3], v[20:23]
ds_read_b128 a[20:23], v9 offset:35840
v_cvt_pk_bf16_f32 v221, v218, v219
v_mfma_f32_16x16x32_bf16 v[24:27], a[140:143], a[0:3], v[24:27]
buffer_load_dwordx4 a[188:191], v5, s[4:7], s59 offen offset:256 sc1
v_fma_mix_f32 v216, v190, v204, v212 op_sel:[0,0,0] op_sel_hi:[1,0,0]
v_mfma_f32_16x16x32_bf16 v[28:31], a[0:3], a[144:147], v[28:31]
ds_read_b128 a[24:27], v9 offset:36864
v_fma_mix_f32 v217, v190, v205, v213 op_sel:[1,0,0] op_sel_hi:[1,0,0]
v_mfma_f32_16x16x32_bf16 v[32:35], a[148:151], a[0:3], v[32:35]
ds_read_b128 a[28:31], v9 offset:37888
v_cvt_pk_bf16_f32 v222, v216, v217
v_mfma_f32_16x16x32_bf16 v[36:39], a[136:139], a[4:7], v[36:39]
ds_read_b128 a[32:35], v9 offset:38912
v_fma_mix_f32 v218, v191, v206, v214 op_sel:[0,0,0] op_sel_hi:[1,0,0]
v_mfma_f32_16x16x32_bf16 v[40:43], a[140:143], a[4:7], v[40:43]
buffer_load_dwordx4 a[192:195], v5, s[4:7], s59 offen offset:512 sc1
v_fma_mix_f32 v219, v191, v207, v215 op_sel:[1,0,0] op_sel_hi:[1,0,0]
v_mfma_f32_16x16x32_bf16 v[44:47], a[4:7], a[144:147], v[44:47]
ds_read_b128 a[36:39], v9 offset:39936
v_cvt_pk_bf16_f32 v223, v218, v219
v_mfma_f32_16x16x32_bf16 v[48:51], a[148:151], a[4:7], v[48:51]
ds_write_b64 v245, v[220:221] offset:40960
v_mfma_f32_16x16x32_bf16 v[52:55], a[136:139], a[8:11], v[52:55]
v_add_u32 v7, 61440, v7
v_add_u32 v253, 61440, v253
v_mfma_f32_16x16x32_bf16 v[56:59], a[140:143], a[8:11], v[56:59]
buffer_load_dwordx4 a[196:199], v6, s[4:7], s59 offen offset:768 sc1
s_add_u32 s59, s59, 16384
v_mfma_f32_16x16x32_bf16 v[60:63], a[8:11], a[144:147], v[60:63]
ds_write_b64 v245, v[222:223] offset:40968
v_mfma_f32_16x16x32_bf16 v[64:67], a[148:151], a[8:11], v[64:67]
v_add_u32 v254, 61440, v254
v_add_u32 v244, 61440, v244
v_mfma_f32_16x16x32_bf16 v[68:71], a[136:139], a[12:15], v[68:71]
ds_read_b128 v[200:203], v10 offset:4096
v_add_u32 v245, 61440, v245
v_mfma_f32_16x16x32_bf16 v[72:75], a[140:143], a[12:15], v[72:75]
buffer_load_dwordx4 a[200:203], v5, s[4:7], s59 offen offset:0 sc1
v_mfma_f32_16x16x32_bf16 v[76:79], a[12:15], a[144:147], v[76:79]
ds_read_b128 v[204:207], v10 offset:4112
v_mfma_f32_16x16x32_bf16 v[80:83], a[148:151], a[12:15], v[80:83]
ds_read_b128 v[208:211], v10 offset:1536
v_mfma_f32_16x16x32_bf16 v[84:87], a[136:139], a[16:19], v[84:87]
ds_read_b128 v[212:215], v10 offset:1552
v_mfma_f32_16x16x32_bf16 v[88:91], a[140:143], a[16:19], v[88:91]
buffer_load_dwordx4 a[204:207], v5, s[4:7], s59 offen offset:256 sc1
v_mfma_f32_16x16x32_bf16 v[92:95], a[16:19], a[144:147], v[92:95]
v_mfma_f32_16x16x32_bf16 v[96:99], a[148:151], a[16:19], v[96:99]
s_waitcnt vmcnt(10) lgkmcnt(4)
s_barrier
v_mfma_f32_16x16x32_bf16 v[20:23], a[152:155], a[20:23], v[20:23]
ds_read_b128 a[0:3], v8 offset:40960
s_waitcnt lgkmcnt(1)
v_mfma_f32_16x16x32_bf16 v[24:27], a[156:159], a[20:23], v[24:27]
buffer_load_dwordx4 a[208:211], v5, s[4:7], s59 offen offset:512 sc1
v_fma_mix_f32 v216, v112, v200, v208 op_sel:[0,0,0] op_sel_hi:[1,0,0]
v_mfma_f32_16x16x32_bf16 v[28:31], a[20:23], a[160:163], v[28:31]
ds_read_b128 a[4:7], v8 offset:41984
v_fma_mix_f32 v217, v112, v201, v209 op_sel:[1,0,0] op_sel_hi:[1,0,0]
v_mfma_f32_16x16x32_bf16 v[32:35], a[164:167], a[20:23], v[32:35]
ds_read_b128 a[8:11], v8 offset:43008
v_cvt_pk_bf16_f32 v220, v216, v217
v_mfma_f32_16x16x32_bf16 v[36:39], a[152:155], a[24:27], v[36:39]
ds_read_b128 a[12:15], v8 offset:44032
v_fma_mix_f32 v218, v113, v202, v210 op_sel:[0,0,0] op_sel_hi:[1,0,0]
v_mfma_f32_16x16x32_bf16 v[40:43], a[156:159], a[24:27], v[40:43]
buffer_load_dwordx4 a[212:215], v6, s[4:7], s59 offen offset:768 sc1
s_add_u32 s59, s59, 16384
v_mfma_f32_16x16x32_bf16 v[44:47], a[24:27], a[160:163], v[44:47]
ds_read_b128 a[16:19], v8 offset:45056
v_fma_mix_f32 v219, v113, v203, v211 op_sel:[1,0,0] op_sel_hi:[1,0,0]
v_mfma_f32_16x16x32_bf16 v[48:51], a[164:167], a[24:27], v[48:51]
v_cvt_pk_bf16_f32 v221, v218, v219
v_fma_mix_f32 v216, v114, v204, v212 op_sel:[0,0,0] op_sel_hi:[1,0,0]
v_mfma_f32_16x16x32_bf16 v[52:55], a[152:155], a[28:31], v[52:55]
v_fma_mix_f32 v217, v114, v205, v213 op_sel:[1,0,0] op_sel_hi:[1,0,0]
v_cvt_pk_bf16_f32 v222, v216, v217
v_mfma_f32_16x16x32_bf16 v[56:59], a[156:159], a[28:31], v[56:59]
buffer_load_dwordx4 a[216:219], v5, s[4:7], s59 offen offset:0 sc1
v_fma_mix_f32 v218, v115, v206, v214 op_sel:[0,0,0] op_sel_hi:[1,0,0]
v_mfma_f32_16x16x32_bf16 v[60:63], a[28:31], a[160:163], v[60:63]
ds_write_b64 v7, v[220:221] offset:0
v_mfma_f32_16x16x32_bf16 v[64:67], a[164:167], a[28:31], v[64:67]
v_fma_mix_f32 v219, v115, v207, v215 op_sel:[1,0,0] op_sel_hi:[1,0,0]
v_cvt_pk_bf16_f32 v223, v218, v219
v_mfma_f32_16x16x32_bf16 v[68:71], a[152:155], a[32:35], v[68:71]
v_fma_mix_f32 v216, v132, v200, v208 op_sel:[0,0,0] op_sel_hi:[1,0,0]
v_fma_mix_f32 v217, v132, v201, v209 op_sel:[1,0,0] op_sel_hi:[1,0,0]
v_mfma_f32_16x16x32_bf16 v[72:75], a[156:159], a[32:35], v[72:75]
buffer_load_dwordx4 a[220:223], v5, s[4:7], s59 offen offset:256 sc1
v_cvt_pk_bf16_f32 v224, v216, v217
v_mfma_f32_16x16x32_bf16 v[76:79], a[32:35], a[160:163], v[76:79]
ds_write_b64 v7, v[222:223] offset:8
v_mfma_f32_16x16x32_bf16 v[80:83], a[164:167], a[32:35], v[80:83]
v_fma_mix_f32 v218, v133, v202, v210 op_sel:[0,0,0] op_sel_hi:[1,0,0]
v_fma_mix_f32 v219, v133, v203, v211 op_sel:[1,0,0] op_sel_hi:[1,0,0]
v_mfma_f32_16x16x32_bf16 v[84:87], a[152:155], a[36:39], v[84:87]
v_cvt_pk_bf16_f32 v225, v218, v219
v_fma_mix_f32 v216, v134, v204, v212 op_sel:[0,0,0] op_sel_hi:[1,0,0]
v_mfma_f32_16x16x32_bf16 v[88:91], a[156:159], a[36:39], v[88:91]
buffer_load_dwordx4 a[224:227], v5, s[4:7], s59 offen offset:512 sc1
v_fma_mix_f32 v217, v134, v205, v213 op_sel:[1,0,0] op_sel_hi:[1,0,0]
v_mfma_f32_16x16x32_bf16 v[92:95], a[36:39], a[160:163], v[92:95]
ds_write_b64 v253, v[224:225] offset:0
v_mfma_f32_16x16x32_bf16 v[96:99], a[164:167], a[36:39], v[96:99]
s_waitcnt vmcnt(11) lgkmcnt(3)
v_cvt_pk_bf16_f32 v226, v216, v217
v_fma_mix_f32 v218, v135, v206, v214 op_sel:[0,0,0] op_sel_hi:[1,0,0]
v_mfma_f32_16x16x32_bf16 v[20:23], a[168:171], a[0:3], v[20:23]
ds_read_b128 a[20:23], v9 offset:46080
v_fma_mix_f32 v219, v135, v207, v215 op_sel:[1,0,0] op_sel_hi:[1,0,0]
v_mfma_f32_16x16x32_bf16 v[24:27], a[172:175], a[0:3], v[24:27]
buffer_load_dwordx4 a[228:231], v6, s[4:7], s59 offen offset:768 sc1
s_add_u32 s59, s59, 16384
v_mfma_f32_16x16x32_bf16 v[28:31], a[0:3], a[176:179], v[28:31]
ds_read_b128 a[24:27], v9 offset:47104
v_cvt_pk_bf16_f32 v227, v218, v219
v_mfma_f32_16x16x32_bf16 v[32:35], a[180:183], a[0:3], v[32:35]
ds_read_b128 a[28:31], v9 offset:48128
v_fma_mix_f32 v216, v152, v200, v208 op_sel:[0,0,0] op_sel_hi:[1,0,0]
v_mfma_f32_16x16x32_bf16 v[36:39], a[168:171], a[4:7], v[36:39]
ds_read_b128 a[32:35], v9 offset:49152
v_fma_mix_f32 v217, v152, v201, v209 op_sel:[1,0,0] op_sel_hi:[1,0,0]
v_mfma_f32_16x16x32_bf16 v[40:43], a[172:175], a[4:7], v[40:43]
buffer_load_dwordx4 a[40:43], v5, s[4:7], s59 offen offset:0 sc1
v_cvt_pk_bf16_f32 v220, v216, v217
v_mfma_f32_16x16x32_bf16 v[44:47], a[4:7], a[176:179], v[44:47]
ds_read_b128 a[36:39], v9 offset:50176
v_fma_mix_f32 v218, v153, v202, v210 op_sel:[0,0,0] op_sel_hi:[1,0,0]
v_mfma_f32_16x16x32_bf16 v[48:51], a[180:183], a[4:7], v[48:51]
ds_write_b64 v253, v[226:227] offset:8
v_mfma_f32_16x16x32_bf16 v[52:55], a[168:171], a[8:11], v[52:55]
v_fma_mix_f32 v219, v153, v203, v211 op_sel:[1,0,0] op_sel_hi:[1,0,0]
v_cvt_pk_bf16_f32 v221, v218, v219
v_mfma_f32_16x16x32_bf16 v[56:59], a[172:175], a[8:11], v[56:59]
buffer_load_dwordx4 a[44:47], v5, s[4:7], s59 offen offset:256 sc1
v_fma_mix_f32 v216, v154, v204, v212 op_sel:[0,0,0] op_sel_hi:[1,0,0]
v_mfma_f32_16x16x32_bf16 v[60:63], a[8:11], a[176:179], v[60:63]
ds_write_b64 v254, v[220:221] offset:0
v_mfma_f32_16x16x32_bf16 v[64:67], a[180:183], a[8:11], v[64:67]
v_fma_mix_f32 v217, v154, v205, v213 op_sel:[1,0,0] op_sel_hi:[1,0,0]
v_cvt_pk_bf16_f32 v222, v216, v217
v_mfma_f32_16x16x32_bf16 v[68:71], a[168:171], a[12:15], v[68:71]
v_fma_mix_f32 v218, v155, v206, v214 op_sel:[0,0,0] op_sel_hi:[1,0,0]
v_fma_mix_f32 v219, v155, v207, v215 op_sel:[1,0,0] op_sel_hi:[1,0,0]
v_mfma_f32_16x16x32_bf16 v[72:75], a[172:175], a[12:15], v[72:75]
buffer_load_dwordx4 a[48:51], v5, s[4:7], s59 offen offset:512 sc1
v_cvt_pk_bf16_f32 v223, v218, v219
v_mfma_f32_16x16x32_bf16 v[76:79], a[12:15], a[176:179], v[76:79]
v_fma_mix_f32 v216, v172, v200, v208 op_sel:[0,0,0] op_sel_hi:[1,0,0]
v_fma_mix_f32 v217, v172, v201, v209 op_sel:[1,0,0] op_sel_hi:[1,0,0]
v_mfma_f32_16x16x32_bf16 v[80:83], a[180:183], a[12:15], v[80:83]
ds_write_b64 v254, v[222:223] offset:8
v_mfma_f32_16x16x32_bf16 v[84:87], a[168:171], a[16:19], v[84:87]
v_cvt_pk_bf16_f32 v224, v216, v217
v_fma_mix_f32 v218, v173, v202, v210 op_sel:[0,0,0] op_sel_hi:[1,0,0]
v_mfma_f32_16x16x32_bf16 v[88:91], a[172:175], a[16:19], v[88:91]
buffer_load_dwordx4 a[52:55], v6, s[4:7], s59 offen offset:768 sc1
s_add_u32 s59, s59, 16384
v_mfma_f32_16x16x32_bf16 v[92:95], a[16:19], a[176:179], v[92:95]
v_fma_mix_f32 v219, v173, v203, v211 op_sel:[1,0,0] op_sel_hi:[1,0,0]
v_cvt_pk_bf16_f32 v225, v218, v219
v_mfma_f32_16x16x32_bf16 v[96:99], a[180:183], a[16:19], v[96:99]
s_waitcnt vmcnt(12) lgkmcnt(3)
v_fma_mix_f32 v216, v174, v204, v212 op_sel:[0,0,0] op_sel_hi:[1,0,0]
v_fma_mix_f32 v217, v174, v205, v213 op_sel:[1,0,0] op_sel_hi:[1,0,0]
v_mfma_f32_16x16x32_bf16 v[20:23], a[184:187], a[20:23], v[20:23]
ds_read_b128 a[0:3], v8 offset:51200
v_cvt_pk_bf16_f32 v226, v216, v217
v_mfma_f32_16x16x32_bf16 v[24:27], a[188:191], a[20:23], v[24:27]
buffer_load_dwordx4 a[56:59], v5, s[4:7], s59 offen offset:0 sc1
v_fma_mix_f32 v218, v175, v206, v214 op_sel:[0,0,0] op_sel_hi:[1,0,0]
v_mfma_f32_16x16x32_bf16 v[28:31], a[20:23], a[192:195], v[28:31]
ds_read_b128 a[4:7], v8 offset:52224
v_fma_mix_f32 v219, v175, v207, v215 op_sel:[1,0,0] op_sel_hi:[1,0,0]
v_mfma_f32_16x16x32_bf16 v[32:35], a[196:199], a[20:23], v[32:35]
ds_read_b128 a[8:11], v8 offset:53248
v_cvt_pk_bf16_f32 v227, v218, v219
v_mfma_f32_16x16x32_bf16 v[36:39], a[184:187], a[24:27], v[36:39]
ds_read_b128 a[12:15], v8 offset:54272
v_fma_mix_f32 v216, v192, v200, v208 op_sel:[0,0,0] op_sel_hi:[1,0,0]
v_mfma_f32_16x16x32_bf16 v[40:43], a[188:191], a[24:27], v[40:43]
buffer_load_dwordx4 a[60:63], v5, s[4:7], s59 offen offset:256 sc1
v_fma_mix_f32 v217, v192, v201, v209 op_sel:[1,0,0] op_sel_hi:[1,0,0]
v_mfma_f32_16x16x32_bf16 v[44:47], a[24:27], a[192:195], v[44:47]
ds_read_b128 a[16:19], v8 offset:55296
v_cvt_pk_bf16_f32 v220, v216, v217
v_mfma_f32_16x16x32_bf16 v[48:51], a[196:199], a[24:27], v[48:51]
ds_write_b64 v244, v[224:225] offset:0
v_mfma_f32_16x16x32_bf16 v[52:55], a[184:187], a[28:31], v[52:55]
v_fma_mix_f32 v218, v193, v202, v210 op_sel:[0,0,0] op_sel_hi:[1,0,0]
v_fma_mix_f32 v219, v193, v203, v211 op_sel:[1,0,0] op_sel_hi:[1,0,0]
v_mfma_f32_16x16x32_bf16 v[56:59], a[188:191], a[28:31], v[56:59]
buffer_load_dwordx4 a[64:67], v5, s[4:7], s59 offen offset:512 sc1
v_cvt_pk_bf16_f32 v221, v218, v219
v_mfma_f32_16x16x32_bf16 v[60:63], a[28:31], a[192:195], v[60:63]
ds_write_b64 v244, v[226:227] offset:8
v_mfma_f32_16x16x32_bf16 v[64:67], a[196:199], a[28:31], v[64:67]
v_fma_mix_f32 v216, v194, v204, v212 op_sel:[0,0,0] op_sel_hi:[1,0,0]
v_fma_mix_f32 v217, v194, v205, v213 op_sel:[1,0,0] op_sel_hi:[1,0,0]
v_mfma_f32_16x16x32_bf16 v[68:71], a[184:187], a[32:35], v[68:71]
ds_write_b64 v245, v[220:221] offset:0
v_mfma_f32_16x16x32_bf16 v[72:75], a[188:191], a[32:35], v[72:75]
buffer_load_dwordx4 a[68:71], v6, s[4:7], s59 offen offset:768 sc1
s_add_u32 s59, s59, 16384
v_mfma_f32_16x16x32_bf16 v[76:79], a[32:35], a[192:195], v[76:79]
v_cvt_pk_bf16_f32 v222, v216, v217
v_fma_mix_f32 v218, v195, v206, v214 op_sel:[0,0,0] op_sel_hi:[1,0,0]
v_mfma_f32_16x16x32_bf16 v[80:83], a[196:199], a[32:35], v[80:83]
v_fma_mix_f32 v219, v195, v207, v215 op_sel:[1,0,0] op_sel_hi:[1,0,0]
v_cvt_pk_bf16_f32 v223, v218, v219
v_mfma_f32_16x16x32_bf16 v[84:87], a[184:187], a[36:39], v[84:87]
v_mfma_f32_16x16x32_bf16 v[88:91], a[188:191], a[36:39], v[88:91]
buffer_load_dwordx4 a[72:75], v5, s[4:7], s59 offen offset:0 sc1
v_mfma_f32_16x16x32_bf16 v[92:95], a[36:39], a[192:195], v[92:95]
ds_write_b64 v245, v[222:223] offset:8
v_mfma_f32_16x16x32_bf16 v[96:99], a[196:199], a[36:39], v[96:99]
s_waitcnt vmcnt(13) lgkmcnt(4)
v_mfma_f32_16x16x32_bf16 v[20:23], a[200:203], a[0:3], v[20:23]
ds_read_b128 a[20:23], v9 offset:56320
v_mfma_f32_16x16x32_bf16 v[24:27], a[204:207], a[0:3], v[24:27]
buffer_load_dwordx4 a[76:79], v5, s[4:7], s59 offen offset:256 sc1
v_mfma_f32_16x16x32_bf16 v[28:31], a[0:3], a[208:211], v[28:31]
ds_read_b128 a[24:27], v9 offset:57344
v_mfma_f32_16x16x32_bf16 v[32:35], a[212:215], a[0:3], v[32:35]
ds_read_b128 a[28:31], v9 offset:58368
v_mfma_f32_16x16x32_bf16 v[36:39], a[200:203], a[4:7], v[36:39]
ds_read_b128 a[32:35], v9 offset:59392
v_mfma_f32_16x16x32_bf16 v[40:43], a[204:207], a[4:7], v[40:43]
buffer_load_dwordx4 a[80:83], v5, s[4:7], s59 offen offset:512 sc1
v_mfma_f32_16x16x32_bf16 v[44:47], a[4:7], a[208:211], v[44:47]
ds_read_b128 a[36:39], v9 offset:60416
v_mfma_f32_16x16x32_bf16 v[48:51], a[212:215], a[4:7], v[48:51]
ds_read_b128 v[200:203], v10 offset:4608
v_mfma_f32_16x16x32_bf16 v[52:55], a[200:203], a[8:11], v[52:55]
ds_read_b128 v[204:207], v10 offset:4624
v_mfma_f32_16x16x32_bf16 v[56:59], a[204:207], a[8:11], v[56:59]
buffer_load_dwordx4 a[84:87], v6, s[4:7], s59 offen offset:768 sc1
s_add_u32 s59, s59, 16384
v_mfma_f32_16x16x32_bf16 v[60:63], a[8:11], a[208:211], v[60:63]
ds_read_b128 v[208:211], v10 offset:2048
v_mfma_f32_16x16x32_bf16 v[64:67], a[212:215], a[8:11], v[64:67]
ds_read_b128 v[212:215], v10 offset:2064
v_mfma_f32_16x16x32_bf16 v[68:71], a[200:203], a[12:15], v[68:71]
v_mfma_f32_16x16x32_bf16 v[72:75], a[204:207], a[12:15], v[72:75]
buffer_load_dwordx4 a[88:91], v5, s[4:7], s59 offen offset:0 sc1
v_mfma_f32_16x16x32_bf16 v[76:79], a[12:15], a[208:211], v[76:79]
v_mfma_f32_16x16x32_bf16 v[80:83], a[212:215], a[12:15], v[80:83]
s_waitcnt lgkmcnt(0)
v_fma_mix_f32 v216, v116, v200, v208 op_sel:[0,0,0] op_sel_hi:[1,0,0]
v_fma_mix_f32 v217, v116, v201, v209 op_sel:[1,0,0] op_sel_hi:[1,0,0]
v_mfma_f32_16x16x32_bf16 v[84:87], a[200:203], a[16:19], v[84:87]
v_cvt_pk_bf16_f32 v220, v216, v217
v_fma_mix_f32 v218, v117, v202, v210 op_sel:[0,0,0] op_sel_hi:[1,0,0]
v_mfma_f32_16x16x32_bf16 v[88:91], a[204:207], a[16:19], v[88:91]
v_fma_mix_f32 v219, v117, v203, v211 op_sel:[1,0,0] op_sel_hi:[1,0,0]
v_cvt_pk_bf16_f32 v221, v218, v219
v_mfma_f32_16x16x32_bf16 v[92:95], a[16:19], a[208:211], v[92:95]
v_fma_mix_f32 v216, v118, v204, v212 op_sel:[0,0,0] op_sel_hi:[1,0,0]
v_fma_mix_f32 v217, v118, v205, v213 op_sel:[1,0,0] op_sel_hi:[1,0,0]
v_mfma_f32_16x16x32_bf16 v[96:99], a[212:215], a[16:19], v[96:99]
s_waitcnt vmcnt(13)
s_barrier
v_cvt_pk_bf16_f32 v222, v216, v217
v_mfma_f32_16x16x32_bf16 v[20:23], a[216:219], a[20:23], v[20:23]
ds_read_b128 a[0:3], v4 offset:0
v_fma_mix_f32 v218, v119, v206, v214 op_sel:[0,0,0] op_sel_hi:[1,0,0]
v_mfma_f32_16x16x32_bf16 v[24:27], a[220:223], a[20:23], v[24:27]
buffer_load_dwordx4 a[92:95], v5, s[4:7], s59 offen offset:256 sc1
v_fma_mix_f32 v219, v119, v207, v215 op_sel:[1,0,0] op_sel_hi:[1,0,0]
v_mfma_f32_16x16x32_bf16 v[28:31], a[20:23], a[224:227], v[28:31]
ds_read_b128 a[4:7], v4 offset:1024
v_cvt_pk_bf16_f32 v223, v218, v219
v_mfma_f32_16x16x32_bf16 v[32:35], a[228:231], a[20:23], v[32:35]
ds_read_b128 a[8:11], v4 offset:2048
v_fma_mix_f32 v216, v136, v200, v208 op_sel:[0,0,0] op_sel_hi:[1,0,0]
v_mfma_f32_16x16x32_bf16 v[36:39], a[216:219], a[24:27], v[36:39]
ds_read_b128 a[12:15], v4 offset:3072
v_fma_mix_f32 v217, v136, v201, v209 op_sel:[1,0,0] op_sel_hi:[1,0,0]
v_mfma_f32_16x16x32_bf16 v[40:43], a[220:223], a[24:27], v[40:43]
buffer_load_dwordx4 a[96:99], v5, s[4:7], s59 offen offset:512 sc1
v_cvt_pk_bf16_f32 v224, v216, v217
v_mfma_f32_16x16x32_bf16 v[44:47], a[24:27], a[224:227], v[44:47]
ds_read_b128 a[16:19], v4 offset:4096
v_fma_mix_f32 v218, v137, v202, v210 op_sel:[0,0,0] op_sel_hi:[1,0,0]
v_mfma_f32_16x16x32_bf16 v[48:51], a[228:231], a[24:27], v[48:51]
ds_write_b64 v7, v[220:221] offset:20480
v_mfma_f32_16x16x32_bf16 v[52:55], a[216:219], a[28:31], v[52:55]
v_fma_mix_f32 v219, v137, v203, v211 op_sel:[1,0,0] op_sel_hi:[1,0,0]
v_cvt_pk_bf16_f32 v225, v218, v219
v_mfma_f32_16x16x32_bf16 v[56:59], a[220:223], a[28:31], v[56:59]
buffer_load_dwordx4 a[100:103], v6, s[4:7], s59 offen offset:768 sc1
s_add_u32 s59, s59, 16384
v_mfma_f32_16x16x32_bf16 v[60:63], a[28:31], a[224:227], v[60:63]
ds_write_b64 v7, v[222:223] offset:20488
v_mfma_f32_16x16x32_bf16 v[64:67], a[228:231], a[28:31], v[64:67]
v_fma_mix_f32 v216, v138, v204, v212 op_sel:[0,0,0] op_sel_hi:[1,0,0]
v_fma_mix_f32 v217, v138, v205, v213 op_sel:[1,0,0] op_sel_hi:[1,0,0]
v_mfma_f32_16x16x32_bf16 v[68:71], a[216:219], a[32:35], v[68:71]
ds_write_b64 v253, v[224:225] offset:20480
v_mfma_f32_16x16x32_bf16 v[72:75], a[220:223], a[32:35], v[72:75]
buffer_load_dwordx4 a[104:107], v5, s[4:7], s59 offen offset:0 sc1
v_cvt_pk_bf16_f32 v226, v216, v217
v_mfma_f32_16x16x32_bf16 v[76:79], a[32:35], a[224:227], v[76:79]
v_fma_mix_f32 v218, v139, v206, v214 op_sel:[0,0,0] op_sel_hi:[1,0,0]
v_fma_mix_f32 v219, v139, v207, v215 op_sel:[1,0,0] op_sel_hi:[1,0,0]
v_mfma_f32_16x16x32_bf16 v[80:83], a[228:231], a[32:35], v[80:83]
v_cvt_pk_bf16_f32 v227, v218, v219
v_fma_mix_f32 v216, v156, v200, v208 op_sel:[0,0,0] op_sel_hi:[1,0,0]
v_mfma_f32_16x16x32_bf16 v[84:87], a[216:219], a[36:39], v[84:87]
v_fma_mix_f32 v217, v156, v201, v209 op_sel:[1,0,0] op_sel_hi:[1,0,0]
v_cvt_pk_bf16_f32 v220, v216, v217
v_mfma_f32_16x16x32_bf16 v[88:91], a[220:223], a[36:39], v[88:91]
buffer_load_dwordx4 a[108:111], v5, s[4:7], s59 offen offset:256 sc1
v_fma_mix_f32 v218, v157, v202, v210 op_sel:[0,0,0] op_sel_hi:[1,0,0]
v_mfma_f32_16x16x32_bf16 v[92:95], a[36:39], a[224:227], v[92:95]
ds_write_b64 v253, v[226:227] offset:20488
v_mfma_f32_16x16x32_bf16 v[96:99], a[228:231], a[36:39], v[96:99]
s_waitcnt vmcnt(14) lgkmcnt(4)
v_fma_mix_f32 v219, v157, v203, v211 op_sel:[1,0,0] op_sel_hi:[1,0,0]
v_cvt_pk_bf16_f32 v221, v218, v219
v_mfma_f32_16x16x32_bf16 v[20:23], a[40:43], a[0:3], v[20:23]
ds_read_b128 a[20:23], v251 offset:5120
v_fma_mix_f32 v216, v158, v204, v212 op_sel:[0,0,0] op_sel_hi:[1,0,0]
v_mfma_f32_16x16x32_bf16 v[24:27], a[44:47], a[0:3], v[24:27]
buffer_load_dwordx4 a[112:115], v5, s[4:7], s59 offen offset:512 sc1
v_fma_mix_f32 v217, v158, v205, v213 op_sel:[1,0,0] op_sel_hi:[1,0,0]
v_mfma_f32_16x16x32_bf16 v[28:31], a[0:3], a[48:51], v[28:31]
ds_read_b128 a[24:27], v251 offset:6144
v_cvt_pk_bf16_f32 v222, v216, v217
v_mfma_f32_16x16x32_bf16 v[32:35], a[52:55], a[0:3], v[32:35]
ds_read_b128 a[28:31], v251 offset:7168
v_fma_mix_f32 v218, v159, v206, v214 op_sel:[0,0,0] op_sel_hi:[1,0,0]
v_mfma_f32_16x16x32_bf16 v[36:39], a[40:43], a[4:7], v[36:39]
ds_read_b128 a[32:35], v251 offset:8192
v_fma_mix_f32 v219, v159, v207, v215 op_sel:[1,0,0] op_sel_hi:[1,0,0]
v_mfma_f32_16x16x32_bf16 v[40:43], a[44:47], a[4:7], v[40:43]
buffer_load_dwordx4 a[116:119], v6, s[4:7], s59 offen offset:768 sc1
s_add_u32 s59, s59, 16384
v_mfma_f32_16x16x32_bf16 v[44:47], a[4:7], a[48:51], v[44:47]
ds_read_b128 a[36:39], v251 offset:9216
v_cvt_pk_bf16_f32 v223, v218, v219
v_mfma_f32_16x16x32_bf16 v[48:51], a[52:55], a[4:7], v[48:51]
ds_read_b64_tr_b16 a[168:169], v249 offset:0
v_fma_mix_f32 v216, v176, v200, v208 op_sel:[0,0,0] op_sel_hi:[1,0,0]
v_mfma_f32_16x16x32_bf16 v[52:55], a[40:43], a[8:11], v[52:55]
ds_read_b64_tr_b16 a[170:171], v249 offset:768
v_fma_mix_f32 v217, v176, v201, v209 op_sel:[1,0,0] op_sel_hi:[1,0,0]
v_mfma_f32_16x16x32_bf16 v[56:59], a[44:47], a[8:11], v[56:59]
buffer_load_dwordx4 a[120:123], v5, s[4:7], s59 offen offset:0 sc1
v_cvt_pk_bf16_f32 v224, v216, v217
v_mfma_f32_16x16x32_bf16 v[60:63], a[8:11], a[48:51], v[60:63]
ds_read_b64_tr_b16 a[172:173], v252 offset:0
v_fma_mix_f32 v218, v177, v202, v210 op_sel:[0,0,0] op_sel_hi:[1,0,0]
v_mfma_f32_16x16x32_bf16 v[64:67], a[52:55], a[8:11], v[64:67]
ds_read_b64_tr_b16 a[174:175], v252 offset:768
v_fma_mix_f32 v219, v177, v203, v211 op_sel:[1,0,0] op_sel_hi:[1,0,0]
v_mfma_f32_16x16x32_bf16 v[68:71], a[40:43], a[12:15], v[68:71]
ds_write_b64 v254, v[220:221] offset:20480
v_mfma_f32_16x16x32_bf16 v[72:75], a[44:47], a[12:15], v[72:75]
buffer_load_dwordx4 a[124:127], v5, s[4:7], s59 offen offset:256 sc1
v_cvt_pk_bf16_f32 v225, v218, v219
v_mfma_f32_16x16x32_bf16 v[76:79], a[12:15], a[48:51], v[76:79]
ds_write_b64 v254, v[222:223] offset:20488
v_mfma_f32_16x16x32_bf16 v[80:83], a[52:55], a[12:15], v[80:83]
v_fma_mix_f32 v216, v178, v204, v212 op_sel:[0,0,0] op_sel_hi:[1,0,0]
v_fma_mix_f32 v217, v178, v205, v213 op_sel:[1,0,0] op_sel_hi:[1,0,0]
v_mfma_f32_16x16x32_bf16 v[84:87], a[40:43], a[16:19], v[84:87]
ds_write_b64 v244, v[224:225] offset:20480
v_mfma_f32_16x16x32_bf16 v[88:91], a[44:47], a[16:19], v[88:91]
buffer_load_dwordx4 a[128:131], v5, s[4:7], s59 offen offset:512 sc1
v_cvt_pk_bf16_f32 v226, v216, v217
v_mfma_f32_16x16x32_bf16 v[92:95], a[16:19], a[48:51], v[92:95]
v_fma_mix_f32 v218, v179, v206, v214 op_sel:[0,0,0] op_sel_hi:[1,0,0]
v_fma_mix_f32 v219, v179, v207, v215 op_sel:[1,0,0] op_sel_hi:[1,0,0]
v_mfma_f32_16x16x32_bf16 v[96:99], a[52:55], a[16:19], v[96:99]
s_waitcnt vmcnt(15) lgkmcnt(7)
v_cvt_pk_bf16_f32 v227, v218, v219
v_fma_mix_f32 v216, v196, v200, v208 op_sel:[0,0,0] op_sel_hi:[1,0,0]
v_mfma_f32_16x16x32_bf16 v[20:23], a[56:59], a[20:23], v[20:23]
ds_read_b128 a[0:3], v4 offset:10240
v_fma_mix_f32 v217, v196, v201, v209 op_sel:[1,0,0] op_sel_hi:[1,0,0]
v_mfma_f32_16x16x32_bf16 v[24:27], a[60:63], a[20:23], v[24:27]
buffer_load_dwordx4 a[132:135], v6, s[4:7], s59 offen offset:768 sc1
s_add_u32 s59, s59, 16384
v_mfma_f32_16x16x32_bf16 v[28:31], a[20:23], a[64:67], v[28:31]
ds_read_b128 a[4:7], v4 offset:11264
v_cvt_pk_bf16_f32 v220, v216, v217
v_mfma_f32_16x16x32_bf16 v[32:35], a[68:71], a[20:23], v[32:35]
ds_read_b128 a[8:11], v4 offset:12288
v_fma_mix_f32 v218, v197, v202, v210 op_sel:[0,0,0] op_sel_hi:[1,0,0]
v_mfma_f32_16x16x32_bf16 v[36:39], a[56:59], a[24:27], v[36:39]
ds_read_b128 a[12:15], v4 offset:13312
v_fma_mix_f32 v219, v197, v203, v211 op_sel:[1,0,0] op_sel_hi:[1,0,0]
v_mfma_f32_16x16x32_bf16 v[40:43], a[60:63], a[24:27], v[40:43]
buffer_load_dwordx4 a[136:139], v5, s[4:7], s59 offen offset:0 sc1
v_cvt_pk_bf16_f32 v221, v218, v219
v_mfma_f32_16x16x32_bf16 v[44:47], a[24:27], a[64:67], v[44:47]
ds_read_b128 a[16:19], v4 offset:14336
v_fma_mix_f32 v216, v198, v204, v212 op_sel:[0,0,0] op_sel_hi:[1,0,0]
v_mfma_f32_16x16x32_bf16 v[48:51], a[68:71], a[24:27], v[48:51]
ds_read_b64_tr_b16 a[176:177], v249 offset:64
v_fma_mix_f32 v217, v198, v205, v213 op_sel:[1,0,0] op_sel_hi:[1,0,0]
v_mfma_f32_16x16x32_bf16 v[52:55], a[56:59], a[28:31], v[52:55]
ds_read_b64_tr_b16 a[178:179], v249 offset:832
v_cvt_pk_bf16_f32 v222, v216, v217
v_mfma_f32_16x16x32_bf16 v[56:59], a[60:63], a[28:31], v[56:59]
buffer_load_dwordx4 a[140:143], v5, s[4:7], s59 offen offset:256 sc1
v_fma_mix_f32 v218, v199, v206, v214 op_sel:[0,0,0] op_sel_hi:[1,0,0]
v_mfma_f32_16x16x32_bf16 v[60:63], a[28:31], a[64:67], v[60:63]
ds_read_b64_tr_b16 a[180:181], v249 offset:6144
v_fma_mix_f32 v219, v199, v207, v215 op_sel:[1,0,0] op_sel_hi:[1,0,0]
v_mfma_f32_16x16x32_bf16 v[64:67], a[68:71], a[28:31], v[64:67]
ds_read_b64_tr_b16 a[182:183], v249 offset:6912
v_cvt_pk_bf16_f32 v223, v218, v219
v_mfma_f32_16x16x32_bf16 v[68:71], a[56:59], a[32:35], v[68:71]
ds_write_b64 v244, v[226:227] offset:20488
v_mfma_f32_16x16x32_bf16 v[72:75], a[60:63], a[32:35], v[72:75]
buffer_load_dwordx4 a[144:147], v5, s[4:7], s59 offen offset:512 sc1
v_add_u32 v253, 61440, v249
v_mfma_f32_16x16x32_bf16 v[76:79], a[32:35], a[64:67], v[76:79]
ds_write_b64 v245, v[220:221] offset:20480
v_mfma_f32_16x16x32_bf16 v[80:83], a[68:71], a[32:35], v[80:83]
v_add_u32 v254, 61440, v252
v_lshlrev_b32 v7, 4, v1
v_mfma_f32_16x16x32_bf16 v[84:87], a[56:59], a[36:39], v[84:87]
ds_write_b64 v245, v[222:223] offset:20488
v_mfma_f32_16x16x32_bf16 v[88:91], a[60:63], a[36:39], v[88:91]
buffer_load_dwordx4 a[148:151], v6, s[4:7], s59 offen offset:768 sc1
s_add_u32 s59, s59, 16384
v_mfma_f32_16x16x32_bf16 v[92:95], a[36:39], a[64:67], v[92:95]
v_lshl_add_u32 v247, v3, 4, s12
v_mul_u32_u24 v228, 192, v2
v_mfma_f32_16x16x32_bf16 v[96:99], a[68:71], a[36:39], v[96:99]
s_waitcnt vmcnt(16) lgkmcnt(7)
v_lshl_add_u32 v228, v3, 3, v228
v_add_u32 v248, s13, v228
v_mfma_f32_16x16x32_bf16 v[20:23], a[72:75], a[0:3], v[20:23]
ds_read_b128 a[20:23], v251 offset:15360
v_add_u32 v250, s13, v7
v_mfma_f32_16x16x32_bf16 v[24:27], a[76:79], a[0:3], v[24:27]
buffer_load_dwordx4 a[152:155], v5, s[4:7], s59 offen offset:0 sc1
v_lshlrev_b32 v0, 2, v1
v_mfma_f32_16x16x32_bf16 v[28:31], a[0:3], a[80:83], v[28:31]
ds_read_b128 a[24:27], v251 offset:16384
v_add_u32 v198, s12, v7
v_mfma_f32_16x16x32_bf16 v[32:35], a[84:87], a[0:3], v[32:35]
ds_read_b128 a[28:31], v251 offset:17408
v_min_u32 v197, 13, v1
v_mfma_f32_16x16x32_bf16 v[36:39], a[72:75], a[4:7], v[36:39]
ds_read_b128 a[32:35], v251 offset:18432
v_lshlrev_b32 v197, 7, v197
v_mfma_f32_16x16x32_bf16 v[40:43], a[76:79], a[4:7], v[40:43]
buffer_load_dwordx4 a[156:159], v5, s[4:7], s59 offen offset:256 sc1
v_lshlrev_b32 v181, 2, v3
v_mfma_f32_16x16x32_bf16 v[44:47], a[4:7], a[80:83], v[44:47]
ds_read_b128 a[36:39], v251 offset:19456
v_sub_u32 v181, v2, v181
v_mfma_f32_16x16x32_bf16 v[48:51], a[84:87], a[4:7], v[48:51]
ds_read_b64_tr_b16 a[184:185], v252 offset:6144
v_mov_b32 v168, 0xf0000000
v_mfma_f32_16x16x32_bf16 v[52:55], a[72:75], a[8:11], v[52:55]
ds_read_b64_tr_b16 a[186:187], v252 offset:6912
v_subrev_u32 v182, 0, v181
v_mfma_f32_16x16x32_bf16 v[56:59], a[76:79], a[8:11], v[56:59]
buffer_load_dwordx4 a[160:163], v5, s[4:7], s59 offen offset:512 sc1
v_bfe_i32 v182, v182, 3, 1
v_mfma_f32_16x16x32_bf16 v[60:63], a[8:11], a[80:83], v[60:63]
ds_read_b64_tr_b16 a[188:189], v249 offset:6208
v_and_b32 v164, v168, v182
v_mfma_f32_16x16x32_bf16 v[64:67], a[84:87], a[8:11], v[64:67]
ds_read_b64_tr_b16 a[190:191], v249 offset:6976
v_mov_b32 v176, 0x3f803f80
v_mfma_f32_16x16x32_bf16 v[68:71], a[72:75], a[12:15], v[68:71]
v_subrev_u32 v182, 1, v181
v_bfe_i32 v182, v182, 3, 1
v_mfma_f32_16x16x32_bf16 v[72:75], a[76:79], a[12:15], v[72:75]
buffer_load_dwordx4 a[164:167], v6, s[4:7], s59 offen offset:768 sc1
s_add_u32 s59, s59, 16384
v_mfma_f32_16x16x32_bf16 v[76:79], a[12:15], a[80:83], v[76:79]
v_and_b32 v165, v168, v182
v_mov_b32 v177, 0x3f803f80
v_mfma_f32_16x16x32_bf16 v[80:83], a[84:87], a[12:15], v[80:83]
v_subrev_u32 v182, 2, v181
v_bfe_i32 v182, v182, 3, 1
v_mfma_f32_16x16x32_bf16 v[84:87], a[72:75], a[16:19], v[84:87]
s_add_u32 m0, s39, 49152
v_and_b32 v166, v168, v182
v_mov_b32 v178, 0x3f803f80
v_mfma_f32_16x16x32_bf16 v[88:91], a[76:79], a[16:19], v[88:91]
buffer_load_dwordx4 v232, s[24:27], s48 offen offset:0 lds
v_subrev_u32 v182, 3, v181
v_mfma_f32_16x16x32_bf16 v[92:95], a[16:19], a[80:83], v[92:95]
v_bfe_i32 v182, v182, 3, 1
v_and_b32 v167, v168, v182
v_mfma_f32_16x16x32_bf16 v[96:99], a[84:87], a[16:19], v[96:99]
s_waitcnt vmcnt(17) lgkmcnt(4)
s_barrier
v_mov_b32 v179, 0x3f803f80
v_mfma_f32_16x16x32_bf16 v[20:23], a[88:91], a[20:23], v[20:23]
ds_read_b128 a[0:3], v4 offset:20480
v_and_b32 v181, 1, v1
v_mfma_f32_16x16x32_bf16 v[24:27], a[92:95], a[20:23], v[24:27]
buffer_load_dwordx4 v233, s[24:27], s48 offen offset:1024 lds
v_lshlrev_b32 v181, 4, v181
v_mfma_f32_16x16x32_bf16 v[28:31], a[20:23], a[96:99], v[28:31]
ds_read_b128 a[4:7], v4 offset:21504
v_mov_b32 v182, 0x3f80
v_mfma_f32_16x16x32_bf16 v[32:35], a[100:103], a[20:23], v[32:35]
ds_read_b128 a[8:11], v4 offset:22528
v_lshlrev_b32 v182, v181, v182
v_mfma_f32_16x16x32_bf16 v[36:39], a[88:91], a[24:27], v[36:39]
ds_read_b128 a[12:15], v4 offset:23552
v_and_b32 v181, 0x32, v1
v_mfma_f32_16x16x32_bf16 v[40:43], a[92:95], a[24:27], v[40:43]
buffer_load_dwordx4 v234, s[24:27], s48 offen offset:2048 lds
s_add_u32 s48, s48, 81920
v_mfma_f32_16x16x32_bf16 v[44:47], a[24:27], a[96:99], v[44:47]
ds_read_b128 a[16:19], v4 offset:24576
v_cmp_eq_u32 vcc, 0x30, v181
v_mfma_f32_16x16x32_bf16 v[48:51], a[100:103], a[24:27], v[48:51]
ds_read_b64_tr_b16 a[192:193], v249 offset:12288
v_cmp_eq_u32 s[62:63], 50, v181
v_mfma_f32_16x16x32_bf16 v[52:55], a[88:91], a[28:31], v[52:55]
ds_read_b64_tr_b16 a[194:195], v249 offset:13056
s_add_u32 m0, s39, 61440
v_mfma_f32_16x16x32_bf16 v[56:59], a[92:95], a[28:31], v[56:59]
buffer_load_dwordx4 v232, s[24:27], s48 offen offset:0 lds
v_mul_u32_u24 v229, 176, v2
v_mfma_f32_16x16x32_bf16 v[60:63], a[28:31], a[96:99], v[60:63]
ds_read_b64_tr_b16 a[196:197], v252 offset:12288
v_cndmask_b32 v174, 0, v182, vcc
v_mfma_f32_16x16x32_bf16 v[64:67], a[100:103], a[28:31], v[64:67]
ds_read_b64_tr_b16 a[198:199], v252 offset:13056
v_cndmask_b32 v175, 0, v182, s[62:63]
v_mfma_f32_16x16x32_bf16 v[68:71], a[88:91], a[32:35], v[68:71]
ds_read_b64_tr_b16 a[206:207], v249 offset:19200
v_mov_b32 v122, 0
v_mfma_f32_16x16x32_bf16 v[72:75], a[92:95], a[32:35], v[72:75]
buffer_load_dwordx4 v233, s[24:27], s48 offen offset:1024 lds
v_mov_b32 v123, 0
v_mfma_f32_16x16x32_bf16 v[76:79], a[32:35], a[96:99], v[76:79]
ds_read_b64_tr_b16 a[200:201], v249 offset:12352
v_mov_b32 v126, 0
v_mfma_f32_16x16x32_bf16 v[80:83], a[100:103], a[32:35], v[80:83]
ds_read_b64_tr_b16 a[202:203], v249 offset:13120
v_mov_b32 v127, 0
v_mfma_f32_16x16x32_bf16 v[84:87], a[88:91], a[36:39], v[84:87]
ds_read_b64_tr_b16 a[208:209], v252 offset:18432
v_mov_b32 v130, 0
v_mfma_f32_16x16x32_bf16 v[88:91], a[92:95], a[36:39], v[88:91]
v_mov_b32 v131, 0
v_mov_b32 v134, 0
v_mfma_f32_16x16x32_bf16 v[92:95], a[36:39], a[96:99], v[92:95]
ds_read_b64_tr_b16 a[204:205], v249 offset:18432
v_mov_b32 v135, 0
v_mfma_f32_16x16x32_bf16 v[96:99], a[100:103], a[36:39], v[96:99]
s_waitcnt vmcnt(17) lgkmcnt(9)
v_mov_b32 v138, 0
v_mov_b32 v139, 0
v_mfma_f32_16x16x32_bf16 v[20:23], a[104:107], a[0:3], v[20:23]
ds_read_b128 a[20:23], v251 offset:25600
v_add_u32 v229, s61, v229
v_mfma_f32_16x16x32_bf16 v[24:27], a[108:111], a[0:3], v[24:27]
buffer_load_dwordx4 v234, s[24:27], s48 offen offset:2048 lds
s_add_u32 s48, s48, 81920
v_mfma_f32_16x16x32_bf16 v[28:31], a[0:3], a[112:115], v[28:31]
ds_read_b128 a[24:27], v251 offset:26624
v_lshl_add_u32 v228, v3, 3, v229
v_mfma_f32_16x16x32_bf16 v[32:35], a[116:119], a[0:3], v[32:35]
ds_read_b128 a[28:31], v251 offset:27648
v_mfma_f32_16x16x32_bf16 v[36:39], a[104:107], a[4:7], v[36:39]
ds_read_b128 a[32:35], v251 offset:28672
s_add_u32 m0, s39, 73728
v_mfma_f32_16x16x32_bf16 v[40:43], a[108:111], a[4:7], v[40:43]
buffer_load_dwordx4 v232, s[24:27], s48 offen offset:0 lds
v_mfma_f32_16x16x32_bf16 v[44:47], a[4:7], a[112:115], v[44:47]
ds_read_b128 a[36:39], v251 offset:29696
v_mfma_f32_16x16x32_bf16 v[48:51], a[116:119], a[4:7], v[48:51]
ds_read_b64_tr_b16 a[210:211], v252 offset:19200
v_mfma_f32_16x16x32_bf16 v[52:55], a[104:107], a[8:11], v[52:55]
ds_read_b64_tr_b16 a[212:213], v249 offset:18496
v_mfma_f32_16x16x32_bf16 v[56:59], a[108:111], a[8:11], v[56:59]
buffer_load_dwordx4 v233, s[24:27], s48 offen offset:1024 lds
v_mfma_f32_16x16x32_bf16 v[60:63], a[8:11], a[112:115], v[60:63]
ds_read_b64_tr_b16 a[214:215], v249 offset:19264
v_mfma_f32_16x16x32_bf16 v[64:67], a[116:119], a[8:11], v[64:67]
ds_read_b64_tr_b16 a[216:217], v249 offset:24576
v_mfma_f32_16x16x32_bf16 v[68:71], a[104:107], a[12:15], v[68:71]
ds_read_b64_tr_b16 a[224:225], v249 offset:24640
v_mfma_f32_16x16x32_bf16 v[72:75], a[108:111], a[12:15], v[72:75]
buffer_load_dwordx4 v234, s[24:27], s48 offen offset:2048 lds
s_add_u32 s48, s48, 81920
v_mfma_f32_16x16x32_bf16 v[76:79], a[12:15], a[112:115], v[76:79]
ds_read_b64_tr_b16 a[218:219], v249 offset:25344
v_mfma_f32_16x16x32_bf16 v[80:83], a[116:119], a[12:15], v[80:83]
ds_read_b64_tr_b16 a[220:221], v252 offset:24576
v_mfma_f32_16x16x32_bf16 v[84:87], a[104:107], a[16:19], v[84:87]
ds_read_b64_tr_b16 a[226:227], v249 offset:25408
s_add_u32 m0, s39, 86016
v_mfma_f32_16x16x32_bf16 v[88:91], a[108:111], a[16:19], v[88:91]
buffer_load_dwordx4 v232, s[24:27], s48 offen offset:0 lds
v_mfma_f32_16x16x32_bf16 v[92:95], a[16:19], a[112:115], v[92:95]
ds_read_b64_tr_b16 a[222:223], v252 offset:25344
v_mfma_f32_16x16x32_bf16 v[96:99], a[116:119], a[16:19], v[96:99]
s_waitcnt vmcnt(18) lgkmcnt(9)
v_mfma_f32_16x16x32_bf16 v[20:23], a[120:123], a[20:23], v[20:23]
ds_read_b128 a[0:3], v4 offset:30720
v_mfma_f32_16x16x32_bf16 v[24:27], a[124:127], a[20:23], v[24:27]
buffer_load_dwordx4 v233, s[24:27], s48 offen offset:1024 lds
v_mfma_f32_16x16x32_bf16 v[28:31], a[20:23], a[128:131], v[28:31]
ds_read_b128 a[4:7], v4 offset:31744
v_mfma_f32_16x16x32_bf16 v[32:35], a[132:135], a[20:23], v[32:35]
ds_read_b128 a[8:11], v4 offset:32768
v_mfma_f32_16x16x32_bf16 v[36:39], a[120:123], a[24:27], v[36:39]
ds_read_b128 a[12:15], v4 offset:33792
v_mfma_f32_16x16x32_bf16 v[40:43], a[124:127], a[24:27], v[40:43]
buffer_load_dwordx4 v234, s[24:27], s48 offen offset:2048 lds
s_add_u32 s48, s48, 81920
v_mfma_f32_16x16x32_bf16 v[44:47], a[24:27], a[128:131], v[44:47]
ds_read_b128 a[16:19], v4 offset:34816
v_mfma_f32_16x16x32_bf16 v[48:51], a[132:135], a[24:27], v[48:51]
ds_read_b64_tr_b16 a[228:229], v249 offset:30720
v_mfma_f32_16x16x32_bf16 v[52:55], a[120:123], a[28:31], v[52:55]
ds_read_b64_tr_b16 a[230:231], v249 offset:31488
s_add_u32 m0, s39, 98304
v_mfma_f32_16x16x32_bf16 v[56:59], a[124:127], a[28:31], v[56:59]
buffer_load_dwordx4 v232, s[24:27], s48 offen offset:0 lds
v_mfma_f32_16x16x32_bf16 v[60:63], a[28:31], a[128:131], v[60:63]
ds_read_b64_tr_b16 a[232:233], v252 offset:30720
v_mfma_f32_16x16x32_bf16 v[64:67], a[132:135], a[28:31], v[64:67]
ds_read_b64_tr_b16 a[234:235], v252 offset:31488
v_mfma_f32_16x16x32_bf16 v[68:71], a[120:123], a[32:35], v[68:71]
ds_read_b64_tr_b16 a[242:243], v249 offset:37632
v_mfma_f32_16x16x32_bf16 v[72:75], a[124:127], a[32:35], v[72:75]
buffer_load_dwordx4 v233, s[24:27], s48 offen offset:1024 lds
v_mfma_f32_16x16x32_bf16 v[76:79], a[32:35], a[128:131], v[76:79]
ds_read_b64_tr_b16 a[236:237], v249 offset:30784
v_mfma_f32_16x16x32_bf16 v[80:83], a[132:135], a[32:35], v[80:83]
ds_read_b64_tr_b16 a[238:239], v249 offset:31552
v_mfma_f32_16x16x32_bf16 v[84:87], a[120:123], a[36:39], v[84:87]
ds_read_b64_tr_b16 a[244:245], v252 offset:36864
v_mfma_f32_16x16x32_bf16 v[88:91], a[124:127], a[36:39], v[88:91]
buffer_load_dwordx4 v234, s[24:27], s48 offen offset:2048 lds
s_add_u32 s48, s48, 81920
v_mfma_f32_16x16x32_bf16 v[92:95], a[36:39], a[128:131], v[92:95]
ds_read_b64_tr_b16 a[240:241], v249 offset:36864
v_mfma_f32_16x16x32_bf16 v[96:99], a[132:135], a[36:39], v[96:99]
s_waitcnt vmcnt(19) lgkmcnt(9)
v_mfma_f32_16x16x32_bf16 v[20:23], a[136:139], a[0:3], v[20:23]
ds_read_b128 a[20:23], v251 offset:35840
s_add_u32 m0, s39, 110592
v_mfma_f32_16x16x32_bf16 v[24:27], a[140:143], a[0:3], v[24:27]
buffer_load_dwordx4 v232, s[24:27], s48 offen offset:0 lds
v_mfma_f32_16x16x32_bf16 v[28:31], a[0:3], a[144:147], v[28:31]
ds_read_b128 a[24:27], v251 offset:36864
v_mfma_f32_16x16x32_bf16 v[32:35], a[148:151], a[0:3], v[32:35]
ds_read_b128 a[28:31], v251 offset:37888
v_mfma_f32_16x16x32_bf16 v[36:39], a[136:139], a[4:7], v[36:39]
ds_read_b128 a[32:35], v251 offset:38912
v_mfma_f32_16x16x32_bf16 v[40:43], a[140:143], a[4:7], v[40:43]
buffer_load_dwordx4 v233, s[24:27], s48 offen offset:1024 lds
v_mfma_f32_16x16x32_bf16 v[44:47], a[4:7], a[144:147], v[44:47]
ds_read_b128 a[36:39], v251 offset:39936
v_mfma_f32_16x16x32_bf16 v[48:51], a[148:151], a[4:7], v[48:51]
ds_read_b64_tr_b16 a[246:247], v252 offset:37632
v_mfma_f32_16x16x32_bf16 v[52:55], a[136:139], a[8:11], v[52:55]
ds_read_b64_tr_b16 a[248:249], v249 offset:36928
v_mfma_f32_16x16x32_bf16 v[56:59], a[140:143], a[8:11], v[56:59]
buffer_load_dwordx4 v234, s[24:27], s48 offen offset:2048 lds
s_add_u32 s48, s48, 81920
v_mfma_f32_16x16x32_bf16 v[60:63], a[8:11], a[144:147], v[60:63]
ds_read_b64_tr_b16 a[250:251], v249 offset:37696
v_mfma_f32_16x16x32_bf16 v[64:67], a[148:151], a[8:11], v[64:67]
ds_read_b64_tr_b16 a[252:253], v249 offset:43008
v_mfma_f32_16x16x32_bf16 v[68:71], a[136:139], a[12:15], v[68:71]
ds_read_b64_tr_b16 a[44:45], v249 offset:43072
s_add_u32 m0, s49, 122880
v_mfma_f32_16x16x32_bf16 v[72:75], a[140:143], a[12:15], v[72:75]
buffer_load_dwordx4 v235, s[8:11], s50 offen offset:0 lds
v_mfma_f32_16x16x32_bf16 v[76:79], a[12:15], a[144:147], v[76:79]
ds_read_b64_tr_b16 a[254:255], v249 offset:43776
v_mfma_f32_16x16x32_bf16 v[80:83], a[148:151], a[12:15], v[80:83]
ds_read_b64_tr_b16 a[40:41], v252 offset:43008
v_mfma_f32_16x16x32_bf16 v[84:87], a[136:139], a[16:19], v[84:87]
ds_read_b64_tr_b16 a[46:47], v249 offset:43840
v_mfma_f32_16x16x32_bf16 v[88:91], a[140:143], a[16:19], v[88:91]
buffer_load_dwordx4 v236, s[8:11], s50 offen offset:1024 lds
v_mfma_f32_16x16x32_bf16 v[92:95], a[16:19], a[144:147], v[92:95]
ds_read_b64_tr_b16 a[42:43], v252 offset:43776
v_mfma_f32_16x16x32_bf16 v[96:99], a[148:151], a[16:19], v[96:99]
s_waitcnt vmcnt(20) lgkmcnt(9)
s_barrier
s_mov_b32 s62, 1051011932
s_mov_b32 s63, 1051011932
s_mov_b32 s36, 0
s_mov_b32 s37, 0x00ff00ff
v_mfma_f32_16x16x32_bf16 v[32:35], a[164:167], a[20:23], v[32:35]
buffer_load_dwordx4 v237, s[8:11], s50 offen offset:2048 lds
v_mfma_f32_16x16x32_bf16 v[48:51], a[164:167], a[24:27], v[48:51]
v_mfma_f32_16x16x32_bf16 v[64:67], a[164:167], a[28:31], v[64:67]
v_mfma_f32_16x16x32_bf16 v[80:83], a[164:167], a[32:35], v[80:83]
v_mfma_f32_16x16x32_bf16 v[20:23], a[152:155], a[20:23], v[20:23]
buffer_load_dwordx2 v[194:195], v231, s[4:7], s23 offen sc1
v_mfma_f32_16x16x32_bf16 v[24:27], a[156:159], a[20:23], v[24:27]
v_mfma_f32_16x16x32_bf16 v[36:39], a[152:155], a[24:27], v[36:39]
v_cvt_pk_bf16_f32 v102, v32, v33
v_mfma_f32_16x16x32_bf16 v[40:43], a[156:159], a[24:27], v[40:43]
buffer_load_dwordx4 v[240:243], v238, s[4:7], s51 offen sc1
v_cvt_pk_bf16_f32 v103, v34, v35
v_cvt_pk_bf16_f32 v106, v48, v49
v_mfma_f32_16x16x32_bf16 v[52:55], a[152:155], a[28:31], v[52:55]
v_cvt_pk_bf16_f32 v107, v50, v51
v_cvt_pk_bf16_f32 v110, v64, v65
v_mfma_f32_16x16x32_bf16 v[56:59], a[156:159], a[28:31], v[56:59]
buffer_load_dwordx4 v[190:193], v238, s[4:7], s22 offen sc1
v_cvt_pk_bf16_f32 v111, v66, v67
v_cvt_pk_bf16_f32 v114, v80, v81
v_mfma_f32_16x16x32_bf16 v[68:71], a[152:155], a[32:35], v[68:71]
v_cvt_pk_bf16_f32 v115, v82, v83
v_permlane32_swap_b32 v122, v102
v_mfma_f32_16x16x32_bf16 v[72:75], a[156:159], a[32:35], v[72:75]
buffer_load_dwordx2 v[244:245], v239, s[28:31], s52 offen
v_permlane32_swap_b32 v123, v103
v_permlane32_swap_b32 v126, v106
v_permlane32_swap_b32 v127, v107
v_permlane32_swap_b32 v130, v110
v_permlane32_swap_b32 v131, v111
v_permlane32_swap_b32 v134, v114
v_permlane32_swap_b32 v135, v115
v_cvt_pk_bf16_f32 v100, v24, v25
v_cvt_pk_bf16_f32 v101, v26, v27
v_cvt_pk_bf16_f32 v120, v20, v21
buffer_load_dword v196, v197, s[4:7], s14 offen sc1
v_cvt_pk_bf16_f32 v121, v22, v23
v_cvt_pk_bf16_f32 v104, v40, v41
v_cvt_pk_bf16_f32 v105, v42, v43
v_cvt_pk_bf16_f32 v124, v36, v37
v_cvt_pk_bf16_f32 v125, v38, v39
v_cvt_pk_bf16_f32 v108, v56, v57
v_cvt_pk_bf16_f32 v109, v58, v59
v_cvt_pk_bf16_f32 v128, v52, v53
v_cvt_pk_bf16_f32 v129, v54, v55
v_cvt_pk_bf16_f32 v112, v72, v73
v_cvt_pk_bf16_f32 v113, v74, v75
v_cvt_pk_bf16_f32 v132, v68, v69
v_cvt_pk_bf16_f32 v133, v70, v71
v_mfma_f32_16x16x32_bf16 v[24:27], v[100:103], v[120:123], v[164:167]
v_mfma_f32_16x16x32_bf16 v[40:43], v[104:107], v[124:127], v[164:167]
v_mfma_f32_16x16x32_bf16 v[36:39], v[100:103], v[124:127], v[164:167]
v_mfma_f32_16x16x32_bf16 v[56:59], v[108:111], v[128:131], v[164:167]
v_mfma_f32_16x16x32_bf16 v[52:55], v[104:107], v[128:131], v[164:167]
v_mfma_f32_16x16x32_bf16 v[72:75], v[112:115], v[132:135], v[164:167]
v_mfma_f32_16x16x32_bf16 v[68:71], v[108:111], v[132:135], v[164:167]
s_nop 1
v_cndmask_b32 v24, v24, v168, s[36:37]
v_cndmask_b32 v25, v25, v168, s[36:37]
v_cndmask_b32 v26, v26, v168, s[36:37]
v_cndmask_b32 v40, v40, v36, s[36:37]
v_cndmask_b32 v41, v41, v37, s[36:37]
v_cndmask_b32 v42, v42, v38, s[36:37]
v_cndmask_b32 v56, v56, v52, s[36:37]
v_cndmask_b32 v57, v57, v53, s[36:37]
v_cndmask_b32 v58, v58, v54, s[36:37]
v_cndmask_b32 v72, v72, v68, s[36:37]
v_cndmask_b32 v73, v73, v69, s[36:37]
v_cndmask_b32 v74, v74, v70, s[36:37]
v_cndmask_b32 v27, v27, v168, s[36:37]
v_max3_f32 v180, v24, v25, v26
v_cndmask_b32 v43, v43, v39, s[36:37]
v_max3_f32 v181, v40, v41, v42
v_cndmask_b32 v59, v59, v55, s[36:37]
v_max3_f32 v182, v56, v57, v58
v_cndmask_b32 v75, v75, v71, s[36:37]
v_max3_f32 v183, v72, v73, v74
v_max_f32 v180, v180, v27
v_max_f32 v181, v181, v43
v_max_f32 v182, v182, v59
v_max_f32 v183, v183, v75
v_mfma_f32_16x16x32_bf16 v[96:99], a[164:167], a[36:39], v[96:99]
v_permlane32_swap_b32 v180, v182
v_permlane32_swap_b32 v181, v183
v_max_f32 v180, v180, v182
v_max_f32 v181, v181, v183
v_mfma_f32_16x16x32_bf16 v[84:87], a[152:155], a[36:39], v[84:87]
s_nop 0
v_permlane16_swap_b32 v180, v181
v_max_f32 v181, v180, v181
v_mul_f32 v180, s62, v181
v_mul_f32 v182, s62, v181
v_mfma_f32_16x16x32_bf16 v[88:91], a[156:159], a[36:39], v[88:91]
s_nop 0
v_permlane32_swap_b32 v180, v182
v_mfma_f32_16x16x32_bf16 v[28:31], a[20:23], a[160:163], v[28:31]
v_mov_b32 v181, v180
v_cvt_pk_bf16_f32 v118, v96, v97
v_mfma_f32_16x16x16_bf16 v[32:35], v[102:103], v[174:175], 0
v_cvt_pk_bf16_f32 v119, v98, v99
v_permlane16_swap_b32 v180, v181
v_mfma_f32_16x16x32_bf16 v[44:47], a[24:27], a[160:163], v[44:47]
v_permlane32_swap_b32 v138, v118
v_permlane32_swap_b32 v139, v119
v_cvt_pk_bf16_f32 v116, v88, v89
v_pk_fma_f32 v[24:25], v[24:25], s[62:63], v[180:181] op_sel:[0,0,0] op_sel_hi:[1,0,0] neg_lo:[0,0,1] neg_hi:[0,0,1]
v_pk_fma_f32 v[26:27], v[26:27], s[62:63], v[180:181] op_sel:[0,0,0] op_sel_hi:[1,0,0] neg_lo:[0,0,1] neg_hi:[0,0,1]
v_cvt_pk_bf16_f32 v117, v90, v91
v_cvt_pk_bf16_f32 v136, v84, v85
v_cvt_pk_bf16_f32 v137, v86, v87
v_exp_f32 v24, v24
v_exp_f32 v25, v25
v_exp_f32 v26, v26
v_exp_f32 v27, v27
v_cvt_pk_bf16_f32 v143, v30, v31
v_mfma_f32_16x16x16_bf16 v[48:51], v[106:107], v[174:175], 0
v_cvt_pk_bf16_f32 v30, v24, v25
v_cvt_pk_bf16_f32 v31, v26, v27
v_mfma_f32_16x16x32_bf16 v[88:91], v[116:119], v[136:139], v[164:167]
v_cvt_pk_bf16_f32 v154, v32, v33
v_cvt_pk_bf16_f32 v155, v34, v35
v_mfma_f32_16x16x32_bf16 v[84:87], v[112:115], v[136:139], v[164:167]
v_cvt_pk_bf16_f32 v142, v28, v29
v_cvt_pk_bf16_f32 v145, v46, v47
v_mfma_f32_16x16x32_bf16 v[60:63], a[28:31], a[160:163], v[60:63]
v_mov_b32 v183, v182
v_cvt_pk_bf16_f32 v144, v44, v45
v_mfma_f32_16x16x16_bf16 v[32:35], v[176:177], v[30:31], 0
v_permlane16_swap_b32 v182, v183
v_mfma_f32_16x16x16_bf16 v[20:23], v[142:143], v[30:31], 0
v_cvt_pk_bf16_f32 v156, v48, v49
v_cvt_pk_bf16_f32 v157, v50, v51
v_mfma_f32_16x16x16_bf16 v[64:67], v[110:111], v[174:175], 0
v_cndmask_b32 v88, v88, v84, s[36:37]
v_cndmask_b32 v89, v89, v85, s[36:37]
v_cndmask_b32 v90, v90, v86, s[36:37]
v_mfma_f32_16x16x16_bf16 v[24:27], v[154:155], v[30:31], 0
v_cndmask_b32 v91, v91, v87, s[36:37]
v_max3_f32 v184, v88, v89, v90
v_mfma_f32_16x16x32_bf16 v[76:79], a[32:35], a[160:163], v[76:79]
v_max_f32 v184, v184, v91
v_cvt_pk_bf16_f32 v147, v62, v63
v_mov_b32 v185, v184
v_rcp_f32 v32, v32
v_pk_fma_f32 v[40:41], v[40:41], s[62:63], v[180:181] op_sel:[0,0,1] op_sel_hi:[1,0,1] neg_lo:[0,0,1] neg_hi:[0,0,1]
v_pk_fma_f32 v[42:43], v[42:43], s[62:63], v[180:181] op_sel:[0,0,1] op_sel_hi:[1,0,1] neg_lo:[0,0,1] neg_hi:[0,0,1]
v_exp_f32 v40, v40
v_exp_f32 v41, v41
v_exp_f32 v42, v42
v_exp_f32 v43, v43
v_cvt_pk_bf16_f32 v46, v40, v41
v_cvt_pk_bf16_f32 v47, v42, v43
v_cndmask_b32 v44, 0, v46, s[36:37]
v_cndmask_b32 v45, 0, v47, s[36:37]
v_xor_b32 v46, v44, v46
v_xor_b32 v47, v45, v47
v_pk_fma_f32 v[56:57], v[56:57], s[62:63], v[182:183] op_sel:[0,0,0] op_sel_hi:[1,0,0] neg_lo:[0,0,1] neg_hi:[0,0,1]
v_pk_fma_f32 v[58:59], v[58:59], s[62:63], v[182:183] op_sel:[0,0,0] op_sel_hi:[1,0,0] neg_lo:[0,0,1] neg_hi:[0,0,1]
v_mfma_f32_16x16x32_bf16 v[48:51], v[176:179], v[44:47], 0
v_exp_f32 v56, v56
v_exp_f32 v57, v57
v_exp_f32 v58, v58
v_exp_f32 v59, v59
v_cvt_pk_bf16_f32 v146, v60, v61
v_mfma_f32_16x16x32_bf16 v[36:39], v[142:145], v[44:47], 0
v_cvt_pk_bf16_f32 v62, v56, v57
v_cvt_pk_bf16_f32 v63, v58, v59
v_cndmask_b32 v60, 0, v62, s[36:37]
v_cndmask_b32 v61, 0, v63, s[36:37]
v_mfma_f32_16x16x16_bf16 v[80:83], v[114:115], v[174:175], 0
v_permlane32_swap_b32 v184, v185
v_xor_b32 v62, v60, v62
v_xor_b32 v63, v61, v63
v_cvt_pk_bf16_f32 v158, v64, v65
v_pk_mul_f32 v[20:21], v[20:21], v[32:33] op_sel_hi:[1,0]
v_pk_mul_f32 v[22:23], v[22:23], v[32:33] op_sel_hi:[1,0]
v_cvt_pk_bf16_f32 v20, v20, v21
v_cvt_pk_bf16_f32 v159, v66, v67
v_max_f32 v184, v184, v185
v_cvt_pk_bf16_f32 v21, v22, v23
v_mfma_f32_16x16x32_bf16 v[40:43], v[154:157], v[44:47], 0
ds_write_b64 v228, v[20:21] offset:0
v_mfma_f32_16x16x32_bf16 v[92:95], a[36:39], a[160:163], v[92:95]
v_mov_b32 v185, v184
v_cvt_pk_bf16_f32 v149, v78, v79
v_mfma_f32_16x16x32_bf16 v[64:67], v[176:179], v[60:63], 0
v_rcp_f32 v48, v48
v_cvt_pk_bf16_f32 v148, v76, v77
v_permlane16_swap_b32 v184, v185
v_pk_fma_f32 v[72:73], v[72:73], s[62:63], v[182:183] op_sel:[0,0,1] op_sel_hi:[1,0,1] neg_lo:[0,0,1] neg_hi:[0,0,1]
v_pk_fma_f32 v[74:75], v[74:75], s[62:63], v[182:183] op_sel:[0,0,1] op_sel_hi:[1,0,1] neg_lo:[0,0,1] neg_hi:[0,0,1]
v_exp_f32 v72, v72
v_exp_f32 v73, v73
v_exp_f32 v74, v74
v_exp_f32 v75, v75
v_pk_mul_f32 v[24:25], v[24:25], v[32:33] op_sel_hi:[1,0]
v_pk_mul_f32 v[26:27], v[26:27], v[32:33] op_sel_hi:[1,0]
v_cvt_pk_bf16_f32 v24, v24, v25
v_cvt_pk_bf16_f32 v25, v26, v27
v_mfma_f32_16x16x32_bf16 v[52:55], v[144:147], v[60:63], 0
ds_write_b64 v229, v[24:25] offset:32
v_cvt_pk_bf16_f32 v78, v72, v73
v_cvt_pk_bf16_f32 v79, v74, v75
v_cndmask_b32 v76, 0, v78, s[36:37]
v_cndmask_b32 v77, 0, v79, s[36:37]
v_mfma_f32_16x16x16_bf16 v[96:99], v[118:119], v[174:175], 0
v_max_f32 v184, v184, v185
v_xor_b32 v78, v76, v78
v_xor_b32 v79, v77, v79
v_mul_f32 v184, s62, v184
v_cvt_pk_bf16_f32 v160, v80, v81
v_pk_mul_f32 v[36:37], v[36:37], v[48:49] op_sel_hi:[1,0]
v_pk_mul_f32 v[38:39], v[38:39], v[48:49] op_sel_hi:[1,0]
v_cvt_pk_bf16_f32 v36, v36, v37
v_cvt_pk_bf16_f32 v161, v82, v83
v_cvt_pk_bf16_f32 v37, v38, v39
v_mfma_f32_16x16x32_bf16 v[56:59], v[156:159], v[60:63], 0
ds_write_b64 v228, v[36:37] offset:2816
v_mfma_f32_16x16x32_bf16 v[80:83], v[176:179], v[76:79], 0
v_cvt_pk_bf16_f32 v151, v94, v95
v_rcp_f32 v64, v64
v_cvt_pk_bf16_f32 v150, v92, v93
v_mfma_f32_16x16x32_bf16 v[68:71], v[146:149], v[76:79], 0
v_cvt_pk_bf16_f32 v162, v96, v97
v_cvt_pk_bf16_f32 v163, v98, v99
v_mfma_f32_16x16x32_bf16 v[72:75], v[158:161], v[76:79], 0
s_nop 0
v_rcp_f32 v80, v80
v_pk_fma_f32 v[88:89], v[88:89], s[62:63], v[184:185] op_sel:[0,0,0] op_sel_hi:[1,0,0] neg_lo:[0,0,1] neg_hi:[0,0,1]
v_pk_fma_f32 v[90:91], v[90:91], s[62:63], v[184:185] op_sel:[0,0,0] op_sel_hi:[1,0,0] neg_lo:[0,0,1] neg_hi:[0,0,1]
v_exp_f32 v88, v88
v_exp_f32 v89, v89
v_exp_f32 v90, v90
v_exp_f32 v91, v91
v_pk_mul_f32 v[40:41], v[40:41], v[48:49] op_sel_hi:[1,0]
v_pk_mul_f32 v[42:43], v[42:43], v[48:49] op_sel_hi:[1,0]
v_cvt_pk_bf16_f32 v40, v40, v41
v_cvt_pk_bf16_f32 v41, v42, v43
v_cvt_pk_bf16_f32 v94, v88, v89
v_cvt_pk_bf16_f32 v95, v90, v91
ds_write_b64 v229, v[40:41] offset:2848
v_cndmask_b32 v92, 0, v94, s[36:37]
v_cndmask_b32 v93, 0, v95, s[36:37]
v_pk_mul_f32 v[52:53], v[52:53], v[64:65] op_sel_hi:[1,0]
v_xor_b32 v94, v92, v94
v_xor_b32 v95, v93, v95
v_pk_mul_f32 v[54:55], v[54:55], v[64:65] op_sel_hi:[1,0]
v_cvt_pk_bf16_f32 v52, v52, v53
v_cvt_pk_bf16_f32 v53, v54, v55
ds_write_b64 v228, v[52:53] offset:5632
v_mfma_f32_16x16x32_bf16 v[96:99], v[176:179], v[92:95], 0
v_mfma_f32_16x16x32_bf16 v[84:87], v[148:151], v[92:95], 0
v_mfma_f32_16x16x32_bf16 v[88:91], v[160:163], v[92:95], 0
v_pk_mul_f32 v[56:57], v[56:57], v[64:65] op_sel_hi:[1,0]
v_pk_mul_f32 v[58:59], v[58:59], v[64:65] op_sel_hi:[1,0]
v_cvt_pk_bf16_f32 v56, v56, v57
v_cvt_pk_bf16_f32 v57, v58, v59
ds_write_b64 v229, v[56:57] offset:5664
v_pk_mul_f32 v[68:69], v[68:69], v[80:81] op_sel_hi:[1,0]
v_pk_mul_f32 v[70:71], v[70:71], v[80:81] op_sel_hi:[1,0]
v_cvt_pk_bf16_f32 v68, v68, v69
v_cvt_pk_bf16_f32 v69, v70, v71
ds_write_b64 v228, v[68:69] offset:8448
v_pk_mul_f32 v[72:73], v[72:73], v[80:81] op_sel_hi:[1,0]
v_pk_mul_f32 v[74:75], v[74:75], v[80:81] op_sel_hi:[1,0]
v_cvt_pk_bf16_f32 v72, v72, v73
v_rcp_f32 v96, v96
v_cvt_pk_bf16_f32 v73, v74, v75
ds_write_b64 v229, v[72:73] offset:8480
v_pk_mul_f32 v[84:85], v[84:85], v[96:97] op_sel_hi:[1,0]
v_pk_mul_f32 v[86:87], v[86:87], v[96:97] op_sel_hi:[1,0]
v_cvt_pk_bf16_f32 v84, v84, v85
v_cvt_pk_bf16_f32 v85, v86, v87
ds_write_b64 v228, v[84:85] offset:11264
v_pk_mul_f32 v[88:89], v[88:89], v[96:97] op_sel_hi:[1,0]
v_pk_mul_f32 v[90:91], v[90:91], v[96:97] op_sel_hi:[1,0]
v_cvt_pk_bf16_f32 v88, v88, v89
v_cvt_pk_bf16_f32 v89, v90, v91
ds_write_b64 v229, v[88:89] offset:11296
s_waitcnt lgkmcnt(0)
s_barrier
ds_read_b128 v[20:23], v15 offset:0
ds_read_b128 v[24:27], v16 offset:256
ds_read_b128 v[28:31], v17 offset:512
ds_read_b128 v[32:35], v18 offset:768
s_mul_i32 s56, s53, 20480
s_add_u32 s56, s56, 4194304
s_add_u32 s57, s56, 4096
s_add_u32 s58, s56, 8192
s_add_u32 s59, s56, 12288
s_add_u32 s60, s56, 16384
s_mov_b32 s55, 0x05040100
s_waitcnt lgkmcnt(3)
buffer_store_dwordx4 v[20:23], v11, s[4:7], s46 offen sc1
s_waitcnt lgkmcnt(2)
buffer_store_dwordx4 v[24:27], v12, s[4:7], s46 offen sc1
s_waitcnt lgkmcnt(1)
buffer_store_dwordx4 v[28:31], v13, s[4:7], s46 offen sc1
s_waitcnt lgkmcnt(0)
buffer_store_dwordx4 v[32:35], v14, s[4:7], s46 offen sc1
s_waitcnt vmcnt(4)
v_perm_b32 v36, v241, v240, s55
v_perm_b32 v37, v243, v242, s55
v_xor_b32 v36, s40, v36
v_xor_b32 v37, s40, v37
v_or_b32 v38, v36, v37
v_perm_b32 v36, v191, v190, s55
v_perm_b32 v37, v193, v192, s55
v_xor_b32 v36, s40, v36
v_xor_b32 v37, s40, v37
v_or3_b32 v38, v38, v36, v37
v_and_b32 v38, v38, v230
v_xor_b32 v37, s40, v194
v_or_b32 v38, v38, v37
v_cmp_ne_u32 vcc, 0, v38
s_barrier
s_cbranch_vccnz L_mv_retry
L_mv_ok:
v_cmp_ne_u32 vcc, s19, v195
v_and_b32 v240, 0xffff0000, v240
v_and_b32 v241, 0xffff0000, v241
v_and_b32 v242, 0xffff0000, v242
v_and_b32 v243, 0xffff0000, v243
v_and_b32 v190, 0xffff0000, v190
v_and_b32 v191, 0xffff0000, v191
v_and_b32 v192, 0xffff0000, v192
v_and_b32 v193, 0xffff0000, v193
s_lshr_b32 s15, vcc_lo, 16
v_lshlrev_b32 v40, 16, v244
v_and_b32 v41, 0xffff0000, v244
v_lshlrev_b32 v42, 16, v245
v_and_b32 v43, 0xffff0000, v245
v_pk_mul_f32 v[40:41], v[40:41], v[190:191]
v_pk_mul_f32 v[42:43], v[42:43], v[192:193]
s_mov_b32 exec_hi, 0xffff
ds_write_b128 v198, v[40:43] offset:1536
ds_write_b128 v198, v[240:243]
ds_write_b128 v198, v[190:193] offset:768
s_mov_b32 exec_hi, -1
ds_read_b128 v[204:207], v247 offset:1536
ds_read_b128 v[208:211], v247 offset:1600
ds_read_b128 v[212:215], v247 offset:1664
ds_read_b128 v[216:219], v247 offset:1728
ds_read_b128 v[220:223], v247 offset:1792
ds_read_b128 v[224:227], v247 offset:1856
ds_read_b64 v[80:81], v248 offset:0
ds_read_b64 v[82:83], v248 offset:32
ds_read_b64 v[84:85], v248 offset:64
ds_read_b64 v[86:87], v248 offset:96
ds_read_b64 v[88:89], v248 offset:128
ds_read_b64 v[90:91], v248 offset:160
ds_read_b64_tr_b16 a[48:49], v249 offset:49152
ds_read_b64_tr_b16 a[50:51], v249 offset:49920
ds_read_b64_tr_b16 a[52:53], v252 offset:49152
ds_read_b64_tr_b16 a[54:55], v252 offset:49920
ds_read_b64_tr_b16 a[56:57], v249 offset:49216
ds_read_b64_tr_b16 a[58:59], v249 offset:49984
ds_read_b64_tr_b16 a[60:61], v249 offset:55296
ds_read_b64_tr_b16 a[62:63], v249 offset:56064
ds_read_b64_tr_b16 a[64:65], v252 offset:55296
ds_read_b64_tr_b16 a[66:67], v252 offset:56064
ds_read_b64_tr_b16 a[68:69], v249 offset:55360
ds_read_b64_tr_b16 a[70:71], v249 offset:56128
ds_read_b64_tr_b16 a[72:73], v253 offset:0
ds_read_b64_tr_b16 a[74:75], v253 offset:768
ds_read_b64_tr_b16 a[76:77], v254 offset:0
ds_read_b64_tr_b16 a[78:79], v254 offset:768
ds_read_b64_tr_b16 a[80:81], v253 offset:64
ds_read_b64_tr_b16 a[82:83], v253 offset:832
ds_read_b64_tr_b16 a[84:85], v253 offset:6144
ds_read_b64_tr_b16 a[86:87], v253 offset:6912
ds_read_b64_tr_b16 a[88:89], v254 offset:6144
ds_read_b64_tr_b16 a[90:91], v254 offset:6912
ds_read_b64_tr_b16 a[92:93], v253 offset:6208
ds_read_b64_tr_b16 a[94:95], v253 offset:6976
ds_read_b64_tr_b16 a[96:97], v253 offset:12288
ds_read_b64_tr_b16 a[98:99], v253 offset:13056
ds_read_b64_tr_b16 a[100:101], v254 offset:12288
ds_read_b64_tr_b16 a[102:103], v254 offset:13056
ds_read_b64_tr_b16 a[104:105], v253 offset:12352
ds_read_b64_tr_b16 a[106:107], v253 offset:13120
ds_read_b64_tr_b16 a[108:109], v253 offset:18432
ds_read_b64_tr_b16 a[110:111], v253 offset:19200
ds_read_b64_tr_b16 a[112:113], v254 offset:18432
ds_read_b64_tr_b16 a[114:115], v254 offset:19200
ds_read_b64_tr_b16 a[116:117], v253 offset:18496
ds_read_b64_tr_b16 a[118:119], v253 offset:19264
ds_read_b64_tr_b16 a[120:121], v253 offset:24576
ds_read_b64_tr_b16 a[122:123], v253 offset:25344
ds_read_b64_tr_b16 a[124:125], v254 offset:24576
ds_read_b64_tr_b16 a[126:127], v254 offset:25344
ds_read_b64_tr_b16 a[128:129], v253 offset:24640
ds_read_b64_tr_b16 a[130:131], v253 offset:25408
ds_read_b64_tr_b16 a[132:133], v253 offset:30720
ds_read_b64_tr_b16 a[134:135], v253 offset:31488
ds_read_b64_tr_b16 a[136:137], v254 offset:30720
ds_read_b64_tr_b16 a[138:139], v254 offset:31488
ds_read_b64_tr_b16 a[140:141], v253 offset:30784
ds_read_b64_tr_b16 a[142:143], v253 offset:31552
ds_read_b64_tr_b16 a[144:145], v253 offset:36864
ds_read_b64_tr_b16 a[146:147], v253 offset:37632
ds_read_b64_tr_b16 a[148:149], v254 offset:36864
ds_read_b64_tr_b16 a[150:151], v254 offset:37632
ds_read_b64_tr_b16 a[152:153], v253 offset:36928
ds_read_b64_tr_b16 a[154:155], v253 offset:37696
ds_read_b64_tr_b16 a[156:157], v253 offset:43008
ds_read_b64_tr_b16 a[158:159], v253 offset:43776
ds_read_b64_tr_b16 a[160:161], v254 offset:43008
ds_read_b64_tr_b16 a[162:163], v254 offset:43776
buffer_load_dwordx4 v[100:103], v7, s[4:7], s56 offen offset:0 sc1
ds_read_b64_tr_b16 a[164:165], v253 offset:43072
ds_read_b64_tr_b16 a[166:167], v253 offset:43840
ds_read_b64_tr_b16 a[0:1], v253 offset:49152
ds_read_b64_tr_b16 a[2:3], v253 offset:49920
buffer_load_dwordx4 v[104:107], v7, s[4:7], s56 offen offset:1024 sc1
ds_read_b64_tr_b16 a[4:5], v254 offset:49152
ds_read_b64_tr_b16 a[6:7], v254 offset:49920
ds_read_b64_tr_b16 a[8:9], v253 offset:49216
ds_read_b64_tr_b16 a[10:11], v253 offset:49984
buffer_load_dwordx4 v[108:111], v7, s[4:7], s56 offen offset:2048 sc1
ds_read_b64_tr_b16 a[12:13], v253 offset:55296
ds_read_b64_tr_b16 a[14:15], v253 offset:56064
ds_read_b64_tr_b16 a[16:17], v254 offset:55296
ds_read_b64_tr_b16 a[18:19], v254 offset:56064
buffer_load_dwordx4 v[112:115], v7, s[4:7], s56 offen offset:3072 sc1
ds_read_b64_tr_b16 a[20:21], v253 offset:55360
ds_read_b64_tr_b16 a[22:23], v253 offset:56128
ds_read_b64_tr_b16 v[44:45], v252 offset:64
ds_read_b64_tr_b16 v[46:47], v252 offset:832
buffer_load_dwordx4 v[116:119], v7, s[4:7], s57 offen offset:0 sc1
ds_read_b64_tr_b16 v[48:49], v249 offset:128
ds_read_b64_tr_b16 v[50:51], v249 offset:896
ds_read_b64_tr_b16 v[52:53], v252 offset:128
ds_read_b64_tr_b16 v[54:55], v252 offset:896
buffer_load_dwordx4 v[120:123], v7, s[4:7], s57 offen offset:1024 sc1
s_waitcnt lgkmcnt(15)
v_pk_add_f32 v[94:95], v[204:205], v[206:207]
v_pk_add_f32 v[94:95], v[94:95], v[208:209]
v_pk_add_f32 v[94:95], v[94:95], v[210:211]
buffer_load_dwordx4 v[124:127], v7, s[4:7], s57 offen offset:2048 sc1
v_pk_add_f32 v[94:95], v[94:95], v[212:213]
v_pk_add_f32 v[94:95], v[94:95], v[214:215]
v_pk_add_f32 v[94:95], v[94:95], v[216:217]
v_pk_add_f32 v[94:95], v[94:95], v[218:219]
buffer_load_dwordx4 v[128:131], v7, s[4:7], s57 offen offset:3072 sc1
v_pk_add_f32 v[94:95], v[94:95], v[220:221]
v_pk_add_f32 v[94:95], v[94:95], v[222:223]
v_pk_add_f32 v[94:95], v[94:95], v[224:225]
v_pk_add_f32 v[94:95], v[94:95], v[226:227]
v_add_f32 v95, v94, v95
s_waitcnt vmcnt(6) lgkmcnt(6)
v_max3_u32 v92, v100, v101, v102
v_max3_u32 v93, v103, v104, v105
v_max3_u32 v92, v92, v106, v107
v_max_u32 v92, v92, v93
v_cmp_eq_u32 vcc, -1, v92
s_cbranch_vccnz L_o0_retry
L_o0_ok:
v_mfma_f32_16x16x32_bf16 v[20:23], a[168:171], v[100:103], 0
ds_read_b64_tr_b16 v[56:57], v252 offset:6208
buffer_load_dwordx4 v[132:135], v7, s[4:7], s58 offen offset:0 sc1
v_mfma_f32_16x16x32_bf16 v[24:27], a[172:175], v[100:103], 0
ds_read_b64_tr_b16 v[58:59], v252 offset:6976
buffer_load_dwordx4 v[136:139], v7, s[4:7], s58 offen offset:1024 sc1
v_mfma_f32_16x16x32_bf16 v[28:31], a[176:179], v[100:103], 0
ds_read_b64_tr_b16 v[60:61], v249 offset:6272
s_waitcnt lgkmcnt(3)
v_mfma_f32_16x16x32_bf16 v[32:35], v[44:47], v[100:103], 0
ds_read_b64_tr_b16 v[62:63], v249 offset:7040
s_waitcnt vmcnt(6)
v_mfma_f32_16x16x32_bf16 v[36:39], v[48:51], v[100:103], 0
ds_read_b64_tr_b16 v[64:65], v252 offset:6272
v_max3_u32 v92, v108, v109, v110
v_mfma_f32_16x16x32_bf16 v[40:43], v[52:55], v[100:103], 0
ds_read_b64_tr_b16 v[66:67], v252 offset:7040
v_max3_u32 v93, v111, v112, v113
v_mfma_f32_16x16x32_bf16 v[20:23], a[180:183], v[104:107], v[20:23]
ds_read_b64_tr_b16 v[44:45], v252 offset:12352
v_max3_u32 v92, v92, v114, v115
v_mfma_f32_16x16x32_bf16 v[24:27], a[184:187], v[104:107], v[24:27]
ds_read_b64_tr_b16 v[46:47], v252 offset:13120
v_max_u32 v92, v92, v93
v_mfma_f32_16x16x32_bf16 v[28:31], a[188:191], v[104:107], v[28:31]
ds_read_b64_tr_b16 v[48:49], v249 offset:12416
s_waitcnt lgkmcnt(3)
v_mfma_f32_16x16x32_bf16 v[32:35], v[56:59], v[104:107], v[32:35]
ds_read_b64_tr_b16 v[50:51], v249 offset:13184
v_cmp_eq_u32 vcc, -1, v92
v_mfma_f32_16x16x32_bf16 v[36:39], v[60:63], v[104:107], v[36:39]
ds_read_b64_tr_b16 v[52:53], v252 offset:12416
v_lshlrev_b32 v68, 16, v80
v_mfma_f32_16x16x32_bf16 v[40:43], v[64:67], v[104:107], v[40:43]
ds_read_b64_tr_b16 v[54:55], v252 offset:13184
s_cbranch_vccnz L_o1_retry
L_o1_ok:
v_mfma_f32_16x16x32_bf16 v[20:23], a[192:195], v[108:111], v[20:23]
ds_read_b64_tr_b16 v[56:57], v252 offset:18496
buffer_load_dwordx4 v[140:143], v7, s[4:7], s58 offen offset:2048 sc1
v_mfma_f32_16x16x32_bf16 v[24:27], a[196:199], v[108:111], v[24:27]
ds_read_b64_tr_b16 v[58:59], v252 offset:19264
buffer_load_dwordx4 v[144:147], v7, s[4:7], s58 offen offset:3072 sc1
v_mfma_f32_16x16x32_bf16 v[28:31], a[200:203], v[108:111], v[28:31]
ds_read_b64_tr_b16 v[60:61], v249 offset:18560
s_waitcnt lgkmcnt(3)
v_mfma_f32_16x16x32_bf16 v[32:35], v[44:47], v[108:111], v[32:35]
ds_read_b64_tr_b16 v[62:63], v249 offset:19328
s_waitcnt vmcnt(6)
v_mfma_f32_16x16x32_bf16 v[36:39], v[48:51], v[108:111], v[36:39]
ds_read_b64_tr_b16 v[64:65], v252 offset:18560
v_max3_u32 v92, v116, v117, v118
v_mfma_f32_16x16x32_bf16 v[40:43], v[52:55], v[108:111], v[40:43]
ds_read_b64_tr_b16 v[66:67], v252 offset:19328
v_max3_u32 v93, v119, v120, v121
v_mfma_f32_16x16x32_bf16 v[20:23], a[204:207], v[112:115], v[20:23]
ds_read_b64_tr_b16 v[44:45], v252 offset:24640
v_max3_u32 v92, v92, v122, v123
v_mfma_f32_16x16x32_bf16 v[24:27], a[208:211], v[112:115], v[24:27]
ds_read_b64_tr_b16 v[46:47], v252 offset:25408
v_max_u32 v92, v92, v93
v_mfma_f32_16x16x32_bf16 v[28:31], a[212:215], v[112:115], v[28:31]
ds_read_b64_tr_b16 v[48:49], v249 offset:24704
s_waitcnt lgkmcnt(3)
v_mfma_f32_16x16x32_bf16 v[32:35], v[56:59], v[112:115], v[32:35]
ds_read_b64_tr_b16 v[50:51], v249 offset:25472
v_cmp_eq_u32 vcc, -1, v92
v_mfma_f32_16x16x32_bf16 v[36:39], v[60:63], v[112:115], v[36:39]
ds_read_b64_tr_b16 v[52:53], v252 offset:24704
v_and_b32 v69, 0xffff0000, v80
v_mfma_f32_16x16x32_bf16 v[40:43], v[64:67], v[112:115], v[40:43]
ds_read_b64_tr_b16 v[54:55], v252 offset:25472
s_cbranch_vccnz L_o2_retry
L_o2_ok:
v_mfma_f32_16x16x32_bf16 v[20:23], a[216:219], v[116:119], v[20:23]
ds_read_b64_tr_b16 v[56:57], v252 offset:30784
buffer_load_dwordx4 v[148:151], v7, s[4:7], s59 offen offset:0 sc1
v_mfma_f32_16x16x32_bf16 v[24:27], a[220:223], v[116:119], v[24:27]
ds_read_b64_tr_b16 v[58:59], v252 offset:31552
buffer_load_dwordx4 v[152:155], v7, s[4:7], s59 offen offset:1024 sc1
v_mfma_f32_16x16x32_bf16 v[28:31], a[224:227], v[116:119], v[28:31]
ds_read_b64_tr_b16 v[60:61], v249 offset:30848
s_waitcnt lgkmcnt(3)
v_mfma_f32_16x16x32_bf16 v[32:35], v[44:47], v[116:119], v[32:35]
ds_read_b64_tr_b16 v[62:63], v249 offset:31616
s_waitcnt vmcnt(6)
v_mfma_f32_16x16x32_bf16 v[36:39], v[48:51], v[116:119], v[36:39]
ds_read_b64_tr_b16 v[64:65], v252 offset:30848
v_max3_u32 v92, v124, v125, v126
v_mfma_f32_16x16x32_bf16 v[40:43], v[52:55], v[116:119], v[40:43]
ds_read_b64_tr_b16 v[66:67], v252 offset:31616
v_max3_u32 v93, v127, v128, v129
v_mfma_f32_16x16x32_bf16 v[20:23], a[228:231], v[120:123], v[20:23]
ds_read_b64_tr_b16 v[44:45], v252 offset:36928
v_max3_u32 v92, v92, v130, v131
v_mfma_f32_16x16x32_bf16 v[24:27], a[232:235], v[120:123], v[24:27]
ds_read_b64_tr_b16 v[46:47], v252 offset:37696
v_max_u32 v92, v92, v93
v_mfma_f32_16x16x32_bf16 v[28:31], a[236:239], v[120:123], v[28:31]
ds_read_b64_tr_b16 v[48:49], v249 offset:36992
s_waitcnt lgkmcnt(3)
v_mfma_f32_16x16x32_bf16 v[32:35], v[56:59], v[120:123], v[32:35]
ds_read_b64_tr_b16 v[50:51], v249 offset:37760
v_cmp_eq_u32 vcc, -1, v92
v_mfma_f32_16x16x32_bf16 v[36:39], v[60:63], v[120:123], v[36:39]
ds_read_b64_tr_b16 v[52:53], v252 offset:36992
v_lshlrev_b32 v70, 16, v81
v_mfma_f32_16x16x32_bf16 v[40:43], v[64:67], v[120:123], v[40:43]
ds_read_b64_tr_b16 v[54:55], v252 offset:37760
s_cbranch_vccnz L_o3_retry
L_o3_ok:
v_mfma_f32_16x16x32_bf16 v[20:23], a[240:243], v[124:127], v[20:23]
ds_read_b64_tr_b16 v[56:57], v252 offset:43072
buffer_load_dwordx4 v[156:159], v7, s[4:7], s59 offen offset:2048 sc1
v_mfma_f32_16x16x32_bf16 v[24:27], a[244:247], v[124:127], v[24:27]
ds_read_b64_tr_b16 v[58:59], v252 offset:43840
buffer_load_dwordx4 v[160:163], v7, s[4:7], s59 offen offset:3072 sc1
v_mfma_f32_16x16x32_bf16 v[28:31], a[248:251], v[124:127], v[28:31]
ds_read_b64_tr_b16 v[60:61], v249 offset:43136
s_waitcnt lgkmcnt(3)
v_mfma_f32_16x16x32_bf16 v[32:35], v[44:47], v[124:127], v[32:35]
ds_read_b64_tr_b16 v[62:63], v249 offset:43904
s_waitcnt vmcnt(6)
v_mfma_f32_16x16x32_bf16 v[36:39], v[48:51], v[124:127], v[36:39]
ds_read_b64_tr_b16 v[64:65], v252 offset:43136
v_max3_u32 v92, v132, v133, v134
v_mfma_f32_16x16x32_bf16 v[40:43], v[52:55], v[124:127], v[40:43]
ds_read_b64_tr_b16 v[66:67], v252 offset:43904
v_max3_u32 v93, v135, v136, v137
v_mfma_f32_16x16x32_bf16 v[20:23], a[252:255], v[128:131], v[20:23]
ds_read_b64_tr_b16 v[44:45], v252 offset:49216
v_max3_u32 v92, v92, v138, v139
v_mfma_f32_16x16x32_bf16 v[24:27], a[40:43], v[128:131], v[24:27]
ds_read_b64_tr_b16 v[46:47], v252 offset:49984
v_max_u32 v92, v92, v93
v_mfma_f32_16x16x32_bf16 v[28:31], a[44:47], v[128:131], v[28:31]
ds_read_b64_tr_b16 v[48:49], v249 offset:49280
s_waitcnt lgkmcnt(3)
v_mfma_f32_16x16x32_bf16 v[32:35], v[56:59], v[128:131], v[32:35]
ds_read_b64_tr_b16 v[50:51], v249 offset:50048
v_cmp_eq_u32 vcc, -1, v92
v_mfma_f32_16x16x32_bf16 v[36:39], v[60:63], v[128:131], v[36:39]
ds_read_b64_tr_b16 v[52:53], v252 offset:49280
v_and_b32 v71, 0xffff0000, v81
v_mfma_f32_16x16x32_bf16 v[40:43], v[64:67], v[128:131], v[40:43]
ds_read_b64_tr_b16 v[54:55], v252 offset:50048
s_cbranch_vccnz L_o4_retry
L_o4_ok:
v_mfma_f32_16x16x32_bf16 v[20:23], a[48:51], v[132:135], v[20:23]
ds_read_b64_tr_b16 v[56:57], v252 offset:55360
buffer_load_dwordx4 v[164:167], v7, s[4:7], s60 offen offset:0 sc1
v_mfma_f32_16x16x32_bf16 v[24:27], a[52:55], v[132:135], v[24:27]
ds_read_b64_tr_b16 v[58:59], v252 offset:56128
buffer_load_dwordx4 v[168:171], v7, s[4:7], s60 offen offset:1024 sc1
v_mfma_f32_16x16x32_bf16 v[28:31], a[56:59], v[132:135], v[28:31]
ds_read_b64_tr_b16 v[60:61], v249 offset:55424
s_waitcnt lgkmcnt(3)
v_mfma_f32_16x16x32_bf16 v[32:35], v[44:47], v[132:135], v[32:35]
ds_read_b64_tr_b16 v[62:63], v249 offset:56192
s_waitcnt vmcnt(6)
v_mfma_f32_16x16x32_bf16 v[36:39], v[48:51], v[132:135], v[36:39]
ds_read_b64_tr_b16 v[64:65], v252 offset:55424
v_max3_u32 v92, v140, v141, v142
v_mfma_f32_16x16x32_bf16 v[40:43], v[52:55], v[132:135], v[40:43]
ds_read_b64_tr_b16 v[66:67], v252 offset:56192
v_max3_u32 v93, v143, v144, v145
v_mfma_f32_16x16x32_bf16 v[20:23], a[60:63], v[136:139], v[20:23]
ds_read_b64_tr_b16 v[44:45], v254 offset:64
v_max3_u32 v92, v92, v146, v147
v_mfma_f32_16x16x32_bf16 v[24:27], a[64:67], v[136:139], v[24:27]
ds_read_b64_tr_b16 v[46:47], v254 offset:832
v_max_u32 v92, v92, v93
v_mfma_f32_16x16x32_bf16 v[28:31], a[68:71], v[136:139], v[28:31]
ds_read_b64_tr_b16 v[48:49], v253 offset:128
s_waitcnt lgkmcnt(3)
v_mfma_f32_16x16x32_bf16 v[32:35], v[56:59], v[136:139], v[32:35]
ds_read_b64_tr_b16 v[50:51], v253 offset:896
v_cmp_eq_u32 vcc, -1, v92
v_mfma_f32_16x16x32_bf16 v[36:39], v[60:63], v[136:139], v[36:39]
ds_read_b64_tr_b16 v[52:53], v254 offset:128
v_lshlrev_b32 v72, 16, v82
v_mfma_f32_16x16x32_bf16 v[40:43], v[64:67], v[136:139], v[40:43]
ds_read_b64_tr_b16 v[54:55], v254 offset:896
s_cbranch_vccnz L_o5_retry
L_o5_ok:
v_mfma_f32_16x16x32_bf16 v[20:23], a[72:75], v[140:143], v[20:23]
ds_read_b64_tr_b16 v[56:57], v254 offset:6208
buffer_load_dwordx4 v[172:175], v7, s[4:7], s60 offen offset:2048 sc1
v_mfma_f32_16x16x32_bf16 v[24:27], a[76:79], v[140:143], v[24:27]
ds_read_b64_tr_b16 v[58:59], v254 offset:6976
buffer_load_dwordx4 v[176:179], v7, s[4:7], s60 offen offset:3072 sc1
v_mfma_f32_16x16x32_bf16 v[28:31], a[80:83], v[140:143], v[28:31]
ds_read_b64_tr_b16 v[60:61], v253 offset:6272
s_waitcnt lgkmcnt(3)
v_mfma_f32_16x16x32_bf16 v[32:35], v[44:47], v[140:143], v[32:35]
ds_read_b64_tr_b16 v[62:63], v253 offset:7040
s_waitcnt vmcnt(6)
v_mfma_f32_16x16x32_bf16 v[36:39], v[48:51], v[140:143], v[36:39]
ds_read_b64_tr_b16 v[64:65], v254 offset:6272
v_max3_u32 v92, v148, v149, v150
v_mfma_f32_16x16x32_bf16 v[40:43], v[52:55], v[140:143], v[40:43]
ds_read_b64_tr_b16 v[66:67], v254 offset:7040
v_max3_u32 v93, v151, v152, v153
v_mfma_f32_16x16x32_bf16 v[20:23], a[84:87], v[144:147], v[20:23]
ds_read_b64_tr_b16 v[44:45], v254 offset:12352
v_max3_u32 v92, v92, v154, v155
v_mfma_f32_16x16x32_bf16 v[24:27], a[88:91], v[144:147], v[24:27]
ds_read_b64_tr_b16 v[46:47], v254 offset:13120
v_max_u32 v92, v92, v93
v_mfma_f32_16x16x32_bf16 v[28:31], a[92:95], v[144:147], v[28:31]
ds_read_b64_tr_b16 v[48:49], v253 offset:12416
s_waitcnt lgkmcnt(3)
v_mfma_f32_16x16x32_bf16 v[32:35], v[56:59], v[144:147], v[32:35]
ds_read_b64_tr_b16 v[50:51], v253 offset:13184
v_cmp_eq_u32 vcc, -1, v92
v_mfma_f32_16x16x32_bf16 v[36:39], v[60:63], v[144:147], v[36:39]
ds_read_b64_tr_b16 v[52:53], v254 offset:12416
v_and_b32 v73, 0xffff0000, v82
v_mfma_f32_16x16x32_bf16 v[40:43], v[64:67], v[144:147], v[40:43]
ds_read_b64_tr_b16 v[54:55], v254 offset:13184
s_cbranch_vccnz L_o6_retry
L_o6_ok:
v_mfma_f32_16x16x32_bf16 v[20:23], a[96:99], v[148:151], v[20:23]
ds_read_b64_tr_b16 v[56:57], v254 offset:18496
v_lshlrev_b32 v74, 16, v83
v_mfma_f32_16x16x32_bf16 v[24:27], a[100:103], v[148:151], v[24:27]
ds_read_b64_tr_b16 v[58:59], v254 offset:19264
v_and_b32 v75, 0xffff0000, v83
v_mfma_f32_16x16x32_bf16 v[28:31], a[104:107], v[148:151], v[28:31]
ds_read_b64_tr_b16 v[60:61], v253 offset:18560
s_waitcnt lgkmcnt(3)
v_mfma_f32_16x16x32_bf16 v[32:35], v[44:47], v[148:151], v[32:35]
ds_read_b64_tr_b16 v[62:63], v253 offset:19328
s_waitcnt vmcnt(4)
v_mfma_f32_16x16x32_bf16 v[36:39], v[48:51], v[148:151], v[36:39]
ds_read_b64_tr_b16 v[64:65], v254 offset:18560
v_max3_u32 v92, v156, v157, v158
v_mfma_f32_16x16x32_bf16 v[40:43], v[52:55], v[148:151], v[40:43]
ds_read_b64_tr_b16 v[66:67], v254 offset:19328
v_max3_u32 v93, v159, v160, v161
v_mfma_f32_16x16x32_bf16 v[20:23], a[108:111], v[152:155], v[20:23]
ds_read_b64_tr_b16 v[44:45], v254 offset:24640
v_max3_u32 v92, v92, v162, v163
v_mfma_f32_16x16x32_bf16 v[24:27], a[112:115], v[152:155], v[24:27]
ds_read_b64_tr_b16 v[46:47], v254 offset:25408
v_max_u32 v92, v92, v93
v_mfma_f32_16x16x32_bf16 v[28:31], a[116:119], v[152:155], v[28:31]
ds_read_b64_tr_b16 v[48:49], v253 offset:24704
s_waitcnt lgkmcnt(3)
v_mfma_f32_16x16x32_bf16 v[32:35], v[56:59], v[152:155], v[32:35]
ds_read_b64_tr_b16 v[50:51], v253 offset:25472
v_cmp_eq_u32 vcc, -1, v92
v_mfma_f32_16x16x32_bf16 v[36:39], v[60:63], v[152:155], v[36:39]
ds_read_b64_tr_b16 v[52:53], v254 offset:24704
v_lshlrev_b32 v76, 16, v84
v_mfma_f32_16x16x32_bf16 v[40:43], v[64:67], v[152:155], v[40:43]
ds_read_b64_tr_b16 v[54:55], v254 offset:25472
s_cbranch_vccnz L_o7_retry
L_o7_ok:
v_mfma_f32_16x16x32_bf16 v[20:23], a[120:123], v[156:159], v[20:23]
ds_read_b64_tr_b16 v[56:57], v254 offset:30784
v_and_b32 v77, 0xffff0000, v84
v_mfma_f32_16x16x32_bf16 v[24:27], a[124:127], v[156:159], v[24:27]
ds_read_b64_tr_b16 v[58:59], v254 offset:31552
v_lshlrev_b32 v78, 16, v85
v_mfma_f32_16x16x32_bf16 v[28:31], a[128:131], v[156:159], v[28:31]
ds_read_b64_tr_b16 v[60:61], v253 offset:30848
s_waitcnt lgkmcnt(3)
v_mfma_f32_16x16x32_bf16 v[32:35], v[44:47], v[156:159], v[32:35]
ds_read_b64_tr_b16 v[62:63], v253 offset:31616
s_waitcnt vmcnt(2)
v_mfma_f32_16x16x32_bf16 v[36:39], v[48:51], v[156:159], v[36:39]
ds_read_b64_tr_b16 v[64:65], v254 offset:30848
v_max3_u32 v92, v164, v165, v166
v_mfma_f32_16x16x32_bf16 v[40:43], v[52:55], v[156:159], v[40:43]
ds_read_b64_tr_b16 v[66:67], v254 offset:31616
v_max3_u32 v93, v167, v168, v169
v_mfma_f32_16x16x32_bf16 v[20:23], a[132:135], v[160:163], v[20:23]
ds_read_b64_tr_b16 v[44:45], v254 offset:36928
v_max3_u32 v92, v92, v170, v171
v_mfma_f32_16x16x32_bf16 v[24:27], a[136:139], v[160:163], v[24:27]
ds_read_b64_tr_b16 v[46:47], v254 offset:37696
v_max_u32 v92, v92, v93
v_mfma_f32_16x16x32_bf16 v[28:31], a[140:143], v[160:163], v[28:31]
ds_read_b64_tr_b16 v[48:49], v253 offset:36992
s_waitcnt lgkmcnt(3)
v_mfma_f32_16x16x32_bf16 v[32:35], v[56:59], v[160:163], v[32:35]
ds_read_b64_tr_b16 v[50:51], v253 offset:37760
v_cmp_eq_u32 vcc, -1, v92
v_mfma_f32_16x16x32_bf16 v[36:39], v[60:63], v[160:163], v[36:39]
ds_read_b64_tr_b16 v[52:53], v254 offset:36992
v_and_b32 v79, 0xffff0000, v85
v_mfma_f32_16x16x32_bf16 v[40:43], v[64:67], v[160:163], v[40:43]
ds_read_b64_tr_b16 v[54:55], v254 offset:37760
s_cbranch_vccnz L_o8_retry
L_o8_ok:
v_mfma_f32_16x16x32_bf16 v[20:23], a[144:147], v[164:167], v[20:23]
ds_read_b64_tr_b16 v[56:57], v254 offset:43072
v_lshlrev_b32 v80, 16, v86
v_mfma_f32_16x16x32_bf16 v[24:27], a[148:151], v[164:167], v[24:27]
ds_read_b64_tr_b16 v[58:59], v254 offset:43840
v_and_b32 v81, 0xffff0000, v86
v_mfma_f32_16x16x32_bf16 v[28:31], a[152:155], v[164:167], v[28:31]
ds_read_b64_tr_b16 v[60:61], v253 offset:43136
s_waitcnt lgkmcnt(3)
v_mfma_f32_16x16x32_bf16 v[32:35], v[44:47], v[164:167], v[32:35]
ds_read_b64_tr_b16 v[62:63], v253 offset:43904
s_waitcnt vmcnt(0)
v_mfma_f32_16x16x32_bf16 v[36:39], v[48:51], v[164:167], v[36:39]
ds_read_b64_tr_b16 v[64:65], v254 offset:43136
v_max3_u32 v92, v172, v173, v174
v_mfma_f32_16x16x32_bf16 v[40:43], v[52:55], v[164:167], v[40:43]
ds_read_b64_tr_b16 v[66:67], v254 offset:43904
v_max3_u32 v93, v175, v176, v177
v_mfma_f32_16x16x32_bf16 v[20:23], a[156:159], v[168:171], v[20:23]
ds_read_b64_tr_b16 v[44:45], v254 offset:49216
v_max3_u32 v92, v92, v178, v179
v_mfma_f32_16x16x32_bf16 v[24:27], a[160:163], v[168:171], v[24:27]
ds_read_b64_tr_b16 v[46:47], v254 offset:49984
v_max_u32 v92, v92, v93
v_mfma_f32_16x16x32_bf16 v[28:31], a[164:167], v[168:171], v[28:31]
ds_read_b64_tr_b16 v[48:49], v253 offset:49280
s_waitcnt lgkmcnt(3)
v_mfma_f32_16x16x32_bf16 v[32:35], v[56:59], v[168:171], v[32:35]
ds_read_b64_tr_b16 v[50:51], v253 offset:50048
v_cmp_eq_u32 vcc, -1, v92
v_mfma_f32_16x16x32_bf16 v[36:39], v[60:63], v[168:171], v[36:39]
ds_read_b64_tr_b16 v[52:53], v254 offset:49280
v_lshlrev_b32 v82, 16, v87
v_mfma_f32_16x16x32_bf16 v[40:43], v[64:67], v[168:171], v[40:43]
ds_read_b64_tr_b16 v[54:55], v254 offset:50048
s_cbranch_vccnz L_o9_retry
L_o9_ok:
v_mfma_f32_16x16x32_bf16 v[20:23], a[0:3], v[172:175], v[20:23]
ds_read_b64_tr_b16 v[56:57], v254 offset:55360
v_and_b32 v83, 0xffff0000, v87
v_mfma_f32_16x16x32_bf16 v[24:27], a[4:7], v[172:175], v[24:27]
ds_read_b64_tr_b16 v[58:59], v254 offset:56128
v_lshlrev_b32 v84, 16, v88
v_mfma_f32_16x16x32_bf16 v[28:31], a[8:11], v[172:175], v[28:31]
ds_read_b64_tr_b16 v[60:61], v253 offset:55424
s_waitcnt lgkmcnt(3)
v_mfma_f32_16x16x32_bf16 v[32:35], v[44:47], v[172:175], v[32:35]
ds_read_b64_tr_b16 v[62:63], v253 offset:56192
v_and_b32 v85, 0xffff0000, v88
v_mfma_f32_16x16x32_bf16 v[36:39], v[48:51], v[172:175], v[36:39]
ds_read_b64_tr_b16 v[64:65], v254 offset:55424
v_lshlrev_b32 v86, 16, v89
v_mfma_f32_16x16x32_bf16 v[40:43], v[52:55], v[172:175], v[40:43]
ds_read_b64_tr_b16 v[66:67], v254 offset:56192
v_and_b32 v87, 0xffff0000, v89
v_mfma_f32_16x16x32_bf16 v[20:23], a[12:15], v[176:179], v[20:23]
ds_read_b128 v[180:183], v247 offset:0
v_lshlrev_b32 v88, 16, v90
v_mfma_f32_16x16x32_bf16 v[24:27], a[16:19], v[176:179], v[24:27]
ds_read_b128 v[184:187], v247 offset:64
v_and_b32 v89, 0xffff0000, v90
v_mfma_f32_16x16x32_bf16 v[28:31], a[20:23], v[176:179], v[28:31]
ds_read_b128 v[188:191], v247 offset:128
s_waitcnt lgkmcnt(3)
v_mfma_f32_16x16x32_bf16 v[32:35], v[56:59], v[176:179], v[32:35]
ds_read_b128 v[192:195], v247 offset:192
v_lshlrev_b32 v90, 16, v91
v_mfma_f32_16x16x32_bf16 v[36:39], v[60:63], v[176:179], v[36:39]
ds_read_b128 v[196:199], v247 offset:256
v_and_b32 v91, 0xffff0000, v91
v_mfma_f32_16x16x32_bf16 v[40:43], v[64:67], v[176:179], v[40:43]
ds_read_b128 v[200:203], v247 offset:320
s_lshl_b32 s57, s96, 8
s_add_u32 s57, s57, s14
s_mov_b32 s55, 0xffffff00
s_cmp_eq_u32 s15, 0
s_waitcnt lgkmcnt(4)
v_pk_fma_f32 v[20:21], v[20:21], v[180:181], v[68:69]
v_pk_fma_f32 v[22:23], v[22:23], v[182:183], v[70:71]
v_pk_mul_f32 v[46:47], v[20:21], v[20:21]
v_pk_mul_f32 v[48:49], v[20:21], v[204:205]
v_pk_fma_f32 v[24:25], v[24:25], v[184:185], v[72:73]
v_pk_add_f32 v[44:45], v[20:21], v[22:23]
v_pk_fma_f32 v[46:47], v[22:23], v[22:23], v[46:47]
v_pk_fma_f32 v[48:49], v[22:23], v[206:207], v[48:49]
v_pk_fma_f32 v[26:27], v[26:27], v[186:187], v[74:75]
v_pk_add_f32 v[44:45], v[44:45], v[24:25]
v_pk_fma_f32 v[46:47], v[24:25], v[24:25], v[46:47]
v_pk_fma_f32 v[48:49], v[24:25], v[208:209], v[48:49]
s_waitcnt lgkmcnt(2)
v_pk_fma_f32 v[28:29], v[28:29], v[188:189], v[76:77]
v_pk_add_f32 v[44:45], v[44:45], v[26:27]
v_pk_fma_f32 v[46:47], v[26:27], v[26:27], v[46:47]
v_pk_fma_f32 v[48:49], v[26:27], v[210:211], v[48:49]
v_pk_fma_f32 v[30:31], v[30:31], v[190:191], v[78:79]
v_pk_add_f32 v[44:45], v[44:45], v[28:29]
v_pk_fma_f32 v[46:47], v[28:29], v[28:29], v[46:47]
v_pk_fma_f32 v[48:49], v[28:29], v[212:213], v[48:49]
v_pk_fma_f32 v[32:33], v[32:33], v[192:193], v[80:81]
v_pk_add_f32 v[44:45], v[44:45], v[30:31]
v_pk_fma_f32 v[46:47], v[30:31], v[30:31], v[46:47]
v_pk_fma_f32 v[48:49], v[30:31], v[214:215], v[48:49]
v_pk_fma_f32 v[34:35], v[34:35], v[194:195], v[82:83]
v_pk_add_f32 v[44:45], v[44:45], v[32:33]
v_pk_fma_f32 v[46:47], v[32:33], v[32:33], v[46:47]
v_pk_fma_f32 v[48:49], v[32:33], v[216:217], v[48:49]
s_waitcnt lgkmcnt(0)
v_pk_fma_f32 v[36:37], v[36:37], v[196:197], v[84:85]
v_pk_add_f32 v[44:45], v[44:45], v[34:35]
v_pk_fma_f32 v[46:47], v[34:35], v[34:35], v[46:47]
v_pk_fma_f32 v[48:49], v[34:35], v[218:219], v[48:49]
v_pk_fma_f32 v[38:39], v[38:39], v[198:199], v[86:87]
v_pk_add_f32 v[44:45], v[44:45], v[36:37]
v_pk_fma_f32 v[46:47], v[36:37], v[36:37], v[46:47]
v_pk_fma_f32 v[48:49], v[36:37], v[220:221], v[48:49]
v_pk_fma_f32 v[40:41], v[40:41], v[200:201], v[88:89]
v_pk_add_f32 v[44:45], v[44:45], v[38:39]
v_pk_fma_f32 v[46:47], v[38:39], v[38:39], v[46:47]
v_pk_fma_f32 v[48:49], v[38:39], v[222:223], v[48:49]
v_pk_fma_f32 v[42:43], v[42:43], v[202:203], v[90:91]
v_pk_add_f32 v[44:45], v[44:45], v[40:41]
v_pk_fma_f32 v[46:47], v[40:41], v[40:41], v[46:47]
v_pk_fma_f32 v[48:49], v[40:41], v[224:225], v[48:49]
v_pk_fma_f32 v[48:49], v[42:43], v[226:227], v[48:49]
v_pk_add_f32 v[44:45], v[44:45], v[42:43]
v_pk_fma_f32 v[46:47], v[42:43], v[42:43], v[46:47]
v_add_f32 v48, v48, v49
v_add_f32 v44, v44, v45
v_add_f32 v46, v46, v47
v_permlane32_swap_b32 v48, v95
s_nop 0
v_permlane32_swap_b32 v44, v46
v_add_f32 v48, v48, v95
v_add_f32 v44, v44, v46
s_nop 1
v_permlane16_swap_b32 v44, v48
v_add_f32 v44, v44, v48
v_and_or_b32 v44, v44, s55, v19
s_cbranch_scc0 L_st_slow
buffer_store_dword v44, v0, s[4:7], s57 offen
L_st_j:
ds_read_b128 v[100:103], v247 offset:768
ds_read_b128 v[104:107], v247 offset:832
ds_read_b128 v[108:111], v247 offset:896
ds_read_b128 v[112:115], v247 offset:960
ds_read_b128 v[116:119], v247 offset:1024
ds_read_b128 v[120:123], v247 offset:1088
ds_read_b128 v[124:127], v247 offset:384
ds_read_b128 v[128:131], v247 offset:448
ds_read_b128 v[132:135], v247 offset:512
ds_read_b128 v[136:139], v247 offset:576
ds_read_b128 v[140:143], v247 offset:640
ds_read_b128 v[144:147], v247 offset:704
ds_read_b128 v[148:151], v247 offset:1152
ds_read_b128 v[152:155], v247 offset:1216
ds_read_b128 v[156:159], v247 offset:1280
ds_read_b128 v[160:163], v247 offset:1344
ds_read_b128 v[164:167], v247 offset:1408
ds_read_b128 v[168:171], v247 offset:1472
s_lshl_b32 s57, s3, 2
s_add_u32 s57, s57, 135168
v_mov_b32 v54, s57
v_and_b32 v55, 12, v0
v_add_u32 v55, 135168, v55
L_st_p:
buffer_load_dword v180, v0, s[4:7], s14 offen offset:0 sc1
buffer_load_dword v181, v0, s[4:7], s14 offen offset:256 sc1
buffer_load_dword v182, v0, s[4:7], s14 offen offset:512 sc1
buffer_load_dword v183, v0, s[4:7], s14 offen offset:768 sc1
buffer_load_dword v184, v0, s[4:7], s14 offen offset:1024 sc1
buffer_load_dword v185, v0, s[4:7], s14 offen offset:1280 sc1
buffer_load_dword v186, v0, s[4:7], s14 offen offset:1536 sc1
s_waitcnt vmcnt(0)
v_xor_b32 v44, v180, v19
v_xor_b32 v45, v181, v19
v_xor_b32 v46, v182, v19
v_xor_b32 v47, v183, v19
v_xor_b32 v48, v184, v19
v_xor_b32 v49, v185, v19
v_xor_b32 v50, v186, v19
v_or3_b32 v52, v44, v45, v46
v_or3_b32 v53, v47, v48, v49
v_or3_b32 v52, v52, v53, v50
v_and_b32 v52, 0xff, v52
v_cmp_ne_u32 vcc, 0, v52
s_cbranch_vccz L_st_ok
s_add_u32 s97, s97, 1
s_cmp_le_u32 s97, 65536
s_cbranch_scc1 L_st_p
L_st_ok:
v_pk_add_f32 v[44:45], v[44:45], v[46:47]
v_add_f32 v48, v48, v50
v_pk_add_f32 v[44:45], v[44:45], v[48:49]
v_add_f32 v46, v44, v45
v_add_f32 v44, v44, v45
s_nop 1
v_permlane32_swap_b32 v44, v46
v_mov_b32 v45, v44
v_mov_b32 v47, v46
s_nop 0
v_permlane16_swap_b32 v44, v45
v_permlane16_swap_b32 v46, v47
v_mul_f32 v44, 0x3acccccd, v44
v_mul_f32 v46, 0x3acccccd, v46
v_fma_f32 v46, -v44, v44, v46
v_fma_f32 v45, -v44, v47, v45
v_max_f32 v46, 0, v46
v_add_f32 v46, 0x3727c5ac, v46
v_rsq_f32 v48, v46
s_nop 0
v_mul_f32 v45, v45, v48
v_mul_f32 v49, -v44, v48
v_pk_fma_f32 v[68:69], v[20:21], v[48:49], v[48:49] op_sel:[0,0,1] op_sel_hi:[1,0,1]
v_max_f32_dpp v46, v45, v45 row_ror:8 row_mask:0xf bank_mask:0xf
v_pk_fma_f32 v[70:71], v[22:23], v[48:49], v[48:49] op_sel:[0,0,1] op_sel_hi:[1,0,1]
v_pk_fma_f32 v[72:73], v[24:25], v[48:49], v[48:49] op_sel:[0,0,1] op_sel_hi:[1,0,1]
v_max_f32_dpp v46, v46, v46 row_ror:4 row_mask:0xf bank_mask:0xf
v_pk_fma_f32 v[74:75], v[26:27], v[48:49], v[48:49] op_sel:[0,0,1] op_sel_hi:[1,0,1]
v_pk_fma_f32 v[76:77], v[28:29], v[48:49], v[48:49] op_sel:[0,0,1] op_sel_hi:[1,0,1]
v_max_f32_dpp v46, v46, v46 row_ror:2 row_mask:0xf bank_mask:0xf
v_pk_fma_f32 v[78:79], v[30:31], v[48:49], v[48:49] op_sel:[0,0,1] op_sel_hi:[1,0,1]
v_pk_fma_f32 v[80:81], v[32:33], v[48:49], v[48:49] op_sel:[0,0,1] op_sel_hi:[1,0,1]
v_max_f32_dpp v46, v46, v46 row_ror:1 row_mask:0xf bank_mask:0xf
ds_write_b32 v54, v46
v_pk_fma_f32 v[82:83], v[34:35], v[48:49], v[48:49] op_sel:[0,0,1] op_sel_hi:[1,0,1]
v_pk_fma_f32 v[84:85], v[36:37], v[48:49], v[48:49] op_sel:[0,0,1] op_sel_hi:[1,0,1]
v_pk_fma_f32 v[86:87], v[38:39], v[48:49], v[48:49] op_sel:[0,0,1] op_sel_hi:[1,0,1]
v_pk_fma_f32 v[88:89], v[40:41], v[48:49], v[48:49] op_sel:[0,0,1] op_sel_hi:[1,0,1]
v_pk_fma_f32 v[90:91], v[42:43], v[48:49], v[48:49] op_sel:[0,0,1] op_sel_hi:[1,0,1]
s_waitcnt lgkmcnt(0)
s_barrier
ds_read_b32 v52, v55
v_pk_fma_f32 v[68:69], v[68:69], v[100:101], v[124:125]
v_pk_fma_f32 v[70:71], v[70:71], v[102:103], v[126:127]
v_pk_fma_f32 v[72:73], v[72:73], v[104:105], v[128:129]
v_pk_fma_f32 v[74:75], v[74:75], v[106:107], v[130:131]
v_pk_fma_f32 v[76:77], v[76:77], v[108:109], v[132:133]
v_pk_fma_f32 v[78:79], v[78:79], v[110:111], v[134:135]
v_pk_fma_f32 v[80:81], v[80:81], v[112:113], v[136:137]
v_pk_fma_f32 v[82:83], v[82:83], v[114:115], v[138:139]
v_pk_fma_f32 v[84:85], v[84:85], v[116:117], v[140:141]
v_pk_fma_f32 v[86:87], v[86:87], v[118:119], v[142:143]
v_pk_fma_f32 v[88:89], v[88:89], v[120:121], v[144:145]
v_pk_fma_f32 v[90:91], v[90:91], v[122:123], v[146:147]
s_waitcnt lgkmcnt(0)
v_max_f32_dpp v53, v52, v52 quad_perm:[1,0,3,2] row_mask:0xf bank_mask:0xf
s_nop 1
v_max_f32_dpp v53, v53, v53 quad_perm:[2,3,0,1] row_mask:0xf bank_mask:0xf
v_cmp_eq_f32 vcc, v53, v52
v_cmp_eq_f32 s[58:59], v53, v45
s_ff1_i32_b64 s57, vcc
s_and_b32 s57, s57, 3
s_cmp_eq_u32 s57, s3
s_cbranch_scc0 L_nowin
s_ff1_i32_b64 s57, s[58:59]
s_and_b32 s57, s57, 15
s_cmp_eq_u32 s96, 0
s_cbranch_scc0 L_nocand
s_lshl_b32 s58, s57, 1
s_add_u32 s58, s58, s54
v_mov_b32 v56, v53
v_mov_b32 v57, s58
v_mov_b32 v58, s40
v_mov_b32 v59, s53
s_lshl_b32 s58, s47, 7
s_add_u32 s58, s58, 393216
s_mov_b64 exec, 0xff
buffer_store_dwordx4 v[56:59], v7, s[4:7], s58 offen sc1
L_nocand:
s_mov_b32 s58, 0x00010001
s_lshl_b32 exec_lo, s58, s57
s_lshl_b32 exec_hi, s58, s57
s_lshl_b32 s58, s47, 11
s_lshl_b32 s59, s96, 8
s_add_u32 s58, s58, s59
s_lshl_b32 s59, s58, 1
s_add_u32 s58, s58, 458752
s_add_u32 s59, s59, 524288
v_lshlrev_b32 v54, 3, v3
v_lshlrev_b32 v55, 4, v3
v_cvt_pk_bf16_f32 v172, v68, v69
v_cvt_pk_bf16_f32 v173, v70, v71
buffer_store_dwordx2 v[172:173], v54, s[4:7], s58 offen offset:0 sc1
v_cvt_pk_bf16_f32 v174, v72, v73
v_cvt_pk_bf16_f32 v175, v74, v75
buffer_store_dwordx2 v[174:175], v54, s[4:7], s58 offen offset:32 sc1
v_cvt_pk_bf16_f32 v176, v76, v77
v_cvt_pk_bf16_f32 v177, v78, v79
buffer_store_dwordx2 v[176:177], v54, s[4:7], s58 offen offset:64 sc1
v_cvt_pk_bf16_f32 v178, v80, v81
v_cvt_pk_bf16_f32 v179, v82, v83
buffer_store_dwordx2 v[178:179], v54, s[4:7], s58 offen offset:96 sc1
v_cvt_pk_bf16_f32 v172, v84, v85
v_cvt_pk_bf16_f32 v173, v86, v87
buffer_store_dwordx2 v[172:173], v54, s[4:7], s58 offen offset:128 sc1
v_cvt_pk_bf16_f32 v174, v88, v89
v_cvt_pk_bf16_f32 v175, v90, v91
buffer_store_dwordx2 v[174:175], v54, s[4:7], s58 offen offset:160 sc1
s_and_b32 s60, s40, 0xff
s_bfe_u32 s61, s40, 0x80008
s_bfe_u32 s62, s40, 0x80010
s_lshr_b32 s63, s40, 24
v_mov_b32 v60, s55
v_pk_fma_f32 v[100:101], v[68:69], v[148:149], v[20:21]
v_pk_fma_f32 v[102:103], v[70:71], v[150:151], v[22:23]
v_and_or_b32 v100, v100, v60, s60
v_and_or_b32 v101, v101, v60, s61
v_and_or_b32 v102, v102, v60, s62
v_and_or_b32 v103, v103, v60, s63
buffer_store_dwordx4 v[100:103], v55, s[4:7], s59 offen offset:0 sc1
v_pk_fma_f32 v[104:105], v[72:73], v[152:153], v[24:25]
v_pk_fma_f32 v[106:107], v[74:75], v[154:155], v[26:27]
v_and_or_b32 v104, v104, v60, s60
v_and_or_b32 v105, v105, v60, s61
v_and_or_b32 v106, v106, v60, s62
v_and_or_b32 v107, v107, v60, s63
buffer_store_dwordx4 v[104:107], v55, s[4:7], s59 offen offset:64 sc1
v_pk_fma_f32 v[108:109], v[76:77], v[156:157], v[28:29]
v_pk_fma_f32 v[110:111], v[78:79], v[158:159], v[30:31]
v_and_or_b32 v108, v108, v60, s60
v_and_or_b32 v109, v109, v60, s61
v_and_or_b32 v110, v110, v60, s62
v_and_or_b32 v111, v111, v60, s63
buffer_store_dwordx4 v[108:111], v55, s[4:7], s59 offen offset:128 sc1
v_pk_fma_f32 v[112:113], v[80:81], v[160:161], v[32:33]
v_pk_fma_f32 v[114:115], v[82:83], v[162:163], v[34:35]
v_and_or_b32 v112, v112, v60, s60
v_and_or_b32 v113, v113, v60, s61
v_and_or_b32 v114, v114, v60, s62
v_and_or_b32 v115, v115, v60, s63
buffer_store_dwordx4 v[112:115], v55, s[4:7], s59 offen offset:192 sc1
v_pk_fma_f32 v[116:117], v[84:85], v[164:165], v[36:37]
v_pk_fma_f32 v[118:119], v[86:87], v[166:167], v[38:39]
v_and_or_b32 v116, v116, v60, s60
v_and_or_b32 v117, v117, v60, s61
v_and_or_b32 v118, v118, v60, s62
v_and_or_b32 v119, v119, v60, s63
buffer_store_dwordx4 v[116:119], v55, s[4:7], s59 offen offset:256 sc1
v_pk_fma_f32 v[120:121], v[88:89], v[168:169], v[40:41]
v_pk_fma_f32 v[122:123], v[90:91], v[170:171], v[42:43]
v_and_or_b32 v120, v120, v60, s60
v_and_or_b32 v121, v121, v60, s61
v_and_or_b32 v122, v122, v60, s62
v_and_or_b32 v123, v123, v60, s63
buffer_store_dwordx4 v[120:123], v55, s[4:7], s59 offen offset:320 sc1
s_mov_b64 exec, -1
s_mul_i32 s57, s57, 12
v_subrev_u32 v56, s57, v1
v_add_u32 v56, 0, v56
v_cmp_gt_u32 vcc, 12, v56
s_nop 1
v_cndmask_b32 v235, v235, v255, vcc
v_subrev_u32 v56, s57, v1
v_add_u32 v56, 64, v56
v_cmp_gt_u32 vcc, 12, v56
s_nop 1
v_cndmask_b32 v236, v236, v255, vcc
v_subrev_u32 v56, s57, v1
v_add_u32 v56, 128, v56
v_cmp_gt_u32 vcc, 12, v56
s_nop 1
v_cndmask_b32 v237, v237, v255, vcc
L_nowin:
v_pk_fma_f32 v[20:21], v[68:69], v[148:149], v[20:21]
v_pk_fma_f32 v[22:23], v[70:71], v[150:151], v[22:23]
v_cvt_pk_bf16_f32 v20, v20, v21
v_cvt_pk_bf16_f32 v21, v22, v23
ds_write_b64 v248, v[20:21] offset:0
v_pk_fma_f32 v[24:25], v[72:73], v[152:153], v[24:25]
v_pk_fma_f32 v[26:27], v[74:75], v[154:155], v[26:27]
v_cvt_pk_bf16_f32 v24, v24, v25
v_cvt_pk_bf16_f32 v25, v26, v27
ds_write_b64 v248, v[24:25] offset:32
v_pk_fma_f32 v[28:29], v[76:77], v[156:157], v[28:29]
v_pk_fma_f32 v[30:31], v[78:79], v[158:159], v[30:31]
v_cvt_pk_bf16_f32 v28, v28, v29
v_cvt_pk_bf16_f32 v29, v30, v31
ds_write_b64 v248, v[28:29] offset:64
v_pk_fma_f32 v[32:33], v[80:81], v[160:161], v[32:33]
v_pk_fma_f32 v[34:35], v[82:83], v[162:163], v[34:35]
v_cvt_pk_bf16_f32 v32, v32, v33
v_cvt_pk_bf16_f32 v33, v34, v35
ds_write_b64 v248, v[32:33] offset:96
v_pk_fma_f32 v[36:37], v[84:85], v[164:165], v[36:37]
v_pk_fma_f32 v[38:39], v[86:87], v[166:167], v[38:39]
v_cvt_pk_bf16_f32 v36, v36, v37
v_cvt_pk_bf16_f32 v37, v38, v39
ds_write_b64 v248, v[36:37] offset:128
v_pk_fma_f32 v[40:41], v[88:89], v[168:169], v[40:41]
v_pk_fma_f32 v[42:43], v[90:91], v[170:171], v[42:43]
v_cvt_pk_bf16_f32 v40, v40, v41
v_cvt_pk_bf16_f32 v41, v42, v43
ds_write_b64 v248, v[40:41] offset:160
s_waitcnt lgkmcnt(0)
ds_read_b128 v[44:47], v250 offset:0
ds_read_b128 v[48:51], v250 offset:1024
ds_read_b128 v[52:55], v250 offset:2048
s_waitcnt lgkmcnt(2)
buffer_store_dwordx4 v[44:47], v235, s[32:35], s50 offen offset:0 sc1
s_waitcnt lgkmcnt(1)
buffer_store_dwordx4 v[48:51], v236, s[32:35], s50 offen offset:1024 sc1
s_waitcnt lgkmcnt(0)
buffer_store_dwordx4 v[52:55], v237, s[32:35], s50 offen offset:2048 sc1
s_branch L_fin
L_bodyM:
v_bfe_u32 v32, v1, 2, 2
v_lshrrev_b32 v33, 1, v32
v_and_b32 v34, 1, v3
v_lshl_or_b32 v33, v34, 1, v33
v_xor_b32 v33, s3, v33
v_and_b32 v34, 3, v1
v_lshlrev_b32 v34, 3, v34
v_lshl_add_u32 v33, v33, 5, v34
v_lshl_add_u32 v32, v3, 3, v32
v_lshl_add_u32 v35, v32, 7, v33
s_lshl_b32 s22, s50, 8
s_lshl_b32 s23, s3, 6
s_add_u32 s22, s22, s23
s_add_u32 s22, s22, 4096
s_lshl_b32 s55, s3, 9
s_add_u32 s55, s55, 28672
v_add_u32 v39, s55, v39
v_lshl_add_u32 v37, v3, 4, s55
v_lshlrev_b32 v38, 2, v1
s_cmp_lt_u32 s98, 220
s_cselect_b32 s55, 16, 0
v_cmp_gt_u32 vcc, s55, v1
s_mov_b32 s54, 0xffffff00
s_waitcnt vmcnt(12)
v_cndmask_b32 v38, v255, v38, vcc
v_lshlrev_b32 v44, 16, v40
v_and_b32 v45, 0xffff0000, v40
v_lshlrev_b32 v46, 16, v41
v_and_b32 v47, 0xffff0000, v41
v_mul_f32 v48, 0xbfb8aa3b, v44
v_mul_f32 v49, 0xbfb8aa3b, v45
v_mul_f32 v50, 0xbfb8aa3b, v46
v_mul_f32 v51, 0xbfb8aa3b, v47
v_exp_f32 v48, v48
v_exp_f32 v49, v49
v_exp_f32 v50, v50
v_exp_f32 v51, v51
v_add_f32 v48, 1.0, v48
v_add_f32 v49, 1.0, v49
v_add_f32 v50, 1.0, v50
v_add_f32 v51, 1.0, v51
v_rcp_f32 v48, v48
v_rcp_f32 v49, v49
v_rcp_f32 v50, v50
v_rcp_f32 v51, v51
v_mul_f32 v44, v44, v48
v_mul_f32 v45, v45, v49
v_mul_f32 v46, v46, v50
v_mul_f32 v47, v47, v51
v_cvt_pk_bf16_f32 v40, v44, v45
v_cvt_pk_bf16_f32 v41, v46, v47
ds_write_b64 v39, v[40:41]
s_waitcnt lgkmcnt(0)
ds_read_b128 v[200:203], v37 offset:0
ds_read_b128 v[204:207], v37 offset:64
ds_read_b128 v[208:211], v37 offset:128
ds_read_b128 v[212:215], v37 offset:192
ds_read_b128 v[216:219], v37 offset:256
ds_read_b128 v[220:223], v37 offset:320
ds_read_b128 v[224:227], v37 offset:384
s_waitcnt vmcnt(7)
s_mov_b32 s55, 0x3f803f80
v_mov_b32 v20, 0
v_mov_b32 v21, 0
v_dot2c_f32_bf16 v20, s55, v100
v_dot2c_f32_bf16 v21, v100, v100
v_dot2c_f32_bf16 v20, s55, v101
v_dot2c_f32_bf16 v21, v101, v101
v_dot2c_f32_bf16 v20, s55, v102
v_dot2c_f32_bf16 v21, v102, v102
v_dot2c_f32_bf16 v20, s55, v103
v_dot2c_f32_bf16 v21, v103, v103
v_dot2c_f32_bf16 v20, s55, v104
v_dot2c_f32_bf16 v21, v104, v104
v_dot2c_f32_bf16 v20, s55, v105
v_dot2c_f32_bf16 v21, v105, v105
v_dot2c_f32_bf16 v20, s55, v106
v_dot2c_f32_bf16 v21, v106, v106
v_dot2c_f32_bf16 v20, s55, v107
v_dot2c_f32_bf16 v21, v107, v107
v_dot2c_f32_bf16 v20, s55, v108
v_dot2c_f32_bf16 v21, v108, v108
v_dot2c_f32_bf16 v20, s55, v109
v_dot2c_f32_bf16 v21, v109, v109
v_dot2c_f32_bf16 v20, s55, v110
v_dot2c_f32_bf16 v21, v110, v110
v_dot2c_f32_bf16 v20, s55, v111
v_dot2c_f32_bf16 v21, v111, v111
v_dot2c_f32_bf16 v20, s55, v112
v_dot2c_f32_bf16 v21, v112, v112
v_dot2c_f32_bf16 v20, s55, v113
v_dot2c_f32_bf16 v21, v113, v113
v_dot2c_f32_bf16 v20, s55, v114
v_dot2c_f32_bf16 v21, v114, v114
v_dot2c_f32_bf16 v20, s55, v115
v_dot2c_f32_bf16 v21, v115, v115
v_dot2c_f32_bf16 v20, s55, v116
v_dot2c_f32_bf16 v21, v116, v116
v_dot2c_f32_bf16 v20, s55, v117
v_dot2c_f32_bf16 v21, v117, v117
v_dot2c_f32_bf16 v20, s55, v118
v_dot2c_f32_bf16 v21, v118, v118
v_dot2c_f32_bf16 v20, s55, v119
v_dot2c_f32_bf16 v21, v119, v119
v_and_b32 v25, 0xffff0000, v100
v_and_b32 v27, 0xffff0000, v101
v_add_f32_dpp v20, v20, v20 row_ror:8 row_mask:0xf bank_mask:0xf
v_add_f32_dpp v21, v21, v21 row_ror:8 row_mask:0xf bank_mask:0xf
v_lshlrev_b32 v24, 16, v100
v_add_f32_dpp v20, v20, v20 row_ror:4 row_mask:0xf bank_mask:0xf
v_add_f32_dpp v21, v21, v21 row_ror:4 row_mask:0xf bank_mask:0xf
v_lshlrev_b32 v26, 16, v101
v_add_f32_dpp v20, v20, v20 row_ror:2 row_mask:0xf bank_mask:0xf
v_add_f32_dpp v21, v21, v21 row_ror:2 row_mask:0xf bank_mask:0xf
v_lshlrev_b32 v28, 16, v102
v_add_f32_dpp v20, v20, v20 row_ror:1 row_mask:0xf bank_mask:0xf
v_add_f32_dpp v21, v21, v21 row_ror:1 row_mask:0xf bank_mask:0xf
v_mul_f32 v20, 0x3acccccd, v20
v_mul_f32 v21, 0x3acccccd, v21
v_fma_f32 v21, -v20, v20, v21
v_max_f32 v21, 0, v21
v_add_f32 v21, 0x3727c5ac, v21
v_rsq_f32 v22, v21
v_and_b32 v29, 0xffff0000, v102
v_mul_f32 v23, -v20, v22
v_pk_fma_f32 v[24:25], v[24:25], v[22:23], v[22:23] op_sel:[0,0,1] op_sel_hi:[1,0,1]
v_pk_fma_f32 v[26:27], v[26:27], v[22:23], v[22:23] op_sel:[0,0,1] op_sel_hi:[1,0,1]
v_cvt_pk_f16_f32 v100, v24, v25
v_pk_fma_f32 v[28:29], v[28:29], v[22:23], v[22:23] op_sel:[0,0,1] op_sel_hi:[1,0,1]
buffer_load_dwordx4 v[120:123], v4, s[8:11], s61 offen offset:0
v_cvt_pk_f16_f32 v101, v26, v27
v_lshlrev_b32 v30, 16, v103
v_and_b32 v31, 0xffff0000, v103
v_pk_fma_f32 v[30:31], v[30:31], v[22:23], v[22:23] op_sel:[0,0,1] op_sel_hi:[1,0,1]
v_cvt_pk_f16_f32 v102, v28, v29
v_lshlrev_b32 v24, 16, v104
v_and_b32 v25, 0xffff0000, v104
v_pk_fma_f32 v[24:25], v[24:25], v[22:23], v[22:23] op_sel:[0,0,1] op_sel_hi:[1,0,1]
v_cvt_pk_f16_f32 v103, v30, v31
v_lshlrev_b32 v26, 16, v105
v_and_b32 v27, 0xffff0000, v105
v_pk_fma_f32 v[26:27], v[26:27], v[22:23], v[22:23] op_sel:[0,0,1] op_sel_hi:[1,0,1]
v_cvt_pk_f16_f32 v104, v24, v25
v_lshlrev_b32 v28, 16, v106
buffer_load_dwordx4 v[124:127], v4, s[8:11], s61 offen offset:256
v_and_b32 v29, 0xffff0000, v106
v_pk_fma_f32 v[28:29], v[28:29], v[22:23], v[22:23] op_sel:[0,0,1] op_sel_hi:[1,0,1]
v_cvt_pk_f16_f32 v105, v26, v27
v_lshlrev_b32 v30, 16, v107
v_and_b32 v31, 0xffff0000, v107
v_pk_fma_f32 v[30:31], v[30:31], v[22:23], v[22:23] op_sel:[0,0,1] op_sel_hi:[1,0,1]
v_cvt_pk_f16_f32 v106, v28, v29
v_lshlrev_b32 v24, 16, v108
v_and_b32 v25, 0xffff0000, v108
v_pk_fma_f32 v[24:25], v[24:25], v[22:23], v[22:23] op_sel:[0,0,1] op_sel_hi:[1,0,1]
v_cvt_pk_f16_f32 v107, v30, v31
v_lshlrev_b32 v26, 16, v109
v_and_b32 v27, 0xffff0000, v109
v_pk_fma_f32 v[26:27], v[26:27], v[22:23], v[22:23] op_sel:[0,0,1] op_sel_hi:[1,0,1]
buffer_load_dwordx4 v[128:131], v4, s[8:11], s61 offen offset:512
v_cvt_pk_f16_f32 v108, v24, v25
v_lshlrev_b32 v28, 16, v110
v_and_b32 v29, 0xffff0000, v110
v_pk_fma_f32 v[28:29], v[28:29], v[22:23], v[22:23] op_sel:[0,0,1] op_sel_hi:[1,0,1]
v_cvt_pk_f16_f32 v109, v26, v27
v_lshlrev_b32 v30, 16, v111
v_and_b32 v31, 0xffff0000, v111
v_pk_fma_f32 v[30:31], v[30:31], v[22:23], v[22:23] op_sel:[0,0,1] op_sel_hi:[1,0,1]
v_cvt_pk_f16_f32 v110, v28, v29
v_lshlrev_b32 v24, 16, v112
v_and_b32 v25, 0xffff0000, v112
v_pk_fma_f32 v[24:25], v[24:25], v[22:23], v[22:23] op_sel:[0,0,1] op_sel_hi:[1,0,1]
v_cvt_pk_f16_f32 v111, v30, v31
v_lshlrev_b32 v26, 16, v113
buffer_load_dwordx4 v[132:135], v4, s[8:11], s61 offen offset:768
v_and_b32 v27, 0xffff0000, v113
v_pk_fma_f32 v[26:27], v[26:27], v[22:23], v[22:23] op_sel:[0,0,1] op_sel_hi:[1,0,1]
v_cvt_pk_f16_f32 v112, v24, v25
v_lshlrev_b32 v28, 16, v114
v_and_b32 v29, 0xffff0000, v114
v_pk_fma_f32 v[28:29], v[28:29], v[22:23], v[22:23] op_sel:[0,0,1] op_sel_hi:[1,0,1]
v_cvt_pk_f16_f32 v113, v26, v27
v_lshlrev_b32 v30, 16, v115
v_and_b32 v31, 0xffff0000, v115
v_pk_fma_f32 v[30:31], v[30:31], v[22:23], v[22:23] op_sel:[0,0,1] op_sel_hi:[1,0,1]
v_cvt_pk_f16_f32 v114, v28, v29
v_lshlrev_b32 v24, 16, v116
v_and_b32 v25, 0xffff0000, v116
v_pk_fma_f32 v[24:25], v[24:25], v[22:23], v[22:23] op_sel:[0,0,1] op_sel_hi:[1,0,1]
buffer_load_dwordx4 v[136:139], v4, s[8:11], s61 offen offset:1024
s_bfe_u32 s61, s62, 262152
s_mul_i32 s61, s61, 40960
s_add_u32 s61, s61, s45
v_cvt_pk_f16_f32 v115, v30, v31
v_lshlrev_b32 v26, 16, v117
v_and_b32 v27, 0xffff0000, v117
v_pk_fma_f32 v[26:27], v[26:27], v[22:23], v[22:23] op_sel:[0,0,1] op_sel_hi:[1,0,1]
v_cvt_pk_f16_f32 v116, v24, v25
v_lshlrev_b32 v28, 16, v118
v_and_b32 v29, 0xffff0000, v118
v_pk_fma_f32 v[28:29], v[28:29], v[22:23], v[22:23] op_sel:[0,0,1] op_sel_hi:[1,0,1]
v_cvt_pk_f16_f32 v117, v26, v27
v_lshlrev_b32 v30, 16, v119
v_and_b32 v31, 0xffff0000, v119
v_pk_fma_f32 v[30:31], v[30:31], v[22:23], v[22:23] op_sel:[0,0,1] op_sel_hi:[1,0,1]
v_cvt_pk_f16_f32 v118, v28, v29
v_cvt_pk_f16_f32 v119, v30, v31
s_waitcnt vmcnt(5)
v_readfirstlane_b32 s41, v42
s_barrier
ds_read_b64_tr_b16 v[60:61], v35 offset:0
ds_read_b64_tr_b16 v[62:63], v35 offset:512
ds_read_b64_tr_b16 v[64:65], v35 offset:4096
ds_read_b64_tr_b16 v[66:67], v35 offset:4608
ds_read_b64_tr_b16 v[68:69], v35 offset:8192
ds_read_b64_tr_b16 v[70:71], v35 offset:8704
ds_read_b64_tr_b16 v[72:73], v35 offset:12288
ds_read_b64_tr_b16 v[74:75], v35 offset:12800
ds_read_b64_tr_b16 v[76:77], v35 offset:16384
ds_read_b64_tr_b16 v[78:79], v35 offset:16896
ds_read_b64_tr_b16 v[80:81], v35 offset:20480
ds_read_b64_tr_b16 v[82:83], v35 offset:20992
ds_read_b64_tr_b16 v[84:85], v35 offset:24576
ds_read_b64_tr_b16 v[86:87], v35 offset:25088
s_mul_i32 s40, s41, 0x9E3779B1
s_add_u32 s40, s40, 0x85EBCA6B
v_and_b32 v33, 3, v1
v_lshlrev_b32 v33, 3, v33
v_lshrrev_b32 v19, v33, s40
v_and_b32 v19, 0xff, v19
v_mov_b32 v240, s40
v_mov_b32 v241, s19
v_mov_b32 v242, s40
v_mov_b32 v243, s40
s_waitcnt lgkmcnt(12)
v_mfma_f32_16x16x32_bf16 v[56:59], v[200:203], v[60:63], 0
s_waitcnt lgkmcnt(10)
v_mfma_f32_16x16x32_bf16 v[56:59], v[204:207], v[64:67], v[56:59]
s_waitcnt lgkmcnt(8)
v_mfma_f32_16x16x32_bf16 v[56:59], v[208:211], v[68:71], v[56:59]
s_waitcnt lgkmcnt(6)
v_mfma_f32_16x16x32_bf16 v[56:59], v[212:215], v[72:75], v[56:59]
s_waitcnt lgkmcnt(4)
v_mfma_f32_16x16x32_bf16 v[56:59], v[216:219], v[76:79], v[56:59]
s_waitcnt lgkmcnt(2)
v_mfma_f32_16x16x32_bf16 v[56:59], v[220:223], v[80:83], v[56:59]
s_waitcnt lgkmcnt(0)
v_mfma_f32_16x16x32_bf16 v[56:59], v[224:227], v[84:87], v[56:59]
s_nop 7
v_and_or_b32 v56, v56, s54, v19
buffer_store_dword v56, v38, s[4:7], s22 offen sc1
buffer_load_dwordx4 v[140:143], v4, s[8:11], s61 offen offset:0
buffer_load_dwordx4 v[144:147], v4, s[8:11], s61 offen offset:256
buffer_load_dwordx4 v[148:151], v4, s[8:11], s61 offen offset:512
buffer_load_dwordx4 v[152:155], v4, s[8:11], s61 offen offset:768
buffer_load_dwordx4 v[156:159], v4, s[8:11], s61 offen offset:1024
s_bfe_u32 s61, s62, 262156
s_mul_i32 s61, s61, 40960
s_add_u32 s61, s61, s45
s_waitcnt vmcnt(6)
s_mov_b32 s55, 0x3f803f80
buffer_load_dwordx4 v[160:163], v4, s[8:11], s61 offen offset:0
v_mov_b32 v20, 0
v_mov_b32 v21, 0
v_dot2c_f32_bf16 v20, s55, v120
v_dot2c_f32_bf16 v21, v120, v120
v_dot2c_f32_bf16 v20, s55, v121
v_dot2c_f32_bf16 v21, v121, v121
v_dot2c_f32_bf16 v20, s55, v122
v_dot2c_f32_bf16 v21, v122, v122
v_dot2c_f32_bf16 v20, s55, v123
v_dot2c_f32_bf16 v21, v123, v123
v_dot2c_f32_bf16 v20, s55, v124
v_dot2c_f32_bf16 v21, v124, v124
v_dot2c_f32_bf16 v20, s55, v125
v_dot2c_f32_bf16 v21, v125, v125
v_dot2c_f32_bf16 v20, s55, v126
v_dot2c_f32_bf16 v21, v126, v126
v_dot2c_f32_bf16 v20, s55, v127
v_dot2c_f32_bf16 v21, v127, v127
v_dot2c_f32_bf16 v20, s55, v128
v_dot2c_f32_bf16 v21, v128, v128
v_dot2c_f32_bf16 v20, s55, v129
v_dot2c_f32_bf16 v21, v129, v129
v_dot2c_f32_bf16 v20, s55, v130
v_dot2c_f32_bf16 v21, v130, v130
v_dot2c_f32_bf16 v20, s55, v131
v_dot2c_f32_bf16 v21, v131, v131
v_dot2c_f32_bf16 v20, s55, v132
v_dot2c_f32_bf16 v21, v132, v132
buffer_load_dwordx4 v[164:167], v4, s[8:11], s61 offen offset:256
v_dot2c_f32_bf16 v20, s55, v133
v_dot2c_f32_bf16 v21, v133, v133
v_dot2c_f32_bf16 v20, s55, v134
v_dot2c_f32_bf16 v21, v134, v134
v_dot2c_f32_bf16 v20, s55, v135
v_dot2c_f32_bf16 v21, v135, v135
v_dot2c_f32_bf16 v20, s55, v136
v_dot2c_f32_bf16 v21, v136, v136
v_dot2c_f32_bf16 v20, s55, v137
v_dot2c_f32_bf16 v21, v137, v137
v_dot2c_f32_bf16 v20, s55, v138
v_dot2c_f32_bf16 v21, v138, v138
v_dot2c_f32_bf16 v20, s55, v139
v_dot2c_f32_bf16 v21, v139, v139
v_and_b32 v25, 0xffff0000, v120
v_and_b32 v27, 0xffff0000, v121
v_add_f32_dpp v20, v20, v20 row_ror:8 row_mask:0xf bank_mask:0xf
v_add_f32_dpp v21, v21, v21 row_ror:8 row_mask:0xf bank_mask:0xf
v_lshlrev_b32 v24, 16, v120
v_add_f32_dpp v20, v20, v20 row_ror:4 row_mask:0xf bank_mask:0xf
v_add_f32_dpp v21, v21, v21 row_ror:4 row_mask:0xf bank_mask:0xf
v_lshlrev_b32 v26, 16, v121
v_add_f32_dpp v20, v20, v20 row_ror:2 row_mask:0xf bank_mask:0xf
v_add_f32_dpp v21, v21, v21 row_ror:2 row_mask:0xf bank_mask:0xf
v_lshlrev_b32 v28, 16, v122
v_add_f32_dpp v20, v20, v20 row_ror:1 row_mask:0xf bank_mask:0xf
v_add_f32_dpp v21, v21, v21 row_ror:1 row_mask:0xf bank_mask:0xf
buffer_load_dwordx4 v[168:171], v4, s[8:11], s61 offen offset:512
v_mul_f32 v20, 0x3acccccd, v20
v_mul_f32 v21, 0x3acccccd, v21
v_fma_f32 v21, -v20, v20, v21
v_max_f32 v21, 0, v21
v_add_f32 v21, 0x3727c5ac, v21
v_rsq_f32 v22, v21
v_and_b32 v29, 0xffff0000, v122
v_mul_f32 v23, -v20, v22
v_pk_fma_f32 v[24:25], v[24:25], v[22:23], v[22:23] op_sel:[0,0,1] op_sel_hi:[1,0,1]
v_pk_fma_f32 v[26:27], v[26:27], v[22:23], v[22:23] op_sel:[0,0,1] op_sel_hi:[1,0,1]
v_cvt_pk_f16_f32 v120, v24, v25
v_pk_fma_f32 v[28:29], v[28:29], v[22:23], v[22:23] op_sel:[0,0,1] op_sel_hi:[1,0,1]
v_cvt_pk_f16_f32 v121, v26, v27
v_lshlrev_b32 v30, 16, v123
v_and_b32 v31, 0xffff0000, v123
v_pk_fma_f32 v[30:31], v[30:31], v[22:23], v[22:23] op_sel:[0,0,1] op_sel_hi:[1,0,1]
v_cvt_pk_f16_f32 v122, v28, v29
v_lshlrev_b32 v24, 16, v124
v_and_b32 v25, 0xffff0000, v124
v_pk_fma_f32 v[24:25], v[24:25], v[22:23], v[22:23] op_sel:[0,0,1] op_sel_hi:[1,0,1]
v_cvt_pk_f16_f32 v123, v30, v31
v_lshlrev_b32 v26, 16, v125
v_and_b32 v27, 0xffff0000, v125
v_pk_fma_f32 v[26:27], v[26:27], v[22:23], v[22:23] op_sel:[0,0,1] op_sel_hi:[1,0,1]
v_cvt_pk_f16_f32 v124, v24, v25
v_lshlrev_b32 v28, 16, v126
v_and_b32 v29, 0xffff0000, v126
buffer_load_dwordx4 v[172:175], v4, s[8:11], s61 offen offset:768
v_pk_fma_f32 v[28:29], v[28:29], v[22:23], v[22:23] op_sel:[0,0,1] op_sel_hi:[1,0,1]
v_cvt_pk_f16_f32 v125, v26, v27
v_lshlrev_b32 v30, 16, v127
v_and_b32 v31, 0xffff0000, v127
v_pk_fma_f32 v[30:31], v[30:31], v[22:23], v[22:23] op_sel:[0,0,1] op_sel_hi:[1,0,1]
v_cvt_pk_f16_f32 v126, v28, v29
v_lshlrev_b32 v24, 16, v128
v_and_b32 v25, 0xffff0000, v128
v_pk_fma_f32 v[24:25], v[24:25], v[22:23], v[22:23] op_sel:[0,0,1] op_sel_hi:[1,0,1]
v_cvt_pk_f16_f32 v127, v30, v31
v_lshlrev_b32 v26, 16, v129
v_and_b32 v27, 0xffff0000, v129
v_pk_fma_f32 v[26:27], v[26:27], v[22:23], v[22:23] op_sel:[0,0,1] op_sel_hi:[1,0,1]
v_cvt_pk_f16_f32 v128, v24, v25
v_lshlrev_b32 v28, 16, v130
v_and_b32 v29, 0xffff0000, v130
v_pk_fma_f32 v[28:29], v[28:29], v[22:23], v[22:23] op_sel:[0,0,1] op_sel_hi:[1,0,1]
v_cvt_pk_f16_f32 v129, v26, v27
v_lshlrev_b32 v30, 16, v131
v_and_b32 v31, 0xffff0000, v131
v_pk_fma_f32 v[30:31], v[30:31], v[22:23], v[22:23] op_sel:[0,0,1] op_sel_hi:[1,0,1]
v_cvt_pk_f16_f32 v130, v28, v29
v_lshlrev_b32 v24, 16, v132
v_and_b32 v25, 0xffff0000, v132
v_pk_fma_f32 v[24:25], v[24:25], v[22:23], v[22:23] op_sel:[0,0,1] op_sel_hi:[1,0,1]
v_cvt_pk_f16_f32 v131, v30, v31
v_lshlrev_b32 v26, 16, v133
buffer_load_dwordx4 v[176:179], v4, s[8:11], s61 offen offset:1024
s_bfe_u32 s61, s62, 262160
s_mul_i32 s61, s61, 40960
s_add_u32 s61, s61, s45
v_and_b32 v27, 0xffff0000, v133
v_pk_fma_f32 v[26:27], v[26:27], v[22:23], v[22:23] op_sel:[0,0,1] op_sel_hi:[1,0,1]
v_cvt_pk_f16_f32 v132, v24, v25
v_lshlrev_b32 v28, 16, v134
v_and_b32 v29, 0xffff0000, v134
v_pk_fma_f32 v[28:29], v[28:29], v[22:23], v[22:23] op_sel:[0,0,1] op_sel_hi:[1,0,1]
v_cvt_pk_f16_f32 v133, v26, v27
v_lshlrev_b32 v30, 16, v135
v_and_b32 v31, 0xffff0000, v135
v_pk_fma_f32 v[30:31], v[30:31], v[22:23], v[22:23] op_sel:[0,0,1] op_sel_hi:[1,0,1]
v_cvt_pk_f16_f32 v134, v28, v29
v_lshlrev_b32 v24, 16, v136
v_and_b32 v25, 0xffff0000, v136
v_pk_fma_f32 v[24:25], v[24:25], v[22:23], v[22:23] op_sel:[0,0,1] op_sel_hi:[1,0,1]
v_cvt_pk_f16_f32 v135, v30, v31
v_lshlrev_b32 v26, 16, v137
v_and_b32 v27, 0xffff0000, v137
v_pk_fma_f32 v[26:27], v[26:27], v[22:23], v[22:23] op_sel:[0,0,1] op_sel_hi:[1,0,1]
v_cvt_pk_f16_f32 v136, v24, v25
v_lshlrev_b32 v28, 16, v138
v_and_b32 v29, 0xffff0000, v138
v_pk_fma_f32 v[28:29], v[28:29], v[22:23], v[22:23] op_sel:[0,0,1] op_sel_hi:[1,0,1]
v_cvt_pk_f16_f32 v137, v26, v27
v_lshlrev_b32 v30, 16, v139
v_and_b32 v31, 0xffff0000, v139
v_pk_fma_f32 v[30:31], v[30:31], v[22:23], v[22:23] op_sel:[0,0,1] op_sel_hi:[1,0,1]
v_cvt_pk_f16_f32 v138, v28, v29
v_cvt_pk_f16_f32 v139, v30, v31
s_barrier
s_waitcnt vmcnt(5)
s_mov_b32 s55, 0x3f803f80
buffer_load_dwordx4 v[180:183], v4, s[8:11], s61 offen offset:0
v_mov_b32 v20, 0
v_mov_b32 v21, 0
v_dot2c_f32_bf16 v20, s55, v140
v_dot2c_f32_bf16 v21, v140, v140
v_dot2c_f32_bf16 v20, s55, v141
v_dot2c_f32_bf16 v21, v141, v141
v_dot2c_f32_bf16 v20, s55, v142
v_dot2c_f32_bf16 v21, v142, v142
v_dot2c_f32_bf16 v20, s55, v143
v_dot2c_f32_bf16 v21, v143, v143
v_dot2c_f32_bf16 v20, s55, v144
v_dot2c_f32_bf16 v21, v144, v144
v_dot2c_f32_bf16 v20, s55, v145
v_dot2c_f32_bf16 v21, v145, v145
buffer_load_dwordx4 v[184:187], v4, s[8:11], s61 offen offset:256
v_dot2c_f32_bf16 v20, s55, v146
v_dot2c_f32_bf16 v21, v146, v146
v_dot2c_f32_bf16 v20, s55, v147
v_dot2c_f32_bf16 v21, v147, v147
v_dot2c_f32_bf16 v20, s55, v148
v_dot2c_f32_bf16 v21, v148, v148
v_dot2c_f32_bf16 v20, s55, v149
v_dot2c_f32_bf16 v21, v149, v149
v_dot2c_f32_bf16 v20, s55, v150
v_dot2c_f32_bf16 v21, v150, v150
v_dot2c_f32_bf16 v20, s55, v151
v_dot2c_f32_bf16 v21, v151, v151
v_dot2c_f32_bf16 v20, s55, v152
v_dot2c_f32_bf16 v21, v152, v152
buffer_load_dwordx4 v[188:191], v4, s[8:11], s61 offen offset:512
v_dot2c_f32_bf16 v20, s55, v153
v_dot2c_f32_bf16 v21, v153, v153
v_dot2c_f32_bf16 v20, s55, v154
v_dot2c_f32_bf16 v21, v154, v154
v_dot2c_f32_bf16 v20, s55, v155
v_dot2c_f32_bf16 v21, v155, v155
v_dot2c_f32_bf16 v20, s55, v156
v_dot2c_f32_bf16 v21, v156, v156
v_dot2c_f32_bf16 v20, s55, v157
v_dot2c_f32_bf16 v21, v157, v157
v_dot2c_f32_bf16 v20, s55, v158
v_dot2c_f32_bf16 v21, v158, v158
v_dot2c_f32_bf16 v20, s55, v159
buffer_load_dwordx4 v[192:195], v4, s[8:11], s61 offen offset:768
v_dot2c_f32_bf16 v21, v159, v159
v_and_b32 v25, 0xffff0000, v140
v_and_b32 v27, 0xffff0000, v141
v_add_f32_dpp v20, v20, v20 row_ror:8 row_mask:0xf bank_mask:0xf
v_add_f32_dpp v21, v21, v21 row_ror:8 row_mask:0xf bank_mask:0xf
v_lshlrev_b32 v24, 16, v140
v_add_f32_dpp v20, v20, v20 row_ror:4 row_mask:0xf bank_mask:0xf
v_add_f32_dpp v21, v21, v21 row_ror:4 row_mask:0xf bank_mask:0xf
v_lshlrev_b32 v26, 16, v141
v_add_f32_dpp v20, v20, v20 row_ror:2 row_mask:0xf bank_mask:0xf
v_add_f32_dpp v21, v21, v21 row_ror:2 row_mask:0xf bank_mask:0xf
v_lshlrev_b32 v28, 16, v142
v_add_f32_dpp v20, v20, v20 row_ror:1 row_mask:0xf bank_mask:0xf
v_add_f32_dpp v21, v21, v21 row_ror:1 row_mask:0xf bank_mask:0xf
buffer_load_dwordx4 v[196:199], v4, s[8:11], s61 offen offset:1024
v_mul_f32 v20, 0x3acccccd, v20
v_mul_f32 v21, 0x3acccccd, v21
v_fma_f32 v21, -v20, v20, v21
v_max_f32 v21, 0, v21
v_add_f32 v21, 0x3727c5ac, v21
v_rsq_f32 v22, v21
v_and_b32 v29, 0xffff0000, v142
v_mul_f32 v23, -v20, v22
v_pk_fma_f32 v[24:25], v[24:25], v[22:23], v[22:23] op_sel:[0,0,1] op_sel_hi:[1,0,1]
v_pk_fma_f32 v[26:27], v[26:27], v[22:23], v[22:23] op_sel:[0,0,1] op_sel_hi:[1,0,1]
v_cvt_pk_f16_f32 v140, v24, v25
v_pk_fma_f32 v[28:29], v[28:29], v[22:23], v[22:23] op_sel:[0,0,1] op_sel_hi:[1,0,1]
v_cvt_pk_f16_f32 v141, v26, v27
buffer_store_dwordx4 a[232:235], v11, s[4:7], s46 offen sc1
v_lshlrev_b32 v30, 16, v143
v_and_b32 v31, 0xffff0000, v143
v_pk_fma_f32 v[30:31], v[30:31], v[22:23], v[22:23] op_sel:[0,0,1] op_sel_hi:[1,0,1]
v_cvt_pk_f16_f32 v142, v28, v29
v_lshlrev_b32 v24, 16, v144
v_and_b32 v25, 0xffff0000, v144
v_pk_fma_f32 v[24:25], v[24:25], v[22:23], v[22:23] op_sel:[0,0,1] op_sel_hi:[1,0,1]
v_cvt_pk_f16_f32 v143, v30, v31
v_lshlrev_b32 v26, 16, v145
v_and_b32 v27, 0xffff0000, v145
v_pk_fma_f32 v[26:27], v[26:27], v[22:23], v[22:23] op_sel:[0,0,1] op_sel_hi:[1,0,1]
v_cvt_pk_f16_f32 v144, v24, v25
v_lshlrev_b32 v28, 16, v146
v_and_b32 v29, 0xffff0000, v146
buffer_store_dwordx4 a[232:235], v12, s[4:7], s46 offen sc1
v_pk_fma_f32 v[28:29], v[28:29], v[22:23], v[22:23] op_sel:[0,0,1] op_sel_hi:[1,0,1]
v_cvt_pk_f16_f32 v145, v26, v27
v_lshlrev_b32 v30, 16, v147
v_and_b32 v31, 0xffff0000, v147
v_pk_fma_f32 v[30:31], v[30:31], v[22:23], v[22:23] op_sel:[0,0,1] op_sel_hi:[1,0,1]
v_cvt_pk_f16_f32 v146, v28, v29
v_lshlrev_b32 v24, 16, v148
v_and_b32 v25, 0xffff0000, v148
v_pk_fma_f32 v[24:25], v[24:25], v[22:23], v[22:23] op_sel:[0,0,1] op_sel_hi:[1,0,1]
v_cvt_pk_f16_f32 v147, v30, v31
v_lshlrev_b32 v26, 16, v149
v_and_b32 v27, 0xffff0000, v149
v_pk_fma_f32 v[26:27], v[26:27], v[22:23], v[22:23] op_sel:[0,0,1] op_sel_hi:[1,0,1]
v_cvt_pk_f16_f32 v148, v24, v25
buffer_store_dwordx4 a[232:235], v13, s[4:7], s46 offen sc1
v_lshlrev_b32 v28, 16, v150
v_and_b32 v29, 0xffff0000, v150
v_pk_fma_f32 v[28:29], v[28:29], v[22:23], v[22:23] op_sel:[0,0,1] op_sel_hi:[1,0,1]
v_cvt_pk_f16_f32 v149, v26, v27
v_lshlrev_b32 v30, 16, v151
v_and_b32 v31, 0xffff0000, v151
v_pk_fma_f32 v[30:31], v[30:31], v[22:23], v[22:23] op_sel:[0,0,1] op_sel_hi:[1,0,1]
v_cvt_pk_f16_f32 v150, v28, v29
v_lshlrev_b32 v24, 16, v152
v_and_b32 v25, 0xffff0000, v152
v_pk_fma_f32 v[24:25], v[24:25], v[22:23], v[22:23] op_sel:[0,0,1] op_sel_hi:[1,0,1]
v_cvt_pk_f16_f32 v151, v30, v31
v_lshlrev_b32 v26, 16, v153
buffer_store_dwordx4 a[232:235], v14, s[4:7], s46 offen sc1
v_and_b32 v27, 0xffff0000, v153
v_pk_fma_f32 v[26:27], v[26:27], v[22:23], v[22:23] op_sel:[0,0,1] op_sel_hi:[1,0,1]
v_cvt_pk_f16_f32 v152, v24, v25
v_lshlrev_b32 v28, 16, v154
v_and_b32 v29, 0xffff0000, v154
v_pk_fma_f32 v[28:29], v[28:29], v[22:23], v[22:23] op_sel:[0,0,1] op_sel_hi:[1,0,1]
v_cvt_pk_f16_f32 v153, v26, v27
v_lshlrev_b32 v30, 16, v155
v_and_b32 v31, 0xffff0000, v155
v_pk_fma_f32 v[30:31], v[30:31], v[22:23], v[22:23] op_sel:[0,0,1] op_sel_hi:[1,0,1]
v_cvt_pk_f16_f32 v154, v28, v29
v_lshlrev_b32 v24, 16, v156
v_and_b32 v25, 0xffff0000, v156
v_pk_fma_f32 v[24:25], v[24:25], v[22:23], v[22:23] op_sel:[0,0,1] op_sel_hi:[1,0,1]
buffer_store_dwordx4 a[232:235], v246, s[4:7], s18 offen sc1
v_cvt_pk_f16_f32 v155, v30, v31
v_lshlrev_b32 v26, 16, v157
v_and_b32 v27, 0xffff0000, v157
v_pk_fma_f32 v[26:27], v[26:27], v[22:23], v[22:23] op_sel:[0,0,1] op_sel_hi:[1,0,1]
v_cvt_pk_f16_f32 v156, v24, v25
v_lshlrev_b32 v28, 16, v158
v_and_b32 v29, 0xffff0000, v158
v_pk_fma_f32 v[28:29], v[28:29], v[22:23], v[22:23] op_sel:[0,0,1] op_sel_hi:[1,0,1]
v_cvt_pk_f16_f32 v157, v26, v27
v_lshlrev_b32 v30, 16, v159
v_and_b32 v31, 0xffff0000, v159
v_pk_fma_f32 v[30:31], v[30:31], v[22:23], v[22:23] op_sel:[0,0,1] op_sel_hi:[1,0,1]
v_cvt_pk_f16_f32 v158, v28, v29
v_cvt_pk_f16_f32 v159, v30, v31
s_waitcnt vmcnt(10)
s_mov_b32 s55, 0x3f803f80
s_add_u32 m0, s39, 0
s_nop 0
buffer_load_dwordx4 v232, s[24:27], s48 offen offset:0 lds
v_mov_b32 v20, 0
v_mov_b32 v21, 0
v_dot2c_f32_bf16 v20, s55, v160
v_dot2c_f32_bf16 v21, v160, v160
v_dot2c_f32_bf16 v20, s55, v161
v_dot2c_f32_bf16 v21, v161, v161
v_dot2c_f32_bf16 v20, s55, v162
v_dot2c_f32_bf16 v21, v162, v162
v_dot2c_f32_bf16 v20, s55, v163
v_dot2c_f32_bf16 v21, v163, v163
v_dot2c_f32_bf16 v20, s55, v164
v_dot2c_f32_bf16 v21, v164, v164
v_dot2c_f32_bf16 v20, s55, v165
v_dot2c_f32_bf16 v21, v165, v165
v_dot2c_f32_bf16 v20, s55, v166
v_dot2c_f32_bf16 v21, v166, v166
v_dot2c_f32_bf16 v20, s55, v167
v_dot2c_f32_bf16 v21, v167, v167
v_dot2c_f32_bf16 v20, s55, v168
v_dot2c_f32_bf16 v21, v168, v168
v_dot2c_f32_bf16 v20, s55, v169
v_dot2c_f32_bf16 v21, v169, v169
v_dot2c_f32_bf16 v20, s55, v170
buffer_load_dwordx4 v233, s[24:27], s48 offen offset:1024 lds
v_dot2c_f32_bf16 v21, v170, v170
v_dot2c_f32_bf16 v20, s55, v171
v_dot2c_f32_bf16 v21, v171, v171
v_dot2c_f32_bf16 v20, s55, v172
v_dot2c_f32_bf16 v21, v172, v172
v_dot2c_f32_bf16 v20, s55, v173
v_dot2c_f32_bf16 v21, v173, v173
v_dot2c_f32_bf16 v20, s55, v174
v_dot2c_f32_bf16 v21, v174, v174
v_dot2c_f32_bf16 v20, s55, v175
v_dot2c_f32_bf16 v21, v175, v175
v_dot2c_f32_bf16 v20, s55, v176
v_dot2c_f32_bf16 v21, v176, v176
v_dot2c_f32_bf16 v20, s55, v177
v_dot2c_f32_bf16 v21, v177, v177
v_dot2c_f32_bf16 v20, s55, v178
v_dot2c_f32_bf16 v21, v178, v178
v_dot2c_f32_bf16 v20, s55, v179
v_dot2c_f32_bf16 v21, v179, v179
v_and_b32 v25, 0xffff0000, v160
v_and_b32 v27, 0xffff0000, v161
v_add_f32_dpp v20, v20, v20 row_ror:8 row_mask:0xf bank_mask:0xf
v_add_f32_dpp v21, v21, v21 row_ror:8 row_mask:0xf bank_mask:0xf
buffer_load_dwordx4 v234, s[24:27], s48 offen offset:2048 lds
s_add_u32 s48, s48, 81920
v_lshlrev_b32 v24, 16, v160
v_add_f32_dpp v20, v20, v20 row_ror:4 row_mask:0xf bank_mask:0xf
v_add_f32_dpp v21, v21, v21 row_ror:4 row_mask:0xf bank_mask:0xf
v_lshlrev_b32 v26, 16, v161
v_add_f32_dpp v20, v20, v20 row_ror:2 row_mask:0xf bank_mask:0xf
v_add_f32_dpp v21, v21, v21 row_ror:2 row_mask:0xf bank_mask:0xf
v_lshlrev_b32 v28, 16, v162
v_add_f32_dpp v20, v20, v20 row_ror:1 row_mask:0xf bank_mask:0xf
v_add_f32_dpp v21, v21, v21 row_ror:1 row_mask:0xf bank_mask:0xf
v_mul_f32 v20, 0x3acccccd, v20
v_mul_f32 v21, 0x3acccccd, v21
v_fma_f32 v21, -v20, v20, v21
v_max_f32 v21, 0, v21
v_add_f32 v21, 0x3727c5ac, v21
v_rsq_f32 v22, v21
v_and_b32 v29, 0xffff0000, v162
v_mul_f32 v23, -v20, v22
v_pk_fma_f32 v[24:25], v[24:25], v[22:23], v[22:23] op_sel:[0,0,1] op_sel_hi:[1,0,1]
v_pk_fma_f32 v[26:27], v[26:27], v[22:23], v[22:23] op_sel:[0,0,1] op_sel_hi:[1,0,1]
v_cvt_pk_f16_f32 v160, v24, v25
v_pk_fma_f32 v[28:29], v[28:29], v[22:23], v[22:23] op_sel:[0,0,1] op_sel_hi:[1,0,1]
v_cvt_pk_f16_f32 v161, v26, v27
s_add_u32 m0, s39, 12288
s_nop 0
buffer_load_dwordx4 v232, s[24:27], s48 offen offset:0 lds
v_lshlrev_b32 v30, 16, v163
v_and_b32 v31, 0xffff0000, v163
v_pk_fma_f32 v[30:31], v[30:31], v[22:23], v[22:23] op_sel:[0,0,1] op_sel_hi:[1,0,1]
v_cvt_pk_f16_f32 v162, v28, v29
v_lshlrev_b32 v24, 16, v164
v_and_b32 v25, 0xffff0000, v164
v_pk_fma_f32 v[24:25], v[24:25], v[22:23], v[22:23] op_sel:[0,0,1] op_sel_hi:[1,0,1]
v_cvt_pk_f16_f32 v163, v30, v31
v_lshlrev_b32 v26, 16, v165
v_and_b32 v27, 0xffff0000, v165
v_pk_fma_f32 v[26:27], v[26:27], v[22:23], v[22:23] op_sel:[0,0,1] op_sel_hi:[1,0,1]
v_cvt_pk_f16_f32 v164, v24, v25
v_lshlrev_b32 v28, 16, v166
v_and_b32 v29, 0xffff0000, v166
v_pk_fma_f32 v[28:29], v[28:29], v[22:23], v[22:23] op_sel:[0,0,1] op_sel_hi:[1,0,1]
v_cvt_pk_f16_f32 v165, v26, v27
v_lshlrev_b32 v30, 16, v167
v_and_b32 v31, 0xffff0000, v167
v_pk_fma_f32 v[30:31], v[30:31], v[22:23], v[22:23] op_sel:[0,0,1] op_sel_hi:[1,0,1]
v_cvt_pk_f16_f32 v166, v28, v29
v_lshlrev_b32 v24, 16, v168
v_and_b32 v25, 0xffff0000, v168
v_pk_fma_f32 v[24:25], v[24:25], v[22:23], v[22:23] op_sel:[0,0,1] op_sel_hi:[1,0,1]
buffer_load_dwordx4 v233, s[24:27], s48 offen offset:1024 lds
v_cvt_pk_f16_f32 v167, v30, v31
v_lshlrev_b32 v26, 16, v169
v_and_b32 v27, 0xffff0000, v169
v_pk_fma_f32 v[26:27], v[26:27], v[22:23], v[22:23] op_sel:[0,0,1] op_sel_hi:[1,0,1]
v_cvt_pk_f16_f32 v168, v24, v25
v_lshlrev_b32 v28, 16, v170
v_and_b32 v29, 0xffff0000, v170
v_pk_fma_f32 v[28:29], v[28:29], v[22:23], v[22:23] op_sel:[0,0,1] op_sel_hi:[1,0,1]
v_cvt_pk_f16_f32 v169, v26, v27
v_lshlrev_b32 v30, 16, v171
v_and_b32 v31, 0xffff0000, v171
v_pk_fma_f32 v[30:31], v[30:31], v[22:23], v[22:23] op_sel:[0,0,1] op_sel_hi:[1,0,1]
v_cvt_pk_f16_f32 v170, v28, v29
v_lshlrev_b32 v24, 16, v172
v_and_b32 v25, 0xffff0000, v172
v_pk_fma_f32 v[24:25], v[24:25], v[22:23], v[22:23] op_sel:[0,0,1] op_sel_hi:[1,0,1]
v_cvt_pk_f16_f32 v171, v30, v31
v_lshlrev_b32 v26, 16, v173
v_and_b32 v27, 0xffff0000, v173
v_pk_fma_f32 v[26:27], v[26:27], v[22:23], v[22:23] op_sel:[0,0,1] op_sel_hi:[1,0,1]
v_cvt_pk_f16_f32 v172, v24, v25
v_lshlrev_b32 v28, 16, v174
v_and_b32 v29, 0xffff0000, v174
buffer_load_dwordx4 v234, s[24:27], s48 offen offset:2048 lds
s_add_u32 s48, s48, 81920
v_pk_fma_f32 v[28:29], v[28:29], v[22:23], v[22:23] op_sel:[0,0,1] op_sel_hi:[1,0,1]
v_cvt_pk_f16_f32 v173, v26, v27
v_lshlrev_b32 v30, 16, v175
v_and_b32 v31, 0xffff0000, v175
v_pk_fma_f32 v[30:31], v[30:31], v[22:23], v[22:23] op_sel:[0,0,1] op_sel_hi:[1,0,1]
v_cvt_pk_f16_f32 v174, v28, v29
v_lshlrev_b32 v24, 16, v176
v_and_b32 v25, 0xffff0000, v176
v_pk_fma_f32 v[24:25], v[24:25], v[22:23], v[22:23] op_sel:[0,0,1] op_sel_hi:[1,0,1]
v_cvt_pk_f16_f32 v175, v30, v31
v_lshlrev_b32 v26, 16, v177
v_and_b32 v27, 0xffff0000, v177
v_pk_fma_f32 v[26:27], v[26:27], v[22:23], v[22:23] op_sel:[0,0,1] op_sel_hi:[1,0,1]
v_cvt_pk_f16_f32 v176, v24, v25
v_lshlrev_b32 v28, 16, v178
v_and_b32 v29, 0xffff0000, v178
v_pk_fma_f32 v[28:29], v[28:29], v[22:23], v[22:23] op_sel:[0,0,1] op_sel_hi:[1,0,1]
v_cvt_pk_f16_f32 v177, v26, v27
v_lshlrev_b32 v30, 16, v179
v_and_b32 v31, 0xffff0000, v179
v_pk_fma_f32 v[30:31], v[30:31], v[22:23], v[22:23] op_sel:[0,0,1] op_sel_hi:[1,0,1]
v_cvt_pk_f16_f32 v178, v28, v29
v_cvt_pk_f16_f32 v179, v30, v31
buffer_load_dwordx4 v[40:43], v248, s[4:7], s56 offen sc1
s_waitcnt vmcnt(12)
s_mov_b32 s55, 0x3f803f80
v_mov_b32 v20, 0
v_mov_b32 v21, 0
v_dot2c_f32_bf16 v20, s55, v180
v_dot2c_f32_bf16 v21, v180, v180
v_dot2c_f32_bf16 v20, s55, v181
v_dot2c_f32_bf16 v21, v181, v181
v_dot2c_f32_bf16 v20, s55, v182
v_dot2c_f32_bf16 v21, v182, v182
buffer_load_dwordx4 v[44:47], v248, s[4:7], s57 offen sc1
v_dot2c_f32_bf16 v20, s55, v183
v_dot2c_f32_bf16 v21, v183, v183
v_dot2c_f32_bf16 v20, s55, v184
v_dot2c_f32_bf16 v21, v184, v184
v_dot2c_f32_bf16 v20, s55, v185
v_dot2c_f32_bf16 v21, v185, v185
v_dot2c_f32_bf16 v20, s55, v186
v_dot2c_f32_bf16 v21, v186, v186
v_dot2c_f32_bf16 v20, s55, v187
v_dot2c_f32_bf16 v21, v187, v187
v_dot2c_f32_bf16 v20, s55, v188
buffer_load_dwordx4 v[48:51], v248, s[4:7], s58 offen sc1
v_dot2c_f32_bf16 v21, v188, v188
v_dot2c_f32_bf16 v20, s55, v189
v_dot2c_f32_bf16 v21, v189, v189
v_dot2c_f32_bf16 v20, s55, v190
v_dot2c_f32_bf16 v21, v190, v190
v_dot2c_f32_bf16 v20, s55, v191
v_dot2c_f32_bf16 v21, v191, v191
v_dot2c_f32_bf16 v20, s55, v192
v_dot2c_f32_bf16 v21, v192, v192
v_dot2c_f32_bf16 v20, s55, v193
v_dot2c_f32_bf16 v21, v193, v193
buffer_load_dword v52, v249, s[4:7], s56 offen sc1
v_dot2c_f32_bf16 v20, s55, v194
v_dot2c_f32_bf16 v21, v194, v194
v_dot2c_f32_bf16 v20, s55, v195
v_dot2c_f32_bf16 v21, v195, v195
v_dot2c_f32_bf16 v20, s55, v196
v_dot2c_f32_bf16 v21, v196, v196
v_dot2c_f32_bf16 v20, s55, v197
v_dot2c_f32_bf16 v21, v197, v197
v_dot2c_f32_bf16 v20, s55, v198
v_dot2c_f32_bf16 v21, v198, v198
buffer_load_dword v53, v249, s[4:7], s57 offen sc1
v_dot2c_f32_bf16 v20, s55, v199
v_dot2c_f32_bf16 v21, v199, v199
v_and_b32 v25, 0xffff0000, v180
v_and_b32 v27, 0xffff0000, v181
v_add_f32_dpp v20, v20, v20 row_ror:8 row_mask:0xf bank_mask:0xf
v_add_f32_dpp v21, v21, v21 row_ror:8 row_mask:0xf bank_mask:0xf
v_lshlrev_b32 v24, 16, v180
v_add_f32_dpp v20, v20, v20 row_ror:4 row_mask:0xf bank_mask:0xf
v_add_f32_dpp v21, v21, v21 row_ror:4 row_mask:0xf bank_mask:0xf
v_lshlrev_b32 v26, 16, v181
v_add_f32_dpp v20, v20, v20 row_ror:2 row_mask:0xf bank_mask:0xf
buffer_load_dword v54, v249, s[4:7], s58 offen sc1
v_add_f32_dpp v21, v21, v21 row_ror:2 row_mask:0xf bank_mask:0xf
v_lshlrev_b32 v28, 16, v182
v_add_f32_dpp v20, v20, v20 row_ror:1 row_mask:0xf bank_mask:0xf
v_add_f32_dpp v21, v21, v21 row_ror:1 row_mask:0xf bank_mask:0xf
v_mul_f32 v20, 0x3acccccd, v20
v_mul_f32 v21, 0x3acccccd, v21
v_fma_f32 v21, -v20, v20, v21
v_max_f32 v21, 0, v21
v_add_f32 v21, 0x3727c5ac, v21
v_rsq_f32 v22, v21
v_and_b32 v29, 0xffff0000, v182
buffer_load_dword v71, v247, s[4:7], s60 offen sc1
v_mul_f32 v23, -v20, v22
v_pk_fma_f32 v[24:25], v[24:25], v[22:23], v[22:23] op_sel:[0,0,1] op_sel_hi:[1,0,1]
v_pk_fma_f32 v[26:27], v[26:27], v[22:23], v[22:23] op_sel:[0,0,1] op_sel_hi:[1,0,1]
v_cvt_pk_f16_f32 v180, v24, v25
v_pk_fma_f32 v[28:29], v[28:29], v[22:23], v[22:23] op_sel:[0,0,1] op_sel_hi:[1,0,1]
v_cvt_pk_f16_f32 v181, v26, v27
v_lshlrev_b32 v30, 16, v183
v_and_b32 v31, 0xffff0000, v183
v_pk_fma_f32 v[30:31], v[30:31], v[22:23], v[22:23] op_sel:[0,0,1] op_sel_hi:[1,0,1]
v_cvt_pk_f16_f32 v182, v28, v29
s_add_u32 m0, s39, 24576
s_nop 0
buffer_load_dwordx4 v232, s[24:27], s48 offen offset:0 lds
v_lshlrev_b32 v24, 16, v184
v_and_b32 v25, 0xffff0000, v184
v_pk_fma_f32 v[24:25], v[24:25], v[22:23], v[22:23] op_sel:[0,0,1] op_sel_hi:[1,0,1]
v_cvt_pk_f16_f32 v183, v30, v31
v_lshlrev_b32 v26, 16, v185
v_and_b32 v27, 0xffff0000, v185
v_pk_fma_f32 v[26:27], v[26:27], v[22:23], v[22:23] op_sel:[0,0,1] op_sel_hi:[1,0,1]
v_cvt_pk_f16_f32 v184, v24, v25
v_lshlrev_b32 v28, 16, v186
v_and_b32 v29, 0xffff0000, v186
v_pk_fma_f32 v[28:29], v[28:29], v[22:23], v[22:23] op_sel:[0,0,1] op_sel_hi:[1,0,1]
buffer_load_dwordx4 v233, s[24:27], s48 offen offset:1024 lds
v_cvt_pk_f16_f32 v185, v26, v27
v_lshlrev_b32 v30, 16, v187
v_and_b32 v31, 0xffff0000, v187
v_pk_fma_f32 v[30:31], v[30:31], v[22:23], v[22:23] op_sel:[0,0,1] op_sel_hi:[1,0,1]
v_cvt_pk_f16_f32 v186, v28, v29
v_lshlrev_b32 v24, 16, v188
v_and_b32 v25, 0xffff0000, v188
v_pk_fma_f32 v[24:25], v[24:25], v[22:23], v[22:23] op_sel:[0,0,1] op_sel_hi:[1,0,1]
v_cvt_pk_f16_f32 v187, v30, v31
v_lshlrev_b32 v26, 16, v189
v_and_b32 v27, 0xffff0000, v189
buffer_load_dwordx4 v234, s[24:27], s48 offen offset:2048 lds
s_add_u32 s48, s48, 81920
v_pk_fma_f32 v[26:27], v[26:27], v[22:23], v[22:23] op_sel:[0,0,1] op_sel_hi:[1,0,1]
v_cvt_pk_f16_f32 v188, v24, v25
v_lshlrev_b32 v28, 16, v190
v_and_b32 v29, 0xffff0000, v190
v_pk_fma_f32 v[28:29], v[28:29], v[22:23], v[22:23] op_sel:[0,0,1] op_sel_hi:[1,0,1]
v_cvt_pk_f16_f32 v189, v26, v27
v_lshlrev_b32 v30, 16, v191
v_and_b32 v31, 0xffff0000, v191
v_pk_fma_f32 v[30:31], v[30:31], v[22:23], v[22:23] op_sel:[0,0,1] op_sel_hi:[1,0,1]
v_cvt_pk_f16_f32 v190, v28, v29
s_add_u32 m0, s39, 36864
s_nop 0
buffer_load_dwordx4 v232, s[24:27], s48 offen offset:0 lds
v_lshlrev_b32 v24, 16, v192
v_and_b32 v25, 0xffff0000, v192
v_pk_fma_f32 v[24:25], v[24:25], v[22:23], v[22:23] op_sel:[0,0,1] op_sel_hi:[1,0,1]
v_cvt_pk_f16_f32 v191, v30, v31
v_lshlrev_b32 v26, 16, v193
v_and_b32 v27, 0xffff0000, v193
v_pk_fma_f32 v[26:27], v[26:27], v[22:23], v[22:23] op_sel:[0,0,1] op_sel_hi:[1,0,1]
v_cvt_pk_f16_f32 v192, v24, v25
v_lshlrev_b32 v28, 16, v194
v_and_b32 v29, 0xffff0000, v194
v_pk_fma_f32 v[28:29], v[28:29], v[22:23], v[22:23] op_sel:[0,0,1] op_sel_hi:[1,0,1]
buffer_load_dwordx4 v233, s[24:27], s48 offen offset:1024 lds
v_cvt_pk_f16_f32 v193, v26, v27
v_lshlrev_b32 v30, 16, v195
v_and_b32 v31, 0xffff0000, v195
v_pk_fma_f32 v[30:31], v[30:31], v[22:23], v[22:23] op_sel:[0,0,1] op_sel_hi:[1,0,1]
v_cvt_pk_f16_f32 v194, v28, v29
v_lshlrev_b32 v24, 16, v196
v_and_b32 v25, 0xffff0000, v196
v_pk_fma_f32 v[24:25], v[24:25], v[22:23], v[22:23] op_sel:[0,0,1] op_sel_hi:[1,0,1]
v_cvt_pk_f16_f32 v195, v30, v31
v_lshlrev_b32 v26, 16, v197
v_and_b32 v27, 0xffff0000, v197
buffer_load_dwordx4 v234, s[24:27], s48 offen offset:2048 lds
s_add_u32 s48, s48, 81920
v_pk_fma_f32 v[26:27], v[26:27], v[22:23], v[22:23] op_sel:[0,0,1] op_sel_hi:[1,0,1]
v_cvt_pk_f16_f32 v196, v24, v25
v_lshlrev_b32 v28, 16, v198
v_and_b32 v29, 0xffff0000, v198
v_pk_fma_f32 v[28:29], v[28:29], v[22:23], v[22:23] op_sel:[0,0,1] op_sel_hi:[1,0,1]
v_cvt_pk_f16_f32 v197, v26, v27
v_lshlrev_b32 v30, 16, v199
v_and_b32 v31, 0xffff0000, v199
v_pk_fma_f32 v[30:31], v[30:31], v[22:23], v[22:23] op_sel:[0,0,1] op_sel_hi:[1,0,1]
v_cvt_pk_f16_f32 v198, v28, v29
v_cvt_pk_f16_f32 v199, v30, v31
s_branch L_bodyj
L_ga_retry:
buffer_load_dwordx4 v[40:43], v248, s[4:7], s56 offen sc1
buffer_load_dwordx4 v[44:47], v248, s[4:7], s57 offen sc1
buffer_load_dwordx4 v[48:51], v248, s[4:7], s58 offen sc1
buffer_load_dword v52, v249, s[4:7], s56 offen sc1
buffer_load_dword v53, v249, s[4:7], s57 offen sc1
buffer_load_dword v54, v249, s[4:7], s58 offen sc1
s_waitcnt vmcnt(0)
v_xor_b32 v40, s12, v40
v_xor_b32 v41, s13, v41
v_xor_b32 v42, s14, v42
v_xor_b32 v43, s15, v43
v_xor_b32 v44, s12, v44
v_xor_b32 v45, s13, v45
v_xor_b32 v46, s14, v46
v_xor_b32 v47, s15, v47
v_xor_b32 v48, s12, v48
v_xor_b32 v49, s13, v49
v_xor_b32 v50, s14, v50
v_xor_b32 v51, s15, v51
v_xor_b32 v52, v19, v52
v_xor_b32 v53, v19, v53
v_xor_b32 v54, v19, v54
v_or3_b32 v64, v40, v41, v42
v_or3_b32 v65, v43, v44, v45
v_or3_b32 v64, v64, v46, v47
v_or3_b32 v65, v65, v48, v49
v_or3_b32 v64, v64, v50, v51
v_or3_b32 v65, v65, v52, v53
v_or3_b32 v64, v64, v65, v54
v_and_b32 v64, 0xff, v64
v_cmp_ne_u32 vcc, 0, v64
s_add_u32 s97, s97, 1
s_cmp_gt_u32 s97, 65536
s_cbranch_scc1 L_ga_ok
s_cbranch_vccnz L_ga_retry
s_branch L_ga_ok
L_fg_retry:
buffer_load_dword v71, v247, s[4:7], s60 offen sc1
s_waitcnt vmcnt(0)
v_cmp_ne_u32 vcc, s40, v71
s_add_u32 s97, s97, 1
s_cmp_gt_u32 s97, 65536
s_cbranch_scc1 L_fg_ok
s_cbranch_vccnz L_fg_retry
s_branch L_fg_ok
L_mv_retry:
buffer_load_dwordx2 v[194:195], v231, s[4:7], s23 offen sc1
buffer_load_dwordx4 v[240:243], v238, s[4:7], s51 offen sc1
buffer_load_dwordx4 v[190:193], v238, s[4:7], s22 offen sc1
s_waitcnt vmcnt(0)
v_perm_b32 v36, v241, v240, s55
v_perm_b32 v37, v243, v242, s55
v_xor_b32 v36, s40, v36
v_xor_b32 v37, s40, v37
v_or_b32 v38, v36, v37
v_perm_b32 v36, v191, v190, s55
v_perm_b32 v37, v193, v192, s55
v_xor_b32 v36, s40, v36
v_xor_b32 v37, s40, v37
v_or3_b32 v38, v38, v36, v37
v_and_b32 v38, v38, v230
v_xor_b32 v37, s40, v194
v_or_b32 v38, v38, v37
v_cmp_ne_u32 vcc, 0, v38
s_add_u32 s97, s97, 1
s_cmp_gt_u32 s97, 65536
s_cbranch_scc1 L_mv_ok
s_cbranch_vccnz L_mv_retry
s_branch L_mv_ok
L_o0_retry:
buffer_load_dwordx4 v[100:103], v7, s[4:7], s56 offen offset:0 sc1
buffer_load_dwordx4 v[104:107], v7, s[4:7], s56 offen offset:1024 sc1
buffer_load_dwordx4 v[108:111], v7, s[4:7], s56 offen offset:2048 sc1
buffer_load_dwordx4 v[112:115], v7, s[4:7], s56 offen offset:3072 sc1
buffer_load_dwordx4 v[116:119], v7, s[4:7], s57 offen offset:0 sc1
buffer_load_dwordx4 v[120:123], v7, s[4:7], s57 offen offset:1024 sc1
buffer_load_dwordx4 v[124:127], v7, s[4:7], s57 offen offset:2048 sc1
buffer_load_dwordx4 v[128:131], v7, s[4:7], s57 offen offset:3072 sc1
s_waitcnt vmcnt(6)
v_max3_u32 v92, v100, v101, v102
v_max3_u32 v93, v103, v104, v105
v_max3_u32 v92, v92, v106, v107
v_max_u32 v92, v92, v93
v_cmp_eq_u32 vcc, -1, v92
s_add_u32 s97, s97, 1
s_cmp_gt_u32 s97, 65536
s_cbranch_scc1 L_o0_ok
s_cbranch_vccnz L_o0_retry
s_branch L_o0_ok
L_o1_retry:
buffer_load_dwordx4 v[108:111], v7, s[4:7], s56 offen offset:2048 sc1
buffer_load_dwordx4 v[112:115], v7, s[4:7], s56 offen offset:3072 sc1
buffer_load_dwordx4 v[116:119], v7, s[4:7], s57 offen offset:0 sc1
buffer_load_dwordx4 v[120:123], v7, s[4:7], s57 offen offset:1024 sc1
buffer_load_dwordx4 v[124:127], v7, s[4:7], s57 offen offset:2048 sc1
buffer_load_dwordx4 v[128:131], v7, s[4:7], s57 offen offset:3072 sc1
buffer_load_dwordx4 v[132:135], v7, s[4:7], s58 offen offset:0 sc1
buffer_load_dwordx4 v[136:139], v7, s[4:7], s58 offen offset:1024 sc1
s_waitcnt vmcnt(6)
v_max3_u32 v92, v108, v109, v110
v_max3_u32 v93, v111, v112, v113
v_max3_u32 v92, v92, v114, v115
v_max_u32 v92, v92, v93
v_cmp_eq_u32 vcc, -1, v92
s_add_u32 s97, s97, 1
s_cmp_gt_u32 s97, 65536
s_cbranch_scc1 L_o1_ok
s_cbranch_vccnz L_o1_retry
s_branch L_o1_ok
L_o2_retry:
buffer_load_dwordx4 v[116:119], v7, s[4:7], s57 offen offset:0 sc1
buffer_load_dwordx4 v[120:123], v7, s[4:7], s57 offen offset:1024 sc1
buffer_load_dwordx4 v[124:127], v7, s[4:7], s57 offen offset:2048 sc1
buffer_load_dwordx4 v[128:131], v7, s[4:7], s57 offen offset:3072 sc1
buffer_load_dwordx4 v[132:135], v7, s[4:7], s58 offen offset:0 sc1
buffer_load_dwordx4 v[136:139], v7, s[4:7], s58 offen offset:1024 sc1
buffer_load_dwordx4 v[140:143], v7, s[4:7], s58 offen offset:2048 sc1
buffer_load_dwordx4 v[144:147], v7, s[4:7], s58 offen offset:3072 sc1
s_waitcnt vmcnt(6)
v_max3_u32 v92, v116, v117, v118
v_max3_u32 v93, v119, v120, v121
v_max3_u32 v92, v92, v122, v123
v_max_u32 v92, v92, v93
v_cmp_eq_u32 vcc, -1, v92
s_add_u32 s97, s97, 1
s_cmp_gt_u32 s97, 65536
s_cbranch_scc1 L_o2_ok
s_cbranch_vccnz L_o2_retry
s_branch L_o2_ok
L_o3_retry:
buffer_load_dwordx4 v[124:127], v7, s[4:7], s57 offen offset:2048 sc1
buffer_load_dwordx4 v[128:131], v7, s[4:7], s57 offen offset:3072 sc1
buffer_load_dwordx4 v[132:135], v7, s[4:7], s58 offen offset:0 sc1
buffer_load_dwordx4 v[136:139], v7, s[4:7], s58 offen offset:1024 sc1
buffer_load_dwordx4 v[140:143], v7, s[4:7], s58 offen offset:2048 sc1
buffer_load_dwordx4 v[144:147], v7, s[4:7], s58 offen offset:3072 sc1
buffer_load_dwordx4 v[148:151], v7, s[4:7], s59 offen offset:0 sc1
buffer_load_dwordx4 v[152:155], v7, s[4:7], s59 offen offset:1024 sc1
s_waitcnt vmcnt(6)
v_max3_u32 v92, v124, v125, v126
v_max3_u32 v93, v127, v128, v129
v_max3_u32 v92, v92, v130, v131
v_max_u32 v92, v92, v93
v_cmp_eq_u32 vcc, -1, v92
s_add_u32 s97, s97, 1
s_cmp_gt_u32 s97, 65536
s_cbranch_scc1 L_o3_ok
s_cbranch_vccnz L_o3_retry
s_branch L_o3_ok
L_o4_retry:
buffer_load_dwordx4 v[132:135], v7, s[4:7], s58 offen offset:0 sc1
buffer_load_dwordx4 v[136:139], v7, s[4:7], s58 offen offset:1024 sc1
buffer_load_dwordx4 v[140:143], v7, s[4:7], s58 offen offset:2048 sc1
buffer_load_dwordx4 v[144:147], v7, s[4:7], s58 offen offset:3072 sc1
buffer_load_dwordx4 v[148:151], v7, s[4:7], s59 offen offset:0 sc1
buffer_load_dwordx4 v[152:155], v7, s[4:7], s59 offen offset:1024 sc1
buffer_load_dwordx4 v[156:159], v7, s[4:7], s59 offen offset:2048 sc1
buffer_load_dwordx4 v[160:163], v7, s[4:7], s59 offen offset:3072 sc1
s_waitcnt vmcnt(6)
v_max3_u32 v92, v132, v133, v134
v_max3_u32 v93, v135, v136, v137
v_max3_u32 v92, v92, v138, v139
v_max_u32 v92, v92, v93
v_cmp_eq_u32 vcc, -1, v92
s_add_u32 s97, s97, 1
s_cmp_gt_u32 s97, 65536
s_cbranch_scc1 L_o4_ok
s_cbranch_vccnz L_o4_retry
s_branch L_o4_ok
L_o5_retry:
buffer_load_dwordx4 v[140:143], v7, s[4:7], s58 offen offset:2048 sc1
buffer_load_dwordx4 v[144:147], v7, s[4:7], s58 offen offset:3072 sc1
buffer_load_dwordx4 v[148:151], v7, s[4:7], s59 offen offset:0 sc1
buffer_load_dwordx4 v[152:155], v7, s[4:7], s59 offen offset:1024 sc1
buffer_load_dwordx4 v[156:159], v7, s[4:7], s59 offen offset:2048 sc1
buffer_load_dwordx4 v[160:163], v7, s[4:7], s59 offen offset:3072 sc1
buffer_load_dwordx4 v[164:167], v7, s[4:7], s60 offen offset:0 sc1
buffer_load_dwordx4 v[168:171], v7, s[4:7], s60 offen offset:1024 sc1
s_waitcnt vmcnt(6)
v_max3_u32 v92, v140, v141, v142
v_max3_u32 v93, v143, v144, v145
v_max3_u32 v92, v92, v146, v147
v_max_u32 v92, v92, v93
v_cmp_eq_u32 vcc, -1, v92
s_add_u32 s97, s97, 1
s_cmp_gt_u32 s97, 65536
s_cbranch_scc1 L_o5_ok
s_cbranch_vccnz L_o5_retry
s_branch L_o5_ok
L_o6_retry:
buffer_load_dwordx4 v[148:151], v7, s[4:7], s59 offen offset:0 sc1
buffer_load_dwordx4 v[152:155], v7, s[4:7], s59 offen offset:1024 sc1
buffer_load_dwordx4 v[156:159], v7, s[4:7], s59 offen offset:2048 sc1
buffer_load_dwordx4 v[160:163], v7, s[4:7], s59 offen offset:3072 sc1
buffer_load_dwordx4 v[164:167], v7, s[4:7], s60 offen offset:0 sc1
buffer_load_dwordx4 v[168:171], v7, s[4:7], s60 offen offset:1024 sc1
buffer_load_dwordx4 v[172:175], v7, s[4:7], s60 offen offset:2048 sc1
buffer_load_dwordx4 v[176:179], v7, s[4:7], s60 offen offset:3072 sc1
s_waitcnt vmcnt(6)
v_max3_u32 v92, v148, v149, v150
v_max3_u32 v93, v151, v152, v153
v_max3_u32 v92, v92, v154, v155
v_max_u32 v92, v92, v93
v_cmp_eq_u32 vcc, -1, v92
s_add_u32 s97, s97, 1
s_cmp_gt_u32 s97, 65536
s_cbranch_scc1 L_o6_ok
s_cbranch_vccnz L_o6_retry
s_branch L_o6_ok
L_o7_retry:
buffer_load_dwordx4 v[156:159], v7, s[4:7], s59 offen offset:2048 sc1
buffer_load_dwordx4 v[160:163], v7, s[4:7], s59 offen offset:3072 sc1
buffer_load_dwordx4 v[164:167], v7, s[4:7], s60 offen offset:0 sc1
buffer_load_dwordx4 v[168:171], v7, s[4:7], s60 offen offset:1024 sc1
buffer_load_dwordx4 v[172:175], v7, s[4:7], s60 offen offset:2048 sc1
buffer_load_dwordx4 v[176:179], v7, s[4:7], s60 offen offset:3072 sc1
s_waitcnt vmcnt(4)
v_max3_u32 v92, v156, v157, v158
v_max3_u32 v93, v159, v160, v161
v_max3_u32 v92, v92, v162, v163
v_max_u32 v92, v92, v93
v_cmp_eq_u32 vcc, -1, v92
s_add_u32 s97, s97, 1
s_cmp_gt_u32 s97, 65536
s_cbranch_scc1 L_o7_ok
s_cbranch_vccnz L_o7_retry
s_branch L_o7_ok
L_o8_retry:
buffer_load_dwordx4 v[164:167], v7, s[4:7], s60 offen offset:0 sc1
buffer_load_dwordx4 v[168:171], v7, s[4:7], s60 offen offset:1024 sc1
buffer_load_dwordx4 v[172:175], v7, s[4:7], s60 offen offset:2048 sc1
buffer_load_dwordx4 v[176:179], v7, s[4:7], s60 offen offset:3072 sc1
s_waitcnt vmcnt(2)
v_max3_u32 v92, v164, v165, v166
v_max3_u32 v93, v167, v168, v169
v_max3_u32 v92, v92, v170, v171
v_max_u32 v92, v92, v93
v_cmp_eq_u32 vcc, -1, v92
s_add_u32 s97, s97, 1
s_cmp_gt_u32 s97, 65536
s_cbranch_scc1 L_o8_ok
s_cbranch_vccnz L_o8_retry
s_branch L_o8_ok
L_o9_retry:
buffer_load_dwordx4 v[172:175], v7, s[4:7], s60 offen offset:2048 sc1
buffer_load_dwordx4 v[176:179], v7, s[4:7], s60 offen offset:3072 sc1
s_waitcnt vmcnt(0)
v_max3_u32 v92, v172, v173, v174
v_max3_u32 v93, v175, v176, v177
v_max3_u32 v92, v92, v178, v179
v_max_u32 v92, v92, v93
v_cmp_eq_u32 vcc, -1, v92
s_add_u32 s97, s97, 1
s_cmp_gt_u32 s97, 65536
s_cbranch_scc1 L_o9_ok
s_cbranch_vccnz L_o9_retry
s_branch L_o9_ok
L_st_slow:
buffer_store_dword v44, v0, s[4:7], s57 offen sc1
s_branch L_st_j
L_svc:
s_sub_u32 s44, s2, 224
v_lshlrev_b32 v28, 3, v0
s_waitcnt lgkmcnt(0)
s_mov_b32 s16, s22
s_mov_b32 s17, s23
s_mov_b32 s22, 1280
s_mov_b32 s23, 0x20000
buffer_load_dwordx2 v[40:41], v28, s[20:23], 0 offen
buffer_load_dword v42, v29, s[4:7], 0 offen sc1
s_load_dwordx2 s[8:9], s[0:1], 40
s_load_dwordx2 s[12:13], s[0:1], 48
s_load_dwordx2 s[36:37], s[0:1], 56
s_load_dwordx2 s[24:25], s[0:1], 16
s_load_dwordx2 s[28:29], s[0:1], 32
s_load_dwordx2 s[32:33], s[0:1], 80
s_mov_b32 s18, 4915200
s_mov_b32 s19, 0x20000
s_mov_b32 s26, 819200
s_mov_b32 s27, 0x20000
s_mov_b32 s30, 1280
s_mov_b32 s31, 0x20000
s_mov_b32 s34, 2621440
s_mov_b32 s35, 0x20000
s_mov_b32 s10, 2211840
s_mov_b32 s11, 0x20000
s_mov_b32 s14, 2211840
s_mov_b32 s15, 0x20000
s_mov_b32 s38, 2211840
s_mov_b32 s39, 0x20000
v_bfe_u32 v32, v1, 2, 2
v_lshrrev_b32 v33, 1, v32
v_and_b32 v34, 1, v3
v_lshl_or_b32 v33, v34, 1, v33
v_xor_b32 v33, s3, v33
v_and_b32 v34, 3, v1
v_lshlrev_b32 v34, 3, v34
v_lshl_add_u32 v33, v33, 5, v34
v_lshl_add_u32 v32, v3, 3, v32
v_lshl_add_u32 v6, v32, 7, v33
s_mov_b32 s97, 0
s_mov_b32 s98, 0x0c0c0400
s_mov_b32 s99, 0x04000c0c
v_add_u32 v7, 40960, v6
v_add_u32 v9, 81920, v6
v_add_u32 v10, 81920+40960, v6
s_mul_i32 s55, s3, 320
s_add_u32 s55, s55, 81920
v_mul_u32_u24 v32, 1280, v32
v_add3_u32 v11, v32, v34, s55
s_and_b32 s55, s3, 1
s_lshl_b32 s55, s55, 2
v_and_b32 v30, 1, v3
v_lshl_or_b32 v30, v30, 1, s55
v_and_b32 v31, 7, v1
v_xor_b32 v31, v30, v31
v_lshlrev_b32 v31, 4, v31
v_lshrrev_b32 v30, 3, v1
v_mad_u32_u24 v4, v30, 60, 0
v_lshl_add_u32 v4, v4, 7, v31
v_mad_u32_u24 v5, v30, 27, 0
v_lshl_add_u32 v5, v5, 7, v31
v_lshlrev_b32 v8, 4, v1
v_lshlrev_b32 v12, 2, v1
v_mov_b32 v255, 1073741824
s_waitcnt lgkmcnt(0)
s_cmp_ge_u32 s44, 27
s_cbranch_scc1 L_fz
s_lshl_b32 s55, s44, 2
s_add_u32 s55, s55, s3
s_mul_i32 s55, s55, 7680
v_lshlrev_b32 v33, 7, v1
s_mov_b32 exec_hi, 0xfffffff
buffer_load_dword v184, v33, s[24:27], s55 offen
s_mov_b32 exec_hi, -1
s_lshl_b32 s50, s44, 7
s_mul_i32 s55, s3, 61440
s_add_u32 s50, s50, s55
s_add_u32 s50, s50, 2560
s_add_u32 m0, s49, 0
s_nop 0
buffer_load_dwordx4 v4, s[16:19], s50 offen nt lds
s_add_u32 m0, m0, 4096
s_add_u32 s50, s50, 245760
buffer_load_dwordx4 v4, s[16:19], s50 offen nt lds
s_add_u32 m0, m0, 4096
s_add_u32 s50, s50, 245760
buffer_load_dwordx4 v4, s[16:19], s50 offen nt lds
s_add_u32 m0, m0, 4096
s_add_u32 s50, s50, 245760
buffer_load_dwordx4 v4, s[16:19], s50 offen nt lds
s_add_u32 m0, m0, 4096
s_add_u32 s50, s50, 245760
buffer_load_dwordx4 v4, s[16:19], s50 offen nt lds
s_add_u32 m0, m0, 4096
s_add_u32 s50, s50, 245760
buffer_load_dwordx4 v4, s[16:19], s50 offen nt lds
s_add_u32 m0, m0, 4096
s_add_u32 s50, s50, 245760
buffer_load_dwordx4 v4, s[16:19], s50 offen nt lds
s_add_u32 m0, m0, 4096
s_add_u32 s50, s50, 245760
buffer_load_dwordx4 v4, s[16:19], s50 offen nt lds
s_add_u32 m0, m0, 4096
s_add_u32 s50, s50, 245760
buffer_load_dwordx4 v4, s[16:19], s50 offen nt lds
s_add_u32 m0, m0, 4096
s_add_u32 s50, s50, 245760
buffer_load_dwordx4 v4, s[16:19], s50 offen nt lds
s_add_u32 m0, m0, 4096
s_add_u32 s50, s50, 245760
buffer_load_dwordx4 v4, s[16:19], s50 offen nt lds
s_add_u32 m0, m0, 4096
s_add_u32 s50, s50, 245760
buffer_load_dwordx4 v4, s[16:19], s50 offen nt lds
s_add_u32 m0, m0, 4096
s_add_u32 s50, s50, 245760
buffer_load_dwordx4 v4, s[16:19], s50 offen nt lds
s_add_u32 m0, m0, 4096
s_add_u32 s50, s50, 245760
buffer_load_dwordx4 v4, s[16:19], s50 offen nt lds
s_add_u32 m0, m0, 4096
s_add_u32 s50, s50, 245760
buffer_load_dwordx4 v4, s[16:19], s50 offen nt lds
s_add_u32 m0, m0, 4096
s_add_u32 s50, s50, 245760
buffer_load_dwordx4 v4, s[16:19], s50 offen nt lds
s_add_u32 m0, m0, 4096
s_add_u32 s50, s50, 245760
buffer_load_dwordx4 v4, s[16:19], s50 offen nt lds
s_add_u32 m0, m0, 4096
s_add_u32 s50, s50, 245760
buffer_load_dwordx4 v4, s[16:19], s50 offen nt lds
s_add_u32 m0, m0, 4096
s_add_u32 s50, s50, 245760
buffer_load_dwordx4 v4, s[16:19], s50 offen nt lds
s_add_u32 m0, m0, 4096
s_add_u32 s50, s50, 245760
buffer_load_dwordx4 v4, s[16:19], s50 offen nt lds
s_waitcnt vmcnt(21)
v_readfirstlane_b32 s41, v42
v_lshlrev_b32 v44, 16, v40
v_and_b32 v45, 0xffff0000, v40
v_lshlrev_b32 v46, 16, v41
v_and_b32 v47, 0xffff0000, v41
v_mul_f32 v48, 0xbfb8aa3b, v44
v_mul_f32 v49, 0xbfb8aa3b, v45
v_mul_f32 v50, 0xbfb8aa3b, v46
v_mul_f32 v51, 0xbfb8aa3b, v47
v_exp_f32 v48, v48
v_exp_f32 v49, v49
v_exp_f32 v50, v50
v_exp_f32 v51, v51
v_add_f32 v48, 1.0, v48
v_add_f32 v49, 1.0, v49
v_add_f32 v50, 1.0, v50
v_add_f32 v51, 1.0, v51
v_rcp_f32 v48, v48
v_rcp_f32 v49, v49
v_rcp_f32 v50, v50
v_rcp_f32 v51, v51
v_mul_f32 v44, v44, v48
v_mul_f32 v45, v45, v49
v_mul_f32 v46, v46, v50
v_mul_f32 v47, v47, v51
v_cvt_pk_bf16_f32 v40, v44, v45
v_cvt_pk_bf16_f32 v41, v46, v47
v_add_u32 v28, 99840, v28
ds_write_b64 v28, v[40:41]
v_lshlrev_b32 v28, 4, v3
v_add_u32 v28, 99840, v28
s_mul_i32 s40, s41, 0x9E3779B1
s_add_u32 s40, s40, 0x85EBCA6B
v_and_b32 v33, 3, v1
v_lshlrev_b32 v33, 3, v33
v_lshrrev_b32 v19, v33, s40
v_and_b32 v19, 0xff, v19
v_mov_b32 v240, s40
v_mov_b32 v241, s19
v_mov_b32 v242, s40
v_mov_b32 v243, s40
v_and_b32 v30, 1, v1
v_lshlrev_b32 v30, 4, v30
v_lshrrev_b32 v13, v30, s40
v_and_b32 v13, 0xffff, v13
s_waitcnt lgkmcnt(0)
s_barrier
ds_read_b128 v[100:103], v28 offset:0
ds_read_b128 v[104:107], v28 offset:64
ds_read_b128 v[108:111], v28 offset:128
ds_read_b128 v[112:115], v28 offset:192
ds_read_b128 v[116:119], v28 offset:256
ds_read_b128 v[120:123], v28 offset:320
ds_read_b128 v[124:127], v28 offset:384
ds_read_b128 v[128:131], v28 offset:448
ds_read_b128 v[132:135], v28 offset:512
ds_read_b128 v[136:139], v28 offset:576
ds_read_b128 v[140:143], v28 offset:640
ds_read_b128 v[144:147], v28 offset:704
ds_read_b128 v[148:151], v28 offset:768
ds_read_b128 v[152:155], v28 offset:832
ds_read_b128 v[156:159], v28 offset:896
ds_read_b128 v[160:163], v28 offset:960
ds_read_b128 v[164:167], v28 offset:1024
ds_read_b128 v[168:171], v28 offset:1088
ds_read_b128 v[172:175], v28 offset:1152
ds_read_b128 v[176:179], v28 offset:1216
s_waitcnt lgkmcnt(0)
s_barrier
s_lshl_b32 s51, s44, 7
s_mul_i32 s55, s3, 27648
s_add_u32 s51, s51, s55
s_mov_b32 s52, s51
s_add_u32 m0, s49, 81920
s_nop 0
buffer_load_dwordx4 v5, s[8:11], s51 offen nt lds
s_add_u32 m0, m0, 4096
s_add_u32 s51, s51, 110592
buffer_load_dwordx4 v5, s[8:11], s51 offen nt lds
s_add_u32 m0, m0, 4096
s_add_u32 s51, s51, 110592
buffer_load_dwordx4 v5, s[8:11], s51 offen nt lds
s_add_u32 m0, m0, 4096
s_add_u32 s51, s51, 110592
buffer_load_dwordx4 v5, s[8:11], s51 offen nt lds
s_add_u32 m0, m0, 4096
s_add_u32 s51, s51, 110592
buffer_load_dwordx4 v5, s[8:11], s51 offen nt lds
s_add_u32 m0, m0, 4096
s_add_u32 s51, s51, 110592
buffer_load_dwordx4 v5, s[8:11], s51 offen nt lds
s_add_u32 m0, m0, 4096
s_add_u32 s51, s51, 110592
buffer_load_dwordx4 v5, s[8:11], s51 offen nt lds
s_add_u32 m0, m0, 4096
s_add_u32 s51, s51, 110592
buffer_load_dwordx4 v5, s[8:11], s51 offen nt lds
s_add_u32 m0, m0, 4096
s_add_u32 s51, s51, 110592
buffer_load_dwordx4 v5, s[8:11], s51 offen nt lds
s_add_u32 m0, m0, 4096
s_add_u32 s51, s51, 110592
buffer_load_dwordx4 v5, s[8:11], s51 offen nt lds
s_add_u32 m0, m0, 4096
s_add_u32 s51, s51, 110592
buffer_load_dwordx4 v5, s[8:11], s51 offen nt lds
s_add_u32 m0, m0, 4096
s_add_u32 s51, s51, 110592
buffer_load_dwordx4 v5, s[8:11], s51 offen nt lds
s_add_u32 m0, m0, 4096
s_add_u32 s51, s51, 110592
buffer_load_dwordx4 v5, s[8:11], s51 offen nt lds
s_add_u32 m0, m0, 4096
s_add_u32 s51, s51, 110592
buffer_load_dwordx4 v5, s[8:11], s51 offen nt lds
s_add_u32 m0, m0, 4096
s_add_u32 s51, s51, 110592
buffer_load_dwordx4 v5, s[8:11], s51 offen nt lds
s_add_u32 m0, m0, 4096
s_add_u32 s51, s51, 110592
buffer_load_dwordx4 v5, s[8:11], s51 offen nt lds
s_add_u32 m0, m0, 4096
s_add_u32 s51, s51, 110592
buffer_load_dwordx4 v5, s[8:11], s51 offen nt lds
s_add_u32 m0, m0, 4096
s_add_u32 s51, s51, 110592
buffer_load_dwordx4 v5, s[8:11], s51 offen nt lds
s_add_u32 m0, m0, 4096
s_add_u32 s51, s51, 110592
buffer_load_dwordx4 v5, s[8:11], s51 offen nt lds
s_add_u32 m0, m0, 4096
s_add_u32 s51, s51, 110592
buffer_load_dwordx4 v5, s[8:11], s51 offen nt lds
s_waitcnt vmcnt(20)
s_barrier
ds_read_b64_tr_b16 v[20:21], v6 offset:0
ds_read_b64_tr_b16 v[22:23], v6 offset:512
ds_read_b64_tr_b16 v[24:25], v6 offset:4096
ds_read_b64_tr_b16 v[26:27], v6 offset:4608
ds_read_b64_tr_b16 v[28:29], v6 offset:8192
ds_read_b64_tr_b16 v[30:31], v6 offset:8704
ds_read_b64_tr_b16 v[32:33], v6 offset:12288
ds_read_b64_tr_b16 v[34:35], v6 offset:12800
ds_read_b64_tr_b16 v[36:37], v6 offset:16384
ds_read_b64_tr_b16 v[38:39], v6 offset:16896
ds_read_b64_tr_b16 v[40:41], v6 offset:20480
ds_read_b64_tr_b16 v[42:43], v6 offset:20992
ds_read_b64_tr_b16 v[44:45], v6 offset:24576
ds_read_b64_tr_b16 v[46:47], v6 offset:25088
ds_read_b64_tr_b16 v[48:49], v6 offset:28672
ds_read_b64_tr_b16 v[50:51], v6 offset:29184
ds_read_b64_tr_b16 v[52:53], v6 offset:32768
ds_read_b64_tr_b16 v[54:55], v6 offset:33280
ds_read_b64_tr_b16 v[56:57], v6 offset:36864
ds_read_b64_tr_b16 v[58:59], v6 offset:37376
ds_read_b64_tr_b16 v[60:61], v7 offset:0
ds_read_b64_tr_b16 v[62:63], v7 offset:512
ds_read_b64_tr_b16 v[64:65], v7 offset:4096
ds_read_b64_tr_b16 v[66:67], v7 offset:4608
ds_read_b64_tr_b16 v[68:69], v7 offset:8192
ds_read_b64_tr_b16 v[70:71], v7 offset:8704
ds_read_b64_tr_b16 v[72:73], v7 offset:12288
ds_read_b64_tr_b16 v[74:75], v7 offset:12800
ds_read_b64_tr_b16 v[76:77], v7 offset:16384
ds_read_b64_tr_b16 v[78:79], v7 offset:16896
ds_read_b64_tr_b16 v[80:81], v7 offset:20480
ds_read_b64_tr_b16 v[82:83], v7 offset:20992
ds_read_b64_tr_b16 v[84:85], v7 offset:24576
ds_read_b64_tr_b16 v[86:87], v7 offset:25088
ds_read_b64_tr_b16 v[88:89], v7 offset:28672
ds_read_b64_tr_b16 v[90:91], v7 offset:29184
ds_read_b64_tr_b16 v[92:93], v7 offset:32768
ds_read_b64_tr_b16 v[94:95], v7 offset:33280
ds_read_b64_tr_b16 v[96:97], v7 offset:36864
ds_read_b64_tr_b16 v[98:99], v7 offset:37376
s_waitcnt lgkmcnt(0)
s_barrier
v_mfma_f32_16x16x32_bf16 v[180:183], v[100:103], v[20:23], 0
v_mfma_f32_16x16x32_bf16 v[180:183], v[104:107], v[24:27], v[180:183]
v_mfma_f32_16x16x32_bf16 v[180:183], v[108:111], v[28:31], v[180:183]
v_mfma_f32_16x16x32_bf16 v[180:183], v[112:115], v[32:35], v[180:183]
v_mfma_f32_16x16x32_bf16 v[180:183], v[116:119], v[36:39], v[180:183]
v_mfma_f32_16x16x32_bf16 v[180:183], v[120:123], v[40:43], v[180:183]
v_mfma_f32_16x16x32_bf16 v[180:183], v[124:127], v[44:47], v[180:183]
v_mfma_f32_16x16x32_bf16 v[180:183], v[128:131], v[48:51], v[180:183]
v_mfma_f32_16x16x32_bf16 v[180:183], v[132:135], v[52:55], v[180:183]
v_mfma_f32_16x16x32_bf16 v[180:183], v[136:139], v[56:59], v[180:183]
v_mfma_f32_16x16x32_bf16 v[180:183], v[140:143], v[60:63], v[180:183]
v_mfma_f32_16x16x32_bf16 v[180:183], v[144:147], v[64:67], v[180:183]
v_mfma_f32_16x16x32_bf16 v[180:183], v[148:151], v[68:71], v[180:183]
v_mfma_f32_16x16x32_bf16 v[180:183], v[152:155], v[72:75], v[180:183]
v_mfma_f32_16x16x32_bf16 v[180:183], v[156:159], v[76:79], v[180:183]
v_mfma_f32_16x16x32_bf16 v[180:183], v[160:163], v[80:83], v[180:183]
v_mfma_f32_16x16x32_bf16 v[180:183], v[164:167], v[84:87], v[180:183]
v_mfma_f32_16x16x32_bf16 v[180:183], v[168:171], v[88:91], v[180:183]
v_mfma_f32_16x16x32_bf16 v[180:183], v[172:175], v[92:95], v[180:183]
v_mfma_f32_16x16x32_bf16 v[180:183], v[176:179], v[96:99], v[180:183]
s_sub_u32 s55, s44, 20
s_cmp_lt_u32 s55, 10
s_cselect_b32 s55, 1.0, 0
s_lshl_b32 s56, s44, 8
s_lshl_b32 s57, s3, 6
s_add_u32 s56, s56, s57
s_add_u32 s56, s56, 65536
s_nop 0
v_cvt_pk_bf16_f32 v180, v180, v180
v_lshlrev_b32 v180, 16, v180
v_add_f32 v180, s55, v180
v_cvt_pk_bf16_f32 v180, v180, v180
v_lshl_or_b32 v180, v180, 16, v13
s_mov_b64 exec, 0xffff
buffer_store_dword v180, v12, s[4:7], s56 offen sc1
s_mov_b64 exec, -1
s_add_u32 m0, s49, 0
s_nop 0
buffer_load_dwordx4 v5, s[12:15], s52 offen nt lds
s_add_u32 m0, m0, 4096
s_add_u32 s52, s52, 110592
buffer_load_dwordx4 v5, s[12:15], s52 offen nt lds
s_add_u32 m0, m0, 4096
s_add_u32 s52, s52, 110592
buffer_load_dwordx4 v5, s[12:15], s52 offen nt lds
s_add_u32 m0, m0, 4096
s_add_u32 s52, s52, 110592
buffer_load_dwordx4 v5, s[12:15], s52 offen nt lds
s_add_u32 m0, m0, 4096
s_add_u32 s52, s52, 110592
buffer_load_dwordx4 v5, s[12:15], s52 offen nt lds
s_add_u32 m0, m0, 4096
s_add_u32 s52, s52, 110592
buffer_load_dwordx4 v5, s[12:15], s52 offen nt lds
s_add_u32 m0, m0, 4096
s_add_u32 s52, s52, 110592
buffer_load_dwordx4 v5, s[12:15], s52 offen nt lds
s_add_u32 m0, m0, 4096
s_add_u32 s52, s52, 110592
buffer_load_dwordx4 v5, s[12:15], s52 offen nt lds
s_add_u32 m0, m0, 4096
s_add_u32 s52, s52, 110592
buffer_load_dwordx4 v5, s[12:15], s52 offen nt lds
s_add_u32 m0, m0, 4096
s_add_u32 s52, s52, 110592
buffer_load_dwordx4 v5, s[12:15], s52 offen nt lds
s_add_u32 m0, m0, 4096
s_add_u32 s52, s52, 110592
buffer_load_dwordx4 v5, s[12:15], s52 offen nt lds
s_add_u32 m0, m0, 4096
s_add_u32 s52, s52, 110592
buffer_load_dwordx4 v5, s[12:15], s52 offen nt lds
s_add_u32 m0, m0, 4096
s_add_u32 s52, s52, 110592
buffer_load_dwordx4 v5, s[12:15], s52 offen nt lds
s_add_u32 m0, m0, 4096
s_add_u32 s52, s52, 110592
buffer_load_dwordx4 v5, s[12:15], s52 offen nt lds
s_add_u32 m0, m0, 4096
s_add_u32 s52, s52, 110592
buffer_load_dwordx4 v5, s[12:15], s52 offen nt lds
s_add_u32 m0, m0, 4096
s_add_u32 s52, s52, 110592
buffer_load_dwordx4 v5, s[12:15], s52 offen nt lds
s_add_u32 m0, m0, 4096
s_add_u32 s52, s52, 110592
buffer_load_dwordx4 v5, s[12:15], s52 offen nt lds
s_add_u32 m0, m0, 4096
s_add_u32 s52, s52, 110592
buffer_load_dwordx4 v5, s[12:15], s52 offen nt lds
s_add_u32 m0, m0, 4096
s_add_u32 s52, s52, 110592
buffer_load_dwordx4 v5, s[12:15], s52 offen nt lds
s_add_u32 m0, m0, 4096
s_add_u32 s52, s52, 110592
buffer_load_dwordx4 v5, s[12:15], s52 offen nt lds
s_waitcnt vmcnt(21)
s_barrier
ds_read_b64_tr_b16 a[0:1], v9 offset:0
ds_read_b64_tr_b16 a[2:3], v9 offset:512
ds_read_b64_tr_b16 a[4:5], v9 offset:4096
ds_read_b64_tr_b16 a[6:7], v9 offset:4608
ds_read_b64_tr_b16 a[8:9], v9 offset:8192
ds_read_b64_tr_b16 a[10:11], v9 offset:8704
ds_read_b64_tr_b16 a[12:13], v9 offset:12288
ds_read_b64_tr_b16 a[14:15], v9 offset:12800
ds_read_b64_tr_b16 a[16:17], v9 offset:16384
ds_read_b64_tr_b16 a[18:19], v9 offset:16896
ds_read_b64_tr_b16 a[20:21], v9 offset:20480
ds_read_b64_tr_b16 a[22:23], v9 offset:20992
ds_read_b64_tr_b16 a[24:25], v9 offset:24576
ds_read_b64_tr_b16 a[26:27], v9 offset:25088
ds_read_b64_tr_b16 a[28:29], v9 offset:28672
ds_read_b64_tr_b16 a[30:31], v9 offset:29184
ds_read_b64_tr_b16 a[32:33], v9 offset:32768
ds_read_b64_tr_b16 a[34:35], v9 offset:33280
ds_read_b64_tr_b16 a[36:37], v9 offset:36864
ds_read_b64_tr_b16 a[38:39], v9 offset:37376
ds_read_b64_tr_b16 a[40:41], v10 offset:0
ds_read_b64_tr_b16 a[42:43], v10 offset:512
ds_read_b64_tr_b16 a[44:45], v10 offset:4096
ds_read_b64_tr_b16 a[46:47], v10 offset:4608
ds_read_b64_tr_b16 a[48:49], v10 offset:8192
ds_read_b64_tr_b16 a[50:51], v10 offset:8704
ds_read_b64_tr_b16 a[52:53], v10 offset:12288
ds_read_b64_tr_b16 a[54:55], v10 offset:12800
ds_read_b64_tr_b16 a[56:57], v10 offset:16384
ds_read_b64_tr_b16 a[58:59], v10 offset:16896
ds_read_b64_tr_b16 a[60:61], v10 offset:20480
ds_read_b64_tr_b16 a[62:63], v10 offset:20992
ds_read_b64_tr_b16 a[64:65], v10 offset:24576
ds_read_b64_tr_b16 a[66:67], v10 offset:25088
ds_read_b64_tr_b16 a[68:69], v10 offset:28672
ds_read_b64_tr_b16 a[70:71], v10 offset:29184
ds_read_b64_tr_b16 a[72:73], v10 offset:32768
ds_read_b64_tr_b16 a[74:75], v10 offset:33280
ds_read_b64_tr_b16 a[76:77], v10 offset:36864
ds_read_b64_tr_b16 a[78:79], v10 offset:37376
s_waitcnt lgkmcnt(0)
s_barrier
s_mul_i32 s51, s44, 81920
s_add_u32 s51, s51, s49
s_add_u32 m0, s49, 81920
s_nop 0
buffer_load_dwordx4 v8, s[36:39], s51 offen nt lds
s_add_u32 m0, m0, 4096
s_add_u32 s51, s51, 4096
buffer_load_dwordx4 v8, s[36:39], s51 offen nt lds
s_add_u32 m0, m0, 4096
s_add_u32 s51, s51, 4096
buffer_load_dwordx4 v8, s[36:39], s51 offen nt lds
s_add_u32 m0, m0, 4096
s_add_u32 s51, s51, 4096
buffer_load_dwordx4 v8, s[36:39], s51 offen nt lds
s_add_u32 m0, m0, 4096
s_add_u32 s51, s51, 4096
buffer_load_dwordx4 v8, s[36:39], s51 offen nt lds
s_add_u32 m0, m0, 4096
s_add_u32 s51, s51, 4096
buffer_load_dwordx4 v8, s[36:39], s51 offen nt lds
s_add_u32 m0, m0, 4096
s_add_u32 s51, s51, 4096
buffer_load_dwordx4 v8, s[36:39], s51 offen nt lds
s_add_u32 m0, m0, 4096
s_add_u32 s51, s51, 4096
buffer_load_dwordx4 v8, s[36:39], s51 offen nt lds
s_add_u32 m0, m0, 4096
s_add_u32 s51, s51, 4096
buffer_load_dwordx4 v8, s[36:39], s51 offen nt lds
s_add_u32 m0, m0, 4096
s_add_u32 s51, s51, 4096
buffer_load_dwordx4 v8, s[36:39], s51 offen nt lds
s_add_u32 m0, m0, 4096
s_add_u32 s51, s51, 4096
buffer_load_dwordx4 v8, s[36:39], s51 offen nt lds
s_add_u32 m0, m0, 4096
s_add_u32 s51, s51, 4096
buffer_load_dwordx4 v8, s[36:39], s51 offen nt lds
s_add_u32 m0, m0, 4096
s_add_u32 s51, s51, 4096
buffer_load_dwordx4 v8, s[36:39], s51 offen nt lds
s_add_u32 m0, m0, 4096
s_add_u32 s51, s51, 4096
buffer_load_dwordx4 v8, s[36:39], s51 offen nt lds
s_add_u32 m0, m0, 4096
s_add_u32 s51, s51, 4096
buffer_load_dwordx4 v8, s[36:39], s51 offen nt lds
s_add_u32 m0, m0, 4096
s_add_u32 s51, s51, 4096
buffer_load_dwordx4 v8, s[36:39], s51 offen nt lds
s_add_u32 m0, m0, 4096
s_add_u32 s51, s51, 4096
buffer_load_dwordx4 v8, s[36:39], s51 offen nt lds
s_add_u32 m0, m0, 4096
s_add_u32 s51, s51, 4096
buffer_load_dwordx4 v8, s[36:39], s51 offen nt lds
s_add_u32 m0, m0, 4096
s_add_u32 s51, s51, 4096
buffer_load_dwordx4 v8, s[36:39], s51 offen nt lds
s_add_u32 m0, m0, 4096
s_add_u32 s51, s51, 4096
buffer_load_dwordx4 v8, s[36:39], s51 offen nt lds
s_waitcnt vmcnt(20)
s_barrier
ds_read_b64_tr_b16 a[80:81], v6 offset:0
ds_read_b64_tr_b16 a[82:83], v6 offset:512
ds_read_b64_tr_b16 a[84:85], v6 offset:4096
ds_read_b64_tr_b16 a[86:87], v6 offset:4608
ds_read_b64_tr_b16 a[88:89], v6 offset:8192
ds_read_b64_tr_b16 a[90:91], v6 offset:8704
ds_read_b64_tr_b16 a[92:93], v6 offset:12288
ds_read_b64_tr_b16 a[94:95], v6 offset:12800
ds_read_b64_tr_b16 a[96:97], v6 offset:16384
ds_read_b64_tr_b16 a[98:99], v6 offset:16896
ds_read_b64_tr_b16 a[100:101], v6 offset:20480
ds_read_b64_tr_b16 a[102:103], v6 offset:20992
ds_read_b64_tr_b16 a[104:105], v6 offset:24576
ds_read_b64_tr_b16 a[106:107], v6 offset:25088
ds_read_b64_tr_b16 a[108:109], v6 offset:28672
ds_read_b64_tr_b16 a[110:111], v6 offset:29184
ds_read_b64_tr_b16 a[112:113], v6 offset:32768
ds_read_b64_tr_b16 a[114:115], v6 offset:33280
ds_read_b64_tr_b16 a[116:117], v6 offset:36864
ds_read_b64_tr_b16 a[118:119], v6 offset:37376
ds_read_b64_tr_b16 a[120:121], v7 offset:0
ds_read_b64_tr_b16 a[122:123], v7 offset:512
ds_read_b64_tr_b16 a[124:125], v7 offset:4096
ds_read_b64_tr_b16 a[126:127], v7 offset:4608
ds_read_b64_tr_b16 a[128:129], v7 offset:8192
ds_read_b64_tr_b16 a[130:131], v7 offset:8704
ds_read_b64_tr_b16 a[132:133], v7 offset:12288
ds_read_b64_tr_b16 a[134:135], v7 offset:12800
ds_read_b64_tr_b16 a[136:137], v7 offset:16384
ds_read_b64_tr_b16 a[138:139], v7 offset:16896
ds_read_b64_tr_b16 a[140:141], v7 offset:20480
ds_read_b64_tr_b16 a[142:143], v7 offset:20992
ds_read_b64_tr_b16 a[144:145], v7 offset:24576
ds_read_b64_tr_b16 a[146:147], v7 offset:25088
ds_read_b64_tr_b16 a[148:149], v7 offset:28672
ds_read_b64_tr_b16 a[150:151], v7 offset:29184
ds_read_b64_tr_b16 a[152:153], v7 offset:32768
ds_read_b64_tr_b16 a[154:155], v7 offset:33280
ds_read_b64_tr_b16 a[156:157], v7 offset:36864
ds_read_b64_tr_b16 a[158:159], v7 offset:37376
s_waitcnt vmcnt(0) lgkmcnt(0)
s_barrier
ds_read_b64_tr_b16 a[160:161], v11 offset:0
ds_read_b64_tr_b16 a[162:163], v11 offset:5120
ds_read_b64_tr_b16 a[164:165], v11 offset:40960
ds_read_b64_tr_b16 a[166:167], v11 offset:46080
ds_read_b64_tr_b16 a[168:169], v11 offset:32
ds_read_b64_tr_b16 a[170:171], v11 offset:5152
ds_read_b64_tr_b16 a[172:173], v11 offset:40992
ds_read_b64_tr_b16 a[174:175], v11 offset:46112
ds_read_b64_tr_b16 a[176:177], v11 offset:64
ds_read_b64_tr_b16 a[178:179], v11 offset:5184
ds_read_b64_tr_b16 a[180:181], v11 offset:41024
ds_read_b64_tr_b16 a[182:183], v11 offset:46144
ds_read_b64_tr_b16 a[184:185], v11 offset:96
ds_read_b64_tr_b16 a[186:187], v11 offset:5216
ds_read_b64_tr_b16 a[188:189], v11 offset:41056
ds_read_b64_tr_b16 a[190:191], v11 offset:46176
ds_read_b64_tr_b16 a[192:193], v11 offset:128
ds_read_b64_tr_b16 a[194:195], v11 offset:5248
ds_read_b64_tr_b16 a[196:197], v11 offset:41088
ds_read_b64_tr_b16 a[198:199], v11 offset:46208
ds_read_b64_tr_b16 a[200:201], v11 offset:160
ds_read_b64_tr_b16 a[202:203], v11 offset:5280
ds_read_b64_tr_b16 a[204:205], v11 offset:41120
ds_read_b64_tr_b16 a[206:207], v11 offset:46240
ds_read_b64_tr_b16 a[208:209], v11 offset:192
ds_read_b64_tr_b16 a[210:211], v11 offset:5312
ds_read_b64_tr_b16 a[212:213], v11 offset:41152
ds_read_b64_tr_b16 a[214:215], v11 offset:46272
ds_read_b64_tr_b16 a[216:217], v11 offset:224
ds_read_b64_tr_b16 a[218:219], v11 offset:5344
ds_read_b64_tr_b16 a[220:221], v11 offset:41184
ds_read_b64_tr_b16 a[222:223], v11 offset:46304
ds_read_b64_tr_b16 a[224:225], v11 offset:256
ds_read_b64_tr_b16 a[226:227], v11 offset:5376
ds_read_b64_tr_b16 a[228:229], v11 offset:41216
ds_read_b64_tr_b16 a[230:231], v11 offset:46336
ds_read_b64_tr_b16 a[232:233], v11 offset:288
ds_read_b64_tr_b16 a[234:235], v11 offset:5408
ds_read_b64_tr_b16 a[236:237], v11 offset:41248
ds_read_b64_tr_b16 a[238:239], v11 offset:46368
s_waitcnt lgkmcnt(0)
v_mov_b32 v20, 0
ds_write_b32 v12, v20 offset:8192
v_mul_u32_u24 v30, 5462, v1
v_lshrrev_b32 v30, 16, v30
v_lshl_add_u32 v14, v30, 6, v8
v_add_u32 v31, 64, v1
v_mul_u32_u24 v30, 5462, v31
v_lshrrev_b32 v30, 16, v30
v_lshlrev_b32 v31, 4, v31
v_lshl_add_u32 v15, v30, 6, v31
v_cmp_gt_u32 vcc, 16, v1
s_lshl_b32 s55, s3, 11
v_add_u32 v16, s55, v8
v_cndmask_b32 v15, v255, v15, vcc
v_lshl_add_u32 v17, v3, 4, s55
s_lshl_b32 s55, s3, 5
v_lshl_add_u32 v18, v2, 1, s55
v_lshrrev_b32 v30, 2, v2
v_lshlrev_b32 v31, 4, v3
v_add_u32 v32, 128, v31
v_cmp_eq_u32 vcc, 0, v30
s_nop 1
v_cndmask_b32 v232, v32, v31, vcc
v_cmp_eq_u32 vcc, 1, v30
s_nop 1
v_cndmask_b32 v233, v32, v31, vcc
v_cmp_eq_u32 vcc, 2, v30
s_nop 1
v_cndmask_b32 v234, v32, v31, vcc
v_cmp_eq_u32 vcc, 3, v30
s_nop 1
v_cndmask_b32 v235, v32, v31, vcc
v_lshrrev_b32 v30, 5, v1
v_and_b32 v31, 31, v1
v_lshlrev_b32 v31, 2, v31
v_lshl_add_u32 v236, v30, 12, v31
v_cmp_gt_u32 vcc, 32, v1
s_mul_i32 s46, s3, 20480
s_lshl_b32 s55, s44, 7
s_add_u32 s46, s46, s55
s_add_u32 s46, s46, 720896
v_cndmask_b32 v237, v255, v236, vcc
s_add_u32 s47, s46, 8192
s_add_u32 s48, s46, 16384
s_mov_b32 s54, 0xffffff00
v_cmp_gt_u32 vcc, 32, v0
s_lshl_b32 s53, s44, 7
s_add_u32 s53, s53, 401408
v_cndmask_b32 v238, v255, v12, vcc
s_waitcnt lgkmcnt(0)
s_barrier
v_and_b32 v30, 31, v1
v_lshlrev_b32 v30, 7, v30
s_mov_b32 s55, 393216
L_m_p:
buffer_load_dwordx4 v[200:203], v30, s[4:7], s55 offen sc1
s_waitcnt vmcnt(0)
v_cmp_ne_u32 vcc, s40, v202
v_mov_b32 v20, v200
s_cbranch_vccz L_m_ok
s_add_u32 s97, s97, 1
s_cmp_le_u32 s97, 65536
s_cbranch_scc1 L_m_p
L_m_ok:
v_max_f32_dpp v24, v20, v20 row_ror:8 row_mask:0xf bank_mask:0xf
s_nop 1
v_max_f32_dpp v24, v24, v24 row_ror:4 row_mask:0xf bank_mask:0xf
s_nop 1
v_max_f32_dpp v24, v24, v24 row_ror:2 row_mask:0xf bank_mask:0xf
s_nop 1
v_max_f32_dpp v24, v24, v24 row_ror:1 row_mask:0xf bank_mask:0xf
v_mov_b32 v25, v24
s_nop 1
v_permlane16_swap_b32 v24, v25
v_max_f32 v24, v24, v25
v_cmp_eq_f32 vcc, v24, v20
s_ff1_i32_b64 s45, vcc
s_and_b32 s45, s45, 31
s_lshl_b32 s55, s45, 11
s_add_u32 s55, s55, 458752
L_m_rp:
buffer_load_dwordx4 v[20:23], v14, s[4:7], s55 offen sc1
buffer_load_dwordx4 v[24:27], v15, s[4:7], s55 offen sc1
s_waitcnt vmcnt(0)
ds_write_b128 v16, v[20:23]
ds_write_b128 v16, v[24:27] offset:1024
v_max3_u32 v28, v20, v21, v22
v_max3_u32 v29, v23, v24, v25
v_max3_u32 v28, v28, v26, v27
v_max_u32 v28, v28, v29
v_cmp_eq_u32 vcc, -1, v28
s_add_u32 s97, s97, 1
s_cmp_gt_u32 s97, 65536
s_cbranch_scc1 L_m_rok
s_cbranch_vccnz L_m_rp
L_m_rok:
ds_read_b128 v[100:103], v17 offset:0
ds_read_b128 v[104:107], v17 offset:64
ds_read_b128 v[108:111], v17 offset:128
ds_read_b128 v[112:115], v17 offset:192
ds_read_b128 v[116:119], v17 offset:256
ds_read_b128 v[120:123], v17 offset:320
s_waitcnt lgkmcnt(5)
v_mfma_f32_16x16x32_bf16 v[32:35], v[100:103], a[0:3], 0
ds_read_b128 v[124:127], v17 offset:384
v_mfma_f32_16x16x32_bf16 v[36:39], v[100:103], a[80:83], 0
s_waitcnt lgkmcnt(5)
v_mfma_f32_16x16x32_bf16 v[32:35], v[104:107], a[4:7], v[32:35]
ds_read_b128 v[128:131], v17 offset:448
v_mfma_f32_16x16x32_bf16 v[36:39], v[104:107], a[84:87], v[36:39]
s_waitcnt lgkmcnt(5)
v_mfma_f32_16x16x32_bf16 v[32:35], v[108:111], a[8:11], v[32:35]
ds_read_b128 v[132:135], v17 offset:512
v_mfma_f32_16x16x32_bf16 v[36:39], v[108:111], a[88:91], v[36:39]
s_waitcnt lgkmcnt(5)
v_mfma_f32_16x16x32_bf16 v[32:35], v[112:115], a[12:15], v[32:35]
ds_read_b128 v[136:139], v17 offset:576
v_mfma_f32_16x16x32_bf16 v[36:39], v[112:115], a[92:95], v[36:39]
s_waitcnt lgkmcnt(5)
v_mfma_f32_16x16x32_bf16 v[32:35], v[116:119], a[16:19], v[32:35]
ds_read_b128 v[140:143], v17 offset:640
v_mfma_f32_16x16x32_bf16 v[36:39], v[116:119], a[96:99], v[36:39]
s_waitcnt lgkmcnt(5)
v_mfma_f32_16x16x32_bf16 v[32:35], v[120:123], a[20:23], v[32:35]
ds_read_b128 v[144:147], v17 offset:704
v_mfma_f32_16x16x32_bf16 v[36:39], v[120:123], a[100:103], v[36:39]
s_waitcnt lgkmcnt(5)
v_mfma_f32_16x16x32_bf16 v[32:35], v[124:127], a[24:27], v[32:35]
ds_read_b128 v[148:151], v17 offset:768
v_mfma_f32_16x16x32_bf16 v[36:39], v[124:127], a[104:107], v[36:39]
s_waitcnt lgkmcnt(5)
v_mfma_f32_16x16x32_bf16 v[32:35], v[128:131], a[28:31], v[32:35]
ds_read_b128 v[152:155], v17 offset:832
v_mfma_f32_16x16x32_bf16 v[36:39], v[128:131], a[108:111], v[36:39]
s_waitcnt lgkmcnt(5)
v_mfma_f32_16x16x32_bf16 v[32:35], v[132:135], a[32:35], v[32:35]
ds_read_b128 v[156:159], v17 offset:896
v_mfma_f32_16x16x32_bf16 v[36:39], v[132:135], a[112:115], v[36:39]
buffer_store_dword v240, v238, s[4:7], s53 offen sc1
s_waitcnt lgkmcnt(5)
v_mfma_f32_16x16x32_bf16 v[32:35], v[136:139], a[36:39], v[32:35]
ds_read_b128 v[160:163], v17 offset:960
v_mfma_f32_16x16x32_bf16 v[36:39], v[136:139], a[116:119], v[36:39]
s_waitcnt lgkmcnt(5)
v_mfma_f32_16x16x32_bf16 v[32:35], v[140:143], a[40:43], v[32:35]
ds_read_b128 v[164:167], v17 offset:1024
v_mfma_f32_16x16x32_bf16 v[36:39], v[140:143], a[120:123], v[36:39]
s_waitcnt lgkmcnt(5)
v_mfma_f32_16x16x32_bf16 v[32:35], v[144:147], a[44:47], v[32:35]
ds_read_b128 v[168:171], v17 offset:1088
v_mfma_f32_16x16x32_bf16 v[36:39], v[144:147], a[124:127], v[36:39]
s_waitcnt lgkmcnt(5)
v_mfma_f32_16x16x32_bf16 v[32:35], v[148:151], a[48:51], v[32:35]
ds_read_b128 v[172:175], v17 offset:1152
v_mfma_f32_16x16x32_bf16 v[36:39], v[148:151], a[128:131], v[36:39]
s_waitcnt lgkmcnt(5)
v_mfma_f32_16x16x32_bf16 v[32:35], v[152:155], a[52:55], v[32:35]
ds_read_b128 v[176:179], v17 offset:1216
v_mfma_f32_16x16x32_bf16 v[36:39], v[152:155], a[132:135], v[36:39]
s_waitcnt lgkmcnt(5)
v_mfma_f32_16x16x32_bf16 v[32:35], v[156:159], a[56:59], v[32:35]
v_mfma_f32_16x16x32_bf16 v[36:39], v[156:159], a[136:139], v[36:39]
s_waitcnt lgkmcnt(4)
v_mfma_f32_16x16x32_bf16 v[32:35], v[160:163], a[60:63], v[32:35]
v_mfma_f32_16x16x32_bf16 v[36:39], v[160:163], a[140:143], v[36:39]
s_waitcnt lgkmcnt(3)
v_mfma_f32_16x16x32_bf16 v[32:35], v[164:167], a[64:67], v[32:35]
v_mfma_f32_16x16x32_bf16 v[36:39], v[164:167], a[144:147], v[36:39]
s_waitcnt lgkmcnt(2)
v_mfma_f32_16x16x32_bf16 v[32:35], v[168:171], a[68:71], v[32:35]
v_mfma_f32_16x16x32_bf16 v[36:39], v[168:171], a[148:151], v[36:39]
s_waitcnt lgkmcnt(1)
v_mfma_f32_16x16x32_bf16 v[32:35], v[172:175], a[72:75], v[32:35]
v_mfma_f32_16x16x32_bf16 v[36:39], v[172:175], a[152:155], v[36:39]
s_waitcnt lgkmcnt(0)
v_mfma_f32_16x16x32_bf16 v[32:35], v[176:179], a[76:79], v[32:35]
v_mfma_f32_16x16x32_bf16 v[36:39], v[176:179], a[156:159], v[36:39]
s_nop 6
v_mul_f32 v33, 0xbfb8aa3b, v32
v_exp_f32 v33, v33
s_nop 0
v_add_f32 v33, 1.0, v33
v_rcp_f32 v33, v33
s_nop 0
v_mul_f32 v32, v32, v33
v_mul_f32 v32, v32, v36
v_cvt_pk_bf16_f32 v32, v32, v32
ds_write_b16 v18, v32 offset:8192
s_waitcnt lgkmcnt(0)
s_barrier
ds_read_b128 v[40:43], v232 offset:8192
ds_read_b128 v[44:47], v232 offset:8256
ds_read_b128 v[48:51], v233 offset:8192
ds_read_b128 v[52:55], v233 offset:8256
ds_read_b128 v[56:59], v234 offset:8192
ds_read_b128 v[60:63], v234 offset:8256
ds_read_b128 v[64:67], v235 offset:8192
ds_read_b128 v[68:71], v235 offset:8256
s_waitcnt lgkmcnt(6)
v_mfma_f32_16x16x32_bf16 v[20:23], v[40:43], a[160:163], 0
v_mfma_f32_16x16x32_bf16 v[20:23], v[44:47], a[164:167], v[20:23]
s_waitcnt lgkmcnt(4)
v_mfma_f32_16x16x32_bf16 v[20:23], v[48:51], a[168:171], v[20:23]
v_mfma_f32_16x16x32_bf16 v[20:23], v[52:55], a[172:175], v[20:23]
s_waitcnt lgkmcnt(2)
v_mfma_f32_16x16x32_bf16 v[20:23], v[56:59], a[176:179], v[20:23]
v_mfma_f32_16x16x32_bf16 v[20:23], v[60:63], a[180:183], v[20:23]
s_waitcnt lgkmcnt(0)
v_mfma_f32_16x16x32_bf16 v[20:23], v[64:67], a[184:187], v[20:23]
v_mfma_f32_16x16x32_bf16 v[20:23], v[68:71], a[188:191], v[20:23]
v_mfma_f32_16x16x32_bf16 v[24:27], v[40:43], a[192:195], 0
v_mfma_f32_16x16x32_bf16 v[24:27], v[44:47], a[196:199], v[24:27]
v_mfma_f32_16x16x32_bf16 v[24:27], v[48:51], a[200:203], v[24:27]
v_mfma_f32_16x16x32_bf16 v[24:27], v[52:55], a[204:207], v[24:27]
v_mfma_f32_16x16x32_bf16 v[24:27], v[56:59], a[208:211], v[24:27]
v_mfma_f32_16x16x32_bf16 v[24:27], v[60:63], a[212:215], v[24:27]
v_mfma_f32_16x16x32_bf16 v[24:27], v[64:67], a[216:219], v[24:27]
v_mfma_f32_16x16x32_bf16 v[24:27], v[68:71], a[220:223], v[24:27]
v_mfma_f32_16x16x32_bf16 v[28:31], v[40:43], a[224:227], 0
v_mfma_f32_16x16x32_bf16 v[28:31], v[44:47], a[228:231], v[28:31]
v_mfma_f32_16x16x32_bf16 v[28:31], v[48:51], a[232:235], v[28:31]
v_mfma_f32_16x16x32_bf16 v[28:31], v[52:55], a[236:239], v[28:31]
v_and_or_b32 v20, v20, s54, v19
buffer_store_dword v20, v236, s[4:7], s46 offen sc1
s_nop 1
v_and_or_b32 v24, v24, s54, v19
buffer_store_dword v24, v236, s[4:7], s47 offen sc1
s_nop 1
v_and_or_b32 v28, v28, s54, v19
buffer_store_dword v28, v237, s[4:7], s48 offen sc1
s_branch L_fin
L_fz:
s_add_u32 s46, s44, 5
s_add_u32 s47, s44, 10
s_lshl_b32 s50, s44, 7
s_mul_i32 s55, s3, 61440
s_add_u32 s50, s50, s55
s_add_u32 s50, s50, 2560
s_add_u32 m0, s49, 0
s_nop 0
buffer_load_dwordx4 v4, s[16:19], s50 offen nt lds
s_add_u32 m0, m0, 4096
s_add_u32 s50, s50, 245760
buffer_load_dwordx4 v4, s[16:19], s50 offen nt lds
s_add_u32 m0, m0, 4096
s_add_u32 s50, s50, 245760
buffer_load_dwordx4 v4, s[16:19], s50 offen nt lds
s_add_u32 m0, m0, 4096
s_add_u32 s50, s50, 245760
buffer_load_dwordx4 v4, s[16:19], s50 offen nt lds
s_add_u32 m0, m0, 4096
s_add_u32 s50, s50, 245760
buffer_load_dwordx4 v4, s[16:19], s50 offen nt lds
s_add_u32 m0, m0, 4096
s_add_u32 s50, s50, 245760
buffer_load_dwordx4 v4, s[16:19], s50 offen nt lds
s_add_u32 m0, m0, 4096
s_add_u32 s50, s50, 245760
buffer_load_dwordx4 v4, s[16:19], s50 offen nt lds
s_add_u32 m0, m0, 4096
s_add_u32 s50, s50, 245760
buffer_load_dwordx4 v4, s[16:19], s50 offen nt lds
s_add_u32 m0, m0, 4096
s_add_u32 s50, s50, 245760
buffer_load_dwordx4 v4, s[16:19], s50 offen nt lds
s_add_u32 m0, m0, 4096
s_add_u32 s50, s50, 245760
buffer_load_dwordx4 v4, s[16:19], s50 offen nt lds
s_add_u32 m0, m0, 4096
s_add_u32 s50, s50, 245760
buffer_load_dwordx4 v4, s[16:19], s50 offen nt lds
s_add_u32 m0, m0, 4096
s_add_u32 s50, s50, 245760
buffer_load_dwordx4 v4, s[16:19], s50 offen nt lds
s_add_u32 m0, m0, 4096
s_add_u32 s50, s50, 245760
buffer_load_dwordx4 v4, s[16:19], s50 offen nt lds
s_add_u32 m0, m0, 4096
s_add_u32 s50, s50, 245760
buffer_load_dwordx4 v4, s[16:19], s50 offen nt lds
s_add_u32 m0, m0, 4096
s_add_u32 s50, s50, 245760
buffer_load_dwordx4 v4, s[16:19], s50 offen nt lds
s_add_u32 m0, m0, 4096
s_add_u32 s50, s50, 245760
buffer_load_dwordx4 v4, s[16:19], s50 offen nt lds
s_add_u32 m0, m0, 4096
s_add_u32 s50, s50, 245760
buffer_load_dwordx4 v4, s[16:19], s50 offen nt lds
s_add_u32 m0, m0, 4096
s_add_u32 s50, s50, 245760
buffer_load_dwordx4 v4, s[16:19], s50 offen nt lds
s_add_u32 m0, m0, 4096
s_add_u32 s50, s50, 245760
buffer_load_dwordx4 v4, s[16:19], s50 offen nt lds
s_add_u32 m0, m0, 4096
s_add_u32 s50, s50, 245760
buffer_load_dwordx4 v4, s[16:19], s50 offen nt lds
s_waitcnt vmcnt(20)
v_readfirstlane_b32 s41, v42
v_lshlrev_b32 v44, 16, v40
v_and_b32 v45, 0xffff0000, v40
v_lshlrev_b32 v46, 16, v41
v_and_b32 v47, 0xffff0000, v41
v_mul_f32 v48, 0xbfb8aa3b, v44
v_mul_f32 v49, 0xbfb8aa3b, v45
v_mul_f32 v50, 0xbfb8aa3b, v46
v_mul_f32 v51, 0xbfb8aa3b, v47
v_exp_f32 v48, v48
v_exp_f32 v49, v49
v_exp_f32 v50, v50
v_exp_f32 v51, v51
v_add_f32 v48, 1.0, v48
v_add_f32 v49, 1.0, v49
v_add_f32 v50, 1.0, v50
v_add_f32 v51, 1.0, v51
v_rcp_f32 v48, v48
v_rcp_f32 v49, v49
v_rcp_f32 v50, v50
v_rcp_f32 v51, v51
v_mul_f32 v44, v44, v48
v_mul_f32 v45, v45, v49
v_mul_f32 v46, v46, v50
v_mul_f32 v47, v47, v51
v_cvt_pk_bf16_f32 v40, v44, v45
v_cvt_pk_bf16_f32 v41, v46, v47
v_add_u32 v28, 99840, v28
ds_write_b64 v28, v[40:41]
v_lshlrev_b32 v28, 4, v3
v_add_u32 v28, 99840, v28
s_mul_i32 s40, s41, 0x9E3779B1
s_add_u32 s40, s40, 0x85EBCA6B
v_and_b32 v33, 3, v1
v_lshlrev_b32 v33, 3, v33
v_lshrrev_b32 v19, v33, s40
v_and_b32 v19, 0xff, v19
v_mov_b32 v240, s40
v_mov_b32 v241, s19
v_mov_b32 v242, s40
v_mov_b32 v243, s40
v_and_b32 v30, 1, v1
v_lshlrev_b32 v30, 4, v30
v_lshrrev_b32 v13, v30, s40
v_and_b32 v13, 0xffff, v13
s_waitcnt lgkmcnt(0)
s_barrier
ds_read_b128 v[100:103], v28 offset:0
ds_read_b128 v[104:107], v28 offset:64
ds_read_b128 v[108:111], v28 offset:128
ds_read_b128 v[112:115], v28 offset:192
ds_read_b128 v[116:119], v28 offset:256
ds_read_b128 v[120:123], v28 offset:320
ds_read_b128 v[124:127], v28 offset:384
ds_read_b128 v[128:131], v28 offset:448
ds_read_b128 v[132:135], v28 offset:512
ds_read_b128 v[136:139], v28 offset:576
ds_read_b128 v[140:143], v28 offset:640
ds_read_b128 v[144:147], v28 offset:704
ds_read_b128 v[148:151], v28 offset:768
ds_read_b128 v[152:155], v28 offset:832
ds_read_b128 v[156:159], v28 offset:896
ds_read_b128 v[160:163], v28 offset:960
ds_read_b128 v[164:167], v28 offset:1024
ds_read_b128 v[168:171], v28 offset:1088
ds_read_b128 v[172:175], v28 offset:1152
ds_read_b128 v[176:179], v28 offset:1216
s_waitcnt lgkmcnt(0)
s_barrier
s_lshl_b32 s50, s46, 7
s_mul_i32 s55, s3, 61440
s_add_u32 s50, s50, s55
s_add_u32 s50, s50, 2560
s_add_u32 m0, s49, 81920
s_nop 0
buffer_load_dwordx4 v4, s[16:19], s50 offen nt lds
s_add_u32 m0, m0, 4096
s_add_u32 s50, s50, 245760
buffer_load_dwordx4 v4, s[16:19], s50 offen nt lds
s_add_u32 m0, m0, 4096
s_add_u32 s50, s50, 245760
buffer_load_dwordx4 v4, s[16:19], s50 offen nt lds
s_add_u32 m0, m0, 4096
s_add_u32 s50, s50, 245760
buffer_load_dwordx4 v4, s[16:19], s50 offen nt lds
s_add_u32 m0, m0, 4096
s_add_u32 s50, s50, 245760
buffer_load_dwordx4 v4, s[16:19], s50 offen nt lds
s_add_u32 m0, m0, 4096
s_add_u32 s50, s50, 245760
buffer_load_dwordx4 v4, s[16:19], s50 offen nt lds
s_add_u32 m0, m0, 4096
s_add_u32 s50, s50, 245760
buffer_load_dwordx4 v4, s[16:19], s50 offen nt lds
s_add_u32 m0, m0, 4096
s_add_u32 s50, s50, 245760
buffer_load_dwordx4 v4, s[16:19], s50 offen nt lds
s_add_u32 m0, m0, 4096
s_add_u32 s50, s50, 245760
buffer_load_dwordx4 v4, s[16:19], s50 offen nt lds
s_add_u32 m0, m0, 4096
s_add_u32 s50, s50, 245760
buffer_load_dwordx4 v4, s[16:19], s50 offen nt lds
s_add_u32 m0, m0, 4096
s_add_u32 s50, s50, 245760
buffer_load_dwordx4 v4, s[16:19], s50 offen nt lds
s_add_u32 m0, m0, 4096
s_add_u32 s50, s50, 245760
buffer_load_dwordx4 v4, s[16:19], s50 offen nt lds
s_add_u32 m0, m0, 4096
s_add_u32 s50, s50, 245760
buffer_load_dwordx4 v4, s[16:19], s50 offen nt lds
s_add_u32 m0, m0, 4096
s_add_u32 s50, s50, 245760
buffer_load_dwordx4 v4, s[16:19], s50 offen nt lds
s_add_u32 m0, m0, 4096
s_add_u32 s50, s50, 245760
buffer_load_dwordx4 v4, s[16:19], s50 offen nt lds
s_add_u32 m0, m0, 4096
s_add_u32 s50, s50, 245760
buffer_load_dwordx4 v4, s[16:19], s50 offen nt lds
s_add_u32 m0, m0, 4096
s_add_u32 s50, s50, 245760
buffer_load_dwordx4 v4, s[16:19], s50 offen nt lds
s_add_u32 m0, m0, 4096
s_add_u32 s50, s50, 245760
buffer_load_dwordx4 v4, s[16:19], s50 offen nt lds
s_add_u32 m0, m0, 4096
s_add_u32 s50, s50, 245760
buffer_load_dwordx4 v4, s[16:19], s50 offen nt lds
s_add_u32 m0, m0, 4096
s_add_u32 s50, s50, 245760
buffer_load_dwordx4 v4, s[16:19], s50 offen nt lds
s_waitcnt vmcnt(20)
s_barrier
ds_read_b64_tr_b16 v[20:21], v6 offset:0
ds_read_b64_tr_b16 v[22:23], v6 offset:512
ds_read_b64_tr_b16 v[24:25], v6 offset:4096
ds_read_b64_tr_b16 v[26:27], v6 offset:4608
ds_read_b64_tr_b16 v[28:29], v6 offset:8192
ds_read_b64_tr_b16 v[30:31], v6 offset:8704
ds_read_b64_tr_b16 v[32:33], v6 offset:12288
ds_read_b64_tr_b16 v[34:35], v6 offset:12800
ds_read_b64_tr_b16 v[36:37], v6 offset:16384
ds_read_b64_tr_b16 v[38:39], v6 offset:16896
ds_read_b64_tr_b16 v[40:41], v6 offset:20480
ds_read_b64_tr_b16 v[42:43], v6 offset:20992
ds_read_b64_tr_b16 v[44:45], v6 offset:24576
ds_read_b64_tr_b16 v[46:47], v6 offset:25088
ds_read_b64_tr_b16 v[48:49], v6 offset:28672
ds_read_b64_tr_b16 v[50:51], v6 offset:29184
ds_read_b64_tr_b16 v[52:53], v6 offset:32768
ds_read_b64_tr_b16 v[54:55], v6 offset:33280
ds_read_b64_tr_b16 v[56:57], v6 offset:36864
ds_read_b64_tr_b16 v[58:59], v6 offset:37376
ds_read_b64_tr_b16 v[60:61], v7 offset:0
ds_read_b64_tr_b16 v[62:63], v7 offset:512
ds_read_b64_tr_b16 v[64:65], v7 offset:4096
ds_read_b64_tr_b16 v[66:67], v7 offset:4608
ds_read_b64_tr_b16 v[68:69], v7 offset:8192
ds_read_b64_tr_b16 v[70:71], v7 offset:8704
ds_read_b64_tr_b16 v[72:73], v7 offset:12288
ds_read_b64_tr_b16 v[74:75], v7 offset:12800
ds_read_b64_tr_b16 v[76:77], v7 offset:16384
ds_read_b64_tr_b16 v[78:79], v7 offset:16896
ds_read_b64_tr_b16 v[80:81], v7 offset:20480
ds_read_b64_tr_b16 v[82:83], v7 offset:20992
ds_read_b64_tr_b16 v[84:85], v7 offset:24576
ds_read_b64_tr_b16 v[86:87], v7 offset:25088
ds_read_b64_tr_b16 v[88:89], v7 offset:28672
ds_read_b64_tr_b16 v[90:91], v7 offset:29184
ds_read_b64_tr_b16 v[92:93], v7 offset:32768
ds_read_b64_tr_b16 v[94:95], v7 offset:33280
ds_read_b64_tr_b16 v[96:97], v7 offset:36864
ds_read_b64_tr_b16 v[98:99], v7 offset:37376
s_waitcnt lgkmcnt(0)
s_barrier
v_mfma_f32_16x16x32_bf16 v[180:183], v[100:103], v[20:23], 0
v_mfma_f32_16x16x32_bf16 v[180:183], v[104:107], v[24:27], v[180:183]
v_mfma_f32_16x16x32_bf16 v[180:183], v[108:111], v[28:31], v[180:183]
v_mfma_f32_16x16x32_bf16 v[180:183], v[112:115], v[32:35], v[180:183]
v_mfma_f32_16x16x32_bf16 v[180:183], v[116:119], v[36:39], v[180:183]
v_mfma_f32_16x16x32_bf16 v[180:183], v[120:123], v[40:43], v[180:183]
v_mfma_f32_16x16x32_bf16 v[180:183], v[124:127], v[44:47], v[180:183]
v_mfma_f32_16x16x32_bf16 v[180:183], v[128:131], v[48:51], v[180:183]
v_mfma_f32_16x16x32_bf16 v[180:183], v[132:135], v[52:55], v[180:183]
v_mfma_f32_16x16x32_bf16 v[180:183], v[136:139], v[56:59], v[180:183]
v_mfma_f32_16x16x32_bf16 v[180:183], v[140:143], v[60:63], v[180:183]
v_mfma_f32_16x16x32_bf16 v[180:183], v[144:147], v[64:67], v[180:183]
v_mfma_f32_16x16x32_bf16 v[180:183], v[148:151], v[68:71], v[180:183]
v_mfma_f32_16x16x32_bf16 v[180:183], v[152:155], v[72:75], v[180:183]
v_mfma_f32_16x16x32_bf16 v[180:183], v[156:159], v[76:79], v[180:183]
v_mfma_f32_16x16x32_bf16 v[180:183], v[160:163], v[80:83], v[180:183]
v_mfma_f32_16x16x32_bf16 v[180:183], v[164:167], v[84:87], v[180:183]
v_mfma_f32_16x16x32_bf16 v[180:183], v[168:171], v[88:91], v[180:183]
v_mfma_f32_16x16x32_bf16 v[180:183], v[172:175], v[92:95], v[180:183]
v_mfma_f32_16x16x32_bf16 v[180:183], v[176:179], v[96:99], v[180:183]
s_sub_u32 s55, s44, 20
s_cmp_lt_u32 s55, 10
s_cselect_b32 s55, 1.0, 0
s_lshl_b32 s56, s44, 8
s_lshl_b32 s57, s3, 6
s_add_u32 s56, s56, s57
s_add_u32 s56, s56, 65536
s_nop 0
v_cvt_pk_bf16_f32 v180, v180, v180
v_lshlrev_b32 v180, 16, v180
v_add_f32 v180, s55, v180
v_cvt_pk_bf16_f32 v180, v180, v180
v_lshl_or_b32 v180, v180, 16, v13
s_mov_b64 exec, 0xffff
buffer_store_dword v180, v12, s[4:7], s56 offen sc1
s_mov_b64 exec, -1
s_cmp_lt_u32 s47, 40
s_cselect_b32 s18, s18, 0
s_lshl_b32 s50, s47, 7
s_mul_i32 s55, s3, 61440
s_add_u32 s50, s50, s55
s_add_u32 s50, s50, 2560
s_add_u32 m0, s49, 0
s_nop 0
buffer_load_dwordx4 v4, s[16:19], s50 offen nt lds
s_add_u32 m0, m0, 4096
s_add_u32 s50, s50, 245760
buffer_load_dwordx4 v4, s[16:19], s50 offen nt lds
s_add_u32 m0, m0, 4096
s_add_u32 s50, s50, 245760
buffer_load_dwordx4 v4, s[16:19], s50 offen nt lds
s_add_u32 m0, m0, 4096
s_add_u32 s50, s50, 245760
buffer_load_dwordx4 v4, s[16:19], s50 offen nt lds
s_add_u32 m0, m0, 4096
s_add_u32 s50, s50, 245760
buffer_load_dwordx4 v4, s[16:19], s50 offen nt lds
s_add_u32 m0, m0, 4096
s_add_u32 s50, s50, 245760
buffer_load_dwordx4 v4, s[16:19], s50 offen nt lds
s_add_u32 m0, m0, 4096
s_add_u32 s50, s50, 245760
buffer_load_dwordx4 v4, s[16:19], s50 offen nt lds
s_add_u32 m0, m0, 4096
s_add_u32 s50, s50, 245760
buffer_load_dwordx4 v4, s[16:19], s50 offen nt lds
s_add_u32 m0, m0, 4096
s_add_u32 s50, s50, 245760
buffer_load_dwordx4 v4, s[16:19], s50 offen nt lds
s_add_u32 m0, m0, 4096
s_add_u32 s50, s50, 245760
buffer_load_dwordx4 v4, s[16:19], s50 offen nt lds
s_add_u32 m0, m0, 4096
s_add_u32 s50, s50, 245760
buffer_load_dwordx4 v4, s[16:19], s50 offen nt lds
s_add_u32 m0, m0, 4096
s_add_u32 s50, s50, 245760
buffer_load_dwordx4 v4, s[16:19], s50 offen nt lds
s_add_u32 m0, m0, 4096
s_add_u32 s50, s50, 245760
buffer_load_dwordx4 v4, s[16:19], s50 offen nt lds
s_add_u32 m0, m0, 4096
s_add_u32 s50, s50, 245760
buffer_load_dwordx4 v4, s[16:19], s50 offen nt lds
s_add_u32 m0, m0, 4096
s_add_u32 s50, s50, 245760
buffer_load_dwordx4 v4, s[16:19], s50 offen nt lds
s_add_u32 m0, m0, 4096
s_add_u32 s50, s50, 245760
buffer_load_dwordx4 v4, s[16:19], s50 offen nt lds
s_add_u32 m0, m0, 4096
s_add_u32 s50, s50, 245760
buffer_load_dwordx4 v4, s[16:19], s50 offen nt lds
s_add_u32 m0, m0, 4096
s_add_u32 s50, s50, 245760
buffer_load_dwordx4 v4, s[16:19], s50 offen nt lds
s_add_u32 m0, m0, 4096
s_add_u32 s50, s50, 245760
buffer_load_dwordx4 v4, s[16:19], s50 offen nt lds
s_add_u32 m0, m0, 4096
s_add_u32 s50, s50, 245760
buffer_load_dwordx4 v4, s[16:19], s50 offen nt lds
s_waitcnt vmcnt(21)
s_barrier
ds_read_b64_tr_b16 v[20:21], v9 offset:0
ds_read_b64_tr_b16 v[22:23], v9 offset:512
ds_read_b64_tr_b16 v[24:25], v9 offset:4096
ds_read_b64_tr_b16 v[26:27], v9 offset:4608
ds_read_b64_tr_b16 v[28:29], v9 offset:8192
ds_read_b64_tr_b16 v[30:31], v9 offset:8704
ds_read_b64_tr_b16 v[32:33], v9 offset:12288
ds_read_b64_tr_b16 v[34:35], v9 offset:12800
ds_read_b64_tr_b16 v[36:37], v9 offset:16384
ds_read_b64_tr_b16 v[38:39], v9 offset:16896
ds_read_b64_tr_b16 v[40:41], v9 offset:20480
ds_read_b64_tr_b16 v[42:43], v9 offset:20992
ds_read_b64_tr_b16 v[44:45], v9 offset:24576
ds_read_b64_tr_b16 v[46:47], v9 offset:25088
ds_read_b64_tr_b16 v[48:49], v9 offset:28672
ds_read_b64_tr_b16 v[50:51], v9 offset:29184
ds_read_b64_tr_b16 v[52:53], v9 offset:32768
ds_read_b64_tr_b16 v[54:55], v9 offset:33280
ds_read_b64_tr_b16 v[56:57], v9 offset:36864
ds_read_b64_tr_b16 v[58:59], v9 offset:37376
ds_read_b64_tr_b16 v[60:61], v10 offset:0
ds_read_b64_tr_b16 v[62:63], v10 offset:512
ds_read_b64_tr_b16 v[64:65], v10 offset:4096
ds_read_b64_tr_b16 v[66:67], v10 offset:4608
ds_read_b64_tr_b16 v[68:69], v10 offset:8192
ds_read_b64_tr_b16 v[70:71], v10 offset:8704
ds_read_b64_tr_b16 v[72:73], v10 offset:12288
ds_read_b64_tr_b16 v[74:75], v10 offset:12800
ds_read_b64_tr_b16 v[76:77], v10 offset:16384
ds_read_b64_tr_b16 v[78:79], v10 offset:16896
ds_read_b64_tr_b16 v[80:81], v10 offset:20480
ds_read_b64_tr_b16 v[82:83], v10 offset:20992
ds_read_b64_tr_b16 v[84:85], v10 offset:24576
ds_read_b64_tr_b16 v[86:87], v10 offset:25088
ds_read_b64_tr_b16 v[88:89], v10 offset:28672
ds_read_b64_tr_b16 v[90:91], v10 offset:29184
ds_read_b64_tr_b16 v[92:93], v10 offset:32768
ds_read_b64_tr_b16 v[94:95], v10 offset:33280
ds_read_b64_tr_b16 v[96:97], v10 offset:36864
ds_read_b64_tr_b16 v[98:99], v10 offset:37376
s_waitcnt lgkmcnt(0)
s_barrier
v_mfma_f32_16x16x32_bf16 v[180:183], v[100:103], v[20:23], 0
v_mfma_f32_16x16x32_bf16 v[180:183], v[104:107], v[24:27], v[180:183]
v_mfma_f32_16x16x32_bf16 v[180:183], v[108:111], v[28:31], v[180:183]
v_mfma_f32_16x16x32_bf16 v[180:183], v[112:115], v[32:35], v[180:183]
v_mfma_f32_16x16x32_bf16 v[180:183], v[116:119], v[36:39], v[180:183]
v_mfma_f32_16x16x32_bf16 v[180:183], v[120:123], v[40:43], v[180:183]
v_mfma_f32_16x16x32_bf16 v[180:183], v[124:127], v[44:47], v[180:183]
v_mfma_f32_16x16x32_bf16 v[180:183], v[128:131], v[48:51], v[180:183]
v_mfma_f32_16x16x32_bf16 v[180:183], v[132:135], v[52:55], v[180:183]
v_mfma_f32_16x16x32_bf16 v[180:183], v[136:139], v[56:59], v[180:183]
v_mfma_f32_16x16x32_bf16 v[180:183], v[140:143], v[60:63], v[180:183]
v_mfma_f32_16x16x32_bf16 v[180:183], v[144:147], v[64:67], v[180:183]
v_mfma_f32_16x16x32_bf16 v[180:183], v[148:151], v[68:71], v[180:183]
v_mfma_f32_16x16x32_bf16 v[180:183], v[152:155], v[72:75], v[180:183]
v_mfma_f32_16x16x32_bf16 v[180:183], v[156:159], v[76:79], v[180:183]
v_mfma_f32_16x16x32_bf16 v[180:183], v[160:163], v[80:83], v[180:183]
v_mfma_f32_16x16x32_bf16 v[180:183], v[164:167], v[84:87], v[180:183]
v_mfma_f32_16x16x32_bf16 v[180:183], v[168:171], v[88:91], v[180:183]
v_mfma_f32_16x16x32_bf16 v[180:183], v[172:175], v[92:95], v[180:183]
v_mfma_f32_16x16x32_bf16 v[180:183], v[176:179], v[96:99], v[180:183]
s_sub_u32 s55, s46, 20
s_cmp_lt_u32 s55, 10
s_cselect_b32 s55, 1.0, 0
s_lshl_b32 s56, s46, 8
s_lshl_b32 s57, s3, 6
s_add_u32 s56, s56, s57
s_add_u32 s56, s56, 65536
s_nop 0
v_cvt_pk_bf16_f32 v180, v180, v180
v_lshlrev_b32 v180, 16, v180
v_add_f32 v180, s55, v180
v_cvt_pk_bf16_f32 v180, v180, v180
v_lshl_or_b32 v180, v180, 16, v13
s_mov_b64 exec, 0xffff
buffer_store_dword v180, v12, s[4:7], s56 offen sc1
s_mov_b64 exec, -1
s_cmp_lt_u32 s47, 40
s_cbranch_scc0 L_fz_u
s_waitcnt vmcnt(1)
s_barrier
ds_read_b64_tr_b16 v[20:21], v6 offset:0
ds_read_b64_tr_b16 v[22:23], v6 offset:512
ds_read_b64_tr_b16 v[24:25], v6 offset:4096
ds_read_b64_tr_b16 v[26:27], v6 offset:4608
ds_read_b64_tr_b16 v[28:29], v6 offset:8192
ds_read_b64_tr_b16 v[30:31], v6 offset:8704
ds_read_b64_tr_b16 v[32:33], v6 offset:12288
ds_read_b64_tr_b16 v[34:35], v6 offset:12800
ds_read_b64_tr_b16 v[36:37], v6 offset:16384
ds_read_b64_tr_b16 v[38:39], v6 offset:16896
ds_read_b64_tr_b16 v[40:41], v6 offset:20480
ds_read_b64_tr_b16 v[42:43], v6 offset:20992
ds_read_b64_tr_b16 v[44:45], v6 offset:24576
ds_read_b64_tr_b16 v[46:47], v6 offset:25088
ds_read_b64_tr_b16 v[48:49], v6 offset:28672
ds_read_b64_tr_b16 v[50:51], v6 offset:29184
ds_read_b64_tr_b16 v[52:53], v6 offset:32768
ds_read_b64_tr_b16 v[54:55], v6 offset:33280
ds_read_b64_tr_b16 v[56:57], v6 offset:36864
ds_read_b64_tr_b16 v[58:59], v6 offset:37376
ds_read_b64_tr_b16 v[60:61], v7 offset:0
ds_read_b64_tr_b16 v[62:63], v7 offset:512
ds_read_b64_tr_b16 v[64:65], v7 offset:4096
ds_read_b64_tr_b16 v[66:67], v7 offset:4608
ds_read_b64_tr_b16 v[68:69], v7 offset:8192
ds_read_b64_tr_b16 v[70:71], v7 offset:8704
ds_read_b64_tr_b16 v[72:73], v7 offset:12288
ds_read_b64_tr_b16 v[74:75], v7 offset:12800
ds_read_b64_tr_b16 v[76:77], v7 offset:16384
ds_read_b64_tr_b16 v[78:79], v7 offset:16896
ds_read_b64_tr_b16 v[80:81], v7 offset:20480
ds_read_b64_tr_b16 v[82:83], v7 offset:20992
ds_read_b64_tr_b16 v[84:85], v7 offset:24576
ds_read_b64_tr_b16 v[86:87], v7 offset:25088
ds_read_b64_tr_b16 v[88:89], v7 offset:28672
ds_read_b64_tr_b16 v[90:91], v7 offset:29184
ds_read_b64_tr_b16 v[92:93], v7 offset:32768
ds_read_b64_tr_b16 v[94:95], v7 offset:33280
ds_read_b64_tr_b16 v[96:97], v7 offset:36864
ds_read_b64_tr_b16 v[98:99], v7 offset:37376
s_waitcnt lgkmcnt(0)
s_barrier
v_mfma_f32_16x16x32_bf16 v[180:183], v[100:103], v[20:23], 0
v_mfma_f32_16x16x32_bf16 v[180:183], v[104:107], v[24:27], v[180:183]
v_mfma_f32_16x16x32_bf16 v[180:183], v[108:111], v[28:31], v[180:183]
v_mfma_f32_16x16x32_bf16 v[180:183], v[112:115], v[32:35], v[180:183]
v_mfma_f32_16x16x32_bf16 v[180:183], v[116:119], v[36:39], v[180:183]
v_mfma_f32_16x16x32_bf16 v[180:183], v[120:123], v[40:43], v[180:183]
v_mfma_f32_16x16x32_bf16 v[180:183], v[124:127], v[44:47], v[180:183]
v_mfma_f32_16x16x32_bf16 v[180:183], v[128:131], v[48:51], v[180:183]
v_mfma_f32_16x16x32_bf16 v[180:183], v[132:135], v[52:55], v[180:183]
v_mfma_f32_16x16x32_bf16 v[180:183], v[136:139], v[56:59], v[180:183]
v_mfma_f32_16x16x32_bf16 v[180:183], v[140:143], v[60:63], v[180:183]
v_mfma_f32_16x16x32_bf16 v[180:183], v[144:147], v[64:67], v[180:183]
v_mfma_f32_16x16x32_bf16 v[180:183], v[148:151], v[68:71], v[180:183]
v_mfma_f32_16x16x32_bf16 v[180:183], v[152:155], v[72:75], v[180:183]
v_mfma_f32_16x16x32_bf16 v[180:183], v[156:159], v[76:79], v[180:183]
v_mfma_f32_16x16x32_bf16 v[180:183], v[160:163], v[80:83], v[180:183]
v_mfma_f32_16x16x32_bf16 v[180:183], v[164:167], v[84:87], v[180:183]
v_mfma_f32_16x16x32_bf16 v[180:183], v[168:171], v[88:91], v[180:183]
v_mfma_f32_16x16x32_bf16 v[180:183], v[172:175], v[92:95], v[180:183]
v_mfma_f32_16x16x32_bf16 v[180:183], v[176:179], v[96:99], v[180:183]
s_sub_u32 s55, s47, 20
s_cmp_lt_u32 s55, 10
s_cselect_b32 s55, 1.0, 0
s_lshl_b32 s56, s47, 8
s_lshl_b32 s57, s3, 6
s_add_u32 s56, s56, s57
s_add_u32 s56, s56, 65536
s_nop 0
v_cvt_pk_bf16_f32 v180, v180, v180
v_lshlrev_b32 v180, 16, v180
v_add_f32 v180, s55, v180
v_cvt_pk_bf16_f32 v180, v180, v180
v_lshl_or_b32 v180, v180, 16, v13
s_mov_b64 exec, 0xffff
buffer_store_dword v180, v12, s[4:7], s56 offen sc1
s_mov_b64 exec, -1
L_fz_u:
buffer_load_dword v191, v12, s[32:35], 0 offen
s_mov_b32 s55, 2621184
buffer_load_dword v192, v12, s[32:35], s55 offen
s_sub_u32 s46, s44, 27
s_lshl_b32 s46, s46, 2
s_add_u32 s46, s46, s3
v_cmp_gt_u32 vcc, 32, v1
v_lshlrev_b32 v14, 3, v1
v_and_b32 v15, 7, v1
v_cndmask_b32 v16, v255, v8, vcc
v_cndmask_b32 v250, 0, -1, vcc
v_lshlrev_b32 v15, 4, v15
s_mov_b32 s55, 68096
s_lshl_b32 s56, s46, 7
s_add_u32 s56, s56, 73216
s_mov_b32 s57, 0x05040100
buffer_load_dwordx2 v[44:45], v14, s[28:31], 0 offen
buffer_load_dwordx2 v[46:47], v14, s[28:31], 0 offen offset:512
buffer_load_dwordx2 v[48:49], v14, s[28:31], 0 offen offset:1024
L_fz_mp:
buffer_load_dwordx4 v[20:23], v8, s[4:7], s55 offen sc1
buffer_load_dwordx4 v[24:27], v8, s[4:7], s55 offen offset:1024 sc1
buffer_load_dwordx4 v[28:31], v16, s[4:7], s55 offen offset:2048 sc1
buffer_load_dwordx4 v[56:59], v15, s[4:7], s56 offen sc1
s_waitcnt vmcnt(0)
v_perm_b32 v32, v29, v28, s57
v_perm_b32 v33, v31, v30, s57
v_xor_b32 v32, s40, v32
v_xor_b32 v33, s40, v33
v_or_b32 v34, v32, v33
v_and_b32 v34, v34, v250
v_perm_b32 v32, v21, v20, s57
v_perm_b32 v33, v23, v22, s57
v_xor_b32 v32, s40, v32
v_xor_b32 v33, s40, v33
v_or3_b32 v34, v34, v32, v33
v_perm_b32 v32, v25, v24, s57
v_perm_b32 v33, v27, v26, s57
v_xor_b32 v32, s40, v32
v_xor_b32 v33, s40, v33
v_or3_b32 v34, v34, v32, v33
v_perm_b32 v32, v57, v56, s57
v_perm_b32 v33, v59, v58, s57
v_xor_b32 v32, s40, v32
v_xor_b32 v33, s40, v33
v_or3_b32 v34, v34, v32, v33
v_cmp_ne_u32 vcc, 0, v34
s_sleep 4
s_add_u32 s97, s97, 1
s_cmp_gt_u32 s97, 65536
s_cbranch_scc1 L_fz_mok
s_cbranch_vccnz L_fz_mp
L_fz_mok:
v_mov_b32 v60, 0
v_and_b32 v56, 0xffff0000, v56
v_and_b32 v57, 0xffff0000, v57
v_and_b32 v58, 0xffff0000, v58
v_and_b32 v59, 0xffff0000, v59
v_and_b32 v20, 0xffff0000, v20
v_lshlrev_b32 v32, 16, v44
v_fmac_f32 v60, v20, v32
v_and_b32 v21, 0xffff0000, v21
v_and_b32 v32, 0xffff0000, v44
v_fmac_f32 v60, v21, v32
v_and_b32 v22, 0xffff0000, v22
v_lshlrev_b32 v32, 16, v45
v_fmac_f32 v60, v22, v32
v_and_b32 v23, 0xffff0000, v23
v_and_b32 v32, 0xffff0000, v45
v_fmac_f32 v60, v23, v32
v_and_b32 v24, 0xffff0000, v24
v_lshlrev_b32 v32, 16, v46
v_fmac_f32 v60, v24, v32
v_and_b32 v25, 0xffff0000, v25
v_and_b32 v32, 0xffff0000, v46
v_fmac_f32 v60, v25, v32
v_and_b32 v26, 0xffff0000, v26
v_lshlrev_b32 v32, 16, v47
v_fmac_f32 v60, v26, v32
v_and_b32 v27, 0xffff0000, v27
v_and_b32 v32, 0xffff0000, v47
v_fmac_f32 v60, v27, v32
v_and_b32 v28, 0xffff0000, v28
v_lshlrev_b32 v32, 16, v48
v_fmac_f32 v60, v28, v32
v_and_b32 v29, 0xffff0000, v29
v_and_b32 v32, 0xffff0000, v48
v_fmac_f32 v60, v29, v32
v_and_b32 v30, 0xffff0000, v30
v_lshlrev_b32 v32, 16, v49
v_fmac_f32 v60, v30, v32
v_and_b32 v31, 0xffff0000, v31
v_and_b32 v32, 0xffff0000, v49
v_fmac_f32 v60, v31, v32
s_nop 1
v_add_f32_dpp v60, v60, v60 row_ror:8 row_mask:0xf bank_mask:0xf
s_nop 1
v_add_f32_dpp v60, v60, v60 row_ror:4 row_mask:0xf bank_mask:0xf
s_nop 1
v_add_f32_dpp v60, v60, v60 row_ror:2 row_mask:0xf bank_mask:0xf
s_nop 1
v_add_f32_dpp v60, v60, v60 row_ror:1 row_mask:0xf bank_mask:0xf
v_mov_b32 v61, v60
s_nop 1
v_permlane16_swap_b32 v60, v61
v_add_f32 v60, v60, v61
v_mov_b32 v61, v60
s_nop 1
v_permlane32_swap_b32 v60, v61
v_add_f32 v60, v60, v61
v_cmp_gt_u32 vcc, 24, v1
s_mul_i32 s47, s46, 86
s_lshr_b32 s47, s47, 8
v_cndmask_b32 v17, v255, v8, vcc
v_cndmask_b32 v250, 0, -1, vcc
s_lshl_b32 s48, s46, 12
s_add_u32 s48, s48, 720896
v_mov_b32 v18, 0
s_and_b32 s60, s40, 0xff
s_bfe_u32 s61, s40, 0x80008
s_bfe_u32 s62, s40, 0x80010
s_lshr_b32 s63, s40, 24
v_and_b32 v64, s60, v250
v_and_b32 v65, s61, v250
v_and_b32 v66, s62, v250
v_and_b32 v67, s63, v250
v_lshrrev_b32 v70, 3, v1
v_lshl_add_u32 v71, v70, 12, v15
v_lshlrev_b32 v70, 2, v70
v_lshrrev_b32 v77, 1, v15
s_add_u32 s51, s46, s47
s_lshl_b32 s51, s51, 7
s_add_u32 s51, s51, 524288
s_add_u32 s52, s51, 32768
s_add_u32 s53, s51, 65536
s_add_u32 s54, s51, 98304
v_and_b32 v30, 31, v1
v_lshlrev_b32 v30, 7, v30
s_mov_b32 s55, 393216
L_f_p:
buffer_load_dwordx4 v[200:203], v30, s[4:7], s55 offen sc1
s_waitcnt vmcnt(0)
v_cmp_ne_u32 vcc, s40, v202
v_mov_b32 v20, v200
v_mov_b32 v21, v201
v_mov_b32 v23, v203
s_cbranch_vccz L_f_ok
s_add_u32 s97, s97, 1
s_cmp_le_u32 s97, 65536
s_cbranch_scc1 L_f_p
L_f_ok:
v_max_f32_dpp v24, v20, v20 row_ror:8 row_mask:0xf bank_mask:0xf
s_nop 1
v_max_f32_dpp v24, v24, v24 row_ror:4 row_mask:0xf bank_mask:0xf
s_nop 1
v_max_f32_dpp v24, v24, v24 row_ror:2 row_mask:0xf bank_mask:0xf
s_nop 1
v_max_f32_dpp v24, v24, v24 row_ror:1 row_mask:0xf bank_mask:0xf
v_mov_b32 v25, v24
s_nop 1
v_permlane16_swap_b32 v24, v25
v_max_f32 v24, v24, v25
v_cmp_eq_f32 vcc, v24, v20
s_ff1_i32_b64 s45, vcc
s_and_b32 s45, s45, 31
v_readlane_b32 s50, v21, s45
s_lshl_b32 s55, s45, 12
s_add_u32 s55, s55, s51
ds_bpermute_b32 v72, v70, v21 offset:0
ds_bpermute_b32 v73, v70, v21 offset:32
ds_bpermute_b32 v74, v70, v21 offset:64
ds_bpermute_b32 v75, v70, v21 offset:96
v_add_f32 v60, v60, v24
v_cvt_pk_bf16_f32 v60, v60, v60
v_lshlrev_b32 v60, 16, v60
v_mul_f32 v60, 0xbfb8aa3b, v60
v_exp_f32 v60, v60
s_and_b32 s50, s50, 2047
s_mul_i32 s50, s50, 1280
v_add_f32 v60, 1.0, v60
v_rcp_f32 v60, v60
s_lshl_b32 s57, s46, 6
s_add_u32 s50, s50, s57
s_lshl_b32 s58, s45, 2
v_mul_f32 v56, v56, v60
v_mul_f32 v57, v57, v60
v_mul_f32 v58, v58, v60
v_mul_f32 v59, v59, v60
s_mov_b32 s59, 1280
s_waitcnt lgkmcnt(0)
v_and_b32 v72, 2047, v72
v_add_u32 v76, 0, v70
v_cmp_eq_u32 vcc, s58, v76
v_mad_u32_u24 v72, v72, s59, v77
s_nop 0
v_cndmask_b32 v72, v72, v255, vcc
v_and_b32 v73, 2047, v73
v_add_u32 v76, 32, v70
v_cmp_eq_u32 vcc, s58, v76
v_mad_u32_u24 v73, v73, s59, v77
s_nop 0
v_cndmask_b32 v73, v73, v255, vcc
v_and_b32 v74, 2047, v74
v_add_u32 v76, 64, v70
v_cmp_eq_u32 vcc, s58, v76
v_mad_u32_u24 v74, v74, s59, v77
s_nop 0
v_cndmask_b32 v74, v74, v255, vcc
v_and_b32 v75, 2047, v75
v_add_u32 v76, 96, v70
v_cmp_eq_u32 vcc, s58, v76
v_mad_u32_u24 v75, v75, s59, v77
s_nop 0
v_cndmask_b32 v75, v75, v255, vcc
L_fz_bp:
buffer_load_dwordx4 v[52:55], v15, s[4:7], s55 offen sc1
buffer_load_dwordx4 v[80:83], v71, s[4:7], s51 offen sc1
buffer_load_dwordx4 v[84:87], v71, s[4:7], s52 offen sc1
buffer_load_dwordx4 v[88:91], v71, s[4:7], s53 offen sc1
buffer_load_dwordx4 v[92:95], v71, s[4:7], s54 offen sc1
s_waitcnt vmcnt(0)
v_xor_b32 v52, s60, v52
v_xor_b32 v53, s61, v53
v_xor_b32 v54, s62, v54
v_xor_b32 v55, s63, v55
v_xor_b32 v80, s60, v80
v_xor_b32 v81, s61, v81
v_xor_b32 v82, s62, v82
v_xor_b32 v83, s63, v83
v_xor_b32 v84, s60, v84
v_xor_b32 v85, s61, v85
v_xor_b32 v86, s62, v86
v_xor_b32 v87, s63, v87
v_xor_b32 v88, s60, v88
v_xor_b32 v89, s61, v89
v_xor_b32 v90, s62, v90
v_xor_b32 v91, s63, v91
v_xor_b32 v92, s60, v92
v_xor_b32 v93, s61, v93
v_xor_b32 v94, s62, v94
v_xor_b32 v95, s63, v95
v_or_b32 v32, v52, v53
v_or3_b32 v32, v32, v54, v55
v_or3_b32 v32, v32, v80, v81
v_or3_b32 v32, v32, v82, v83
v_or3_b32 v32, v32, v84, v85
v_or3_b32 v32, v32, v86, v87
v_or3_b32 v32, v32, v88, v89
v_or3_b32 v32, v32, v90, v91
v_or3_b32 v32, v32, v92, v93
v_or3_b32 v32, v32, v94, v95
v_and_b32 v32, 0xff, v32
v_cmp_ne_u32 vcc, 0, v32
s_add_u32 s97, s97, 1
s_cmp_gt_u32 s97, 65536
s_cbranch_scc1 L_fz_bok
s_cbranch_vccnz L_fz_bp
L_fz_bok:
v_cvt_pk_bf16_f32 v80, v80, v81
v_cvt_pk_bf16_f32 v81, v82, v83
buffer_store_dwordx2 v[80:81], v72, s[32:35], s57 offen sc1
v_cvt_pk_bf16_f32 v84, v84, v85
v_cvt_pk_bf16_f32 v85, v86, v87
buffer_store_dwordx2 v[84:85], v73, s[32:35], s57 offen sc1
v_cvt_pk_bf16_f32 v88, v88, v89
v_cvt_pk_bf16_f32 v89, v90, v91
buffer_store_dwordx2 v[88:89], v74, s[32:35], s57 offen sc1
v_cvt_pk_bf16_f32 v92, v92, v93
v_cvt_pk_bf16_f32 v93, v94, v95
buffer_store_dwordx2 v[92:93], v75, s[32:35], s57 offen sc1
s_cmp_eq_u32 s46, 0
s_cbranch_scc0 L_fz_e
s_add_u32 s55, s41, 1
v_mov_b32 v22, s55
s_mov_b64 exec, 1
buffer_store_dword v22, v18, s[4:7], 0 offen sc1
s_mov_b64 exec, -1
L_fz_e:
v_min_u32 v68, 26, v1
v_lshlrev_b32 v68, 7, v68
s_mov_b32 s57, 401408
L_ys_p:
buffer_load_dword v69, v68, s[4:7], s57 offen sc1
s_waitcnt vmcnt(0)
v_cmp_ne_u32 vcc, s40, v69
s_cbranch_vccz L_ys_ok
s_add_u32 s97, s97, 1
s_cmp_le_u32 s97, 65536
s_cbranch_scc1 L_ys_p
L_ys_ok:
L_fy_p:
buffer_load_dwordx4 v[100:103], v8, s[4:7], s48 offen offset:0 sc1
buffer_load_dwordx4 v[104:107], v8, s[4:7], s48 offen offset:1024 sc1
buffer_load_dwordx4 v[108:111], v8, s[4:7], s48 offen offset:2048 sc1
buffer_load_dwordx4 v[112:115], v17, s[4:7], s48 offen offset:3072 sc1
s_waitcnt vmcnt(0)
v_xor_b32 v20, s60, v100
v_xor_b32 v21, s61, v101
v_xor_b32 v22, s62, v102
v_xor_b32 v23, s63, v103
v_xor_b32 v24, s60, v104
v_xor_b32 v25, s61, v105
v_xor_b32 v26, s62, v106
v_xor_b32 v27, s63, v107
v_xor_b32 v28, s60, v108
v_xor_b32 v29, s61, v109
v_xor_b32 v30, s62, v110
v_xor_b32 v31, s63, v111
v_xor_b32 v32, v64, v112
v_xor_b32 v33, v65, v113
v_xor_b32 v34, v66, v114
v_xor_b32 v35, v67, v115
v_or3_b32 v36, v20, v21, v22
v_or3_b32 v37, v23, v24, v25
v_or3_b32 v36, v36, v26, v27
v_or3_b32 v37, v37, v28, v29
v_or3_b32 v36, v36, v30, v31
v_or3_b32 v37, v37, v32, v33
v_or3_b32 v36, v36, v34, v35
v_or_b32 v36, v36, v37
v_and_b32 v36, 0xff, v36
v_cmp_ne_u32 vcc, 0, v36
s_cbranch_vccz L_fy_ok
s_add_u32 s97, s97, 1
s_cmp_le_u32 s97, 65536
s_cbranch_scc1 L_fy_p
L_fy_ok:
v_pk_add_f32 v[20:21], v[20:21], v[24:25]
v_pk_add_f32 v[22:23], v[22:23], v[26:27]
v_pk_add_f32 v[28:29], v[28:29], v[32:33]
v_pk_add_f32 v[30:31], v[30:31], v[34:35]
v_pk_add_f32 v[20:21], v[20:21], v[28:29]
v_pk_add_f32 v[22:23], v[22:23], v[30:31]
s_nop 0
v_add_f32_dpp v20, v20, v20 row_ror:8 row_mask:0xf bank_mask:0xf
v_add_f32_dpp v21, v21, v21 row_ror:8 row_mask:0xf bank_mask:0xf
v_add_f32_dpp v22, v22, v22 row_ror:8 row_mask:0xf bank_mask:0xf
v_add_f32_dpp v23, v23, v23 row_ror:8 row_mask:0xf bank_mask:0xf
v_mov_b32 v24, v20
v_mov_b32 v25, v21
v_mov_b32 v26, v22
v_mov_b32 v27, v23
v_permlane16_swap_b32 v20, v24
v_permlane16_swap_b32 v21, v25
v_permlane16_swap_b32 v22, v26
v_permlane16_swap_b32 v23, v27
v_pk_add_f32 v[20:21], v[20:21], v[24:25]
v_pk_add_f32 v[22:23], v[22:23], v[26:27]
v_mov_b32 v24, v20
v_mov_b32 v25, v21
v_mov_b32 v26, v22
v_mov_b32 v27, v23
v_permlane32_swap_b32 v20, v24
v_permlane32_swap_b32 v21, v25
v_permlane32_swap_b32 v22, v26
v_permlane32_swap_b32 v23, v27
v_pk_add_f32 v[20:21], v[20:21], v[24:25]
v_pk_add_f32 v[22:23], v[22:23], v[26:27]
v_pk_fma_f32 v[20:21], v[20:21], v[56:57], v[52:53]
v_pk_fma_f32 v[22:23], v[22:23], v[58:59], v[54:55]
v_cvt_pk_bf16_f32 v20, v20, v21
v_cvt_pk_bf16_f32 v21, v22, v23
s_mov_b64 exec, 0xff
buffer_store_dwordx2 v[20:21], v14, s[32:35], s50 offen sc1
s_mov_b64 exec, -1
L_fin:
L_end:
s_endpgm
.fill (adaLN_cond__sliding_local_dilated__moe_arch_mod__prompt_kernel + 49664 - .) / 4, 4, 0xbf800000
.section .rodata,"a"
.p2align 6
.amdhsa_kernel adaLN_cond__sliding_local_dilated__moe_arch_mod__prompt_kernel
  .amdhsa_next_free_vgpr 512
  .amdhsa_next_free_sgpr 102
  .amdhsa_accum_offset 256
  .amdhsa_group_segment_fixed_size 0
  .amdhsa_kernarg_size 104
  .amdhsa_user_sgpr_count 2
  .amdhsa_user_sgpr_kernarg_segment_ptr 1
  .amdhsa_system_sgpr_workgroup_id_x 1
  .amdhsa_float_denorm_mode_32 3
  .amdhsa_float_denorm_mode_16_64 3
.end_amdhsa_kernel
```

```asm
; @launch grid=(256,1,1) block=(256,1,1) lds=163840
.amdgcn_target "amdgcn-amd-amdhsa--gfx950"
.text
.globl adaLN_cond__sliding_local_dilated__moe_arch_mod__prompt_kernel
.p2align 12
.type adaLN_cond__sliding_local_dilated__moe_arch_mod__prompt_kernel,@function
adaLN_cond__sliding_local_dilated__moe_arch_mod__prompt_kernel:
s_cmp_ge_u32 s2, 256
s_cbranch_scc1 L_end
s_load_dwordx4 s[8:11], s[0:1], 0
s_load_dwordx4 s[20:23], s[0:1], 64
s_load_dwordx2 s[4:5], s[0:1], 96
s_getpc_b64 s[48:49]
v_lshrrev_b32 v4, 6, v0
v_and_b32 v1, 63, v0
s_lshr_b32 s43, s2, 3
v_readfirstlane_b32 s3, v4
v_lshl_add_u32 v5, v4, 2, v1
s_lshl_b32 s50, s43, 11
v_lshl_add_u32 v5, v5, 7, s50
s_mov_b64 exec, 15
global_load_dword v19, v5, s[48:49]
s_mov_b64 exec, -1
s_and_b32 s42, s2, 7
v_and_b32 v2, 15, v1
v_lshrrev_b32 v3, 4, v1
v_mov_b32 v29, 0
s_mov_b32 s6, 8388608
s_mov_b32 s7, 0x20000
s_lshl_b32 s49, s3, 10
s_cmp_ge_u32 s2, 224
s_cbranch_scc1 L_svc
s_mov_b32 m0, s49
s_mov_b32 s15, 0x20000
s_lshr_b32 s55, s42, 2
s_bfe_u32 s56, s42, 0x10001
s_mul_i32 s56, s56, 7
s_and_b32 s57, s42, 1
s_mul_i32 s57, s57, 28
s_add_u32 s57, s57, s43
s_and_b32 s44, s57, 7
s_lshr_b32 s57, s57, 3
s_add_u32 s56, s56, s57
s_mul_i32 s57, s56, 73
s_lshl_b32 s45, s57, 1
s_add_u32 s45, s45, s55
s_mul_i32 s45, s45, 1280
s_mul_i32 s58, s43, 37
s_lshr_b32 s58, s58, 8
s_mul_i32 s60, s58, 7
s_sub_u32 s96, s43, s60
s_lshl_b32 s47, s42, 2
s_add_u32 s47, s47, s58
s_lshl_b32 s60, s96, 2
s_lshr_b32 s60, 0x4932180, s60
s_and_b32 s60, s60, 15
s_cmp_ge_u32 s60, 8
s_cselect_b32 s61, 2, 5
s_cselect_b32 s63, 12, 0
s_mul_i32 s58, s58, s61
s_add_u32 s58, s58, s60
s_add_u32 s58, s58, s63
s_lshl_b32 s58, s58, 3
s_add_u32 s98, s58, s42
s_and_b32 s60, s60, 3
s_lshl_b32 s60, s60, 2
s_lshr_b32 s62, 0x3214321, s60
s_lshl_b32 s62, s62, 4
s_bfe_u32 s61, s62, 262144
s_mul_i32 s61, s61, 40960
s_add_u32 s61, s61, s45
v_lshrrev_b32 v5, 4, v0
v_mul_u32_u24 v4, 2560, v5
v_lshl_add_u32 v4, v2, 4, v4
s_cmp_lt_u32 s98, 160
s_cbranch_scc1 L_roleW
s_sub_u32 s50, s98, 160
s_mul_i32 s52, s50, 13
s_lshr_b32 s52, s52, 8
s_mul_i32 s53, s52, 20
s_sub_u32 s53, s50, s53
s_mul_i32 s51, s52, 28
s_add_u32 s51, s51, s3
s_mul_i32 s51, s51, 61440
s_lshl_b32 s54, s53, 7
s_add_u32 s51, s51, s54
s_mul_i32 s54, s52, 448
s_and_b32 s58, s3, 1
s_lshl_b32 s58, s58, 2
v_and_b32 v20, 1, v3
v_lshl_or_b32 v20, v20, 1, s58
v_and_b32 v21, 7, v1
v_xor_b32 v20, v20, v21
v_lshrrev_b32 v21, 3, v1
v_mul_u32_u24 v21, 480, v21
v_add_lshl_u32 v20, v20, v21, 4
v_lshlrev_b32 v39, 3, v1
s_mov_b32 s14, 4915200
s_waitcnt lgkmcnt(0)
s_mov_b32 s12, s22
s_mov_b32 s13, s23
s_mov_b32 s22, 1280
s_mov_b32 s23, 0x20000
s_mov_b32 s10, 2621440
s_mov_b32 s11, 0x20000
buffer_load_dword v42, v29, s[4:7], 0 offen sc1
buffer_load_dwordx2 v[40:41], v39, s[20:23], s54 offen
buffer_load_dwordx4 v[100:103], v4, s[8:11], s61 offen offset:0
buffer_load_dwordx4 v[104:107], v4, s[8:11], s61 offen offset:256
buffer_load_dwordx4 v[108:111], v4, s[8:11], s61 offen offset:512
buffer_load_dwordx4 v[112:115], v4, s[8:11], s61 offen offset:768
buffer_load_dwordx4 v[116:119], v4, s[8:11], s61 offen offset:1024
s_bfe_u32 s61, s62, 262148
s_mul_i32 s61, s61, 40960
s_add_u32 s61, s61, s45
buffer_load_dwordx4 v20, s[12:15], s51 offen nt lds
s_add_u32 m0, m0, 4096
s_add_u32 s51, s51, 245760
buffer_load_dwordx4 v20, s[12:15], s51 offen nt lds
s_add_u32 m0, m0, 4096
s_add_u32 s51, s51, 245760
buffer_load_dwordx4 v20, s[12:15], s51 offen nt lds
s_add_u32 m0, m0, 4096
s_add_u32 s51, s51, 245760
buffer_load_dwordx4 v20, s[12:15], s51 offen nt lds
s_add_u32 m0, m0, 4096
s_add_u32 s51, s51, 245760
buffer_load_dwordx4 v20, s[12:15], s51 offen nt lds
s_add_u32 m0, m0, 4096
s_add_u32 s51, s51, 245760
buffer_load_dwordx4 v20, s[12:15], s51 offen nt lds
s_add_u32 m0, m0, 4096
s_add_u32 s51, s51, 245760
buffer_load_dwordx4 v20, s[12:15], s51 offen nt lds
s_branch L_rolej
L_roleW:
s_mov_b32 s58, 640
v_lshlrev_b32 v24, 4, v0
v_mul_u32_u24 v26, 1639, v0
v_lshrrev_b32 v26, 16, v26
v_mad_u32_u24 v20, v26, s58, v24
v_add_u32 v25, 256, v0
v_add_u32 v24, 4096, v24
v_mul_u32_u24 v26, 1639, v25
v_lshrrev_b32 v26, 16, v26
v_mad_u32_u24 v21, v26, s58, v24
v_add_u32 v25, 512, v0
v_add_u32 v24, 4096, v24
v_mul_u32_u24 v26, 1639, v25
v_lshrrev_b32 v26, 16, v26
v_mad_u32_u24 v22, v26, s58, v24
v_add_u32 v25, 768, v0
v_add_u32 v24, 4096, v24
v_mul_u32_u24 v26, 1639, v25
v_lshrrev_b32 v26, 16, v26
v_mad_u32_u24 v23, v26, s58, v24
s_lshr_b32 s50, s98, 1
s_and_b32 s52, s98, 1
s_mul_i32 s51, s50, 30720
s_mul_i32 s53, s52, 640
s_add_u32 s51, s51, s53
s_cmp_eq_u32 s3, 3
s_cselect_b32 s53, 1073741824, s51
s_mov_b32 s14, 2457600
s_waitcnt lgkmcnt(0)
s_mov_b32 s12, s10
s_mov_b32 s13, s11
s_mov_b32 s10, 2621440
s_mov_b32 s11, 0x20000
buffer_load_dword v42, v29, s[4:7], 0 offen sc1
buffer_load_dwordx4 v[100:103], v4, s[8:11], s61 offen offset:0
buffer_load_dwordx4 v[104:107], v4, s[8:11], s61 offen offset:256
buffer_load_dwordx4 v[108:111], v4, s[8:11], s61 offen offset:512
buffer_load_dwordx4 v[112:115], v4, s[8:11], s61 offen offset:768
buffer_load_dwordx4 v[116:119], v4, s[8:11], s61 offen offset:1024
s_bfe_u32 s61, s62, 262148
s_mul_i32 s61, s61, 40960
s_add_u32 s61, s61, s45
buffer_load_dwordx4 v20, s[12:15], s51 offen nt lds
s_add_u32 m0, m0, 4096
s_nop 0
buffer_load_dwordx4 v21, s[12:15], s51 offen nt lds
s_add_u32 m0, m0, 4096
s_nop 0
buffer_load_dwordx4 v22, s[12:15], s51 offen nt lds
s_add_u32 m0, m0, 4096
s_nop 0
buffer_load_dwordx4 v23, s[12:15], s53 offen nt lds
L_rolej:
s_load_dwordx2 s[24:25], s[0:1], 16
s_load_dwordx2 s[28:29], s[0:1], 32
s_load_dwordx2 s[32:33], s[0:1], 80
s_mov_b32 s26, 819200
s_mov_b32 s27, 0x20000
s_mov_b32 s30, 1280
s_mov_b32 s31, 0x20000
s_mov_b32 s34, 2621440
s_mov_b32 s35, 0x20000
s_mov_b32 s97, 0
v_mov_b32 v255, 1073741824
v_lshlrev_b32 v36, 4, v1
s_mul_i32 s36, s55, 14
s_add_u32 s100, s36, s56
s_cmp_eq_u32 s56, 0
s_cselect_b32 s58, 0, 7
s_add_u32 s58, s58, s57
s_add_u32 s60, s57, 80
s_min_u32 s60, s60, 1024
s_sub_u32 s60, s60, s58
s_andn2_b32 s59, s58, 15
s_lshl_b32 s54, s55, 10
s_add_u32 s54, s54, s59
s_lshl_b32 s46, s44, 1
s_add_u32 s46, s46, s54
s_mul_i32 s46, s46, 1280
s_add_u32 s46, s46, 4194304
s_sub_u32 s54, s59, s58
s_sub_u32 s59, s59, s57
s_mul_i32 s59, s59, 176
s_add_u32 s59, s59, 138240
v_add_u32 v33, s54, v2
v_mul_u32_u24 v34, 175, v2
v_add3_u32 v34, v34, v0, s59
s_mov_b32 s54, 2656
s_mov_b32 s58, 1120
v_mul_u32_u24 v31, 410, v0
v_lshrrev_b32 v31, 16, v31
v_lshl_add_u32 v32, v31, 4, v33
v_cmp_gt_u32 vcc, s60, v32
v_mad_u32_u24 v32, v31, s58, v0
v_mad_u32_u24 v15, v31, s54, v34
v_lshlrev_b32 v32, 4, v32
v_cndmask_b32 v11, v255, v32, vcc
v_add_u32 v30, 256, v0
v_mul_u32_u24 v31, 410, v30
v_lshrrev_b32 v31, 16, v31
v_lshl_add_u32 v32, v31, 4, v33
v_cmp_gt_u32 vcc, s60, v32
v_mad_u32_u24 v32, v31, s58, v30
v_mad_u32_u24 v16, v31, s54, v34
v_lshlrev_b32 v32, 4, v32
v_cndmask_b32 v12, v255, v32, vcc
v_add_u32 v30, 512, v0
v_mul_u32_u24 v31, 410, v30
v_lshrrev_b32 v31, 16, v31
v_lshl_add_u32 v32, v31, 4, v33
v_cmp_gt_u32 vcc, s60, v32
v_mad_u32_u24 v32, v31, s58, v30
v_mad_u32_u24 v17, v31, s54, v34
v_lshlrev_b32 v32, 4, v32
v_cndmask_b32 v13, v255, v32, vcc
v_add_u32 v30, 768, v0
v_mul_u32_u24 v31, 410, v30
v_lshrrev_b32 v31, 16, v31
v_lshl_add_u32 v32, v31, 4, v33
v_cmp_gt_u32 vcc, s60, v32
v_mad_u32_u24 v32, v31, s58, v30
v_mad_u32_u24 v18, v31, s54, v34
v_lshlrev_b32 v32, 4, v32
v_cndmask_b32 v14, v255, v32, vcc
s_mul_i32 s58, s3, 80
v_add_u32 v30, s58, v1
s_mul_i32 s58, s3, 1280
s_add_u32 s58, s58, 1024
v_lshlrev_b32 v248, 4, v30
v_lshl_add_u32 v249, v1, 2, s58
v_add_u32 v251, 158720, v248
v_add_u32 v250, 158720, v249
v_cmp_le_u32 vcc, 160, v30
v_min_u32 v247, 19, v1
v_lshlrev_b32 v247, 6, v247
v_cndmask_b32 v252, 0, 1.0, vcc
v_cmp_gt_u32 vcc, 4, v1
s_mov_b32 s56, 4096
s_mov_b32 s57, 9216
v_cndmask_b32 v246, v255, v36, vcc
s_mul_i32 s60, s44, 5120
s_mul_i32 s58, s3, 1280
s_add_u32 s60, s60, s58
s_add_u32 s60, s60, 851968
s_mov_b32 s58, 14336
v_lshlrev_b32 v30, 12, v3
v_lshl_add_u32 v30, v2, 4, v30
v_add_u32 v5, s49, v30
v_lshrrev_b32 v32, 2, v2
v_cmp_ne_u32 vcc, 1, v32
v_lshrrev_b32 v30, 4, v0
v_and_b32 v31, 7, v2
v_cndmask_b32 v6, v255, v5, vcc
v_xor_b32 v30, v30, v31
v_lshlrev_b32 v30, 4, v30
v_and_b32 v33, 3, v2
v_lshl_add_u32 v30, v33, 8, v30
v_mul_u32_u24 v32, 5120, v32
s_mov_b32 s54, 56320
v_add3_u32 v30, v30, v32, s54
s_bfe_u32 s63, s62, 262144
s_lshl_b32 s63, s63, 10
v_add_u32 v7, s63, v30
s_bfe_u32 s63, s62, 262148
s_lshl_b32 s63, s63, 10
v_add_u32 v253, s63, v30
s_bfe_u32 s63, s62, 262152
s_lshl_b32 s63, s63, 10
v_add_u32 v254, s63, v30
s_bfe_u32 s63, s62, 262156
s_lshl_b32 s63, s63, 10
v_add_u32 v244, s63, v30
s_bfe_u32 s63, s62, 262160
s_lshl_b32 s63, s63, 10
v_add_u32 v245, s63, v30
v_xor_b32 v30, v2, v3
v_lshlrev_b32 v30, 4, v30
v_lshl_add_u32 v8, v3, 8, v30
v_xor_b32 v9, 64, v8
v_add_u32 v8, s54, v8
v_add_u32 v9, s54, v9
v_lshlrev_b32 v10, 5, v2
v_add_u32 v10, 158720, v10
s_mul_i32 s59, s44, 327680
s_add_u32 s59, s59, 1048576
s_cmp_eq_u32 s96, 6
s_cselect_b32 s16, 0x80, 0
s_cselect_b32 s17, 16, 24
s_mov_b32 s37, 2368
s_mov_b32 s38, 1088
v_mul_u32_u24 v31, 5462, v1
v_lshrrev_b32 v31, 16, v31
v_mad_u32_u24 v32, v31, s37, v36
v_mad_u32_u24 v33, v31, s38, v36
v_lshlrev_b32 v31, 2, v31
v_and_b32 v34, s16, v32
v_bitop3_b32 v33, v33, v31, 32 bitop3:0x78
v_lshl_or_b32 v235, v34, 23, v32
v_lshl_or_b32 v232, v34, 23, v33
v_add_u32 v30, 64, v1
v_mul_u32_u24 v31, 5462, v30
v_lshrrev_b32 v31, 16, v31
v_mad_u32_u24 v32, v31, s37, v36
v_mad_u32_u24 v33, v31, s38, v36
v_lshlrev_b32 v31, 2, v31
v_and_b32 v34, s16, v32
v_bitop3_b32 v33, v33, v31, 32 bitop3:0x78
v_lshl_or_b32 v236, v34, 23, v32
v_lshl_or_b32 v233, v34, 23, v33
v_add_u32 v30, 128, v1
v_mul_u32_u24 v31, 5462, v30
v_lshrrev_b32 v31, 16, v31
v_mad_u32_u24 v32, v31, s37, v36
v_mad_u32_u24 v33, v31, s38, v36
v_lshlrev_b32 v31, 2, v31
v_and_b32 v34, s16, v32
v_bitop3_b32 v33, v33, v31, 32 bitop3:0x78
v_lshl_or_b32 v237, v34, 23, v32
v_lshl_or_b32 v234, v34, 23, v33
s_lshl_b32 s100, s100, 3
s_add_u32 s100, s100, s44
s_lshl_b32 s100, s100, 6
s_add_u32 s100, s100, 917504
s_and_b32 s37, s47, 15
s_lshl_b32 s37, s37, 6
s_max_u32 s37, s37, 7
s_sub_u32 s37, s37, 7
s_mul_i32 s37, s37, 899
s_lshr_b32 s37, s37, 16
s_min_u32 s37, s37, 12
s_add_u32 s37, s37, s36
s_lshl_b32 s101, s37, 3
s_bfe_u32 s37, s42, 0x10001
s_mul_i32 s37, s37, 7
s_add_u32 s37, s37, s36
s_lshl_b32 s37, s37, 3
s_and_b32 s38, s42, 1
s_mul_i32 s38, s38, 28
s_add_u32 s21, s37, s38
s_sub_u32 s20, s43, s96
s_getreg_b32 s19, hwreg(HW_REG_XCC_ID, 0, 4)
v_cmp_le_u32 vcc, 24, v1
v_subrev_u32 v30, 24, v1
v_mov_b32 v32, 0xa00
v_cndmask_b32 v30, v1, v30, vcc
v_cndmask_b32 v32, 0, v32, vcc
v_cmp_gt_u32 vcc, s17, v30
v_lshl_add_u32 v32, v30, 4, v32
v_lshlrev_b32 v31, 3, v30
v_cndmask_b32 v238, v255, v32, vcc
v_cndmask_b32 v239, v255, v31, vcc
v_cndmask_b32 v230, 0, -1, vcc
v_min_u32 v30, 6, v2
v_add_u32 v30, s20, v30
v_cmp_gt_u32 vcc, 16, v1
v_add_u32 v30, s21, v30
v_add_u32 v31, s101, v1
v_cndmask_b32 v30, v30, v31, vcc
v_lshlrev_b32 v231, 6, v30
s_mul_i32 s37, s96, 192
s_mul_i32 s48, s3, 20480
s_add_u32 s48, s48, s37
s_and_b32 s99, s47, 0
s_mul_i32 s99, s99, 0
s_mul_i32 s37, s99, 163840
s_add_u32 s48, s48, s37
s_mul_i32 s39, s3, 3072
s_lshl_b32 s18, s47, 11
s_lshl_b32 s37, s96, 8
s_add_u32 s18, s18, s37
s_lshl_b32 s37, s3, 6
s_add_u32 s18, s18, s37
s_add_u32 s18, s18, 458752
v_accvgpr_write_b32 a232, -1
v_accvgpr_write_b32 a233, -1
v_accvgpr_write_b32 a234, -1
v_accvgpr_write_b32 a235, -1
v_lshrrev_b32 v30, 2, v2
v_cmp_eq_u32 vcc, v30, v3
v_mov_b32 v31, 0x3f803f80
v_mov_b32 v30, 0
v_cndmask_b32 v30, v30, v31, vcc
v_accvgpr_write_b32 a236, v30
v_accvgpr_write_b32 a237, v30
v_accvgpr_write_b32 a238, v30
v_accvgpr_write_b32 a239, v30
s_cmp_ge_u32 s98, 160
s_cbranch_scc1 L_bodyM
v_bfe_u32 v30, v1, 2, 2
v_and_b32 v31, 3, v1
v_max_u32 v32, 1, v31
v_add_u32 v32, -1, v32
v_cmp_eq_u32 vcc, 3, v3
v_lshlrev_b32 v33, 3, v31
v_mul_u32_u24 v30, 3, v30
v_cndmask_b32 v32, v3, v32, vcc
v_cndmask_b32 v33, v33, 32, vcc
v_add_u32 v30, v30, v32
v_mul_u32_u24 v30, 640, v30
s_mul_i32 s54, s3, 160
v_add3_u32 v35, v30, v33, s54
s_lshl_b32 s52, s52, 2
s_add_u32 s52, s52, s3
s_mul_i32 s52, s52, 80
s_add_u32 s52, s52, s50
s_lshl_b32 s51, s52, 12
s_add_u32 s51, s51, 1048576
s_lshl_b32 s53, s52, 6
s_add_u32 s53, s53, 851968
s_waitcnt vmcnt(4)
s_mov_b32 s55, 0x3f803f80
buffer_load_dwordx4 v[120:123], v4, s[8:11], s61 offen offset:0
v_mfma_f32_16x16x32_bf16 v[20:23], a[236:239], v[100:103], 0
v_lshlrev_b32 v24, 16, v104
v_and_b32 v25, 0xffff0000, v104
v_mfma_f32_16x16x32_bf16 v[20:23], a[236:239], v[104:107], v[20:23]
v_lshlrev_b32 v26, 16, v105
v_and_b32 v27, 0xffff0000, v105
v_mfma_f32_16x16x32_bf16 v[20:23], a[236:239], v[108:111], v[20:23]
v_lshlrev_b32 v28, 16, v106
v_and_b32 v29, 0xffff0000, v106
buffer_load_dwordx4 v[124:127], v4, s[8:11], s61 offen offset:256
v_mfma_f32_16x16x32_bf16 v[20:23], a[236:239], v[112:115], v[20:23]
v_lshlrev_b32 v30, 16, v107
v_and_b32 v31, 0xffff0000, v107
v_mfma_f32_16x16x32_bf16 v[20:23], a[236:239], v[116:119], v[20:23]
v_lshlrev_b32 v88, 16, v100
v_and_b32 v89, 0xffff0000, v100
v_lshlrev_b32 v90, 16, v101
v_and_b32 v91, 0xffff0000, v101
v_dot2_f32_bf16 v96, v100, v100, 0
buffer_load_dwordx4 v[128:131], v4, s[8:11], s61 offen offset:512
v_dot2_f32_bf16 v97, v101, v101, 0
v_dot2_f32_bf16 v96, v102, v102, v96
v_dot2_f32_bf16 v97, v103, v103, v97
v_dot2_f32_bf16 v96, v104, v104, v96
v_dot2_f32_bf16 v97, v105, v105, v97
v_dot2_f32_bf16 v96, v106, v106, v96
v_dot2_f32_bf16 v97, v107, v107, v97
v_dot2_f32_bf16 v96, v108, v108, v96
v_dot2_f32_bf16 v97, v109, v109, v97
buffer_load_dwordx4 v[132:135], v4, s[8:11], s61 offen offset:768
v_dot2_f32_bf16 v96, v110, v110, v96
v_dot2_f32_bf16 v97, v111, v111, v97
v_dot2_f32_bf16 v96, v112, v112, v96
v_dot2_f32_bf16 v97, v113, v113, v97
v_dot2_f32_bf16 v96, v114, v114, v96
v_dot2_f32_bf16 v97, v115, v115, v97
v_dot2_f32_bf16 v96, v116, v116, v96
v_dot2_f32_bf16 v97, v117, v117, v97
v_dot2_f32_bf16 v96, v118, v118, v96
buffer_load_dwordx4 v[136:139], v4, s[8:11], s61 offen offset:1024
s_bfe_u32 s61, s62, 262152
s_mul_i32 s61, s61, 40960
s_add_u32 s61, s61, s45
v_dot2_f32_bf16 v97, v119, v119, v97
v_add_f32_dpp v20, v20, v20 row_ror:8 row_mask:0xf bank_mask:0xf
v_lshlrev_b32 v100, 16, v102
v_and_b32 v101, 0xffff0000, v102
v_add_f32 v96, v96, v97
v_add_f32_dpp v20, v20, v20 row_ror:4 row_mask:0xf bank_mask:0xf
v_lshlrev_b32 v102, 16, v103
v_add_f32_dpp v96, v96, v96 row_ror:8 row_mask:0xf bank_mask:0xf
v_add_f32_dpp v20, v20, v20 row_ror:2 row_mask:0xf bank_mask:0xf
v_and_b32 v103, 0xffff0000, v103
v_add_f32_dpp v96, v96, v96 row_ror:4 row_mask:0xf bank_mask:0xf
v_add_f32_dpp v20, v20, v20 row_ror:1 row_mask:0xf bank_mask:0xf
v_mul_f32 v20, 0x3acccccd, v20
v_add_f32_dpp v96, v96, v96 row_ror:2 row_mask:0xf bank_mask:0xf
s_nop 1
v_add_f32_dpp v96, v96, v96 row_ror:1 row_mask:0xf bank_mask:0xf
v_mul_f32 v96, 0x3acccccd, v96
v_fma_f32 v96, -v20, v20, v96
v_max_f32 v96, 0, v96
v_add_f32 v96, 0x3727c5ac, v96
v_rsq_f32 v96, v96
s_nop 0
v_mul_f32 v97, -v20, v96
v_pk_fma_f32 v[24:25], v[24:25], v[96:97], v[96:97] op_sel:[0,0,1] op_sel_hi:[1,0,1]
v_pk_fma_f32 v[26:27], v[26:27], v[96:97], v[96:97] op_sel:[0,0,1] op_sel_hi:[1,0,1]
v_pk_fma_f32 v[28:29], v[28:29], v[96:97], v[96:97] op_sel:[0,0,1] op_sel_hi:[1,0,1]
v_pk_fma_f32 v[30:31], v[30:31], v[96:97], v[96:97] op_sel:[0,0,1] op_sel_hi:[1,0,1]
v_cvt_pk_f16_f32 v104, v24, v25
v_cvt_pk_f16_f32 v105, v26, v27
v_cvt_pk_f16_f32 v106, v28, v29
v_cvt_pk_f16_f32 v107, v30, v31
v_lshlrev_b32 v24, 16, v108
v_and_b32 v25, 0xffff0000, v108
v_lshlrev_b32 v26, 16, v109
v_and_b32 v27, 0xffff0000, v109
v_lshlrev_b32 v28, 16, v110
v_and_b32 v29, 0xffff0000, v110
v_lshlrev_b32 v30, 16, v111
v_and_b32 v31, 0xffff0000, v111
v_pk_fma_f32 v[24:25], v[24:25], v[96:97], v[96:97] op_sel:[0,0,1] op_sel_hi:[1,0,1]
v_pk_fma_f32 v[26:27], v[26:27], v[96:97], v[96:97] op_sel:[0,0,1] op_sel_hi:[1,0,1]
v_pk_fma_f32 v[28:29], v[28:29], v[96:97], v[96:97] op_sel:[0,0,1] op_sel_hi:[1,0,1]
v_pk_fma_f32 v[30:31], v[30:31], v[96:97], v[96:97] op_sel:[0,0,1] op_sel_hi:[1,0,1]
v_cvt_pk_f16_f32 v108, v24, v25
v_cvt_pk_f16_f32 v109, v26, v27
v_cvt_pk_f16_f32 v110, v28, v29
v_cvt_pk_f16_f32 v111, v30, v31
v_lshlrev_b32 v24, 16, v112
v_and_b32 v25, 0xffff0000, v112
v_lshlrev_b32 v26, 16, v113
v_and_b32 v27, 0xffff0000, v113
v_lshlrev_b32 v28, 16, v114
v_and_b32 v29, 0xffff0000, v114
v_lshlrev_b32 v30, 16, v115
v_and_b32 v31, 0xffff0000, v115
v_pk_fma_f32 v[24:25], v[24:25], v[96:97], v[96:97] op_sel:[0,0,1] op_sel_hi:[1,0,1]
v_pk_fma_f32 v[26:27], v[26:27], v[96:97], v[96:97] op_sel:[0,0,1] op_sel_hi:[1,0,1]
v_pk_fma_f32 v[28:29], v[28:29], v[96:97], v[96:97] op_sel:[0,0,1] op_sel_hi:[1,0,1]
v_pk_fma_f32 v[30:31], v[30:31], v[96:97], v[96:97] op_sel:[0,0,1] op_sel_hi:[1,0,1]
v_cvt_pk_f16_f32 v112, v24, v25
v_cvt_pk_f16_f32 v113, v26, v27
v_cvt_pk_f16_f32 v114, v28, v29
v_cvt_pk_f16_f32 v115, v30, v31
v_lshlrev_b32 v24, 16, v116
v_and_b32 v25, 0xffff0000, v116
v_lshlrev_b32 v26, 16, v117
v_and_b32 v27, 0xffff0000, v117
v_lshlrev_b32 v28, 16, v118
v_and_b32 v29, 0xffff0000, v118
v_lshlrev_b32 v30, 16, v119
v_and_b32 v31, 0xffff0000, v119
v_pk_fma_f32 v[24:25], v[24:25], v[96:97], v[96:97] op_sel:[0,0,1] op_sel_hi:[1,0,1]
v_pk_fma_f32 v[26:27], v[26:27], v[96:97], v[96:97] op_sel:[0,0,1] op_sel_hi:[1,0,1]
v_pk_fma_f32 v[28:29], v[28:29], v[96:97], v[96:97] op_sel:[0,0,1] op_sel_hi:[1,0,1]
v_pk_fma_f32 v[30:31], v[30:31], v[96:97], v[96:97] op_sel:[0,0,1] op_sel_hi:[1,0,1]
v_pk_fma_f32 v[88:89], v[88:89], v[96:97], v[96:97] op_sel:[0,0,1] op_sel_hi:[1,0,1]
v_pk_fma_f32 v[90:91], v[90:91], v[96:97], v[96:97] op_sel:[0,0,1] op_sel_hi:[1,0,1]
v_pk_fma_f32 v[100:101], v[100:101], v[96:97], v[96:97] op_sel:[0,0,1] op_sel_hi:[1,0,1]
v_pk_fma_f32 v[102:103], v[102:103], v[96:97], v[96:97] op_sel:[0,0,1] op_sel_hi:[1,0,1]
v_cvt_pk_f16_f32 v116, v24, v25
v_cvt_pk_f16_f32 v117, v26, v27
v_cvt_pk_f16_f32 v118, v28, v29
v_cvt_pk_f16_f32 v119, v30, v31
buffer_load_dwordx4 v[140:143], v4, s[8:11], s61 offen offset:0
buffer_load_dwordx4 v[144:147], v4, s[8:11], s61 offen offset:256
buffer_load_dwordx4 v[148:151], v4, s[8:11], s61 offen offset:512
s_waitcnt vmcnt(8)
v_readfirstlane_b32 s41, v42
s_waitcnt lgkmcnt(0)
s_barrier
ds_read_b64_tr_b16 v[44:45], v35 offset:0
ds_read_b64_tr_b16 v[46:47], v35 offset:7680
ds_read_b64_tr_b16 v[48:49], v35 offset:40
ds_read_b64_tr_b16 v[50:51], v35 offset:7720
ds_read_b64_tr_b16 v[52:53], v35 offset:80
ds_read_b64_tr_b16 v[54:55], v35 offset:7760
ds_read_b64_tr_b16 v[56:57], v35 offset:120
ds_read_b64_tr_b16 v[58:59], v35 offset:7800
s_mul_i32 s40, s41, 0x9E3779B1
s_add_u32 s40, s40, 0x85EBCA6B
v_and_b32 v33, 3, v1
v_lshlrev_b32 v33, 3, v33
v_lshrrev_b32 v19, v33, s40
v_and_b32 v19, 0xff, v19
v_mov_b32 v240, s40
v_mov_b32 v241, s19
v_mov_b32 v242, s40
v_mov_b32 v243, s40
s_waitcnt lgkmcnt(6)
buffer_store_dwordx4 v[44:47], v36, s[4:7], s51 offen offset:0 sc1
s_waitcnt lgkmcnt(4)
buffer_store_dwordx4 v[48:51], v36, s[4:7], s51 offen offset:1024 sc1
s_waitcnt lgkmcnt(2)
buffer_store_dwordx4 v[52:55], v36, s[4:7], s51 offen offset:2048 sc1
s_waitcnt lgkmcnt(0)
buffer_store_dwordx4 v[56:59], v36, s[4:7], s51 offen offset:3072 sc1
buffer_load_dwordx4 v[152:155], v4, s[8:11], s61 offen offset:768
buffer_load_dwordx4 v[156:159], v4, s[8:11], s61 offen offset:1024
s_bfe_u32 s61, s62, 262156
s_mul_i32 s61, s61, 40960
s_add_u32 s61, s61, s45
s_waitcnt vmcnt(9)
s_mov_b32 s55, 0x3f803f80
buffer_load_dwordx4 v[160:163], v4, s[8:11], s61 offen offset:0
v_mfma_f32_16x16x32_bf16 v[20:23], a[236:239], v[120:123], 0
v_lshlrev_b32 v24, 16, v124
v_and_b32 v25, 0xffff0000, v124
v_mfma_f32_16x16x32_bf16 v[20:23], a[236:239], v[124:127], v[20:23]
v_lshlrev_b32 v26, 16, v125
v_and_b32 v27, 0xffff0000, v125
v_mfma_f32_16x16x32_bf16 v[20:23], a[236:239], v[128:131], v[20:23]
v_lshlrev_b32 v28, 16, v126
v_and_b32 v29, 0xffff0000, v126
v_mfma_f32_16x16x32_bf16 v[20:23], a[236:239], v[132:135], v[20:23]
v_lshlrev_b32 v30, 16, v127
v_and_b32 v31, 0xffff0000, v127
v_mfma_f32_16x16x32_bf16 v[20:23], a[236:239], v[136:139], v[20:23]
v_lshlrev_b32 v92, 16, v120
v_and_b32 v93, 0xffff0000, v120
v_lshlrev_b32 v94, 16, v121
v_and_b32 v95, 0xffff0000, v121
v_dot2_f32_bf16 v98, v120, v120, 0
v_dot2_f32_bf16 v99, v121, v121, 0
v_dot2_f32_bf16 v98, v122, v122, v98
v_dot2_f32_bf16 v99, v123, v123, v99
v_dot2_f32_bf16 v98, v124, v124, v98
v_dot2_f32_bf16 v99, v125, v125, v99
buffer_load_dwordx4 v[164:167], v4, s[8:11], s61 offen offset:256
v_dot2_f32_bf16 v98, v126, v126, v98
v_dot2_f32_bf16 v99, v127, v127, v99
v_dot2_f32_bf16 v98, v128, v128, v98
v_dot2_f32_bf16 v99, v129, v129, v99
v_dot2_f32_bf16 v98, v130, v130, v98
v_dot2_f32_bf16 v99, v131, v131, v99
v_dot2_f32_bf16 v98, v132, v132, v98
v_dot2_f32_bf16 v99, v133, v133, v99
v_dot2_f32_bf16 v98, v134, v134, v98
v_dot2_f32_bf16 v99, v135, v135, v99
v_dot2_f32_bf16 v98, v136, v136, v98
v_dot2_f32_bf16 v99, v137, v137, v99
v_dot2_f32_bf16 v98, v138, v138, v98
v_dot2_f32_bf16 v99, v139, v139, v99
v_add_f32_dpp v20, v20, v20 row_ror:8 row_mask:0xf bank_mask:0xf
v_lshlrev_b32 v120, 16, v122
v_and_b32 v121, 0xffff0000, v122
v_add_f32 v98, v98, v99
v_add_f32_dpp v20, v20, v20 row_ror:4 row_mask:0xf bank_mask:0xf
v_lshlrev_b32 v122, 16, v123
v_add_f32_dpp v98, v98, v98 row_ror:8 row_mask:0xf bank_mask:0xf
v_add_f32_dpp v20, v20, v20 row_ror:2 row_mask:0xf bank_mask:0xf
v_and_b32 v123, 0xffff0000, v123
v_add_f32_dpp v98, v98, v98 row_ror:4 row_mask:0xf bank_mask:0xf
buffer_load_dwordx4 v[168:171], v4, s[8:11], s61 offen offset:512
v_add_f32_dpp v20, v20, v20 row_ror:1 row_mask:0xf bank_mask:0xf
v_mul_f32 v20, 0x3acccccd, v20
v_add_f32_dpp v98, v98, v98 row_ror:2 row_mask:0xf bank_mask:0xf
s_nop 1
v_add_f32_dpp v98, v98, v98 row_ror:1 row_mask:0xf bank_mask:0xf
v_mul_f32 v98, 0x3acccccd, v98
v_fma_f32 v98, -v20, v20, v98
v_max_f32 v98, 0, v98
v_add_f32 v98, 0x3727c5ac, v98
v_rsq_f32 v98, v98
s_nop 0
v_mul_f32 v99, -v20, v98
v_pk_fma_f32 v[24:25], v[24:25], v[98:99], v[98:99] op_sel:[0,0,1] op_sel_hi:[1,0,1]
v_pk_fma_f32 v[26:27], v[26:27], v[98:99], v[98:99] op_sel:[0,0,1] op_sel_hi:[1,0,1]
v_pk_fma_f32 v[28:29], v[28:29], v[98:99], v[98:99] op_sel:[0,0,1] op_sel_hi:[1,0,1]
v_pk_fma_f32 v[30:31], v[30:31], v[98:99], v[98:99] op_sel:[0,0,1] op_sel_hi:[1,0,1]
v_cvt_pk_f16_f32 v124, v24, v25
v_cvt_pk_f16_f32 v125, v26, v27
v_cvt_pk_f16_f32 v126, v28, v29
v_cvt_pk_f16_f32 v127, v30, v31
v_lshlrev_b32 v24, 16, v128
v_and_b32 v25, 0xffff0000, v128
v_lshlrev_b32 v26, 16, v129
v_and_b32 v27, 0xffff0000, v129
v_lshlrev_b32 v28, 16, v130
buffer_load_dwordx4 v[172:175], v4, s[8:11], s61 offen offset:768
v_and_b32 v29, 0xffff0000, v130
v_lshlrev_b32 v30, 16, v131
v_and_b32 v31, 0xffff0000, v131
v_pk_fma_f32 v[24:25], v[24:25], v[98:99], v[98:99] op_sel:[0,0,1] op_sel_hi:[1,0,1]
v_pk_fma_f32 v[26:27], v[26:27], v[98:99], v[98:99] op_sel:[0,0,1] op_sel_hi:[1,0,1]
v_pk_fma_f32 v[28:29], v[28:29], v[98:99], v[98:99] op_sel:[0,0,1] op_sel_hi:[1,0,1]
v_pk_fma_f32 v[30:31], v[30:31], v[98:99], v[98:99] op_sel:[0,0,1] op_sel_hi:[1,0,1]
v_cvt_pk_f16_f32 v128, v24, v25
v_cvt_pk_f16_f32 v129, v26, v27
v_cvt_pk_f16_f32 v130, v28, v29
v_cvt_pk_f16_f32 v131, v30, v31
v_lshlrev_b32 v24, 16, v132
v_and_b32 v25, 0xffff0000, v132
v_lshlrev_b32 v26, 16, v133
v_and_b32 v27, 0xffff0000, v133
v_lshlrev_b32 v28, 16, v134
v_and_b32 v29, 0xffff0000, v134
v_lshlrev_b32 v30, 16, v135
v_and_b32 v31, 0xffff0000, v135
v_pk_fma_f32 v[24:25], v[24:25], v[98:99], v[98:99] op_sel:[0,0,1] op_sel_hi:[1,0,1]
v_pk_fma_f32 v[26:27], v[26:27], v[98:99], v[98:99] op_sel:[0,0,1] op_sel_hi:[1,0,1]
v_pk_fma_f32 v[28:29], v[28:29], v[98:99], v[98:99] op_sel:[0,0,1] op_sel_hi:[1,0,1]
v_pk_fma_f32 v[30:31], v[30:31], v[98:99], v[98:99] op_sel:[0,0,1] op_sel_hi:[1,0,1]
buffer_load_dwordx4 v[176:179], v4, s[8:11], s61 offen offset:1024
s_bfe_u32 s61, s62, 262160
s_mul_i32 s61, s61, 40960
s_add_u32 s61, s61, s45
v_cvt_pk_f16_f32 v132, v24, v25
v_cvt_pk_f16_f32 v133, v26, v27
v_cvt_pk_f16_f32 v134, v28, v29
v_cvt_pk_f16_f32 v135, v30, v31
v_lshlrev_b32 v24, 16, v136
v_and_b32 v25, 0xffff0000, v136
v_lshlrev_b32 v26, 16, v137
v_and_b32 v27, 0xffff0000, v137
v_lshlrev_b32 v28, 16, v138
v_and_b32 v29, 0xffff0000, v138
v_lshlrev_b32 v30, 16, v139
v_and_b32 v31, 0xffff0000, v139
v_pk_fma_f32 v[24:25], v[24:25], v[98:99], v[98:99] op_sel:[0,0,1] op_sel_hi:[1,0,1]
v_pk_fma_f32 v[26:27], v[26:27], v[98:99], v[98:99] op_sel:[0,0,1] op_sel_hi:[1,0,1]
v_pk_fma_f32 v[28:29], v[28:29], v[98:99], v[98:99] op_sel:[0,0,1] op_sel_hi:[1,0,1]
v_pk_fma_f32 v[30:31], v[30:31], v[98:99], v[98:99] op_sel:[0,0,1] op_sel_hi:[1,0,1]
v_pk_fma_f32 v[92:93], v[92:93], v[98:99], v[98:99] op_sel:[0,0,1] op_sel_hi:[1,0,1]
v_pk_fma_f32 v[94:95], v[94:95], v[98:99], v[98:99] op_sel:[0,0,1] op_sel_hi:[1,0,1]
v_pk_fma_f32 v[120:121], v[120:121], v[98:99], v[98:99] op_sel:[0,0,1] op_sel_hi:[1,0,1]
v_pk_fma_f32 v[122:123], v[122:123], v[98:99], v[98:99] op_sel:[0,0,1] op_sel_hi:[1,0,1]
v_cvt_pk_f16_f32 v136, v24, v25
v_cvt_pk_f16_f32 v137, v26, v27
v_cvt_pk_f16_f32 v138, v28, v29
v_cvt_pk_f16_f32 v139, v30, v31
s_waitcnt vmcnt(7)
buffer_store_dwordx4 v[240:243], v246, s[4:7], s53 offen sc1
s_barrier
s_waitcnt vmcnt(6)
s_mov_b32 s55, 0x3f803f80
buffer_load_dwordx4 v[180:183], v4, s[8:11], s61 offen offset:0
v_mfma_f32_16x16x32_bf16 v[20:23], a[236:239], v[140:143], 0
v_lshlrev_b32 v24, 16, v144
v_and_b32 v25, 0xffff0000, v144
v_mfma_f32_16x16x32_bf16 v[20:23], a[236:239], v[144:147], v[20:23]
v_lshlrev_b32 v26, 16, v145
v_and_b32 v27, 0xffff0000, v145
v_mfma_f32_16x16x32_bf16 v[20:23], a[236:239], v[148:151], v[20:23]
v_lshlrev_b32 v28, 16, v146
v_and_b32 v29, 0xffff0000, v146
v_mfma_f32_16x16x32_bf16 v[20:23], a[236:239], v[152:155], v[20:23]
buffer_load_dwordx4 v[184:187], v4, s[8:11], s61 offen offset:256
v_lshlrev_b32 v30, 16, v147
v_and_b32 v31, 0xffff0000, v147
v_mfma_f32_16x16x32_bf16 v[20:23], a[236:239], v[156:159], v[20:23]
v_lshlrev_b32 v72, 16, v140
v_and_b32 v73, 0xffff0000, v140
v_lshlrev_b32 v74, 16, v141
v_and_b32 v75, 0xffff0000, v141
v_dot2_f32_bf16 v84, v140, v140, 0
v_dot2_f32_bf16 v85, v141, v141, 0
v_dot2_f32_bf16 v84, v142, v142, v84
v_dot2_f32_bf16 v85, v143, v143, v85
buffer_load_dwordx4 v[188:191], v4, s[8:11], s61 offen offset:512
v_dot2_f32_bf16 v84, v144, v144, v84
v_dot2_f32_bf16 v85, v145, v145, v85
v_dot2_f32_bf16 v84, v146, v146, v84
v_dot2_f32_bf16 v85, v147, v147, v85
v_dot2_f32_bf16 v84, v148, v148, v84
v_dot2_f32_bf16 v85, v149, v149, v85
v_dot2_f32_bf16 v84, v150, v150, v84
v_dot2_f32_bf16 v85, v151, v151, v85
v_dot2_f32_bf16 v84, v152, v152, v84
v_dot2_f32_bf16 v85, v153, v153, v85
v_dot2_f32_bf16 v84, v154, v154, v84
buffer_load_dwordx4 v[192:195], v4, s[8:11], s61 offen offset:768
v_dot2_f32_bf16 v85, v155, v155, v85
v_dot2_f32_bf16 v84, v156, v156, v84
v_dot2_f32_bf16 v85, v157, v157, v85
v_dot2_f32_bf16 v84, v158, v158, v84
v_dot2_f32_bf16 v85, v159, v159, v85
v_add_f32_dpp v20, v20, v20 row_ror:8 row_mask:0xf bank_mask:0xf
v_lshlrev_b32 v140, 16, v142
v_and_b32 v141, 0xffff0000, v142
v_add_f32 v84, v84, v85
v_add_f32_dpp v20, v20, v20 row_ror:4 row_mask:0xf bank_mask:0xf
buffer_load_dwordx4 v[196:199], v4, s[8:11], s61 offen offset:1024
v_lshlrev_b32 v142, 16, v143
v_add_f32_dpp v84, v84, v84 row_ror:8 row_mask:0xf bank_mask:0xf
v_add_f32_dpp v20, v20, v20 row_ror:2 row_mask:0xf bank_mask:0xf
v_and_b32 v143, 0xffff0000, v143
v_add_f32_dpp v84, v84, v84 row_ror:4 row_mask:0xf bank_mask:0xf
v_add_f32_dpp v20, v20, v20 row_ror:1 row_mask:0xf bank_mask:0xf
v_mul_f32 v20, 0x3acccccd, v20
v_add_f32_dpp v84, v84, v84 row_ror:2 row_mask:0xf bank_mask:0xf
s_nop 1
v_add_f32_dpp v84, v84, v84 row_ror:1 row_mask:0xf bank_mask:0xf
v_mul_f32 v84, 0x3acccccd, v84
v_fma_f32 v84, -v20, v20, v84
s_add_u32 m0, s39, 0
s_nop 0
buffer_load_dwordx4 v232, s[24:27], s48 offen offset:0 lds
v_max_f32 v84, 0, v84
v_add_f32 v84, 0x3727c5ac, v84
v_rsq_f32 v84, v84
s_nop 0
v_mul_f32 v85, -v20, v84
v_pk_fma_f32 v[24:25], v[24:25], v[84:85], v[84:85] op_sel:[0,0,1] op_sel_hi:[1,0,1]
v_pk_fma_f32 v[26:27], v[26:27], v[84:85], v[84:85] op_sel:[0,0,1] op_sel_hi:[1,0,1]
v_pk_fma_f32 v[28:29], v[28:29], v[84:85], v[84:85] op_sel:[0,0,1] op_sel_hi:[1,0,1]
v_pk_fma_f32 v[30:31], v[30:31], v[84:85], v[84:85] op_sel:[0,0,1] op_sel_hi:[1,0,1]
v_cvt_pk_f16_f32 v144, v24, v25
v_cvt_pk_f16_f32 v145, v26, v27
buffer_load_dwordx4 v233, s[24:27], s48 offen offset:1024 lds
v_cvt_pk_f16_f32 v146, v28, v29
v_cvt_pk_f16_f32 v147, v30, v31
v_lshlrev_b32 v24, 16, v148
v_and_b32 v25, 0xffff0000, v148
v_lshlrev_b32 v26, 16, v149
v_and_b32 v27, 0xffff0000, v149
v_lshlrev_b32 v28, 16, v150
v_and_b32 v29, 0xffff0000, v150
v_lshlrev_b32 v30, 16, v151
v_and_b32 v31, 0xffff0000, v151
v_pk_fma_f32 v[24:25], v[24:25], v[84:85], v[84:85] op_sel:[0,0,1] op_sel_hi:[1,0,1]
buffer_load_dwordx4 v234, s[24:27], s48 offen offset:2048 lds
s_add_u32 s48, s48, 81920
v_pk_fma_f32 v[26:27], v[26:27], v[84:85], v[84:85] op_sel:[0,0,1] op_sel_hi:[1,0,1]
v_pk_fma_f32 v[28:29], v[28:29], v[84:85], v[84:85] op_sel:[0,0,1] op_sel_hi:[1,0,1]
v_pk_fma_f32 v[30:31], v[30:31], v[84:85], v[84:85] op_sel:[0,0,1] op_sel_hi:[1,0,1]
v_cvt_pk_f16_f32 v148, v24, v25
v_cvt_pk_f16_f32 v149, v26, v27
v_cvt_pk_f16_f32 v150, v28, v29
v_cvt_pk_f16_f32 v151, v30, v31
v_lshlrev_b32 v24, 16, v152
v_and_b32 v25, 0xffff0000, v152
v_lshlrev_b32 v26, 16, v153
v_and_b32 v27, 0xffff0000, v153
s_add_u32 m0, s39, 12288
s_nop 0
buffer_load_dwordx4 v232, s[24:27], s48 offen offset:0 lds
v_lshlrev_b32 v28, 16, v154
v_and_b32 v29, 0xffff0000, v154
v_lshlrev_b32 v30, 16, v155
v_and_b32 v31, 0xffff0000, v155
v_pk_fma_f32 v[24:25], v[24:25], v[84:85], v[84:85] op_sel:[0,0,1] op_sel_hi:[1,0,1]
v_pk_fma_f32 v[26:27], v[26:27], v[84:85], v[84:85] op_sel:[0,0,1] op_sel_hi:[1,0,1]
v_pk_fma_f32 v[28:29], v[28:29], v[84:85], v[84:85] op_sel:[0,0,1] op_sel_hi:[1,0,1]
v_pk_fma_f32 v[30:31], v[30:31], v[84:85], v[84:85] op_sel:[0,0,1] op_sel_hi:[1,0,1]
v_cvt_pk_f16_f32 v152, v24, v25
v_cvt_pk_f16_f32 v153, v26, v27
buffer_load_dwordx4 v233, s[24:27], s48 offen offset:1024 lds
v_cvt_pk_f16_f32 v154, v28, v29
v_cvt_pk_f16_f32 v155, v30, v31
v_lshlrev_b32 v24, 16, v156
v_and_b32 v25, 0xffff0000, v156
v_lshlrev_b32 v26, 16, v157
v_and_b32 v27, 0xffff0000, v157
v_lshlrev_b32 v28, 16, v158
v_and_b32 v29, 0xffff0000, v158
v_lshlrev_b32 v30, 16, v159
v_and_b32 v31, 0xffff0000, v159
v_pk_fma_f32 v[24:25], v[24:25], v[84:85], v[84:85] op_sel:[0,0,1] op_sel_hi:[1,0,1]
buffer_load_dwordx4 v234, s[24:27], s48 offen offset:2048 lds
s_add_u32 s48, s48, 81920
v_pk_fma_f32 v[26:27], v[26:27], v[84:85], v[84:85] op_sel:[0,0,1] op_sel_hi:[1,0,1]
v_pk_fma_f32 v[28:29], v[28:29], v[84:85], v[84:85] op_sel:[0,0,1] op_sel_hi:[1,0,1]
v_pk_fma_f32 v[30:31], v[30:31], v[84:85], v[84:85] op_sel:[0,0,1] op_sel_hi:[1,0,1]
v_pk_fma_f32 v[72:73], v[72:73], v[84:85], v[84:85] op_sel:[0,0,1] op_sel_hi:[1,0,1]
v_pk_fma_f32 v[74:75], v[74:75], v[84:85], v[84:85] op_sel:[0,0,1] op_sel_hi:[1,0,1]
v_pk_fma_f32 v[140:141], v[140:141], v[84:85], v[84:85] op_sel:[0,0,1] op_sel_hi:[1,0,1]
v_pk_fma_f32 v[142:143], v[142:143], v[84:85], v[84:85] op_sel:[0,0,1] op_sel_hi:[1,0,1]
v_cvt_pk_f16_f32 v156, v24, v25
v_cvt_pk_f16_f32 v157, v26, v27
v_cvt_pk_f16_f32 v158, v28, v29
v_cvt_pk_f16_f32 v159, v30, v31
s_waitcnt vmcnt(12)
s_mov_b32 s55, 0x3f803f80
buffer_store_dwordx4 a[232:235], v11, s[4:7], s46 offen sc1
v_mfma_f32_16x16x32_bf16 v[20:23], a[236:239], v[160:163], 0
v_lshlrev_b32 v24, 16, v164
v_and_b32 v25, 0xffff0000, v164
v_mfma_f32_16x16x32_bf16 v[20:23], a[236:239], v[164:167], v[20:23]
v_lshlrev_b32 v26, 16, v165
v_and_b32 v27, 0xffff0000, v165
v_mfma_f32_16x16x32_bf16 v[20:23], a[236:239], v[168:171], v[20:23]
v_lshlrev_b32 v28, 16, v166
v_and_b32 v29, 0xffff0000, v166
v_mfma_f32_16x16x32_bf16 v[20:23], a[236:239], v[172:175], v[20:23]
v_lshlrev_b32 v30, 16, v167
v_and_b32 v31, 0xffff0000, v167
v_mfma_f32_16x16x32_bf16 v[20:23], a[236:239], v[176:179], v[20:23]
v_lshlrev_b32 v76, 16, v160
v_and_b32 v77, 0xffff0000, v160
v_lshlrev_b32 v78, 16, v161
v_and_b32 v79, 0xffff0000, v161
v_dot2_f32_bf16 v86, v160, v160, 0
v_dot2_f32_bf16 v87, v161, v161, 0
buffer_store_dwordx4 a[232:235], v12, s[4:7], s46 offen sc1
v_dot2_f32_bf16 v86, v162, v162, v86
v_dot2_f32_bf16 v87, v163, v163, v87
v_dot2_f32_bf16 v86, v164, v164, v86
v_dot2_f32_bf16 v87, v165, v165, v87
v_dot2_f32_bf16 v86, v166, v166, v86
v_dot2_f32_bf16 v87, v167, v167, v87
v_dot2_f32_bf16 v86, v168, v168, v86
v_dot2_f32_bf16 v87, v169, v169, v87
v_dot2_f32_bf16 v86, v170, v170, v86
v_dot2_f32_bf16 v87, v171, v171, v87
v_dot2_f32_bf16 v86, v172, v172, v86
v_dot2_f32_bf16 v87, v173, v173, v87
v_dot2_f32_bf16 v86, v174, v174, v86
v_dot2_f32_bf16 v87, v175, v175, v87
v_dot2_f32_bf16 v86, v176, v176, v86
v_dot2_f32_bf16 v87, v177, v177, v87
v_dot2_f32_bf16 v86, v178, v178, v86
v_dot2_f32_bf16 v87, v179, v179, v87
v_add_f32_dpp v20, v20, v20 row_ror:8 row_mask:0xf bank_mask:0xf
v_lshlrev_b32 v160, 16, v162
buffer_store_dwordx4 a[232:235], v13, s[4:7], s46 offen sc1
v_and_b32 v161, 0xffff0000, v162
v_add_f32 v86, v86, v87
v_add_f32_dpp v20, v20, v20 row_ror:4 row_mask:0xf bank_mask:0xf
v_lshlrev_b32 v162, 16, v163
v_add_f32_dpp v86, v86, v86 row_ror:8 row_mask:0xf bank_mask:0xf
v_add_f32_dpp v20, v20, v20 row_ror:2 row_mask:0xf bank_mask:0xf
v_and_b32 v163, 0xffff0000, v163
v_add_f32_dpp v86, v86, v86 row_ror:4 row_mask:0xf bank_mask:0xf
v_add_f32_dpp v20, v20, v20 row_ror:1 row_mask:0xf bank_mask:0xf
v_mul_f32 v20, 0x3acccccd, v20
v_add_f32_dpp v86, v86, v86 row_ror:2 row_mask:0xf bank_mask:0xf
s_nop 1
v_add_f32_dpp v86, v86, v86 row_ror:1 row_mask:0xf bank_mask:0xf
v_mul_f32 v86, 0x3acccccd, v86
v_fma_f32 v86, -v20, v20, v86
v_max_f32 v86, 0, v86
v_add_f32 v86, 0x3727c5ac, v86
v_rsq_f32 v86, v86
s_nop 0
v_mul_f32 v87, -v20, v86
v_pk_fma_f32 v[24:25], v[24:25], v[86:87], v[86:87] op_sel:[0,0,1] op_sel_hi:[1,0,1]
buffer_store_dwordx4 a[232:235], v14, s[4:7], s46 offen sc1
v_pk_fma_f32 v[26:27], v[26:27], v[86:87], v[86:87] op_sel:[0,0,1] op_sel_hi:[1,0,1]
v_pk_fma_f32 v[28:29], v[28:29], v[86:87], v[86:87] op_sel:[0,0,1] op_sel_hi:[1,0,1]
v_pk_fma_f32 v[30:31], v[30:31], v[86:87], v[86:87] op_sel:[0,0,1] op_sel_hi:[1,0,1]
v_cvt_pk_f16_f32 v164, v24, v25
v_cvt_pk_f16_f32 v165, v26, v27
v_cvt_pk_f16_f32 v166, v28, v29
v_cvt_pk_f16_f32 v167, v30, v31
v_lshlrev_b32 v24, 16, v168
v_and_b32 v25, 0xffff0000, v168
v_lshlrev_b32 v26, 16, v169
v_and_b32 v27, 0xffff0000, v169
v_lshlrev_b32 v28, 16, v170
v_and_b32 v29, 0xffff0000, v170
v_lshlrev_b32 v30, 16, v171
v_and_b32 v31, 0xffff0000, v171
v_pk_fma_f32 v[24:25], v[24:25], v[86:87], v[86:87] op_sel:[0,0,1] op_sel_hi:[1,0,1]
v_pk_fma_f32 v[26:27], v[26:27], v[86:87], v[86:87] op_sel:[0,0,1] op_sel_hi:[1,0,1]
v_pk_fma_f32 v[28:29], v[28:29], v[86:87], v[86:87] op_sel:[0,0,1] op_sel_hi:[1,0,1]
v_pk_fma_f32 v[30:31], v[30:31], v[86:87], v[86:87] op_sel:[0,0,1] op_sel_hi:[1,0,1]
v_cvt_pk_f16_f32 v168, v24, v25
buffer_store_dwordx4 a[232:235], v246, s[4:7], s18 offen sc1
v_cvt_pk_f16_f32 v169, v26, v27
v_cvt_pk_f16_f32 v170, v28, v29
v_cvt_pk_f16_f32 v171, v30, v31
v_lshlrev_b32 v24, 16, v172
v_and_b32 v25, 0xffff0000, v172
v_lshlrev_b32 v26, 16, v173
v_and_b32 v27, 0xffff0000, v173
v_lshlrev_b32 v28, 16, v174
v_and_b32 v29, 0xffff0000, v174
v_lshlrev_b32 v30, 16, v175
v_and_b32 v31, 0xffff0000, v175
v_pk_fma_f32 v[24:25], v[24:25], v[86:87], v[86:87] op_sel:[0,0,1] op_sel_hi:[1,0,1]
v_pk_fma_f32 v[26:27], v[26:27], v[86:87], v[86:87] op_sel:[0,0,1] op_sel_hi:[1,0,1]
v_pk_fma_f32 v[28:29], v[28:29], v[86:87], v[86:87] op_sel:[0,0,1] op_sel_hi:[1,0,1]
v_pk_fma_f32 v[30:31], v[30:31], v[86:87], v[86:87] op_sel:[0,0,1] op_sel_hi:[1,0,1]
v_cvt_pk_f16_f32 v172, v24, v25
v_cvt_pk_f16_f32 v173, v26, v27
v_cvt_pk_f16_f32 v174, v28, v29
v_cvt_pk_f16_f32 v175, v30, v31
s_lshl_b32 s37, s47, 2
s_add_u32 s37, s37, s3
s_lshl_b32 s37, s37, 3
s_add_u32 s37, s37, s96
s_lshl_b32 s37, s37, 8
s_add_u32 s37, s37, 131072
v_lshlrev_b32 v69, 2, v1
v_xor_b32 v70, 0xff, v19
buffer_store_dword v70, v69, s[4:7], s37 offen sc1
v_lshlrev_b32 v24, 16, v176
v_and_b32 v25, 0xffff0000, v176
v_lshlrev_b32 v26, 16, v177
v_and_b32 v27, 0xffff0000, v177
v_lshlrev_b32 v28, 16, v178
v_and_b32 v29, 0xffff0000, v178
v_lshlrev_b32 v30, 16, v179
v_and_b32 v31, 0xffff0000, v179
v_pk_fma_f32 v[24:25], v[24:25], v[86:87], v[86:87] op_sel:[0,0,1] op_sel_hi:[1,0,1]
v_pk_fma_f32 v[26:27], v[26:27], v[86:87], v[86:87] op_sel:[0,0,1] op_sel_hi:[1,0,1]
v_pk_fma_f32 v[28:29], v[28:29], v[86:87], v[86:87] op_sel:[0,0,1] op_sel_hi:[1,0,1]
v_pk_fma_f32 v[30:31], v[30:31], v[86:87], v[86:87] op_sel:[0,0,1] op_sel_hi:[1,0,1]
v_pk_fma_f32 v[76:77], v[76:77], v[86:87], v[86:87] op_sel:[0,0,1] op_sel_hi:[1,0,1]
v_pk_fma_f32 v[78:79], v[78:79], v[86:87], v[86:87] op_sel:[0,0,1] op_sel_hi:[1,0,1]
v_pk_fma_f32 v[160:161], v[160:161], v[86:87], v[86:87] op_sel:[0,0,1] op_sel_hi:[1,0,1]
v_pk_fma_f32 v[162:163], v[162:163], v[86:87], v[86:87] op_sel:[0,0,1] op_sel_hi:[1,0,1]
v_cvt_pk_f16_f32 v176, v24, v25
v_cvt_pk_f16_f32 v177, v26, v27
v_cvt_pk_f16_f32 v178, v28, v29
v_cvt_pk_f16_f32 v179, v30, v31
buffer_load_dwordx4 v[40:43], v248, s[4:7], s56 offen sc1
s_waitcnt vmcnt(13)
s_mov_b32 s55, 0x3f803f80
v_mfma_f32_16x16x32_bf16 v[20:23], a[236:239], v[180:183], 0
v_lshlrev_b32 v24, 16, v184
v_and_b32 v25, 0xffff0000, v184
v_mfma_f32_16x16x32_bf16 v[20:23], a[236:239], v[184:187], v[20:23]
v_lshlrev_b32 v26, 16, v185
v_and_b32 v27, 0xffff0000, v185
v_mfma_f32_16x16x32_bf16 v[20:23], a[236:239], v[188:191], v[20:23]
buffer_load_dwordx4 v[44:47], v248, s[4:7], s57 offen sc1
v_lshlrev_b32 v28, 16, v186
v_and_b32 v29, 0xffff0000, v186
v_mfma_f32_16x16x32_bf16 v[20:23], a[236:239], v[192:195], v[20:23]
v_lshlrev_b32 v30, 16, v187
v_and_b32 v31, 0xffff0000, v187
v_mfma_f32_16x16x32_bf16 v[20:23], a[236:239], v[196:199], v[20:23]
v_lshlrev_b32 v80, 16, v180
v_and_b32 v81, 0xffff0000, v180
v_lshlrev_b32 v82, 16, v181
buffer_load_dwordx4 v[48:51], v248, s[4:7], s58 offen sc1
v_and_b32 v83, 0xffff0000, v181
v_dot2_f32_bf16 v66, v180, v180, 0
v_dot2_f32_bf16 v67, v181, v181, 0
v_dot2_f32_bf16 v66, v182, v182, v66
v_dot2_f32_bf16 v67, v183, v183, v67
v_dot2_f32_bf16 v66, v184, v184, v66
v_dot2_f32_bf16 v67, v185, v185, v67
v_dot2_f32_bf16 v66, v186, v186, v66
v_dot2_f32_bf16 v67, v187, v187, v67
buffer_load_dword v52, v249, s[4:7], s56 offen sc1
v_dot2_f32_bf16 v66, v188, v188, v66
v_dot2_f32_bf16 v67, v189, v189, v67
v_dot2_f32_bf16 v66, v190, v190, v66
v_dot2_f32_bf16 v67, v191, v191, v67
v_dot2_f32_bf16 v66, v192, v192, v66
v_dot2_f32_bf16 v67, v193, v193, v67
v_dot2_f32_bf16 v66, v194, v194, v66
v_dot2_f32_bf16 v67, v195, v195, v67
v_dot2_f32_bf16 v66, v196, v196, v66
buffer_load_dword v53, v249, s[4:7], s57 offen sc1
v_dot2_f32_bf16 v67, v197, v197, v67
v_dot2_f32_bf16 v66, v198, v198, v66
v_dot2_f32_bf16 v67, v199, v199, v67
v_add_f32_dpp v20, v20, v20 row_ror:8 row_mask:0xf bank_mask:0xf
v_lshlrev_b32 v180, 16, v182
v_and_b32 v181, 0xffff0000, v182
v_add_f32 v66, v66, v67
v_add_f32_dpp v20, v20, v20 row_ror:4 row_mask:0xf bank_mask:0xf
v_lshlrev_b32 v182, 16, v183
buffer_load_dword v54, v249, s[4:7], s58 offen sc1
v_add_f32_dpp v66, v66, v66 row_ror:8 row_mask:0xf bank_mask:0xf
v_add_f32_dpp v20, v20, v20 row_ror:2 row_mask:0xf bank_mask:0xf
v_and_b32 v183, 0xffff0000, v183
v_add_f32_dpp v66, v66, v66 row_ror:4 row_mask:0xf bank_mask:0xf
v_add_f32_dpp v20, v20, v20 row_ror:1 row_mask:0xf bank_mask:0xf
v_mul_f32 v20, 0x3acccccd, v20
v_add_f32_dpp v66, v66, v66 row_ror:2 row_mask:0xf bank_mask:0xf
s_nop 1
v_add_f32_dpp v66, v66, v66 row_ror:1 row_mask:0xf bank_mask:0xf
v_mul_f32 v66, 0x3acccccd, v66
buffer_load_dword v71, v247, s[4:7], s60 offen sc1
v_fma_f32 v66, -v20, v20, v66
v_max_f32 v66, 0, v66
v_add_f32 v66, 0x3727c5ac, v66
v_rsq_f32 v66, v66
s_nop 0
v_mul_f32 v67, -v20, v66
v_pk_fma_f32 v[24:25], v[24:25], v[66:67], v[66:67] op_sel:[0,0,1] op_sel_hi:[1,0,1]
v_pk_fma_f32 v[26:27], v[26:27], v[66:67], v[66:67] op_sel:[0,0,1] op_sel_hi:[1,0,1]
v_pk_fma_f32 v[28:29], v[28:29], v[66:67], v[66:67] op_sel:[0,0,1] op_sel_hi:[1,0,1]
v_pk_fma_f32 v[30:31], v[30:31], v[66:67], v[66:67] op_sel:[0,0,1] op_sel_hi:[1,0,1]
v_cvt_pk_f16_f32 v184, v24, v25
s_add_u32 m0, s39, 24576
s_nop 0
buffer_load_dwordx4 v232, s[24:27], s48 offen offset:0 lds
v_cvt_pk_f16_f32 v185, v26, v27
v_cvt_pk_f16_f32 v186, v28, v29
v_cvt_pk_f16_f32 v187, v30, v31
v_lshlrev_b32 v24, 16, v188
v_and_b32 v25, 0xffff0000, v188
v_lshlrev_b32 v26, 16, v189
v_and_b32 v27, 0xffff0000, v189
v_lshlrev_b32 v28, 16, v190
v_and_b32 v29, 0xffff0000, v190
buffer_load_dwordx4 v233, s[24:27], s48 offen offset:1024 lds
v_lshlrev_b32 v30, 16, v191
v_and_b32 v31, 0xffff0000, v191
v_pk_fma_f32 v[24:25], v[24:25], v[66:67], v[66:67] op_sel:[0,0,1] op_sel_hi:[1,0,1]
v_pk_fma_f32 v[26:27], v[26:27], v[66:67], v[66:67] op_sel:[0,0,1] op_sel_hi:[1,0,1]
v_pk_fma_f32 v[28:29], v[28:29], v[66:67], v[66:67] op_sel:[0,0,1] op_sel_hi:[1,0,1]
v_pk_fma_f32 v[30:31], v[30:31], v[66:67], v[66:67] op_sel:[0,0,1] op_sel_hi:[1,0,1]
v_cvt_pk_f16_f32 v188, v24, v25
v_cvt_pk_f16_f32 v189, v26, v27
v_cvt_pk_f16_f32 v190, v28, v29
buffer_load_dwordx4 v234, s[24:27], s48 offen offset:2048 lds
s_add_u32 s48, s48, 81920
v_cvt_pk_f16_f32 v191, v30, v31
v_lshlrev_b32 v24, 16, v192
v_and_b32 v25, 0xffff0000, v192
v_lshlrev_b32 v26, 16, v193
v_and_b32 v27, 0xffff0000, v193
v_lshlrev_b32 v28, 16, v194
v_and_b32 v29, 0xffff0000, v194
v_lshlrev_b32 v30, 16, v195
v_and_b32 v31, 0xffff0000, v195
s_add_u32 m0, s39, 36864
s_nop 0
buffer_load_dwordx4 v232, s[24:27], s48 offen offset:0 lds
v_pk_fma_f32 v[24:25], v[24:25], v[66:67], v[66:67] op_sel:[0,0,1] op_sel_hi:[1,0,1]
v_pk_fma_f32 v[26:27], v[26:27], v[66:67], v[66:67] op_sel:[0,0,1] op_sel_hi:[1,0,1]
v_pk_fma_f32 v[28:29], v[28:29], v[66:67], v[66:67] op_sel:[0,0,1] op_sel_hi:[1,0,1]
v_pk_fma_f32 v[30:31], v[30:31], v[66:67], v[66:67] op_sel:[0,0,1] op_sel_hi:[1,0,1]
v_cvt_pk_f16_f32 v192, v24, v25
v_cvt_pk_f16_f32 v193, v26, v27
v_cvt_pk_f16_f32 v194, v28, v29
v_cvt_pk_f16_f32 v195, v30, v31
v_lshlrev_b32 v24, 16, v196
buffer_load_dwordx4 v233, s[24:27], s48 offen offset:1024 lds
v_and_b32 v25, 0xffff0000, v196
v_lshlrev_b32 v26, 16, v197
v_and_b32 v27, 0xffff0000, v197
v_lshlrev_b32 v28, 16, v198
v_and_b32 v29, 0xffff0000, v198
v_lshlrev_b32 v30, 16, v199
v_and_b32 v31, 0xffff0000, v199
v_pk_fma_f32 v[24:25], v[24:25], v[66:67], v[66:67] op_sel:[0,0,1] op_sel_hi:[1,0,1]
v_pk_fma_f32 v[26:27], v[26:27], v[66:67], v[66:67] op_sel:[0,0,1] op_sel_hi:[1,0,1]
buffer_load_dwordx4 v234, s[24:27], s48 offen offset:2048 lds
s_add_u32 s48, s48, 81920
v_pk_fma_f32 v[28:29], v[28:29], v[66:67], v[66:67] op_sel:[0,0,1] op_sel_hi:[1,0,1]
v_pk_fma_f32 v[30:31], v[30:31], v[66:67], v[66:67] op_sel:[0,0,1] op_sel_hi:[1,0,1]
v_pk_fma_f32 v[80:81], v[80:81], v[66:67], v[66:67] op_sel:[0,0,1] op_sel_hi:[1,0,1]
v_pk_fma_f32 v[82:83], v[82:83], v[66:67], v[66:67] op_sel:[0,0,1] op_sel_hi:[1,0,1]
v_pk_fma_f32 v[180:181], v[180:181], v[66:67], v[66:67] op_sel:[0,0,1] op_sel_hi:[1,0,1]
v_pk_fma_f32 v[182:183], v[182:183], v[66:67], v[66:67] op_sel:[0,0,1] op_sel_hi:[1,0,1]
v_cvt_pk_f16_f32 v196, v24, v25
v_cvt_pk_f16_f32 v197, v26, v27
v_cvt_pk_f16_f32 v198, v28, v29
v_cvt_pk_f16_f32 v199, v30, v31
L_bodyj:
s_and_b32 s12, s40, 0xff
s_bfe_u32 s13, s40, 0x80008
s_bfe_u32 s14, s40, 0x80010
s_lshr_b32 s15, s40, 24
s_waitcnt vmcnt(7)
v_xor_b32 v40, s12, v40
v_xor_b32 v41, s13, v41
v_xor_b32 v42, s14, v42
v_xor_b32 v43, s15, v43
v_xor_b32 v44, s12, v44
v_xor_b32 v45, s13, v45
v_xor_b32 v46, s14, v46
v_xor_b32 v47, s15, v47
v_xor_b32 v48, s12, v48
v_xor_b32 v49, s13, v49
v_xor_b32 v50, s14, v50
v_xor_b32 v51, s15, v51
v_xor_b32 v52, v19, v52
v_xor_b32 v53, v19, v53
v_xor_b32 v54, v19, v54
v_or3_b32 v64, v40, v41, v42
v_or3_b32 v65, v43, v44, v45
v_or3_b32 v64, v64, v46, v47
v_or3_b32 v65, v65, v48, v49
v_or3_b32 v64, v64, v50, v51
v_or3_b32 v65, v65, v52, v53
v_or3_b32 v64, v64, v65, v54
v_and_b32 v64, 0xff, v64
v_cmp_ne_u32 vcc, 0, v64
s_cbranch_vccnz L_ga_retry
L_ga_ok:
v_pk_add_f32 v[40:41], v[40:41], v[44:45]
v_pk_add_f32 v[42:43], v[42:43], v[46:47]
v_add_f32 v52, v52, v53
v_pk_add_f32 v[40:41], v[40:41], v[48:49]
v_pk_add_f32 v[42:43], v[42:43], v[50:51]
v_add_f32 v52, v52, v54
v_cvt_pk_bf16_f32 v44, v40, v41
v_cvt_pk_bf16_f32 v45, v42, v43
v_cvt_pk_bf16_f32 v52, v52, v52
v_lshlrev_b32 v40, 16, v44
v_and_b32 v41, 0xffff0000, v44
v_lshlrev_b32 v42, 16, v45
v_and_b32 v43, 0xffff0000, v45
v_lshlrev_b32 v52, 16, v52
v_pk_add_f32 v[40:41], v[40:41], v[252:253] op_sel_hi:[1,0]
v_pk_add_f32 v[42:43], v[42:43], v[252:253] op_sel_hi:[1,0]
v_add_f32 v52, v52, v252
v_cvt_pk_bf16_f32 v44, v40, v41
v_cvt_pk_bf16_f32 v45, v42, v43
v_cvt_pk_bf16_f32 v52, v52, v52
v_lshlrev_b32 v40, 16, v44
v_and_b32 v41, 0xffff0000, v44
v_lshlrev_b32 v42, 16, v45
v_and_b32 v43, 0xffff0000, v45
v_lshlrev_b32 v52, 16, v52
ds_write_b128 v251, v[40:43]
ds_write_b32 v250, v52
s_waitcnt vmcnt(6)
v_cmp_ne_u32 vcc, s40, v71
s_cbranch_vccnz L_fg_retry
L_fg_ok:
s_waitcnt lgkmcnt(0)
s_barrier
buffer_load_dwordx4 a[40:43], v5, s[4:7], s59 offen offset:0 sc1
ds_read_b128 v[200:203], v10 offset:2560
ds_read_b128 v[204:207], v10 offset:2576
ds_read_b128 v[208:211], v10 offset:0
ds_read_b128 v[212:215], v10 offset:16
buffer_load_dwordx4 a[44:47], v5, s[4:7], s59 offen offset:256 sc1
s_mul_i32 s52, s96, 192
s_mul_i32 s49, s3, 3072
s_lshl_b32 s53, s47, 2
s_add_u32 s53, s53, s3
s_and_b32 s50, s53, 63
buffer_load_dwordx4 a[48:51], v5, s[4:7], s59 offen offset:512 sc1
s_waitcnt lgkmcnt(0)
v_pk_fma_f32 v[216:217], v[88:89], v[200:201], v[208:209]
v_cvt_pk_bf16_f32 v220, v216, v217
v_pk_fma_f32 v[218:219], v[90:91], v[202:203], v[210:211]
v_cvt_pk_bf16_f32 v221, v218, v219
buffer_load_dwordx4 a[52:55], v6, s[4:7], s59 offen offset:768 sc1
s_add_u32 s59, s59, 16384
v_pk_fma_f32 v[216:217], v[100:101], v[204:205], v[212:213]
v_cvt_pk_bf16_f32 v222, v216, v217
v_pk_fma_f32 v[218:219], v[102:103], v[206:207], v[214:215]
v_cvt_pk_bf16_f32 v223, v218, v219
ds_write_b128 v7, v[220:223] offset:0
buffer_load_dwordx4 a[56:59], v5, s[4:7], s59 offen offset:0 sc1
v_pk_fma_f32 v[216:217], v[92:93], v[200:201], v[208:209]
v_cvt_pk_bf16_f32 v224, v216, v217
v_pk_fma_f32 v[218:219], v[94:95], v[202:203], v[210:211]
v_cvt_pk_bf16_f32 v225, v218, v219
v_pk_fma_f32 v[216:217], v[120:121], v[204:205], v[212:213]
buffer_load_dwordx4 a[60:63], v5, s[4:7], s59 offen offset:256 sc1
v_cvt_pk_bf16_f32 v226, v216, v217
v_pk_fma_f32 v[218:219], v[122:123], v[206:207], v[214:215]
v_cvt_pk_bf16_f32 v227, v218, v219
ds_write_b128 v253, v[224:227] offset:0
v_pk_fma_f32 v[216:217], v[72:73], v[200:201], v[208:209]
buffer_load_dwordx4 a[64:67], v5, s[4:7], s59 offen offset:512 sc1
v_cvt_pk_bf16_f32 v220, v216, v217
v_pk_fma_f32 v[218:219], v[74:75], v[202:203], v[210:211]
v_cvt_pk_bf16_f32 v221, v218, v219
v_pk_fma_f32 v[216:217], v[140:141], v[204:205], v[212:213]
v_cvt_pk_bf16_f32 v222, v216, v217
buffer_load_dwordx4 a[68:71], v6, s[4:7], s59 offen offset:768 sc1
s_add_u32 s59, s59, 16384
v_pk_fma_f32 v[218:219], v[142:143], v[206:207], v[214:215]
v_cvt_pk_bf16_f32 v223, v218, v219
ds_write_b128 v254, v[220:223] offset:0
v_pk_fma_f32 v[216:217], v[76:77], v[200:201], v[208:209]
v_cvt_pk_bf16_f32 v224, v216, v217
buffer_load_dwordx4 a[72:75], v5, s[4:7], s59 offen offset:0 sc1
v_pk_fma_f32 v[218:219], v[78:79], v[202:203], v[210:211]
v_cvt_pk_bf16_f32 v225, v218, v219
v_pk_fma_f32 v[216:217], v[160:161], v[204:205], v[212:213]
v_cvt_pk_bf16_f32 v226, v216, v217
v_pk_fma_f32 v[218:219], v[162:163], v[206:207], v[214:215]
buffer_load_dwordx4 a[76:79], v5, s[4:7], s59 offen offset:256 sc1
v_cvt_pk_bf16_f32 v227, v218, v219
ds_write_b128 v244, v[224:227] offset:0
v_pk_fma_f32 v[216:217], v[80:81], v[200:201], v[208:209]
v_cvt_pk_bf16_f32 v220, v216, v217
v_pk_fma_f32 v[218:219], v[82:83], v[202:203], v[210:211]
buffer_load_dwordx4 a[80:83], v5, s[4:7], s59 offen offset:512 sc1
v_cvt_pk_bf16_f32 v221, v218, v219
v_pk_fma_f32 v[216:217], v[180:181], v[204:205], v[212:213]
v_cvt_pk_bf16_f32 v222, v216, v217
v_pk_fma_f32 v[218:219], v[182:183], v[206:207], v[214:215]
v_cvt_pk_bf16_f32 v223, v218, v219
buffer_load_dwordx4 a[84:87], v6, s[4:7], s59 offen offset:768 sc1
s_add_u32 s59, s59, 16384
ds_write_b128 v245, v[220:223] offset:0
ds_read_b128 v[200:203], v10 offset:3072
ds_read_b128 v[204:207], v10 offset:3088
ds_read_b128 v[208:211], v10 offset:512
ds_read_b128 v[212:215], v10 offset:528
s_lshl_b32 s50, s50, 5
s_lshr_b32 s54, s53, 6
s_add_u32 s54, s50, s54
s_mul_i32 s50, s54, 1280
s_add_u32 s50, s50, s52
s_lshl_b32 s51, s52, 1
s_add_u32 s51, s51, 65536
s_add_u32 s22, s51, 5120
s_mov_b32 s23, 917504
s_mul_i32 s12, s3, 2304
s_add_u32 s12, s12, 152320
s_add_u32 s13, s49, 122880
s_waitcnt lgkmcnt(4)
s_barrier
ds_read_b128 a[0:3], v8 offset:0
ds_read_b128 a[4:7], v8 offset:1024
ds_read_b128 a[8:11], v8 offset:2048
ds_read_b128 a[12:15], v8 offset:3072
ds_read_b128 a[16:19], v8 offset:4096
s_lshl_b32 s14, s53, 11
s_add_u32 s14, s14, 131072
s_mul_i32 s61, s3, 40
s_add_u32 s61, s61, 138240
s_waitcnt vmcnt(8) lgkmcnt(0)
v_mfma_f32_16x16x32_bf16 v[20:23], a[40:43], a[0:3], 0
ds_read_b128 a[20:23], v9 offset:5120
v_fma_mix_f32 v216, v104, v200, v208 op_sel:[0,0,0] op_sel_hi:[1,0,0]
v_mfma_f32_16x16x32_bf16 v[24:27], a[44:47], a[0:3], 0
buffer_load_dwordx4 a[88:91], v5, s[4:7], s59 offen offset:0 sc1
v_fma_mix_f32 v217, v104, v201, v209 op_sel:[1,0,0] op_sel_hi:[1,0,0]
v_mfma_f32_16x16x32_bf16 v[28:31], a[0:3], a[48:51], 0
ds_read_b128 a[24:27], v9 offset:6144
v_cvt_pk_bf16_f32 v220, v216, v217
v_mfma_f32_16x16x32_bf16 v[32:35], a[52:55], a[0:3], 0
ds_read_b128 a[28:31], v9 offset:7168
v_fma_mix_f32 v218, v105, v202, v210 op_sel:[0,0,0] op_sel_hi:[1,0,0]
v_mfma_f32_16x16x32_bf16 v[36:39], a[40:43], a[4:7], 0
ds_read_b128 a[32:35], v9 offset:8192
v_fma_mix_f32 v219, v105, v203, v211 op_sel:[1,0,0] op_sel_hi:[1,0,0]
v_mfma_f32_16x16x32_bf16 v[40:43], a[44:47], a[4:7], 0
buffer_load_dwordx4 a[92:95], v5, s[4:7], s59 offen offset:256 sc1
v_cvt_pk_bf16_f32 v221, v218, v219
v_mfma_f32_16x16x32_bf16 v[44:47], a[4:7], a[48:51], 0
ds_read_b128 a[36:39], v9 offset:9216
v_fma_mix_f32 v216, v106, v204, v212 op_sel:[0,0,0] op_sel_hi:[1,0,0]
v_mfma_f32_16x16x32_bf16 v[48:51], a[52:55], a[4:7], 0
v_fma_mix_f32 v217, v106, v205, v213 op_sel:[1,0,0] op_sel_hi:[1,0,0]
v_cvt_pk_bf16_f32 v222, v216, v217
v_mfma_f32_16x16x32_bf16 v[52:55], a[40:43], a[8:11], 0
v_fma_mix_f32 v218, v107, v206, v214 op_sel:[0,0,0] op_sel_hi:[1,0,0]
v_fma_mix_f32 v219, v107, v207, v215 op_sel:[1,0,0] op_sel_hi:[1,0,0]
v_mfma_f32_16x16x32_bf16 v[56:59], a[44:47], a[8:11], 0
buffer_load_dwordx4 a[96:99], v5, s[4:7], s59 offen offset:512 sc1
v_cvt_pk_bf16_f32 v223, v218, v219
v_mfma_f32_16x16x32_bf16 v[60:63], a[8:11], a[48:51], 0
v_fma_mix_f32 v216, v124, v200, v208 op_sel:[0,0,0] op_sel_hi:[1,0,0]
v_fma_mix_f32 v217, v124, v201, v209 op_sel:[1,0,0] op_sel_hi:[1,0,0]
v_mfma_f32_16x16x32_bf16 v[64:67], a[52:55], a[8:11], 0
ds_write_b128 v7, v[220:223] offset:20480
v_mfma_f32_16x16x32_bf16 v[68:71], a[40:43], a[12:15], 0
v_cvt_pk_bf16_f32 v224, v216, v217
v_fma_mix_f32 v218, v125, v202, v210 op_sel:[0,0,0] op_sel_hi:[1,0,0]
v_mfma_f32_16x16x32_bf16 v[72:75], a[44:47], a[12:15], 0
buffer_load_dwordx4 a[100:103], v6, s[4:7], s59 offen offset:768 sc1
s_add_u32 s59, s59, 16384
v_mfma_f32_16x16x32_bf16 v[76:79], a[12:15], a[48:51], 0
v_fma_mix_f32 v219, v125, v203, v211 op_sel:[1,0,0] op_sel_hi:[1,0,0]
v_cvt_pk_bf16_f32 v225, v218, v219
v_mfma_f32_16x16x32_bf16 v[80:83], a[52:55], a[12:15], 0
v_fma_mix_f32 v216, v126, v204, v212 op_sel:[0,0,0] op_sel_hi:[1,0,0]
v_fma_mix_f32 v217, v126, v205, v213 op_sel:[1,0,0] op_sel_hi:[1,0,0]
v_mfma_f32_16x16x32_bf16 v[84:87], a[40:43], a[16:19], 0
v_cvt_pk_bf16_f32 v226, v216, v217
v_fma_mix_f32 v218, v127, v206, v214 op_sel:[0,0,0] op_sel_hi:[1,0,0]
v_mfma_f32_16x16x32_bf16 v[88:91], a[44:47], a[16:19], 0
v_fma_mix_f32 v219, v127, v207, v215 op_sel:[1,0,0] op_sel_hi:[1,0,0]
v_cvt_pk_bf16_f32 v227, v218, v219
v_mfma_f32_16x16x32_bf16 v[92:95], a[16:19], a[48:51], 0
v_fma_mix_f32 v216, v144, v200, v208 op_sel:[0,0,0] op_sel_hi:[1,0,0]
v_fma_mix_f32 v217, v144, v201, v209 op_sel:[1,0,0] op_sel_hi:[1,0,0]
v_mfma_f32_16x16x32_bf16 v[96:99], a[52:55], a[16:19], 0
s_waitcnt vmcnt(8) lgkmcnt(1)
v_cvt_pk_bf16_f32 v220, v216, v217
v_fma_mix_f32 v218, v145, v202, v210 op_sel:[0,0,0] op_sel_hi:[1,0,0]
v_mfma_f32_16x16x32_bf16 v[20:23], a[56:59], a[20:23], v[20:23]
ds_read_b128 a[0:3], v8 offset:10240
v_fma_mix_f32 v219, v145, v203, v211 op_sel:[1,0,0] op_sel_hi:[1,0,0]
v_mfma_f32_16x16x32_bf16 v[24:27], a[60:63], a[20:23], v[24:27]
buffer_load_dwordx4 a[104:107], v5, s[4:7], s59 offen offset:0 sc1
v_cvt_pk_bf16_f32 v221, v218, v219
v_mfma_f32_16x16x32_bf16 v[28:31], a[20:23], a[64:67], v[28:31]
ds_read_b128 a[4:7], v8 offset:11264
v_fma_mix_f32 v216, v146, v204, v212 op_sel:[0,0,0] op_sel_hi:[1,0,0]
v_mfma_f32_16x16x32_bf16 v[32:35], a[68:71], a[20:23], v[32:35]
ds_read_b128 a[8:11], v8 offset:12288
v_fma_mix_f32 v217, v146, v205, v213 op_sel:[1,0,0] op_sel_hi:[1,0,0]
v_mfma_f32_16x16x32_bf16 v[36:39], a[56:59], a[24:27], v[36:39]
ds_read_b128 a[12:15], v8 offset:13312
v_cvt_pk_bf16_f32 v222, v216, v217
v_mfma_f32_16x16x32_bf16 v[40:43], a[60:63], a[24:27], v[40:43]
buffer_load_dwordx4 a[108:111], v5, s[4:7], s59 offen offset:256 sc1
v_fma_mix_f32 v218, v147, v206, v214 op_sel:[0,0,0] op_sel_hi:[1,0,0]
v_mfma_f32_16x16x32_bf16 v[44:47], a[24:27], a[64:67], v[44:47]
ds_read_b128 a[16:19], v8 offset:14336
v_fma_mix_f32 v219, v147, v207, v215 op_sel:[1,0,0] op_sel_hi:[1,0,0]
v_mfma_f32_16x16x32_bf16 v[48:51], a[68:71], a[24:27], v[48:51]
ds_write_b128 v253, v[224:227] offset:20480
v_mfma_f32_16x16x32_bf16 v[52:55], a[56:59], a[28:31], v[52:55]
v_cvt_pk_bf16_f32 v223, v218, v219
v_fma_mix_f32 v216, v164, v200, v208 op_sel:[0,0,0] op_sel_hi:[1,0,0]
v_mfma_f32_16x16x32_bf16 v[56:59], a[60:63], a[28:31], v[56:59]
buffer_load_dwordx4 a[112:115], v5, s[4:7], s59 offen offset:512 sc1
v_fma_mix_f32 v217, v164, v201, v209 op_sel:[1,0,0] op_sel_hi:[1,0,0]
v_mfma_f32_16x16x32_bf16 v[60:63], a[28:31], a[64:67], v[60:63]
v_cvt_pk_bf16_f32 v224, v216, v217
v_fma_mix_f32 v218, v165, v202, v210 op_sel:[0,0,0] op_sel_hi:[1,0,0]
v_mfma_f32_16x16x32_bf16 v[64:67], a[68:71], a[28:31], v[64:67]
ds_write_b128 v254, v[220:223] offset:20480
v_mfma_f32_16x16x32_bf16 v[68:71], a[56:59], a[32:35], v[68:71]
v_fma_mix_f32 v219, v165, v203, v211 op_sel:[1,0,0] op_sel_hi:[1,0,0]
v_cvt_pk_bf16_f32 v225, v218, v219
v_mfma_f32_16x16x32_bf16 v[72:75], a[60:63], a[32:35], v[72:75]
buffer_load_dwordx4 a[116:119], v6, s[4:7], s59 offen offset:768 sc1
s_add_u32 s59, s59, 16384
v_mfma_f32_16x16x32_bf16 v[76:79], a[32:35], a[64:67], v[76:79]
v_fma_mix_f32 v216, v166, v204, v212 op_sel:[0,0,0] op_sel_hi:[1,0,0]
v_fma_mix_f32 v217, v166, v205, v213 op_sel:[1,0,0] op_sel_hi:[1,0,0]
v_mfma_f32_16x16x32_bf16 v[80:83], a[68:71], a[32:35], v[80:83]
v_cvt_pk_bf16_f32 v226, v216, v217
v_fma_mix_f32 v218, v167, v206, v214 op_sel:[0,0,0] op_sel_hi:[1,0,0]
v_mfma_f32_16x16x32_bf16 v[84:87], a[56:59], a[36:39], v[84:87]
v_fma_mix_f32 v219, v167, v207, v215 op_sel:[1,0,0] op_sel_hi:[1,0,0]
v_cvt_pk_bf16_f32 v227, v218, v219
v_mfma_f32_16x16x32_bf16 v[88:91], a[60:63], a[36:39], v[88:91]
v_fma_mix_f32 v216, v184, v200, v208 op_sel:[0,0,0] op_sel_hi:[1,0,0]
v_fma_mix_f32 v217, v184, v201, v209 op_sel:[1,0,0] op_sel_hi:[1,0,0]
v_mfma_f32_16x16x32_bf16 v[92:95], a[36:39], a[64:67], v[92:95]
v_cvt_pk_bf16_f32 v220, v216, v217
v_fma_mix_f32 v218, v185, v202, v210 op_sel:[0,0,0] op_sel_hi:[1,0,0]
v_mfma_f32_16x16x32_bf16 v[96:99], a[68:71], a[36:39], v[96:99]
s_waitcnt vmcnt(8) lgkmcnt(2)
v_fma_mix_f32 v219, v185, v203, v211 op_sel:[1,0,0] op_sel_hi:[1,0,0]
v_cvt_pk_bf16_f32 v221, v218, v219
v_mfma_f32_16x16x32_bf16 v[20:23], a[72:75], a[0:3], v[20:23]
ds_read_b128 a[20:23], v9 offset:15360
v_fma_mix_f32 v216, v186, v204, v212 op_sel:[0,0,0] op_sel_hi:[1,0,0]
v_mfma_f32_16x16x32_bf16 v[24:27], a[76:79], a[0:3], v[24:27]
buffer_load_dwordx4 a[120:123], v5, s[4:7], s59 offen offset:0 sc1
v_fma_mix_f32 v217, v186, v205, v213 op_sel:[1,0,0] op_sel_hi:[1,0,0]
v_mfma_f32_16x16x32_bf16 v[28:31], a[0:3], a[80:83], v[28:31]
ds_read_b128 a[24:27], v9 offset:16384
v_cvt_pk_bf16_f32 v222, v216, v217
v_mfma_f32_16x16x32_bf16 v[32:35], a[84:87], a[0:3], v[32:35]
ds_read_b128 a[28:31], v9 offset:17408
v_fma_mix_f32 v218, v187, v206, v214 op_sel:[0,0,0] op_sel_hi:[1,0,0]
v_mfma_f32_16x16x32_bf16 v[36:39], a[72:75], a[4:7], v[36:39]
ds_read_b128 a[32:35], v9 offset:18432
v_fma_mix_f32 v219, v187, v207, v215 op_sel:[1,0,0] op_sel_hi:[1,0,0]
v_mfma_f32_16x16x32_bf16 v[40:43], a[76:79], a[4:7], v[40:43]
buffer_load_dwordx4 a[124:127], v5, s[4:7], s59 offen offset:256 sc1
v_cvt_pk_bf16_f32 v223, v218, v219
v_mfma_f32_16x16x32_bf16 v[44:47], a[4:7], a[80:83], v[44:47]
ds_read_b128 a[36:39], v9 offset:19456
v_bfe_u32 v228, v1, 2, 2
v_mfma_f32_16x16x32_bf16 v[48:51], a[84:87], a[4:7], v[48:51]
ds_write_b128 v244, v[224:227] offset:20480
v_mfma_f32_16x16x32_bf16 v[52:55], a[72:75], a[8:11], v[52:55]
v_lshl_add_u32 v228, v3, 3, v228
v_mul_u32_u24 v228, 192, v228
v_mfma_f32_16x16x32_bf16 v[56:59], a[76:79], a[8:11], v[56:59]
buffer_load_dwordx4 a[128:131], v5, s[4:7], s59 offen offset:512 sc1
v_and_b32 v229, 3, v1
v_mfma_f32_16x16x32_bf16 v[60:63], a[8:11], a[80:83], v[60:63]
v_lshl_add_u32 v228, v229, 3, v228
v_and_b32 v229, 1, v3
v_mfma_f32_16x16x32_bf16 v[64:67], a[84:87], a[8:11], v[64:67]
ds_write_b128 v245, v[220:223] offset:20480
v_mfma_f32_16x16x32_bf16 v[68:71], a[72:75], a[12:15], v[68:71]
v_lshl_add_u32 v249, v229, 5, v228
v_xor_b32 v229, 1, v229
v_mfma_f32_16x16x32_bf16 v[72:75], a[76:79], a[12:15], v[72:75]
buffer_load_dwordx4 a[132:135], v6, s[4:7], s59 offen offset:768 sc1
s_add_u32 s59, s59, 16384
v_mfma_f32_16x16x32_bf16 v[76:79], a[12:15], a[80:83], v[76:79]
v_lshl_add_u32 v252, v229, 5, v228
v_add_u32 v4, 61440, v8
v_mfma_f32_16x16x32_bf16 v[80:83], a[84:87], a[12:15], v[80:83]
ds_read_b128 v[200:203], v10 offset:3584
v_add_u32 v251, 61440, v9
v_mfma_f32_16x16x32_bf16 v[84:87], a[72:75], a[16:19], v[84:87]
ds_read_b128 v[204:207], v10 offset:3600
v_mfma_f32_16x16x32_bf16 v[88:91], a[76:79], a[16:19], v[88:91]
buffer_load_dwordx4 a[136:139], v5, s[4:7], s59 offen offset:0 sc1
v_mfma_f32_16x16x32_bf16 v[92:95], a[16:19], a[80:83], v[92:95]
ds_read_b128 v[208:211], v10 offset:1024
v_mfma_f32_16x16x32_bf16 v[96:99], a[84:87], a[16:19], v[96:99]
s_waitcnt vmcnt(9) lgkmcnt(3)
s_barrier
v_mfma_f32_16x16x32_bf16 v[20:23], a[88:91], a[20:23], v[20:23]
ds_read_b128 a[0:3], v8 offset:20480
v_mfma_f32_16x16x32_bf16 v[24:27], a[92:95], a[20:23], v[24:27]
buffer_load_dwordx4 a[140:143], v5, s[4:7], s59 offen offset:256 sc1
v_mfma_f32_16x16x32_bf16 v[28:31], a[20:23], a[96:99], v[28:31]
ds_read_b128 a[4:7], v8 offset:21504
v_mfma_f32_16x16x32_bf16 v[32:35], a[100:103], a[20:23], v[32:35]
ds_read_b128 a[8:11], v8 offset:22528
v_mfma_f32_16x16x32_bf16 v[36:39], a[88:91], a[24:27], v[36:39]
ds_read_b128 a[12:15], v8 offset:23552
v_mfma_f32_16x16x32_bf16 v[40:43], a[92:95], a[24:27], v[40:43]
buffer_load_dwordx4 a[144:147], v5, s[4:7], s59 offen offset:512 sc1
v_mfma_f32_16x16x32_bf16 v[44:47], a[24:27], a[96:99], v[44:47]
ds_read_b128 a[16:19], v8 offset:24576
v_mfma_f32_16x16x32_bf16 v[48:51], a[100:103], a[24:27], v[48:51]
ds_read_b128 v[212:215], v10 offset:1040
v_mfma_f32_16x16x32_bf16 v[52:55], a[88:91], a[28:31], v[52:55]
v_mfma_f32_16x16x32_bf16 v[56:59], a[92:95], a[28:31], v[56:59]
buffer_store_dwordx4 v[240:243], v246, s[4:7], s100 offen sc1
v_mfma_f32_16x16x32_bf16 v[60:63], a[28:31], a[96:99], v[60:63]
v_mfma_f32_16x16x32_bf16 v[64:67], a[100:103], a[28:31], v[64:67]
s_waitcnt lgkmcnt(0)
v_fma_mix_f32 v216, v108, v200, v208 op_sel:[0,0,0] op_sel_hi:[1,0,0]
v_fma_mix_f32 v217, v108, v201, v209 op_sel:[1,0,0] op_sel_hi:[1,0,0]
v_mfma_f32_16x16x32_bf16 v[68:71], a[88:91], a[32:35], v[68:71]
v_cvt_pk_bf16_f32 v220, v216, v217
v_fma_mix_f32 v218, v109, v202, v210 op_sel:[0,0,0] op_sel_hi:[1,0,0]
v_mfma_f32_16x16x32_bf16 v[72:75], a[92:95], a[32:35], v[72:75]
buffer_load_dwordx4 a[148:151], v6, s[4:7], s59 offen offset:768 sc1
s_add_u32 s59, s59, 16384
v_mfma_f32_16x16x32_bf16 v[76:79], a[32:35], a[96:99], v[76:79]
v_fma_mix_f32 v219, v109, v203, v211 op_sel:[1,0,0] op_sel_hi:[1,0,0]
v_cvt_pk_bf16_f32 v221, v218, v219
v_mfma_f32_16x16x32_bf16 v[80:83], a[100:103], a[32:35], v[80:83]
v_fma_mix_f32 v216, v110, v204, v212 op_sel:[0,0,0] op_sel_hi:[1,0,0]
v_fma_mix_f32 v217, v110, v205, v213 op_sel:[1,0,0] op_sel_hi:[1,0,0]
v_mfma_f32_16x16x32_bf16 v[84:87], a[88:91], a[36:39], v[84:87]
v_cvt_pk_bf16_f32 v222, v216, v217
v_fma_mix_f32 v218, v111, v206, v214 op_sel:[0,0,0] op_sel_hi:[1,0,0]
v_mfma_f32_16x16x32_bf16 v[88:91], a[92:95], a[36:39], v[88:91]
v_fma_mix_f32 v219, v111, v207, v215 op_sel:[1,0,0] op_sel_hi:[1,0,0]
v_cvt_pk_bf16_f32 v223, v218, v219
v_mfma_f32_16x16x32_bf16 v[92:95], a[36:39], a[96:99], v[92:95]
v_fma_mix_f32 v216, v128, v200, v208 op_sel:[0,0,0] op_sel_hi:[1,0,0]
v_fma_mix_f32 v217, v128, v201, v209 op_sel:[1,0,0] op_sel_hi:[1,0,0]
v_mfma_f32_16x16x32_bf16 v[96:99], a[100:103], a[36:39], v[96:99]
s_waitcnt vmcnt(9)
v_cvt_pk_bf16_f32 v224, v216, v217
v_fma_mix_f32 v218, v129, v202, v210 op_sel:[0,0,0] op_sel_hi:[1,0,0]
v_mfma_f32_16x16x32_bf16 v[20:23], a[104:107], a[0:3], v[20:23]
ds_read_b128 a[20:23], v9 offset:25600
v_fma_mix_f32 v219, v129, v203, v211 op_sel:[1,0,0] op_sel_hi:[1,0,0]
v_mfma_f32_16x16x32_bf16 v[24:27], a[108:111], a[0:3], v[24:27]
buffer_load_dwordx4 a[152:155], v5, s[4:7], s59 offen offset:0 sc1
v_cvt_pk_bf16_f32 v225, v218, v219
v_mfma_f32_16x16x32_bf16 v[28:31], a[0:3], a[112:115], v[28:31]
ds_read_b128 a[24:27], v9 offset:26624
v_fma_mix_f32 v216, v130, v204, v212 op_sel:[0,0,0] op_sel_hi:[1,0,0]
v_mfma_f32_16x16x32_bf16 v[32:35], a[116:119], a[0:3], v[32:35]
ds_read_b128 a[28:31], v9 offset:27648
v_fma_mix_f32 v217, v130, v205, v213 op_sel:[1,0,0] op_sel_hi:[1,0,0]
v_mfma_f32_16x16x32_bf16 v[36:39], a[104:107], a[4:7], v[36:39]
ds_read_b128 a[32:35], v9 offset:28672
v_cvt_pk_bf16_f32 v226, v216, v217
v_mfma_f32_16x16x32_bf16 v[40:43], a[108:111], a[4:7], v[40:43]
buffer_load_dwordx4 a[156:159], v5, s[4:7], s59 offen offset:256 sc1
v_fma_mix_f32 v218, v131, v206, v214 op_sel:[0,0,0] op_sel_hi:[1,0,0]
v_mfma_f32_16x16x32_bf16 v[44:47], a[4:7], a[112:115], v[44:47]
ds_read_b128 a[36:39], v9 offset:29696
v_fma_mix_f32 v219, v131, v207, v215 op_sel:[1,0,0] op_sel_hi:[1,0,0]
v_mfma_f32_16x16x32_bf16 v[48:51], a[116:119], a[4:7], v[48:51]
ds_write_b128 v7, v[220:223] offset:40960
v_mfma_f32_16x16x32_bf16 v[52:55], a[104:107], a[8:11], v[52:55]
v_cvt_pk_bf16_f32 v227, v218, v219
v_fma_mix_f32 v216, v148, v200, v208 op_sel:[0,0,0] op_sel_hi:[1,0,0]
v_mfma_f32_16x16x32_bf16 v[56:59], a[108:111], a[8:11], v[56:59]
buffer_load_dwordx4 a[160:163], v5, s[4:7], s59 offen offset:512 sc1
v_fma_mix_f32 v217, v148, v201, v209 op_sel:[1,0,0] op_sel_hi:[1,0,0]
v_mfma_f32_16x16x32_bf16 v[60:63], a[8:11], a[112:115], v[60:63]
v_cvt_pk_bf16_f32 v220, v216, v217
v_fma_mix_f32 v218, v149, v202, v210 op_sel:[0,0,0] op_sel_hi:[1,0,0]
v_mfma_f32_16x16x32_bf16 v[64:67], a[116:119], a[8:11], v[64:67]
ds_write_b128 v253, v[224:227] offset:40960
v_mfma_f32_16x16x32_bf16 v[68:71], a[104:107], a[12:15], v[68:71]
v_fma_mix_f32 v219, v149, v203, v211 op_sel:[1,0,0] op_sel_hi:[1,0,0]
v_cvt_pk_bf16_f32 v221, v218, v219
v_mfma_f32_16x16x32_bf16 v[72:75], a[108:111], a[12:15], v[72:75]
buffer_load_dwordx4 a[164:167], v6, s[4:7], s59 offen offset:768 sc1
s_add_u32 s59, s59, 16384
v_mfma_f32_16x16x32_bf16 v[76:79], a[12:15], a[112:115], v[76:79]
v_fma_mix_f32 v216, v150, v204, v212 op_sel:[0,0,0] op_sel_hi:[1,0,0]
v_fma_mix_f32 v217, v150, v205, v213 op_sel:[1,0,0] op_sel_hi:[1,0,0]
v_mfma_f32_16x16x32_bf16 v[80:83], a[116:119], a[12:15], v[80:83]
v_cvt_pk_bf16_f32 v222, v216, v217
v_fma_mix_f32 v218, v151, v206, v214 op_sel:[0,0,0] op_sel_hi:[1,0,0]
v_mfma_f32_16x16x32_bf16 v[84:87], a[104:107], a[16:19], v[84:87]
v_fma_mix_f32 v219, v151, v207, v215 op_sel:[1,0,0] op_sel_hi:[1,0,0]
v_cvt_pk_bf16_f32 v223, v218, v219
v_mfma_f32_16x16x32_bf16 v[88:91], a[108:111], a[16:19], v[88:91]
buffer_load_dwordx4 a[168:171], v5, s[4:7], s59 offen offset:0 sc1
v_fma_mix_f32 v216, v168, v200, v208 op_sel:[0,0,0] op_sel_hi:[1,0,0]
v_mfma_f32_16x16x32_bf16 v[92:95], a[16:19], a[112:115], v[92:95]
v_fma_mix_f32 v217, v168, v201, v209 op_sel:[1,0,0] op_sel_hi:[1,0,0]
v_cvt_pk_bf16_f32 v224, v216, v217
v_mfma_f32_16x16x32_bf16 v[96:99], a[116:119], a[16:19], v[96:99]
s_waitcnt vmcnt(10) lgkmcnt(2)
v_fma_mix_f32 v218, v169, v202, v210 op_sel:[0,0,0] op_sel_hi:[1,0,0]
v_fma_mix_f32 v219, v169, v203, v211 op_sel:[1,0,0] op_sel_hi:[1,0,0]
v_mfma_f32_16x16x32_bf16 v[20:23], a[120:123], a[20:23], v[20:23]
ds_read_b128 a[0:3], v8 offset:30720
v_cvt_pk_bf16_f32 v225, v218, v219
v_mfma_f32_16x16x32_bf16 v[24:27], a[124:127], a[20:23], v[24:27]
buffer_load_dwordx4 a[172:175], v5, s[4:7], s59 offen offset:256 sc1
v_fma_mix_f32 v216, v170, v204, v212 op_sel:[0,0,0] op_sel_hi:[1,0,0]
v_mfma_f32_16x16x32_bf16 v[28:31], a[20:23], a[128:131], v[28:31]
ds_read_b128 a[4:7], v8 offset:31744
v_fma_mix_f32 v217, v170, v205, v213 op_sel:[1,0,0] op_sel_hi:[1,0,0]
v_mfma_f32_16x16x32_bf16 v[32:35], a[132:135], a[20:23], v[32:35]
ds_read_b128 a[8:11], v8 offset:32768
v_cvt_pk_bf16_f32 v226, v216, v217
v_mfma_f32_16x16x32_bf16 v[36:39], a[120:123], a[24:27], v[36:39]
ds_read_b128 a[12:15], v8 offset:33792
v_fma_mix_f32 v218, v171, v206, v214 op_sel:[0,0,0] op_sel_hi:[1,0,0]
v_mfma_f32_16x16x32_bf16 v[40:43], a[124:127], a[24:27], v[40:43]
buffer_load_dwordx4 a[176:179], v5, s[4:7], s59 offen offset:512 sc1
v_fma_mix_f32 v219, v171, v207, v215 op_sel:[1,0,0] op_sel_hi:[1,0,0]
v_mfma_f32_16x16x32_bf16 v[44:47], a[24:27], a[128:131], v[44:47]
ds_read_b128 a[16:19], v8 offset:34816
v_cvt_pk_bf16_f32 v227, v218, v219
v_mfma_f32_16x16x32_bf16 v[48:51], a[132:135], a[24:27], v[48:51]
ds_write_b128 v254, v[220:223] offset:40960
v_mfma_f32_16x16x32_bf16 v[52:55], a[120:123], a[28:31], v[52:55]
v_fma_mix_f32 v216, v188, v200, v208 op_sel:[0,0,0] op_sel_hi:[1,0,0]
v_fma_mix_f32 v217, v188, v201, v209 op_sel:[1,0,0] op_sel_hi:[1,0,0]
v_mfma_f32_16x16x32_bf16 v[56:59], a[124:127], a[28:31], v[56:59]
buffer_load_dwordx4 a[180:183], v6, s[4:7], s59 offen offset:768 sc1
s_add_u32 s59, s59, 16384
v_mfma_f32_16x16x32_bf16 v[60:63], a[28:31], a[128:131], v[60:63]
v_cvt_pk_bf16_f32 v220, v216, v217
v_fma_mix_f32 v218, v189, v202, v210 op_sel:[0,0,0] op_sel_hi:[1,0,0]
v_mfma_f32_16x16x32_bf16 v[64:67], a[132:135], a[28:31], v[64:67]
ds_write_b128 v244, v[224:227] offset:40960
v_mfma_f32_16x16x32_bf16 v[68:71], a[120:123], a[32:35], v[68:71]
v_fma_mix_f32 v219, v189, v203, v211 op_sel:[1,0,0] op_sel_hi:[1,0,0]
v_cvt_pk_bf16_f32 v221, v218, v219
v_mfma_f32_16x16x32_bf16 v[72:75], a[124:127], a[32:35], v[72:75]
buffer_load_dwordx4 a[184:187], v5, s[4:7], s59 offen offset:0 sc1
v_fma_mix_f32 v216, v190, v204, v212 op_sel:[0,0,0] op_sel_hi:[1,0,0]
v_mfma_f32_16x16x32_bf16 v[76:79], a[32:35], a[128:131], v[76:79]
v_fma_mix_f32 v217, v190, v205, v213 op_sel:[1,0,0] op_sel_hi:[1,0,0]
v_cvt_pk_bf16_f32 v222, v216, v217
v_mfma_f32_16x16x32_bf16 v[80:83], a[132:135], a[32:35], v[80:83]
v_fma_mix_f32 v218, v191, v206, v214 op_sel:[0,0,0] op_sel_hi:[1,0,0]
v_fma_mix_f32 v219, v191, v207, v215 op_sel:[1,0,0] op_sel_hi:[1,0,0]
v_mfma_f32_16x16x32_bf16 v[84:87], a[120:123], a[36:39], v[84:87]
v_cvt_pk_bf16_f32 v223, v218, v219
v_add_u32 v7, 61440, v7
v_mfma_f32_16x16x32_bf16 v[88:91], a[124:127], a[36:39], v[88:91]
v_add_u32 v253, 61440, v253
v_add_u32 v254, 61440, v254
v_mfma_f32_16x16x32_bf16 v[92:95], a[36:39], a[128:131], v[92:95]
v_add_u32 v244, 61440, v244
v_mfma_f32_16x16x32_bf16 v[96:99], a[132:135], a[36:39], v[96:99]
s_waitcnt vmcnt(9) lgkmcnt(2)
v_mfma_f32_16x16x32_bf16 v[20:23], a[136:139], a[0:3], v[20:23]
ds_read_b128 a[20:23], v9 offset:35840
v_mfma_f32_16x16x32_bf16 v[24:27], a[140:143], a[0:3], v[24:27]
buffer_load_dwordx4 a[188:191], v5, s[4:7], s59 offen offset:256 sc1
v_mfma_f32_16x16x32_bf16 v[28:31], a[0:3], a[144:147], v[28:31]
ds_read_b128 a[24:27], v9 offset:36864
v_mfma_f32_16x16x32_bf16 v[32:35], a[148:151], a[0:3], v[32:35]
ds_read_b128 a[28:31], v9 offset:37888
v_mfma_f32_16x16x32_bf16 v[36:39], a[136:139], a[4:7], v[36:39]
ds_read_b128 a[32:35], v9 offset:38912
v_mfma_f32_16x16x32_bf16 v[40:43], a[140:143], a[4:7], v[40:43]
buffer_load_dwordx4 a[192:195], v5, s[4:7], s59 offen offset:512 sc1
v_mfma_f32_16x16x32_bf16 v[44:47], a[4:7], a[144:147], v[44:47]
ds_read_b128 a[36:39], v9 offset:39936
v_mfma_f32_16x16x32_bf16 v[48:51], a[148:151], a[4:7], v[48:51]
ds_write_b128 v245, v[220:223] offset:40960
v_mfma_f32_16x16x32_bf16 v[52:55], a[136:139], a[8:11], v[52:55]
v_add_u32 v245, 61440, v245
v_mfma_f32_16x16x32_bf16 v[56:59], a[140:143], a[8:11], v[56:59]
buffer_load_dwordx4 a[196:199], v6, s[4:7], s59 offen offset:768 sc1
s_add_u32 s59, s59, 16384
v_mfma_f32_16x16x32_bf16 v[60:63], a[8:11], a[144:147], v[60:63]
v_mfma_f32_16x16x32_bf16 v[64:67], a[148:151], a[8:11], v[64:67]
ds_read_b128 v[200:203], v10 offset:4096
v_mfma_f32_16x16x32_bf16 v[68:71], a[136:139], a[12:15], v[68:71]
ds_read_b128 v[204:207], v10 offset:4112
v_mfma_f32_16x16x32_bf16 v[72:75], a[140:143], a[12:15], v[72:75]
buffer_load_dwordx4 a[200:203], v5, s[4:7], s59 offen offset:0 sc1
v_mfma_f32_16x16x32_bf16 v[76:79], a[12:15], a[144:147], v[76:79]
ds_read_b128 v[208:211], v10 offset:1536
v_mfma_f32_16x16x32_bf16 v[80:83], a[148:151], a[12:15], v[80:83]
ds_read_b128 v[212:215], v10 offset:1552
v_mfma_f32_16x16x32_bf16 v[84:87], a[136:139], a[16:19], v[84:87]
v_mfma_f32_16x16x32_bf16 v[88:91], a[140:143], a[16:19], v[88:91]
v_mfma_f32_16x16x32_bf16 v[92:95], a[16:19], a[144:147], v[92:95]
v_mfma_f32_16x16x32_bf16 v[96:99], a[148:151], a[16:19], v[96:99]
s_waitcnt vmcnt(9) lgkmcnt(4)
s_barrier
s_waitcnt lgkmcnt(0)
v_mfma_f32_16x16x32_bf16 v[20:23], a[152:155], a[20:23], v[20:23]
ds_read_b128 a[0:3], v8 offset:40960
v_fma_mix_f32 v216, v112, v200, v208 op_sel:[0,0,0] op_sel_hi:[1,0,0]
v_mfma_f32_16x16x32_bf16 v[24:27], a[156:159], a[20:23], v[24:27]
buffer_load_dwordx4 a[204:207], v5, s[4:7], s59 offen offset:256 sc1
v_fma_mix_f32 v217, v112, v201, v209 op_sel:[1,0,0] op_sel_hi:[1,0,0]
v_mfma_f32_16x16x32_bf16 v[28:31], a[20:23], a[160:163], v[28:31]
ds_read_b128 a[4:7], v8 offset:41984
v_cvt_pk_bf16_f32 v220, v216, v217
v_mfma_f32_16x16x32_bf16 v[32:35], a[164:167], a[20:23], v[32:35]
ds_read_b128 a[8:11], v8 offset:43008
v_fma_mix_f32 v218, v113, v202, v210 op_sel:[0,0,0] op_sel_hi:[1,0,0]
v_mfma_f32_16x16x32_bf16 v[36:39], a[152:155], a[24:27], v[36:39]
ds_read_b128 a[12:15], v8 offset:44032
v_fma_mix_f32 v219, v113, v203, v211 op_sel:[1,0,0] op_sel_hi:[1,0,0]
v_mfma_f32_16x16x32_bf16 v[40:43], a[156:159], a[24:27], v[40:43]
buffer_load_dwordx4 a[208:211], v5, s[4:7], s59 offen offset:512 sc1
v_cvt_pk_bf16_f32 v221, v218, v219
v_mfma_f32_16x16x32_bf16 v[44:47], a[24:27], a[160:163], v[44:47]
ds_read_b128 a[16:19], v8 offset:45056
v_fma_mix_f32 v216, v114, v204, v212 op_sel:[0,0,0] op_sel_hi:[1,0,0]
v_mfma_f32_16x16x32_bf16 v[48:51], a[164:167], a[24:27], v[48:51]
v_fma_mix_f32 v217, v114, v205, v213 op_sel:[1,0,0] op_sel_hi:[1,0,0]
v_cvt_pk_bf16_f32 v222, v216, v217
v_mfma_f32_16x16x32_bf16 v[52:55], a[152:155], a[28:31], v[52:55]
v_fma_mix_f32 v218, v115, v206, v214 op_sel:[0,0,0] op_sel_hi:[1,0,0]
v_fma_mix_f32 v219, v115, v207, v215 op_sel:[1,0,0] op_sel_hi:[1,0,0]
v_mfma_f32_16x16x32_bf16 v[56:59], a[156:159], a[28:31], v[56:59]
buffer_load_dwordx4 a[212:215], v6, s[4:7], s59 offen offset:768 sc1
s_add_u32 s59, s59, 16384
v_mfma_f32_16x16x32_bf16 v[60:63], a[28:31], a[160:163], v[60:63]
v_cvt_pk_bf16_f32 v223, v218, v219
v_fma_mix_f32 v216, v132, v200, v208 op_sel:[0,0,0] op_sel_hi:[1,0,0]
v_mfma_f32_16x16x32_bf16 v[64:67], a[164:167], a[28:31], v[64:67]
v_fma_mix_f32 v217, v132, v201, v209 op_sel:[1,0,0] op_sel_hi:[1,0,0]
v_cvt_pk_bf16_f32 v224, v216, v217
v_mfma_f32_16x16x32_bf16 v[68:71], a[152:155], a[32:35], v[68:71]
ds_write_b128 v7, v[220:223] offset:0
v_mfma_f32_16x16x32_bf16 v[72:75], a[156:159], a[32:35], v[72:75]
buffer_load_dwordx4 a[216:219], v5, s[4:7], s59 offen offset:0 sc1
v_fma_mix_f32 v218, v133, v202, v210 op_sel:[0,0,0] op_sel_hi:[1,0,0]
v_mfma_f32_16x16x32_bf16 v[76:79], a[32:35], a[160:163], v[76:79]
v_fma_mix_f32 v219, v133, v203, v211 op_sel:[1,0,0] op_sel_hi:[1,0,0]
v_cvt_pk_bf16_f32 v225, v218, v219
v_mfma_f32_16x16x32_bf16 v[80:83], a[164:167], a[32:35], v[80:83]
v_fma_mix_f32 v216, v134, v204, v212 op_sel:[0,0,0] op_sel_hi:[1,0,0]
v_fma_mix_f32 v217, v134, v205, v213 op_sel:[1,0,0] op_sel_hi:[1,0,0]
v_mfma_f32_16x16x32_bf16 v[84:87], a[152:155], a[36:39], v[84:87]
v_cvt_pk_bf16_f32 v226, v216, v217
v_fma_mix_f32 v218, v135, v206, v214 op_sel:[0,0,0] op_sel_hi:[1,0,0]
v_mfma_f32_16x16x32_bf16 v[88:91], a[156:159], a[36:39], v[88:91]
buffer_load_dwordx4 a[220:223], v5, s[4:7], s59 offen offset:256 sc1
v_fma_mix_f32 v219, v135, v207, v215 op_sel:[1,0,0] op_sel_hi:[1,0,0]
v_mfma_f32_16x16x32_bf16 v[92:95], a[36:39], a[160:163], v[92:95]
v_cvt_pk_bf16_f32 v227, v218, v219
v_fma_mix_f32 v216, v152, v200, v208 op_sel:[0,0,0] op_sel_hi:[1,0,0]
v_mfma_f32_16x16x32_bf16 v[96:99], a[164:167], a[36:39], v[96:99]
s_waitcnt vmcnt(10) lgkmcnt(1)
v_fma_mix_f32 v217, v152, v201, v209 op_sel:[1,0,0] op_sel_hi:[1,0,0]
v_cvt_pk_bf16_f32 v220, v216, v217
v_mfma_f32_16x16x32_bf16 v[20:23], a[168:171], a[0:3], v[20:23]
ds_read_b128 a[20:23], v9 offset:46080
v_fma_mix_f32 v218, v153, v202, v210 op_sel:[0,0,0] op_sel_hi:[1,0,0]
v_mfma_f32_16x16x32_bf16 v[24:27], a[172:175], a[0:3], v[24:27]
buffer_load_dwordx4 a[224:227], v5, s[4:7], s59 offen offset:512 sc1
v_fma_mix_f32 v219, v153, v203, v211 op_sel:[1,0,0] op_sel_hi:[1,0,0]
v_mfma_f32_16x16x32_bf16 v[28:31], a[0:3], a[176:179], v[28:31]
ds_read_b128 a[24:27], v9 offset:47104
v_cvt_pk_bf16_f32 v221, v218, v219
v_mfma_f32_16x16x32_bf16 v[32:35], a[180:183], a[0:3], v[32:35]
ds_read_b128 a[28:31], v9 offset:48128
v_fma_mix_f32 v216, v154, v204, v212 op_sel:[0,0,0] op_sel_hi:[1,0,0]
v_mfma_f32_16x16x32_bf16 v[36:39], a[168:171], a[4:7], v[36:39]
ds_read_b128 a[32:35], v9 offset:49152
v_fma_mix_f32 v217, v154, v205, v213 op_sel:[1,0,0] op_sel_hi:[1,0,0]
v_mfma_f32_16x16x32_bf16 v[40:43], a[172:175], a[4:7], v[40:43]
buffer_load_dwordx4 a[228:231], v6, s[4:7], s59 offen offset:768 sc1
s_add_u32 s59, s59, 16384
v_mfma_f32_16x16x32_bf16 v[44:47], a[4:7], a[176:179], v[44:47]
ds_read_b128 a[36:39], v9 offset:50176
v_cvt_pk_bf16_f32 v222, v216, v217
v_mfma_f32_16x16x32_bf16 v[48:51], a[180:183], a[4:7], v[48:51]
ds_write_b128 v253, v[224:227] offset:0
v_mfma_f32_16x16x32_bf16 v[52:55], a[168:171], a[8:11], v[52:55]
v_fma_mix_f32 v218, v155, v206, v214 op_sel:[0,0,0] op_sel_hi:[1,0,0]
v_fma_mix_f32 v219, v155, v207, v215 op_sel:[1,0,0] op_sel_hi:[1,0,0]
v_mfma_f32_16x16x32_bf16 v[56:59], a[172:175], a[8:11], v[56:59]
buffer_load_dwordx4 a[40:43], v5, s[4:7], s59 offen offset:0 sc1
v_cvt_pk_bf16_f32 v223, v218, v219
v_mfma_f32_16x16x32_bf16 v[60:63], a[8:11], a[176:179], v[60:63]
v_fma_mix_f32 v216, v172, v200, v208 op_sel:[0,0,0] op_sel_hi:[1,0,0]
v_fma_mix_f32 v217, v172, v201, v209 op_sel:[1,0,0] op_sel_hi:[1,0,0]
v_mfma_f32_16x16x32_bf16 v[64:67], a[180:183], a[8:11], v[64:67]
ds_write_b128 v254, v[220:223] offset:0
v_mfma_f32_16x16x32_bf16 v[68:71], a[168:171], a[12:15], v[68:71]
v_cvt_pk_bf16_f32 v224, v216, v217
v_fma_mix_f32 v218, v173, v202, v210 op_sel:[0,0,0] op_sel_hi:[1,0,0]
v_mfma_f32_16x16x32_bf16 v[72:75], a[172:175], a[12:15], v[72:75]
buffer_load_dwordx4 a[44:47], v5, s[4:7], s59 offen offset:256 sc1
v_fma_mix_f32 v219, v173, v203, v211 op_sel:[1,0,0] op_sel_hi:[1,0,0]
v_mfma_f32_16x16x32_bf16 v[76:79], a[12:15], a[176:179], v[76:79]
v_cvt_pk_bf16_f32 v225, v218, v219
v_fma_mix_f32 v216, v174, v204, v212 op_sel:[0,0,0] op_sel_hi:[1,0,0]
v_mfma_f32_16x16x32_bf16 v[80:83], a[180:183], a[12:15], v[80:83]
v_fma_mix_f32 v217, v174, v205, v213 op_sel:[1,0,0] op_sel_hi:[1,0,0]
v_cvt_pk_bf16_f32 v226, v216, v217
v_mfma_f32_16x16x32_bf16 v[84:87], a[168:171], a[16:19], v[84:87]
v_fma_mix_f32 v218, v175, v206, v214 op_sel:[0,0,0] op_sel_hi:[1,0,0]
v_fma_mix_f32 v219, v175, v207, v215 op_sel:[1,0,0] op_sel_hi:[1,0,0]
v_mfma_f32_16x16x32_bf16 v[88:91], a[172:175], a[16:19], v[88:91]
v_cvt_pk_bf16_f32 v227, v218, v219
v_fma_mix_f32 v216, v192, v200, v208 op_sel:[0,0,0] op_sel_hi:[1,0,0]
v_mfma_f32_16x16x32_bf16 v[92:95], a[16:19], a[176:179], v[92:95]
v_fma_mix_f32 v217, v192, v201, v209 op_sel:[1,0,0] op_sel_hi:[1,0,0]
v_cvt_pk_bf16_f32 v220, v216, v217
v_mfma_f32_16x16x32_bf16 v[96:99], a[180:183], a[16:19], v[96:99]
s_waitcnt vmcnt(10) lgkmcnt(2)
v_fma_mix_f32 v218, v193, v202, v210 op_sel:[0,0,0] op_sel_hi:[1,0,0]
v_fma_mix_f32 v219, v193, v203, v211 op_sel:[1,0,0] op_sel_hi:[1,0,0]
v_mfma_f32_16x16x32_bf16 v[20:23], a[184:187], a[20:23], v[20:23]
ds_read_b128 a[0:3], v8 offset:51200
v_cvt_pk_bf16_f32 v221, v218, v219
v_mfma_f32_16x16x32_bf16 v[24:27], a[188:191], a[20:23], v[24:27]
buffer_load_dwordx4 a[48:51], v5, s[4:7], s59 offen offset:512 sc1
v_fma_mix_f32 v216, v194, v204, v212 op_sel:[0,0,0] op_sel_hi:[1,0,0]
v_mfma_f32_16x16x32_bf16 v[28:31], a[20:23], a[192:195], v[28:31]
ds_read_b128 a[4:7], v8 offset:52224
v_fma_mix_f32 v217, v194, v205, v213 op_sel:[1,0,0] op_sel_hi:[1,0,0]
v_mfma_f32_16x16x32_bf16 v[32:35], a[196:199], a[20:23], v[32:35]
ds_read_b128 a[8:11], v8 offset:53248
v_cvt_pk_bf16_f32 v222, v216, v217
v_mfma_f32_16x16x32_bf16 v[36:39], a[184:187], a[24:27], v[36:39]
ds_read_b128 a[12:15], v8 offset:54272
v_fma_mix_f32 v218, v195, v206, v214 op_sel:[0,0,0] op_sel_hi:[1,0,0]
v_mfma_f32_16x16x32_bf16 v[40:43], a[188:191], a[24:27], v[40:43]
buffer_load_dwordx4 a[52:55], v6, s[4:7], s59 offen offset:768 sc1
s_add_u32 s59, s59, 16384
v_mfma_f32_16x16x32_bf16 v[44:47], a[24:27], a[192:195], v[44:47]
ds_read_b128 a[16:19], v8 offset:55296
v_fma_mix_f32 v219, v195, v207, v215 op_sel:[1,0,0] op_sel_hi:[1,0,0]
v_mfma_f32_16x16x32_bf16 v[48:51], a[196:199], a[24:27], v[48:51]
ds_write_b128 v244, v[224:227] offset:0
v_mfma_f32_16x16x32_bf16 v[52:55], a[184:187], a[28:31], v[52:55]
v_cvt_pk_bf16_f32 v223, v218, v219
v_mfma_f32_16x16x32_bf16 v[56:59], a[188:191], a[28:31], v[56:59]
buffer_load_dwordx4 a[56:59], v5, s[4:7], s59 offen offset:0 sc1
v_mfma_f32_16x16x32_bf16 v[60:63], a[28:31], a[192:195], v[60:63]
v_mfma_f32_16x16x32_bf16 v[64:67], a[196:199], a[28:31], v[64:67]
ds_write_b128 v245, v[220:223] offset:0
v_mfma_f32_16x16x32_bf16 v[68:71], a[184:187], a[32:35], v[68:71]
v_mfma_f32_16x16x32_bf16 v[72:75], a[188:191], a[32:35], v[72:75]
buffer_load_dwordx4 a[60:63], v5, s[4:7], s59 offen offset:256 sc1
v_mfma_f32_16x16x32_bf16 v[76:79], a[32:35], a[192:195], v[76:79]
v_mfma_f32_16x16x32_bf16 v[80:83], a[196:199], a[32:35], v[80:83]
ds_read_b128 v[200:203], v10 offset:4608
v_mfma_f32_16x16x32_bf16 v[84:87], a[184:187], a[36:39], v[84:87]
ds_read_b128 v[204:207], v10 offset:4624
v_mfma_f32_16x16x32_bf16 v[88:91], a[188:191], a[36:39], v[88:91]
buffer_load_dwordx4 a[64:67], v5, s[4:7], s59 offen offset:512 sc1
v_mfma_f32_16x16x32_bf16 v[92:95], a[36:39], a[192:195], v[92:95]
ds_read_b128 v[208:211], v10 offset:2048
v_mfma_f32_16x16x32_bf16 v[96:99], a[196:199], a[36:39], v[96:99]
s_waitcnt vmcnt(11) lgkmcnt(5)
v_mfma_f32_16x16x32_bf16 v[20:23], a[200:203], a[0:3], v[20:23]
ds_read_b128 a[20:23], v9 offset:56320
v_mfma_f32_16x16x32_bf16 v[24:27], a[204:207], a[0:3], v[24:27]
buffer_load_dwordx4 a[68:71], v6, s[4:7], s59 offen offset:768 sc1
s_add_u32 s59, s59, 16384
v_mfma_f32_16x16x32_bf16 v[28:31], a[0:3], a[208:211], v[28:31]
ds_read_b128 a[24:27], v9 offset:57344
v_mfma_f32_16x16x32_bf16 v[32:35], a[212:215], a[0:3], v[32:35]
ds_read_b128 a[28:31], v9 offset:58368
v_mfma_f32_16x16x32_bf16 v[36:39], a[200:203], a[4:7], v[36:39]
ds_read_b128 a[32:35], v9 offset:59392
v_mfma_f32_16x16x32_bf16 v[40:43], a[204:207], a[4:7], v[40:43]
buffer_load_dwordx4 a[72:75], v5, s[4:7], s59 offen offset:0 sc1
v_mfma_f32_16x16x32_bf16 v[44:47], a[4:7], a[208:211], v[44:47]
ds_read_b128 a[36:39], v9 offset:60416
v_mfma_f32_16x16x32_bf16 v[48:51], a[212:215], a[4:7], v[48:51]
ds_read_b128 v[212:215], v10 offset:2064
v_mfma_f32_16x16x32_bf16 v[52:55], a[200:203], a[8:11], v[52:55]
v_mfma_f32_16x16x32_bf16 v[56:59], a[204:207], a[8:11], v[56:59]
buffer_load_dwordx4 a[76:79], v5, s[4:7], s59 offen offset:256 sc1
v_mfma_f32_16x16x32_bf16 v[60:63], a[8:11], a[208:211], v[60:63]
v_mfma_f32_16x16x32_bf16 v[64:67], a[212:215], a[8:11], v[64:67]
s_waitcnt lgkmcnt(0)
v_fma_mix_f32 v216, v116, v200, v208 op_sel:[0,0,0] op_sel_hi:[1,0,0]
v_fma_mix_f32 v217, v116, v201, v209 op_sel:[1,0,0] op_sel_hi:[1,0,0]
v_mfma_f32_16x16x32_bf16 v[68:71], a[200:203], a[12:15], v[68:71]
v_cvt_pk_bf16_f32 v220, v216, v217
v_fma_mix_f32 v218, v117, v202, v210 op_sel:[0,0,0] op_sel_hi:[1,0,0]
v_mfma_f32_16x16x32_bf16 v[72:75], a[204:207], a[12:15], v[72:75]
buffer_load_dwordx4 a[80:83], v5, s[4:7], s59 offen offset:512 sc1
v_fma_mix_f32 v219, v117, v203, v211 op_sel:[1,0,0] op_sel_hi:[1,0,0]
v_mfma_f32_16x16x32_bf16 v[76:79], a[12:15], a[208:211], v[76:79]
v_cvt_pk_bf16_f32 v221, v218, v219
v_fma_mix_f32 v216, v118, v204, v212 op_sel:[0,0,0] op_sel_hi:[1,0,0]
v_mfma_f32_16x16x32_bf16 v[80:83], a[212:215], a[12:15], v[80:83]
v_fma_mix_f32 v217, v118, v205, v213 op_sel:[1,0,0] op_sel_hi:[1,0,0]
v_cvt_pk_bf16_f32 v222, v216, v217
v_mfma_f32_16x16x32_bf16 v[84:87], a[200:203], a[16:19], v[84:87]
v_fma_mix_f32 v218, v119, v206, v214 op_sel:[0,0,0] op_sel_hi:[1,0,0]
v_fma_mix_f32 v219, v119, v207, v215 op_sel:[1,0,0] op_sel_hi:[1,0,0]
v_mfma_f32_16x16x32_bf16 v[88:91], a[204:207], a[16:19], v[88:91]
v_cvt_pk_bf16_f32 v223, v218, v219
v_fma_mix_f32 v216, v136, v200, v208 op_sel:[0,0,0] op_sel_hi:[1,0,0]
v_mfma_f32_16x16x32_bf16 v[92:95], a[16:19], a[208:211], v[92:95]
v_fma_mix_f32 v217, v136, v201, v209 op_sel:[1,0,0] op_sel_hi:[1,0,0]
v_cvt_pk_bf16_f32 v224, v216, v217
v_mfma_f32_16x16x32_bf16 v[96:99], a[212:215], a[16:19], v[96:99]
s_waitcnt vmcnt(11)
s_barrier
v_fma_mix_f32 v218, v137, v202, v210 op_sel:[0,0,0] op_sel_hi:[1,0,0]
v_mfma_f32_16x16x32_bf16 v[20:23], a[216:219], a[20:23], v[20:23]
ds_read_b128 a[0:3], v4 offset:0
v_fma_mix_f32 v219, v137, v203, v211 op_sel:[1,0,0] op_sel_hi:[1,0,0]
v_mfma_f32_16x16x32_bf16 v[24:27], a[220:223], a[20:23], v[24:27]
buffer_load_dwordx4 a[84:87], v6, s[4:7], s59 offen offset:768 sc1
s_add_u32 s59, s59, 16384
v_mfma_f32_16x16x32_bf16 v[28:31], a[20:23], a[224:227], v[28:31]
ds_read_b128 a[4:7], v4 offset:1024
v_cvt_pk_bf16_f32 v225, v218, v219
v_mfma_f32_16x16x32_bf16 v[32:35], a[228:231], a[20:23], v[32:35]
ds_read_b128 a[8:11], v4 offset:2048
v_fma_mix_f32 v216, v138, v204, v212 op_sel:[0,0,0] op_sel_hi:[1,0,0]
v_mfma_f32_16x16x32_bf16 v[36:39], a[216:219], a[24:27], v[36:39]
ds_read_b128 a[12:15], v4 offset:3072
v_fma_mix_f32 v217, v138, v205, v213 op_sel:[1,0,0] op_sel_hi:[1,0,0]
v_mfma_f32_16x16x32_bf16 v[40:43], a[220:223], a[24:27], v[40:43]
buffer_load_dwordx4 a[88:91], v5, s[4:7], s59 offen offset:0 sc1
v_cvt_pk_bf16_f32 v226, v216, v217
v_mfma_f32_16x16x32_bf16 v[44:47], a[24:27], a[224:227], v[44:47]
ds_read_b128 a[16:19], v4 offset:4096
v_fma_mix_f32 v218, v139, v206, v214 op_sel:[0,0,0] op_sel_hi:[1,0,0]
v_mfma_f32_16x16x32_bf16 v[48:51], a[228:231], a[24:27], v[48:51]
ds_write_b128 v7, v[220:223] offset:20480
v_mfma_f32_16x16x32_bf16 v[52:55], a[216:219], a[28:31], v[52:55]
v_fma_mix_f32 v219, v139, v207, v215 op_sel:[1,0,0] op_sel_hi:[1,0,0]
v_cvt_pk_bf16_f32 v227, v218, v219
v_mfma_f32_16x16x32_bf16 v[56:59], a[220:223], a[28:31], v[56:59]
buffer_load_dwordx4 a[92:95], v5, s[4:7], s59 offen offset:256 sc1
v_fma_mix_f32 v216, v156, v200, v208 op_sel:[0,0,0] op_sel_hi:[1,0,0]
v_mfma_f32_16x16x32_bf16 v[60:63], a[28:31], a[224:227], v[60:63]
v_fma_mix_f32 v217, v156, v201, v209 op_sel:[1,0,0] op_sel_hi:[1,0,0]
v_cvt_pk_bf16_f32 v220, v216, v217
v_mfma_f32_16x16x32_bf16 v[64:67], a[228:231], a[28:31], v[64:67]
ds_write_b128 v253, v[224:227] offset:20480
v_mfma_f32_16x16x32_bf16 v[68:71], a[216:219], a[32:35], v[68:71]
v_fma_mix_f32 v218, v157, v202, v210 op_sel:[0,0,0] op_sel_hi:[1,0,0]
v_fma_mix_f32 v219, v157, v203, v211 op_sel:[1,0,0] op_sel_hi:[1,0,0]
v_mfma_f32_16x16x32_bf16 v[72:75], a[220:223], a[32:35], v[72:75]
buffer_load_dwordx4 a[96:99], v5, s[4:7], s59 offen offset:512 sc1
v_cvt_pk_bf16_f32 v221, v218, v219
v_mfma_f32_16x16x32_bf16 v[76:79], a[32:35], a[224:227], v[76:79]
v_fma_mix_f32 v216, v158, v204, v212 op_sel:[0,0,0] op_sel_hi:[1,0,0]
v_fma_mix_f32 v217, v158, v205, v213 op_sel:[1,0,0] op_sel_hi:[1,0,0]
v_mfma_f32_16x16x32_bf16 v[80:83], a[228:231], a[32:35], v[80:83]
v_cvt_pk_bf16_f32 v222, v216, v217
v_fma_mix_f32 v218, v159, v206, v214 op_sel:[0,0,0] op_sel_hi:[1,0,0]
v_mfma_f32_16x16x32_bf16 v[84:87], a[216:219], a[36:39], v[84:87]
v_fma_mix_f32 v219, v159, v207, v215 op_sel:[1,0,0] op_sel_hi:[1,0,0]
v_cvt_pk_bf16_f32 v223, v218, v219
v_mfma_f32_16x16x32_bf16 v[88:91], a[220:223], a[36:39], v[88:91]
v_fma_mix_f32 v216, v176, v200, v208 op_sel:[0,0,0] op_sel_hi:[1,0,0]
v_fma_mix_f32 v217, v176, v201, v209 op_sel:[1,0,0] op_sel_hi:[1,0,0]
v_mfma_f32_16x16x32_bf16 v[92:95], a[36:39], a[224:227], v[92:95]
v_cvt_pk_bf16_f32 v224, v216, v217
v_fma_mix_f32 v218, v177, v202, v210 op_sel:[0,0,0] op_sel_hi:[1,0,0]
v_mfma_f32_16x16x32_bf16 v[96:99], a[228:231], a[36:39], v[96:99]
s_waitcnt vmcnt(11) lgkmcnt(2)
v_fma_mix_f32 v219, v177, v203, v211 op_sel:[1,0,0] op_sel_hi:[1,0,0]
v_cvt_pk_bf16_f32 v225, v218, v219
v_mfma_f32_16x16x32_bf16 v[20:23], a[40:43], a[0:3], v[20:23]
ds_read_b128 a[20:23], v251 offset:5120
v_fma_mix_f32 v216, v178, v204, v212 op_sel:[0,0,0] op_sel_hi:[1,0,0]
v_mfma_f32_16x16x32_bf16 v[24:27], a[44:47], a[0:3], v[24:27]
buffer_load_dwordx4 a[100:103], v6, s[4:7], s59 offen offset:768 sc1
s_add_u32 s59, s59, 16384
v_mfma_f32_16x16x32_bf16 v[28:31], a[0:3], a[48:51], v[28:31]
ds_read_b128 a[24:27], v251 offset:6144
v_fma_mix_f32 v217, v178, v205, v213 op_sel:[1,0,0] op_sel_hi:[1,0,0]
v_mfma_f32_16x16x32_bf16 v[32:35], a[52:55], a[0:3], v[32:35]
ds_read_b128 a[28:31], v251 offset:7168
v_cvt_pk_bf16_f32 v226, v216, v217
v_mfma_f32_16x16x32_bf16 v[36:39], a[40:43], a[4:7], v[36:39]
ds_read_b128 a[32:35], v251 offset:8192
v_fma_mix_f32 v218, v179, v206, v214 op_sel:[0,0,0] op_sel_hi:[1,0,0]
v_mfma_f32_16x16x32_bf16 v[40:43], a[44:47], a[4:7], v[40:43]
buffer_load_dwordx4 a[104:107], v5, s[4:7], s59 offen offset:0 sc1
v_fma_mix_f32 v219, v179, v207, v215 op_sel:[1,0,0] op_sel_hi:[1,0,0]
v_mfma_f32_16x16x32_bf16 v[44:47], a[4:7], a[48:51], v[44:47]
ds_read_b128 a[36:39], v251 offset:9216
v_cvt_pk_bf16_f32 v227, v218, v219
v_mfma_f32_16x16x32_bf16 v[48:51], a[52:55], a[4:7], v[48:51]
ds_read_b64_tr_b16 a[168:169], v249 offset:0
v_fma_mix_f32 v216, v196, v200, v208 op_sel:[0,0,0] op_sel_hi:[1,0,0]
v_mfma_f32_16x16x32_bf16 v[52:55], a[40:43], a[8:11], v[52:55]
ds_read_b64_tr_b16 a[170:171], v249 offset:768
v_fma_mix_f32 v217, v196, v201, v209 op_sel:[1,0,0] op_sel_hi:[1,0,0]
v_mfma_f32_16x16x32_bf16 v[56:59], a[44:47], a[8:11], v[56:59]
buffer_load_dwordx4 a[108:111], v5, s[4:7], s59 offen offset:256 sc1
v_mfma_f32_16x16x32_bf16 v[60:63], a[8:11], a[48:51], v[60:63]
ds_read_b64_tr_b16 a[172:173], v252 offset:0
v_mfma_f32_16x16x32_bf16 v[64:67], a[52:55], a[8:11], v[64:67]
ds_read_b64_tr_b16 a[174:175], v252 offset:768
v_mfma_f32_16x16x32_bf16 v[68:71], a[40:43], a[12:15], v[68:71]
ds_write_b128 v254, v[220:223] offset:20480
v_mfma_f32_16x16x32_bf16 v[72:75], a[44:47], a[12:15], v[72:75]
buffer_load_dwordx4 a[112:115], v5, s[4:7], s59 offen offset:512 sc1
v_cvt_pk_bf16_f32 v220, v216, v217
v_mfma_f32_16x16x32_bf16 v[76:79], a[12:15], a[48:51], v[76:79]
v_fma_mix_f32 v218, v197, v202, v210 op_sel:[0,0,0] op_sel_hi:[1,0,0]
v_fma_mix_f32 v219, v197, v203, v211 op_sel:[1,0,0] op_sel_hi:[1,0,0]
v_mfma_f32_16x16x32_bf16 v[80:83], a[52:55], a[12:15], v[80:83]
v_cvt_pk_bf16_f32 v221, v218, v219
v_fma_mix_f32 v216, v198, v204, v212 op_sel:[0,0,0] op_sel_hi:[1,0,0]
v_mfma_f32_16x16x32_bf16 v[84:87], a[40:43], a[16:19], v[84:87]
ds_write_b128 v244, v[224:227] offset:20480
v_mfma_f32_16x16x32_bf16 v[88:91], a[44:47], a[16:19], v[88:91]
buffer_load_dwordx4 a[116:119], v6, s[4:7], s59 offen offset:768 sc1
s_add_u32 s59, s59, 16384
v_mfma_f32_16x16x32_bf16 v[92:95], a[16:19], a[48:51], v[92:95]
v_fma_mix_f32 v217, v198, v205, v213 op_sel:[1,0,0] op_sel_hi:[1,0,0]
v_cvt_pk_bf16_f32 v222, v216, v217
v_mfma_f32_16x16x32_bf16 v[96:99], a[52:55], a[16:19], v[96:99]
s_waitcnt vmcnt(12) lgkmcnt(6)
v_fma_mix_f32 v218, v199, v206, v214 op_sel:[0,0,0] op_sel_hi:[1,0,0]
v_fma_mix_f32 v219, v199, v207, v215 op_sel:[1,0,0] op_sel_hi:[1,0,0]
v_mfma_f32_16x16x32_bf16 v[20:23], a[56:59], a[20:23], v[20:23]
ds_read_b128 a[0:3], v4 offset:10240
v_cvt_pk_bf16_f32 v223, v218, v219
v_mfma_f32_16x16x32_bf16 v[24:27], a[60:63], a[20:23], v[24:27]
buffer_load_dwordx4 a[120:123], v5, s[4:7], s59 offen offset:0 sc1
v_add_u32 v253, 61440, v249
v_mfma_f32_16x16x32_bf16 v[28:31], a[20:23], a[64:67], v[28:31]
ds_read_b128 a[4:7], v4 offset:11264
v_add_u32 v254, 61440, v252
v_mfma_f32_16x16x32_bf16 v[32:35], a[68:71], a[20:23], v[32:35]
ds_read_b128 a[8:11], v4 offset:12288
v_lshlrev_b32 v7, 4, v1
v_mfma_f32_16x16x32_bf16 v[36:39], a[56:59], a[24:27], v[36:39]
ds_read_b128 a[12:15], v4 offset:13312
v_lshl_add_u32 v247, v3, 4, s12
v_mfma_f32_16x16x32_bf16 v[40:43], a[60:63], a[24:27], v[40:43]
buffer_load_dwordx4 a[124:127], v5, s[4:7], s59 offen offset:256 sc1
v_mul_u32_u24 v228, 192, v2
v_mfma_f32_16x16x32_bf16 v[44:47], a[24:27], a[64:67], v[44:47]
ds_read_b128 a[16:19], v4 offset:14336
v_lshl_add_u32 v228, v3, 3, v228
v_mfma_f32_16x16x32_bf16 v[48:51], a[68:71], a[24:27], v[48:51]
ds_read_b64_tr_b16 a[176:177], v249 offset:64
v_add_u32 v248, s13, v228
v_mfma_f32_16x16x32_bf16 v[52:55], a[56:59], a[28:31], v[52:55]
ds_read_b64_tr_b16 a[178:179], v249 offset:832
v_add_u32 v250, s13, v7
v_mfma_f32_16x16x32_bf16 v[56:59], a[60:63], a[28:31], v[56:59]
buffer_load_dwordx4 a[128:131], v5, s[4:7], s59 offen offset:512 sc1
v_lshlrev_b32 v0, 2, v1
v_mfma_f32_16x16x32_bf16 v[60:63], a[28:31], a[64:67], v[60:63]
ds_read_b64_tr_b16 a[180:181], v252 offset:64
v_add_u32 v227, s12, v7
v_mfma_f32_16x16x32_bf16 v[64:67], a[68:71], a[28:31], v[64:67]
ds_read_b64_tr_b16 a[182:183], v252 offset:832
v_min_u32 v226, 13, v1
v_mfma_f32_16x16x32_bf16 v[68:71], a[56:59], a[32:35], v[68:71]
ds_write_b128 v245, v[220:223] offset:20480
v_mfma_f32_16x16x32_bf16 v[72:75], a[60:63], a[32:35], v[72:75]
buffer_load_dwordx4 a[132:135], v6, s[4:7], s59 offen offset:768 sc1
s_add_u32 s59, s59, 16384
v_mfma_f32_16x16x32_bf16 v[76:79], a[32:35], a[64:67], v[76:79]
v_lshlrev_b32 v226, 7, v226
v_lshlrev_b32 v181, 2, v3
v_mfma_f32_16x16x32_bf16 v[80:83], a[68:71], a[32:35], v[80:83]
v_sub_u32 v181, v2, v181
v_mov_b32 v168, 0xf0000000
v_mfma_f32_16x16x32_bf16 v[84:87], a[56:59], a[36:39], v[84:87]
v_subrev_u32 v182, 0, v181
v_bfe_i32 v182, v182, 3, 1
v_mfma_f32_16x16x32_bf16 v[88:91], a[60:63], a[36:39], v[88:91]
v_and_b32 v164, v168, v182
v_mov_b32 v176, 0x3f803f80
v_mfma_f32_16x16x32_bf16 v[92:95], a[36:39], a[64:67], v[92:95]
v_subrev_u32 v182, 1, v181
v_bfe_i32 v182, v182, 3, 1
v_mfma_f32_16x16x32_bf16 v[96:99], a[68:71], a[36:39], v[96:99]
s_waitcnt vmcnt(12) lgkmcnt(5)
v_and_b32 v165, v168, v182
v_mov_b32 v177, 0x3f803f80
v_mfma_f32_16x16x32_bf16 v[20:23], a[72:75], a[0:3], v[20:23]
ds_read_b128 a[20:23], v251 offset:15360
v_subrev_u32 v182, 2, v181
v_mfma_f32_16x16x32_bf16 v[24:27], a[76:79], a[0:3], v[24:27]
buffer_load_dwordx4 a[136:139], v5, s[4:7], s59 offen offset:0 sc1
v_bfe_i32 v182, v182, 3, 1
v_mfma_f32_16x16x32_bf16 v[28:31], a[0:3], a[80:83], v[28:31]
ds_read_b128 a[24:27], v251 offset:16384
v_and_b32 v166, v168, v182
v_mfma_f32_16x16x32_bf16 v[32:35], a[84:87], a[0:3], v[32:35]
ds_read_b128 a[28:31], v251 offset:17408
v_mov_b32 v178, 0x3f803f80
v_mfma_f32_16x16x32_bf16 v[36:39], a[72:75], a[4:7], v[36:39]
ds_read_b128 a[32:35], v251 offset:18432
v_subrev_u32 v182, 3, v181
v_mfma_f32_16x16x32_bf16 v[40:43], a[76:79], a[4:7], v[40:43]
buffer_load_dwordx4 a[140:143], v5, s[4:7], s59 offen offset:256 sc1
v_bfe_i32 v182, v182, 3, 1
v_mfma_f32_16x16x32_bf16 v[44:47], a[4:7], a[80:83], v[44:47]
ds_read_b128 a[36:39], v251 offset:19456
v_and_b32 v167, v168, v182
v_mfma_f32_16x16x32_bf16 v[48:51], a[84:87], a[4:7], v[48:51]
ds_read_b64_tr_b16 a[184:185], v249 offset:128
v_mov_b32 v179, 0x3f803f80
v_mfma_f32_16x16x32_bf16 v[52:55], a[72:75], a[8:11], v[52:55]
ds_read_b64_tr_b16 a[186:187], v249 offset:896
v_and_b32 v181, 1, v1
v_mfma_f32_16x16x32_bf16 v[56:59], a[76:79], a[8:11], v[56:59]
buffer_load_dwordx4 a[144:147], v5, s[4:7], s59 offen offset:512 sc1
v_lshlrev_b32 v181, 4, v181
v_mfma_f32_16x16x32_bf16 v[60:63], a[8:11], a[80:83], v[60:63]
ds_read_b64_tr_b16 a[188:189], v252 offset:128
v_mov_b32 v182, 0x3f80
v_mfma_f32_16x16x32_bf16 v[64:67], a[84:87], a[8:11], v[64:67]
ds_read_b64_tr_b16 a[190:191], v252 offset:896
v_lshlrev_b32 v182, v181, v182
v_mfma_f32_16x16x32_bf16 v[68:71], a[72:75], a[12:15], v[68:71]
v_and_b32 v181, 0x32, v1
v_cmp_eq_u32 vcc, 0x30, v181
v_mfma_f32_16x16x32_bf16 v[72:75], a[76:79], a[12:15], v[72:75]
buffer_load_dwordx4 a[148:151], v6, s[4:7], s59 offen offset:768 sc1
s_add_u32 s59, s59, 16384
v_mfma_f32_16x16x32_bf16 v[76:79], a[12:15], a[80:83], v[76:79]
v_cmp_eq_u32 s[62:63], 50, v181
v_mul_u32_u24 v229, 176, v2
v_mfma_f32_16x16x32_bf16 v[80:83], a[84:87], a[12:15], v[80:83]
v_cndmask_b32 v174, 0, v182, vcc
v_cndmask_b32 v175, 0, v182, s[62:63]
v_mfma_f32_16x16x32_bf16 v[84:87], a[72:75], a[16:19], v[84:87]
v_add_u32 v229, s61, v229
v_lshl_add_u32 v228, v3, 3, v229
v_mfma_f32_16x16x32_bf16 v[88:91], a[76:79], a[16:19], v[88:91]
buffer_load_dwordx4 a[152:155], v5, s[4:7], s59 offen offset:0 sc1
v_mov_b32 v122, 0
v_mfma_f32_16x16x32_bf16 v[92:95], a[16:19], a[80:83], v[92:95]
v_mov_b32 v123, 0
v_mov_b32 v126, 0
v_mfma_f32_16x16x32_bf16 v[96:99], a[84:87], a[16:19], v[96:99]
s_waitcnt vmcnt(13) lgkmcnt(4)
s_barrier
v_mov_b32 v127, 0
v_mfma_f32_16x16x32_bf16 v[20:23], a[88:91], a[20:23], v[20:23]
ds_read_b128 a[0:3], v4 offset:20480
v_mov_b32 v130, 0
v_mfma_f32_16x16x32_bf16 v[24:27], a[92:95], a[20:23], v[24:27]
buffer_load_dwordx4 a[156:159], v5, s[4:7], s59 offen offset:256 sc1
v_mov_b32 v131, 0
v_mfma_f32_16x16x32_bf16 v[28:31], a[20:23], a[96:99], v[28:31]
ds_read_b128 a[4:7], v4 offset:21504
v_mov_b32 v134, 0
v_mfma_f32_16x16x32_bf16 v[32:35], a[100:103], a[20:23], v[32:35]
ds_read_b128 a[8:11], v4 offset:22528
v_mov_b32 v135, 0
v_mfma_f32_16x16x32_bf16 v[36:39], a[88:91], a[24:27], v[36:39]
ds_read_b128 a[12:15], v4 offset:23552
v_mov_b32 v138, 0
v_mfma_f32_16x16x32_bf16 v[40:43], a[92:95], a[24:27], v[40:43]
buffer_load_dwordx4 a[160:163], v5, s[4:7], s59 offen offset:512 sc1
v_mov_b32 v139, 0
v_mfma_f32_16x16x32_bf16 v[44:47], a[24:27], a[96:99], v[44:47]
ds_read_b128 a[16:19], v4 offset:24576
v_mfma_f32_16x16x32_bf16 v[48:51], a[100:103], a[24:27], v[48:51]
ds_read_b64_tr_b16 a[192:193], v249 offset:6144
v_mfma_f32_16x16x32_bf16 v[52:55], a[88:91], a[28:31], v[52:55]
ds_read_b64_tr_b16 a[194:195], v249 offset:6912
v_mfma_f32_16x16x32_bf16 v[56:59], a[92:95], a[28:31], v[56:59]
buffer_load_dwordx4 a[164:167], v6, s[4:7], s59 offen offset:768 sc1
s_add_u32 s59, s59, 16384
v_mfma_f32_16x16x32_bf16 v[60:63], a[28:31], a[96:99], v[60:63]
ds_read_b64_tr_b16 a[196:197], v252 offset:6144
v_mfma_f32_16x16x32_bf16 v[64:67], a[100:103], a[28:31], v[64:67]
ds_read_b64_tr_b16 a[198:199], v252 offset:6912
v_mfma_f32_16x16x32_bf16 v[68:71], a[88:91], a[32:35], v[68:71]
ds_read_b64_tr_b16 a[206:207], v252 offset:6976
s_add_u32 m0, s39, 49152
v_mfma_f32_16x16x32_bf16 v[72:75], a[92:95], a[32:35], v[72:75]
buffer_load_dwordx4 v232, s[24:27], s48 offen offset:0 lds
v_mfma_f32_16x16x32_bf16 v[76:79], a[32:35], a[96:99], v[76:79]
ds_read_b64_tr_b16 a[200:201], v249 offset:6208
v_mfma_f32_16x16x32_bf16 v[80:83], a[100:103], a[32:35], v[80:83]
ds_read_b64_tr_b16 a[202:203], v249 offset:6976
v_mfma_f32_16x16x32_bf16 v[84:87], a[88:91], a[36:39], v[84:87]
ds_read_b64_tr_b16 a[208:209], v249 offset:6272
v_mfma_f32_16x16x32_bf16 v[88:91], a[92:95], a[36:39], v[88:91]
v_mfma_f32_16x16x32_bf16 v[92:95], a[36:39], a[96:99], v[92:95]
ds_read_b64_tr_b16 a[204:205], v252 offset:6208
v_mfma_f32_16x16x32_bf16 v[96:99], a[100:103], a[36:39], v[96:99]
s_waitcnt vmcnt(13) lgkmcnt(9)
v_mfma_f32_16x16x32_bf16 v[20:23], a[104:107], a[0:3], v[20:23]
ds_read_b128 a[20:23], v251 offset:25600
v_mfma_f32_16x16x32_bf16 v[24:27], a[108:111], a[0:3], v[24:27]
buffer_load_dwordx4 v233, s[24:27], s48 offen offset:1024 lds
v_mfma_f32_16x16x32_bf16 v[28:31], a[0:3], a[112:115], v[28:31]
ds_read_b128 a[24:27], v251 offset:26624
v_mfma_f32_16x16x32_bf16 v[32:35], a[116:119], a[0:3], v[32:35]
ds_read_b128 a[28:31], v251 offset:27648
v_mfma_f32_16x16x32_bf16 v[36:39], a[104:107], a[4:7], v[36:39]
ds_read_b128 a[32:35], v251 offset:28672
v_mfma_f32_16x16x32_bf16 v[40:43], a[108:111], a[4:7], v[40:43]
buffer_load_dwordx4 v234, s[24:27], s48 offen offset:2048 lds
s_add_u32 s48, s48, 81920
v_mfma_f32_16x16x32_bf16 v[44:47], a[4:7], a[112:115], v[44:47]
ds_read_b128 a[36:39], v251 offset:29696
v_mfma_f32_16x16x32_bf16 v[48:51], a[116:119], a[4:7], v[48:51]
ds_read_b64_tr_b16 a[210:211], v249 offset:7040
v_mfma_f32_16x16x32_bf16 v[52:55], a[104:107], a[8:11], v[52:55]
ds_read_b64_tr_b16 a[212:213], v252 offset:6272
s_add_u32 m0, s39, 61440
v_mfma_f32_16x16x32_bf16 v[56:59], a[108:111], a[8:11], v[56:59]
buffer_load_dwordx4 v232, s[24:27], s48 offen offset:0 lds
v_mfma_f32_16x16x32_bf16 v[60:63], a[8:11], a[112:115], v[60:63]
ds_read_b64_tr_b16 a[214:215], v252 offset:7040
v_mfma_f32_16x16x32_bf16 v[64:67], a[116:119], a[8:11], v[64:67]
ds_read_b64_tr_b16 a[216:217], v249 offset:12288
v_mfma_f32_16x16x32_bf16 v[68:71], a[104:107], a[12:15], v[68:71]
ds_read_b64_tr_b16 a[224:225], v249 offset:12352
v_mfma_f32_16x16x32_bf16 v[72:75], a[108:111], a[12:15], v[72:75]
buffer_load_dwordx4 v233, s[24:27], s48 offen offset:1024 lds
v_mfma_f32_16x16x32_bf16 v[76:79], a[12:15], a[112:115], v[76:79]
ds_read_b64_tr_b16 a[218:219], v249 offset:13056
v_mfma_f32_16x16x32_bf16 v[80:83], a[116:119], a[12:15], v[80:83]
ds_read_b64_tr_b16 a[220:221], v252 offset:12288
v_mfma_f32_16x16x32_bf16 v[84:87], a[104:107], a[16:19], v[84:87]
ds_read_b64_tr_b16 a[226:227], v249 offset:13120
v_mfma_f32_16x16x32_bf16 v[88:91], a[108:111], a[16:19], v[88:91]
v_mfma_f32_16x16x32_bf16 v[92:95], a[16:19], a[112:115], v[92:95]
ds_read_b64_tr_b16 a[222:223], v252 offset:13056
v_mfma_f32_16x16x32_bf16 v[96:99], a[116:119], a[16:19], v[96:99]
s_waitcnt vmcnt(13) lgkmcnt(9)
v_mfma_f32_16x16x32_bf16 v[20:23], a[120:123], a[20:23], v[20:23]
ds_read_b128 a[0:3], v4 offset:30720
v_mfma_f32_16x16x32_bf16 v[24:27], a[124:127], a[20:23], v[24:27]
buffer_load_dwordx4 v234, s[24:27], s48 offen offset:2048 lds
s_add_u32 s48, s48, 81920
v_mfma_f32_16x16x32_bf16 v[28:31], a[20:23], a[128:131], v[28:31]
ds_read_b128 a[4:7], v4 offset:31744
v_mfma_f32_16x16x32_bf16 v[32:35], a[132:135], a[20:23], v[32:35]
ds_read_b128 a[8:11], v4 offset:32768
v_mfma_f32_16x16x32_bf16 v[36:39], a[120:123], a[24:27], v[36:39]
ds_read_b128 a[12:15], v4 offset:33792
s_add_u32 m0, s49, 122880
v_mfma_f32_16x16x32_bf16 v[40:43], a[124:127], a[24:27], v[40:43]
buffer_load_dwordx4 v235, s[8:11], s50 offen offset:0 lds
v_mfma_f32_16x16x32_bf16 v[44:47], a[24:27], a[128:131], v[44:47]
ds_read_b128 a[16:19], v4 offset:34816
v_mfma_f32_16x16x32_bf16 v[48:51], a[132:135], a[24:27], v[48:51]
ds_read_b64_tr_b16 a[228:229], v252 offset:12352
v_mfma_f32_16x16x32_bf16 v[52:55], a[120:123], a[28:31], v[52:55]
ds_read_b64_tr_b16 a[230:231], v252 offset:13120
v_mfma_f32_16x16x32_bf16 v[56:59], a[124:127], a[28:31], v[56:59]
buffer_load_dwordx4 v236, s[8:11], s50 offen offset:1024 lds
v_mfma_f32_16x16x32_bf16 v[60:63], a[28:31], a[128:131], v[60:63]
ds_read_b64_tr_b16 a[232:233], v249 offset:12416
v_mfma_f32_16x16x32_bf16 v[64:67], a[132:135], a[28:31], v[64:67]
ds_read_b64_tr_b16 a[234:235], v249 offset:13184
v_mfma_f32_16x16x32_bf16 v[68:71], a[120:123], a[32:35], v[68:71]
ds_read_b64_tr_b16 a[242:243], v249 offset:19200
v_mfma_f32_16x16x32_bf16 v[72:75], a[124:127], a[32:35], v[72:75]
buffer_load_dwordx4 v237, s[8:11], s50 offen offset:2048 lds
v_mfma_f32_16x16x32_bf16 v[76:79], a[32:35], a[128:131], v[76:79]
ds_read_b64_tr_b16 a[236:237], v252 offset:12416
v_mfma_f32_16x16x32_bf16 v[80:83], a[132:135], a[32:35], v[80:83]
ds_read_b64_tr_b16 a[238:239], v252 offset:13184
v_mfma_f32_16x16x32_bf16 v[84:87], a[120:123], a[36:39], v[84:87]
ds_read_b64_tr_b16 a[244:245], v252 offset:18432
s_add_u32 m0, s39, 73728
v_mfma_f32_16x16x32_bf16 v[88:91], a[124:127], a[36:39], v[88:91]
buffer_load_dwordx4 v232, s[24:27], s48 offen offset:0 lds
v_mfma_f32_16x16x32_bf16 v[92:95], a[36:39], a[128:131], v[92:95]
ds_read_b64_tr_b16 a[240:241], v249 offset:18432
v_mfma_f32_16x16x32_bf16 v[96:99], a[132:135], a[36:39], v[96:99]
s_waitcnt vmcnt(14) lgkmcnt(9)
v_mfma_f32_16x16x32_bf16 v[20:23], a[136:139], a[0:3], v[20:23]
ds_read_b128 a[20:23], v251 offset:35840
v_mfma_f32_16x16x32_bf16 v[24:27], a[140:143], a[0:3], v[24:27]
buffer_load_dwordx4 v233, s[24:27], s48 offen offset:1024 lds
v_mfma_f32_16x16x32_bf16 v[28:31], a[0:3], a[144:147], v[28:31]
ds_read_b128 a[24:27], v251 offset:36864
v_mfma_f32_16x16x32_bf16 v[32:35], a[148:151], a[0:3], v[32:35]
ds_read_b128 a[28:31], v251 offset:37888
v_mfma_f32_16x16x32_bf16 v[36:39], a[136:139], a[4:7], v[36:39]
ds_read_b128 a[32:35], v251 offset:38912
v_mfma_f32_16x16x32_bf16 v[40:43], a[140:143], a[4:7], v[40:43]
buffer_load_dwordx4 v234, s[24:27], s48 offen offset:2048 lds
s_add_u32 s48, s48, 81920
v_mfma_f32_16x16x32_bf16 v[44:47], a[4:7], a[144:147], v[44:47]
ds_read_b128 a[36:39], v251 offset:39936
v_mfma_f32_16x16x32_bf16 v[48:51], a[148:151], a[4:7], v[48:51]
ds_read_b64_tr_b16 a[246:247], v252 offset:19200
v_mfma_f32_16x16x32_bf16 v[52:55], a[136:139], a[8:11], v[52:55]
ds_read_b64_tr_b16 a[248:249], v249 offset:18496
s_add_u32 m0, s39, 86016
v_mfma_f32_16x16x32_bf16 v[56:59], a[140:143], a[8:11], v[56:59]
buffer_load_dwordx4 v232, s[24:27], s48 offen offset:0 lds
v_mfma_f32_16x16x32_bf16 v[60:63], a[8:11], a[144:147], v[60:63]
ds_read_b64_tr_b16 a[250:251], v249 offset:19264
v_mfma_f32_16x16x32_bf16 v[64:67], a[148:151], a[8:11], v[64:67]
ds_read_b64_tr_b16 a[252:253], v252 offset:18496
v_mfma_f32_16x16x32_bf16 v[68:71], a[136:139], a[12:15], v[68:71]
ds_read_b64_tr_b16 a[44:45], v252 offset:18560
v_mfma_f32_16x16x32_bf16 v[72:75], a[140:143], a[12:15], v[72:75]
buffer_load_dwordx4 v233, s[24:27], s48 offen offset:1024 lds
v_mfma_f32_16x16x32_bf16 v[76:79], a[12:15], a[144:147], v[76:79]
ds_read_b64_tr_b16 a[254:255], v252 offset:19264
v_mfma_f32_16x16x32_bf16 v[80:83], a[148:151], a[12:15], v[80:83]
ds_read_b64_tr_b16 a[40:41], v249 offset:18560
v_mfma_f32_16x16x32_bf16 v[84:87], a[136:139], a[16:19], v[84:87]
ds_read_b64_tr_b16 a[46:47], v252 offset:19328
v_mfma_f32_16x16x32_bf16 v[88:91], a[140:143], a[16:19], v[88:91]
v_mfma_f32_16x16x32_bf16 v[92:95], a[16:19], a[144:147], v[92:95]
ds_read_b64_tr_b16 a[42:43], v249 offset:19328
v_mfma_f32_16x16x32_bf16 v[96:99], a[148:151], a[16:19], v[96:99]
s_waitcnt vmcnt(14) lgkmcnt(9)
s_barrier
s_mov_b32 s62, 1051011932
s_mov_b32 s63, 1051011932
s_mov_b32 s20, 0
s_mov_b32 s21, 0x00ff00ff
v_mfma_f32_16x16x32_bf16 v[32:35], a[164:167], a[20:23], v[32:35]
buffer_load_dwordx2 v[194:195], v231, s[4:7], s23 offen sc1
v_mfma_f32_16x16x32_bf16 v[48:51], a[164:167], a[24:27], v[48:51]
v_mfma_f32_16x16x32_bf16 v[64:67], a[164:167], a[28:31], v[64:67]
v_mfma_f32_16x16x32_bf16 v[80:83], a[164:167], a[32:35], v[80:83]
v_mfma_f32_16x16x32_bf16 v[20:23], a[152:155], a[20:23], v[20:23]
v_mfma_f32_16x16x32_bf16 v[24:27], a[156:159], a[20:23], v[24:27]
v_mfma_f32_16x16x32_bf16 v[36:39], a[152:155], a[24:27], v[36:39]
s_nop 0
v_cvt_pk_bf16_f32 v102, v32, v33
v_mfma_f32_16x16x32_bf16 v[40:43], a[156:159], a[24:27], v[40:43]
v_cvt_pk_bf16_f32 v103, v34, v35
v_cvt_pk_bf16_f32 v106, v48, v49
v_mfma_f32_16x16x32_bf16 v[52:55], a[152:155], a[28:31], v[52:55]
v_cvt_pk_bf16_f32 v107, v50, v51
v_cvt_pk_bf16_f32 v110, v64, v65
v_mfma_f32_16x16x32_bf16 v[56:59], a[156:159], a[28:31], v[56:59]
buffer_load_dwordx4 v[240:243], v238, s[4:7], s51 offen sc1
v_cvt_pk_bf16_f32 v111, v66, v67
v_cvt_pk_bf16_f32 v114, v80, v81
v_mfma_f32_16x16x32_bf16 v[68:71], a[152:155], a[32:35], v[68:71]
v_cvt_pk_bf16_f32 v115, v82, v83
v_permlane32_swap_b32 v122, v102
v_mfma_f32_16x16x32_bf16 v[72:75], a[156:159], a[32:35], v[72:75]
v_permlane32_swap_b32 v123, v103
v_permlane32_swap_b32 v126, v106
v_permlane32_swap_b32 v127, v107
v_permlane32_swap_b32 v130, v110
v_permlane32_swap_b32 v131, v111
v_permlane32_swap_b32 v134, v114
v_permlane32_swap_b32 v135, v115
v_cvt_pk_bf16_f32 v100, v24, v25
v_cvt_pk_bf16_f32 v101, v26, v27
v_cvt_pk_bf16_f32 v120, v20, v21
v_cvt_pk_bf16_f32 v121, v22, v23
buffer_load_dwordx4 v[190:193], v238, s[4:7], s22 offen sc1
v_cvt_pk_bf16_f32 v104, v40, v41
v_cvt_pk_bf16_f32 v105, v42, v43
v_cvt_pk_bf16_f32 v124, v36, v37
v_cvt_pk_bf16_f32 v125, v38, v39
v_cvt_pk_bf16_f32 v108, v56, v57
v_cvt_pk_bf16_f32 v109, v58, v59
v_cvt_pk_bf16_f32 v128, v52, v53
v_cvt_pk_bf16_f32 v129, v54, v55
v_cvt_pk_bf16_f32 v112, v72, v73
v_cvt_pk_bf16_f32 v113, v74, v75
v_cvt_pk_bf16_f32 v132, v68, v69
v_cvt_pk_bf16_f32 v133, v70, v71
v_mfma_f32_16x16x32_bf16 v[24:27], v[100:103], v[120:123], v[164:167]
v_mfma_f32_16x16x32_bf16 v[40:43], v[104:107], v[124:127], v[164:167]
buffer_load_dwordx2 v[244:245], v239, s[28:31], s52 offen
v_mfma_f32_16x16x32_bf16 v[36:39], v[100:103], v[124:127], v[164:167]
v_mfma_f32_16x16x32_bf16 v[56:59], v[108:111], v[128:131], v[164:167]
v_mfma_f32_16x16x32_bf16 v[52:55], v[104:107], v[128:131], v[164:167]
v_mfma_f32_16x16x32_bf16 v[72:75], v[112:115], v[132:135], v[164:167]
v_mfma_f32_16x16x32_bf16 v[68:71], v[108:111], v[132:135], v[164:167]
s_nop 0
v_cndmask_b32 v24, v24, v168, s[20:21]
v_cndmask_b32 v25, v25, v168, s[20:21]
v_cndmask_b32 v26, v26, v168, s[20:21]
v_cndmask_b32 v40, v40, v36, s[20:21]
v_cndmask_b32 v41, v41, v37, s[20:21]
v_cndmask_b32 v42, v42, v38, s[20:21]
v_cndmask_b32 v56, v56, v52, s[20:21]
v_cndmask_b32 v57, v57, v53, s[20:21]
v_cndmask_b32 v58, v58, v54, s[20:21]
v_cndmask_b32 v72, v72, v68, s[20:21]
v_cndmask_b32 v73, v73, v69, s[20:21]
v_cndmask_b32 v74, v74, v70, s[20:21]
buffer_load_dword v196, v226, s[4:7], s14 offen sc1
v_cndmask_b32 v27, v27, v168, s[20:21]
v_max3_f32 v180, v24, v25, v26
v_cndmask_b32 v43, v43, v39, s[20:21]
v_max3_f32 v181, v40, v41, v42
v_cndmask_b32 v59, v59, v55, s[20:21]
v_max3_f32 v182, v56, v57, v58
v_cndmask_b32 v75, v75, v71, s[20:21]
v_max3_f32 v183, v72, v73, v74
v_max_f32 v180, v180, v27
v_max_f32 v181, v181, v43
v_max_f32 v182, v182, v59
v_max_f32 v183, v183, v75
v_mfma_f32_16x16x32_bf16 v[96:99], a[164:167], a[36:39], v[96:99]
v_permlane32_swap_b32 v180, v182
v_permlane32_swap_b32 v181, v183
v_max_f32 v180, v180, v182
v_max_f32 v181, v181, v183
buffer_load_dwordx4 v234, s[24:27], s48 offen offset:2048 lds
s_add_u32 s48, s48, 81920
v_mfma_f32_16x16x32_bf16 v[84:87], a[152:155], a[36:39], v[84:87]
v_permlane16_swap_b32 v180, v181
v_max_f32 v181, v180, v181
v_mul_f32 v180, s62, v181
v_mul_f32 v182, s62, v181
v_mfma_f32_16x16x32_bf16 v[88:91], a[156:159], a[36:39], v[88:91]
s_nop 0
v_permlane32_swap_b32 v180, v182
v_mfma_f32_16x16x32_bf16 v[28:31], a[20:23], a[160:163], v[28:31]
v_mov_b32 v181, v180
v_cvt_pk_bf16_f32 v118, v96, v97
v_mfma_f32_16x16x16_bf16 v[32:35], v[102:103], v[174:175], 0
v_cvt_pk_bf16_f32 v119, v98, v99
v_permlane16_swap_b32 v180, v181
s_add_u32 m0, s39, 98304
v_mfma_f32_16x16x32_bf16 v[44:47], a[24:27], a[160:163], v[44:47]
buffer_load_dwordx4 v232, s[24:27], s48 offen offset:0 lds
v_permlane32_swap_b32 v138, v118
v_permlane32_swap_b32 v139, v119
v_cvt_pk_bf16_f32 v116, v88, v89
v_pk_fma_f32 v[24:25], v[24:25], s[62:63], v[180:181] op_sel:[0,0,0] op_sel_hi:[1,0,0] neg_lo:[0,0,1] neg_hi:[0,0,1]
v_pk_fma_f32 v[26:27], v[26:27], s[62:63], v[180:181] op_sel:[0,0,0] op_sel_hi:[1,0,0] neg_lo:[0,0,1] neg_hi:[0,0,1]
v_cvt_pk_bf16_f32 v117, v90, v91
v_cvt_pk_bf16_f32 v136, v84, v85
v_cvt_pk_bf16_f32 v137, v86, v87
v_exp_f32 v24, v24
v_exp_f32 v25, v25
v_exp_f32 v26, v26
v_exp_f32 v27, v27
v_cvt_pk_bf16_f32 v143, v30, v31
v_mfma_f32_16x16x16_bf16 v[48:51], v[106:107], v[174:175], 0
buffer_load_dwordx4 v233, s[24:27], s48 offen offset:1024 lds
v_cvt_pk_bf16_f32 v30, v24, v25
v_cvt_pk_bf16_f32 v31, v26, v27
v_mfma_f32_16x16x32_bf16 v[88:91], v[116:119], v[136:139], v[164:167]
v_cvt_pk_bf16_f32 v154, v32, v33
v_cvt_pk_bf16_f32 v155, v34, v35
v_mfma_f32_16x16x32_bf16 v[84:87], v[112:115], v[136:139], v[164:167]
v_cvt_pk_bf16_f32 v142, v28, v29
v_cvt_pk_bf16_f32 v145, v46, v47
v_mfma_f32_16x16x32_bf16 v[60:63], a[28:31], a[160:163], v[60:63]
v_mov_b32 v183, v182
v_cvt_pk_bf16_f32 v144, v44, v45
v_mfma_f32_16x16x16_bf16 v[32:35], v[176:177], v[30:31], 0
v_permlane16_swap_b32 v182, v183
v_mfma_f32_16x16x16_bf16 v[20:23], v[142:143], v[30:31], 0
buffer_load_dwordx4 v234, s[24:27], s48 offen offset:2048 lds
s_add_u32 s48, s48, 81920
v_cvt_pk_bf16_f32 v156, v48, v49
v_cvt_pk_bf16_f32 v157, v50, v51
v_mfma_f32_16x16x16_bf16 v[64:67], v[110:111], v[174:175], 0
v_cndmask_b32 v88, v88, v84, s[20:21]
v_cndmask_b32 v89, v89, v85, s[20:21]
v_cndmask_b32 v90, v90, v86, s[20:21]
v_mfma_f32_16x16x16_bf16 v[24:27], v[154:155], v[30:31], 0
v_cndmask_b32 v91, v91, v87, s[20:21]
v_max3_f32 v184, v88, v89, v90
v_mfma_f32_16x16x32_bf16 v[76:79], a[32:35], a[160:163], v[76:79]
v_max_f32 v184, v184, v91
v_cvt_pk_bf16_f32 v147, v62, v63
v_mov_b32 v185, v184
v_rcp_f32 v32, v32
v_pk_fma_f32 v[40:41], v[40:41], s[62:63], v[180:181] op_sel:[0,0,1] op_sel_hi:[1,0,1] neg_lo:[0,0,1] neg_hi:[0,0,1]
v_pk_fma_f32 v[42:43], v[42:43], s[62:63], v[180:181] op_sel:[0,0,1] op_sel_hi:[1,0,1] neg_lo:[0,0,1] neg_hi:[0,0,1]
v_exp_f32 v40, v40
v_exp_f32 v41, v41
v_exp_f32 v42, v42
v_exp_f32 v43, v43
v_cvt_pk_bf16_f32 v46, v40, v41
v_cvt_pk_bf16_f32 v47, v42, v43
v_cndmask_b32 v44, 0, v46, s[20:21]
v_cndmask_b32 v45, 0, v47, s[20:21]
v_xor_b32 v46, v44, v46
v_xor_b32 v47, v45, v47
v_pk_fma_f32 v[56:57], v[56:57], s[62:63], v[182:183] op_sel:[0,0,0] op_sel_hi:[1,0,0] neg_lo:[0,0,1] neg_hi:[0,0,1]
v_pk_fma_f32 v[58:59], v[58:59], s[62:63], v[182:183] op_sel:[0,0,0] op_sel_hi:[1,0,0] neg_lo:[0,0,1] neg_hi:[0,0,1]
v_mfma_f32_16x16x32_bf16 v[48:51], v[176:179], v[44:47], 0
v_exp_f32 v56, v56
v_exp_f32 v57, v57
v_exp_f32 v58, v58
v_exp_f32 v59, v59
v_cvt_pk_bf16_f32 v146, v60, v61
v_mfma_f32_16x16x32_bf16 v[36:39], v[142:145], v[44:47], 0
v_cvt_pk_bf16_f32 v62, v56, v57
v_cvt_pk_bf16_f32 v63, v58, v59
v_cndmask_b32 v60, 0, v62, s[20:21]
v_cndmask_b32 v61, 0, v63, s[20:21]
v_mfma_f32_16x16x16_bf16 v[80:83], v[114:115], v[174:175], 0
v_permlane32_swap_b32 v184, v185
v_xor_b32 v62, v60, v62
v_xor_b32 v63, v61, v63
v_cvt_pk_bf16_f32 v158, v64, v65
v_pk_mul_f32 v[20:21], v[20:21], v[32:33] op_sel_hi:[1,0]
v_pk_mul_f32 v[22:23], v[22:23], v[32:33] op_sel_hi:[1,0]
v_cvt_pk_bf16_f32 v20, v20, v21
v_cvt_pk_bf16_f32 v159, v66, v67
v_max_f32 v184, v184, v185
v_cvt_pk_bf16_f32 v21, v22, v23
v_mfma_f32_16x16x32_bf16 v[40:43], v[154:157], v[44:47], 0
ds_write_b64 v228, v[20:21] offset:0
v_mfma_f32_16x16x32_bf16 v[92:95], a[36:39], a[160:163], v[92:95]
v_mov_b32 v185, v184
v_cvt_pk_bf16_f32 v149, v78, v79
v_mfma_f32_16x16x32_bf16 v[64:67], v[176:179], v[60:63], 0
v_rcp_f32 v48, v48
v_cvt_pk_bf16_f32 v148, v76, v77
v_permlane16_swap_b32 v184, v185
v_pk_fma_f32 v[72:73], v[72:73], s[62:63], v[182:183] op_sel:[0,0,1] op_sel_hi:[1,0,1] neg_lo:[0,0,1] neg_hi:[0,0,1]
v_pk_fma_f32 v[74:75], v[74:75], s[62:63], v[182:183] op_sel:[0,0,1] op_sel_hi:[1,0,1] neg_lo:[0,0,1] neg_hi:[0,0,1]
v_exp_f32 v72, v72
v_exp_f32 v73, v73
v_exp_f32 v74, v74
v_exp_f32 v75, v75
v_pk_mul_f32 v[24:25], v[24:25], v[32:33] op_sel_hi:[1,0]
v_pk_mul_f32 v[26:27], v[26:27], v[32:33] op_sel_hi:[1,0]
v_cvt_pk_bf16_f32 v24, v24, v25
v_cvt_pk_bf16_f32 v25, v26, v27
v_mfma_f32_16x16x32_bf16 v[52:55], v[144:147], v[60:63], 0
ds_write_b64 v229, v[24:25] offset:32
v_cvt_pk_bf16_f32 v78, v72, v73
v_cvt_pk_bf16_f32 v79, v74, v75
v_cndmask_b32 v76, 0, v78, s[20:21]
v_cndmask_b32 v77, 0, v79, s[20:21]
v_mfma_f32_16x16x16_bf16 v[96:99], v[118:119], v[174:175], 0
v_max_f32 v184, v184, v185
v_xor_b32 v78, v76, v78
v_xor_b32 v79, v77, v79
v_mul_f32 v184, s62, v184
v_cvt_pk_bf16_f32 v160, v80, v81
v_pk_mul_f32 v[36:37], v[36:37], v[48:49] op_sel_hi:[1,0]
v_pk_mul_f32 v[38:39], v[38:39], v[48:49] op_sel_hi:[1,0]
v_cvt_pk_bf16_f32 v36, v36, v37
v_cvt_pk_bf16_f32 v161, v82, v83
v_cvt_pk_bf16_f32 v37, v38, v39
v_mfma_f32_16x16x32_bf16 v[56:59], v[156:159], v[60:63], 0
ds_write_b64 v228, v[36:37] offset:2816
v_mfma_f32_16x16x32_bf16 v[80:83], v[176:179], v[76:79], 0
v_cvt_pk_bf16_f32 v151, v94, v95
v_rcp_f32 v64, v64
v_cvt_pk_bf16_f32 v150, v92, v93
v_mfma_f32_16x16x32_bf16 v[68:71], v[146:149], v[76:79], 0
v_cvt_pk_bf16_f32 v162, v96, v97
v_cvt_pk_bf16_f32 v163, v98, v99
v_mfma_f32_16x16x32_bf16 v[72:75], v[158:161], v[76:79], 0
s_nop 0
v_rcp_f32 v80, v80
v_pk_fma_f32 v[88:89], v[88:89], s[62:63], v[184:185] op_sel:[0,0,0] op_sel_hi:[1,0,0] neg_lo:[0,0,1] neg_hi:[0,0,1]
v_pk_fma_f32 v[90:91], v[90:91], s[62:63], v[184:185] op_sel:[0,0,0] op_sel_hi:[1,0,0] neg_lo:[0,0,1] neg_hi:[0,0,1]
v_exp_f32 v88, v88
v_exp_f32 v89, v89
v_exp_f32 v90, v90
v_exp_f32 v91, v91
v_pk_mul_f32 v[40:41], v[40:41], v[48:49] op_sel_hi:[1,0]
v_pk_mul_f32 v[42:43], v[42:43], v[48:49] op_sel_hi:[1,0]
v_cvt_pk_bf16_f32 v40, v40, v41
v_cvt_pk_bf16_f32 v41, v42, v43
v_cvt_pk_bf16_f32 v94, v88, v89
v_cvt_pk_bf16_f32 v95, v90, v91
ds_write_b64 v229, v[40:41] offset:2848
v_cndmask_b32 v92, 0, v94, s[20:21]
v_cndmask_b32 v93, 0, v95, s[20:21]
v_pk_mul_f32 v[52:53], v[52:53], v[64:65] op_sel_hi:[1,0]
v_xor_b32 v94, v92, v94
v_xor_b32 v95, v93, v95
v_pk_mul_f32 v[54:55], v[54:55], v[64:65] op_sel_hi:[1,0]
v_cvt_pk_bf16_f32 v52, v52, v53
v_cvt_pk_bf16_f32 v53, v54, v55
ds_write_b64 v228, v[52:53] offset:5632
v_mfma_f32_16x16x32_bf16 v[96:99], v[176:179], v[92:95], 0
v_mfma_f32_16x16x32_bf16 v[84:87], v[148:151], v[92:95], 0
v_mfma_f32_16x16x32_bf16 v[88:91], v[160:163], v[92:95], 0
v_pk_mul_f32 v[56:57], v[56:57], v[64:65] op_sel_hi:[1,0]
v_pk_mul_f32 v[58:59], v[58:59], v[64:65] op_sel_hi:[1,0]
v_cvt_pk_bf16_f32 v56, v56, v57
v_cvt_pk_bf16_f32 v57, v58, v59
ds_write_b64 v229, v[56:57] offset:5664
v_pk_mul_f32 v[68:69], v[68:69], v[80:81] op_sel_hi:[1,0]
v_pk_mul_f32 v[70:71], v[70:71], v[80:81] op_sel_hi:[1,0]
v_cvt_pk_bf16_f32 v68, v68, v69
v_cvt_pk_bf16_f32 v69, v70, v71
ds_write_b64 v228, v[68:69] offset:8448
v_pk_mul_f32 v[72:73], v[72:73], v[80:81] op_sel_hi:[1,0]
v_pk_mul_f32 v[74:75], v[74:75], v[80:81] op_sel_hi:[1,0]
v_cvt_pk_bf16_f32 v72, v72, v73
v_rcp_f32 v96, v96
v_cvt_pk_bf16_f32 v73, v74, v75
ds_write_b64 v229, v[72:73] offset:8480
v_pk_mul_f32 v[84:85], v[84:85], v[96:97] op_sel_hi:[1,0]
v_pk_mul_f32 v[86:87], v[86:87], v[96:97] op_sel_hi:[1,0]
v_cvt_pk_bf16_f32 v84, v84, v85
v_cvt_pk_bf16_f32 v85, v86, v87
ds_write_b64 v228, v[84:85] offset:11264
v_pk_mul_f32 v[88:89], v[88:89], v[96:97] op_sel_hi:[1,0]
v_pk_mul_f32 v[90:91], v[90:91], v[96:97] op_sel_hi:[1,0]
v_cvt_pk_bf16_f32 v88, v88, v89
v_cvt_pk_bf16_f32 v89, v90, v91
ds_write_b64 v229, v[88:89] offset:11296
s_waitcnt vmcnt(17) lgkmcnt(0)
s_barrier
ds_read_b128 v[20:23], v15 offset:0
ds_read_b128 v[24:27], v16 offset:256
ds_read_b128 v[28:31], v17 offset:512
ds_read_b128 v[32:35], v18 offset:768
s_mul_i32 s56, s53, 20480
s_add_u32 s56, s56, 4194304
s_mov_b32 s55, 0x05040100
s_add_u32 s57, s56, 4096
s_add_u32 s58, s56, 8192
s_add_u32 s59, s56, 12288
s_add_u32 s60, s56, 16384
s_waitcnt lgkmcnt(3)
buffer_store_dwordx4 v[20:23], v11, s[4:7], s46 offen sc1
s_waitcnt lgkmcnt(2)
buffer_store_dwordx4 v[24:27], v12, s[4:7], s46 offen sc1
s_waitcnt lgkmcnt(1)
buffer_store_dwordx4 v[28:31], v13, s[4:7], s46 offen sc1
s_waitcnt lgkmcnt(0)
buffer_store_dwordx4 v[32:35], v14, s[4:7], s46 offen sc1
s_waitcnt vmcnt(8)
v_perm_b32 v36, v241, v240, s55
v_perm_b32 v37, v243, v242, s55
v_xor_b32 v36, s40, v36
v_xor_b32 v37, s40, v37
v_or_b32 v38, v36, v37
v_perm_b32 v36, v191, v190, s55
v_perm_b32 v37, v193, v192, s55
v_xor_b32 v36, s40, v36
v_xor_b32 v37, s40, v37
v_or3_b32 v38, v38, v36, v37
v_and_b32 v38, v38, v230
v_xor_b32 v37, s40, v194
v_or_b32 v38, v38, v37
v_cmp_ne_u32 vcc, 0, v38
s_cbranch_vccnz L_mv_retry
L_mv_ok:
v_cmp_ne_u32 vcc, s19, v195
v_and_b32 v240, 0xffff0000, v240
v_and_b32 v241, 0xffff0000, v241
v_and_b32 v242, 0xffff0000, v242
v_and_b32 v243, 0xffff0000, v243
v_and_b32 v190, 0xffff0000, v190
v_and_b32 v191, 0xffff0000, v191
v_and_b32 v192, 0xffff0000, v192
v_and_b32 v193, 0xffff0000, v193
s_lshr_b32 s15, vcc_lo, 16
v_lshlrev_b32 v40, 16, v244
v_and_b32 v41, 0xffff0000, v244
v_lshlrev_b32 v42, 16, v245
v_and_b32 v43, 0xffff0000, v245
v_pk_mul_f32 v[40:41], v[40:41], v[190:191]
v_pk_mul_f32 v[42:43], v[42:43], v[192:193]
s_mov_b32 exec_hi, 0xffff
ds_write_b128 v227, v[40:43] offset:1536
ds_write_b128 v227, v[240:243]
ds_write_b128 v227, v[190:193] offset:768
s_mov_b32 exec_hi, -1
s_add_u32 m0, s39, 110592
s_nop 0
buffer_load_dwordx4 v232, s[24:27], s48 offen offset:0 lds
ds_read_b128 v[204:207], v247 offset:1536
ds_read_b128 v[208:211], v247 offset:1600
ds_read_b128 v[212:215], v247 offset:1664
ds_read_b128 v[216:219], v247 offset:1728
ds_read_b128 v[220:223], v247 offset:1792
ds_read_b128 v[224:227], v247 offset:1856
buffer_load_dwordx4 v233, s[24:27], s48 offen offset:1024 lds
ds_read_b64 v[80:81], v248 offset:0
ds_read_b64 v[82:83], v248 offset:32
ds_read_b64 v[84:85], v248 offset:64
ds_read_b64 v[86:87], v248 offset:96
ds_read_b64 v[88:89], v248 offset:128
ds_read_b64 v[90:91], v248 offset:160
buffer_load_dwordx4 v234, s[24:27], s48 offen offset:2048 lds
s_add_u32 s48, s48, 81920
ds_read_b64_tr_b16 a[48:49], v249 offset:24576
ds_read_b64_tr_b16 a[50:51], v249 offset:25344
ds_read_b64_tr_b16 a[52:53], v252 offset:24576
ds_read_b64_tr_b16 a[54:55], v252 offset:25344
ds_read_b64_tr_b16 a[56:57], v249 offset:24640
ds_read_b64_tr_b16 a[58:59], v249 offset:25408
ds_read_b64_tr_b16 a[60:61], v252 offset:24640
ds_read_b64_tr_b16 a[62:63], v252 offset:25408
ds_read_b64_tr_b16 a[64:65], v249 offset:24704
ds_read_b64_tr_b16 a[66:67], v249 offset:25472
ds_read_b64_tr_b16 a[68:69], v252 offset:24704
ds_read_b64_tr_b16 a[70:71], v252 offset:25472
ds_read_b64_tr_b16 a[72:73], v249 offset:30720
ds_read_b64_tr_b16 a[74:75], v249 offset:31488
ds_read_b64_tr_b16 a[76:77], v252 offset:30720
ds_read_b64_tr_b16 a[78:79], v252 offset:31488
ds_read_b64_tr_b16 a[80:81], v249 offset:30784
ds_read_b64_tr_b16 a[82:83], v249 offset:31552
ds_read_b64_tr_b16 a[84:85], v252 offset:30784
ds_read_b64_tr_b16 a[86:87], v252 offset:31552
ds_read_b64_tr_b16 a[88:89], v249 offset:30848
ds_read_b64_tr_b16 a[90:91], v249 offset:31616
ds_read_b64_tr_b16 a[92:93], v252 offset:30848
ds_read_b64_tr_b16 a[94:95], v252 offset:31616
ds_read_b64_tr_b16 a[96:97], v249 offset:36864
ds_read_b64_tr_b16 a[98:99], v249 offset:37632
ds_read_b64_tr_b16 a[100:101], v252 offset:36864
ds_read_b64_tr_b16 a[102:103], v252 offset:37632
ds_read_b64_tr_b16 a[104:105], v249 offset:36928
ds_read_b64_tr_b16 a[106:107], v249 offset:37696
ds_read_b64_tr_b16 a[108:109], v252 offset:36928
ds_read_b64_tr_b16 a[110:111], v252 offset:37696
ds_read_b64_tr_b16 a[112:113], v249 offset:36992
ds_read_b64_tr_b16 a[114:115], v249 offset:37760
ds_read_b64_tr_b16 a[116:117], v252 offset:36992
ds_read_b64_tr_b16 a[118:119], v252 offset:37760
ds_read_b64_tr_b16 a[120:121], v249 offset:43008
ds_read_b64_tr_b16 a[122:123], v249 offset:43776
ds_read_b64_tr_b16 a[124:125], v252 offset:43008
ds_read_b64_tr_b16 a[126:127], v252 offset:43776
ds_read_b64_tr_b16 a[128:129], v249 offset:43072
ds_read_b64_tr_b16 a[130:131], v249 offset:43840
ds_read_b64_tr_b16 a[132:133], v252 offset:43072
ds_read_b64_tr_b16 a[134:135], v252 offset:43840
ds_read_b64_tr_b16 a[136:137], v249 offset:43136
ds_read_b64_tr_b16 a[138:139], v249 offset:43904
ds_read_b64_tr_b16 a[140:141], v252 offset:43136
ds_read_b64_tr_b16 a[142:143], v252 offset:43904
ds_read_b64_tr_b16 a[144:145], v249 offset:49152
ds_read_b64_tr_b16 a[146:147], v249 offset:49920
ds_read_b64_tr_b16 a[148:149], v252 offset:49152
ds_read_b64_tr_b16 a[150:151], v252 offset:49920
ds_read_b64_tr_b16 a[152:153], v249 offset:49216
ds_read_b64_tr_b16 a[154:155], v249 offset:49984
ds_read_b64_tr_b16 a[156:157], v252 offset:49216
ds_read_b64_tr_b16 a[158:159], v252 offset:49984
ds_read_b64_tr_b16 a[160:161], v249 offset:49280
ds_read_b64_tr_b16 a[162:163], v249 offset:50048
buffer_load_dwordx4 v[100:103], v7, s[4:7], s56 offen offset:0 sc1
ds_read_b64_tr_b16 a[164:165], v252 offset:49280
ds_read_b64_tr_b16 a[166:167], v252 offset:50048
ds_read_b64_tr_b16 a[0:1], v249 offset:55296
ds_read_b64_tr_b16 a[2:3], v249 offset:56064
buffer_load_dwordx4 v[104:107], v7, s[4:7], s56 offen offset:1024 sc1
ds_read_b64_tr_b16 a[4:5], v252 offset:55296
ds_read_b64_tr_b16 a[6:7], v252 offset:56064
ds_read_b64_tr_b16 a[8:9], v249 offset:55360
ds_read_b64_tr_b16 a[10:11], v249 offset:56128
buffer_load_dwordx4 v[108:111], v7, s[4:7], s56 offen offset:2048 sc1
ds_read_b64_tr_b16 a[12:13], v252 offset:55360
ds_read_b64_tr_b16 a[14:15], v252 offset:56128
ds_read_b64_tr_b16 a[16:17], v249 offset:55424
ds_read_b64_tr_b16 a[18:19], v249 offset:56192
buffer_load_dwordx4 v[112:115], v7, s[4:7], s56 offen offset:3072 sc1
ds_read_b64_tr_b16 a[20:21], v252 offset:55424
ds_read_b64_tr_b16 a[22:23], v252 offset:56192
ds_read_b64_tr_b16 a[24:25], v253 offset:0
ds_read_b64_tr_b16 a[26:27], v253 offset:768
buffer_load_dwordx4 v[116:119], v7, s[4:7], s57 offen offset:0 sc1
ds_read_b64_tr_b16 a[28:29], v254 offset:0
ds_read_b64_tr_b16 a[30:31], v254 offset:768
ds_read_b64_tr_b16 a[32:33], v253 offset:64
ds_read_b64_tr_b16 a[34:35], v253 offset:832
buffer_load_dwordx4 v[120:123], v7, s[4:7], s57 offen offset:1024 sc1
s_waitcnt lgkmcnt(15)
v_pk_add_f32 v[94:95], v[204:205], v[206:207]
v_pk_add_f32 v[94:95], v[94:95], v[208:209]
v_pk_add_f32 v[94:95], v[94:95], v[210:211]
buffer_load_dwordx4 v[124:127], v7, s[4:7], s57 offen offset:2048 sc1
v_pk_add_f32 v[94:95], v[94:95], v[212:213]
v_pk_add_f32 v[94:95], v[94:95], v[214:215]
v_pk_add_f32 v[94:95], v[94:95], v[216:217]
v_pk_add_f32 v[94:95], v[94:95], v[218:219]
buffer_load_dwordx4 v[128:131], v7, s[4:7], s57 offen offset:3072 sc1
v_pk_add_f32 v[94:95], v[94:95], v[220:221]
v_pk_add_f32 v[94:95], v[94:95], v[222:223]
v_pk_add_f32 v[94:95], v[94:95], v[224:225]
v_pk_add_f32 v[94:95], v[94:95], v[226:227]
v_add_f32 v95, v94, v95
s_waitcnt vmcnt(6) lgkmcnt(0)
v_max3_u32 v92, v100, v101, v102
v_max3_u32 v93, v103, v104, v105
v_max3_u32 v92, v92, v106, v107
v_max_u32 v92, v92, v93
v_cmp_eq_u32 vcc, -1, v92
s_cbranch_vccnz L_o0_retry
L_o0_ok:
v_mfma_f32_16x16x32_bf16 v[20:23], a[168:171], v[100:103], 0
ds_read_b64_tr_b16 a[168:169], v254 offset:64
buffer_load_dwordx4 v[132:135], v7, s[4:7], s58 offen offset:0 sc1
v_mfma_f32_16x16x32_bf16 v[24:27], a[172:175], v[100:103], 0
ds_read_b64_tr_b16 a[170:171], v254 offset:832
buffer_load_dwordx4 v[136:139], v7, s[4:7], s58 offen offset:1024 sc1
v_mfma_f32_16x16x32_bf16 v[28:31], a[176:179], v[100:103], 0
ds_read_b64_tr_b16 a[172:173], v253 offset:128
s_barrier
v_mfma_f32_16x16x32_bf16 v[32:35], a[180:183], v[100:103], 0
ds_read_b64_tr_b16 a[174:175], v253 offset:896
s_waitcnt vmcnt(6)
v_mfma_f32_16x16x32_bf16 v[36:39], a[184:187], v[100:103], 0
ds_read_b64_tr_b16 a[176:177], v254 offset:128
v_max3_u32 v92, v108, v109, v110
v_mfma_f32_16x16x32_bf16 v[40:43], a[188:191], v[100:103], 0
ds_read_b64_tr_b16 a[178:179], v254 offset:896
v_max3_u32 v93, v111, v112, v113
v_mfma_f32_16x16x32_bf16 v[20:23], a[192:195], v[104:107], v[20:23]
ds_read_b64_tr_b16 a[180:181], v253 offset:6144
v_max3_u32 v92, v92, v114, v115
v_mfma_f32_16x16x32_bf16 v[24:27], a[196:199], v[104:107], v[24:27]
ds_read_b64_tr_b16 a[182:183], v253 offset:6912
v_max_u32 v92, v92, v93
v_mfma_f32_16x16x32_bf16 v[28:31], a[200:203], v[104:107], v[28:31]
ds_read_b64_tr_b16 a[184:185], v254 offset:6144
v_lshlrev_b32 v68, 16, v80
v_mfma_f32_16x16x32_bf16 v[32:35], a[204:207], v[104:107], v[32:35]
ds_read_b64_tr_b16 a[186:187], v254 offset:6912
v_cmp_eq_u32 vcc, -1, v92
v_mfma_f32_16x16x32_bf16 v[36:39], a[208:211], v[104:107], v[36:39]
ds_read_b64_tr_b16 a[188:189], v253 offset:6208
v_and_b32 v69, 0xffff0000, v80
v_mfma_f32_16x16x32_bf16 v[40:43], a[212:215], v[104:107], v[40:43]
ds_read_b64_tr_b16 a[190:191], v253 offset:6976
s_cbranch_vccnz L_o1_retry
L_o1_ok:
v_mfma_f32_16x16x32_bf16 v[20:23], a[216:219], v[108:111], v[20:23]
ds_read_b64_tr_b16 a[192:193], v254 offset:6208
buffer_load_dwordx4 v[140:143], v7, s[4:7], s58 offen offset:2048 sc1
v_mfma_f32_16x16x32_bf16 v[24:27], a[220:223], v[108:111], v[24:27]
ds_read_b64_tr_b16 a[194:195], v254 offset:6976
buffer_load_dwordx4 v[144:147], v7, s[4:7], s58 offen offset:3072 sc1
v_mfma_f32_16x16x32_bf16 v[28:31], a[224:227], v[108:111], v[28:31]
ds_read_b64_tr_b16 a[196:197], v253 offset:6272
v_lshlrev_b32 v70, 16, v81
v_mfma_f32_16x16x32_bf16 v[32:35], a[228:231], v[108:111], v[32:35]
ds_read_b64_tr_b16 a[198:199], v253 offset:7040
s_waitcnt vmcnt(6)
v_mfma_f32_16x16x32_bf16 v[36:39], a[232:235], v[108:111], v[36:39]
ds_read_b64_tr_b16 a[200:201], v254 offset:6272
v_max3_u32 v92, v116, v117, v118
v_mfma_f32_16x16x32_bf16 v[40:43], a[236:239], v[108:111], v[40:43]
ds_read_b64_tr_b16 a[202:203], v254 offset:7040
v_max3_u32 v93, v119, v120, v121
v_mfma_f32_16x16x32_bf16 v[20:23], a[240:243], v[112:115], v[20:23]
ds_read_b64_tr_b16 a[204:205], v253 offset:12288
v_max3_u32 v92, v92, v122, v123
v_mfma_f32_16x16x32_bf16 v[24:27], a[244:247], v[112:115], v[24:27]
ds_read_b64_tr_b16 a[206:207], v253 offset:13056
v_max_u32 v92, v92, v93
v_mfma_f32_16x16x32_bf16 v[28:31], a[248:251], v[112:115], v[28:31]
ds_read_b64_tr_b16 a[208:209], v254 offset:12288
v_and_b32 v71, 0xffff0000, v81
v_mfma_f32_16x16x32_bf16 v[32:35], a[252:255], v[112:115], v[32:35]
ds_read_b64_tr_b16 a[210:211], v254 offset:13056
v_cmp_eq_u32 vcc, -1, v92
v_mfma_f32_16x16x32_bf16 v[36:39], a[40:43], v[112:115], v[36:39]
ds_read_b64_tr_b16 a[212:213], v253 offset:12352
v_lshlrev_b32 v72, 16, v82
v_mfma_f32_16x16x32_bf16 v[40:43], a[44:47], v[112:115], v[40:43]
ds_read_b64_tr_b16 a[214:215], v253 offset:13120
s_cbranch_vccnz L_o2_retry
L_o2_ok:
v_mfma_f32_16x16x32_bf16 v[20:23], a[48:51], v[116:119], v[20:23]
ds_read_b64_tr_b16 a[216:217], v254 offset:12352
buffer_load_dwordx4 v[148:151], v7, s[4:7], s59 offen offset:0 sc1
v_mfma_f32_16x16x32_bf16 v[24:27], a[52:55], v[116:119], v[24:27]
ds_read_b64_tr_b16 a[218:219], v254 offset:13120
buffer_load_dwordx4 v[152:155], v7, s[4:7], s59 offen offset:1024 sc1
v_mfma_f32_16x16x32_bf16 v[28:31], a[56:59], v[116:119], v[28:31]
ds_read_b64_tr_b16 a[220:221], v253 offset:12416
v_and_b32 v73, 0xffff0000, v82
v_mfma_f32_16x16x32_bf16 v[32:35], a[60:63], v[116:119], v[32:35]
ds_read_b64_tr_b16 a[222:223], v253 offset:13184
s_waitcnt vmcnt(6)
v_mfma_f32_16x16x32_bf16 v[36:39], a[64:67], v[116:119], v[36:39]
ds_read_b64_tr_b16 a[224:225], v254 offset:12416
v_max3_u32 v92, v124, v125, v126
v_mfma_f32_16x16x32_bf16 v[40:43], a[68:71], v[116:119], v[40:43]
ds_read_b64_tr_b16 a[226:227], v254 offset:13184
v_max3_u32 v93, v127, v128, v129
v_mfma_f32_16x16x32_bf16 v[20:23], a[72:75], v[120:123], v[20:23]
ds_read_b64_tr_b16 a[228:229], v253 offset:18432
v_max3_u32 v92, v92, v130, v131
v_mfma_f32_16x16x32_bf16 v[24:27], a[76:79], v[120:123], v[24:27]
ds_read_b64_tr_b16 a[230:231], v253 offset:19200
v_max_u32 v92, v92, v93
v_mfma_f32_16x16x32_bf16 v[28:31], a[80:83], v[120:123], v[28:31]
ds_read_b64_tr_b16 a[232:233], v254 offset:18432
v_lshlrev_b32 v74, 16, v83
v_mfma_f32_16x16x32_bf16 v[32:35], a[84:87], v[120:123], v[32:35]
ds_read_b64_tr_b16 a[234:235], v254 offset:19200
v_cmp_eq_u32 vcc, -1, v92
v_mfma_f32_16x16x32_bf16 v[36:39], a[88:91], v[120:123], v[36:39]
ds_read_b64_tr_b16 a[236:237], v253 offset:18496
v_and_b32 v75, 0xffff0000, v83
v_mfma_f32_16x16x32_bf16 v[40:43], a[92:95], v[120:123], v[40:43]
ds_read_b64_tr_b16 a[238:239], v253 offset:19264
s_cbranch_vccnz L_o3_retry
L_o3_ok:
v_mfma_f32_16x16x32_bf16 v[20:23], a[96:99], v[124:127], v[20:23]
ds_read_b64_tr_b16 a[240:241], v254 offset:18496
buffer_load_dwordx4 v[156:159], v7, s[4:7], s59 offen offset:2048 sc1
v_mfma_f32_16x16x32_bf16 v[24:27], a[100:103], v[124:127], v[24:27]
ds_read_b64_tr_b16 a[242:243], v254 offset:19264
buffer_load_dwordx4 v[160:163], v7, s[4:7], s59 offen offset:3072 sc1
v_mfma_f32_16x16x32_bf16 v[28:31], a[104:107], v[124:127], v[28:31]
ds_read_b64_tr_b16 a[244:245], v253 offset:18560
v_lshlrev_b32 v76, 16, v84
v_mfma_f32_16x16x32_bf16 v[32:35], a[108:111], v[124:127], v[32:35]
ds_read_b64_tr_b16 a[246:247], v253 offset:19328
s_waitcnt vmcnt(6)
v_mfma_f32_16x16x32_bf16 v[36:39], a[112:115], v[124:127], v[36:39]
ds_read_b64_tr_b16 a[248:249], v254 offset:18560
v_max3_u32 v92, v132, v133, v134
v_mfma_f32_16x16x32_bf16 v[40:43], a[116:119], v[124:127], v[40:43]
ds_read_b64_tr_b16 a[250:251], v254 offset:19328
v_max3_u32 v93, v135, v136, v137
v_mfma_f32_16x16x32_bf16 v[20:23], a[120:123], v[128:131], v[20:23]
ds_read_b64_tr_b16 a[252:253], v253 offset:24576
v_max3_u32 v92, v92, v138, v139
v_mfma_f32_16x16x32_bf16 v[24:27], a[124:127], v[128:131], v[24:27]
ds_read_b64_tr_b16 a[254:255], v253 offset:25344
v_max_u32 v92, v92, v93
v_mfma_f32_16x16x32_bf16 v[28:31], a[128:131], v[128:131], v[28:31]
ds_read_b64_tr_b16 a[40:41], v254 offset:24576
v_and_b32 v77, 0xffff0000, v84
v_mfma_f32_16x16x32_bf16 v[32:35], a[132:135], v[128:131], v[32:35]
ds_read_b64_tr_b16 a[42:43], v254 offset:25344
v_cmp_eq_u32 vcc, -1, v92
v_mfma_f32_16x16x32_bf16 v[36:39], a[136:139], v[128:131], v[36:39]
ds_read_b64_tr_b16 a[44:45], v253 offset:24640
v_lshlrev_b32 v78, 16, v85
v_mfma_f32_16x16x32_bf16 v[40:43], a[140:143], v[128:131], v[40:43]
ds_read_b64_tr_b16 a[46:47], v253 offset:25408
s_cbranch_vccnz L_o4_retry
L_o4_ok:
v_mfma_f32_16x16x32_bf16 v[20:23], a[144:147], v[132:135], v[20:23]
ds_read_b64_tr_b16 a[48:49], v254 offset:24640
buffer_load_dwordx4 v[164:167], v7, s[4:7], s60 offen offset:0 sc1
v_mfma_f32_16x16x32_bf16 v[24:27], a[148:151], v[132:135], v[24:27]
ds_read_b64_tr_b16 a[50:51], v254 offset:25408
buffer_load_dwordx4 v[168:171], v7, s[4:7], s60 offen offset:1024 sc1
v_mfma_f32_16x16x32_bf16 v[28:31], a[152:155], v[132:135], v[28:31]
ds_read_b64_tr_b16 a[52:53], v253 offset:24704
v_and_b32 v79, 0xffff0000, v85
v_mfma_f32_16x16x32_bf16 v[32:35], a[156:159], v[132:135], v[32:35]
ds_read_b64_tr_b16 a[54:55], v253 offset:25472
s_waitcnt vmcnt(6)
v_mfma_f32_16x16x32_bf16 v[36:39], a[160:163], v[132:135], v[36:39]
ds_read_b64_tr_b16 a[56:57], v254 offset:24704
v_max3_u32 v92, v140, v141, v142
v_mfma_f32_16x16x32_bf16 v[40:43], a[164:167], v[132:135], v[40:43]
ds_read_b64_tr_b16 a[58:59], v254 offset:25472
v_max3_u32 v93, v143, v144, v145
v_mfma_f32_16x16x32_bf16 v[20:23], a[0:3], v[136:139], v[20:23]
ds_read_b64_tr_b16 a[60:61], v253 offset:30720
v_max3_u32 v92, v92, v146, v147
v_mfma_f32_16x16x32_bf16 v[24:27], a[4:7], v[136:139], v[24:27]
ds_read_b64_tr_b16 a[62:63], v253 offset:31488
v_max_u32 v92, v92, v93
v_mfma_f32_16x16x32_bf16 v[28:31], a[8:11], v[136:139], v[28:31]
ds_read_b64_tr_b16 a[64:65], v254 offset:30720
v_lshlrev_b32 v80, 16, v86
v_mfma_f32_16x16x32_bf16 v[32:35], a[12:15], v[136:139], v[32:35]
ds_read_b64_tr_b16 a[66:67], v254 offset:31488
v_cmp_eq_u32 vcc, -1, v92
v_mfma_f32_16x16x32_bf16 v[36:39], a[16:19], v[136:139], v[36:39]
ds_read_b64_tr_b16 a[68:69], v253 offset:30784
v_and_b32 v81, 0xffff0000, v86
v_mfma_f32_16x16x32_bf16 v[40:43], a[20:23], v[136:139], v[40:43]
ds_read_b64_tr_b16 a[70:71], v253 offset:31552
s_cbranch_vccnz L_o5_retry
L_o5_ok:
v_mfma_f32_16x16x32_bf16 v[20:23], a[24:27], v[140:143], v[20:23]
ds_read_b64_tr_b16 a[72:73], v254 offset:30784
buffer_load_dwordx4 v[172:175], v7, s[4:7], s60 offen offset:2048 sc1
v_mfma_f32_16x16x32_bf16 v[24:27], a[28:31], v[140:143], v[24:27]
ds_read_b64_tr_b16 a[74:75], v254 offset:31552
buffer_load_dwordx4 v[176:179], v7, s[4:7], s60 offen offset:3072 sc1
v_mfma_f32_16x16x32_bf16 v[28:31], a[32:35], v[140:143], v[28:31]
ds_read_b64_tr_b16 a[76:77], v253 offset:30848
s_waitcnt lgkmcnt(15)
v_mfma_f32_16x16x32_bf16 v[32:35], a[168:171], v[140:143], v[32:35]
ds_read_b64_tr_b16 a[78:79], v253 offset:31616
s_waitcnt vmcnt(6)
v_mfma_f32_16x16x32_bf16 v[36:39], a[172:175], v[140:143], v[36:39]
ds_read_b64_tr_b16 a[80:81], v254 offset:30848
v_max3_u32 v92, v148, v149, v150
v_mfma_f32_16x16x32_bf16 v[40:43], a[176:179], v[140:143], v[40:43]
ds_read_b64_tr_b16 a[82:83], v254 offset:31616
v_max3_u32 v93, v151, v152, v153
v_mfma_f32_16x16x32_bf16 v[20:23], a[180:183], v[144:147], v[20:23]
ds_read_b64_tr_b16 a[84:85], v253 offset:36864
v_max3_u32 v92, v92, v154, v155
v_mfma_f32_16x16x32_bf16 v[24:27], a[184:187], v[144:147], v[24:27]
ds_read_b64_tr_b16 a[86:87], v253 offset:37632
v_max_u32 v92, v92, v93
v_mfma_f32_16x16x32_bf16 v[28:31], a[188:191], v[144:147], v[28:31]
ds_read_b64_tr_b16 a[88:89], v254 offset:36864
v_mfma_f32_16x16x32_bf16 v[32:35], a[192:195], v[144:147], v[32:35]
ds_read_b64_tr_b16 a[90:91], v254 offset:37632
v_cmp_eq_u32 vcc, -1, v92
v_mfma_f32_16x16x32_bf16 v[36:39], a[196:199], v[144:147], v[36:39]
ds_read_b64_tr_b16 a[92:93], v253 offset:36928
v_lshlrev_b32 v82, 16, v87
v_mfma_f32_16x16x32_bf16 v[40:43], a[200:203], v[144:147], v[40:43]
ds_read_b64_tr_b16 a[94:95], v253 offset:37696
s_cbranch_vccnz L_o6_retry
L_o6_ok:
v_mfma_f32_16x16x32_bf16 v[20:23], a[204:207], v[148:151], v[20:23]
ds_read_b64_tr_b16 a[96:97], v254 offset:36928
v_and_b32 v83, 0xffff0000, v87
v_mfma_f32_16x16x32_bf16 v[24:27], a[208:211], v[148:151], v[24:27]
ds_read_b64_tr_b16 a[98:99], v254 offset:37696
v_lshlrev_b32 v84, 16, v88
v_mfma_f32_16x16x32_bf16 v[28:31], a[212:215], v[148:151], v[28:31]
ds_read_b64_tr_b16 a[100:101], v253 offset:36992
v_mfma_f32_16x16x32_bf16 v[32:35], a[216:219], v[148:151], v[32:35]
ds_read_b64_tr_b16 a[102:103], v253 offset:37760
s_waitcnt vmcnt(4)
v_mfma_f32_16x16x32_bf16 v[36:39], a[220:223], v[148:151], v[36:39]
ds_read_b64_tr_b16 a[104:105], v254 offset:36992
v_max3_u32 v92, v156, v157, v158
v_mfma_f32_16x16x32_bf16 v[40:43], a[224:227], v[148:151], v[40:43]
ds_read_b64_tr_b16 a[106:107], v254 offset:37760
v_max3_u32 v93, v159, v160, v161
v_mfma_f32_16x16x32_bf16 v[20:23], a[228:231], v[152:155], v[20:23]
ds_read_b64_tr_b16 a[108:109], v253 offset:43008
v_max3_u32 v92, v92, v162, v163
v_mfma_f32_16x16x32_bf16 v[24:27], a[232:235], v[152:155], v[24:27]
ds_read_b64_tr_b16 a[110:111], v253 offset:43776
v_max_u32 v92, v92, v93
v_mfma_f32_16x16x32_bf16 v[28:31], a[236:239], v[152:155], v[28:31]
ds_read_b64_tr_b16 a[112:113], v254 offset:43008
v_mfma_f32_16x16x32_bf16 v[32:35], a[240:243], v[152:155], v[32:35]
ds_read_b64_tr_b16 a[114:115], v254 offset:43776
v_cmp_eq_u32 vcc, -1, v92
v_mfma_f32_16x16x32_bf16 v[36:39], a[244:247], v[152:155], v[36:39]
ds_read_b64_tr_b16 a[116:117], v253 offset:43072
v_and_b32 v85, 0xffff0000, v88
v_mfma_f32_16x16x32_bf16 v[40:43], a[248:251], v[152:155], v[40:43]
ds_read_b64_tr_b16 a[118:119], v253 offset:43840
s_cbranch_vccnz L_o7_retry
L_o7_ok:
v_mfma_f32_16x16x32_bf16 v[20:23], a[252:255], v[156:159], v[20:23]
ds_read_b64_tr_b16 a[120:121], v254 offset:43072
v_lshlrev_b32 v86, 16, v89
v_mfma_f32_16x16x32_bf16 v[24:27], a[40:43], v[156:159], v[24:27]
ds_read_b64_tr_b16 a[122:123], v254 offset:43840
v_and_b32 v87, 0xffff0000, v89
v_mfma_f32_16x16x32_bf16 v[28:31], a[44:47], v[156:159], v[28:31]
ds_read_b64_tr_b16 a[124:125], v253 offset:43136
s_waitcnt lgkmcnt(15)
v_mfma_f32_16x16x32_bf16 v[32:35], a[48:51], v[156:159], v[32:35]
ds_read_b64_tr_b16 a[126:127], v253 offset:43904
s_waitcnt vmcnt(2)
v_mfma_f32_16x16x32_bf16 v[36:39], a[52:55], v[156:159], v[36:39]
ds_read_b64_tr_b16 a[128:129], v254 offset:43136
v_max3_u32 v92, v164, v165, v166
v_mfma_f32_16x16x32_bf16 v[40:43], a[56:59], v[156:159], v[40:43]
ds_read_b64_tr_b16 a[130:131], v254 offset:43904
v_max3_u32 v93, v167, v168, v169
v_mfma_f32_16x16x32_bf16 v[20:23], a[60:63], v[160:163], v[20:23]
ds_read_b64_tr_b16 a[132:133], v253 offset:49152
v_max3_u32 v92, v92, v170, v171
v_mfma_f32_16x16x32_bf16 v[24:27], a[64:67], v[160:163], v[24:27]
ds_read_b64_tr_b16 a[134:135], v253 offset:49920
v_max_u32 v92, v92, v93
v_mfma_f32_16x16x32_bf16 v[28:31], a[68:71], v[160:163], v[28:31]
ds_read_b64_tr_b16 a[136:137], v254 offset:49152
v_mfma_f32_16x16x32_bf16 v[32:35], a[72:75], v[160:163], v[32:35]
ds_read_b64_tr_b16 a[138:139], v254 offset:49920
v_cmp_eq_u32 vcc, -1, v92
v_mfma_f32_16x16x32_bf16 v[36:39], a[76:79], v[160:163], v[36:39]
ds_read_b64_tr_b16 a[140:141], v253 offset:49216
v_lshlrev_b32 v88, 16, v90
v_mfma_f32_16x16x32_bf16 v[40:43], a[80:83], v[160:163], v[40:43]
ds_read_b64_tr_b16 a[142:143], v253 offset:49984
s_cbranch_vccnz L_o8_retry
L_o8_ok:
v_mfma_f32_16x16x32_bf16 v[20:23], a[84:87], v[164:167], v[20:23]
ds_read_b64_tr_b16 a[144:145], v254 offset:49216
v_and_b32 v89, 0xffff0000, v90
v_mfma_f32_16x16x32_bf16 v[24:27], a[88:91], v[164:167], v[24:27]
ds_read_b64_tr_b16 a[146:147], v254 offset:49984
v_lshlrev_b32 v90, 16, v91
v_mfma_f32_16x16x32_bf16 v[28:31], a[92:95], v[164:167], v[28:31]
ds_read_b64_tr_b16 a[148:149], v253 offset:49280
s_waitcnt lgkmcnt(15)
v_mfma_f32_16x16x32_bf16 v[32:35], a[96:99], v[164:167], v[32:35]
ds_read_b64_tr_b16 a[150:151], v253 offset:50048
s_waitcnt vmcnt(0)
v_mfma_f32_16x16x32_bf16 v[36:39], a[100:103], v[164:167], v[36:39]
ds_read_b64_tr_b16 a[152:153], v254 offset:49280
v_max3_u32 v92, v172, v173, v174
v_mfma_f32_16x16x32_bf16 v[40:43], a[104:107], v[164:167], v[40:43]
ds_read_b64_tr_b16 a[154:155], v254 offset:50048
v_max3_u32 v93, v175, v176, v177
v_mfma_f32_16x16x32_bf16 v[20:23], a[108:111], v[168:171], v[20:23]
ds_read_b64_tr_b16 a[156:157], v253 offset:55296
v_max3_u32 v92, v92, v178, v179
v_mfma_f32_16x16x32_bf16 v[24:27], a[112:115], v[168:171], v[24:27]
ds_read_b64_tr_b16 a[158:159], v253 offset:56064
v_max_u32 v92, v92, v93
v_mfma_f32_16x16x32_bf16 v[28:31], a[116:119], v[168:171], v[28:31]
ds_read_b64_tr_b16 a[160:161], v254 offset:55296
s_waitcnt lgkmcnt(9)
v_mfma_f32_16x16x32_bf16 v[32:35], a[120:123], v[168:171], v[32:35]
ds_read_b64_tr_b16 a[162:163], v254 offset:56064
v_cmp_eq_u32 vcc, -1, v92
v_mfma_f32_16x16x32_bf16 v[36:39], a[124:127], v[168:171], v[36:39]
ds_read_b64_tr_b16 a[164:165], v253 offset:55360
v_and_b32 v91, 0xffff0000, v91
v_mfma_f32_16x16x32_bf16 v[40:43], a[128:131], v[168:171], v[40:43]
ds_read_b64_tr_b16 a[166:167], v253 offset:56128
s_cbranch_vccnz L_o9_retry
L_o9_ok:
v_mfma_f32_16x16x32_bf16 v[20:23], a[132:135], v[172:175], v[20:23]
ds_read_b64_tr_b16 a[0:1], v254 offset:55360
v_mfma_f32_16x16x32_bf16 v[24:27], a[136:139], v[172:175], v[24:27]
ds_read_b64_tr_b16 a[2:3], v254 offset:56128
v_mfma_f32_16x16x32_bf16 v[28:31], a[140:143], v[172:175], v[28:31]
ds_read_b64_tr_b16 a[4:5], v253 offset:55424
s_waitcnt lgkmcnt(9)
v_mfma_f32_16x16x32_bf16 v[32:35], a[144:147], v[172:175], v[32:35]
ds_read_b64_tr_b16 a[6:7], v253 offset:56192
v_mfma_f32_16x16x32_bf16 v[36:39], a[148:151], v[172:175], v[36:39]
ds_read_b64_tr_b16 a[8:9], v254 offset:55424
v_mfma_f32_16x16x32_bf16 v[40:43], a[152:155], v[172:175], v[40:43]
ds_read_b64_tr_b16 a[10:11], v254 offset:56192
s_waitcnt lgkmcnt(6)
v_mfma_f32_16x16x32_bf16 v[20:23], a[156:159], v[176:179], v[20:23]
ds_read_b128 v[180:183], v247 offset:0
v_mfma_f32_16x16x32_bf16 v[24:27], a[160:163], v[176:179], v[24:27]
ds_read_b128 v[184:187], v247 offset:64
v_mfma_f32_16x16x32_bf16 v[28:31], a[164:167], v[176:179], v[28:31]
ds_read_b128 v[188:191], v247 offset:128
s_waitcnt lgkmcnt(3)
v_mfma_f32_16x16x32_bf16 v[32:35], a[0:3], v[176:179], v[32:35]
ds_read_b128 v[192:195], v247 offset:192
v_mfma_f32_16x16x32_bf16 v[36:39], a[4:7], v[176:179], v[36:39]
ds_read_b128 v[196:199], v247 offset:256
v_mfma_f32_16x16x32_bf16 v[40:43], a[8:11], v[176:179], v[40:43]
ds_read_b128 v[200:203], v247 offset:320
s_lshl_b32 s57, s96, 8
s_add_u32 s57, s57, s14
s_mov_b32 s55, 0xffffff00
s_cmp_eq_u32 s15, 0
s_waitcnt lgkmcnt(4)
v_pk_fma_f32 v[20:21], v[20:21], v[180:181], v[68:69]
v_pk_fma_f32 v[22:23], v[22:23], v[182:183], v[70:71]
v_pk_mul_f32 v[46:47], v[20:21], v[20:21]
v_pk_mul_f32 v[48:49], v[20:21], v[204:205]
v_pk_fma_f32 v[24:25], v[24:25], v[184:185], v[72:73]
v_pk_add_f32 v[44:45], v[20:21], v[22:23]
v_pk_fma_f32 v[46:47], v[22:23], v[22:23], v[46:47]
v_pk_fma_f32 v[48:49], v[22:23], v[206:207], v[48:49]
v_pk_fma_f32 v[26:27], v[26:27], v[186:187], v[74:75]
v_pk_add_f32 v[44:45], v[44:45], v[24:25]
v_pk_fma_f32 v[46:47], v[24:25], v[24:25], v[46:47]
v_pk_fma_f32 v[48:49], v[24:25], v[208:209], v[48:49]
s_waitcnt lgkmcnt(2)
v_pk_fma_f32 v[28:29], v[28:29], v[188:189], v[76:77]
v_pk_add_f32 v[44:45], v[44:45], v[26:27]
v_pk_fma_f32 v[46:47], v[26:27], v[26:27], v[46:47]
v_pk_fma_f32 v[48:49], v[26:27], v[210:211], v[48:49]
v_pk_fma_f32 v[30:31], v[30:31], v[190:191], v[78:79]
v_pk_add_f32 v[44:45], v[44:45], v[28:29]
v_pk_fma_f32 v[46:47], v[28:29], v[28:29], v[46:47]
v_pk_fma_f32 v[48:49], v[28:29], v[212:213], v[48:49]
v_pk_fma_f32 v[32:33], v[32:33], v[192:193], v[80:81]
v_pk_add_f32 v[44:45], v[44:45], v[30:31]
v_pk_fma_f32 v[46:47], v[30:31], v[30:31], v[46:47]
v_pk_fma_f32 v[48:49], v[30:31], v[214:215], v[48:49]
v_pk_fma_f32 v[34:35], v[34:35], v[194:195], v[82:83]
v_pk_add_f32 v[44:45], v[44:45], v[32:33]
v_pk_fma_f32 v[46:47], v[32:33], v[32:33], v[46:47]
v_pk_fma_f32 v[48:49], v[32:33], v[216:217], v[48:49]
s_waitcnt lgkmcnt(0)
v_pk_fma_f32 v[36:37], v[36:37], v[196:197], v[84:85]
v_pk_add_f32 v[44:45], v[44:45], v[34:35]
v_pk_fma_f32 v[46:47], v[34:35], v[34:35], v[46:47]
v_pk_fma_f32 v[48:49], v[34:35], v[218:219], v[48:49]
v_pk_fma_f32 v[38:39], v[38:39], v[198:199], v[86:87]
v_pk_add_f32 v[44:45], v[44:45], v[36:37]
v_pk_fma_f32 v[46:47], v[36:37], v[36:37], v[46:47]
v_pk_fma_f32 v[48:49], v[36:37], v[220:221], v[48:49]
v_pk_fma_f32 v[40:41], v[40:41], v[200:201], v[88:89]
v_pk_add_f32 v[44:45], v[44:45], v[38:39]
v_pk_fma_f32 v[46:47], v[38:39], v[38:39], v[46:47]
v_pk_fma_f32 v[48:49], v[38:39], v[222:223], v[48:49]
v_pk_fma_f32 v[42:43], v[42:43], v[202:203], v[90:91]
v_pk_add_f32 v[44:45], v[44:45], v[40:41]
v_pk_fma_f32 v[46:47], v[40:41], v[40:41], v[46:47]
v_pk_fma_f32 v[48:49], v[40:41], v[224:225], v[48:49]
v_pk_fma_f32 v[48:49], v[42:43], v[226:227], v[48:49]
v_pk_add_f32 v[44:45], v[44:45], v[42:43]
v_pk_fma_f32 v[46:47], v[42:43], v[42:43], v[46:47]
v_add_f32 v48, v48, v49
v_add_f32 v44, v44, v45
v_add_f32 v46, v46, v47
v_permlane32_swap_b32 v48, v95
s_nop 0
v_permlane32_swap_b32 v44, v46
v_add_f32 v48, v48, v95
v_add_f32 v44, v44, v46
s_nop 1
v_permlane16_swap_b32 v44, v48
v_add_f32 v44, v44, v48
v_and_or_b32 v44, v44, s55, v19
s_cbranch_scc0 L_st_slow
buffer_store_dword v44, v0, s[4:7], s57 offen
L_st_j:
ds_read_b128 v[100:103], v247 offset:768
ds_read_b128 v[104:107], v247 offset:832
ds_read_b128 v[108:111], v247 offset:896
ds_read_b128 v[112:115], v247 offset:960
ds_read_b128 v[116:119], v247 offset:1024
ds_read_b128 v[120:123], v247 offset:1088
ds_read_b128 v[124:127], v247 offset:384
ds_read_b128 v[128:131], v247 offset:448
ds_read_b128 v[132:135], v247 offset:512
ds_read_b128 v[136:139], v247 offset:576
ds_read_b128 v[140:143], v247 offset:640
ds_read_b128 v[144:147], v247 offset:704
ds_read_b128 v[148:151], v247 offset:1152
ds_read_b128 v[152:155], v247 offset:1216
ds_read_b128 v[156:159], v247 offset:1280
ds_read_b128 v[160:163], v247 offset:1344
ds_read_b128 v[164:167], v247 offset:1408
ds_read_b128 v[168:171], v247 offset:1472
s_lshl_b32 s57, s3, 2
s_add_u32 s57, s57, 135168
v_mov_b32 v54, s57
v_and_b32 v55, 12, v0
v_add_u32 v55, 135168, v55
v_lshrrev_b32 v65, 3, v1
v_mul_u32_u24 v65, 384, v65
v_add_u32 v65, v65, v7
L_st_p:
buffer_load_dword v180, v0, s[4:7], s14 offen offset:0 sc1
buffer_load_dword v181, v0, s[4:7], s14 offen offset:256 sc1
buffer_load_dword v182, v0, s[4:7], s14 offen offset:512 sc1
buffer_load_dword v183, v0, s[4:7], s14 offen offset:768 sc1
buffer_load_dword v184, v0, s[4:7], s14 offen offset:1024 sc1
buffer_load_dword v185, v0, s[4:7], s14 offen offset:1280 sc1
buffer_load_dword v186, v0, s[4:7], s14 offen offset:1536 sc1
s_waitcnt vmcnt(0)
v_xor_b32 v44, v180, v19
v_xor_b32 v45, v181, v19
v_xor_b32 v46, v182, v19
v_xor_b32 v47, v183, v19
v_xor_b32 v48, v184, v19
v_xor_b32 v49, v185, v19
v_xor_b32 v50, v186, v19
v_or3_b32 v52, v44, v45, v46
v_or3_b32 v53, v47, v48, v49
v_or3_b32 v52, v52, v53, v50
v_and_b32 v52, 0xff, v52
v_cmp_ne_u32 vcc, 0, v52
s_cbranch_vccz L_st_ok
s_add_u32 s97, s97, 1
s_cmp_le_u32 s97, 65536
s_cbranch_scc1 L_st_p
L_st_ok:
v_pk_add_f32 v[44:45], v[44:45], v[46:47]
v_add_f32 v48, v48, v50
v_pk_add_f32 v[44:45], v[44:45], v[48:49]
v_add_f32 v46, v44, v45
v_add_f32 v44, v44, v45
s_nop 1
v_permlane32_swap_b32 v44, v46
v_mov_b32 v45, v44
v_mov_b32 v47, v46
s_nop 0
v_permlane16_swap_b32 v44, v45
v_permlane16_swap_b32 v46, v47
v_mul_f32 v44, 0x3acccccd, v44
v_mul_f32 v46, 0x3acccccd, v46
v_fma_f32 v46, -v44, v44, v46
v_fma_f32 v45, -v44, v47, v45
v_max_f32 v46, 0, v46
v_add_f32 v46, 0x3727c5ac, v46
v_rsq_f32 v48, v46
s_nop 0
v_mul_f32 v45, v45, v48
v_mul_f32 v49, -v44, v48
v_pk_fma_f32 v[68:69], v[20:21], v[48:49], v[48:49] op_sel:[0,0,1] op_sel_hi:[1,0,1]
v_max_f32_dpp v46, v45, v45 row_ror:8 row_mask:0xf bank_mask:0xf
v_pk_fma_f32 v[70:71], v[22:23], v[48:49], v[48:49] op_sel:[0,0,1] op_sel_hi:[1,0,1]
v_pk_fma_f32 v[72:73], v[24:25], v[48:49], v[48:49] op_sel:[0,0,1] op_sel_hi:[1,0,1]
v_max_f32_dpp v46, v46, v46 row_ror:4 row_mask:0xf bank_mask:0xf
v_pk_fma_f32 v[74:75], v[26:27], v[48:49], v[48:49] op_sel:[0,0,1] op_sel_hi:[1,0,1]
v_pk_fma_f32 v[76:77], v[28:29], v[48:49], v[48:49] op_sel:[0,0,1] op_sel_hi:[1,0,1]
v_max_f32_dpp v46, v46, v46 row_ror:2 row_mask:0xf bank_mask:0xf
v_pk_fma_f32 v[78:79], v[30:31], v[48:49], v[48:49] op_sel:[0,0,1] op_sel_hi:[1,0,1]
v_pk_fma_f32 v[80:81], v[32:33], v[48:49], v[48:49] op_sel:[0,0,1] op_sel_hi:[1,0,1]
v_max_f32_dpp v46, v46, v46 row_ror:1 row_mask:0xf bank_mask:0xf
ds_write_b32 v54, v46
v_pk_fma_f32 v[82:83], v[34:35], v[48:49], v[48:49] op_sel:[0,0,1] op_sel_hi:[1,0,1]
v_pk_fma_f32 v[84:85], v[36:37], v[48:49], v[48:49] op_sel:[0,0,1] op_sel_hi:[1,0,1]
v_pk_fma_f32 v[86:87], v[38:39], v[48:49], v[48:49] op_sel:[0,0,1] op_sel_hi:[1,0,1]
v_pk_fma_f32 v[88:89], v[40:41], v[48:49], v[48:49] op_sel:[0,0,1] op_sel_hi:[1,0,1]
v_pk_fma_f32 v[90:91], v[42:43], v[48:49], v[48:49] op_sel:[0,0,1] op_sel_hi:[1,0,1]
s_waitcnt lgkmcnt(0)
s_barrier
ds_read_b32 v52, v55
v_pk_fma_f32 v[68:69], v[68:69], v[100:101], v[124:125]
v_pk_fma_f32 v[70:71], v[70:71], v[102:103], v[126:127]
v_pk_fma_f32 v[72:73], v[72:73], v[104:105], v[128:129]
v_pk_fma_f32 v[74:75], v[74:75], v[106:107], v[130:131]
v_pk_fma_f32 v[76:77], v[76:77], v[108:109], v[132:133]
v_pk_fma_f32 v[78:79], v[78:79], v[110:111], v[134:135]
v_pk_fma_f32 v[80:81], v[80:81], v[112:113], v[136:137]
v_pk_fma_f32 v[82:83], v[82:83], v[114:115], v[138:139]
v_pk_fma_f32 v[84:85], v[84:85], v[116:117], v[140:141]
v_pk_fma_f32 v[86:87], v[86:87], v[118:119], v[142:143]
v_pk_fma_f32 v[88:89], v[88:89], v[120:121], v[144:145]
v_pk_fma_f32 v[90:91], v[90:91], v[122:123], v[146:147]
s_waitcnt lgkmcnt(0)
v_max_f32_dpp v53, v52, v52 quad_perm:[1,0,3,2] row_mask:0xf bank_mask:0xf
s_nop 1
v_max_f32_dpp v53, v53, v53 quad_perm:[2,3,0,1] row_mask:0xf bank_mask:0xf
v_cmp_eq_f32 vcc, v53, v52
v_cmp_eq_f32 s[58:59], v53, v45
s_ff1_i32_b64 s57, vcc
s_and_b32 s57, s57, 3
s_cmp_eq_u32 s57, s3
s_cbranch_scc0 L_nowin
s_ff1_i32_b64 s57, s[58:59]
s_and_b32 s57, s57, 15
s_cmp_eq_u32 s96, 0
s_cbranch_scc0 L_nocand
s_lshl_b32 s58, s57, 1
s_add_u32 s58, s58, s54
v_mov_b32 v56, v53
v_mov_b32 v57, s58
v_mov_b32 v58, s40
v_mov_b32 v59, s53
s_mul_i32 s58, s47, 4224
s_add_u32 s58, s58, 6881280
buffer_store_dwordx4 v[56:59], v65, s[4:7], s58 offen sc1
L_nocand:
s_mov_b32 s58, 0x00010001
s_lshl_b32 exec_lo, s58, s57
s_lshl_b32 exec_hi, s58, s57
s_lshl_b32 s58, s47, 11
s_lshl_b32 s59, s96, 8
s_add_u32 s58, s58, s59
s_lshl_b32 s59, s58, 1
s_add_u32 s58, s58, 458752
s_add_u32 s59, s59, 524288
v_lshlrev_b32 v54, 3, v3
v_lshlrev_b32 v55, 4, v3
v_cvt_pk_bf16_f32 v172, v68, v69
v_cvt_pk_bf16_f32 v173, v70, v71
buffer_store_dwordx2 v[172:173], v54, s[4:7], s58 offen offset:0 sc1
v_cvt_pk_bf16_f32 v174, v72, v73
v_cvt_pk_bf16_f32 v175, v74, v75
buffer_store_dwordx2 v[174:175], v54, s[4:7], s58 offen offset:32 sc1
v_cvt_pk_bf16_f32 v176, v76, v77
v_cvt_pk_bf16_f32 v177, v78, v79
buffer_store_dwordx2 v[176:177], v54, s[4:7], s58 offen offset:64 sc1
v_cvt_pk_bf16_f32 v178, v80, v81
v_cvt_pk_bf16_f32 v179, v82, v83
buffer_store_dwordx2 v[178:179], v54, s[4:7], s58 offen offset:96 sc1
v_cvt_pk_bf16_f32 v172, v84, v85
v_cvt_pk_bf16_f32 v173, v86, v87
buffer_store_dwordx2 v[172:173], v54, s[4:7], s58 offen offset:128 sc1
v_cvt_pk_bf16_f32 v174, v88, v89
v_cvt_pk_bf16_f32 v175, v90, v91
buffer_store_dwordx2 v[174:175], v54, s[4:7], s58 offen offset:160 sc1
s_and_b32 s60, s40, 0xff
s_bfe_u32 s61, s40, 0x80008
s_bfe_u32 s62, s40, 0x80010
s_lshr_b32 s63, s40, 24
v_mov_b32 v60, s55
v_pk_fma_f32 v[100:101], v[68:69], v[148:149], v[20:21]
v_pk_fma_f32 v[102:103], v[70:71], v[150:151], v[22:23]
v_and_or_b32 v100, v100, v60, s60
v_and_or_b32 v101, v101, v60, s61
v_and_or_b32 v102, v102, v60, s62
v_and_or_b32 v103, v103, v60, s63
buffer_store_dwordx4 v[100:103], v55, s[4:7], s59 offen offset:0 sc1
v_pk_fma_f32 v[104:105], v[72:73], v[152:153], v[24:25]
v_pk_fma_f32 v[106:107], v[74:75], v[154:155], v[26:27]
v_and_or_b32 v104, v104, v60, s60
v_and_or_b32 v105, v105, v60, s61
v_and_or_b32 v106, v106, v60, s62
v_and_or_b32 v107, v107, v60, s63
buffer_store_dwordx4 v[104:107], v55, s[4:7], s59 offen offset:64 sc1
v_pk_fma_f32 v[108:109], v[76:77], v[156:157], v[28:29]
v_pk_fma_f32 v[110:111], v[78:79], v[158:159], v[30:31]
v_and_or_b32 v108, v108, v60, s60
v_and_or_b32 v109, v109, v60, s61
v_and_or_b32 v110, v110, v60, s62
v_and_or_b32 v111, v111, v60, s63
buffer_store_dwordx4 v[108:111], v55, s[4:7], s59 offen offset:128 sc1
v_pk_fma_f32 v[112:113], v[80:81], v[160:161], v[32:33]
v_pk_fma_f32 v[114:115], v[82:83], v[162:163], v[34:35]
v_and_or_b32 v112, v112, v60, s60
v_and_or_b32 v113, v113, v60, s61
v_and_or_b32 v114, v114, v60, s62
v_and_or_b32 v115, v115, v60, s63
buffer_store_dwordx4 v[112:115], v55, s[4:7], s59 offen offset:192 sc1
v_pk_fma_f32 v[116:117], v[84:85], v[164:165], v[36:37]
v_pk_fma_f32 v[118:119], v[86:87], v[166:167], v[38:39]
v_and_or_b32 v116, v116, v60, s60
v_and_or_b32 v117, v117, v60, s61
v_and_or_b32 v118, v118, v60, s62
v_and_or_b32 v119, v119, v60, s63
buffer_store_dwordx4 v[116:119], v55, s[4:7], s59 offen offset:256 sc1
v_pk_fma_f32 v[120:121], v[88:89], v[168:169], v[40:41]
v_pk_fma_f32 v[122:123], v[90:91], v[170:171], v[42:43]
v_and_or_b32 v120, v120, v60, s60
v_and_or_b32 v121, v121, v60, s61
v_and_or_b32 v122, v122, v60, s62
v_and_or_b32 v123, v123, v60, s63
buffer_store_dwordx4 v[120:123], v55, s[4:7], s59 offen offset:320 sc1
s_mov_b64 exec, -1
s_mul_i32 s57, s57, 12
v_subrev_u32 v56, s57, v1
v_add_u32 v56, 0, v56
v_cmp_gt_u32 vcc, 12, v56
s_nop 1
v_cndmask_b32 v235, v235, v255, vcc
v_subrev_u32 v56, s57, v1
v_add_u32 v56, 64, v56
v_cmp_gt_u32 vcc, 12, v56
s_nop 1
v_cndmask_b32 v236, v236, v255, vcc
v_subrev_u32 v56, s57, v1
v_add_u32 v56, 128, v56
v_cmp_gt_u32 vcc, 12, v56
s_nop 1
v_cndmask_b32 v237, v237, v255, vcc
L_nowin:
v_pk_fma_f32 v[20:21], v[68:69], v[148:149], v[20:21]
v_pk_fma_f32 v[22:23], v[70:71], v[150:151], v[22:23]
v_cvt_pk_bf16_f32 v20, v20, v21
v_cvt_pk_bf16_f32 v21, v22, v23
ds_write_b64 v248, v[20:21] offset:0
v_pk_fma_f32 v[24:25], v[72:73], v[152:153], v[24:25]
v_pk_fma_f32 v[26:27], v[74:75], v[154:155], v[26:27]
v_cvt_pk_bf16_f32 v24, v24, v25
v_cvt_pk_bf16_f32 v25, v26, v27
ds_write_b64 v248, v[24:25] offset:32
v_pk_fma_f32 v[28:29], v[76:77], v[156:157], v[28:29]
v_pk_fma_f32 v[30:31], v[78:79], v[158:159], v[30:31]
v_cvt_pk_bf16_f32 v28, v28, v29
v_cvt_pk_bf16_f32 v29, v30, v31
ds_write_b64 v248, v[28:29] offset:64
v_pk_fma_f32 v[32:33], v[80:81], v[160:161], v[32:33]
v_pk_fma_f32 v[34:35], v[82:83], v[162:163], v[34:35]
v_cvt_pk_bf16_f32 v32, v32, v33
v_cvt_pk_bf16_f32 v33, v34, v35
ds_write_b64 v248, v[32:33] offset:96
v_pk_fma_f32 v[36:37], v[84:85], v[164:165], v[36:37]
v_pk_fma_f32 v[38:39], v[86:87], v[166:167], v[38:39]
v_cvt_pk_bf16_f32 v36, v36, v37
v_cvt_pk_bf16_f32 v37, v38, v39
ds_write_b64 v248, v[36:37] offset:128
v_pk_fma_f32 v[40:41], v[88:89], v[168:169], v[40:41]
v_pk_fma_f32 v[42:43], v[90:91], v[170:171], v[42:43]
v_cvt_pk_bf16_f32 v40, v40, v41
v_cvt_pk_bf16_f32 v41, v42, v43
ds_write_b64 v248, v[40:41] offset:160
s_waitcnt lgkmcnt(0)
ds_read_b128 v[44:47], v250 offset:0
ds_read_b128 v[48:51], v250 offset:1024
ds_read_b128 v[52:55], v250 offset:2048
s_waitcnt lgkmcnt(2)
buffer_store_dwordx4 v[44:47], v235, s[32:35], s50 offen offset:0 sc1
s_waitcnt lgkmcnt(1)
buffer_store_dwordx4 v[48:51], v236, s[32:35], s50 offen offset:1024 sc1
s_waitcnt lgkmcnt(0)
buffer_store_dwordx4 v[52:55], v237, s[32:35], s50 offen offset:2048 sc1
s_branch L_fin
L_bodyM:
v_bfe_u32 v32, v1, 2, 2
v_lshrrev_b32 v33, 1, v32
v_and_b32 v34, 1, v3
v_lshl_or_b32 v33, v34, 1, v33
v_xor_b32 v33, s3, v33
v_and_b32 v34, 3, v1
v_lshlrev_b32 v34, 3, v34
v_lshl_add_u32 v33, v33, 5, v34
v_lshl_add_u32 v32, v3, 3, v32
v_lshl_add_u32 v35, v32, 7, v33
s_lshl_b32 s22, s50, 8
s_lshl_b32 s23, s3, 6
s_add_u32 s22, s22, s23
s_add_u32 s22, s22, 4096
s_lshl_b32 s55, s3, 9
s_add_u32 s55, s55, 28672
v_add_u32 v39, s55, v39
v_lshl_add_u32 v37, v3, 4, s55
v_lshlrev_b32 v38, 2, v1
s_cmp_lt_u32 s98, 220
s_cselect_b32 s55, 16, 0
v_cmp_gt_u32 vcc, s55, v1
s_mov_b32 s54, 0xffffff00
s_waitcnt vmcnt(12)
v_cndmask_b32 v38, v255, v38, vcc
v_lshlrev_b32 v44, 16, v40
v_and_b32 v45, 0xffff0000, v40
v_lshlrev_b32 v46, 16, v41
v_and_b32 v47, 0xffff0000, v41
v_mul_f32 v48, 0xbfb8aa3b, v44
v_mul_f32 v49, 0xbfb8aa3b, v45
v_mul_f32 v50, 0xbfb8aa3b, v46
v_mul_f32 v51, 0xbfb8aa3b, v47
v_exp_f32 v48, v48
v_exp_f32 v49, v49
v_exp_f32 v50, v50
v_exp_f32 v51, v51
v_add_f32 v48, 1.0, v48
v_add_f32 v49, 1.0, v49
v_add_f32 v50, 1.0, v50
v_add_f32 v51, 1.0, v51
v_rcp_f32 v48, v48
v_rcp_f32 v49, v49
v_rcp_f32 v50, v50
v_rcp_f32 v51, v51
v_mul_f32 v44, v44, v48
v_mul_f32 v45, v45, v49
v_mul_f32 v46, v46, v50
v_mul_f32 v47, v47, v51
v_cvt_pk_bf16_f32 v40, v44, v45
v_cvt_pk_bf16_f32 v41, v46, v47
ds_write_b64 v39, v[40:41]
s_waitcnt lgkmcnt(0)
ds_read_b128 v[200:203], v37 offset:0
ds_read_b128 v[204:207], v37 offset:64
ds_read_b128 v[208:211], v37 offset:128
ds_read_b128 v[212:215], v37 offset:192
ds_read_b128 v[216:219], v37 offset:256
ds_read_b128 v[220:223], v37 offset:320
ds_read_b128 v[224:227], v37 offset:384
s_waitcnt vmcnt(7)
s_mov_b32 s55, 0x3f803f80
v_mfma_f32_16x16x32_bf16 v[20:23], a[236:239], v[100:103], 0
v_lshlrev_b32 v24, 16, v104
v_and_b32 v25, 0xffff0000, v104
v_mfma_f32_16x16x32_bf16 v[20:23], a[236:239], v[104:107], v[20:23]
v_lshlrev_b32 v26, 16, v105
v_and_b32 v27, 0xffff0000, v105
v_mfma_f32_16x16x32_bf16 v[20:23], a[236:239], v[108:111], v[20:23]
v_lshlrev_b32 v28, 16, v106
v_and_b32 v29, 0xffff0000, v106
v_mfma_f32_16x16x32_bf16 v[20:23], a[236:239], v[112:115], v[20:23]
v_lshlrev_b32 v30, 16, v107
v_and_b32 v31, 0xffff0000, v107
v_mfma_f32_16x16x32_bf16 v[20:23], a[236:239], v[116:119], v[20:23]
v_lshlrev_b32 v88, 16, v100
v_and_b32 v89, 0xffff0000, v100
v_lshlrev_b32 v90, 16, v101
v_and_b32 v91, 0xffff0000, v101
v_dot2_f32_bf16 v96, v100, v100, 0
v_dot2_f32_bf16 v97, v101, v101, 0
v_dot2_f32_bf16 v96, v102, v102, v96
v_dot2_f32_bf16 v97, v103, v103, v97
v_dot2_f32_bf16 v96, v104, v104, v96
v_dot2_f32_bf16 v97, v105, v105, v97
v_dot2_f32_bf16 v96, v106, v106, v96
v_dot2_f32_bf16 v97, v107, v107, v97
v_dot2_f32_bf16 v96, v108, v108, v96
v_dot2_f32_bf16 v97, v109, v109, v97
v_dot2_f32_bf16 v96, v110, v110, v96
v_dot2_f32_bf16 v97, v111, v111, v97
v_dot2_f32_bf16 v96, v112, v112, v96
v_dot2_f32_bf16 v97, v113, v113, v97
v_dot2_f32_bf16 v96, v114, v114, v96
v_dot2_f32_bf16 v97, v115, v115, v97
v_dot2_f32_bf16 v96, v116, v116, v96
v_dot2_f32_bf16 v97, v117, v117, v97
v_dot2_f32_bf16 v96, v118, v118, v96
v_dot2_f32_bf16 v97, v119, v119, v97
v_add_f32_dpp v20, v20, v20 row_ror:8 row_mask:0xf bank_mask:0xf
v_lshlrev_b32 v100, 16, v102
v_and_b32 v101, 0xffff0000, v102
v_add_f32 v96, v96, v97
v_add_f32_dpp v20, v20, v20 row_ror:4 row_mask:0xf bank_mask:0xf
v_lshlrev_b32 v102, 16, v103
v_add_f32_dpp v96, v96, v96 row_ror:8 row_mask:0xf bank_mask:0xf
v_add_f32_dpp v20, v20, v20 row_ror:2 row_mask:0xf bank_mask:0xf
v_and_b32 v103, 0xffff0000, v103
v_add_f32_dpp v96, v96, v96 row_ror:4 row_mask:0xf bank_mask:0xf
v_add_f32_dpp v20, v20, v20 row_ror:1 row_mask:0xf bank_mask:0xf
v_mul_f32 v20, 0x3acccccd, v20
v_add_f32_dpp v96, v96, v96 row_ror:2 row_mask:0xf bank_mask:0xf
s_nop 1
v_add_f32_dpp v96, v96, v96 row_ror:1 row_mask:0xf bank_mask:0xf
v_mul_f32 v96, 0x3acccccd, v96
v_fma_f32 v96, -v20, v20, v96
v_max_f32 v96, 0, v96
v_add_f32 v96, 0x3727c5ac, v96
v_rsq_f32 v96, v96
s_nop 0
v_mul_f32 v97, -v20, v96
buffer_load_dwordx4 v[120:123], v4, s[8:11], s61 offen offset:0
v_pk_fma_f32 v[24:25], v[24:25], v[96:97], v[96:97] op_sel:[0,0,1] op_sel_hi:[1,0,1]
v_pk_fma_f32 v[26:27], v[26:27], v[96:97], v[96:97] op_sel:[0,0,1] op_sel_hi:[1,0,1]
v_pk_fma_f32 v[28:29], v[28:29], v[96:97], v[96:97] op_sel:[0,0,1] op_sel_hi:[1,0,1]
v_pk_fma_f32 v[30:31], v[30:31], v[96:97], v[96:97] op_sel:[0,0,1] op_sel_hi:[1,0,1]
v_cvt_pk_f16_f32 v104, v24, v25
v_cvt_pk_f16_f32 v105, v26, v27
v_cvt_pk_f16_f32 v106, v28, v29
v_cvt_pk_f16_f32 v107, v30, v31
v_lshlrev_b32 v24, 16, v108
v_and_b32 v25, 0xffff0000, v108
v_lshlrev_b32 v26, 16, v109
v_and_b32 v27, 0xffff0000, v109
buffer_load_dwordx4 v[124:127], v4, s[8:11], s61 offen offset:256
v_lshlrev_b32 v28, 16, v110
v_and_b32 v29, 0xffff0000, v110
v_lshlrev_b32 v30, 16, v111
v_and_b32 v31, 0xffff0000, v111
v_pk_fma_f32 v[24:25], v[24:25], v[96:97], v[96:97] op_sel:[0,0,1] op_sel_hi:[1,0,1]
v_pk_fma_f32 v[26:27], v[26:27], v[96:97], v[96:97] op_sel:[0,0,1] op_sel_hi:[1,0,1]
v_pk_fma_f32 v[28:29], v[28:29], v[96:97], v[96:97] op_sel:[0,0,1] op_sel_hi:[1,0,1]
v_pk_fma_f32 v[30:31], v[30:31], v[96:97], v[96:97] op_sel:[0,0,1] op_sel_hi:[1,0,1]
v_cvt_pk_f16_f32 v108, v24, v25
v_cvt_pk_f16_f32 v109, v26, v27
v_cvt_pk_f16_f32 v110, v28, v29
v_cvt_pk_f16_f32 v111, v30, v31
buffer_load_dwordx4 v[128:131], v4, s[8:11], s61 offen offset:512
v_lshlrev_b32 v24, 16, v112
v_and_b32 v25, 0xffff0000, v112
v_lshlrev_b32 v26, 16, v113
v_and_b32 v27, 0xffff0000, v113
v_lshlrev_b32 v28, 16, v114
v_and_b32 v29, 0xffff0000, v114
v_lshlrev_b32 v30, 16, v115
v_and_b32 v31, 0xffff0000, v115
v_pk_fma_f32 v[24:25], v[24:25], v[96:97], v[96:97] op_sel:[0,0,1] op_sel_hi:[1,0,1]
v_pk_fma_f32 v[26:27], v[26:27], v[96:97], v[96:97] op_sel:[0,0,1] op_sel_hi:[1,0,1]
v_pk_fma_f32 v[28:29], v[28:29], v[96:97], v[96:97] op_sel:[0,0,1] op_sel_hi:[1,0,1]
v_pk_fma_f32 v[30:31], v[30:31], v[96:97], v[96:97] op_sel:[0,0,1] op_sel_hi:[1,0,1]
buffer_load_dwordx4 v[132:135], v4, s[8:11], s61 offen offset:768
v_cvt_pk_f16_f32 v112, v24, v25
v_cvt_pk_f16_f32 v113, v26, v27
v_cvt_pk_f16_f32 v114, v28, v29
v_cvt_pk_f16_f32 v115, v30, v31
v_lshlrev_b32 v24, 16, v116
v_and_b32 v25, 0xffff0000, v116
v_lshlrev_b32 v26, 16, v117
v_and_b32 v27, 0xffff0000, v117
v_lshlrev_b32 v28, 16, v118
v_and_b32 v29, 0xffff0000, v118
v_lshlrev_b32 v30, 16, v119
v_and_b32 v31, 0xffff0000, v119
buffer_load_dwordx4 v[136:139], v4, s[8:11], s61 offen offset:1024
s_bfe_u32 s61, s62, 262152
s_mul_i32 s61, s61, 40960
s_add_u32 s61, s61, s45
v_pk_fma_f32 v[24:25], v[24:25], v[96:97], v[96:97] op_sel:[0,0,1] op_sel_hi:[1,0,1]
v_pk_fma_f32 v[26:27], v[26:27], v[96:97], v[96:97] op_sel:[0,0,1] op_sel_hi:[1,0,1]
v_pk_fma_f32 v[28:29], v[28:29], v[96:97], v[96:97] op_sel:[0,0,1] op_sel_hi:[1,0,1]
v_pk_fma_f32 v[30:31], v[30:31], v[96:97], v[96:97] op_sel:[0,0,1] op_sel_hi:[1,0,1]
v_pk_fma_f32 v[88:89], v[88:89], v[96:97], v[96:97] op_sel:[0,0,1] op_sel_hi:[1,0,1]
v_pk_fma_f32 v[90:91], v[90:91], v[96:97], v[96:97] op_sel:[0,0,1] op_sel_hi:[1,0,1]
v_pk_fma_f32 v[100:101], v[100:101], v[96:97], v[96:97] op_sel:[0,0,1] op_sel_hi:[1,0,1]
v_pk_fma_f32 v[102:103], v[102:103], v[96:97], v[96:97] op_sel:[0,0,1] op_sel_hi:[1,0,1]
v_cvt_pk_f16_f32 v116, v24, v25
v_cvt_pk_f16_f32 v117, v26, v27
v_cvt_pk_f16_f32 v118, v28, v29
v_cvt_pk_f16_f32 v119, v30, v31
s_waitcnt vmcnt(5)
v_readfirstlane_b32 s41, v42
s_barrier
ds_read_b64_tr_b16 v[60:61], v35 offset:0
ds_read_b64_tr_b16 v[62:63], v35 offset:512
ds_read_b64_tr_b16 v[64:65], v35 offset:4096
ds_read_b64_tr_b16 v[66:67], v35 offset:4608
ds_read_b64_tr_b16 v[68:69], v35 offset:8192
ds_read_b64_tr_b16 v[70:71], v35 offset:8704
ds_read_b64_tr_b16 v[72:73], v35 offset:12288
ds_read_b64_tr_b16 v[74:75], v35 offset:12800
ds_read_b64_tr_b16 v[76:77], v35 offset:16384
ds_read_b64_tr_b16 v[78:79], v35 offset:16896
ds_read_b64_tr_b16 v[80:81], v35 offset:20480
ds_read_b64_tr_b16 v[82:83], v35 offset:20992
ds_read_b64_tr_b16 v[84:85], v35 offset:24576
ds_read_b64_tr_b16 v[86:87], v35 offset:25088
s_mul_i32 s40, s41, 0x9E3779B1
s_add_u32 s40, s40, 0x85EBCA6B
v_and_b32 v33, 3, v1
v_lshlrev_b32 v33, 3, v33
v_lshrrev_b32 v19, v33, s40
v_and_b32 v19, 0xff, v19
v_mov_b32 v240, s40
v_mov_b32 v241, s19
v_mov_b32 v242, s40
v_mov_b32 v243, s40
s_waitcnt lgkmcnt(12)
v_mfma_f32_16x16x32_bf16 v[56:59], v[200:203], v[60:63], 0
s_waitcnt lgkmcnt(10)
v_mfma_f32_16x16x32_bf16 v[56:59], v[204:207], v[64:67], v[56:59]
s_waitcnt lgkmcnt(8)
v_mfma_f32_16x16x32_bf16 v[56:59], v[208:211], v[68:71], v[56:59]
s_waitcnt lgkmcnt(6)
v_mfma_f32_16x16x32_bf16 v[56:59], v[212:215], v[72:75], v[56:59]
s_waitcnt lgkmcnt(4)
v_mfma_f32_16x16x32_bf16 v[56:59], v[216:219], v[76:79], v[56:59]
s_waitcnt lgkmcnt(2)
v_mfma_f32_16x16x32_bf16 v[56:59], v[220:223], v[80:83], v[56:59]
s_waitcnt lgkmcnt(0)
v_mfma_f32_16x16x32_bf16 v[56:59], v[224:227], v[84:87], v[56:59]
s_nop 7
v_and_or_b32 v56, v56, s54, v19
buffer_store_dword v56, v38, s[4:7], s22 offen sc1
buffer_load_dwordx4 v[140:143], v4, s[8:11], s61 offen offset:0
buffer_load_dwordx4 v[144:147], v4, s[8:11], s61 offen offset:256
buffer_load_dwordx4 v[148:151], v4, s[8:11], s61 offen offset:512
buffer_load_dwordx4 v[152:155], v4, s[8:11], s61 offen offset:768
buffer_load_dwordx4 v[156:159], v4, s[8:11], s61 offen offset:1024
s_bfe_u32 s61, s62, 262156
s_mul_i32 s61, s61, 40960
s_add_u32 s61, s61, s45
s_waitcnt vmcnt(6)
s_mov_b32 s55, 0x3f803f80
buffer_load_dwordx4 v[160:163], v4, s[8:11], s61 offen offset:0
v_mfma_f32_16x16x32_bf16 v[20:23], a[236:239], v[120:123], 0
v_lshlrev_b32 v24, 16, v124
v_and_b32 v25, 0xffff0000, v124
v_mfma_f32_16x16x32_bf16 v[20:23], a[236:239], v[124:127], v[20:23]
v_lshlrev_b32 v26, 16, v125
v_and_b32 v27, 0xffff0000, v125
v_mfma_f32_16x16x32_bf16 v[20:23], a[236:239], v[128:131], v[20:23]
v_lshlrev_b32 v28, 16, v126
v_and_b32 v29, 0xffff0000, v126
v_mfma_f32_16x16x32_bf16 v[20:23], a[236:239], v[132:135], v[20:23]
v_lshlrev_b32 v30, 16, v127
v_and_b32 v31, 0xffff0000, v127
v_mfma_f32_16x16x32_bf16 v[20:23], a[236:239], v[136:139], v[20:23]
v_lshlrev_b32 v92, 16, v120
v_and_b32 v93, 0xffff0000, v120
v_lshlrev_b32 v94, 16, v121
v_and_b32 v95, 0xffff0000, v121
v_dot2_f32_bf16 v98, v120, v120, 0
v_dot2_f32_bf16 v99, v121, v121, 0
v_dot2_f32_bf16 v98, v122, v122, v98
v_dot2_f32_bf16 v99, v123, v123, v99
v_dot2_f32_bf16 v98, v124, v124, v98
v_dot2_f32_bf16 v99, v125, v125, v99
buffer_load_dwordx4 v[164:167], v4, s[8:11], s61 offen offset:256
v_dot2_f32_bf16 v98, v126, v126, v98
v_dot2_f32_bf16 v99, v127, v127, v99
v_dot2_f32_bf16 v98, v128, v128, v98
v_dot2_f32_bf16 v99, v129, v129, v99
v_dot2_f32_bf16 v98, v130, v130, v98
v_dot2_f32_bf16 v99, v131, v131, v99
v_dot2_f32_bf16 v98, v132, v132, v98
v_dot2_f32_bf16 v99, v133, v133, v99
v_dot2_f32_bf16 v98, v134, v134, v98
v_dot2_f32_bf16 v99, v135, v135, v99
v_dot2_f32_bf16 v98, v136, v136, v98
v_dot2_f32_bf16 v99, v137, v137, v99
v_dot2_f32_bf16 v98, v138, v138, v98
v_dot2_f32_bf16 v99, v139, v139, v99
v_add_f32_dpp v20, v20, v20 row_ror:8 row_mask:0xf bank_mask:0xf
v_lshlrev_b32 v120, 16, v122
v_and_b32 v121, 0xffff0000, v122
v_add_f32 v98, v98, v99
v_add_f32_dpp v20, v20, v20 row_ror:4 row_mask:0xf bank_mask:0xf
v_lshlrev_b32 v122, 16, v123
v_add_f32_dpp v98, v98, v98 row_ror:8 row_mask:0xf bank_mask:0xf
v_add_f32_dpp v20, v20, v20 row_ror:2 row_mask:0xf bank_mask:0xf
v_and_b32 v123, 0xffff0000, v123
v_add_f32_dpp v98, v98, v98 row_ror:4 row_mask:0xf bank_mask:0xf
buffer_load_dwordx4 v[168:171], v4, s[8:11], s61 offen offset:512
v_add_f32_dpp v20, v20, v20 row_ror:1 row_mask:0xf bank_mask:0xf
v_mul_f32 v20, 0x3acccccd, v20
v_add_f32_dpp v98, v98, v98 row_ror:2 row_mask:0xf bank_mask:0xf
s_nop 1
v_add_f32_dpp v98, v98, v98 row_ror:1 row_mask:0xf bank_mask:0xf
v_mul_f32 v98, 0x3acccccd, v98
v_fma_f32 v98, -v20, v20, v98
v_max_f32 v98, 0, v98
v_add_f32 v98, 0x3727c5ac, v98
v_rsq_f32 v98, v98
s_nop 0
v_mul_f32 v99, -v20, v98
v_pk_fma_f32 v[24:25], v[24:25], v[98:99], v[98:99] op_sel:[0,0,1] op_sel_hi:[1,0,1]
v_pk_fma_f32 v[26:27], v[26:27], v[98:99], v[98:99] op_sel:[0,0,1] op_sel_hi:[1,0,1]
v_pk_fma_f32 v[28:29], v[28:29], v[98:99], v[98:99] op_sel:[0,0,1] op_sel_hi:[1,0,1]
v_pk_fma_f32 v[30:31], v[30:31], v[98:99], v[98:99] op_sel:[0,0,1] op_sel_hi:[1,0,1]
v_cvt_pk_f16_f32 v124, v24, v25
v_cvt_pk_f16_f32 v125, v26, v27
v_cvt_pk_f16_f32 v126, v28, v29
v_cvt_pk_f16_f32 v127, v30, v31
v_lshlrev_b32 v24, 16, v128
v_and_b32 v25, 0xffff0000, v128
v_lshlrev_b32 v26, 16, v129
v_and_b32 v27, 0xffff0000, v129
v_lshlrev_b32 v28, 16, v130
buffer_load_dwordx4 v[172:175], v4, s[8:11], s61 offen offset:768
v_and_b32 v29, 0xffff0000, v130
v_lshlrev_b32 v30, 16, v131
v_and_b32 v31, 0xffff0000, v131
v_pk_fma_f32 v[24:25], v[24:25], v[98:99], v[98:99] op_sel:[0,0,1] op_sel_hi:[1,0,1]
v_pk_fma_f32 v[26:27], v[26:27], v[98:99], v[98:99] op_sel:[0,0,1] op_sel_hi:[1,0,1]
v_pk_fma_f32 v[28:29], v[28:29], v[98:99], v[98:99] op_sel:[0,0,1] op_sel_hi:[1,0,1]
v_pk_fma_f32 v[30:31], v[30:31], v[98:99], v[98:99] op_sel:[0,0,1] op_sel_hi:[1,0,1]
v_cvt_pk_f16_f32 v128, v24, v25
v_cvt_pk_f16_f32 v129, v26, v27
v_cvt_pk_f16_f32 v130, v28, v29
v_cvt_pk_f16_f32 v131, v30, v31
v_lshlrev_b32 v24, 16, v132
v_and_b32 v25, 0xffff0000, v132
v_lshlrev_b32 v26, 16, v133
v_and_b32 v27, 0xffff0000, v133
v_lshlrev_b32 v28, 16, v134
v_and_b32 v29, 0xffff0000, v134
v_lshlrev_b32 v30, 16, v135
v_and_b32 v31, 0xffff0000, v135
v_pk_fma_f32 v[24:25], v[24:25], v[98:99], v[98:99] op_sel:[0,0,1] op_sel_hi:[1,0,1]
v_pk_fma_f32 v[26:27], v[26:27], v[98:99], v[98:99] op_sel:[0,0,1] op_sel_hi:[1,0,1]
v_pk_fma_f32 v[28:29], v[28:29], v[98:99], v[98:99] op_sel:[0,0,1] op_sel_hi:[1,0,1]
v_pk_fma_f32 v[30:31], v[30:31], v[98:99], v[98:99] op_sel:[0,0,1] op_sel_hi:[1,0,1]
buffer_load_dwordx4 v[176:179], v4, s[8:11], s61 offen offset:1024
s_bfe_u32 s61, s62, 262160
s_mul_i32 s61, s61, 40960
s_add_u32 s61, s61, s45
v_cvt_pk_f16_f32 v132, v24, v25
v_cvt_pk_f16_f32 v133, v26, v27
v_cvt_pk_f16_f32 v134, v28, v29
v_cvt_pk_f16_f32 v135, v30, v31
v_lshlrev_b32 v24, 16, v136
v_and_b32 v25, 0xffff0000, v136
v_lshlrev_b32 v26, 16, v137
v_and_b32 v27, 0xffff0000, v137
v_lshlrev_b32 v28, 16, v138
v_and_b32 v29, 0xffff0000, v138
v_lshlrev_b32 v30, 16, v139
v_and_b32 v31, 0xffff0000, v139
v_pk_fma_f32 v[24:25], v[24:25], v[98:99], v[98:99] op_sel:[0,0,1] op_sel_hi:[1,0,1]
v_pk_fma_f32 v[26:27], v[26:27], v[98:99], v[98:99] op_sel:[0,0,1] op_sel_hi:[1,0,1]
v_pk_fma_f32 v[28:29], v[28:29], v[98:99], v[98:99] op_sel:[0,0,1] op_sel_hi:[1,0,1]
v_pk_fma_f32 v[30:31], v[30:31], v[98:99], v[98:99] op_sel:[0,0,1] op_sel_hi:[1,0,1]
v_pk_fma_f32 v[92:93], v[92:93], v[98:99], v[98:99] op_sel:[0,0,1] op_sel_hi:[1,0,1]
v_pk_fma_f32 v[94:95], v[94:95], v[98:99], v[98:99] op_sel:[0,0,1] op_sel_hi:[1,0,1]
v_pk_fma_f32 v[120:121], v[120:121], v[98:99], v[98:99] op_sel:[0,0,1] op_sel_hi:[1,0,1]
v_pk_fma_f32 v[122:123], v[122:123], v[98:99], v[98:99] op_sel:[0,0,1] op_sel_hi:[1,0,1]
v_cvt_pk_f16_f32 v136, v24, v25
v_cvt_pk_f16_f32 v137, v26, v27
v_cvt_pk_f16_f32 v138, v28, v29
v_cvt_pk_f16_f32 v139, v30, v31
s_barrier
s_waitcnt vmcnt(5)
s_mov_b32 s55, 0x3f803f80
buffer_load_dwordx4 v[180:183], v4, s[8:11], s61 offen offset:0
v_mfma_f32_16x16x32_bf16 v[20:23], a[236:239], v[140:143], 0
v_lshlrev_b32 v24, 16, v144
v_and_b32 v25, 0xffff0000, v144
v_mfma_f32_16x16x32_bf16 v[20:23], a[236:239], v[144:147], v[20:23]
v_lshlrev_b32 v26, 16, v145
v_and_b32 v27, 0xffff0000, v145
v_mfma_f32_16x16x32_bf16 v[20:23], a[236:239], v[148:151], v[20:23]
v_lshlrev_b32 v28, 16, v146
v_and_b32 v29, 0xffff0000, v146
v_mfma_f32_16x16x32_bf16 v[20:23], a[236:239], v[152:155], v[20:23]
buffer_load_dwordx4 v[184:187], v4, s[8:11], s61 offen offset:256
v_lshlrev_b32 v30, 16, v147
v_and_b32 v31, 0xffff0000, v147
v_mfma_f32_16x16x32_bf16 v[20:23], a[236:239], v[156:159], v[20:23]
v_lshlrev_b32 v72, 16, v140
v_and_b32 v73, 0xffff0000, v140
v_lshlrev_b32 v74, 16, v141
v_and_b32 v75, 0xffff0000, v141
v_dot2_f32_bf16 v84, v140, v140, 0
v_dot2_f32_bf16 v85, v141, v141, 0
v_dot2_f32_bf16 v84, v142, v142, v84
v_dot2_f32_bf16 v85, v143, v143, v85
buffer_load_dwordx4 v[188:191], v4, s[8:11], s61 offen offset:512
v_dot2_f32_bf16 v84, v144, v144, v84
v_dot2_f32_bf16 v85, v145, v145, v85
v_dot2_f32_bf16 v84, v146, v146, v84
v_dot2_f32_bf16 v85, v147, v147, v85
v_dot2_f32_bf16 v84, v148, v148, v84
v_dot2_f32_bf16 v85, v149, v149, v85
v_dot2_f32_bf16 v84, v150, v150, v84
v_dot2_f32_bf16 v85, v151, v151, v85
v_dot2_f32_bf16 v84, v152, v152, v84
v_dot2_f32_bf16 v85, v153, v153, v85
v_dot2_f32_bf16 v84, v154, v154, v84
buffer_load_dwordx4 v[192:195], v4, s[8:11], s61 offen offset:768
v_dot2_f32_bf16 v85, v155, v155, v85
v_dot2_f32_bf16 v84, v156, v156, v84
v_dot2_f32_bf16 v85, v157, v157, v85
v_dot2_f32_bf16 v84, v158, v158, v84
v_dot2_f32_bf16 v85, v159, v159, v85
v_add_f32_dpp v20, v20, v20 row_ror:8 row_mask:0xf bank_mask:0xf
v_lshlrev_b32 v140, 16, v142
v_and_b32 v141, 0xffff0000, v142
v_add_f32 v84, v84, v85
v_add_f32_dpp v20, v20, v20 row_ror:4 row_mask:0xf bank_mask:0xf
buffer_load_dwordx4 v[196:199], v4, s[8:11], s61 offen offset:1024
v_lshlrev_b32 v142, 16, v143
v_add_f32_dpp v84, v84, v84 row_ror:8 row_mask:0xf bank_mask:0xf
v_add_f32_dpp v20, v20, v20 row_ror:2 row_mask:0xf bank_mask:0xf
v_and_b32 v143, 0xffff0000, v143
v_add_f32_dpp v84, v84, v84 row_ror:4 row_mask:0xf bank_mask:0xf
v_add_f32_dpp v20, v20, v20 row_ror:1 row_mask:0xf bank_mask:0xf
v_mul_f32 v20, 0x3acccccd, v20
v_add_f32_dpp v84, v84, v84 row_ror:2 row_mask:0xf bank_mask:0xf
s_nop 1
v_add_f32_dpp v84, v84, v84 row_ror:1 row_mask:0xf bank_mask:0xf
v_mul_f32 v84, 0x3acccccd, v84
v_fma_f32 v84, -v20, v20, v84
s_add_u32 m0, s39, 0
s_nop 0
buffer_load_dwordx4 v232, s[24:27], s48 offen offset:0 lds
v_max_f32 v84, 0, v84
v_add_f32 v84, 0x3727c5ac, v84
v_rsq_f32 v84, v84
s_nop 0
v_mul_f32 v85, -v20, v84
v_pk_fma_f32 v[24:25], v[24:25], v[84:85], v[84:85] op_sel:[0,0,1] op_sel_hi:[1,0,1]
v_pk_fma_f32 v[26:27], v[26:27], v[84:85], v[84:85] op_sel:[0,0,1] op_sel_hi:[1,0,1]
v_pk_fma_f32 v[28:29], v[28:29], v[84:85], v[84:85] op_sel:[0,0,1] op_sel_hi:[1,0,1]
v_pk_fma_f32 v[30:31], v[30:31], v[84:85], v[84:85] op_sel:[0,0,1] op_sel_hi:[1,0,1]
v_cvt_pk_f16_f32 v144, v24, v25
v_cvt_pk_f16_f32 v145, v26, v27
buffer_load_dwordx4 v233, s[24:27], s48 offen offset:1024 lds
v_cvt_pk_f16_f32 v146, v28, v29
v_cvt_pk_f16_f32 v147, v30, v31
v_lshlrev_b32 v24, 16, v148
v_and_b32 v25, 0xffff0000, v148
v_lshlrev_b32 v26, 16, v149
v_and_b32 v27, 0xffff0000, v149
v_lshlrev_b32 v28, 16, v150
v_and_b32 v29, 0xffff0000, v150
v_lshlrev_b32 v30, 16, v151
v_and_b32 v31, 0xffff0000, v151
v_pk_fma_f32 v[24:25], v[24:25], v[84:85], v[84:85] op_sel:[0,0,1] op_sel_hi:[1,0,1]
buffer_load_dwordx4 v234, s[24:27], s48 offen offset:2048 lds
s_add_u32 s48, s48, 81920
v_pk_fma_f32 v[26:27], v[26:27], v[84:85], v[84:85] op_sel:[0,0,1] op_sel_hi:[1,0,1]
v_pk_fma_f32 v[28:29], v[28:29], v[84:85], v[84:85] op_sel:[0,0,1] op_sel_hi:[1,0,1]
v_pk_fma_f32 v[30:31], v[30:31], v[84:85], v[84:85] op_sel:[0,0,1] op_sel_hi:[1,0,1]
v_cvt_pk_f16_f32 v148, v24, v25
v_cvt_pk_f16_f32 v149, v26, v27
v_cvt_pk_f16_f32 v150, v28, v29
v_cvt_pk_f16_f32 v151, v30, v31
v_lshlrev_b32 v24, 16, v152
v_and_b32 v25, 0xffff0000, v152
v_lshlrev_b32 v26, 16, v153
v_and_b32 v27, 0xffff0000, v153
s_add_u32 m0, s39, 12288
s_nop 0
buffer_load_dwordx4 v232, s[24:27], s48 offen offset:0 lds
v_lshlrev_b32 v28, 16, v154
v_and_b32 v29, 0xffff0000, v154
v_lshlrev_b32 v30, 16, v155
v_and_b32 v31, 0xffff0000, v155
v_pk_fma_f32 v[24:25], v[24:25], v[84:85], v[84:85] op_sel:[0,0,1] op_sel_hi:[1,0,1]
v_pk_fma_f32 v[26:27], v[26:27], v[84:85], v[84:85] op_sel:[0,0,1] op_sel_hi:[1,0,1]
v_pk_fma_f32 v[28:29], v[28:29], v[84:85], v[84:85] op_sel:[0,0,1] op_sel_hi:[1,0,1]
v_pk_fma_f32 v[30:31], v[30:31], v[84:85], v[84:85] op_sel:[0,0,1] op_sel_hi:[1,0,1]
v_cvt_pk_f16_f32 v152, v24, v25
v_cvt_pk_f16_f32 v153, v26, v27
buffer_load_dwordx4 v233, s[24:27], s48 offen offset:1024 lds
v_cvt_pk_f16_f32 v154, v28, v29
v_cvt_pk_f16_f32 v155, v30, v31
v_lshlrev_b32 v24, 16, v156
v_and_b32 v25, 0xffff0000, v156
v_lshlrev_b32 v26, 16, v157
v_and_b32 v27, 0xffff0000, v157
v_lshlrev_b32 v28, 16, v158
v_and_b32 v29, 0xffff0000, v158
v_lshlrev_b32 v30, 16, v159
v_and_b32 v31, 0xffff0000, v159
v_pk_fma_f32 v[24:25], v[24:25], v[84:85], v[84:85] op_sel:[0,0,1] op_sel_hi:[1,0,1]
buffer_load_dwordx4 v234, s[24:27], s48 offen offset:2048 lds
s_add_u32 s48, s48, 81920
v_pk_fma_f32 v[26:27], v[26:27], v[84:85], v[84:85] op_sel:[0,0,1] op_sel_hi:[1,0,1]
v_pk_fma_f32 v[28:29], v[28:29], v[84:85], v[84:85] op_sel:[0,0,1] op_sel_hi:[1,0,1]
v_pk_fma_f32 v[30:31], v[30:31], v[84:85], v[84:85] op_sel:[0,0,1] op_sel_hi:[1,0,1]
v_pk_fma_f32 v[72:73], v[72:73], v[84:85], v[84:85] op_sel:[0,0,1] op_sel_hi:[1,0,1]
v_pk_fma_f32 v[74:75], v[74:75], v[84:85], v[84:85] op_sel:[0,0,1] op_sel_hi:[1,0,1]
v_pk_fma_f32 v[140:141], v[140:141], v[84:85], v[84:85] op_sel:[0,0,1] op_sel_hi:[1,0,1]
v_pk_fma_f32 v[142:143], v[142:143], v[84:85], v[84:85] op_sel:[0,0,1] op_sel_hi:[1,0,1]
v_cvt_pk_f16_f32 v156, v24, v25
v_cvt_pk_f16_f32 v157, v26, v27
v_cvt_pk_f16_f32 v158, v28, v29
v_cvt_pk_f16_f32 v159, v30, v31
s_waitcnt vmcnt(11)
s_mov_b32 s55, 0x3f803f80
buffer_store_dwordx4 a[232:235], v11, s[4:7], s46 offen sc1
v_mfma_f32_16x16x32_bf16 v[20:23], a[236:239], v[160:163], 0
v_lshlrev_b32 v24, 16, v164
v_and_b32 v25, 0xffff0000, v164
v_mfma_f32_16x16x32_bf16 v[20:23], a[236:239], v[164:167], v[20:23]
v_lshlrev_b32 v26, 16, v165
v_and_b32 v27, 0xffff0000, v165
v_mfma_f32_16x16x32_bf16 v[20:23], a[236:239], v[168:171], v[20:23]
v_lshlrev_b32 v28, 16, v166
v_and_b32 v29, 0xffff0000, v166
v_mfma_f32_16x16x32_bf16 v[20:23], a[236:239], v[172:175], v[20:23]
v_lshlrev_b32 v30, 16, v167
v_and_b32 v31, 0xffff0000, v167
v_mfma_f32_16x16x32_bf16 v[20:23], a[236:239], v[176:179], v[20:23]
v_lshlrev_b32 v76, 16, v160
v_and_b32 v77, 0xffff0000, v160
v_lshlrev_b32 v78, 16, v161
v_and_b32 v79, 0xffff0000, v161
v_dot2_f32_bf16 v86, v160, v160, 0
v_dot2_f32_bf16 v87, v161, v161, 0
buffer_store_dwordx4 a[232:235], v12, s[4:7], s46 offen sc1
v_dot2_f32_bf16 v86, v162, v162, v86
v_dot2_f32_bf16 v87, v163, v163, v87
v_dot2_f32_bf16 v86, v164, v164, v86
v_dot2_f32_bf16 v87, v165, v165, v87
v_dot2_f32_bf16 v86, v166, v166, v86
v_dot2_f32_bf16 v87, v167, v167, v87
v_dot2_f32_bf16 v86, v168, v168, v86
v_dot2_f32_bf16 v87, v169, v169, v87
v_dot2_f32_bf16 v86, v170, v170, v86
v_dot2_f32_bf16 v87, v171, v171, v87
v_dot2_f32_bf16 v86, v172, v172, v86
v_dot2_f32_bf16 v87, v173, v173, v87
v_dot2_f32_bf16 v86, v174, v174, v86
v_dot2_f32_bf16 v87, v175, v175, v87
v_dot2_f32_bf16 v86, v176, v176, v86
v_dot2_f32_bf16 v87, v177, v177, v87
v_dot2_f32_bf16 v86, v178, v178, v86
v_dot2_f32_bf16 v87, v179, v179, v87
v_add_f32_dpp v20, v20, v20 row_ror:8 row_mask:0xf bank_mask:0xf
v_lshlrev_b32 v160, 16, v162
buffer_store_dwordx4 a[232:235], v13, s[4:7], s46 offen sc1
v_and_b32 v161, 0xffff0000, v162
v_add_f32 v86, v86, v87
v_add_f32_dpp v20, v20, v20 row_ror:4 row_mask:0xf bank_mask:0xf
v_lshlrev_b32 v162, 16, v163
v_add_f32_dpp v86, v86, v86 row_ror:8 row_mask:0xf bank_mask:0xf
v_add_f32_dpp v20, v20, v20 row_ror:2 row_mask:0xf bank_mask:0xf
v_and_b32 v163, 0xffff0000, v163
v_add_f32_dpp v86, v86, v86 row_ror:4 row_mask:0xf bank_mask:0xf
v_add_f32_dpp v20, v20, v20 row_ror:1 row_mask:0xf bank_mask:0xf
v_mul_f32 v20, 0x3acccccd, v20
v_add_f32_dpp v86, v86, v86 row_ror:2 row_mask:0xf bank_mask:0xf
s_nop 1
v_add_f32_dpp v86, v86, v86 row_ror:1 row_mask:0xf bank_mask:0xf
v_mul_f32 v86, 0x3acccccd, v86
v_fma_f32 v86, -v20, v20, v86
v_max_f32 v86, 0, v86
v_add_f32 v86, 0x3727c5ac, v86
v_rsq_f32 v86, v86
s_nop 0
v_mul_f32 v87, -v20, v86
v_pk_fma_f32 v[24:25], v[24:25], v[86:87], v[86:87] op_sel:[0,0,1] op_sel_hi:[1,0,1]
buffer_store_dwordx4 a[232:235], v14, s[4:7], s46 offen sc1
v_pk_fma_f32 v[26:27], v[26:27], v[86:87], v[86:87] op_sel:[0,0,1] op_sel_hi:[1,0,1]
v_pk_fma_f32 v[28:29], v[28:29], v[86:87], v[86:87] op_sel:[0,0,1] op_sel_hi:[1,0,1]
v_pk_fma_f32 v[30:31], v[30:31], v[86:87], v[86:87] op_sel:[0,0,1] op_sel_hi:[1,0,1]
v_cvt_pk_f16_f32 v164, v24, v25
v_cvt_pk_f16_f32 v165, v26, v27
v_cvt_pk_f16_f32 v166, v28, v29
v_cvt_pk_f16_f32 v167, v30, v31
v_lshlrev_b32 v24, 16, v168
v_and_b32 v25, 0xffff0000, v168
v_lshlrev_b32 v26, 16, v169
v_and_b32 v27, 0xffff0000, v169
v_lshlrev_b32 v28, 16, v170
v_and_b32 v29, 0xffff0000, v170
v_lshlrev_b32 v30, 16, v171
v_and_b32 v31, 0xffff0000, v171
v_pk_fma_f32 v[24:25], v[24:25], v[86:87], v[86:87] op_sel:[0,0,1] op_sel_hi:[1,0,1]
v_pk_fma_f32 v[26:27], v[26:27], v[86:87], v[86:87] op_sel:[0,0,1] op_sel_hi:[1,0,1]
v_pk_fma_f32 v[28:29], v[28:29], v[86:87], v[86:87] op_sel:[0,0,1] op_sel_hi:[1,0,1]
v_pk_fma_f32 v[30:31], v[30:31], v[86:87], v[86:87] op_sel:[0,0,1] op_sel_hi:[1,0,1]
v_cvt_pk_f16_f32 v168, v24, v25
buffer_store_dwordx4 a[232:235], v246, s[4:7], s18 offen sc1
v_cvt_pk_f16_f32 v169, v26, v27
v_cvt_pk_f16_f32 v170, v28, v29
v_cvt_pk_f16_f32 v171, v30, v31
v_lshlrev_b32 v24, 16, v172
v_and_b32 v25, 0xffff0000, v172
v_lshlrev_b32 v26, 16, v173
v_and_b32 v27, 0xffff0000, v173
v_lshlrev_b32 v28, 16, v174
v_and_b32 v29, 0xffff0000, v174
v_lshlrev_b32 v30, 16, v175
v_and_b32 v31, 0xffff0000, v175
v_pk_fma_f32 v[24:25], v[24:25], v[86:87], v[86:87] op_sel:[0,0,1] op_sel_hi:[1,0,1]
v_pk_fma_f32 v[26:27], v[26:27], v[86:87], v[86:87] op_sel:[0,0,1] op_sel_hi:[1,0,1]
v_pk_fma_f32 v[28:29], v[28:29], v[86:87], v[86:87] op_sel:[0,0,1] op_sel_hi:[1,0,1]
v_pk_fma_f32 v[30:31], v[30:31], v[86:87], v[86:87] op_sel:[0,0,1] op_sel_hi:[1,0,1]
v_cvt_pk_f16_f32 v172, v24, v25
v_cvt_pk_f16_f32 v173, v26, v27
v_cvt_pk_f16_f32 v174, v28, v29
v_cvt_pk_f16_f32 v175, v30, v31
s_lshl_b32 s37, s47, 2
s_add_u32 s37, s37, s3
s_lshl_b32 s37, s37, 3
s_add_u32 s37, s37, s96
s_lshl_b32 s37, s37, 8
s_add_u32 s37, s37, 131072
v_lshlrev_b32 v69, 2, v1
v_xor_b32 v70, 0xff, v19
buffer_store_dword v70, v69, s[4:7], s37 offen sc1
v_lshlrev_b32 v24, 16, v176
v_and_b32 v25, 0xffff0000, v176
v_lshlrev_b32 v26, 16, v177
v_and_b32 v27, 0xffff0000, v177
v_lshlrev_b32 v28, 16, v178
v_and_b32 v29, 0xffff0000, v178
v_lshlrev_b32 v30, 16, v179
v_and_b32 v31, 0xffff0000, v179
v_pk_fma_f32 v[24:25], v[24:25], v[86:87], v[86:87] op_sel:[0,0,1] op_sel_hi:[1,0,1]
v_pk_fma_f32 v[26:27], v[26:27], v[86:87], v[86:87] op_sel:[0,0,1] op_sel_hi:[1,0,1]
v_pk_fma_f32 v[28:29], v[28:29], v[86:87], v[86:87] op_sel:[0,0,1] op_sel_hi:[1,0,1]
v_pk_fma_f32 v[30:31], v[30:31], v[86:87], v[86:87] op_sel:[0,0,1] op_sel_hi:[1,0,1]
v_pk_fma_f32 v[76:77], v[76:77], v[86:87], v[86:87] op_sel:[0,0,1] op_sel_hi:[1,0,1]
v_pk_fma_f32 v[78:79], v[78:79], v[86:87], v[86:87] op_sel:[0,0,1] op_sel_hi:[1,0,1]
v_pk_fma_f32 v[160:161], v[160:161], v[86:87], v[86:87] op_sel:[0,0,1] op_sel_hi:[1,0,1]
v_pk_fma_f32 v[162:163], v[162:163], v[86:87], v[86:87] op_sel:[0,0,1] op_sel_hi:[1,0,1]
v_cvt_pk_f16_f32 v176, v24, v25
v_cvt_pk_f16_f32 v177, v26, v27
v_cvt_pk_f16_f32 v178, v28, v29
v_cvt_pk_f16_f32 v179, v30, v31
buffer_load_dwordx4 v[40:43], v248, s[4:7], s56 offen sc1
s_waitcnt vmcnt(13)
s_mov_b32 s55, 0x3f803f80
v_mfma_f32_16x16x32_bf16 v[20:23], a[236:239], v[180:183], 0
v_lshlrev_b32 v24, 16, v184
v_and_b32 v25, 0xffff0000, v184
v_mfma_f32_16x16x32_bf16 v[20:23], a[236:239], v[184:187], v[20:23]
v_lshlrev_b32 v26, 16, v185
v_and_b32 v27, 0xffff0000, v185
v_mfma_f32_16x16x32_bf16 v[20:23], a[236:239], v[188:191], v[20:23]
buffer_load_dwordx4 v[44:47], v248, s[4:7], s57 offen sc1
v_lshlrev_b32 v28, 16, v186
v_and_b32 v29, 0xffff0000, v186
v_mfma_f32_16x16x32_bf16 v[20:23], a[236:239], v[192:195], v[20:23]
v_lshlrev_b32 v30, 16, v187
v_and_b32 v31, 0xffff0000, v187
v_mfma_f32_16x16x32_bf16 v[20:23], a[236:239], v[196:199], v[20:23]
v_lshlrev_b32 v80, 16, v180
v_and_b32 v81, 0xffff0000, v180
v_lshlrev_b32 v82, 16, v181
buffer_load_dwordx4 v[48:51], v248, s[4:7], s58 offen sc1
v_and_b32 v83, 0xffff0000, v181
v_dot2_f32_bf16 v66, v180, v180, 0
v_dot2_f32_bf16 v67, v181, v181, 0
v_dot2_f32_bf16 v66, v182, v182, v66
v_dot2_f32_bf16 v67, v183, v183, v67
v_dot2_f32_bf16 v66, v184, v184, v66
v_dot2_f32_bf16 v67, v185, v185, v67
v_dot2_f32_bf16 v66, v186, v186, v66
v_dot2_f32_bf16 v67, v187, v187, v67
buffer_load_dword v52, v249, s[4:7], s56 offen sc1
v_dot2_f32_bf16 v66, v188, v188, v66
v_dot2_f32_bf16 v67, v189, v189, v67
v_dot2_f32_bf16 v66, v190, v190, v66
v_dot2_f32_bf16 v67, v191, v191, v67
v_dot2_f32_bf16 v66, v192, v192, v66
v_dot2_f32_bf16 v67, v193, v193, v67
v_dot2_f32_bf16 v66, v194, v194, v66
v_dot2_f32_bf16 v67, v195, v195, v67
v_dot2_f32_bf16 v66, v196, v196, v66
buffer_load_dword v53, v249, s[4:7], s57 offen sc1
v_dot2_f32_bf16 v67, v197, v197, v67
v_dot2_f32_bf16 v66, v198, v198, v66
v_dot2_f32_bf16 v67, v199, v199, v67
v_add_f32_dpp v20, v20, v20 row_ror:8 row_mask:0xf bank_mask:0xf
v_lshlrev_b32 v180, 16, v182
v_and_b32 v181, 0xffff0000, v182
v_add_f32 v66, v66, v67
v_add_f32_dpp v20, v20, v20 row_ror:4 row_mask:0xf bank_mask:0xf
v_lshlrev_b32 v182, 16, v183
buffer_load_dword v54, v249, s[4:7], s58 offen sc1
v_add_f32_dpp v66, v66, v66 row_ror:8 row_mask:0xf bank_mask:0xf
v_add_f32_dpp v20, v20, v20 row_ror:2 row_mask:0xf bank_mask:0xf
v_and_b32 v183, 0xffff0000, v183
v_add_f32_dpp v66, v66, v66 row_ror:4 row_mask:0xf bank_mask:0xf
v_add_f32_dpp v20, v20, v20 row_ror:1 row_mask:0xf bank_mask:0xf
v_mul_f32 v20, 0x3acccccd, v20
v_add_f32_dpp v66, v66, v66 row_ror:2 row_mask:0xf bank_mask:0xf
s_nop 1
v_add_f32_dpp v66, v66, v66 row_ror:1 row_mask:0xf bank_mask:0xf
v_mul_f32 v66, 0x3acccccd, v66
buffer_load_dword v71, v247, s[4:7], s60 offen sc1
v_fma_f32 v66, -v20, v20, v66
v_max_f32 v66, 0, v66
v_add_f32 v66, 0x3727c5ac, v66
v_rsq_f32 v66, v66
s_nop 0
v_mul_f32 v67, -v20, v66
v_pk_fma_f32 v[24:25], v[24:25], v[66:67], v[66:67] op_sel:[0,0,1] op_sel_hi:[1,0,1]
v_pk_fma_f32 v[26:27], v[26:27], v[66:67], v[66:67] op_sel:[0,0,1] op_sel_hi:[1,0,1]
v_pk_fma_f32 v[28:29], v[28:29], v[66:67], v[66:67] op_sel:[0,0,1] op_sel_hi:[1,0,1]
v_pk_fma_f32 v[30:31], v[30:31], v[66:67], v[66:67] op_sel:[0,0,1] op_sel_hi:[1,0,1]
v_cvt_pk_f16_f32 v184, v24, v25
s_add_u32 m0, s39, 24576
s_nop 0
buffer_load_dwordx4 v232, s[24:27], s48 offen offset:0 lds
v_cvt_pk_f16_f32 v185, v26, v27
v_cvt_pk_f16_f32 v186, v28, v29
v_cvt_pk_f16_f32 v187, v30, v31
v_lshlrev_b32 v24, 16, v188
v_and_b32 v25, 0xffff0000, v188
v_lshlrev_b32 v26, 16, v189
v_and_b32 v27, 0xffff0000, v189
v_lshlrev_b32 v28, 16, v190
v_and_b32 v29, 0xffff0000, v190
buffer_load_dwordx4 v233, s[24:27], s48 offen offset:1024 lds
v_lshlrev_b32 v30, 16, v191
v_and_b32 v31, 0xffff0000, v191
v_pk_fma_f32 v[24:25], v[24:25], v[66:67], v[66:67] op_sel:[0,0,1] op_sel_hi:[1,0,1]
v_pk_fma_f32 v[26:27], v[26:27], v[66:67], v[66:67] op_sel:[0,0,1] op_sel_hi:[1,0,1]
v_pk_fma_f32 v[28:29], v[28:29], v[66:67], v[66:67] op_sel:[0,0,1] op_sel_hi:[1,0,1]
v_pk_fma_f32 v[30:31], v[30:31], v[66:67], v[66:67] op_sel:[0,0,1] op_sel_hi:[1,0,1]
v_cvt_pk_f16_f32 v188, v24, v25
v_cvt_pk_f16_f32 v189, v26, v27
v_cvt_pk_f16_f32 v190, v28, v29
buffer_load_dwordx4 v234, s[24:27], s48 offen offset:2048 lds
s_add_u32 s48, s48, 81920
v_cvt_pk_f16_f32 v191, v30, v31
v_lshlrev_b32 v24, 16, v192
v_and_b32 v25, 0xffff0000, v192
v_lshlrev_b32 v26, 16, v193
v_and_b32 v27, 0xffff0000, v193
v_lshlrev_b32 v28, 16, v194
v_and_b32 v29, 0xffff0000, v194
v_lshlrev_b32 v30, 16, v195
v_and_b32 v31, 0xffff0000, v195
s_add_u32 m0, s39, 36864
s_nop 0
buffer_load_dwordx4 v232, s[24:27], s48 offen offset:0 lds
v_pk_fma_f32 v[24:25], v[24:25], v[66:67], v[66:67] op_sel:[0,0,1] op_sel_hi:[1,0,1]
v_pk_fma_f32 v[26:27], v[26:27], v[66:67], v[66:67] op_sel:[0,0,1] op_sel_hi:[1,0,1]
v_pk_fma_f32 v[28:29], v[28:29], v[66:67], v[66:67] op_sel:[0,0,1] op_sel_hi:[1,0,1]
v_pk_fma_f32 v[30:31], v[30:31], v[66:67], v[66:67] op_sel:[0,0,1] op_sel_hi:[1,0,1]
v_cvt_pk_f16_f32 v192, v24, v25
v_cvt_pk_f16_f32 v193, v26, v27
v_cvt_pk_f16_f32 v194, v28, v29
v_cvt_pk_f16_f32 v195, v30, v31
v_lshlrev_b32 v24, 16, v196
buffer_load_dwordx4 v233, s[24:27], s48 offen offset:1024 lds
v_and_b32 v25, 0xffff0000, v196
v_lshlrev_b32 v26, 16, v197
v_and_b32 v27, 0xffff0000, v197
v_lshlrev_b32 v28, 16, v198
v_and_b32 v29, 0xffff0000, v198
v_lshlrev_b32 v30, 16, v199
v_and_b32 v31, 0xffff0000, v199
v_pk_fma_f32 v[24:25], v[24:25], v[66:67], v[66:67] op_sel:[0,0,1] op_sel_hi:[1,0,1]
v_pk_fma_f32 v[26:27], v[26:27], v[66:67], v[66:67] op_sel:[0,0,1] op_sel_hi:[1,0,1]
buffer_load_dwordx4 v234, s[24:27], s48 offen offset:2048 lds
s_add_u32 s48, s48, 81920
v_pk_fma_f32 v[28:29], v[28:29], v[66:67], v[66:67] op_sel:[0,0,1] op_sel_hi:[1,0,1]
v_pk_fma_f32 v[30:31], v[30:31], v[66:67], v[66:67] op_sel:[0,0,1] op_sel_hi:[1,0,1]
v_pk_fma_f32 v[80:81], v[80:81], v[66:67], v[66:67] op_sel:[0,0,1] op_sel_hi:[1,0,1]
v_pk_fma_f32 v[82:83], v[82:83], v[66:67], v[66:67] op_sel:[0,0,1] op_sel_hi:[1,0,1]
v_pk_fma_f32 v[180:181], v[180:181], v[66:67], v[66:67] op_sel:[0,0,1] op_sel_hi:[1,0,1]
v_pk_fma_f32 v[182:183], v[182:183], v[66:67], v[66:67] op_sel:[0,0,1] op_sel_hi:[1,0,1]
v_cvt_pk_f16_f32 v196, v24, v25
v_cvt_pk_f16_f32 v197, v26, v27
v_cvt_pk_f16_f32 v198, v28, v29
v_cvt_pk_f16_f32 v199, v30, v31
s_branch L_bodyj
L_ga_retry:
buffer_load_dwordx4 v[40:43], v248, s[4:7], s56 offen sc1
buffer_load_dwordx4 v[44:47], v248, s[4:7], s57 offen sc1
buffer_load_dwordx4 v[48:51], v248, s[4:7], s58 offen sc1
buffer_load_dword v52, v249, s[4:7], s56 offen sc1
buffer_load_dword v53, v249, s[4:7], s57 offen sc1
buffer_load_dword v54, v249, s[4:7], s58 offen sc1
s_waitcnt vmcnt(0)
v_xor_b32 v40, s12, v40
v_xor_b32 v41, s13, v41
v_xor_b32 v42, s14, v42
v_xor_b32 v43, s15, v43
v_xor_b32 v44, s12, v44
v_xor_b32 v45, s13, v45
v_xor_b32 v46, s14, v46
v_xor_b32 v47, s15, v47
v_xor_b32 v48, s12, v48
v_xor_b32 v49, s13, v49
v_xor_b32 v50, s14, v50
v_xor_b32 v51, s15, v51
v_xor_b32 v52, v19, v52
v_xor_b32 v53, v19, v53
v_xor_b32 v54, v19, v54
v_or3_b32 v64, v40, v41, v42
v_or3_b32 v65, v43, v44, v45
v_or3_b32 v64, v64, v46, v47
v_or3_b32 v65, v65, v48, v49
v_or3_b32 v64, v64, v50, v51
v_or3_b32 v65, v65, v52, v53
v_or3_b32 v64, v64, v65, v54
v_and_b32 v64, 0xff, v64
v_cmp_ne_u32 vcc, 0, v64
s_add_u32 s97, s97, 1
s_cmp_gt_u32 s97, 65536
s_cbranch_scc1 L_ga_ok
s_cbranch_vccnz L_ga_retry
s_branch L_ga_ok
L_fg_retry:
buffer_load_dword v71, v247, s[4:7], s60 offen sc1
s_waitcnt vmcnt(0)
v_cmp_ne_u32 vcc, s40, v71
s_add_u32 s97, s97, 1
s_cmp_gt_u32 s97, 65536
s_cbranch_scc1 L_fg_ok
s_cbranch_vccnz L_fg_retry
s_branch L_fg_ok
L_mv_retry:
buffer_load_dwordx2 v[194:195], v231, s[4:7], s23 offen sc1
buffer_load_dwordx4 v[240:243], v238, s[4:7], s51 offen sc1
buffer_load_dwordx4 v[190:193], v238, s[4:7], s22 offen sc1
s_waitcnt vmcnt(0)
v_perm_b32 v36, v241, v240, s55
v_perm_b32 v37, v243, v242, s55
v_xor_b32 v36, s40, v36
v_xor_b32 v37, s40, v37
v_or_b32 v38, v36, v37
v_perm_b32 v36, v191, v190, s55
v_perm_b32 v37, v193, v192, s55
v_xor_b32 v36, s40, v36
v_xor_b32 v37, s40, v37
v_or3_b32 v38, v38, v36, v37
v_and_b32 v38, v38, v230
v_xor_b32 v37, s40, v194
v_or_b32 v38, v38, v37
v_cmp_ne_u32 vcc, 0, v38
s_add_u32 s97, s97, 1
s_cmp_gt_u32 s97, 65536
s_cbranch_scc1 L_mv_ok
s_cbranch_vccnz L_mv_retry
s_branch L_mv_ok
L_o0_retry:
buffer_load_dwordx4 v[100:103], v7, s[4:7], s56 offen offset:0 sc1
buffer_load_dwordx4 v[104:107], v7, s[4:7], s56 offen offset:1024 sc1
buffer_load_dwordx4 v[108:111], v7, s[4:7], s56 offen offset:2048 sc1
buffer_load_dwordx4 v[112:115], v7, s[4:7], s56 offen offset:3072 sc1
buffer_load_dwordx4 v[116:119], v7, s[4:7], s57 offen offset:0 sc1
buffer_load_dwordx4 v[120:123], v7, s[4:7], s57 offen offset:1024 sc1
buffer_load_dwordx4 v[124:127], v7, s[4:7], s57 offen offset:2048 sc1
buffer_load_dwordx4 v[128:131], v7, s[4:7], s57 offen offset:3072 sc1
s_waitcnt vmcnt(6)
v_max3_u32 v92, v100, v101, v102
v_max3_u32 v93, v103, v104, v105
v_max3_u32 v92, v92, v106, v107
v_max_u32 v92, v92, v93
v_cmp_eq_u32 vcc, -1, v92
s_add_u32 s97, s97, 1
s_cmp_gt_u32 s97, 65536
s_cbranch_scc1 L_o0_ok
s_cbranch_vccnz L_o0_retry
s_branch L_o0_ok
L_o1_retry:
buffer_load_dwordx4 v[108:111], v7, s[4:7], s56 offen offset:2048 sc1
buffer_load_dwordx4 v[112:115], v7, s[4:7], s56 offen offset:3072 sc1
buffer_load_dwordx4 v[116:119], v7, s[4:7], s57 offen offset:0 sc1
buffer_load_dwordx4 v[120:123], v7, s[4:7], s57 offen offset:1024 sc1
buffer_load_dwordx4 v[124:127], v7, s[4:7], s57 offen offset:2048 sc1
buffer_load_dwordx4 v[128:131], v7, s[4:7], s57 offen offset:3072 sc1
buffer_load_dwordx4 v[132:135], v7, s[4:7], s58 offen offset:0 sc1
buffer_load_dwordx4 v[136:139], v7, s[4:7], s58 offen offset:1024 sc1
s_waitcnt vmcnt(6)
v_max3_u32 v92, v108, v109, v110
v_max3_u32 v93, v111, v112, v113
v_max3_u32 v92, v92, v114, v115
v_max_u32 v92, v92, v93
v_cmp_eq_u32 vcc, -1, v92
s_add_u32 s97, s97, 1
s_cmp_gt_u32 s97, 65536
s_cbranch_scc1 L_o1_ok
s_cbranch_vccnz L_o1_retry
s_branch L_o1_ok
L_o2_retry:
buffer_load_dwordx4 v[116:119], v7, s[4:7], s57 offen offset:0 sc1
buffer_load_dwordx4 v[120:123], v7, s[4:7], s57 offen offset:1024 sc1
buffer_load_dwordx4 v[124:127], v7, s[4:7], s57 offen offset:2048 sc1
buffer_load_dwordx4 v[128:131], v7, s[4:7], s57 offen offset:3072 sc1
buffer_load_dwordx4 v[132:135], v7, s[4:7], s58 offen offset:0 sc1
buffer_load_dwordx4 v[136:139], v7, s[4:7], s58 offen offset:1024 sc1
buffer_load_dwordx4 v[140:143], v7, s[4:7], s58 offen offset:2048 sc1
buffer_load_dwordx4 v[144:147], v7, s[4:7], s58 offen offset:3072 sc1
s_waitcnt vmcnt(6)
v_max3_u32 v92, v116, v117, v118
v_max3_u32 v93, v119, v120, v121
v_max3_u32 v92, v92, v122, v123
v_max_u32 v92, v92, v93
v_cmp_eq_u32 vcc, -1, v92
s_add_u32 s97, s97, 1
s_cmp_gt_u32 s97, 65536
s_cbranch_scc1 L_o2_ok
s_cbranch_vccnz L_o2_retry
s_branch L_o2_ok
L_o3_retry:
buffer_load_dwordx4 v[124:127], v7, s[4:7], s57 offen offset:2048 sc1
buffer_load_dwordx4 v[128:131], v7, s[4:7], s57 offen offset:3072 sc1
buffer_load_dwordx4 v[132:135], v7, s[4:7], s58 offen offset:0 sc1
buffer_load_dwordx4 v[136:139], v7, s[4:7], s58 offen offset:1024 sc1
buffer_load_dwordx4 v[140:143], v7, s[4:7], s58 offen offset:2048 sc1
buffer_load_dwordx4 v[144:147], v7, s[4:7], s58 offen offset:3072 sc1
buffer_load_dwordx4 v[148:151], v7, s[4:7], s59 offen offset:0 sc1
buffer_load_dwordx4 v[152:155], v7, s[4:7], s59 offen offset:1024 sc1
s_waitcnt vmcnt(6)
v_max3_u32 v92, v124, v125, v126
v_max3_u32 v93, v127, v128, v129
v_max3_u32 v92, v92, v130, v131
v_max_u32 v92, v92, v93
v_cmp_eq_u32 vcc, -1, v92
s_add_u32 s97, s97, 1
s_cmp_gt_u32 s97, 65536
s_cbranch_scc1 L_o3_ok
s_cbranch_vccnz L_o3_retry
s_branch L_o3_ok
L_o4_retry:
buffer_load_dwordx4 v[132:135], v7, s[4:7], s58 offen offset:0 sc1
buffer_load_dwordx4 v[136:139], v7, s[4:7], s58 offen offset:1024 sc1
buffer_load_dwordx4 v[140:143], v7, s[4:7], s58 offen offset:2048 sc1
buffer_load_dwordx4 v[144:147], v7, s[4:7], s58 offen offset:3072 sc1
buffer_load_dwordx4 v[148:151], v7, s[4:7], s59 offen offset:0 sc1
buffer_load_dwordx4 v[152:155], v7, s[4:7], s59 offen offset:1024 sc1
buffer_load_dwordx4 v[156:159], v7, s[4:7], s59 offen offset:2048 sc1
buffer_load_dwordx4 v[160:163], v7, s[4:7], s59 offen offset:3072 sc1
s_waitcnt vmcnt(6)
v_max3_u32 v92, v132, v133, v134
v_max3_u32 v93, v135, v136, v137
v_max3_u32 v92, v92, v138, v139
v_max_u32 v92, v92, v93
v_cmp_eq_u32 vcc, -1, v92
s_add_u32 s97, s97, 1
s_cmp_gt_u32 s97, 65536
s_cbranch_scc1 L_o4_ok
s_cbranch_vccnz L_o4_retry
s_branch L_o4_ok
L_o5_retry:
buffer_load_dwordx4 v[140:143], v7, s[4:7], s58 offen offset:2048 sc1
buffer_load_dwordx4 v[144:147], v7, s[4:7], s58 offen offset:3072 sc1
buffer_load_dwordx4 v[148:151], v7, s[4:7], s59 offen offset:0 sc1
buffer_load_dwordx4 v[152:155], v7, s[4:7], s59 offen offset:1024 sc1
buffer_load_dwordx4 v[156:159], v7, s[4:7], s59 offen offset:2048 sc1
buffer_load_dwordx4 v[160:163], v7, s[4:7], s59 offen offset:3072 sc1
buffer_load_dwordx4 v[164:167], v7, s[4:7], s60 offen offset:0 sc1
buffer_load_dwordx4 v[168:171], v7, s[4:7], s60 offen offset:1024 sc1
s_waitcnt vmcnt(6)
v_max3_u32 v92, v140, v141, v142
v_max3_u32 v93, v143, v144, v145
v_max3_u32 v92, v92, v146, v147
v_max_u32 v92, v92, v93
v_cmp_eq_u32 vcc, -1, v92
s_add_u32 s97, s97, 1
s_cmp_gt_u32 s97, 65536
s_cbranch_scc1 L_o5_ok
s_cbranch_vccnz L_o5_retry
s_branch L_o5_ok
L_o6_retry:
buffer_load_dwordx4 v[148:151], v7, s[4:7], s59 offen offset:0 sc1
buffer_load_dwordx4 v[152:155], v7, s[4:7], s59 offen offset:1024 sc1
buffer_load_dwordx4 v[156:159], v7, s[4:7], s59 offen offset:2048 sc1
buffer_load_dwordx4 v[160:163], v7, s[4:7], s59 offen offset:3072 sc1
buffer_load_dwordx4 v[164:167], v7, s[4:7], s60 offen offset:0 sc1
buffer_load_dwordx4 v[168:171], v7, s[4:7], s60 offen offset:1024 sc1
buffer_load_dwordx4 v[172:175], v7, s[4:7], s60 offen offset:2048 sc1
buffer_load_dwordx4 v[176:179], v7, s[4:7], s60 offen offset:3072 sc1
s_waitcnt vmcnt(6)
v_max3_u32 v92, v148, v149, v150
v_max3_u32 v93, v151, v152, v153
v_max3_u32 v92, v92, v154, v155
v_max_u32 v92, v92, v93
v_cmp_eq_u32 vcc, -1, v92
s_add_u32 s97, s97, 1
s_cmp_gt_u32 s97, 65536
s_cbranch_scc1 L_o6_ok
s_cbranch_vccnz L_o6_retry
s_branch L_o6_ok
L_o7_retry:
buffer_load_dwordx4 v[156:159], v7, s[4:7], s59 offen offset:2048 sc1
buffer_load_dwordx4 v[160:163], v7, s[4:7], s59 offen offset:3072 sc1
buffer_load_dwordx4 v[164:167], v7, s[4:7], s60 offen offset:0 sc1
buffer_load_dwordx4 v[168:171], v7, s[4:7], s60 offen offset:1024 sc1
buffer_load_dwordx4 v[172:175], v7, s[4:7], s60 offen offset:2048 sc1
buffer_load_dwordx4 v[176:179], v7, s[4:7], s60 offen offset:3072 sc1
s_waitcnt vmcnt(4)
v_max3_u32 v92, v156, v157, v158
v_max3_u32 v93, v159, v160, v161
v_max3_u32 v92, v92, v162, v163
v_max_u32 v92, v92, v93
v_cmp_eq_u32 vcc, -1, v92
s_add_u32 s97, s97, 1
s_cmp_gt_u32 s97, 65536
s_cbranch_scc1 L_o7_ok
s_cbranch_vccnz L_o7_retry
s_branch L_o7_ok
L_o8_retry:
buffer_load_dwordx4 v[164:167], v7, s[4:7], s60 offen offset:0 sc1
buffer_load_dwordx4 v[168:171], v7, s[4:7], s60 offen offset:1024 sc1
buffer_load_dwordx4 v[172:175], v7, s[4:7], s60 offen offset:2048 sc1
buffer_load_dwordx4 v[176:179], v7, s[4:7], s60 offen offset:3072 sc1
s_waitcnt vmcnt(2)
v_max3_u32 v92, v164, v165, v166
v_max3_u32 v93, v167, v168, v169
v_max3_u32 v92, v92, v170, v171
v_max_u32 v92, v92, v93
v_cmp_eq_u32 vcc, -1, v92
s_add_u32 s97, s97, 1
s_cmp_gt_u32 s97, 65536
s_cbranch_scc1 L_o8_ok
s_cbranch_vccnz L_o8_retry
s_branch L_o8_ok
L_o9_retry:
buffer_load_dwordx4 v[172:175], v7, s[4:7], s60 offen offset:2048 sc1
buffer_load_dwordx4 v[176:179], v7, s[4:7], s60 offen offset:3072 sc1
s_waitcnt vmcnt(0)
v_max3_u32 v92, v172, v173, v174
v_max3_u32 v93, v175, v176, v177
v_max3_u32 v92, v92, v178, v179
v_max_u32 v92, v92, v93
v_cmp_eq_u32 vcc, -1, v92
s_add_u32 s97, s97, 1
s_cmp_gt_u32 s97, 65536
s_cbranch_scc1 L_o9_ok
s_cbranch_vccnz L_o9_retry
s_branch L_o9_ok
L_st_slow:
buffer_store_dword v44, v0, s[4:7], s57 offen sc1
s_branch L_st_j
L_svc:
s_sub_u32 s44, s2, 224
v_lshlrev_b32 v28, 3, v0
s_waitcnt lgkmcnt(0)
s_mov_b32 s16, s22
s_mov_b32 s17, s23
s_mov_b32 s22, 1280
s_mov_b32 s23, 0x20000
buffer_load_dwordx2 v[40:41], v28, s[20:23], 0 offen
buffer_load_dword v42, v29, s[4:7], 0 offen sc1
s_load_dwordx2 s[8:9], s[0:1], 40
s_load_dwordx2 s[12:13], s[0:1], 48
s_load_dwordx2 s[36:37], s[0:1], 56
s_load_dwordx2 s[24:25], s[0:1], 16
s_load_dwordx2 s[28:29], s[0:1], 32
s_load_dwordx2 s[32:33], s[0:1], 80
s_mov_b32 s18, 4915200
s_mov_b32 s19, 0x20000
s_mov_b32 s26, 819200
s_mov_b32 s27, 0x20000
s_mov_b32 s30, 1280
s_mov_b32 s31, 0x20000
s_mov_b32 s34, 2621440
s_mov_b32 s35, 0x20000
s_mov_b32 s10, 2211840
s_mov_b32 s11, 0x20000
s_mov_b32 s14, 2211840
s_mov_b32 s15, 0x20000
s_mov_b32 s38, 2211840
s_mov_b32 s39, 0x20000
v_bfe_u32 v32, v1, 2, 2
v_lshrrev_b32 v33, 1, v32
v_and_b32 v34, 1, v3
v_lshl_or_b32 v33, v34, 1, v33
v_xor_b32 v33, s3, v33
v_and_b32 v34, 3, v1
v_lshlrev_b32 v34, 3, v34
v_lshl_add_u32 v33, v33, 5, v34
v_lshl_add_u32 v32, v3, 3, v32
v_lshl_add_u32 v6, v32, 7, v33
s_mov_b32 s97, 0
s_mov_b32 s98, 0x0c0c0400
s_mov_b32 s99, 0x04000c0c
v_add_u32 v7, 40960, v6
v_add_u32 v9, 81920, v6
v_add_u32 v10, 81920+40960, v6
s_mul_i32 s55, s3, 320
s_add_u32 s55, s55, 81920
v_mul_u32_u24 v32, 1280, v32
v_add3_u32 v11, v32, v34, s55
s_and_b32 s55, s3, 1
s_lshl_b32 s55, s55, 2
v_and_b32 v30, 1, v3
v_lshl_or_b32 v30, v30, 1, s55
v_and_b32 v31, 7, v1
v_xor_b32 v31, v30, v31
v_lshlrev_b32 v31, 4, v31
v_lshrrev_b32 v30, 3, v1
v_mad_u32_u24 v4, v30, 60, 0
v_lshl_add_u32 v4, v4, 7, v31
v_mad_u32_u24 v5, v30, 27, 0
v_lshl_add_u32 v5, v5, 7, v31
v_lshlrev_b32 v8, 4, v1
v_lshlrev_b32 v12, 2, v1
v_mov_b32 v255, 1073741824
s_waitcnt lgkmcnt(0)
s_cmp_ge_u32 s44, 27
s_cbranch_scc1 L_fz
s_lshl_b32 s55, s44, 2
s_add_u32 s55, s55, s3
s_mul_i32 s55, s55, 7680
v_lshlrev_b32 v33, 7, v1
s_mov_b32 exec_hi, 0xfffffff
buffer_load_dword v184, v33, s[24:27], s55 offen
s_mov_b32 exec_hi, -1
s_lshl_b32 s50, s44, 7
s_mul_i32 s55, s3, 61440
s_add_u32 s50, s50, s55
s_add_u32 s50, s50, 2560
s_add_u32 m0, s49, 0
s_nop 0
buffer_load_dwordx4 v4, s[16:19], s50 offen nt lds
s_add_u32 m0, m0, 4096
s_add_u32 s50, s50, 245760
buffer_load_dwordx4 v4, s[16:19], s50 offen nt lds
s_add_u32 m0, m0, 4096
s_add_u32 s50, s50, 245760
buffer_load_dwordx4 v4, s[16:19], s50 offen nt lds
s_add_u32 m0, m0, 4096
s_add_u32 s50, s50, 245760
buffer_load_dwordx4 v4, s[16:19], s50 offen nt lds
s_add_u32 m0, m0, 4096
s_add_u32 s50, s50, 245760
buffer_load_dwordx4 v4, s[16:19], s50 offen nt lds
s_add_u32 m0, m0, 4096
s_add_u32 s50, s50, 245760
buffer_load_dwordx4 v4, s[16:19], s50 offen nt lds
s_add_u32 m0, m0, 4096
s_add_u32 s50, s50, 245760
buffer_load_dwordx4 v4, s[16:19], s50 offen nt lds
s_add_u32 m0, m0, 4096
s_add_u32 s50, s50, 245760
buffer_load_dwordx4 v4, s[16:19], s50 offen nt lds
s_add_u32 m0, m0, 4096
s_add_u32 s50, s50, 245760
buffer_load_dwordx4 v4, s[16:19], s50 offen nt lds
s_add_u32 m0, m0, 4096
s_add_u32 s50, s50, 245760
buffer_load_dwordx4 v4, s[16:19], s50 offen nt lds
s_add_u32 m0, m0, 4096
s_add_u32 s50, s50, 245760
buffer_load_dwordx4 v4, s[16:19], s50 offen nt lds
s_add_u32 m0, m0, 4096
s_add_u32 s50, s50, 245760
buffer_load_dwordx4 v4, s[16:19], s50 offen nt lds
s_add_u32 m0, m0, 4096
s_add_u32 s50, s50, 245760
buffer_load_dwordx4 v4, s[16:19], s50 offen nt lds
s_add_u32 m0, m0, 4096
s_add_u32 s50, s50, 245760
buffer_load_dwordx4 v4, s[16:19], s50 offen nt lds
s_add_u32 m0, m0, 4096
s_add_u32 s50, s50, 245760
buffer_load_dwordx4 v4, s[16:19], s50 offen nt lds
s_add_u32 m0, m0, 4096
s_add_u32 s50, s50, 245760
buffer_load_dwordx4 v4, s[16:19], s50 offen nt lds
s_add_u32 m0, m0, 4096
s_add_u32 s50, s50, 245760
buffer_load_dwordx4 v4, s[16:19], s50 offen nt lds
s_add_u32 m0, m0, 4096
s_add_u32 s50, s50, 245760
buffer_load_dwordx4 v4, s[16:19], s50 offen nt lds
s_add_u32 m0, m0, 4096
s_add_u32 s50, s50, 245760
buffer_load_dwordx4 v4, s[16:19], s50 offen nt lds
s_add_u32 m0, m0, 4096
s_add_u32 s50, s50, 245760
buffer_load_dwordx4 v4, s[16:19], s50 offen nt lds
s_waitcnt vmcnt(21)
v_readfirstlane_b32 s41, v42
v_lshlrev_b32 v44, 16, v40
v_and_b32 v45, 0xffff0000, v40
v_lshlrev_b32 v46, 16, v41
v_and_b32 v47, 0xffff0000, v41
v_mul_f32 v48, 0xbfb8aa3b, v44
v_mul_f32 v49, 0xbfb8aa3b, v45
v_mul_f32 v50, 0xbfb8aa3b, v46
v_mul_f32 v51, 0xbfb8aa3b, v47
v_exp_f32 v48, v48
v_exp_f32 v49, v49
v_exp_f32 v50, v50
v_exp_f32 v51, v51
v_add_f32 v48, 1.0, v48
v_add_f32 v49, 1.0, v49
v_add_f32 v50, 1.0, v50
v_add_f32 v51, 1.0, v51
v_rcp_f32 v48, v48
v_rcp_f32 v49, v49
v_rcp_f32 v50, v50
v_rcp_f32 v51, v51
v_mul_f32 v44, v44, v48
v_mul_f32 v45, v45, v49
v_mul_f32 v46, v46, v50
v_mul_f32 v47, v47, v51
v_cvt_pk_bf16_f32 v40, v44, v45
v_cvt_pk_bf16_f32 v41, v46, v47
v_add_u32 v28, 99840, v28
ds_write_b64 v28, v[40:41]
v_lshlrev_b32 v28, 4, v3
v_add_u32 v28, 99840, v28
s_mul_i32 s40, s41, 0x9E3779B1
s_add_u32 s40, s40, 0x85EBCA6B
v_and_b32 v33, 3, v1
v_lshlrev_b32 v33, 3, v33
v_lshrrev_b32 v19, v33, s40
v_and_b32 v19, 0xff, v19
v_mov_b32 v240, s40
v_mov_b32 v241, s19
v_mov_b32 v242, s40
v_mov_b32 v243, s40
v_and_b32 v30, 1, v1
v_lshlrev_b32 v30, 4, v30
v_lshrrev_b32 v13, v30, s40
v_and_b32 v13, 0xffff, v13
s_waitcnt lgkmcnt(0)
s_barrier
ds_read_b128 v[100:103], v28 offset:0
ds_read_b128 v[104:107], v28 offset:64
ds_read_b128 v[108:111], v28 offset:128
ds_read_b128 v[112:115], v28 offset:192
ds_read_b128 v[116:119], v28 offset:256
ds_read_b128 v[120:123], v28 offset:320
ds_read_b128 v[124:127], v28 offset:384
ds_read_b128 v[128:131], v28 offset:448
ds_read_b128 v[132:135], v28 offset:512
ds_read_b128 v[136:139], v28 offset:576
ds_read_b128 v[140:143], v28 offset:640
ds_read_b128 v[144:147], v28 offset:704
ds_read_b128 v[148:151], v28 offset:768
ds_read_b128 v[152:155], v28 offset:832
ds_read_b128 v[156:159], v28 offset:896
ds_read_b128 v[160:163], v28 offset:960
ds_read_b128 v[164:167], v28 offset:1024
ds_read_b128 v[168:171], v28 offset:1088
ds_read_b128 v[172:175], v28 offset:1152
ds_read_b128 v[176:179], v28 offset:1216
s_waitcnt lgkmcnt(0)
s_barrier
s_lshl_b32 s51, s44, 7
s_mul_i32 s55, s3, 27648
s_add_u32 s51, s51, s55
s_mov_b32 s52, s51
s_add_u32 m0, s49, 81920
s_nop 0
buffer_load_dwordx4 v5, s[8:11], s51 offen nt lds
s_add_u32 m0, m0, 4096
s_add_u32 s51, s51, 110592
buffer_load_dwordx4 v5, s[8:11], s51 offen nt lds
s_add_u32 m0, m0, 4096
s_add_u32 s51, s51, 110592
buffer_load_dwordx4 v5, s[8:11], s51 offen nt lds
s_add_u32 m0, m0, 4096
s_add_u32 s51, s51, 110592
buffer_load_dwordx4 v5, s[8:11], s51 offen nt lds
s_add_u32 m0, m0, 4096
s_add_u32 s51, s51, 110592
buffer_load_dwordx4 v5, s[8:11], s51 offen nt lds
s_add_u32 m0, m0, 4096
s_add_u32 s51, s51, 110592
buffer_load_dwordx4 v5, s[8:11], s51 offen nt lds
s_add_u32 m0, m0, 4096
s_add_u32 s51, s51, 110592
buffer_load_dwordx4 v5, s[8:11], s51 offen nt lds
s_add_u32 m0, m0, 4096
s_add_u32 s51, s51, 110592
buffer_load_dwordx4 v5, s[8:11], s51 offen nt lds
s_add_u32 m0, m0, 4096
s_add_u32 s51, s51, 110592
buffer_load_dwordx4 v5, s[8:11], s51 offen nt lds
s_add_u32 m0, m0, 4096
s_add_u32 s51, s51, 110592
buffer_load_dwordx4 v5, s[8:11], s51 offen nt lds
s_add_u32 m0, m0, 4096
s_add_u32 s51, s51, 110592
buffer_load_dwordx4 v5, s[8:11], s51 offen nt lds
s_add_u32 m0, m0, 4096
s_add_u32 s51, s51, 110592
buffer_load_dwordx4 v5, s[8:11], s51 offen nt lds
s_add_u32 m0, m0, 4096
s_add_u32 s51, s51, 110592
buffer_load_dwordx4 v5, s[8:11], s51 offen nt lds
s_add_u32 m0, m0, 4096
s_add_u32 s51, s51, 110592
buffer_load_dwordx4 v5, s[8:11], s51 offen nt lds
s_add_u32 m0, m0, 4096
s_add_u32 s51, s51, 110592
buffer_load_dwordx4 v5, s[8:11], s51 offen nt lds
s_add_u32 m0, m0, 4096
s_add_u32 s51, s51, 110592
buffer_load_dwordx4 v5, s[8:11], s51 offen nt lds
s_add_u32 m0, m0, 4096
s_add_u32 s51, s51, 110592
buffer_load_dwordx4 v5, s[8:11], s51 offen nt lds
s_add_u32 m0, m0, 4096
s_add_u32 s51, s51, 110592
buffer_load_dwordx4 v5, s[8:11], s51 offen nt lds
s_add_u32 m0, m0, 4096
s_add_u32 s51, s51, 110592
buffer_load_dwordx4 v5, s[8:11], s51 offen nt lds
s_add_u32 m0, m0, 4096
s_add_u32 s51, s51, 110592
buffer_load_dwordx4 v5, s[8:11], s51 offen nt lds
s_waitcnt vmcnt(20)
s_barrier
ds_read_b64_tr_b16 v[20:21], v6 offset:0
ds_read_b64_tr_b16 v[22:23], v6 offset:512
ds_read_b64_tr_b16 v[24:25], v6 offset:4096
ds_read_b64_tr_b16 v[26:27], v6 offset:4608
ds_read_b64_tr_b16 v[28:29], v6 offset:8192
ds_read_b64_tr_b16 v[30:31], v6 offset:8704
ds_read_b64_tr_b16 v[32:33], v6 offset:12288
ds_read_b64_tr_b16 v[34:35], v6 offset:12800
ds_read_b64_tr_b16 v[36:37], v6 offset:16384
ds_read_b64_tr_b16 v[38:39], v6 offset:16896
ds_read_b64_tr_b16 v[40:41], v6 offset:20480
ds_read_b64_tr_b16 v[42:43], v6 offset:20992
ds_read_b64_tr_b16 v[44:45], v6 offset:24576
ds_read_b64_tr_b16 v[46:47], v6 offset:25088
ds_read_b64_tr_b16 v[48:49], v6 offset:28672
ds_read_b64_tr_b16 v[50:51], v6 offset:29184
ds_read_b64_tr_b16 v[52:53], v6 offset:32768
ds_read_b64_tr_b16 v[54:55], v6 offset:33280
ds_read_b64_tr_b16 v[56:57], v6 offset:36864
ds_read_b64_tr_b16 v[58:59], v6 offset:37376
ds_read_b64_tr_b16 v[60:61], v7 offset:0
ds_read_b64_tr_b16 v[62:63], v7 offset:512
ds_read_b64_tr_b16 v[64:65], v7 offset:4096
ds_read_b64_tr_b16 v[66:67], v7 offset:4608
ds_read_b64_tr_b16 v[68:69], v7 offset:8192
ds_read_b64_tr_b16 v[70:71], v7 offset:8704
ds_read_b64_tr_b16 v[72:73], v7 offset:12288
ds_read_b64_tr_b16 v[74:75], v7 offset:12800
ds_read_b64_tr_b16 v[76:77], v7 offset:16384
ds_read_b64_tr_b16 v[78:79], v7 offset:16896
ds_read_b64_tr_b16 v[80:81], v7 offset:20480
ds_read_b64_tr_b16 v[82:83], v7 offset:20992
ds_read_b64_tr_b16 v[84:85], v7 offset:24576
ds_read_b64_tr_b16 v[86:87], v7 offset:25088
ds_read_b64_tr_b16 v[88:89], v7 offset:28672
ds_read_b64_tr_b16 v[90:91], v7 offset:29184
ds_read_b64_tr_b16 v[92:93], v7 offset:32768
ds_read_b64_tr_b16 v[94:95], v7 offset:33280
ds_read_b64_tr_b16 v[96:97], v7 offset:36864
ds_read_b64_tr_b16 v[98:99], v7 offset:37376
s_waitcnt lgkmcnt(0)
s_barrier
v_mfma_f32_16x16x32_bf16 v[180:183], v[100:103], v[20:23], 0
v_mfma_f32_16x16x32_bf16 v[180:183], v[104:107], v[24:27], v[180:183]
v_mfma_f32_16x16x32_bf16 v[180:183], v[108:111], v[28:31], v[180:183]
v_mfma_f32_16x16x32_bf16 v[180:183], v[112:115], v[32:35], v[180:183]
v_mfma_f32_16x16x32_bf16 v[180:183], v[116:119], v[36:39], v[180:183]
v_mfma_f32_16x16x32_bf16 v[180:183], v[120:123], v[40:43], v[180:183]
v_mfma_f32_16x16x32_bf16 v[180:183], v[124:127], v[44:47], v[180:183]
v_mfma_f32_16x16x32_bf16 v[180:183], v[128:131], v[48:51], v[180:183]
v_mfma_f32_16x16x32_bf16 v[180:183], v[132:135], v[52:55], v[180:183]
v_mfma_f32_16x16x32_bf16 v[180:183], v[136:139], v[56:59], v[180:183]
v_mfma_f32_16x16x32_bf16 v[180:183], v[140:143], v[60:63], v[180:183]
v_mfma_f32_16x16x32_bf16 v[180:183], v[144:147], v[64:67], v[180:183]
v_mfma_f32_16x16x32_bf16 v[180:183], v[148:151], v[68:71], v[180:183]
v_mfma_f32_16x16x32_bf16 v[180:183], v[152:155], v[72:75], v[180:183]
v_mfma_f32_16x16x32_bf16 v[180:183], v[156:159], v[76:79], v[180:183]
v_mfma_f32_16x16x32_bf16 v[180:183], v[160:163], v[80:83], v[180:183]
v_mfma_f32_16x16x32_bf16 v[180:183], v[164:167], v[84:87], v[180:183]
v_mfma_f32_16x16x32_bf16 v[180:183], v[168:171], v[88:91], v[180:183]
v_mfma_f32_16x16x32_bf16 v[180:183], v[172:175], v[92:95], v[180:183]
v_mfma_f32_16x16x32_bf16 v[180:183], v[176:179], v[96:99], v[180:183]
s_sub_u32 s55, s44, 20
s_cmp_lt_u32 s55, 10
s_cselect_b32 s55, 1.0, 0
s_lshl_b32 s56, s44, 8
s_lshl_b32 s57, s3, 6
s_add_u32 s56, s56, s57
s_add_u32 s56, s56, 65536
s_nop 0
v_cvt_pk_bf16_f32 v180, v180, v180
v_lshlrev_b32 v180, 16, v180
v_add_f32 v180, s55, v180
v_cvt_pk_bf16_f32 v180, v180, v180
v_lshl_or_b32 v180, v180, 16, v13
s_mov_b64 exec, 0xffff
buffer_store_dword v180, v12, s[4:7], s56 offen sc1
s_mov_b64 exec, -1
s_add_u32 m0, s49, 0
s_nop 0
buffer_load_dwordx4 v5, s[12:15], s52 offen nt lds
s_add_u32 m0, m0, 4096
s_add_u32 s52, s52, 110592
buffer_load_dwordx4 v5, s[12:15], s52 offen nt lds
s_add_u32 m0, m0, 4096
s_add_u32 s52, s52, 110592
buffer_load_dwordx4 v5, s[12:15], s52 offen nt lds
s_add_u32 m0, m0, 4096
s_add_u32 s52, s52, 110592
buffer_load_dwordx4 v5, s[12:15], s52 offen nt lds
s_add_u32 m0, m0, 4096
s_add_u32 s52, s52, 110592
buffer_load_dwordx4 v5, s[12:15], s52 offen nt lds
s_add_u32 m0, m0, 4096
s_add_u32 s52, s52, 110592
buffer_load_dwordx4 v5, s[12:15], s52 offen nt lds
s_add_u32 m0, m0, 4096
s_add_u32 s52, s52, 110592
buffer_load_dwordx4 v5, s[12:15], s52 offen nt lds
s_add_u32 m0, m0, 4096
s_add_u32 s52, s52, 110592
buffer_load_dwordx4 v5, s[12:15], s52 offen nt lds
s_add_u32 m0, m0, 4096
s_add_u32 s52, s52, 110592
buffer_load_dwordx4 v5, s[12:15], s52 offen nt lds
s_add_u32 m0, m0, 4096
s_add_u32 s52, s52, 110592
buffer_load_dwordx4 v5, s[12:15], s52 offen nt lds
s_add_u32 m0, m0, 4096
s_add_u32 s52, s52, 110592
buffer_load_dwordx4 v5, s[12:15], s52 offen nt lds
s_add_u32 m0, m0, 4096
s_add_u32 s52, s52, 110592
buffer_load_dwordx4 v5, s[12:15], s52 offen nt lds
s_add_u32 m0, m0, 4096
s_add_u32 s52, s52, 110592
buffer_load_dwordx4 v5, s[12:15], s52 offen nt lds
s_add_u32 m0, m0, 4096
s_add_u32 s52, s52, 110592
buffer_load_dwordx4 v5, s[12:15], s52 offen nt lds
s_add_u32 m0, m0, 4096
s_add_u32 s52, s52, 110592
buffer_load_dwordx4 v5, s[12:15], s52 offen nt lds
s_add_u32 m0, m0, 4096
s_add_u32 s52, s52, 110592
buffer_load_dwordx4 v5, s[12:15], s52 offen nt lds
s_add_u32 m0, m0, 4096
s_add_u32 s52, s52, 110592
buffer_load_dwordx4 v5, s[12:15], s52 offen nt lds
s_add_u32 m0, m0, 4096
s_add_u32 s52, s52, 110592
buffer_load_dwordx4 v5, s[12:15], s52 offen nt lds
s_add_u32 m0, m0, 4096
s_add_u32 s52, s52, 110592
buffer_load_dwordx4 v5, s[12:15], s52 offen nt lds
s_add_u32 m0, m0, 4096
s_add_u32 s52, s52, 110592
buffer_load_dwordx4 v5, s[12:15], s52 offen nt lds
s_waitcnt vmcnt(21)
s_barrier
ds_read_b64_tr_b16 a[0:1], v9 offset:0
ds_read_b64_tr_b16 a[2:3], v9 offset:512
ds_read_b64_tr_b16 a[4:5], v9 offset:4096
ds_read_b64_tr_b16 a[6:7], v9 offset:4608
ds_read_b64_tr_b16 a[8:9], v9 offset:8192
ds_read_b64_tr_b16 a[10:11], v9 offset:8704
ds_read_b64_tr_b16 a[12:13], v9 offset:12288
ds_read_b64_tr_b16 a[14:15], v9 offset:12800
ds_read_b64_tr_b16 a[16:17], v9 offset:16384
ds_read_b64_tr_b16 a[18:19], v9 offset:16896
ds_read_b64_tr_b16 a[20:21], v9 offset:20480
ds_read_b64_tr_b16 a[22:23], v9 offset:20992
ds_read_b64_tr_b16 a[24:25], v9 offset:24576
ds_read_b64_tr_b16 a[26:27], v9 offset:25088
ds_read_b64_tr_b16 a[28:29], v9 offset:28672
ds_read_b64_tr_b16 a[30:31], v9 offset:29184
ds_read_b64_tr_b16 a[32:33], v9 offset:32768
ds_read_b64_tr_b16 a[34:35], v9 offset:33280
ds_read_b64_tr_b16 a[36:37], v9 offset:36864
ds_read_b64_tr_b16 a[38:39], v9 offset:37376
ds_read_b64_tr_b16 a[40:41], v10 offset:0
ds_read_b64_tr_b16 a[42:43], v10 offset:512
ds_read_b64_tr_b16 a[44:45], v10 offset:4096
ds_read_b64_tr_b16 a[46:47], v10 offset:4608
ds_read_b64_tr_b16 a[48:49], v10 offset:8192
ds_read_b64_tr_b16 a[50:51], v10 offset:8704
ds_read_b64_tr_b16 a[52:53], v10 offset:12288
ds_read_b64_tr_b16 a[54:55], v10 offset:12800
ds_read_b64_tr_b16 a[56:57], v10 offset:16384
ds_read_b64_tr_b16 a[58:59], v10 offset:16896
ds_read_b64_tr_b16 a[60:61], v10 offset:20480
ds_read_b64_tr_b16 a[62:63], v10 offset:20992
ds_read_b64_tr_b16 a[64:65], v10 offset:24576
ds_read_b64_tr_b16 a[66:67], v10 offset:25088
ds_read_b64_tr_b16 a[68:69], v10 offset:28672
ds_read_b64_tr_b16 a[70:71], v10 offset:29184
ds_read_b64_tr_b16 a[72:73], v10 offset:32768
ds_read_b64_tr_b16 a[74:75], v10 offset:33280
ds_read_b64_tr_b16 a[76:77], v10 offset:36864
ds_read_b64_tr_b16 a[78:79], v10 offset:37376
s_waitcnt lgkmcnt(0)
s_barrier
s_mul_i32 s51, s44, 81920
s_add_u32 s51, s51, s49
s_add_u32 m0, s49, 81920
s_nop 0
buffer_load_dwordx4 v8, s[36:39], s51 offen nt lds
s_add_u32 m0, m0, 4096
s_add_u32 s51, s51, 4096
buffer_load_dwordx4 v8, s[36:39], s51 offen nt lds
s_add_u32 m0, m0, 4096
s_add_u32 s51, s51, 4096
buffer_load_dwordx4 v8, s[36:39], s51 offen nt lds
s_add_u32 m0, m0, 4096
s_add_u32 s51, s51, 4096
buffer_load_dwordx4 v8, s[36:39], s51 offen nt lds
s_add_u32 m0, m0, 4096
s_add_u32 s51, s51, 4096
buffer_load_dwordx4 v8, s[36:39], s51 offen nt lds
s_add_u32 m0, m0, 4096
s_add_u32 s51, s51, 4096
buffer_load_dwordx4 v8, s[36:39], s51 offen nt lds
s_add_u32 m0, m0, 4096
s_add_u32 s51, s51, 4096
buffer_load_dwordx4 v8, s[36:39], s51 offen nt lds
s_add_u32 m0, m0, 4096
s_add_u32 s51, s51, 4096
buffer_load_dwordx4 v8, s[36:39], s51 offen nt lds
s_add_u32 m0, m0, 4096
s_add_u32 s51, s51, 4096
buffer_load_dwordx4 v8, s[36:39], s51 offen nt lds
s_add_u32 m0, m0, 4096
s_add_u32 s51, s51, 4096
buffer_load_dwordx4 v8, s[36:39], s51 offen nt lds
s_add_u32 m0, m0, 4096
s_add_u32 s51, s51, 4096
buffer_load_dwordx4 v8, s[36:39], s51 offen nt lds
s_add_u32 m0, m0, 4096
s_add_u32 s51, s51, 4096
buffer_load_dwordx4 v8, s[36:39], s51 offen nt lds
s_add_u32 m0, m0, 4096
s_add_u32 s51, s51, 4096
buffer_load_dwordx4 v8, s[36:39], s51 offen nt lds
s_add_u32 m0, m0, 4096
s_add_u32 s51, s51, 4096
buffer_load_dwordx4 v8, s[36:39], s51 offen nt lds
s_add_u32 m0, m0, 4096
s_add_u32 s51, s51, 4096
buffer_load_dwordx4 v8, s[36:39], s51 offen nt lds
s_add_u32 m0, m0, 4096
s_add_u32 s51, s51, 4096
buffer_load_dwordx4 v8, s[36:39], s51 offen nt lds
s_add_u32 m0, m0, 4096
s_add_u32 s51, s51, 4096
buffer_load_dwordx4 v8, s[36:39], s51 offen nt lds
s_add_u32 m0, m0, 4096
s_add_u32 s51, s51, 4096
buffer_load_dwordx4 v8, s[36:39], s51 offen nt lds
s_add_u32 m0, m0, 4096
s_add_u32 s51, s51, 4096
buffer_load_dwordx4 v8, s[36:39], s51 offen nt lds
s_add_u32 m0, m0, 4096
s_add_u32 s51, s51, 4096
buffer_load_dwordx4 v8, s[36:39], s51 offen nt lds
s_waitcnt vmcnt(20)
s_barrier
ds_read_b64_tr_b16 a[80:81], v6 offset:0
ds_read_b64_tr_b16 a[82:83], v6 offset:512
ds_read_b64_tr_b16 a[84:85], v6 offset:4096
ds_read_b64_tr_b16 a[86:87], v6 offset:4608
ds_read_b64_tr_b16 a[88:89], v6 offset:8192
ds_read_b64_tr_b16 a[90:91], v6 offset:8704
ds_read_b64_tr_b16 a[92:93], v6 offset:12288
ds_read_b64_tr_b16 a[94:95], v6 offset:12800
ds_read_b64_tr_b16 a[96:97], v6 offset:16384
ds_read_b64_tr_b16 a[98:99], v6 offset:16896
ds_read_b64_tr_b16 a[100:101], v6 offset:20480
ds_read_b64_tr_b16 a[102:103], v6 offset:20992
ds_read_b64_tr_b16 a[104:105], v6 offset:24576
ds_read_b64_tr_b16 a[106:107], v6 offset:25088
ds_read_b64_tr_b16 a[108:109], v6 offset:28672
ds_read_b64_tr_b16 a[110:111], v6 offset:29184
ds_read_b64_tr_b16 a[112:113], v6 offset:32768
ds_read_b64_tr_b16 a[114:115], v6 offset:33280
ds_read_b64_tr_b16 a[116:117], v6 offset:36864
ds_read_b64_tr_b16 a[118:119], v6 offset:37376
ds_read_b64_tr_b16 a[120:121], v7 offset:0
ds_read_b64_tr_b16 a[122:123], v7 offset:512
ds_read_b64_tr_b16 a[124:125], v7 offset:4096
ds_read_b64_tr_b16 a[126:127], v7 offset:4608
ds_read_b64_tr_b16 a[128:129], v7 offset:8192
ds_read_b64_tr_b16 a[130:131], v7 offset:8704
ds_read_b64_tr_b16 a[132:133], v7 offset:12288
ds_read_b64_tr_b16 a[134:135], v7 offset:12800
ds_read_b64_tr_b16 a[136:137], v7 offset:16384
ds_read_b64_tr_b16 a[138:139], v7 offset:16896
ds_read_b64_tr_b16 a[140:141], v7 offset:20480
ds_read_b64_tr_b16 a[142:143], v7 offset:20992
ds_read_b64_tr_b16 a[144:145], v7 offset:24576
ds_read_b64_tr_b16 a[146:147], v7 offset:25088
ds_read_b64_tr_b16 a[148:149], v7 offset:28672
ds_read_b64_tr_b16 a[150:151], v7 offset:29184
ds_read_b64_tr_b16 a[152:153], v7 offset:32768
ds_read_b64_tr_b16 a[154:155], v7 offset:33280
ds_read_b64_tr_b16 a[156:157], v7 offset:36864
ds_read_b64_tr_b16 a[158:159], v7 offset:37376
s_waitcnt vmcnt(0) lgkmcnt(0)
s_barrier
ds_read_b64_tr_b16 a[160:161], v11 offset:0
ds_read_b64_tr_b16 a[162:163], v11 offset:5120
ds_read_b64_tr_b16 a[164:165], v11 offset:40960
ds_read_b64_tr_b16 a[166:167], v11 offset:46080
ds_read_b64_tr_b16 a[168:169], v11 offset:32
ds_read_b64_tr_b16 a[170:171], v11 offset:5152
ds_read_b64_tr_b16 a[172:173], v11 offset:40992
ds_read_b64_tr_b16 a[174:175], v11 offset:46112
ds_read_b64_tr_b16 a[176:177], v11 offset:64
ds_read_b64_tr_b16 a[178:179], v11 offset:5184
ds_read_b64_tr_b16 a[180:181], v11 offset:41024
ds_read_b64_tr_b16 a[182:183], v11 offset:46144
ds_read_b64_tr_b16 a[184:185], v11 offset:96
ds_read_b64_tr_b16 a[186:187], v11 offset:5216
ds_read_b64_tr_b16 a[188:189], v11 offset:41056
ds_read_b64_tr_b16 a[190:191], v11 offset:46176
ds_read_b64_tr_b16 a[192:193], v11 offset:128
ds_read_b64_tr_b16 a[194:195], v11 offset:5248
ds_read_b64_tr_b16 a[196:197], v11 offset:41088
ds_read_b64_tr_b16 a[198:199], v11 offset:46208
ds_read_b64_tr_b16 a[200:201], v11 offset:160
ds_read_b64_tr_b16 a[202:203], v11 offset:5280
ds_read_b64_tr_b16 a[204:205], v11 offset:41120
ds_read_b64_tr_b16 a[206:207], v11 offset:46240
ds_read_b64_tr_b16 a[208:209], v11 offset:192
ds_read_b64_tr_b16 a[210:211], v11 offset:5312
ds_read_b64_tr_b16 a[212:213], v11 offset:41152
ds_read_b64_tr_b16 a[214:215], v11 offset:46272
ds_read_b64_tr_b16 a[216:217], v11 offset:224
ds_read_b64_tr_b16 a[218:219], v11 offset:5344
ds_read_b64_tr_b16 a[220:221], v11 offset:41184
ds_read_b64_tr_b16 a[222:223], v11 offset:46304
ds_read_b64_tr_b16 a[224:225], v11 offset:256
ds_read_b64_tr_b16 a[226:227], v11 offset:5376
ds_read_b64_tr_b16 a[228:229], v11 offset:41216
ds_read_b64_tr_b16 a[230:231], v11 offset:46336
ds_read_b64_tr_b16 a[232:233], v11 offset:288
ds_read_b64_tr_b16 a[234:235], v11 offset:5408
ds_read_b64_tr_b16 a[236:237], v11 offset:41248
ds_read_b64_tr_b16 a[238:239], v11 offset:46368
s_waitcnt lgkmcnt(0)
v_mov_b32 v20, 0
ds_write_b32 v12, v20 offset:8192
v_mul_u32_u24 v30, 5462, v1
v_lshrrev_b32 v30, 16, v30
v_lshl_add_u32 v14, v30, 6, v8
v_add_u32 v31, 64, v1
v_mul_u32_u24 v30, 5462, v31
v_lshrrev_b32 v30, 16, v30
v_lshlrev_b32 v31, 4, v31
v_lshl_add_u32 v15, v30, 6, v31
v_cmp_gt_u32 vcc, 16, v1
s_lshl_b32 s55, s3, 11
v_add_u32 v16, s55, v8
v_cndmask_b32 v15, v255, v15, vcc
v_lshl_add_u32 v17, v3, 4, s55
s_lshl_b32 s55, s3, 5
v_lshl_add_u32 v18, v2, 1, s55
v_lshrrev_b32 v30, 2, v2
v_lshlrev_b32 v31, 4, v3
v_add_u32 v32, 128, v31
v_cmp_eq_u32 vcc, 0, v30
s_nop 1
v_cndmask_b32 v232, v32, v31, vcc
v_cmp_eq_u32 vcc, 1, v30
s_nop 1
v_cndmask_b32 v233, v32, v31, vcc
v_cmp_eq_u32 vcc, 2, v30
s_nop 1
v_cndmask_b32 v234, v32, v31, vcc
v_cmp_eq_u32 vcc, 3, v30
s_nop 1
v_cndmask_b32 v235, v32, v31, vcc
v_lshrrev_b32 v30, 5, v1
v_and_b32 v31, 31, v1
v_lshlrev_b32 v31, 2, v31
v_lshl_add_u32 v236, v30, 12, v31
v_cmp_gt_u32 vcc, 32, v1
s_mul_i32 s46, s3, 20480
s_lshl_b32 s55, s44, 7
s_add_u32 s46, s46, s55
s_add_u32 s46, s46, 720896
v_cndmask_b32 v237, v255, v236, vcc
s_add_u32 s47, s46, 8192
s_add_u32 s48, s46, 16384
s_mov_b32 s54, 0xffffff00
v_cmp_gt_u32 vcc, 32, v0
s_lshl_b32 s53, s44, 7
s_add_u32 s53, s53, 425984
v_cndmask_b32 v238, v255, v12, vcc
s_waitcnt lgkmcnt(0)
s_barrier
s_branch L_pg2
.p2align 12
L_pg2:
v_and_b32 v30, 31, v1
v_mul_u32_u24 v30, 4224, v30
s_mul_i32 s55, s42, 512
s_add_u32 s55, s55, 6881280
s_mov_b32 exec_hi, 0
L_m_p:
buffer_load_dwordx3 v[200:202], v30, s[4:7], s55 offen sc1
s_waitcnt vmcnt(0)
v_cmp_ne_u32 vcc, s40, v202
v_mov_b32 v20, v200
s_cbranch_vccz L_m_ok
s_add_u32 s97, s97, 1
s_cmp_le_u32 s97, 65536
s_cbranch_scc1 L_m_p
L_m_ok:
v_max_f32_dpp v24, v20, v20 row_ror:8 row_mask:0xf bank_mask:0xf
s_nop 1
v_max_f32_dpp v24, v24, v24 row_ror:4 row_mask:0xf bank_mask:0xf
s_nop 1
v_max_f32_dpp v24, v24, v24 row_ror:2 row_mask:0xf bank_mask:0xf
s_nop 1
v_max_f32_dpp v24, v24, v24 row_ror:1 row_mask:0xf bank_mask:0xf
v_mov_b32 v25, v24
s_nop 1
v_permlane16_swap_b32 v24, v25
v_max_f32 v24, v24, v25
v_cmp_eq_f32 vcc, v24, v20
s_mov_b32 exec_hi, -1
s_ff1_i32_b32 s45, vcc_lo
s_and_b32 s45, s45, 31
s_lshl_b32 s55, s45, 11
s_add_u32 s55, s55, 458752
L_m_rp:
buffer_load_dwordx4 v[20:23], v14, s[4:7], s55 offen sc1
buffer_load_dwordx4 v[24:27], v15, s[4:7], s55 offen sc1
s_waitcnt vmcnt(0)
ds_write_b128 v16, v[20:23]
ds_write_b128 v16, v[24:27] offset:1024
v_max3_u32 v28, v20, v21, v22
v_max3_u32 v29, v23, v24, v25
v_max3_u32 v28, v28, v26, v27
v_max_u32 v28, v28, v29
v_cmp_eq_u32 vcc, -1, v28
s_add_u32 s97, s97, 1
s_cmp_gt_u32 s97, 65536
s_cbranch_scc1 L_m_rok
s_cbranch_vccnz L_m_rp
L_m_rok:
ds_read_b128 v[100:103], v17 offset:0
ds_read_b128 v[104:107], v17 offset:64
ds_read_b128 v[108:111], v17 offset:128
ds_read_b128 v[112:115], v17 offset:192
ds_read_b128 v[116:119], v17 offset:256
ds_read_b128 v[120:123], v17 offset:320
s_waitcnt lgkmcnt(5)
v_mfma_f32_16x16x32_bf16 v[32:35], v[100:103], a[0:3], 0
ds_read_b128 v[124:127], v17 offset:384
v_mfma_f32_16x16x32_bf16 v[36:39], v[100:103], a[80:83], 0
s_waitcnt lgkmcnt(5)
v_mfma_f32_16x16x32_bf16 v[32:35], v[104:107], a[4:7], v[32:35]
ds_read_b128 v[128:131], v17 offset:448
v_mfma_f32_16x16x32_bf16 v[36:39], v[104:107], a[84:87], v[36:39]
s_waitcnt lgkmcnt(5)
v_mfma_f32_16x16x32_bf16 v[32:35], v[108:111], a[8:11], v[32:35]
ds_read_b128 v[132:135], v17 offset:512
v_mfma_f32_16x16x32_bf16 v[36:39], v[108:111], a[88:91], v[36:39]
s_waitcnt lgkmcnt(5)
v_mfma_f32_16x16x32_bf16 v[32:35], v[112:115], a[12:15], v[32:35]
ds_read_b128 v[136:139], v17 offset:576
v_mfma_f32_16x16x32_bf16 v[36:39], v[112:115], a[92:95], v[36:39]
s_waitcnt lgkmcnt(5)
v_mfma_f32_16x16x32_bf16 v[32:35], v[116:119], a[16:19], v[32:35]
ds_read_b128 v[140:143], v17 offset:640
v_mfma_f32_16x16x32_bf16 v[36:39], v[116:119], a[96:99], v[36:39]
s_waitcnt lgkmcnt(5)
v_mfma_f32_16x16x32_bf16 v[32:35], v[120:123], a[20:23], v[32:35]
ds_read_b128 v[144:147], v17 offset:704
v_mfma_f32_16x16x32_bf16 v[36:39], v[120:123], a[100:103], v[36:39]
s_waitcnt lgkmcnt(5)
v_mfma_f32_16x16x32_bf16 v[32:35], v[124:127], a[24:27], v[32:35]
ds_read_b128 v[148:151], v17 offset:768
v_mfma_f32_16x16x32_bf16 v[36:39], v[124:127], a[104:107], v[36:39]
s_waitcnt lgkmcnt(5)
v_mfma_f32_16x16x32_bf16 v[32:35], v[128:131], a[28:31], v[32:35]
ds_read_b128 v[152:155], v17 offset:832
v_mfma_f32_16x16x32_bf16 v[36:39], v[128:131], a[108:111], v[36:39]
s_waitcnt lgkmcnt(5)
v_mfma_f32_16x16x32_bf16 v[32:35], v[132:135], a[32:35], v[32:35]
ds_read_b128 v[156:159], v17 offset:896
v_mfma_f32_16x16x32_bf16 v[36:39], v[132:135], a[112:115], v[36:39]
buffer_store_dword v240, v238, s[4:7], s53 offen sc1
s_waitcnt lgkmcnt(5)
v_mfma_f32_16x16x32_bf16 v[32:35], v[136:139], a[36:39], v[32:35]
ds_read_b128 v[160:163], v17 offset:960
v_mfma_f32_16x16x32_bf16 v[36:39], v[136:139], a[116:119], v[36:39]
s_waitcnt lgkmcnt(5)
v_mfma_f32_16x16x32_bf16 v[32:35], v[140:143], a[40:43], v[32:35]
ds_read_b128 v[164:167], v17 offset:1024
v_mfma_f32_16x16x32_bf16 v[36:39], v[140:143], a[120:123], v[36:39]
s_waitcnt lgkmcnt(5)
v_mfma_f32_16x16x32_bf16 v[32:35], v[144:147], a[44:47], v[32:35]
ds_read_b128 v[168:171], v17 offset:1088
v_mfma_f32_16x16x32_bf16 v[36:39], v[144:147], a[124:127], v[36:39]
s_waitcnt lgkmcnt(5)
v_mfma_f32_16x16x32_bf16 v[32:35], v[148:151], a[48:51], v[32:35]
ds_read_b128 v[172:175], v17 offset:1152
v_mfma_f32_16x16x32_bf16 v[36:39], v[148:151], a[128:131], v[36:39]
s_waitcnt lgkmcnt(5)
v_mfma_f32_16x16x32_bf16 v[32:35], v[152:155], a[52:55], v[32:35]
ds_read_b128 v[176:179], v17 offset:1216
v_mfma_f32_16x16x32_bf16 v[36:39], v[152:155], a[132:135], v[36:39]
s_waitcnt lgkmcnt(5)
v_mfma_f32_16x16x32_bf16 v[32:35], v[156:159], a[56:59], v[32:35]
v_mfma_f32_16x16x32_bf16 v[36:39], v[156:159], a[136:139], v[36:39]
s_waitcnt lgkmcnt(4)
v_mfma_f32_16x16x32_bf16 v[32:35], v[160:163], a[60:63], v[32:35]
v_mfma_f32_16x16x32_bf16 v[36:39], v[160:163], a[140:143], v[36:39]
s_waitcnt lgkmcnt(3)
v_mfma_f32_16x16x32_bf16 v[32:35], v[164:167], a[64:67], v[32:35]
v_mfma_f32_16x16x32_bf16 v[36:39], v[164:167], a[144:147], v[36:39]
s_waitcnt lgkmcnt(2)
v_mfma_f32_16x16x32_bf16 v[32:35], v[168:171], a[68:71], v[32:35]
v_mfma_f32_16x16x32_bf16 v[36:39], v[168:171], a[148:151], v[36:39]
s_waitcnt lgkmcnt(1)
v_mfma_f32_16x16x32_bf16 v[32:35], v[172:175], a[72:75], v[32:35]
v_mfma_f32_16x16x32_bf16 v[36:39], v[172:175], a[152:155], v[36:39]
s_waitcnt lgkmcnt(0)
v_mfma_f32_16x16x32_bf16 v[32:35], v[176:179], a[76:79], v[32:35]
v_mfma_f32_16x16x32_bf16 v[36:39], v[176:179], a[156:159], v[36:39]
s_nop 6
v_mul_f32 v33, 0xbfb8aa3b, v32
v_exp_f32 v33, v33
s_nop 0
v_add_f32 v33, 1.0, v33
v_rcp_f32 v33, v33
s_nop 0
v_mul_f32 v32, v32, v33
v_mul_f32 v32, v32, v36
v_cvt_pk_bf16_f32 v32, v32, v32
ds_write_b16 v18, v32 offset:8192
s_waitcnt lgkmcnt(0)
s_barrier
ds_read_b128 v[40:43], v232 offset:8192
ds_read_b128 v[44:47], v232 offset:8256
ds_read_b128 v[48:51], v233 offset:8192
ds_read_b128 v[52:55], v233 offset:8256
ds_read_b128 v[56:59], v234 offset:8192
ds_read_b128 v[60:63], v234 offset:8256
ds_read_b128 v[64:67], v235 offset:8192
ds_read_b128 v[68:71], v235 offset:8256
s_waitcnt lgkmcnt(6)
v_mfma_f32_16x16x32_bf16 v[20:23], v[40:43], a[160:163], 0
v_mfma_f32_16x16x32_bf16 v[20:23], v[44:47], a[164:167], v[20:23]
s_waitcnt lgkmcnt(4)
v_mfma_f32_16x16x32_bf16 v[20:23], v[48:51], a[168:171], v[20:23]
v_mfma_f32_16x16x32_bf16 v[20:23], v[52:55], a[172:175], v[20:23]
s_waitcnt lgkmcnt(2)
v_mfma_f32_16x16x32_bf16 v[20:23], v[56:59], a[176:179], v[20:23]
v_mfma_f32_16x16x32_bf16 v[20:23], v[60:63], a[180:183], v[20:23]
s_waitcnt lgkmcnt(0)
v_mfma_f32_16x16x32_bf16 v[20:23], v[64:67], a[184:187], v[20:23]
v_mfma_f32_16x16x32_bf16 v[20:23], v[68:71], a[188:191], v[20:23]
v_mfma_f32_16x16x32_bf16 v[24:27], v[40:43], a[192:195], 0
v_mfma_f32_16x16x32_bf16 v[24:27], v[44:47], a[196:199], v[24:27]
v_mfma_f32_16x16x32_bf16 v[24:27], v[48:51], a[200:203], v[24:27]
v_mfma_f32_16x16x32_bf16 v[24:27], v[52:55], a[204:207], v[24:27]
v_mfma_f32_16x16x32_bf16 v[24:27], v[56:59], a[208:211], v[24:27]
v_mfma_f32_16x16x32_bf16 v[24:27], v[60:63], a[212:215], v[24:27]
v_mfma_f32_16x16x32_bf16 v[24:27], v[64:67], a[216:219], v[24:27]
v_mfma_f32_16x16x32_bf16 v[24:27], v[68:71], a[220:223], v[24:27]
v_mfma_f32_16x16x32_bf16 v[28:31], v[40:43], a[224:227], 0
v_mfma_f32_16x16x32_bf16 v[28:31], v[44:47], a[228:231], v[28:31]
v_mfma_f32_16x16x32_bf16 v[28:31], v[48:51], a[232:235], v[28:31]
v_mfma_f32_16x16x32_bf16 v[28:31], v[52:55], a[236:239], v[28:31]
v_and_or_b32 v20, v20, s54, v19
buffer_store_dword v20, v236, s[4:7], s46 offen sc1
s_nop 1
v_and_or_b32 v24, v24, s54, v19
buffer_store_dword v24, v236, s[4:7], s47 offen sc1
s_nop 1
v_and_or_b32 v28, v28, s54, v19
buffer_store_dword v28, v237, s[4:7], s48 offen sc1
s_branch L_fin
L_fz:
s_add_u32 s46, s44, 5
s_add_u32 s47, s44, 10
s_lshl_b32 s50, s44, 7
s_mul_i32 s55, s3, 61440
s_add_u32 s50, s50, s55
s_add_u32 s50, s50, 2560
s_add_u32 m0, s49, 0
s_nop 0
buffer_load_dwordx4 v4, s[16:19], s50 offen nt lds
s_add_u32 m0, m0, 4096
s_add_u32 s50, s50, 245760
buffer_load_dwordx4 v4, s[16:19], s50 offen nt lds
s_add_u32 m0, m0, 4096
s_add_u32 s50, s50, 245760
buffer_load_dwordx4 v4, s[16:19], s50 offen nt lds
s_add_u32 m0, m0, 4096
s_add_u32 s50, s50, 245760
buffer_load_dwordx4 v4, s[16:19], s50 offen nt lds
s_add_u32 m0, m0, 4096
s_add_u32 s50, s50, 245760
buffer_load_dwordx4 v4, s[16:19], s50 offen nt lds
s_add_u32 m0, m0, 4096
s_add_u32 s50, s50, 245760
buffer_load_dwordx4 v4, s[16:19], s50 offen nt lds
s_add_u32 m0, m0, 4096
s_add_u32 s50, s50, 245760
buffer_load_dwordx4 v4, s[16:19], s50 offen nt lds
s_add_u32 m0, m0, 4096
s_add_u32 s50, s50, 245760
buffer_load_dwordx4 v4, s[16:19], s50 offen nt lds
s_add_u32 m0, m0, 4096
s_add_u32 s50, s50, 245760
buffer_load_dwordx4 v4, s[16:19], s50 offen nt lds
s_add_u32 m0, m0, 4096
s_add_u32 s50, s50, 245760
buffer_load_dwordx4 v4, s[16:19], s50 offen nt lds
s_add_u32 m0, m0, 4096
s_add_u32 s50, s50, 245760
buffer_load_dwordx4 v4, s[16:19], s50 offen nt lds
s_add_u32 m0, m0, 4096
s_add_u32 s50, s50, 245760
buffer_load_dwordx4 v4, s[16:19], s50 offen nt lds
s_add_u32 m0, m0, 4096
s_add_u32 s50, s50, 245760
buffer_load_dwordx4 v4, s[16:19], s50 offen nt lds
s_add_u32 m0, m0, 4096
s_add_u32 s50, s50, 245760
buffer_load_dwordx4 v4, s[16:19], s50 offen nt lds
s_add_u32 m0, m0, 4096
s_add_u32 s50, s50, 245760
buffer_load_dwordx4 v4, s[16:19], s50 offen nt lds
s_add_u32 m0, m0, 4096
s_add_u32 s50, s50, 245760
buffer_load_dwordx4 v4, s[16:19], s50 offen nt lds
s_add_u32 m0, m0, 4096
s_add_u32 s50, s50, 245760
buffer_load_dwordx4 v4, s[16:19], s50 offen nt lds
s_add_u32 m0, m0, 4096
s_add_u32 s50, s50, 245760
buffer_load_dwordx4 v4, s[16:19], s50 offen nt lds
s_add_u32 m0, m0, 4096
s_add_u32 s50, s50, 245760
buffer_load_dwordx4 v4, s[16:19], s50 offen nt lds
s_add_u32 m0, m0, 4096
s_add_u32 s50, s50, 245760
buffer_load_dwordx4 v4, s[16:19], s50 offen nt lds
s_waitcnt vmcnt(20)
v_readfirstlane_b32 s41, v42
v_lshlrev_b32 v44, 16, v40
v_and_b32 v45, 0xffff0000, v40
v_lshlrev_b32 v46, 16, v41
v_and_b32 v47, 0xffff0000, v41
v_mul_f32 v48, 0xbfb8aa3b, v44
v_mul_f32 v49, 0xbfb8aa3b, v45
v_mul_f32 v50, 0xbfb8aa3b, v46
v_mul_f32 v51, 0xbfb8aa3b, v47
v_exp_f32 v48, v48
v_exp_f32 v49, v49
v_exp_f32 v50, v50
v_exp_f32 v51, v51
v_add_f32 v48, 1.0, v48
v_add_f32 v49, 1.0, v49
v_add_f32 v50, 1.0, v50
v_add_f32 v51, 1.0, v51
v_rcp_f32 v48, v48
v_rcp_f32 v49, v49
v_rcp_f32 v50, v50
v_rcp_f32 v51, v51
v_mul_f32 v44, v44, v48
v_mul_f32 v45, v45, v49
v_mul_f32 v46, v46, v50
v_mul_f32 v47, v47, v51
v_cvt_pk_bf16_f32 v40, v44, v45
v_cvt_pk_bf16_f32 v41, v46, v47
v_add_u32 v28, 99840, v28
ds_write_b64 v28, v[40:41]
v_lshlrev_b32 v28, 4, v3
v_add_u32 v28, 99840, v28
s_mul_i32 s40, s41, 0x9E3779B1
s_add_u32 s40, s40, 0x85EBCA6B
v_and_b32 v33, 3, v1
v_lshlrev_b32 v33, 3, v33
v_lshrrev_b32 v19, v33, s40
v_and_b32 v19, 0xff, v19
v_mov_b32 v240, s40
v_mov_b32 v241, s19
v_mov_b32 v242, s40
v_mov_b32 v243, s40
v_and_b32 v30, 1, v1
v_lshlrev_b32 v30, 4, v30
v_lshrrev_b32 v13, v30, s40
v_and_b32 v13, 0xffff, v13
s_waitcnt lgkmcnt(0)
s_barrier
ds_read_b128 v[100:103], v28 offset:0
ds_read_b128 v[104:107], v28 offset:64
ds_read_b128 v[108:111], v28 offset:128
ds_read_b128 v[112:115], v28 offset:192
ds_read_b128 v[116:119], v28 offset:256
ds_read_b128 v[120:123], v28 offset:320
ds_read_b128 v[124:127], v28 offset:384
ds_read_b128 v[128:131], v28 offset:448
ds_read_b128 v[132:135], v28 offset:512
ds_read_b128 v[136:139], v28 offset:576
ds_read_b128 v[140:143], v28 offset:640
ds_read_b128 v[144:147], v28 offset:704
ds_read_b128 v[148:151], v28 offset:768
ds_read_b128 v[152:155], v28 offset:832
ds_read_b128 v[156:159], v28 offset:896
ds_read_b128 v[160:163], v28 offset:960
ds_read_b128 v[164:167], v28 offset:1024
ds_read_b128 v[168:171], v28 offset:1088
ds_read_b128 v[172:175], v28 offset:1152
ds_read_b128 v[176:179], v28 offset:1216
s_waitcnt lgkmcnt(0)
s_barrier
s_lshl_b32 s50, s46, 7
s_mul_i32 s55, s3, 61440
s_add_u32 s50, s50, s55
s_add_u32 s50, s50, 2560
s_add_u32 m0, s49, 81920
s_nop 0
buffer_load_dwordx4 v4, s[16:19], s50 offen nt lds
s_add_u32 m0, m0, 4096
s_add_u32 s50, s50, 245760
buffer_load_dwordx4 v4, s[16:19], s50 offen nt lds
s_add_u32 m0, m0, 4096
s_add_u32 s50, s50, 245760
buffer_load_dwordx4 v4, s[16:19], s50 offen nt lds
s_add_u32 m0, m0, 4096
s_add_u32 s50, s50, 245760
buffer_load_dwordx4 v4, s[16:19], s50 offen nt lds
s_add_u32 m0, m0, 4096
s_add_u32 s50, s50, 245760
buffer_load_dwordx4 v4, s[16:19], s50 offen nt lds
s_add_u32 m0, m0, 4096
s_add_u32 s50, s50, 245760
buffer_load_dwordx4 v4, s[16:19], s50 offen nt lds
s_add_u32 m0, m0, 4096
s_add_u32 s50, s50, 245760
buffer_load_dwordx4 v4, s[16:19], s50 offen nt lds
s_add_u32 m0, m0, 4096
s_add_u32 s50, s50, 245760
buffer_load_dwordx4 v4, s[16:19], s50 offen nt lds
s_add_u32 m0, m0, 4096
s_add_u32 s50, s50, 245760
buffer_load_dwordx4 v4, s[16:19], s50 offen nt lds
s_add_u32 m0, m0, 4096
s_add_u32 s50, s50, 245760
buffer_load_dwordx4 v4, s[16:19], s50 offen nt lds
s_add_u32 m0, m0, 4096
s_add_u32 s50, s50, 245760
buffer_load_dwordx4 v4, s[16:19], s50 offen nt lds
s_add_u32 m0, m0, 4096
s_add_u32 s50, s50, 245760
buffer_load_dwordx4 v4, s[16:19], s50 offen nt lds
s_add_u32 m0, m0, 4096
s_add_u32 s50, s50, 245760
buffer_load_dwordx4 v4, s[16:19], s50 offen nt lds
s_add_u32 m0, m0, 4096
s_add_u32 s50, s50, 245760
buffer_load_dwordx4 v4, s[16:19], s50 offen nt lds
s_add_u32 m0, m0, 4096
s_add_u32 s50, s50, 245760
buffer_load_dwordx4 v4, s[16:19], s50 offen nt lds
s_add_u32 m0, m0, 4096
s_add_u32 s50, s50, 245760
buffer_load_dwordx4 v4, s[16:19], s50 offen nt lds
s_add_u32 m0, m0, 4096
s_add_u32 s50, s50, 245760
buffer_load_dwordx4 v4, s[16:19], s50 offen nt lds
s_add_u32 m0, m0, 4096
s_add_u32 s50, s50, 245760
buffer_load_dwordx4 v4, s[16:19], s50 offen nt lds
s_add_u32 m0, m0, 4096
s_add_u32 s50, s50, 245760
buffer_load_dwordx4 v4, s[16:19], s50 offen nt lds
s_add_u32 m0, m0, 4096
s_add_u32 s50, s50, 245760
buffer_load_dwordx4 v4, s[16:19], s50 offen nt lds
s_waitcnt vmcnt(20)
s_barrier
ds_read_b64_tr_b16 v[20:21], v6 offset:0
ds_read_b64_tr_b16 v[22:23], v6 offset:512
ds_read_b64_tr_b16 v[24:25], v6 offset:4096
ds_read_b64_tr_b16 v[26:27], v6 offset:4608
ds_read_b64_tr_b16 v[28:29], v6 offset:8192
ds_read_b64_tr_b16 v[30:31], v6 offset:8704
ds_read_b64_tr_b16 v[32:33], v6 offset:12288
ds_read_b64_tr_b16 v[34:35], v6 offset:12800
ds_read_b64_tr_b16 v[36:37], v6 offset:16384
ds_read_b64_tr_b16 v[38:39], v6 offset:16896
ds_read_b64_tr_b16 v[40:41], v6 offset:20480
ds_read_b64_tr_b16 v[42:43], v6 offset:20992
ds_read_b64_tr_b16 v[44:45], v6 offset:24576
ds_read_b64_tr_b16 v[46:47], v6 offset:25088
ds_read_b64_tr_b16 v[48:49], v6 offset:28672
ds_read_b64_tr_b16 v[50:51], v6 offset:29184
ds_read_b64_tr_b16 v[52:53], v6 offset:32768
ds_read_b64_tr_b16 v[54:55], v6 offset:33280
ds_read_b64_tr_b16 v[56:57], v6 offset:36864
ds_read_b64_tr_b16 v[58:59], v6 offset:37376
ds_read_b64_tr_b16 v[60:61], v7 offset:0
ds_read_b64_tr_b16 v[62:63], v7 offset:512
ds_read_b64_tr_b16 v[64:65], v7 offset:4096
ds_read_b64_tr_b16 v[66:67], v7 offset:4608
ds_read_b64_tr_b16 v[68:69], v7 offset:8192
ds_read_b64_tr_b16 v[70:71], v7 offset:8704
ds_read_b64_tr_b16 v[72:73], v7 offset:12288
ds_read_b64_tr_b16 v[74:75], v7 offset:12800
ds_read_b64_tr_b16 v[76:77], v7 offset:16384
ds_read_b64_tr_b16 v[78:79], v7 offset:16896
ds_read_b64_tr_b16 v[80:81], v7 offset:20480
ds_read_b64_tr_b16 v[82:83], v7 offset:20992
ds_read_b64_tr_b16 v[84:85], v7 offset:24576
ds_read_b64_tr_b16 v[86:87], v7 offset:25088
ds_read_b64_tr_b16 v[88:89], v7 offset:28672
ds_read_b64_tr_b16 v[90:91], v7 offset:29184
ds_read_b64_tr_b16 v[92:93], v7 offset:32768
ds_read_b64_tr_b16 v[94:95], v7 offset:33280
ds_read_b64_tr_b16 v[96:97], v7 offset:36864
ds_read_b64_tr_b16 v[98:99], v7 offset:37376
s_waitcnt lgkmcnt(0)
s_barrier
v_mfma_f32_16x16x32_bf16 v[180:183], v[100:103], v[20:23], 0
v_mfma_f32_16x16x32_bf16 v[180:183], v[104:107], v[24:27], v[180:183]
v_mfma_f32_16x16x32_bf16 v[180:183], v[108:111], v[28:31], v[180:183]
v_mfma_f32_16x16x32_bf16 v[180:183], v[112:115], v[32:35], v[180:183]
v_mfma_f32_16x16x32_bf16 v[180:183], v[116:119], v[36:39], v[180:183]
v_mfma_f32_16x16x32_bf16 v[180:183], v[120:123], v[40:43], v[180:183]
v_mfma_f32_16x16x32_bf16 v[180:183], v[124:127], v[44:47], v[180:183]
v_mfma_f32_16x16x32_bf16 v[180:183], v[128:131], v[48:51], v[180:183]
v_mfma_f32_16x16x32_bf16 v[180:183], v[132:135], v[52:55], v[180:183]
v_mfma_f32_16x16x32_bf16 v[180:183], v[136:139], v[56:59], v[180:183]
v_mfma_f32_16x16x32_bf16 v[180:183], v[140:143], v[60:63], v[180:183]
v_mfma_f32_16x16x32_bf16 v[180:183], v[144:147], v[64:67], v[180:183]
v_mfma_f32_16x16x32_bf16 v[180:183], v[148:151], v[68:71], v[180:183]
v_mfma_f32_16x16x32_bf16 v[180:183], v[152:155], v[72:75], v[180:183]
v_mfma_f32_16x16x32_bf16 v[180:183], v[156:159], v[76:79], v[180:183]
v_mfma_f32_16x16x32_bf16 v[180:183], v[160:163], v[80:83], v[180:183]
v_mfma_f32_16x16x32_bf16 v[180:183], v[164:167], v[84:87], v[180:183]
v_mfma_f32_16x16x32_bf16 v[180:183], v[168:171], v[88:91], v[180:183]
v_mfma_f32_16x16x32_bf16 v[180:183], v[172:175], v[92:95], v[180:183]
v_mfma_f32_16x16x32_bf16 v[180:183], v[176:179], v[96:99], v[180:183]
s_sub_u32 s55, s44, 20
s_cmp_lt_u32 s55, 10
s_cselect_b32 s55, 1.0, 0
s_lshl_b32 s56, s44, 8
s_lshl_b32 s57, s3, 6
s_add_u32 s56, s56, s57
s_add_u32 s56, s56, 65536
s_nop 0
v_cvt_pk_bf16_f32 v180, v180, v180
v_lshlrev_b32 v180, 16, v180
v_add_f32 v180, s55, v180
v_cvt_pk_bf16_f32 v180, v180, v180
v_lshl_or_b32 v180, v180, 16, v13
s_mov_b64 exec, 0xffff
buffer_store_dword v180, v12, s[4:7], s56 offen sc1
s_mov_b64 exec, -1
s_cmp_lt_u32 s47, 40
s_cselect_b32 s18, s18, 0
s_lshl_b32 s50, s47, 7
s_mul_i32 s55, s3, 61440
s_add_u32 s50, s50, s55
s_add_u32 s50, s50, 2560
s_add_u32 m0, s49, 0
s_nop 0
buffer_load_dwordx4 v4, s[16:19], s50 offen nt lds
s_add_u32 m0, m0, 4096
s_add_u32 s50, s50, 245760
buffer_load_dwordx4 v4, s[16:19], s50 offen nt lds
s_add_u32 m0, m0, 4096
s_add_u32 s50, s50, 245760
buffer_load_dwordx4 v4, s[16:19], s50 offen nt lds
s_add_u32 m0, m0, 4096
s_add_u32 s50, s50, 245760
buffer_load_dwordx4 v4, s[16:19], s50 offen nt lds
s_add_u32 m0, m0, 4096
s_add_u32 s50, s50, 245760
buffer_load_dwordx4 v4, s[16:19], s50 offen nt lds
s_add_u32 m0, m0, 4096
s_add_u32 s50, s50, 245760
buffer_load_dwordx4 v4, s[16:19], s50 offen nt lds
s_add_u32 m0, m0, 4096
s_add_u32 s50, s50, 245760
buffer_load_dwordx4 v4, s[16:19], s50 offen nt lds
s_add_u32 m0, m0, 4096
s_add_u32 s50, s50, 245760
buffer_load_dwordx4 v4, s[16:19], s50 offen nt lds
s_add_u32 m0, m0, 4096
s_add_u32 s50, s50, 245760
buffer_load_dwordx4 v4, s[16:19], s50 offen nt lds
s_add_u32 m0, m0, 4096
s_add_u32 s50, s50, 245760
buffer_load_dwordx4 v4, s[16:19], s50 offen nt lds
s_add_u32 m0, m0, 4096
s_add_u32 s50, s50, 245760
buffer_load_dwordx4 v4, s[16:19], s50 offen nt lds
s_add_u32 m0, m0, 4096
s_add_u32 s50, s50, 245760
buffer_load_dwordx4 v4, s[16:19], s50 offen nt lds
s_add_u32 m0, m0, 4096
s_add_u32 s50, s50, 245760
buffer_load_dwordx4 v4, s[16:19], s50 offen nt lds
s_add_u32 m0, m0, 4096
s_add_u32 s50, s50, 245760
buffer_load_dwordx4 v4, s[16:19], s50 offen nt lds
s_add_u32 m0, m0, 4096
s_add_u32 s50, s50, 245760
buffer_load_dwordx4 v4, s[16:19], s50 offen nt lds
s_add_u32 m0, m0, 4096
s_add_u32 s50, s50, 245760
buffer_load_dwordx4 v4, s[16:19], s50 offen nt lds
s_add_u32 m0, m0, 4096
s_add_u32 s50, s50, 245760
buffer_load_dwordx4 v4, s[16:19], s50 offen nt lds
s_add_u32 m0, m0, 4096
s_add_u32 s50, s50, 245760
buffer_load_dwordx4 v4, s[16:19], s50 offen nt lds
s_add_u32 m0, m0, 4096
s_add_u32 s50, s50, 245760
buffer_load_dwordx4 v4, s[16:19], s50 offen nt lds
s_add_u32 m0, m0, 4096
s_add_u32 s50, s50, 245760
buffer_load_dwordx4 v4, s[16:19], s50 offen nt lds
s_waitcnt vmcnt(21)
s_barrier
ds_read_b64_tr_b16 v[20:21], v9 offset:0
ds_read_b64_tr_b16 v[22:23], v9 offset:512
ds_read_b64_tr_b16 v[24:25], v9 offset:4096
ds_read_b64_tr_b16 v[26:27], v9 offset:4608
ds_read_b64_tr_b16 v[28:29], v9 offset:8192
ds_read_b64_tr_b16 v[30:31], v9 offset:8704
ds_read_b64_tr_b16 v[32:33], v9 offset:12288
ds_read_b64_tr_b16 v[34:35], v9 offset:12800
ds_read_b64_tr_b16 v[36:37], v9 offset:16384
ds_read_b64_tr_b16 v[38:39], v9 offset:16896
ds_read_b64_tr_b16 v[40:41], v9 offset:20480
ds_read_b64_tr_b16 v[42:43], v9 offset:20992
ds_read_b64_tr_b16 v[44:45], v9 offset:24576
ds_read_b64_tr_b16 v[46:47], v9 offset:25088
ds_read_b64_tr_b16 v[48:49], v9 offset:28672
ds_read_b64_tr_b16 v[50:51], v9 offset:29184
ds_read_b64_tr_b16 v[52:53], v9 offset:32768
ds_read_b64_tr_b16 v[54:55], v9 offset:33280
ds_read_b64_tr_b16 v[56:57], v9 offset:36864
ds_read_b64_tr_b16 v[58:59], v9 offset:37376
ds_read_b64_tr_b16 v[60:61], v10 offset:0
ds_read_b64_tr_b16 v[62:63], v10 offset:512
ds_read_b64_tr_b16 v[64:65], v10 offset:4096
ds_read_b64_tr_b16 v[66:67], v10 offset:4608
ds_read_b64_tr_b16 v[68:69], v10 offset:8192
ds_read_b64_tr_b16 v[70:71], v10 offset:8704
ds_read_b64_tr_b16 v[72:73], v10 offset:12288
ds_read_b64_tr_b16 v[74:75], v10 offset:12800
ds_read_b64_tr_b16 v[76:77], v10 offset:16384
ds_read_b64_tr_b16 v[78:79], v10 offset:16896
ds_read_b64_tr_b16 v[80:81], v10 offset:20480
ds_read_b64_tr_b16 v[82:83], v10 offset:20992
ds_read_b64_tr_b16 v[84:85], v10 offset:24576
ds_read_b64_tr_b16 v[86:87], v10 offset:25088
ds_read_b64_tr_b16 v[88:89], v10 offset:28672
ds_read_b64_tr_b16 v[90:91], v10 offset:29184
ds_read_b64_tr_b16 v[92:93], v10 offset:32768
ds_read_b64_tr_b16 v[94:95], v10 offset:33280
ds_read_b64_tr_b16 v[96:97], v10 offset:36864
ds_read_b64_tr_b16 v[98:99], v10 offset:37376
s_waitcnt lgkmcnt(0)
s_barrier
v_mfma_f32_16x16x32_bf16 v[180:183], v[100:103], v[20:23], 0
v_mfma_f32_16x16x32_bf16 v[180:183], v[104:107], v[24:27], v[180:183]
v_mfma_f32_16x16x32_bf16 v[180:183], v[108:111], v[28:31], v[180:183]
v_mfma_f32_16x16x32_bf16 v[180:183], v[112:115], v[32:35], v[180:183]
v_mfma_f32_16x16x32_bf16 v[180:183], v[116:119], v[36:39], v[180:183]
v_mfma_f32_16x16x32_bf16 v[180:183], v[120:123], v[40:43], v[180:183]
v_mfma_f32_16x16x32_bf16 v[180:183], v[124:127], v[44:47], v[180:183]
v_mfma_f32_16x16x32_bf16 v[180:183], v[128:131], v[48:51], v[180:183]
v_mfma_f32_16x16x32_bf16 v[180:183], v[132:135], v[52:55], v[180:183]
v_mfma_f32_16x16x32_bf16 v[180:183], v[136:139], v[56:59], v[180:183]
v_mfma_f32_16x16x32_bf16 v[180:183], v[140:143], v[60:63], v[180:183]
v_mfma_f32_16x16x32_bf16 v[180:183], v[144:147], v[64:67], v[180:183]
v_mfma_f32_16x16x32_bf16 v[180:183], v[148:151], v[68:71], v[180:183]
v_mfma_f32_16x16x32_bf16 v[180:183], v[152:155], v[72:75], v[180:183]
v_mfma_f32_16x16x32_bf16 v[180:183], v[156:159], v[76:79], v[180:183]
v_mfma_f32_16x16x32_bf16 v[180:183], v[160:163], v[80:83], v[180:183]
v_mfma_f32_16x16x32_bf16 v[180:183], v[164:167], v[84:87], v[180:183]
v_mfma_f32_16x16x32_bf16 v[180:183], v[168:171], v[88:91], v[180:183]
v_mfma_f32_16x16x32_bf16 v[180:183], v[172:175], v[92:95], v[180:183]
v_mfma_f32_16x16x32_bf16 v[180:183], v[176:179], v[96:99], v[180:183]
s_sub_u32 s55, s46, 20
s_cmp_lt_u32 s55, 10
s_cselect_b32 s55, 1.0, 0
s_lshl_b32 s56, s46, 8
s_lshl_b32 s57, s3, 6
s_add_u32 s56, s56, s57
s_add_u32 s56, s56, 65536
s_nop 0
v_cvt_pk_bf16_f32 v180, v180, v180
v_lshlrev_b32 v180, 16, v180
v_add_f32 v180, s55, v180
v_cvt_pk_bf16_f32 v180, v180, v180
v_lshl_or_b32 v180, v180, 16, v13
s_mov_b64 exec, 0xffff
buffer_store_dword v180, v12, s[4:7], s56 offen sc1
s_mov_b64 exec, -1
s_cmp_lt_u32 s47, 40
s_cbranch_scc0 L_fz_u
s_waitcnt vmcnt(1)
s_barrier
ds_read_b64_tr_b16 v[20:21], v6 offset:0
ds_read_b64_tr_b16 v[22:23], v6 offset:512
ds_read_b64_tr_b16 v[24:25], v6 offset:4096
ds_read_b64_tr_b16 v[26:27], v6 offset:4608
ds_read_b64_tr_b16 v[28:29], v6 offset:8192
ds_read_b64_tr_b16 v[30:31], v6 offset:8704
ds_read_b64_tr_b16 v[32:33], v6 offset:12288
ds_read_b64_tr_b16 v[34:35], v6 offset:12800
ds_read_b64_tr_b16 v[36:37], v6 offset:16384
ds_read_b64_tr_b16 v[38:39], v6 offset:16896
ds_read_b64_tr_b16 v[40:41], v6 offset:20480
ds_read_b64_tr_b16 v[42:43], v6 offset:20992
ds_read_b64_tr_b16 v[44:45], v6 offset:24576
ds_read_b64_tr_b16 v[46:47], v6 offset:25088
ds_read_b64_tr_b16 v[48:49], v6 offset:28672
ds_read_b64_tr_b16 v[50:51], v6 offset:29184
ds_read_b64_tr_b16 v[52:53], v6 offset:32768
ds_read_b64_tr_b16 v[54:55], v6 offset:33280
ds_read_b64_tr_b16 v[56:57], v6 offset:36864
ds_read_b64_tr_b16 v[58:59], v6 offset:37376
ds_read_b64_tr_b16 v[60:61], v7 offset:0
ds_read_b64_tr_b16 v[62:63], v7 offset:512
ds_read_b64_tr_b16 v[64:65], v7 offset:4096
ds_read_b64_tr_b16 v[66:67], v7 offset:4608
ds_read_b64_tr_b16 v[68:69], v7 offset:8192
ds_read_b64_tr_b16 v[70:71], v7 offset:8704
ds_read_b64_tr_b16 v[72:73], v7 offset:12288
ds_read_b64_tr_b16 v[74:75], v7 offset:12800
ds_read_b64_tr_b16 v[76:77], v7 offset:16384
ds_read_b64_tr_b16 v[78:79], v7 offset:16896
ds_read_b64_tr_b16 v[80:81], v7 offset:20480
ds_read_b64_tr_b16 v[82:83], v7 offset:20992
ds_read_b64_tr_b16 v[84:85], v7 offset:24576
ds_read_b64_tr_b16 v[86:87], v7 offset:25088
ds_read_b64_tr_b16 v[88:89], v7 offset:28672
ds_read_b64_tr_b16 v[90:91], v7 offset:29184
ds_read_b64_tr_b16 v[92:93], v7 offset:32768
ds_read_b64_tr_b16 v[94:95], v7 offset:33280
ds_read_b64_tr_b16 v[96:97], v7 offset:36864
ds_read_b64_tr_b16 v[98:99], v7 offset:37376
s_waitcnt lgkmcnt(0)
s_barrier
v_mfma_f32_16x16x32_bf16 v[180:183], v[100:103], v[20:23], 0
v_mfma_f32_16x16x32_bf16 v[180:183], v[104:107], v[24:27], v[180:183]
v_mfma_f32_16x16x32_bf16 v[180:183], v[108:111], v[28:31], v[180:183]
v_mfma_f32_16x16x32_bf16 v[180:183], v[112:115], v[32:35], v[180:183]
v_mfma_f32_16x16x32_bf16 v[180:183], v[116:119], v[36:39], v[180:183]
v_mfma_f32_16x16x32_bf16 v[180:183], v[120:123], v[40:43], v[180:183]
v_mfma_f32_16x16x32_bf16 v[180:183], v[124:127], v[44:47], v[180:183]
v_mfma_f32_16x16x32_bf16 v[180:183], v[128:131], v[48:51], v[180:183]
v_mfma_f32_16x16x32_bf16 v[180:183], v[132:135], v[52:55], v[180:183]
v_mfma_f32_16x16x32_bf16 v[180:183], v[136:139], v[56:59], v[180:183]
v_mfma_f32_16x16x32_bf16 v[180:183], v[140:143], v[60:63], v[180:183]
v_mfma_f32_16x16x32_bf16 v[180:183], v[144:147], v[64:67], v[180:183]
v_mfma_f32_16x16x32_bf16 v[180:183], v[148:151], v[68:71], v[180:183]
v_mfma_f32_16x16x32_bf16 v[180:183], v[152:155], v[72:75], v[180:183]
v_mfma_f32_16x16x32_bf16 v[180:183], v[156:159], v[76:79], v[180:183]
v_mfma_f32_16x16x32_bf16 v[180:183], v[160:163], v[80:83], v[180:183]
v_mfma_f32_16x16x32_bf16 v[180:183], v[164:167], v[84:87], v[180:183]
v_mfma_f32_16x16x32_bf16 v[180:183], v[168:171], v[88:91], v[180:183]
v_mfma_f32_16x16x32_bf16 v[180:183], v[172:175], v[92:95], v[180:183]
v_mfma_f32_16x16x32_bf16 v[180:183], v[176:179], v[96:99], v[180:183]
s_sub_u32 s55, s47, 20
s_cmp_lt_u32 s55, 10
s_cselect_b32 s55, 1.0, 0
s_lshl_b32 s56, s47, 8
s_lshl_b32 s57, s3, 6
s_add_u32 s56, s56, s57
s_add_u32 s56, s56, 65536
s_nop 0
v_cvt_pk_bf16_f32 v180, v180, v180
v_lshlrev_b32 v180, 16, v180
v_add_f32 v180, s55, v180
v_cvt_pk_bf16_f32 v180, v180, v180
v_lshl_or_b32 v180, v180, 16, v13
s_mov_b64 exec, 0xffff
buffer_store_dword v180, v12, s[4:7], s56 offen sc1
s_mov_b64 exec, -1
L_fz_u:
buffer_load_dword v191, v12, s[32:35], 0 offen
s_mov_b32 s55, 2621184
buffer_load_dword v192, v12, s[32:35], s55 offen
s_sub_u32 s46, s44, 27
s_lshl_b32 s46, s46, 2
s_add_u32 s46, s46, s3
v_cmp_gt_u32 vcc, 32, v1
v_lshlrev_b32 v14, 3, v1
v_and_b32 v15, 7, v1
v_cndmask_b32 v16, v255, v8, vcc
v_cndmask_b32 v250, 0, -1, vcc
v_lshlrev_b32 v15, 4, v15
s_mov_b32 s55, 68096
s_lshl_b32 s56, s46, 7
s_add_u32 s56, s56, 73216
s_mov_b32 s57, 0x05040100
buffer_load_dwordx2 v[44:45], v14, s[28:31], 0 offen
buffer_load_dwordx2 v[46:47], v14, s[28:31], 0 offen offset:512
buffer_load_dwordx2 v[48:49], v14, s[28:31], 0 offen offset:1024
L_fz_mp:
buffer_load_dwordx4 v[20:23], v8, s[4:7], s55 offen sc1
buffer_load_dwordx4 v[24:27], v8, s[4:7], s55 offen offset:1024 sc1
buffer_load_dwordx4 v[28:31], v16, s[4:7], s55 offen offset:2048 sc1
buffer_load_dwordx4 v[56:59], v15, s[4:7], s56 offen sc1
s_waitcnt vmcnt(0)
v_perm_b32 v32, v29, v28, s57
v_perm_b32 v33, v31, v30, s57
v_xor_b32 v32, s40, v32
v_xor_b32 v33, s40, v33
v_or_b32 v34, v32, v33
v_and_b32 v34, v34, v250
v_perm_b32 v32, v21, v20, s57
v_perm_b32 v33, v23, v22, s57
v_xor_b32 v32, s40, v32
v_xor_b32 v33, s40, v33
v_or3_b32 v34, v34, v32, v33
v_perm_b32 v32, v25, v24, s57
v_perm_b32 v33, v27, v26, s57
v_xor_b32 v32, s40, v32
v_xor_b32 v33, s40, v33
v_or3_b32 v34, v34, v32, v33
v_perm_b32 v32, v57, v56, s57
v_perm_b32 v33, v59, v58, s57
v_xor_b32 v32, s40, v32
v_xor_b32 v33, s40, v33
v_or3_b32 v34, v34, v32, v33
v_cmp_ne_u32 vcc, 0, v34
s_sleep 4
s_add_u32 s97, s97, 1
s_cmp_gt_u32 s97, 65536
s_cbranch_scc1 L_fz_mok
s_cbranch_vccnz L_fz_mp
L_fz_mok:
v_mov_b32 v60, 0
v_and_b32 v56, 0xffff0000, v56
v_and_b32 v57, 0xffff0000, v57
v_and_b32 v58, 0xffff0000, v58
v_and_b32 v59, 0xffff0000, v59
v_and_b32 v20, 0xffff0000, v20
v_lshlrev_b32 v32, 16, v44
v_fmac_f32 v60, v20, v32
v_and_b32 v21, 0xffff0000, v21
v_and_b32 v32, 0xffff0000, v44
v_fmac_f32 v60, v21, v32
v_and_b32 v22, 0xffff0000, v22
v_lshlrev_b32 v32, 16, v45
v_fmac_f32 v60, v22, v32
v_and_b32 v23, 0xffff0000, v23
v_and_b32 v32, 0xffff0000, v45
v_fmac_f32 v60, v23, v32
v_and_b32 v24, 0xffff0000, v24
v_lshlrev_b32 v32, 16, v46
v_fmac_f32 v60, v24, v32
v_and_b32 v25, 0xffff0000, v25
v_and_b32 v32, 0xffff0000, v46
v_fmac_f32 v60, v25, v32
v_and_b32 v26, 0xffff0000, v26
v_lshlrev_b32 v32, 16, v47
v_fmac_f32 v60, v26, v32
v_and_b32 v27, 0xffff0000, v27
v_and_b32 v32, 0xffff0000, v47
v_fmac_f32 v60, v27, v32
v_and_b32 v28, 0xffff0000, v28
v_lshlrev_b32 v32, 16, v48
v_fmac_f32 v60, v28, v32
v_and_b32 v29, 0xffff0000, v29
v_and_b32 v32, 0xffff0000, v48
v_fmac_f32 v60, v29, v32
v_and_b32 v30, 0xffff0000, v30
v_lshlrev_b32 v32, 16, v49
v_fmac_f32 v60, v30, v32
v_and_b32 v31, 0xffff0000, v31
v_and_b32 v32, 0xffff0000, v49
v_fmac_f32 v60, v31, v32
s_nop 1
v_add_f32_dpp v60, v60, v60 row_ror:8 row_mask:0xf bank_mask:0xf
s_nop 1
v_add_f32_dpp v60, v60, v60 row_ror:4 row_mask:0xf bank_mask:0xf
s_nop 1
v_add_f32_dpp v60, v60, v60 row_ror:2 row_mask:0xf bank_mask:0xf
s_nop 1
v_add_f32_dpp v60, v60, v60 row_ror:1 row_mask:0xf bank_mask:0xf
v_mov_b32 v61, v60
s_nop 1
v_permlane16_swap_b32 v60, v61
v_add_f32 v60, v60, v61
v_mov_b32 v61, v60
s_nop 1
v_permlane32_swap_b32 v60, v61
v_add_f32 v60, v60, v61
v_cmp_gt_u32 vcc, 24, v1
s_mul_i32 s47, s46, 86
s_lshr_b32 s47, s47, 8
v_cndmask_b32 v17, v255, v8, vcc
v_cndmask_b32 v250, 0, -1, vcc
s_lshl_b32 s48, s46, 12
s_add_u32 s48, s48, 720896
v_mov_b32 v18, 0
s_and_b32 s60, s40, 0xff
s_bfe_u32 s61, s40, 0x80008
s_bfe_u32 s62, s40, 0x80010
s_lshr_b32 s63, s40, 24
v_and_b32 v64, s60, v250
v_and_b32 v65, s61, v250
v_and_b32 v66, s62, v250
v_and_b32 v67, s63, v250
v_lshrrev_b32 v70, 3, v1
v_lshl_add_u32 v71, v70, 12, v15
v_lshlrev_b32 v70, 2, v70
v_lshrrev_b32 v77, 1, v15
s_add_u32 s51, s46, s47
s_lshl_b32 s51, s51, 7
s_add_u32 s51, s51, 524288
s_add_u32 s52, s51, 32768
s_add_u32 s53, s51, 65536
s_add_u32 s54, s51, 98304
s_branch L_pg3
.p2align 12
L_pg3:
v_and_b32 v30, 31, v1
v_mul_u32_u24 v30, 4224, v30
s_mul_i32 s55, s42, 512
s_add_u32 s55, s55, 6881280
s_mov_b32 exec_hi, 0
L_f_p:
buffer_load_dwordx3 v[200:202], v30, s[4:7], s55 offen sc1
s_waitcnt vmcnt(0)
v_cmp_ne_u32 vcc, s40, v202
v_mov_b32 v20, v200
v_mov_b32 v21, v201
s_cbranch_vccz L_f_ok
s_add_u32 s97, s97, 1
s_cmp_le_u32 s97, 65536
s_cbranch_scc1 L_f_p
L_f_ok:
v_max_f32_dpp v24, v20, v20 row_ror:8 row_mask:0xf bank_mask:0xf
s_nop 1
v_max_f32_dpp v24, v24, v24 row_ror:4 row_mask:0xf bank_mask:0xf
s_nop 1
v_max_f32_dpp v24, v24, v24 row_ror:2 row_mask:0xf bank_mask:0xf
s_nop 1
v_max_f32_dpp v24, v24, v24 row_ror:1 row_mask:0xf bank_mask:0xf
v_mov_b32 v25, v24
s_nop 1
v_permlane16_swap_b32 v24, v25
v_max_f32 v24, v24, v25
v_cmp_eq_f32 vcc, v24, v20
s_mov_b32 exec_hi, -1
s_ff1_i32_b32 s45, vcc_lo
s_and_b32 s45, s45, 31
v_readlane_b32 s50, v21, s45
s_lshl_b32 s55, s45, 12
s_add_u32 s55, s55, s51
ds_bpermute_b32 v72, v70, v21 offset:0
ds_bpermute_b32 v73, v70, v21 offset:32
ds_bpermute_b32 v74, v70, v21 offset:64
ds_bpermute_b32 v75, v70, v21 offset:96
v_readlane_b32 s58, v24, 0
s_nop 1
v_add_f32 v60, s58, v60
v_cvt_pk_bf16_f32 v60, v60, v60
v_lshlrev_b32 v60, 16, v60
v_mul_f32 v60, 0xbfb8aa3b, v60
v_exp_f32 v60, v60
s_and_b32 s50, s50, 2047
s_mul_i32 s50, s50, 1280
v_add_f32 v60, 1.0, v60
v_rcp_f32 v60, v60
s_lshl_b32 s57, s46, 6
s_add_u32 s50, s50, s57
s_lshl_b32 s58, s45, 2
v_mul_f32 v56, v56, v60
v_mul_f32 v57, v57, v60
v_mul_f32 v58, v58, v60
v_mul_f32 v59, v59, v60
s_mov_b32 s59, 1280
s_waitcnt lgkmcnt(0)
v_and_b32 v72, 2047, v72
v_add_u32 v76, 0, v70
v_cmp_eq_u32 vcc, s58, v76
v_mad_u32_u24 v72, v72, s59, v77
s_nop 0
v_cndmask_b32 v72, v72, v255, vcc
v_and_b32 v73, 2047, v73
v_add_u32 v76, 32, v70
v_cmp_eq_u32 vcc, s58, v76
v_mad_u32_u24 v73, v73, s59, v77
s_nop 0
v_cndmask_b32 v73, v73, v255, vcc
v_and_b32 v74, 2047, v74
v_add_u32 v76, 64, v70
v_cmp_eq_u32 vcc, s58, v76
v_mad_u32_u24 v74, v74, s59, v77
s_nop 0
v_cndmask_b32 v74, v74, v255, vcc
v_and_b32 v75, 2047, v75
v_add_u32 v76, 96, v70
v_cmp_eq_u32 vcc, s58, v76
v_mad_u32_u24 v75, v75, s59, v77
s_nop 0
v_cndmask_b32 v75, v75, v255, vcc
L_fz_bp:
buffer_load_dwordx4 v[52:55], v15, s[4:7], s55 offen sc1
buffer_load_dwordx4 v[80:83], v71, s[4:7], s51 offen sc1
buffer_load_dwordx4 v[84:87], v71, s[4:7], s52 offen sc1
buffer_load_dwordx4 v[88:91], v71, s[4:7], s53 offen sc1
buffer_load_dwordx4 v[92:95], v71, s[4:7], s54 offen sc1
s_waitcnt vmcnt(0)
v_xor_b32 v52, s60, v52
v_xor_b32 v53, s61, v53
v_xor_b32 v54, s62, v54
v_xor_b32 v55, s63, v55
v_xor_b32 v80, s60, v80
v_xor_b32 v81, s61, v81
v_xor_b32 v82, s62, v82
v_xor_b32 v83, s63, v83
v_xor_b32 v84, s60, v84
v_xor_b32 v85, s61, v85
v_xor_b32 v86, s62, v86
v_xor_b32 v87, s63, v87
v_xor_b32 v88, s60, v88
v_xor_b32 v89, s61, v89
v_xor_b32 v90, s62, v90
v_xor_b32 v91, s63, v91
v_xor_b32 v92, s60, v92
v_xor_b32 v93, s61, v93
v_xor_b32 v94, s62, v94
v_xor_b32 v95, s63, v95
v_or_b32 v32, v52, v53
v_or3_b32 v32, v32, v54, v55
v_or3_b32 v32, v32, v80, v81
v_or3_b32 v32, v32, v82, v83
v_or3_b32 v32, v32, v84, v85
v_or3_b32 v32, v32, v86, v87
v_or3_b32 v32, v32, v88, v89
v_or3_b32 v32, v32, v90, v91
v_or3_b32 v32, v32, v92, v93
v_or3_b32 v32, v32, v94, v95
v_and_b32 v32, 0xff, v32
v_cmp_ne_u32 vcc, 0, v32
s_add_u32 s97, s97, 1
s_cmp_gt_u32 s97, 65536
s_cbranch_scc1 L_fz_bok
s_cbranch_vccnz L_fz_bp
L_fz_bok:
v_cvt_pk_bf16_f32 v80, v80, v81
v_cvt_pk_bf16_f32 v81, v82, v83
buffer_store_dwordx2 v[80:81], v72, s[32:35], s57 offen sc1
v_cvt_pk_bf16_f32 v84, v84, v85
v_cvt_pk_bf16_f32 v85, v86, v87
buffer_store_dwordx2 v[84:85], v73, s[32:35], s57 offen sc1
v_cvt_pk_bf16_f32 v88, v88, v89
v_cvt_pk_bf16_f32 v89, v90, v91
buffer_store_dwordx2 v[88:89], v74, s[32:35], s57 offen sc1
v_cvt_pk_bf16_f32 v92, v92, v93
v_cvt_pk_bf16_f32 v93, v94, v95
buffer_store_dwordx2 v[92:93], v75, s[32:35], s57 offen sc1
s_cmp_eq_u32 s46, 0
s_cbranch_scc0 L_fz_e
s_add_u32 s55, s41, 1
v_mov_b32 v22, s55
s_mov_b64 exec, 1
buffer_store_dword v22, v18, s[4:7], 0 offen sc1
s_mov_b64 exec, -1
L_fz_e:
v_min_u32 v68, 26, v1
v_lshlrev_b32 v68, 7, v68
s_mov_b32 s57, 425984
L_ys_p:
buffer_load_dword v69, v68, s[4:7], s57 offen sc1
s_waitcnt vmcnt(0)
v_cmp_ne_u32 vcc, s40, v69
s_cbranch_vccz L_ys_ok
s_add_u32 s97, s97, 1
s_cmp_le_u32 s97, 65536
s_cbranch_scc1 L_ys_p
L_ys_ok:
L_fy_p:
buffer_load_dwordx4 v[100:103], v8, s[4:7], s48 offen offset:0 sc1
buffer_load_dwordx4 v[104:107], v8, s[4:7], s48 offen offset:1024 sc1
buffer_load_dwordx4 v[108:111], v8, s[4:7], s48 offen offset:2048 sc1
buffer_load_dwordx4 v[112:115], v17, s[4:7], s48 offen offset:3072 sc1
s_waitcnt vmcnt(0)
v_xor_b32 v20, s60, v100
v_xor_b32 v21, s61, v101
v_xor_b32 v22, s62, v102
v_xor_b32 v23, s63, v103
v_xor_b32 v24, s60, v104
v_xor_b32 v25, s61, v105
v_xor_b32 v26, s62, v106
v_xor_b32 v27, s63, v107
v_xor_b32 v28, s60, v108
v_xor_b32 v29, s61, v109
v_xor_b32 v30, s62, v110
v_xor_b32 v31, s63, v111
v_xor_b32 v32, v64, v112
v_xor_b32 v33, v65, v113
v_xor_b32 v34, v66, v114
v_xor_b32 v35, v67, v115
v_or3_b32 v36, v20, v21, v22
v_or3_b32 v37, v23, v24, v25
v_or3_b32 v36, v36, v26, v27
v_or3_b32 v37, v37, v28, v29
v_or3_b32 v36, v36, v30, v31
v_or3_b32 v37, v37, v32, v33
v_or3_b32 v36, v36, v34, v35
v_or_b32 v36, v36, v37
v_and_b32 v36, 0xff, v36
v_cmp_ne_u32 vcc, 0, v36
s_cbranch_vccz L_fy_ok
s_add_u32 s97, s97, 1
s_cmp_le_u32 s97, 65536
s_cbranch_scc1 L_fy_p
L_fy_ok:
v_pk_add_f32 v[20:21], v[20:21], v[24:25]
v_pk_add_f32 v[22:23], v[22:23], v[26:27]
v_pk_add_f32 v[28:29], v[28:29], v[32:33]
v_pk_add_f32 v[30:31], v[30:31], v[34:35]
v_pk_add_f32 v[20:21], v[20:21], v[28:29]
v_pk_add_f32 v[22:23], v[22:23], v[30:31]
s_nop 0
v_add_f32_dpp v20, v20, v20 row_ror:8 row_mask:0xf bank_mask:0xf
v_add_f32_dpp v21, v21, v21 row_ror:8 row_mask:0xf bank_mask:0xf
v_add_f32_dpp v22, v22, v22 row_ror:8 row_mask:0xf bank_mask:0xf
v_add_f32_dpp v23, v23, v23 row_ror:8 row_mask:0xf bank_mask:0xf
v_mov_b32 v24, v20
v_mov_b32 v25, v21
v_mov_b32 v26, v22
v_mov_b32 v27, v23
v_permlane16_swap_b32 v20, v24
v_permlane16_swap_b32 v21, v25
v_permlane16_swap_b32 v22, v26
v_permlane16_swap_b32 v23, v27
v_pk_add_f32 v[20:21], v[20:21], v[24:25]
v_pk_add_f32 v[22:23], v[22:23], v[26:27]
v_mov_b32 v24, v20
v_mov_b32 v25, v21
v_mov_b32 v26, v22
v_mov_b32 v27, v23
v_permlane32_swap_b32 v20, v24
v_permlane32_swap_b32 v21, v25
v_permlane32_swap_b32 v22, v26
v_permlane32_swap_b32 v23, v27
v_pk_add_f32 v[20:21], v[20:21], v[24:25]
v_pk_add_f32 v[22:23], v[22:23], v[26:27]
v_pk_fma_f32 v[20:21], v[20:21], v[56:57], v[52:53]
v_pk_fma_f32 v[22:23], v[22:23], v[58:59], v[54:55]
v_cvt_pk_bf16_f32 v20, v20, v21
v_cvt_pk_bf16_f32 v21, v22, v23
s_mov_b64 exec, 0xff
buffer_store_dwordx2 v[20:21], v14, s[32:35], s50 offen
s_mov_b64 exec, -1
L_fin:
L_end:
s_endpgm
.fill (adaLN_cond__sliding_local_dilated__moe_arch_mod__prompt_kernel + 66048 - .) / 4, 4, 0xbf800000
.section .rodata,"a"
.p2align 6
.amdhsa_kernel adaLN_cond__sliding_local_dilated__moe_arch_mod__prompt_kernel
  .amdhsa_next_free_vgpr 512
  .amdhsa_next_free_sgpr 102
  .amdhsa_accum_offset 256
  .amdhsa_group_segment_fixed_size 0
  .amdhsa_kernarg_size 104
  .amdhsa_user_sgpr_count 2
  .amdhsa_user_sgpr_kernarg_segment_ptr 1
  .amdhsa_system_sgpr_workgroup_id_x 1
  .amdhsa_float_denorm_mode_32 3
  .amdhsa_float_denorm_mode_16_64 3
.end_amdhsa_kernel
```

```asm
; @launch grid=(256,1,1) block=(256,1,1) lds=163840
.amdgcn_target "amdgcn-amd-amdhsa--gfx950"
.text
.globl adaLN_cond__sliding_local_dilated__moe_arch_mod__prompt_kernel
.p2align 12
.type adaLN_cond__sliding_local_dilated__moe_arch_mod__prompt_kernel,@function
adaLN_cond__sliding_local_dilated__moe_arch_mod__prompt_kernel:
s_cmp_ge_u32 s2, 256
s_cbranch_scc1 L_end
s_load_dwordx4 s[8:11], s[0:1], 0
s_load_dwordx4 s[20:23], s[0:1], 64
s_load_dwordx2 s[4:5], s[0:1], 96
s_getpc_b64 s[48:49]
v_lshrrev_b32 v4, 6, v0
v_and_b32 v1, 63, v0
s_lshr_b32 s43, s2, 3
v_readfirstlane_b32 s3, v4
v_lshl_add_u32 v5, v4, 2, v1
s_lshl_b32 s50, s43, 11
v_lshl_add_u32 v5, v5, 7, s50
s_mov_b64 exec, 15
global_load_dword v19, v5, s[48:49]
s_mov_b64 exec, -1
s_and_b32 s42, s2, 7
v_and_b32 v2, 15, v1
v_lshrrev_b32 v3, 4, v1
v_mov_b32 v29, 0
s_mov_b32 s6, 8388608
s_mov_b32 s7, 0x20000
s_lshl_b32 s49, s3, 10
s_cmp_ge_u32 s2, 224
s_cbranch_scc1 L_svc
s_mov_b32 m0, s49
s_mov_b32 s15, 0x20000
s_lshr_b32 s55, s42, 2
s_bfe_u32 s56, s42, 0x10001
s_mul_i32 s56, s56, 7
s_and_b32 s57, s42, 1
s_mul_i32 s57, s57, 28
s_add_u32 s57, s57, s43
s_and_b32 s44, s57, 7
s_lshr_b32 s57, s57, 3
s_add_u32 s56, s56, s57
s_mul_i32 s57, s56, 73
s_lshl_b32 s45, s57, 1
s_add_u32 s45, s45, s55
s_mul_i32 s45, s45, 1280
s_mul_i32 s58, s43, 37
s_lshr_b32 s58, s58, 8
s_mul_i32 s60, s58, 7
s_sub_u32 s96, s43, s60
s_lshl_b32 s47, s42, 2
s_add_u32 s47, s47, s58
s_lshl_b32 s60, s96, 2
s_lshr_b32 s60, 0x4932180, s60
s_and_b32 s60, s60, 15
s_cmp_ge_u32 s60, 8
s_cselect_b32 s61, 2, 5
s_cselect_b32 s63, 12, 0
s_mul_i32 s58, s58, s61
s_add_u32 s58, s58, s60
s_add_u32 s58, s58, s63
s_lshl_b32 s58, s58, 3
s_add_u32 s98, s58, s42
s_and_b32 s60, s60, 3
s_lshl_b32 s60, s60, 2
s_lshr_b32 s62, 0x3214321, s60
s_lshl_b32 s62, s62, 4
s_bfe_u32 s61, s62, 262144
s_mul_i32 s61, s61, 40960
s_add_u32 s61, s61, s45
v_lshrrev_b32 v5, 4, v0
v_mul_u32_u24 v4, 2560, v5
v_lshl_add_u32 v4, v2, 4, v4
s_cmp_lt_u32 s98, 160
s_cbranch_scc1 L_roleW
s_sub_u32 s50, s98, 160
s_mul_i32 s52, s50, 13
s_lshr_b32 s52, s52, 8
s_mul_i32 s53, s52, 20
s_sub_u32 s53, s50, s53
s_mul_i32 s51, s52, 28
s_add_u32 s51, s51, s3
s_mul_i32 s51, s51, 61440
s_lshl_b32 s54, s53, 7
s_add_u32 s51, s51, s54
s_mul_i32 s54, s52, 448
s_and_b32 s58, s3, 1
s_lshl_b32 s58, s58, 2
v_and_b32 v20, 1, v3
v_lshl_or_b32 v20, v20, 1, s58
v_and_b32 v21, 7, v1
v_xor_b32 v20, v20, v21
v_lshrrev_b32 v21, 3, v1
v_mul_u32_u24 v21, 480, v21
v_add_lshl_u32 v20, v20, v21, 4
v_lshlrev_b32 v39, 3, v1
s_mov_b32 s14, 4915200
s_waitcnt lgkmcnt(0)
s_mov_b32 s12, s22
s_mov_b32 s13, s23
s_mov_b32 s22, 1280
s_mov_b32 s23, 0x20000
s_mov_b32 s10, 2621440
s_mov_b32 s11, 0x20000
buffer_load_dword v42, v29, s[4:7], 0 offen sc1
buffer_load_dwordx2 v[40:41], v39, s[20:23], s54 offen
buffer_load_dwordx4 v[100:103], v4, s[8:11], s61 offen offset:0
buffer_load_dwordx4 v[104:107], v4, s[8:11], s61 offen offset:256
buffer_load_dwordx4 v[108:111], v4, s[8:11], s61 offen offset:512
buffer_load_dwordx4 v[112:115], v4, s[8:11], s61 offen offset:768
buffer_load_dwordx4 v[116:119], v4, s[8:11], s61 offen offset:1024
s_bfe_u32 s61, s62, 262148
s_mul_i32 s61, s61, 40960
s_add_u32 s61, s61, s45
buffer_load_dwordx4 v20, s[12:15], s51 offen nt lds
s_add_u32 m0, m0, 4096
s_add_u32 s51, s51, 245760
buffer_load_dwordx4 v20, s[12:15], s51 offen nt lds
s_add_u32 m0, m0, 4096
s_add_u32 s51, s51, 245760
buffer_load_dwordx4 v20, s[12:15], s51 offen nt lds
s_add_u32 m0, m0, 4096
s_add_u32 s51, s51, 245760
buffer_load_dwordx4 v20, s[12:15], s51 offen nt lds
s_add_u32 m0, m0, 4096
s_add_u32 s51, s51, 245760
buffer_load_dwordx4 v20, s[12:15], s51 offen nt lds
s_add_u32 m0, m0, 4096
s_add_u32 s51, s51, 245760
buffer_load_dwordx4 v20, s[12:15], s51 offen nt lds
s_add_u32 m0, m0, 4096
s_add_u32 s51, s51, 245760
buffer_load_dwordx4 v20, s[12:15], s51 offen nt lds
s_branch L_rolej
L_roleW:
s_mov_b32 s58, 640
v_lshlrev_b32 v24, 4, v0
v_mul_u32_u24 v26, 1639, v0
v_lshrrev_b32 v26, 16, v26
v_mad_u32_u24 v20, v26, s58, v24
v_add_u32 v25, 256, v0
v_add_u32 v24, 4096, v24
v_mul_u32_u24 v26, 1639, v25
v_lshrrev_b32 v26, 16, v26
v_mad_u32_u24 v21, v26, s58, v24
v_add_u32 v25, 512, v0
v_add_u32 v24, 4096, v24
v_mul_u32_u24 v26, 1639, v25
v_lshrrev_b32 v26, 16, v26
v_mad_u32_u24 v22, v26, s58, v24
v_add_u32 v25, 768, v0
v_add_u32 v24, 4096, v24
v_mul_u32_u24 v26, 1639, v25
v_lshrrev_b32 v26, 16, v26
v_mad_u32_u24 v23, v26, s58, v24
s_lshr_b32 s50, s98, 1
s_and_b32 s52, s98, 1
s_mul_i32 s51, s50, 30720
s_mul_i32 s53, s52, 640
s_add_u32 s51, s51, s53
s_cmp_eq_u32 s3, 3
s_cselect_b32 s53, 1073741824, s51
s_mov_b32 s14, 2457600
s_waitcnt lgkmcnt(0)
s_mov_b32 s12, s10
s_mov_b32 s13, s11
s_mov_b32 s10, 2621440
s_mov_b32 s11, 0x20000
buffer_load_dword v42, v29, s[4:7], 0 offen sc1
buffer_load_dwordx4 v[100:103], v4, s[8:11], s61 offen offset:0
buffer_load_dwordx4 v[104:107], v4, s[8:11], s61 offen offset:256
buffer_load_dwordx4 v[108:111], v4, s[8:11], s61 offen offset:512
buffer_load_dwordx4 v[112:115], v4, s[8:11], s61 offen offset:768
buffer_load_dwordx4 v[116:119], v4, s[8:11], s61 offen offset:1024
s_bfe_u32 s61, s62, 262148
s_mul_i32 s61, s61, 40960
s_add_u32 s61, s61, s45
buffer_load_dwordx4 v20, s[12:15], s51 offen nt lds
s_add_u32 m0, m0, 4096
s_nop 0
buffer_load_dwordx4 v21, s[12:15], s51 offen nt lds
s_add_u32 m0, m0, 4096
s_nop 0
buffer_load_dwordx4 v22, s[12:15], s51 offen nt lds
s_add_u32 m0, m0, 4096
s_nop 0
buffer_load_dwordx4 v23, s[12:15], s53 offen nt lds
L_rolej:
s_load_dwordx2 s[24:25], s[0:1], 16
s_load_dwordx2 s[28:29], s[0:1], 32
s_load_dwordx2 s[32:33], s[0:1], 80
s_mov_b32 s26, 819200
s_mov_b32 s27, 0x20000
s_mov_b32 s30, 1280
s_mov_b32 s31, 0x20000
s_mov_b32 s34, 2621440
s_mov_b32 s35, 0x20000
s_mov_b32 s97, 0
v_mov_b32 v255, 1073741824
v_lshlrev_b32 v36, 4, v1
s_mul_i32 s36, s55, 14
s_add_u32 s100, s36, s56
s_cmp_eq_u32 s56, 0
s_cselect_b32 s58, 0, 7
s_add_u32 s58, s58, s57
s_add_u32 s60, s57, 80
s_min_u32 s60, s60, 1024
s_sub_u32 s60, s60, s58
s_andn2_b32 s59, s58, 15
s_mul_i32 s54, s55, 1024
s_add_u32 s54, s54, s59
s_lshl_b32 s46, s44, 1
s_add_u32 s46, s46, s54
s_mul_i32 s46, s46, 1280
s_add_u32 s46, s46, 4194304
s_sub_u32 s54, s59, s58
s_sub_u32 s59, s59, s57
s_mul_i32 s59, s59, 176
s_add_u32 s59, s59, 138240
v_add_u32 v33, s54, v2
v_mul_u32_u24 v34, 175, v2
v_add3_u32 v34, v34, v0, s59
s_mov_b32 s54, 2656
s_mov_b32 s58, 1120
v_mul_u32_u24 v31, 410, v0
v_lshrrev_b32 v31, 16, v31
v_lshl_add_u32 v32, v31, 4, v33
v_cmp_gt_u32 vcc, s60, v32
v_mad_u32_u24 v32, v31, s58, v0
v_mad_u32_u24 v15, v31, s54, v34
v_lshlrev_b32 v32, 4, v32
v_cndmask_b32 v11, v255, v32, vcc
v_add_u32 v30, 256, v0
v_mul_u32_u24 v31, 410, v30
v_lshrrev_b32 v31, 16, v31
v_lshl_add_u32 v32, v31, 4, v33
v_cmp_gt_u32 vcc, s60, v32
v_mad_u32_u24 v32, v31, s58, v30
v_mad_u32_u24 v16, v31, s54, v34
v_lshlrev_b32 v32, 4, v32
v_cndmask_b32 v12, v255, v32, vcc
v_add_u32 v30, 512, v0
v_mul_u32_u24 v31, 410, v30
v_lshrrev_b32 v31, 16, v31
v_lshl_add_u32 v32, v31, 4, v33
v_cmp_gt_u32 vcc, s60, v32
v_mad_u32_u24 v32, v31, s58, v30
v_mad_u32_u24 v17, v31, s54, v34
v_lshlrev_b32 v32, 4, v32
v_cndmask_b32 v13, v255, v32, vcc
v_add_u32 v30, 768, v0
v_mul_u32_u24 v31, 410, v30
v_lshrrev_b32 v31, 16, v31
v_lshl_add_u32 v32, v31, 4, v33
v_cmp_gt_u32 vcc, s60, v32
v_mad_u32_u24 v32, v31, s58, v30
v_mad_u32_u24 v18, v31, s54, v34
v_lshlrev_b32 v32, 4, v32
v_cndmask_b32 v14, v255, v32, vcc
s_mul_i32 s58, s3, 80
v_add_u32 v30, s58, v1
s_mul_i32 s58, s3, 1280
s_add_u32 s58, s58, 1024
v_lshlrev_b32 v248, 4, v30
v_lshl_add_u32 v249, v1, 2, s58
v_add_u32 v251, 158720, v248
v_add_u32 v250, 158720, v249
v_cmp_le_u32 vcc, 160, v30
v_min_u32 v247, 19, v1
v_lshlrev_b32 v247, 6, v247
v_cndmask_b32 v252, 0, 1.0, vcc
v_cmp_gt_u32 vcc, 4, v1
s_mov_b32 s56, 4096
s_mov_b32 s57, 9216
v_cndmask_b32 v246, v255, v36, vcc
s_mul_i32 s60, s44, 5120
s_mul_i32 s58, s3, 1280
s_add_u32 s60, s60, s58
s_add_u32 s60, s60, 851968
s_mov_b32 s58, 14336
v_lshlrev_b32 v30, 12, v3
v_lshl_add_u32 v30, v2, 4, v30
v_add_u32 v5, s49, v30
v_lshrrev_b32 v32, 2, v2
v_cmp_ne_u32 vcc, 1, v32
v_lshrrev_b32 v30, 4, v0
v_and_b32 v31, 7, v2
v_cndmask_b32 v6, v255, v5, vcc
v_xor_b32 v30, v30, v31
v_lshlrev_b32 v30, 4, v30
v_and_b32 v33, 3, v2
v_lshl_add_u32 v30, v33, 8, v30
v_mul_u32_u24 v32, 5120, v32
s_mov_b32 s54, 56320
v_add3_u32 v30, v30, v32, s54
s_bfe_u32 s63, s62, 262144
s_lshl_b32 s63, s63, 10
v_add_u32 v7, s63, v30
s_bfe_u32 s63, s62, 262148
s_lshl_b32 s63, s63, 10
v_add_u32 v253, s63, v30
s_bfe_u32 s63, s62, 262152
s_lshl_b32 s63, s63, 10
v_add_u32 v254, s63, v30
s_bfe_u32 s63, s62, 262156
s_lshl_b32 s63, s63, 10
v_add_u32 v244, s63, v30
s_bfe_u32 s63, s62, 262160
s_lshl_b32 s63, s63, 10
v_add_u32 v245, s63, v30
v_xor_b32 v30, v2, v3
v_lshlrev_b32 v30, 4, v30
v_lshl_add_u32 v8, v3, 8, v30
v_xor_b32 v9, 64, v8
v_add_u32 v8, s54, v8
v_add_u32 v9, s54, v9
v_lshlrev_b32 v10, 5, v2
v_add_u32 v10, 158720, v10
s_mul_i32 s59, s44, 327680
s_add_u32 s59, s59, 1048576
s_cmp_eq_u32 s96, 6
s_cselect_b32 s16, 0x80, 0
s_cselect_b32 s17, 16, 24
s_mov_b32 s37, 2368
s_mov_b32 s38, 1088
v_mul_u32_u24 v31, 5462, v1
v_lshrrev_b32 v31, 16, v31
v_mad_u32_u24 v32, v31, s37, v36
v_mad_u32_u24 v33, v31, s38, v36
v_lshlrev_b32 v31, 2, v31
v_and_b32 v34, s16, v32
v_bitop3_b32 v33, v33, v31, 32 bitop3:0x78
v_lshl_or_b32 v235, v34, 23, v32
v_lshl_or_b32 v232, v34, 23, v33
v_add_u32 v30, 64, v1
v_mul_u32_u24 v31, 5462, v30
v_lshrrev_b32 v31, 16, v31
v_mad_u32_u24 v32, v31, s37, v36
v_mad_u32_u24 v33, v31, s38, v36
v_lshlrev_b32 v31, 2, v31
v_and_b32 v34, s16, v32
v_bitop3_b32 v33, v33, v31, 32 bitop3:0x78
v_lshl_or_b32 v236, v34, 23, v32
v_lshl_or_b32 v233, v34, 23, v33
v_add_u32 v30, 128, v1
v_mul_u32_u24 v31, 5462, v30
v_lshrrev_b32 v31, 16, v31
v_mad_u32_u24 v32, v31, s37, v36
v_mad_u32_u24 v33, v31, s38, v36
v_lshlrev_b32 v31, 2, v31
v_and_b32 v34, s16, v32
v_bitop3_b32 v33, v33, v31, 32 bitop3:0x78
v_lshl_or_b32 v237, v34, 23, v32
v_lshl_or_b32 v234, v34, 23, v33
s_lshl_b32 s100, s100, 3
s_add_u32 s100, s100, s44
s_lshl_b32 s100, s100, 6
s_add_u32 s100, s100, 917504
s_and_b32 s37, s47, 15
s_lshl_b32 s37, s37, 6
s_max_u32 s37, s37, 7
s_sub_u32 s37, s37, 7
s_mul_i32 s37, s37, 899
s_lshr_b32 s37, s37, 16
s_min_u32 s37, s37, 12
s_add_u32 s37, s37, s36
s_lshl_b32 s101, s37, 3
s_bfe_u32 s37, s42, 0x10001
s_mul_i32 s37, s37, 7
s_add_u32 s37, s37, s36
s_lshl_b32 s37, s37, 3
s_and_b32 s38, s42, 1
s_mul_i32 s38, s38, 28
s_add_u32 s21, s37, s38
s_sub_u32 s20, s43, s96
s_getreg_b32 s19, hwreg(HW_REG_XCC_ID, 0, 4)
v_cmp_le_u32 vcc, 24, v1
v_subrev_u32 v30, 24, v1
v_mov_b32 v32, 0xa00
v_cndmask_b32 v30, v1, v30, vcc
v_cndmask_b32 v32, 0, v32, vcc
v_cmp_gt_u32 vcc, s17, v30
v_lshl_add_u32 v32, v30, 4, v32
v_lshlrev_b32 v31, 3, v30
v_cndmask_b32 v238, v255, v32, vcc
v_cndmask_b32 v239, v255, v31, vcc
v_cndmask_b32 v230, 0, -1, vcc
v_min_u32 v30, 6, v2
v_add_u32 v30, s20, v30
v_cmp_gt_u32 vcc, 16, v1
v_add_u32 v30, s21, v30
v_add_u32 v31, s101, v1
v_cndmask_b32 v30, v30, v31, vcc
v_lshlrev_b32 v231, 6, v30
s_mul_i32 s37, s96, 192
s_mul_i32 s48, s3, 20480
s_add_u32 s48, s48, s37
s_and_b32 s99, s47, 0
s_mul_i32 s99, s99, 0
s_mul_i32 s37, s99, 163840
s_add_u32 s48, s48, s37
s_mul_i32 s39, s3, 3072
s_lshl_b32 s18, s47, 11
s_andn2_b32 s37, s18, 8191
s_add_u32 s18, s18, s37
s_lshl_b32 s37, s96, 8
s_add_u32 s18, s18, s37
s_lshl_b32 s37, s3, 6
s_add_u32 s18, s18, s37
s_add_u32 s18, s18, 7733248
v_accvgpr_write_b32 a232, -1
v_accvgpr_write_b32 a233, -1
v_accvgpr_write_b32 a234, -1
v_accvgpr_write_b32 a235, -1
v_lshrrev_b32 v30, 2, v2
v_cmp_eq_u32 vcc, v30, v3
v_mov_b32 v31, 0x3f803f80
v_mov_b32 v30, 0
v_cndmask_b32 v30, v30, v31, vcc
v_accvgpr_write_b32 a236, v30
v_accvgpr_write_b32 a237, v30
v_accvgpr_write_b32 a238, v30
v_accvgpr_write_b32 a239, v30
s_cmp_ge_u32 s98, 160
s_cbranch_scc1 L_bodyM
v_bfe_u32 v30, v1, 2, 2
v_and_b32 v31, 3, v1
v_max_u32 v32, 1, v31
v_add_u32 v32, -1, v32
v_cmp_eq_u32 vcc, 3, v3
v_lshlrev_b32 v33, 3, v31
v_mul_u32_u24 v30, 3, v30
v_cndmask_b32 v32, v3, v32, vcc
v_cndmask_b32 v33, v33, 32, vcc
v_add_u32 v30, v30, v32
v_mul_u32_u24 v30, 640, v30
s_mul_i32 s54, s3, 160
v_add3_u32 v35, v30, v33, s54
s_lshl_b32 s52, s52, 2
s_add_u32 s52, s52, s3
s_mul_i32 s52, s52, 80
s_add_u32 s52, s52, s50
s_lshl_b32 s51, s52, 12
s_add_u32 s51, s51, 1048576
s_lshl_b32 s53, s52, 6
s_add_u32 s53, s53, 851968
s_waitcnt vmcnt(4)
s_mov_b32 s55, 0x3f803f80
buffer_load_dwordx4 v[120:123], v4, s[8:11], s61 offen offset:0
v_mfma_f32_16x16x32_bf16 v[20:23], a[236:239], v[100:103], 0
v_lshlrev_b32 v24, 16, v104
v_and_b32 v25, 0xffff0000, v104
v_mfma_f32_16x16x32_bf16 v[20:23], a[236:239], v[104:107], v[20:23]
v_lshlrev_b32 v26, 16, v105
v_and_b32 v27, 0xffff0000, v105
v_mfma_f32_16x16x32_bf16 v[20:23], a[236:239], v[108:111], v[20:23]
v_lshlrev_b32 v28, 16, v106
v_and_b32 v29, 0xffff0000, v106
buffer_load_dwordx4 v[124:127], v4, s[8:11], s61 offen offset:256
v_mfma_f32_16x16x32_bf16 v[20:23], a[236:239], v[112:115], v[20:23]
v_lshlrev_b32 v30, 16, v107
v_and_b32 v31, 0xffff0000, v107
v_mfma_f32_16x16x32_bf16 v[20:23], a[236:239], v[116:119], v[20:23]
v_lshlrev_b32 v88, 16, v100
v_and_b32 v89, 0xffff0000, v100
v_lshlrev_b32 v90, 16, v101
v_and_b32 v91, 0xffff0000, v101
v_dot2_f32_bf16 v96, v100, v100, 0
buffer_load_dwordx4 v[128:131], v4, s[8:11], s61 offen offset:512
v_dot2_f32_bf16 v97, v101, v101, 0
v_dot2_f32_bf16 v96, v102, v102, v96
v_dot2_f32_bf16 v97, v103, v103, v97
v_dot2_f32_bf16 v96, v104, v104, v96
v_dot2_f32_bf16 v97, v105, v105, v97
v_dot2_f32_bf16 v96, v106, v106, v96
v_dot2_f32_bf16 v97, v107, v107, v97
v_dot2_f32_bf16 v96, v108, v108, v96
v_dot2_f32_bf16 v97, v109, v109, v97
buffer_load_dwordx4 v[132:135], v4, s[8:11], s61 offen offset:768
v_dot2_f32_bf16 v96, v110, v110, v96
v_dot2_f32_bf16 v97, v111, v111, v97
v_dot2_f32_bf16 v96, v112, v112, v96
v_dot2_f32_bf16 v97, v113, v113, v97
v_dot2_f32_bf16 v96, v114, v114, v96
v_dot2_f32_bf16 v97, v115, v115, v97
v_dot2_f32_bf16 v96, v116, v116, v96
v_dot2_f32_bf16 v97, v117, v117, v97
v_dot2_f32_bf16 v96, v118, v118, v96
buffer_load_dwordx4 v[136:139], v4, s[8:11], s61 offen offset:1024
s_bfe_u32 s61, s62, 262152
s_mul_i32 s61, s61, 40960
s_add_u32 s61, s61, s45
v_dot2_f32_bf16 v97, v119, v119, v97
v_add_f32_dpp v20, v20, v20 row_ror:8 row_mask:0xf bank_mask:0xf
v_lshlrev_b32 v100, 16, v102
v_and_b32 v101, 0xffff0000, v102
v_add_f32 v96, v96, v97
v_add_f32_dpp v20, v20, v20 row_ror:4 row_mask:0xf bank_mask:0xf
v_lshlrev_b32 v102, 16, v103
v_add_f32_dpp v96, v96, v96 row_ror:8 row_mask:0xf bank_mask:0xf
v_add_f32_dpp v20, v20, v20 row_ror:2 row_mask:0xf bank_mask:0xf
v_and_b32 v103, 0xffff0000, v103
v_add_f32_dpp v96, v96, v96 row_ror:4 row_mask:0xf bank_mask:0xf
v_add_f32_dpp v20, v20, v20 row_ror:1 row_mask:0xf bank_mask:0xf
v_mul_f32 v20, 0x3acccccd, v20
v_add_f32_dpp v96, v96, v96 row_ror:2 row_mask:0xf bank_mask:0xf
s_nop 1
v_add_f32_dpp v96, v96, v96 row_ror:1 row_mask:0xf bank_mask:0xf
v_mul_f32 v96, 0x3acccccd, v96
v_fma_f32 v96, -v20, v20, v96
v_max_f32 v96, 0, v96
v_add_f32 v96, 0x3727c5ac, v96
v_rsq_f32 v96, v96
s_nop 0
v_mul_f32 v97, -v20, v96
v_pk_fma_f32 v[24:25], v[24:25], v[96:97], v[96:97] op_sel:[0,0,1] op_sel_hi:[1,0,1]
v_pk_fma_f32 v[26:27], v[26:27], v[96:97], v[96:97] op_sel:[0,0,1] op_sel_hi:[1,0,1]
v_pk_fma_f32 v[28:29], v[28:29], v[96:97], v[96:97] op_sel:[0,0,1] op_sel_hi:[1,0,1]
v_pk_fma_f32 v[30:31], v[30:31], v[96:97], v[96:97] op_sel:[0,0,1] op_sel_hi:[1,0,1]
v_cvt_pk_f16_f32 v104, v24, v25
v_cvt_pk_f16_f32 v105, v26, v27
v_cvt_pk_f16_f32 v106, v28, v29
v_cvt_pk_f16_f32 v107, v30, v31
v_lshlrev_b32 v24, 16, v108
v_and_b32 v25, 0xffff0000, v108
v_lshlrev_b32 v26, 16, v109
v_and_b32 v27, 0xffff0000, v109
v_lshlrev_b32 v28, 16, v110
v_and_b32 v29, 0xffff0000, v110
v_lshlrev_b32 v30, 16, v111
v_and_b32 v31, 0xffff0000, v111
v_pk_fma_f32 v[24:25], v[24:25], v[96:97], v[96:97] op_sel:[0,0,1] op_sel_hi:[1,0,1]
v_pk_fma_f32 v[26:27], v[26:27], v[96:97], v[96:97] op_sel:[0,0,1] op_sel_hi:[1,0,1]
v_pk_fma_f32 v[28:29], v[28:29], v[96:97], v[96:97] op_sel:[0,0,1] op_sel_hi:[1,0,1]
v_pk_fma_f32 v[30:31], v[30:31], v[96:97], v[96:97] op_sel:[0,0,1] op_sel_hi:[1,0,1]
v_cvt_pk_f16_f32 v108, v24, v25
v_cvt_pk_f16_f32 v109, v26, v27
v_cvt_pk_f16_f32 v110, v28, v29
v_cvt_pk_f16_f32 v111, v30, v31
v_lshlrev_b32 v24, 16, v112
v_and_b32 v25, 0xffff0000, v112
v_lshlrev_b32 v26, 16, v113
v_and_b32 v27, 0xffff0000, v113
v_lshlrev_b32 v28, 16, v114
v_and_b32 v29, 0xffff0000, v114
v_lshlrev_b32 v30, 16, v115
v_and_b32 v31, 0xffff0000, v115
v_pk_fma_f32 v[24:25], v[24:25], v[96:97], v[96:97] op_sel:[0,0,1] op_sel_hi:[1,0,1]
v_pk_fma_f32 v[26:27], v[26:27], v[96:97], v[96:97] op_sel:[0,0,1] op_sel_hi:[1,0,1]
v_pk_fma_f32 v[28:29], v[28:29], v[96:97], v[96:97] op_sel:[0,0,1] op_sel_hi:[1,0,1]
v_pk_fma_f32 v[30:31], v[30:31], v[96:97], v[96:97] op_sel:[0,0,1] op_sel_hi:[1,0,1]
v_cvt_pk_f16_f32 v112, v24, v25
v_cvt_pk_f16_f32 v113, v26, v27
v_cvt_pk_f16_f32 v114, v28, v29
v_cvt_pk_f16_f32 v115, v30, v31
v_lshlrev_b32 v24, 16, v116
v_and_b32 v25, 0xffff0000, v116
v_lshlrev_b32 v26, 16, v117
v_and_b32 v27, 0xffff0000, v117
v_lshlrev_b32 v28, 16, v118
v_and_b32 v29, 0xffff0000, v118
v_lshlrev_b32 v30, 16, v119
v_and_b32 v31, 0xffff0000, v119
v_pk_fma_f32 v[24:25], v[24:25], v[96:97], v[96:97] op_sel:[0,0,1] op_sel_hi:[1,0,1]
v_pk_fma_f32 v[26:27], v[26:27], v[96:97], v[96:97] op_sel:[0,0,1] op_sel_hi:[1,0,1]
v_pk_fma_f32 v[28:29], v[28:29], v[96:97], v[96:97] op_sel:[0,0,1] op_sel_hi:[1,0,1]
v_pk_fma_f32 v[30:31], v[30:31], v[96:97], v[96:97] op_sel:[0,0,1] op_sel_hi:[1,0,1]
v_pk_fma_f32 v[88:89], v[88:89], v[96:97], v[96:97] op_sel:[0,0,1] op_sel_hi:[1,0,1]
v_pk_fma_f32 v[90:91], v[90:91], v[96:97], v[96:97] op_sel:[0,0,1] op_sel_hi:[1,0,1]
v_pk_fma_f32 v[100:101], v[100:101], v[96:97], v[96:97] op_sel:[0,0,1] op_sel_hi:[1,0,1]
v_pk_fma_f32 v[102:103], v[102:103], v[96:97], v[96:97] op_sel:[0,0,1] op_sel_hi:[1,0,1]
v_cvt_pk_f16_f32 v116, v24, v25
v_cvt_pk_f16_f32 v117, v26, v27
v_cvt_pk_f16_f32 v118, v28, v29
v_cvt_pk_f16_f32 v119, v30, v31
buffer_load_dwordx4 v[140:143], v4, s[8:11], s61 offen offset:0
buffer_load_dwordx4 v[144:147], v4, s[8:11], s61 offen offset:256
buffer_load_dwordx4 v[148:151], v4, s[8:11], s61 offen offset:512
s_waitcnt vmcnt(8)
v_readfirstlane_b32 s41, v42
s_waitcnt lgkmcnt(0)
s_barrier
ds_read_b64_tr_b16 v[44:45], v35 offset:0
ds_read_b64_tr_b16 v[46:47], v35 offset:7680
ds_read_b64_tr_b16 v[48:49], v35 offset:40
ds_read_b64_tr_b16 v[50:51], v35 offset:7720
ds_read_b64_tr_b16 v[52:53], v35 offset:80
ds_read_b64_tr_b16 v[54:55], v35 offset:7760
ds_read_b64_tr_b16 v[56:57], v35 offset:120
ds_read_b64_tr_b16 v[58:59], v35 offset:7800
s_mul_i32 s40, s41, 0x9E3779B1
s_add_u32 s40, s40, 0x85EBCA6B
v_and_b32 v33, 3, v1
v_lshlrev_b32 v33, 3, v33
v_lshrrev_b32 v19, v33, s40
v_and_b32 v19, 0xff, v19
v_mov_b32 v240, s40
v_mov_b32 v241, s19
v_mov_b32 v242, s40
v_mov_b32 v243, s40
s_waitcnt lgkmcnt(6)
buffer_store_dwordx4 v[44:47], v36, s[4:7], s51 offen offset:0 sc1
s_waitcnt lgkmcnt(4)
buffer_store_dwordx4 v[48:51], v36, s[4:7], s51 offen offset:1024 sc1
s_waitcnt lgkmcnt(2)
buffer_store_dwordx4 v[52:55], v36, s[4:7], s51 offen offset:2048 sc1
s_waitcnt lgkmcnt(0)
buffer_store_dwordx4 v[56:59], v36, s[4:7], s51 offen offset:3072 sc1
buffer_load_dwordx4 v[152:155], v4, s[8:11], s61 offen offset:768
buffer_load_dwordx4 v[156:159], v4, s[8:11], s61 offen offset:1024
s_bfe_u32 s61, s62, 262156
s_mul_i32 s61, s61, 40960
s_add_u32 s61, s61, s45
s_waitcnt vmcnt(9)
s_mov_b32 s55, 0x3f803f80
buffer_load_dwordx4 v[160:163], v4, s[8:11], s61 offen offset:0
v_mfma_f32_16x16x32_bf16 v[20:23], a[236:239], v[120:123], 0
v_lshlrev_b32 v24, 16, v124
v_and_b32 v25, 0xffff0000, v124
v_mfma_f32_16x16x32_bf16 v[20:23], a[236:239], v[124:127], v[20:23]
v_lshlrev_b32 v26, 16, v125
v_and_b32 v27, 0xffff0000, v125
v_mfma_f32_16x16x32_bf16 v[20:23], a[236:239], v[128:131], v[20:23]
v_lshlrev_b32 v28, 16, v126
v_and_b32 v29, 0xffff0000, v126
v_mfma_f32_16x16x32_bf16 v[20:23], a[236:239], v[132:135], v[20:23]
v_lshlrev_b32 v30, 16, v127
v_and_b32 v31, 0xffff0000, v127
v_mfma_f32_16x16x32_bf16 v[20:23], a[236:239], v[136:139], v[20:23]
v_lshlrev_b32 v92, 16, v120
v_and_b32 v93, 0xffff0000, v120
v_lshlrev_b32 v94, 16, v121
v_and_b32 v95, 0xffff0000, v121
v_dot2_f32_bf16 v98, v120, v120, 0
v_dot2_f32_bf16 v99, v121, v121, 0
v_dot2_f32_bf16 v98, v122, v122, v98
v_dot2_f32_bf16 v99, v123, v123, v99
v_dot2_f32_bf16 v98, v124, v124, v98
v_dot2_f32_bf16 v99, v125, v125, v99
buffer_load_dwordx4 v[164:167], v4, s[8:11], s61 offen offset:256
v_dot2_f32_bf16 v98, v126, v126, v98
v_dot2_f32_bf16 v99, v127, v127, v99
v_dot2_f32_bf16 v98, v128, v128, v98
v_dot2_f32_bf16 v99, v129, v129, v99
v_dot2_f32_bf16 v98, v130, v130, v98
v_dot2_f32_bf16 v99, v131, v131, v99
v_dot2_f32_bf16 v98, v132, v132, v98
v_dot2_f32_bf16 v99, v133, v133, v99
v_dot2_f32_bf16 v98, v134, v134, v98
v_dot2_f32_bf16 v99, v135, v135, v99
v_dot2_f32_bf16 v98, v136, v136, v98
v_dot2_f32_bf16 v99, v137, v137, v99
v_dot2_f32_bf16 v98, v138, v138, v98
v_dot2_f32_bf16 v99, v139, v139, v99
v_add_f32_dpp v20, v20, v20 row_ror:8 row_mask:0xf bank_mask:0xf
v_lshlrev_b32 v120, 16, v122
v_and_b32 v121, 0xffff0000, v122
v_add_f32 v98, v98, v99
v_add_f32_dpp v20, v20, v20 row_ror:4 row_mask:0xf bank_mask:0xf
v_lshlrev_b32 v122, 16, v123
v_add_f32_dpp v98, v98, v98 row_ror:8 row_mask:0xf bank_mask:0xf
v_add_f32_dpp v20, v20, v20 row_ror:2 row_mask:0xf bank_mask:0xf
v_and_b32 v123, 0xffff0000, v123
v_add_f32_dpp v98, v98, v98 row_ror:4 row_mask:0xf bank_mask:0xf
buffer_load_dwordx4 v[168:171], v4, s[8:11], s61 offen offset:512
v_add_f32_dpp v20, v20, v20 row_ror:1 row_mask:0xf bank_mask:0xf
v_mul_f32 v20, 0x3acccccd, v20
v_add_f32_dpp v98, v98, v98 row_ror:2 row_mask:0xf bank_mask:0xf
s_nop 1
v_add_f32_dpp v98, v98, v98 row_ror:1 row_mask:0xf bank_mask:0xf
v_mul_f32 v98, 0x3acccccd, v98
v_fma_f32 v98, -v20, v20, v98
v_max_f32 v98, 0, v98
v_add_f32 v98, 0x3727c5ac, v98
v_rsq_f32 v98, v98
s_nop 0
v_mul_f32 v99, -v20, v98
v_pk_fma_f32 v[24:25], v[24:25], v[98:99], v[98:99] op_sel:[0,0,1] op_sel_hi:[1,0,1]
v_pk_fma_f32 v[26:27], v[26:27], v[98:99], v[98:99] op_sel:[0,0,1] op_sel_hi:[1,0,1]
v_pk_fma_f32 v[28:29], v[28:29], v[98:99], v[98:99] op_sel:[0,0,1] op_sel_hi:[1,0,1]
v_pk_fma_f32 v[30:31], v[30:31], v[98:99], v[98:99] op_sel:[0,0,1] op_sel_hi:[1,0,1]
v_cvt_pk_f16_f32 v124, v24, v25
v_cvt_pk_f16_f32 v125, v26, v27
v_cvt_pk_f16_f32 v126, v28, v29
v_cvt_pk_f16_f32 v127, v30, v31
v_lshlrev_b32 v24, 16, v128
v_and_b32 v25, 0xffff0000, v128
v_lshlrev_b32 v26, 16, v129
v_and_b32 v27, 0xffff0000, v129
v_lshlrev_b32 v28, 16, v130
buffer_load_dwordx4 v[172:175], v4, s[8:11], s61 offen offset:768
v_and_b32 v29, 0xffff0000, v130
v_lshlrev_b32 v30, 16, v131
v_and_b32 v31, 0xffff0000, v131
v_pk_fma_f32 v[24:25], v[24:25], v[98:99], v[98:99] op_sel:[0,0,1] op_sel_hi:[1,0,1]
v_pk_fma_f32 v[26:27], v[26:27], v[98:99], v[98:99] op_sel:[0,0,1] op_sel_hi:[1,0,1]
v_pk_fma_f32 v[28:29], v[28:29], v[98:99], v[98:99] op_sel:[0,0,1] op_sel_hi:[1,0,1]
v_pk_fma_f32 v[30:31], v[30:31], v[98:99], v[98:99] op_sel:[0,0,1] op_sel_hi:[1,0,1]
v_cvt_pk_f16_f32 v128, v24, v25
v_cvt_pk_f16_f32 v129, v26, v27
v_cvt_pk_f16_f32 v130, v28, v29
v_cvt_pk_f16_f32 v131, v30, v31
v_lshlrev_b32 v24, 16, v132
v_and_b32 v25, 0xffff0000, v132
v_lshlrev_b32 v26, 16, v133
v_and_b32 v27, 0xffff0000, v133
v_lshlrev_b32 v28, 16, v134
v_and_b32 v29, 0xffff0000, v134
v_lshlrev_b32 v30, 16, v135
v_and_b32 v31, 0xffff0000, v135
v_pk_fma_f32 v[24:25], v[24:25], v[98:99], v[98:99] op_sel:[0,0,1] op_sel_hi:[1,0,1]
v_pk_fma_f32 v[26:27], v[26:27], v[98:99], v[98:99] op_sel:[0,0,1] op_sel_hi:[1,0,1]
v_pk_fma_f32 v[28:29], v[28:29], v[98:99], v[98:99] op_sel:[0,0,1] op_sel_hi:[1,0,1]
v_pk_fma_f32 v[30:31], v[30:31], v[98:99], v[98:99] op_sel:[0,0,1] op_sel_hi:[1,0,1]
buffer_load_dwordx4 v[176:179], v4, s[8:11], s61 offen offset:1024
s_bfe_u32 s61, s62, 262160
s_mul_i32 s61, s61, 40960
s_add_u32 s61, s61, s45
v_cvt_pk_f16_f32 v132, v24, v25
v_cvt_pk_f16_f32 v133, v26, v27
v_cvt_pk_f16_f32 v134, v28, v29
v_cvt_pk_f16_f32 v135, v30, v31
v_lshlrev_b32 v24, 16, v136
v_and_b32 v25, 0xffff0000, v136
v_lshlrev_b32 v26, 16, v137
v_and_b32 v27, 0xffff0000, v137
v_lshlrev_b32 v28, 16, v138
v_and_b32 v29, 0xffff0000, v138
v_lshlrev_b32 v30, 16, v139
v_and_b32 v31, 0xffff0000, v139
v_pk_fma_f32 v[24:25], v[24:25], v[98:99], v[98:99] op_sel:[0,0,1] op_sel_hi:[1,0,1]
v_pk_fma_f32 v[26:27], v[26:27], v[98:99], v[98:99] op_sel:[0,0,1] op_sel_hi:[1,0,1]
v_pk_fma_f32 v[28:29], v[28:29], v[98:99], v[98:99] op_sel:[0,0,1] op_sel_hi:[1,0,1]
v_pk_fma_f32 v[30:31], v[30:31], v[98:99], v[98:99] op_sel:[0,0,1] op_sel_hi:[1,0,1]
v_pk_fma_f32 v[92:93], v[92:93], v[98:99], v[98:99] op_sel:[0,0,1] op_sel_hi:[1,0,1]
v_pk_fma_f32 v[94:95], v[94:95], v[98:99], v[98:99] op_sel:[0,0,1] op_sel_hi:[1,0,1]
v_pk_fma_f32 v[120:121], v[120:121], v[98:99], v[98:99] op_sel:[0,0,1] op_sel_hi:[1,0,1]
v_pk_fma_f32 v[122:123], v[122:123], v[98:99], v[98:99] op_sel:[0,0,1] op_sel_hi:[1,0,1]
v_cvt_pk_f16_f32 v136, v24, v25
v_cvt_pk_f16_f32 v137, v26, v27
v_cvt_pk_f16_f32 v138, v28, v29
v_cvt_pk_f16_f32 v139, v30, v31
s_waitcnt vmcnt(7)
buffer_store_dwordx4 v[240:243], v246, s[4:7], s53 offen sc1
s_barrier
s_waitcnt vmcnt(6)
s_mov_b32 s55, 0x3f803f80
buffer_load_dwordx4 v[180:183], v4, s[8:11], s61 offen offset:0
v_mfma_f32_16x16x32_bf16 v[20:23], a[236:239], v[140:143], 0
v_lshlrev_b32 v24, 16, v144
v_and_b32 v25, 0xffff0000, v144
v_mfma_f32_16x16x32_bf16 v[20:23], a[236:239], v[144:147], v[20:23]
v_lshlrev_b32 v26, 16, v145
v_and_b32 v27, 0xffff0000, v145
v_mfma_f32_16x16x32_bf16 v[20:23], a[236:239], v[148:151], v[20:23]
v_lshlrev_b32 v28, 16, v146
v_and_b32 v29, 0xffff0000, v146
v_mfma_f32_16x16x32_bf16 v[20:23], a[236:239], v[152:155], v[20:23]
buffer_load_dwordx4 v[184:187], v4, s[8:11], s61 offen offset:256
v_lshlrev_b32 v30, 16, v147
v_and_b32 v31, 0xffff0000, v147
v_mfma_f32_16x16x32_bf16 v[20:23], a[236:239], v[156:159], v[20:23]
v_lshlrev_b32 v72, 16, v140
v_and_b32 v73, 0xffff0000, v140
v_lshlrev_b32 v74, 16, v141
v_and_b32 v75, 0xffff0000, v141
v_dot2_f32_bf16 v84, v140, v140, 0
v_dot2_f32_bf16 v85, v141, v141, 0
v_dot2_f32_bf16 v84, v142, v142, v84
v_dot2_f32_bf16 v85, v143, v143, v85
buffer_load_dwordx4 v[188:191], v4, s[8:11], s61 offen offset:512
v_dot2_f32_bf16 v84, v144, v144, v84
v_dot2_f32_bf16 v85, v145, v145, v85
v_dot2_f32_bf16 v84, v146, v146, v84
v_dot2_f32_bf16 v85, v147, v147, v85
v_dot2_f32_bf16 v84, v148, v148, v84
v_dot2_f32_bf16 v85, v149, v149, v85
v_dot2_f32_bf16 v84, v150, v150, v84
v_dot2_f32_bf16 v85, v151, v151, v85
v_dot2_f32_bf16 v84, v152, v152, v84
v_dot2_f32_bf16 v85, v153, v153, v85
v_dot2_f32_bf16 v84, v154, v154, v84
buffer_load_dwordx4 v[192:195], v4, s[8:11], s61 offen offset:768
v_dot2_f32_bf16 v85, v155, v155, v85
v_dot2_f32_bf16 v84, v156, v156, v84
v_dot2_f32_bf16 v85, v157, v157, v85
v_dot2_f32_bf16 v84, v158, v158, v84
v_dot2_f32_bf16 v85, v159, v159, v85
v_add_f32_dpp v20, v20, v20 row_ror:8 row_mask:0xf bank_mask:0xf
v_lshlrev_b32 v140, 16, v142
v_and_b32 v141, 0xffff0000, v142
v_add_f32 v84, v84, v85
v_add_f32_dpp v20, v20, v20 row_ror:4 row_mask:0xf bank_mask:0xf
buffer_load_dwordx4 v[196:199], v4, s[8:11], s61 offen offset:1024
v_lshlrev_b32 v142, 16, v143
v_add_f32_dpp v84, v84, v84 row_ror:8 row_mask:0xf bank_mask:0xf
v_add_f32_dpp v20, v20, v20 row_ror:2 row_mask:0xf bank_mask:0xf
v_and_b32 v143, 0xffff0000, v143
v_add_f32_dpp v84, v84, v84 row_ror:4 row_mask:0xf bank_mask:0xf
v_add_f32_dpp v20, v20, v20 row_ror:1 row_mask:0xf bank_mask:0xf
v_mul_f32 v20, 0x3acccccd, v20
v_add_f32_dpp v84, v84, v84 row_ror:2 row_mask:0xf bank_mask:0xf
s_nop 1
v_add_f32_dpp v84, v84, v84 row_ror:1 row_mask:0xf bank_mask:0xf
v_mul_f32 v84, 0x3acccccd, v84
v_fma_f32 v84, -v20, v20, v84
s_add_u32 m0, s39, 0
s_nop 0
buffer_load_dwordx4 v232, s[24:27], s48 offen offset:0 lds
v_max_f32 v84, 0, v84
v_add_f32 v84, 0x3727c5ac, v84
v_rsq_f32 v84, v84
s_nop 0
v_mul_f32 v85, -v20, v84
v_pk_fma_f32 v[24:25], v[24:25], v[84:85], v[84:85] op_sel:[0,0,1] op_sel_hi:[1,0,1]
v_pk_fma_f32 v[26:27], v[26:27], v[84:85], v[84:85] op_sel:[0,0,1] op_sel_hi:[1,0,1]
v_pk_fma_f32 v[28:29], v[28:29], v[84:85], v[84:85] op_sel:[0,0,1] op_sel_hi:[1,0,1]
v_pk_fma_f32 v[30:31], v[30:31], v[84:85], v[84:85] op_sel:[0,0,1] op_sel_hi:[1,0,1]
v_cvt_pk_f16_f32 v144, v24, v25
v_cvt_pk_f16_f32 v145, v26, v27
buffer_load_dwordx4 v233, s[24:27], s48 offen offset:1024 lds
v_cvt_pk_f16_f32 v146, v28, v29
v_cvt_pk_f16_f32 v147, v30, v31
v_lshlrev_b32 v24, 16, v148
v_and_b32 v25, 0xffff0000, v148
v_lshlrev_b32 v26, 16, v149
v_and_b32 v27, 0xffff0000, v149
v_lshlrev_b32 v28, 16, v150
v_and_b32 v29, 0xffff0000, v150
v_lshlrev_b32 v30, 16, v151
v_and_b32 v31, 0xffff0000, v151
v_pk_fma_f32 v[24:25], v[24:25], v[84:85], v[84:85] op_sel:[0,0,1] op_sel_hi:[1,0,1]
buffer_load_dwordx4 v234, s[24:27], s48 offen offset:2048 lds
s_add_u32 s48, s48, 81920
v_pk_fma_f32 v[26:27], v[26:27], v[84:85], v[84:85] op_sel:[0,0,1] op_sel_hi:[1,0,1]
v_pk_fma_f32 v[28:29], v[28:29], v[84:85], v[84:85] op_sel:[0,0,1] op_sel_hi:[1,0,1]
v_pk_fma_f32 v[30:31], v[30:31], v[84:85], v[84:85] op_sel:[0,0,1] op_sel_hi:[1,0,1]
v_cvt_pk_f16_f32 v148, v24, v25
v_cvt_pk_f16_f32 v149, v26, v27
v_cvt_pk_f16_f32 v150, v28, v29
v_cvt_pk_f16_f32 v151, v30, v31
v_lshlrev_b32 v24, 16, v152
v_and_b32 v25, 0xffff0000, v152
v_lshlrev_b32 v26, 16, v153
v_and_b32 v27, 0xffff0000, v153
s_add_u32 m0, s39, 12288
s_nop 0
buffer_load_dwordx4 v232, s[24:27], s48 offen offset:0 lds
v_lshlrev_b32 v28, 16, v154
v_and_b32 v29, 0xffff0000, v154
v_lshlrev_b32 v30, 16, v155
v_and_b32 v31, 0xffff0000, v155
v_pk_fma_f32 v[24:25], v[24:25], v[84:85], v[84:85] op_sel:[0,0,1] op_sel_hi:[1,0,1]
v_pk_fma_f32 v[26:27], v[26:27], v[84:85], v[84:85] op_sel:[0,0,1] op_sel_hi:[1,0,1]
v_pk_fma_f32 v[28:29], v[28:29], v[84:85], v[84:85] op_sel:[0,0,1] op_sel_hi:[1,0,1]
v_pk_fma_f32 v[30:31], v[30:31], v[84:85], v[84:85] op_sel:[0,0,1] op_sel_hi:[1,0,1]
v_cvt_pk_f16_f32 v152, v24, v25
v_cvt_pk_f16_f32 v153, v26, v27
buffer_load_dwordx4 v233, s[24:27], s48 offen offset:1024 lds
v_cvt_pk_f16_f32 v154, v28, v29
v_cvt_pk_f16_f32 v155, v30, v31
v_lshlrev_b32 v24, 16, v156
v_and_b32 v25, 0xffff0000, v156
v_lshlrev_b32 v26, 16, v157
v_and_b32 v27, 0xffff0000, v157
v_lshlrev_b32 v28, 16, v158
v_and_b32 v29, 0xffff0000, v158
v_lshlrev_b32 v30, 16, v159
v_and_b32 v31, 0xffff0000, v159
v_pk_fma_f32 v[24:25], v[24:25], v[84:85], v[84:85] op_sel:[0,0,1] op_sel_hi:[1,0,1]
buffer_load_dwordx4 v234, s[24:27], s48 offen offset:2048 lds
s_add_u32 s48, s48, 81920
v_pk_fma_f32 v[26:27], v[26:27], v[84:85], v[84:85] op_sel:[0,0,1] op_sel_hi:[1,0,1]
v_pk_fma_f32 v[28:29], v[28:29], v[84:85], v[84:85] op_sel:[0,0,1] op_sel_hi:[1,0,1]
v_pk_fma_f32 v[30:31], v[30:31], v[84:85], v[84:85] op_sel:[0,0,1] op_sel_hi:[1,0,1]
v_pk_fma_f32 v[72:73], v[72:73], v[84:85], v[84:85] op_sel:[0,0,1] op_sel_hi:[1,0,1]
v_pk_fma_f32 v[74:75], v[74:75], v[84:85], v[84:85] op_sel:[0,0,1] op_sel_hi:[1,0,1]
v_pk_fma_f32 v[140:141], v[140:141], v[84:85], v[84:85] op_sel:[0,0,1] op_sel_hi:[1,0,1]
v_pk_fma_f32 v[142:143], v[142:143], v[84:85], v[84:85] op_sel:[0,0,1] op_sel_hi:[1,0,1]
v_cvt_pk_f16_f32 v156, v24, v25
v_cvt_pk_f16_f32 v157, v26, v27
v_cvt_pk_f16_f32 v158, v28, v29
v_cvt_pk_f16_f32 v159, v30, v31
s_waitcnt vmcnt(12)
s_mov_b32 s55, 0x3f803f80
buffer_store_dwordx4 a[232:235], v11, s[4:7], s46 offen sc1
v_mfma_f32_16x16x32_bf16 v[20:23], a[236:239], v[160:163], 0
v_lshlrev_b32 v24, 16, v164
v_and_b32 v25, 0xffff0000, v164
v_mfma_f32_16x16x32_bf16 v[20:23], a[236:239], v[164:167], v[20:23]
v_lshlrev_b32 v26, 16, v165
v_and_b32 v27, 0xffff0000, v165
v_mfma_f32_16x16x32_bf16 v[20:23], a[236:239], v[168:171], v[20:23]
v_lshlrev_b32 v28, 16, v166
v_and_b32 v29, 0xffff0000, v166
v_mfma_f32_16x16x32_bf16 v[20:23], a[236:239], v[172:175], v[20:23]
v_lshlrev_b32 v30, 16, v167
v_and_b32 v31, 0xffff0000, v167
v_mfma_f32_16x16x32_bf16 v[20:23], a[236:239], v[176:179], v[20:23]
v_lshlrev_b32 v76, 16, v160
v_and_b32 v77, 0xffff0000, v160
v_lshlrev_b32 v78, 16, v161
v_and_b32 v79, 0xffff0000, v161
buffer_store_dwordx4 a[232:235], v12, s[4:7], s46 offen sc1
v_dot2_f32_bf16 v86, v160, v160, 0
v_dot2_f32_bf16 v87, v161, v161, 0
v_dot2_f32_bf16 v86, v162, v162, v86
v_dot2_f32_bf16 v87, v163, v163, v87
v_dot2_f32_bf16 v86, v164, v164, v86
v_dot2_f32_bf16 v87, v165, v165, v87
v_dot2_f32_bf16 v86, v166, v166, v86
v_dot2_f32_bf16 v87, v167, v167, v87
v_dot2_f32_bf16 v86, v168, v168, v86
v_dot2_f32_bf16 v87, v169, v169, v87
v_dot2_f32_bf16 v86, v170, v170, v86
v_dot2_f32_bf16 v87, v171, v171, v87
v_dot2_f32_bf16 v86, v172, v172, v86
v_dot2_f32_bf16 v87, v173, v173, v87
v_dot2_f32_bf16 v86, v174, v174, v86
v_dot2_f32_bf16 v87, v175, v175, v87
buffer_store_dwordx4 a[232:235], v13, s[4:7], s46 offen sc1
v_dot2_f32_bf16 v86, v176, v176, v86
v_dot2_f32_bf16 v87, v177, v177, v87
v_dot2_f32_bf16 v86, v178, v178, v86
v_dot2_f32_bf16 v87, v179, v179, v87
v_add_f32_dpp v20, v20, v20 row_ror:8 row_mask:0xf bank_mask:0xf
v_lshlrev_b32 v160, 16, v162
v_and_b32 v161, 0xffff0000, v162
v_add_f32 v86, v86, v87
v_add_f32_dpp v20, v20, v20 row_ror:4 row_mask:0xf bank_mask:0xf
v_lshlrev_b32 v162, 16, v163
v_add_f32_dpp v86, v86, v86 row_ror:8 row_mask:0xf bank_mask:0xf
v_add_f32_dpp v20, v20, v20 row_ror:2 row_mask:0xf bank_mask:0xf
v_and_b32 v163, 0xffff0000, v163
v_add_f32_dpp v86, v86, v86 row_ror:4 row_mask:0xf bank_mask:0xf
v_add_f32_dpp v20, v20, v20 row_ror:1 row_mask:0xf bank_mask:0xf
v_mul_f32 v20, 0x3acccccd, v20
v_add_f32_dpp v86, v86, v86 row_ror:2 row_mask:0xf bank_mask:0xf
buffer_store_dwordx4 a[232:235], v14, s[4:7], s46 offen sc1
s_nop 0
v_add_f32_dpp v86, v86, v86 row_ror:1 row_mask:0xf bank_mask:0xf
v_mul_f32 v86, 0x3acccccd, v86
v_fma_f32 v86, -v20, v20, v86
v_max_f32 v86, 0, v86
v_add_f32 v86, 0x3727c5ac, v86
v_rsq_f32 v86, v86
s_nop 0
v_mul_f32 v87, -v20, v86
v_pk_fma_f32 v[24:25], v[24:25], v[86:87], v[86:87] op_sel:[0,0,1] op_sel_hi:[1,0,1]
v_pk_fma_f32 v[26:27], v[26:27], v[86:87], v[86:87] op_sel:[0,0,1] op_sel_hi:[1,0,1]
v_pk_fma_f32 v[28:29], v[28:29], v[86:87], v[86:87] op_sel:[0,0,1] op_sel_hi:[1,0,1]
v_pk_fma_f32 v[30:31], v[30:31], v[86:87], v[86:87] op_sel:[0,0,1] op_sel_hi:[1,0,1]
v_cvt_pk_f16_f32 v164, v24, v25
v_cvt_pk_f16_f32 v165, v26, v27
v_cvt_pk_f16_f32 v166, v28, v29
v_cvt_pk_f16_f32 v167, v30, v31
v_lshlrev_b32 v24, 16, v168
v_and_b32 v25, 0xffff0000, v168
buffer_store_dwordx4 a[232:235], v246, s[4:7], s18 offen sc1
v_lshlrev_b32 v26, 16, v169
v_and_b32 v27, 0xffff0000, v169
v_lshlrev_b32 v28, 16, v170
v_and_b32 v29, 0xffff0000, v170
v_lshlrev_b32 v30, 16, v171
v_and_b32 v31, 0xffff0000, v171
v_pk_fma_f32 v[24:25], v[24:25], v[86:87], v[86:87] op_sel:[0,0,1] op_sel_hi:[1,0,1]
v_pk_fma_f32 v[26:27], v[26:27], v[86:87], v[86:87] op_sel:[0,0,1] op_sel_hi:[1,0,1]
v_pk_fma_f32 v[28:29], v[28:29], v[86:87], v[86:87] op_sel:[0,0,1] op_sel_hi:[1,0,1]
v_pk_fma_f32 v[30:31], v[30:31], v[86:87], v[86:87] op_sel:[0,0,1] op_sel_hi:[1,0,1]
v_cvt_pk_f16_f32 v168, v24, v25
v_cvt_pk_f16_f32 v169, v26, v27
v_cvt_pk_f16_f32 v170, v28, v29
v_cvt_pk_f16_f32 v171, v30, v31
v_lshlrev_b32 v24, 16, v172
v_and_b32 v25, 0xffff0000, v172
s_add_u32 s37, s18, 8192
buffer_store_dwordx4 a[232:235], v246, s[4:7], s37 offen sc1
v_lshlrev_b32 v26, 16, v173
v_and_b32 v27, 0xffff0000, v173
v_lshlrev_b32 v28, 16, v174
v_and_b32 v29, 0xffff0000, v174
v_lshlrev_b32 v30, 16, v175
v_and_b32 v31, 0xffff0000, v175
v_pk_fma_f32 v[24:25], v[24:25], v[86:87], v[86:87] op_sel:[0,0,1] op_sel_hi:[1,0,1]
v_pk_fma_f32 v[26:27], v[26:27], v[86:87], v[86:87] op_sel:[0,0,1] op_sel_hi:[1,0,1]
v_pk_fma_f32 v[28:29], v[28:29], v[86:87], v[86:87] op_sel:[0,0,1] op_sel_hi:[1,0,1]
v_pk_fma_f32 v[30:31], v[30:31], v[86:87], v[86:87] op_sel:[0,0,1] op_sel_hi:[1,0,1]
v_cvt_pk_f16_f32 v172, v24, v25
v_cvt_pk_f16_f32 v173, v26, v27
v_cvt_pk_f16_f32 v174, v28, v29
v_cvt_pk_f16_f32 v175, v30, v31
v_lshlrev_b32 v24, 16, v176
v_and_b32 v25, 0xffff0000, v176
v_lshlrev_b32 v26, 16, v177
s_lshl_b32 s37, s47, 2
s_add_u32 s37, s37, s3
s_lshl_b32 s37, s37, 3
s_add_u32 s37, s37, s96
s_lshl_b32 s37, s37, 8
s_add_u32 s37, s37, 131072
v_lshlrev_b32 v69, 2, v1
v_xor_b32 v70, 0xff, v19
buffer_store_dword v70, v69, s[4:7], s37 offen sc1
v_and_b32 v27, 0xffff0000, v177
v_lshlrev_b32 v28, 16, v178
v_and_b32 v29, 0xffff0000, v178
v_lshlrev_b32 v30, 16, v179
v_and_b32 v31, 0xffff0000, v179
v_pk_fma_f32 v[24:25], v[24:25], v[86:87], v[86:87] op_sel:[0,0,1] op_sel_hi:[1,0,1]
v_pk_fma_f32 v[26:27], v[26:27], v[86:87], v[86:87] op_sel:[0,0,1] op_sel_hi:[1,0,1]
v_pk_fma_f32 v[28:29], v[28:29], v[86:87], v[86:87] op_sel:[0,0,1] op_sel_hi:[1,0,1]
v_pk_fma_f32 v[30:31], v[30:31], v[86:87], v[86:87] op_sel:[0,0,1] op_sel_hi:[1,0,1]
v_pk_fma_f32 v[76:77], v[76:77], v[86:87], v[86:87] op_sel:[0,0,1] op_sel_hi:[1,0,1]
v_pk_fma_f32 v[78:79], v[78:79], v[86:87], v[86:87] op_sel:[0,0,1] op_sel_hi:[1,0,1]
v_pk_fma_f32 v[160:161], v[160:161], v[86:87], v[86:87] op_sel:[0,0,1] op_sel_hi:[1,0,1]
v_pk_fma_f32 v[162:163], v[162:163], v[86:87], v[86:87] op_sel:[0,0,1] op_sel_hi:[1,0,1]
v_cvt_pk_f16_f32 v176, v24, v25
v_cvt_pk_f16_f32 v177, v26, v27
v_cvt_pk_f16_f32 v178, v28, v29
v_cvt_pk_f16_f32 v179, v30, v31
buffer_load_dwordx4 v[40:43], v248, s[4:7], s56 offen sc1
s_waitcnt vmcnt(14)
s_mov_b32 s55, 0x3f803f80
v_mfma_f32_16x16x32_bf16 v[20:23], a[236:239], v[180:183], 0
v_lshlrev_b32 v24, 16, v184
v_and_b32 v25, 0xffff0000, v184
v_mfma_f32_16x16x32_bf16 v[20:23], a[236:239], v[184:187], v[20:23]
v_lshlrev_b32 v26, 16, v185
v_and_b32 v27, 0xffff0000, v185
v_mfma_f32_16x16x32_bf16 v[20:23], a[236:239], v[188:191], v[20:23]
buffer_load_dwordx4 v[44:47], v248, s[4:7], s57 offen sc1
v_lshlrev_b32 v28, 16, v186
v_and_b32 v29, 0xffff0000, v186
v_mfma_f32_16x16x32_bf16 v[20:23], a[236:239], v[192:195], v[20:23]
v_lshlrev_b32 v30, 16, v187
v_and_b32 v31, 0xffff0000, v187
v_mfma_f32_16x16x32_bf16 v[20:23], a[236:239], v[196:199], v[20:23]
v_lshlrev_b32 v80, 16, v180
v_and_b32 v81, 0xffff0000, v180
v_lshlrev_b32 v82, 16, v181
buffer_load_dwordx4 v[48:51], v248, s[4:7], s58 offen sc1
v_and_b32 v83, 0xffff0000, v181
v_dot2_f32_bf16 v66, v180, v180, 0
v_dot2_f32_bf16 v67, v181, v181, 0
v_dot2_f32_bf16 v66, v182, v182, v66
v_dot2_f32_bf16 v67, v183, v183, v67
v_dot2_f32_bf16 v66, v184, v184, v66
v_dot2_f32_bf16 v67, v185, v185, v67
v_dot2_f32_bf16 v66, v186, v186, v66
v_dot2_f32_bf16 v67, v187, v187, v67
buffer_load_dword v52, v249, s[4:7], s56 offen sc1
v_dot2_f32_bf16 v66, v188, v188, v66
v_dot2_f32_bf16 v67, v189, v189, v67
v_dot2_f32_bf16 v66, v190, v190, v66
v_dot2_f32_bf16 v67, v191, v191, v67
v_dot2_f32_bf16 v66, v192, v192, v66
v_dot2_f32_bf16 v67, v193, v193, v67
v_dot2_f32_bf16 v66, v194, v194, v66
v_dot2_f32_bf16 v67, v195, v195, v67
v_dot2_f32_bf16 v66, v196, v196, v66
buffer_load_dword v53, v249, s[4:7], s57 offen sc1
v_dot2_f32_bf16 v67, v197, v197, v67
v_dot2_f32_bf16 v66, v198, v198, v66
v_dot2_f32_bf16 v67, v199, v199, v67
v_add_f32_dpp v20, v20, v20 row_ror:8 row_mask:0xf bank_mask:0xf
v_lshlrev_b32 v180, 16, v182
v_and_b32 v181, 0xffff0000, v182
v_add_f32 v66, v66, v67
v_add_f32_dpp v20, v20, v20 row_ror:4 row_mask:0xf bank_mask:0xf
v_lshlrev_b32 v182, 16, v183
buffer_load_dword v54, v249, s[4:7], s58 offen sc1
v_add_f32_dpp v66, v66, v66 row_ror:8 row_mask:0xf bank_mask:0xf
v_add_f32_dpp v20, v20, v20 row_ror:2 row_mask:0xf bank_mask:0xf
v_and_b32 v183, 0xffff0000, v183
v_add_f32_dpp v66, v66, v66 row_ror:4 row_mask:0xf bank_mask:0xf
v_add_f32_dpp v20, v20, v20 row_ror:1 row_mask:0xf bank_mask:0xf
v_mul_f32 v20, 0x3acccccd, v20
v_add_f32_dpp v66, v66, v66 row_ror:2 row_mask:0xf bank_mask:0xf
s_nop 1
v_add_f32_dpp v66, v66, v66 row_ror:1 row_mask:0xf bank_mask:0xf
v_mul_f32 v66, 0x3acccccd, v66
buffer_load_dword v71, v247, s[4:7], s60 offen sc1
v_fma_f32 v66, -v20, v20, v66
v_max_f32 v66, 0, v66
v_add_f32 v66, 0x3727c5ac, v66
v_rsq_f32 v66, v66
s_nop 0
v_mul_f32 v67, -v20, v66
v_pk_fma_f32 v[24:25], v[24:25], v[66:67], v[66:67] op_sel:[0,0,1] op_sel_hi:[1,0,1]
v_pk_fma_f32 v[26:27], v[26:27], v[66:67], v[66:67] op_sel:[0,0,1] op_sel_hi:[1,0,1]
v_pk_fma_f32 v[28:29], v[28:29], v[66:67], v[66:67] op_sel:[0,0,1] op_sel_hi:[1,0,1]
v_pk_fma_f32 v[30:31], v[30:31], v[66:67], v[66:67] op_sel:[0,0,1] op_sel_hi:[1,0,1]
v_cvt_pk_f16_f32 v184, v24, v25
s_add_u32 m0, s39, 24576
s_nop 0
buffer_load_dwordx4 v232, s[24:27], s48 offen offset:0 lds
v_cvt_pk_f16_f32 v185, v26, v27
v_cvt_pk_f16_f32 v186, v28, v29
v_cvt_pk_f16_f32 v187, v30, v31
v_lshlrev_b32 v24, 16, v188
v_and_b32 v25, 0xffff0000, v188
v_lshlrev_b32 v26, 16, v189
v_and_b32 v27, 0xffff0000, v189
v_lshlrev_b32 v28, 16, v190
v_and_b32 v29, 0xffff0000, v190
buffer_load_dwordx4 v233, s[24:27], s48 offen offset:1024 lds
v_lshlrev_b32 v30, 16, v191
v_and_b32 v31, 0xffff0000, v191
v_pk_fma_f32 v[24:25], v[24:25], v[66:67], v[66:67] op_sel:[0,0,1] op_sel_hi:[1,0,1]
v_pk_fma_f32 v[26:27], v[26:27], v[66:67], v[66:67] op_sel:[0,0,1] op_sel_hi:[1,0,1]
v_pk_fma_f32 v[28:29], v[28:29], v[66:67], v[66:67] op_sel:[0,0,1] op_sel_hi:[1,0,1]
v_pk_fma_f32 v[30:31], v[30:31], v[66:67], v[66:67] op_sel:[0,0,1] op_sel_hi:[1,0,1]
v_cvt_pk_f16_f32 v188, v24, v25
v_cvt_pk_f16_f32 v189, v26, v27
v_cvt_pk_f16_f32 v190, v28, v29
buffer_load_dwordx4 v234, s[24:27], s48 offen offset:2048 lds
s_add_u32 s48, s48, 81920
v_cvt_pk_f16_f32 v191, v30, v31
v_lshlrev_b32 v24, 16, v192
v_and_b32 v25, 0xffff0000, v192
v_lshlrev_b32 v26, 16, v193
v_and_b32 v27, 0xffff0000, v193
v_lshlrev_b32 v28, 16, v194
v_and_b32 v29, 0xffff0000, v194
v_lshlrev_b32 v30, 16, v195
v_and_b32 v31, 0xffff0000, v195
s_add_u32 m0, s39, 36864
s_nop 0
buffer_load_dwordx4 v232, s[24:27], s48 offen offset:0 lds
v_pk_fma_f32 v[24:25], v[24:25], v[66:67], v[66:67] op_sel:[0,0,1] op_sel_hi:[1,0,1]
v_pk_fma_f32 v[26:27], v[26:27], v[66:67], v[66:67] op_sel:[0,0,1] op_sel_hi:[1,0,1]
v_pk_fma_f32 v[28:29], v[28:29], v[66:67], v[66:67] op_sel:[0,0,1] op_sel_hi:[1,0,1]
v_pk_fma_f32 v[30:31], v[30:31], v[66:67], v[66:67] op_sel:[0,0,1] op_sel_hi:[1,0,1]
v_cvt_pk_f16_f32 v192, v24, v25
v_cvt_pk_f16_f32 v193, v26, v27
v_cvt_pk_f16_f32 v194, v28, v29
v_cvt_pk_f16_f32 v195, v30, v31
v_lshlrev_b32 v24, 16, v196
buffer_load_dwordx4 v233, s[24:27], s48 offen offset:1024 lds
v_and_b32 v25, 0xffff0000, v196
v_lshlrev_b32 v26, 16, v197
v_and_b32 v27, 0xffff0000, v197
v_lshlrev_b32 v28, 16, v198
v_and_b32 v29, 0xffff0000, v198
v_lshlrev_b32 v30, 16, v199
v_and_b32 v31, 0xffff0000, v199
v_pk_fma_f32 v[24:25], v[24:25], v[66:67], v[66:67] op_sel:[0,0,1] op_sel_hi:[1,0,1]
v_pk_fma_f32 v[26:27], v[26:27], v[66:67], v[66:67] op_sel:[0,0,1] op_sel_hi:[1,0,1]
buffer_load_dwordx4 v234, s[24:27], s48 offen offset:2048 lds
s_add_u32 s48, s48, 81920
v_pk_fma_f32 v[28:29], v[28:29], v[66:67], v[66:67] op_sel:[0,0,1] op_sel_hi:[1,0,1]
v_pk_fma_f32 v[30:31], v[30:31], v[66:67], v[66:67] op_sel:[0,0,1] op_sel_hi:[1,0,1]
v_pk_fma_f32 v[80:81], v[80:81], v[66:67], v[66:67] op_sel:[0,0,1] op_sel_hi:[1,0,1]
v_pk_fma_f32 v[82:83], v[82:83], v[66:67], v[66:67] op_sel:[0,0,1] op_sel_hi:[1,0,1]
v_pk_fma_f32 v[180:181], v[180:181], v[66:67], v[66:67] op_sel:[0,0,1] op_sel_hi:[1,0,1]
v_pk_fma_f32 v[182:183], v[182:183], v[66:67], v[66:67] op_sel:[0,0,1] op_sel_hi:[1,0,1]
v_cvt_pk_f16_f32 v196, v24, v25
v_cvt_pk_f16_f32 v197, v26, v27
v_cvt_pk_f16_f32 v198, v28, v29
v_cvt_pk_f16_f32 v199, v30, v31
L_bodyj:
s_and_b32 s12, s40, 0xff
s_bfe_u32 s13, s40, 0x80008
s_bfe_u32 s14, s40, 0x80010
s_lshr_b32 s15, s40, 24
s_waitcnt vmcnt(7)
v_xor_b32 v40, s12, v40
v_xor_b32 v41, s13, v41
v_xor_b32 v42, s14, v42
v_xor_b32 v43, s15, v43
v_xor_b32 v44, s12, v44
v_xor_b32 v45, s13, v45
v_xor_b32 v46, s14, v46
v_xor_b32 v47, s15, v47
v_xor_b32 v48, s12, v48
v_xor_b32 v49, s13, v49
v_xor_b32 v50, s14, v50
v_xor_b32 v51, s15, v51
v_xor_b32 v52, v19, v52
v_xor_b32 v53, v19, v53
v_xor_b32 v54, v19, v54
v_or3_b32 v64, v40, v41, v42
v_or3_b32 v65, v43, v44, v45
v_or3_b32 v64, v64, v46, v47
v_or3_b32 v65, v65, v48, v49
v_or3_b32 v64, v64, v50, v51
v_or3_b32 v65, v65, v52, v53
v_or3_b32 v64, v64, v65, v54
v_and_b32 v64, 0xff, v64
v_cmp_ne_u32 vcc, 0, v64
s_cbranch_vccnz L_ga_retry
L_ga_ok:
v_pk_add_f32 v[40:41], v[40:41], v[44:45]
v_pk_add_f32 v[42:43], v[42:43], v[46:47]
v_add_f32 v52, v52, v53
v_pk_add_f32 v[40:41], v[40:41], v[48:49]
v_pk_add_f32 v[42:43], v[42:43], v[50:51]
v_add_f32 v52, v52, v54
v_cvt_pk_bf16_f32 v44, v40, v41
v_cvt_pk_bf16_f32 v45, v42, v43
v_cvt_pk_bf16_f32 v52, v52, v52
v_lshlrev_b32 v40, 16, v44
v_and_b32 v41, 0xffff0000, v44
v_lshlrev_b32 v42, 16, v45
v_and_b32 v43, 0xffff0000, v45
v_lshlrev_b32 v52, 16, v52
v_pk_add_f32 v[40:41], v[40:41], v[252:253] op_sel_hi:[1,0]
v_pk_add_f32 v[42:43], v[42:43], v[252:253] op_sel_hi:[1,0]
v_add_f32 v52, v52, v252
v_cvt_pk_bf16_f32 v44, v40, v41
v_cvt_pk_bf16_f32 v45, v42, v43
v_cvt_pk_bf16_f32 v52, v52, v52
v_lshlrev_b32 v40, 16, v44
v_and_b32 v41, 0xffff0000, v44
v_lshlrev_b32 v42, 16, v45
v_and_b32 v43, 0xffff0000, v45
v_lshlrev_b32 v52, 16, v52
ds_write_b128 v251, v[40:43]
ds_write_b32 v250, v52
s_waitcnt vmcnt(6)
v_cmp_ne_u32 vcc, s40, v71
s_cbranch_vccnz L_fg_retry
L_fg_ok:
s_waitcnt lgkmcnt(0)
s_barrier
buffer_load_dwordx4 a[40:43], v5, s[4:7], s59 offen offset:0 sc1
ds_read_b128 v[200:203], v10 offset:2560
ds_read_b128 v[204:207], v10 offset:2576
ds_read_b128 v[208:211], v10 offset:0
ds_read_b128 v[212:215], v10 offset:16
buffer_load_dwordx4 a[44:47], v5, s[4:7], s59 offen offset:256 sc1
s_mul_i32 s52, s96, 192
s_mul_i32 s49, s3, 3072
s_lshl_b32 s53, s47, 2
s_add_u32 s53, s53, s3
s_and_b32 s50, s53, 63
buffer_load_dwordx4 a[48:51], v5, s[4:7], s59 offen offset:512 sc1
s_waitcnt lgkmcnt(0)
v_pk_fma_f32 v[216:217], v[88:89], v[200:201], v[208:209]
v_cvt_pk_bf16_f32 v220, v216, v217
v_pk_fma_f32 v[218:219], v[90:91], v[202:203], v[210:211]
v_cvt_pk_bf16_f32 v221, v218, v219
buffer_load_dwordx4 a[52:55], v6, s[4:7], s59 offen offset:768 sc1
s_add_u32 s59, s59, 16384
v_pk_fma_f32 v[216:217], v[100:101], v[204:205], v[212:213]
v_cvt_pk_bf16_f32 v222, v216, v217
v_pk_fma_f32 v[218:219], v[102:103], v[206:207], v[214:215]
v_cvt_pk_bf16_f32 v223, v218, v219
ds_write_b128 v7, v[220:223] offset:0
buffer_load_dwordx4 a[56:59], v5, s[4:7], s59 offen offset:0 sc1
v_pk_fma_f32 v[216:217], v[92:93], v[200:201], v[208:209]
v_cvt_pk_bf16_f32 v224, v216, v217
v_pk_fma_f32 v[218:219], v[94:95], v[202:203], v[210:211]
v_cvt_pk_bf16_f32 v225, v218, v219
v_pk_fma_f32 v[216:217], v[120:121], v[204:205], v[212:213]
buffer_load_dwordx4 a[60:63], v5, s[4:7], s59 offen offset:256 sc1
v_cvt_pk_bf16_f32 v226, v216, v217
v_pk_fma_f32 v[218:219], v[122:123], v[206:207], v[214:215]
v_cvt_pk_bf16_f32 v227, v218, v219
ds_write_b128 v253, v[224:227] offset:0
v_pk_fma_f32 v[216:217], v[72:73], v[200:201], v[208:209]
buffer_load_dwordx4 a[64:67], v5, s[4:7], s59 offen offset:512 sc1
v_cvt_pk_bf16_f32 v220, v216, v217
v_pk_fma_f32 v[218:219], v[74:75], v[202:203], v[210:211]
v_cvt_pk_bf16_f32 v221, v218, v219
v_pk_fma_f32 v[216:217], v[140:141], v[204:205], v[212:213]
v_cvt_pk_bf16_f32 v222, v216, v217
buffer_load_dwordx4 a[68:71], v6, s[4:7], s59 offen offset:768 sc1
s_add_u32 s59, s59, 16384
v_pk_fma_f32 v[218:219], v[142:143], v[206:207], v[214:215]
v_cvt_pk_bf16_f32 v223, v218, v219
ds_write_b128 v254, v[220:223] offset:0
v_pk_fma_f32 v[216:217], v[76:77], v[200:201], v[208:209]
v_cvt_pk_bf16_f32 v224, v216, v217
buffer_load_dwordx4 a[72:75], v5, s[4:7], s59 offen offset:0 sc1
v_pk_fma_f32 v[218:219], v[78:79], v[202:203], v[210:211]
v_cvt_pk_bf16_f32 v225, v218, v219
v_pk_fma_f32 v[216:217], v[160:161], v[204:205], v[212:213]
v_cvt_pk_bf16_f32 v226, v216, v217
v_pk_fma_f32 v[218:219], v[162:163], v[206:207], v[214:215]
buffer_load_dwordx4 a[76:79], v5, s[4:7], s59 offen offset:256 sc1
v_cvt_pk_bf16_f32 v227, v218, v219
ds_write_b128 v244, v[224:227] offset:0
v_pk_fma_f32 v[216:217], v[80:81], v[200:201], v[208:209]
v_cvt_pk_bf16_f32 v220, v216, v217
v_pk_fma_f32 v[218:219], v[82:83], v[202:203], v[210:211]
buffer_load_dwordx4 a[80:83], v5, s[4:7], s59 offen offset:512 sc1
v_cvt_pk_bf16_f32 v221, v218, v219
v_pk_fma_f32 v[216:217], v[180:181], v[204:205], v[212:213]
v_cvt_pk_bf16_f32 v222, v216, v217
v_pk_fma_f32 v[218:219], v[182:183], v[206:207], v[214:215]
v_cvt_pk_bf16_f32 v223, v218, v219
buffer_load_dwordx4 a[84:87], v6, s[4:7], s59 offen offset:768 sc1
s_add_u32 s59, s59, 16384
ds_write_b128 v245, v[220:223] offset:0
ds_read_b128 v[200:203], v10 offset:3072
ds_read_b128 v[204:207], v10 offset:3088
ds_read_b128 v[208:211], v10 offset:512
ds_read_b128 v[212:215], v10 offset:528
s_lshl_b32 s50, s50, 5
s_lshr_b32 s54, s53, 6
s_add_u32 s54, s50, s54
s_mul_i32 s50, s54, 1280
s_add_u32 s50, s50, s52
s_lshl_b32 s51, s52, 1
s_add_u32 s51, s51, 65536
s_add_u32 s22, s51, 5120
s_mov_b32 s23, 917504
s_mul_i32 s12, s3, 2304
s_add_u32 s12, s12, 152320
s_add_u32 s13, s49, 122880
s_waitcnt lgkmcnt(4)
s_barrier
ds_read_b128 a[0:3], v8 offset:0
ds_read_b128 a[4:7], v8 offset:1024
ds_read_b128 a[8:11], v8 offset:2048
ds_read_b128 a[12:15], v8 offset:3072
ds_read_b128 a[16:19], v8 offset:4096
s_lshl_b32 s14, s53, 11
s_add_u32 s14, s14, 131072
s_mul_i32 s61, s3, 40
s_add_u32 s61, s61, 138240
s_waitcnt vmcnt(8) lgkmcnt(0)
v_mfma_f32_16x16x32_bf16 v[20:23], a[40:43], a[0:3], 0
ds_read_b128 a[20:23], v9 offset:5120
v_fma_mix_f32 v216, v104, v200, v208 op_sel:[0,0,0] op_sel_hi:[1,0,0]
v_mfma_f32_16x16x32_bf16 v[24:27], a[44:47], a[0:3], 0
buffer_load_dwordx4 a[88:91], v5, s[4:7], s59 offen offset:0 sc1
v_fma_mix_f32 v217, v104, v201, v209 op_sel:[1,0,0] op_sel_hi:[1,0,0]
v_mfma_f32_16x16x32_bf16 v[28:31], a[0:3], a[48:51], 0
ds_read_b128 a[24:27], v9 offset:6144
v_cvt_pk_bf16_f32 v220, v216, v217
v_mfma_f32_16x16x32_bf16 v[32:35], a[52:55], a[0:3], 0
ds_read_b128 a[28:31], v9 offset:7168
v_fma_mix_f32 v218, v105, v202, v210 op_sel:[0,0,0] op_sel_hi:[1,0,0]
v_mfma_f32_16x16x32_bf16 v[36:39], a[40:43], a[4:7], 0
ds_read_b128 a[32:35], v9 offset:8192
v_fma_mix_f32 v219, v105, v203, v211 op_sel:[1,0,0] op_sel_hi:[1,0,0]
v_mfma_f32_16x16x32_bf16 v[40:43], a[44:47], a[4:7], 0
buffer_load_dwordx4 a[92:95], v5, s[4:7], s59 offen offset:256 sc1
v_cvt_pk_bf16_f32 v221, v218, v219
v_mfma_f32_16x16x32_bf16 v[44:47], a[4:7], a[48:51], 0
ds_read_b128 a[36:39], v9 offset:9216
v_fma_mix_f32 v216, v106, v204, v212 op_sel:[0,0,0] op_sel_hi:[1,0,0]
v_mfma_f32_16x16x32_bf16 v[48:51], a[52:55], a[4:7], 0
v_fma_mix_f32 v217, v106, v205, v213 op_sel:[1,0,0] op_sel_hi:[1,0,0]
v_cvt_pk_bf16_f32 v222, v216, v217
v_mfma_f32_16x16x32_bf16 v[52:55], a[40:43], a[8:11], 0
v_fma_mix_f32 v218, v107, v206, v214 op_sel:[0,0,0] op_sel_hi:[1,0,0]
v_fma_mix_f32 v219, v107, v207, v215 op_sel:[1,0,0] op_sel_hi:[1,0,0]
v_mfma_f32_16x16x32_bf16 v[56:59], a[44:47], a[8:11], 0
buffer_load_dwordx4 a[96:99], v5, s[4:7], s59 offen offset:512 sc1
v_cvt_pk_bf16_f32 v223, v218, v219
v_mfma_f32_16x16x32_bf16 v[60:63], a[8:11], a[48:51], 0
v_fma_mix_f32 v216, v124, v200, v208 op_sel:[0,0,0] op_sel_hi:[1,0,0]
v_fma_mix_f32 v217, v124, v201, v209 op_sel:[1,0,0] op_sel_hi:[1,0,0]
v_mfma_f32_16x16x32_bf16 v[64:67], a[52:55], a[8:11], 0
ds_write_b128 v7, v[220:223] offset:20480
v_mfma_f32_16x16x32_bf16 v[68:71], a[40:43], a[12:15], 0
v_cvt_pk_bf16_f32 v224, v216, v217
v_fma_mix_f32 v218, v125, v202, v210 op_sel:[0,0,0] op_sel_hi:[1,0,0]
v_mfma_f32_16x16x32_bf16 v[72:75], a[44:47], a[12:15], 0
buffer_load_dwordx4 a[100:103], v6, s[4:7], s59 offen offset:768 sc1
s_add_u32 s59, s59, 16384
v_mfma_f32_16x16x32_bf16 v[76:79], a[12:15], a[48:51], 0
v_fma_mix_f32 v219, v125, v203, v211 op_sel:[1,0,0] op_sel_hi:[1,0,0]
v_cvt_pk_bf16_f32 v225, v218, v219
v_mfma_f32_16x16x32_bf16 v[80:83], a[52:55], a[12:15], 0
v_fma_mix_f32 v216, v126, v204, v212 op_sel:[0,0,0] op_sel_hi:[1,0,0]
v_fma_mix_f32 v217, v126, v205, v213 op_sel:[1,0,0] op_sel_hi:[1,0,0]
v_mfma_f32_16x16x32_bf16 v[84:87], a[40:43], a[16:19], 0
v_cvt_pk_bf16_f32 v226, v216, v217
v_fma_mix_f32 v218, v127, v206, v214 op_sel:[0,0,0] op_sel_hi:[1,0,0]
v_mfma_f32_16x16x32_bf16 v[88:91], a[44:47], a[16:19], 0
v_fma_mix_f32 v219, v127, v207, v215 op_sel:[1,0,0] op_sel_hi:[1,0,0]
v_cvt_pk_bf16_f32 v227, v218, v219
v_mfma_f32_16x16x32_bf16 v[92:95], a[16:19], a[48:51], 0
v_fma_mix_f32 v216, v144, v200, v208 op_sel:[0,0,0] op_sel_hi:[1,0,0]
v_fma_mix_f32 v217, v144, v201, v209 op_sel:[1,0,0] op_sel_hi:[1,0,0]
v_mfma_f32_16x16x32_bf16 v[96:99], a[52:55], a[16:19], 0
s_waitcnt vmcnt(8) lgkmcnt(1)
v_cvt_pk_bf16_f32 v220, v216, v217
v_fma_mix_f32 v218, v145, v202, v210 op_sel:[0,0,0] op_sel_hi:[1,0,0]
v_mfma_f32_16x16x32_bf16 v[20:23], a[56:59], a[20:23], v[20:23]
ds_read_b128 a[0:3], v8 offset:10240
v_fma_mix_f32 v219, v145, v203, v211 op_sel:[1,0,0] op_sel_hi:[1,0,0]
v_mfma_f32_16x16x32_bf16 v[24:27], a[60:63], a[20:23], v[24:27]
buffer_load_dwordx4 a[104:107], v5, s[4:7], s59 offen offset:0 sc1
v_cvt_pk_bf16_f32 v221, v218, v219
v_mfma_f32_16x16x32_bf16 v[28:31], a[20:23], a[64:67], v[28:31]
ds_read_b128 a[4:7], v8 offset:11264
v_fma_mix_f32 v216, v146, v204, v212 op_sel:[0,0,0] op_sel_hi:[1,0,0]
v_mfma_f32_16x16x32_bf16 v[32:35], a[68:71], a[20:23], v[32:35]
ds_read_b128 a[8:11], v8 offset:12288
v_fma_mix_f32 v217, v146, v205, v213 op_sel:[1,0,0] op_sel_hi:[1,0,0]
v_mfma_f32_16x16x32_bf16 v[36:39], a[56:59], a[24:27], v[36:39]
ds_read_b128 a[12:15], v8 offset:13312
v_cvt_pk_bf16_f32 v222, v216, v217
v_mfma_f32_16x16x32_bf16 v[40:43], a[60:63], a[24:27], v[40:43]
buffer_load_dwordx4 a[108:111], v5, s[4:7], s59 offen offset:256 sc1
v_fma_mix_f32 v218, v147, v206, v214 op_sel:[0,0,0] op_sel_hi:[1,0,0]
v_mfma_f32_16x16x32_bf16 v[44:47], a[24:27], a[64:67], v[44:47]
ds_read_b128 a[16:19], v8 offset:14336
v_fma_mix_f32 v219, v147, v207, v215 op_sel:[1,0,0] op_sel_hi:[1,0,0]
v_mfma_f32_16x16x32_bf16 v[48:51], a[68:71], a[24:27], v[48:51]
ds_write_b128 v253, v[224:227] offset:20480
v_mfma_f32_16x16x32_bf16 v[52:55], a[56:59], a[28:31], v[52:55]
v_cvt_pk_bf16_f32 v223, v218, v219
v_fma_mix_f32 v216, v164, v200, v208 op_sel:[0,0,0] op_sel_hi:[1,0,0]
v_mfma_f32_16x16x32_bf16 v[56:59], a[60:63], a[28:31], v[56:59]
buffer_load_dwordx4 a[112:115], v5, s[4:7], s59 offen offset:512 sc1
v_fma_mix_f32 v217, v164, v201, v209 op_sel:[1,0,0] op_sel_hi:[1,0,0]
v_mfma_f32_16x16x32_bf16 v[60:63], a[28:31], a[64:67], v[60:63]
v_cvt_pk_bf16_f32 v224, v216, v217
v_fma_mix_f32 v218, v165, v202, v210 op_sel:[0,0,0] op_sel_hi:[1,0,0]
v_mfma_f32_16x16x32_bf16 v[64:67], a[68:71], a[28:31], v[64:67]
ds_write_b128 v254, v[220:223] offset:20480
v_mfma_f32_16x16x32_bf16 v[68:71], a[56:59], a[32:35], v[68:71]
v_fma_mix_f32 v219, v165, v203, v211 op_sel:[1,0,0] op_sel_hi:[1,0,0]
v_cvt_pk_bf16_f32 v225, v218, v219
v_mfma_f32_16x16x32_bf16 v[72:75], a[60:63], a[32:35], v[72:75]
buffer_load_dwordx4 a[116:119], v6, s[4:7], s59 offen offset:768 sc1
s_add_u32 s59, s59, 16384
v_mfma_f32_16x16x32_bf16 v[76:79], a[32:35], a[64:67], v[76:79]
v_fma_mix_f32 v216, v166, v204, v212 op_sel:[0,0,0] op_sel_hi:[1,0,0]
v_fma_mix_f32 v217, v166, v205, v213 op_sel:[1,0,0] op_sel_hi:[1,0,0]
v_mfma_f32_16x16x32_bf16 v[80:83], a[68:71], a[32:35], v[80:83]
v_cvt_pk_bf16_f32 v226, v216, v217
v_fma_mix_f32 v218, v167, v206, v214 op_sel:[0,0,0] op_sel_hi:[1,0,0]
v_mfma_f32_16x16x32_bf16 v[84:87], a[56:59], a[36:39], v[84:87]
v_fma_mix_f32 v219, v167, v207, v215 op_sel:[1,0,0] op_sel_hi:[1,0,0]
v_cvt_pk_bf16_f32 v227, v218, v219
v_mfma_f32_16x16x32_bf16 v[88:91], a[60:63], a[36:39], v[88:91]
v_fma_mix_f32 v216, v184, v200, v208 op_sel:[0,0,0] op_sel_hi:[1,0,0]
v_fma_mix_f32 v217, v184, v201, v209 op_sel:[1,0,0] op_sel_hi:[1,0,0]
v_mfma_f32_16x16x32_bf16 v[92:95], a[36:39], a[64:67], v[92:95]
v_cvt_pk_bf16_f32 v220, v216, v217
v_fma_mix_f32 v218, v185, v202, v210 op_sel:[0,0,0] op_sel_hi:[1,0,0]
v_mfma_f32_16x16x32_bf16 v[96:99], a[68:71], a[36:39], v[96:99]
s_waitcnt vmcnt(8) lgkmcnt(2)
v_fma_mix_f32 v219, v185, v203, v211 op_sel:[1,0,0] op_sel_hi:[1,0,0]
v_cvt_pk_bf16_f32 v221, v218, v219
v_mfma_f32_16x16x32_bf16 v[20:23], a[72:75], a[0:3], v[20:23]
ds_read_b128 a[20:23], v9 offset:15360
v_fma_mix_f32 v216, v186, v204, v212 op_sel:[0,0,0] op_sel_hi:[1,0,0]
v_mfma_f32_16x16x32_bf16 v[24:27], a[76:79], a[0:3], v[24:27]
buffer_load_dwordx4 a[120:123], v5, s[4:7], s59 offen offset:0 sc1
v_fma_mix_f32 v217, v186, v205, v213 op_sel:[1,0,0] op_sel_hi:[1,0,0]
v_mfma_f32_16x16x32_bf16 v[28:31], a[0:3], a[80:83], v[28:31]
ds_read_b128 a[24:27], v9 offset:16384
v_cvt_pk_bf16_f32 v222, v216, v217
v_mfma_f32_16x16x32_bf16 v[32:35], a[84:87], a[0:3], v[32:35]
ds_read_b128 a[28:31], v9 offset:17408
v_fma_mix_f32 v218, v187, v206, v214 op_sel:[0,0,0] op_sel_hi:[1,0,0]
v_mfma_f32_16x16x32_bf16 v[36:39], a[72:75], a[4:7], v[36:39]
ds_read_b128 a[32:35], v9 offset:18432
v_fma_mix_f32 v219, v187, v207, v215 op_sel:[1,0,0] op_sel_hi:[1,0,0]
v_mfma_f32_16x16x32_bf16 v[40:43], a[76:79], a[4:7], v[40:43]
buffer_load_dwordx4 a[124:127], v5, s[4:7], s59 offen offset:256 sc1
v_cvt_pk_bf16_f32 v223, v218, v219
v_mfma_f32_16x16x32_bf16 v[44:47], a[4:7], a[80:83], v[44:47]
ds_read_b128 a[36:39], v9 offset:19456
v_bfe_u32 v228, v1, 2, 2
v_mfma_f32_16x16x32_bf16 v[48:51], a[84:87], a[4:7], v[48:51]
ds_write_b128 v244, v[224:227] offset:20480
v_mfma_f32_16x16x32_bf16 v[52:55], a[72:75], a[8:11], v[52:55]
v_lshl_add_u32 v228, v3, 3, v228
v_mul_u32_u24 v228, 192, v228
v_mfma_f32_16x16x32_bf16 v[56:59], a[76:79], a[8:11], v[56:59]
buffer_load_dwordx4 a[128:131], v5, s[4:7], s59 offen offset:512 sc1
v_and_b32 v229, 3, v1
v_mfma_f32_16x16x32_bf16 v[60:63], a[8:11], a[80:83], v[60:63]
v_lshl_add_u32 v228, v229, 3, v228
v_and_b32 v229, 1, v3
v_mfma_f32_16x16x32_bf16 v[64:67], a[84:87], a[8:11], v[64:67]
ds_write_b128 v245, v[220:223] offset:20480
v_mfma_f32_16x16x32_bf16 v[68:71], a[72:75], a[12:15], v[68:71]
v_lshl_add_u32 v249, v229, 5, v228
v_xor_b32 v229, 1, v229
v_mfma_f32_16x16x32_bf16 v[72:75], a[76:79], a[12:15], v[72:75]
buffer_load_dwordx4 a[132:135], v6, s[4:7], s59 offen offset:768 sc1
s_add_u32 s59, s59, 16384
v_mfma_f32_16x16x32_bf16 v[76:79], a[12:15], a[80:83], v[76:79]
v_lshl_add_u32 v252, v229, 5, v228
v_add_u32 v4, 61440, v8
v_mfma_f32_16x16x32_bf16 v[80:83], a[84:87], a[12:15], v[80:83]
ds_read_b128 v[200:203], v10 offset:3584
v_add_u32 v251, 61440, v9
v_mfma_f32_16x16x32_bf16 v[84:87], a[72:75], a[16:19], v[84:87]
ds_read_b128 v[204:207], v10 offset:3600
v_mfma_f32_16x16x32_bf16 v[88:91], a[76:79], a[16:19], v[88:91]
buffer_load_dwordx4 a[136:139], v5, s[4:7], s59 offen offset:0 sc1
v_mfma_f32_16x16x32_bf16 v[92:95], a[16:19], a[80:83], v[92:95]
ds_read_b128 v[208:211], v10 offset:1024
v_mfma_f32_16x16x32_bf16 v[96:99], a[84:87], a[16:19], v[96:99]
s_waitcnt vmcnt(9) lgkmcnt(3)
s_barrier
v_mfma_f32_16x16x32_bf16 v[20:23], a[88:91], a[20:23], v[20:23]
ds_read_b128 a[0:3], v8 offset:20480
v_mfma_f32_16x16x32_bf16 v[24:27], a[92:95], a[20:23], v[24:27]
buffer_load_dwordx4 a[140:143], v5, s[4:7], s59 offen offset:256 sc1
v_mfma_f32_16x16x32_bf16 v[28:31], a[20:23], a[96:99], v[28:31]
ds_read_b128 a[4:7], v8 offset:21504
v_mfma_f32_16x16x32_bf16 v[32:35], a[100:103], a[20:23], v[32:35]
ds_read_b128 a[8:11], v8 offset:22528
v_mfma_f32_16x16x32_bf16 v[36:39], a[88:91], a[24:27], v[36:39]
ds_read_b128 a[12:15], v8 offset:23552
v_mfma_f32_16x16x32_bf16 v[40:43], a[92:95], a[24:27], v[40:43]
buffer_load_dwordx4 a[144:147], v5, s[4:7], s59 offen offset:512 sc1
v_mfma_f32_16x16x32_bf16 v[44:47], a[24:27], a[96:99], v[44:47]
ds_read_b128 a[16:19], v8 offset:24576
v_mfma_f32_16x16x32_bf16 v[48:51], a[100:103], a[24:27], v[48:51]
ds_read_b128 v[212:215], v10 offset:1040
v_mfma_f32_16x16x32_bf16 v[52:55], a[88:91], a[28:31], v[52:55]
v_mfma_f32_16x16x32_bf16 v[56:59], a[92:95], a[28:31], v[56:59]
buffer_store_dwordx4 v[240:243], v246, s[4:7], s100 offen sc1
v_mfma_f32_16x16x32_bf16 v[60:63], a[28:31], a[96:99], v[60:63]
v_mfma_f32_16x16x32_bf16 v[64:67], a[100:103], a[28:31], v[64:67]
s_waitcnt lgkmcnt(0)
v_fma_mix_f32 v216, v108, v200, v208 op_sel:[0,0,0] op_sel_hi:[1,0,0]
v_fma_mix_f32 v217, v108, v201, v209 op_sel:[1,0,0] op_sel_hi:[1,0,0]
v_mfma_f32_16x16x32_bf16 v[68:71], a[88:91], a[32:35], v[68:71]
v_cvt_pk_bf16_f32 v220, v216, v217
v_fma_mix_f32 v218, v109, v202, v210 op_sel:[0,0,0] op_sel_hi:[1,0,0]
v_mfma_f32_16x16x32_bf16 v[72:75], a[92:95], a[32:35], v[72:75]
buffer_load_dwordx4 a[148:151], v6, s[4:7], s59 offen offset:768 sc1
s_add_u32 s59, s59, 16384
v_mfma_f32_16x16x32_bf16 v[76:79], a[32:35], a[96:99], v[76:79]
v_fma_mix_f32 v219, v109, v203, v211 op_sel:[1,0,0] op_sel_hi:[1,0,0]
v_cvt_pk_bf16_f32 v221, v218, v219
v_mfma_f32_16x16x32_bf16 v[80:83], a[100:103], a[32:35], v[80:83]
v_fma_mix_f32 v216, v110, v204, v212 op_sel:[0,0,0] op_sel_hi:[1,0,0]
v_fma_mix_f32 v217, v110, v205, v213 op_sel:[1,0,0] op_sel_hi:[1,0,0]
v_mfma_f32_16x16x32_bf16 v[84:87], a[88:91], a[36:39], v[84:87]
v_cvt_pk_bf16_f32 v222, v216, v217
v_fma_mix_f32 v218, v111, v206, v214 op_sel:[0,0,0] op_sel_hi:[1,0,0]
v_mfma_f32_16x16x32_bf16 v[88:91], a[92:95], a[36:39], v[88:91]
v_fma_mix_f32 v219, v111, v207, v215 op_sel:[1,0,0] op_sel_hi:[1,0,0]
v_cvt_pk_bf16_f32 v223, v218, v219
v_mfma_f32_16x16x32_bf16 v[92:95], a[36:39], a[96:99], v[92:95]
v_fma_mix_f32 v216, v128, v200, v208 op_sel:[0,0,0] op_sel_hi:[1,0,0]
v_fma_mix_f32 v217, v128, v201, v209 op_sel:[1,0,0] op_sel_hi:[1,0,0]
v_mfma_f32_16x16x32_bf16 v[96:99], a[100:103], a[36:39], v[96:99]
s_waitcnt vmcnt(9)
v_cvt_pk_bf16_f32 v224, v216, v217
v_fma_mix_f32 v218, v129, v202, v210 op_sel:[0,0,0] op_sel_hi:[1,0,0]
v_mfma_f32_16x16x32_bf16 v[20:23], a[104:107], a[0:3], v[20:23]
ds_read_b128 a[20:23], v9 offset:25600
v_fma_mix_f32 v219, v129, v203, v211 op_sel:[1,0,0] op_sel_hi:[1,0,0]
v_mfma_f32_16x16x32_bf16 v[24:27], a[108:111], a[0:3], v[24:27]
buffer_load_dwordx4 a[152:155], v5, s[4:7], s59 offen offset:0 sc1
v_cvt_pk_bf16_f32 v225, v218, v219
v_mfma_f32_16x16x32_bf16 v[28:31], a[0:3], a[112:115], v[28:31]
ds_read_b128 a[24:27], v9 offset:26624
v_fma_mix_f32 v216, v130, v204, v212 op_sel:[0,0,0] op_sel_hi:[1,0,0]
v_mfma_f32_16x16x32_bf16 v[32:35], a[116:119], a[0:3], v[32:35]
ds_read_b128 a[28:31], v9 offset:27648
v_fma_mix_f32 v217, v130, v205, v213 op_sel:[1,0,0] op_sel_hi:[1,0,0]
v_mfma_f32_16x16x32_bf16 v[36:39], a[104:107], a[4:7], v[36:39]
ds_read_b128 a[32:35], v9 offset:28672
v_cvt_pk_bf16_f32 v226, v216, v217
v_mfma_f32_16x16x32_bf16 v[40:43], a[108:111], a[4:7], v[40:43]
buffer_load_dwordx4 a[156:159], v5, s[4:7], s59 offen offset:256 sc1
v_fma_mix_f32 v218, v131, v206, v214 op_sel:[0,0,0] op_sel_hi:[1,0,0]
v_mfma_f32_16x16x32_bf16 v[44:47], a[4:7], a[112:115], v[44:47]
ds_read_b128 a[36:39], v9 offset:29696
v_fma_mix_f32 v219, v131, v207, v215 op_sel:[1,0,0] op_sel_hi:[1,0,0]
v_mfma_f32_16x16x32_bf16 v[48:51], a[116:119], a[4:7], v[48:51]
ds_write_b128 v7, v[220:223] offset:40960
v_mfma_f32_16x16x32_bf16 v[52:55], a[104:107], a[8:11], v[52:55]
v_cvt_pk_bf16_f32 v227, v218, v219
v_fma_mix_f32 v216, v148, v200, v208 op_sel:[0,0,0] op_sel_hi:[1,0,0]
v_mfma_f32_16x16x32_bf16 v[56:59], a[108:111], a[8:11], v[56:59]
buffer_load_dwordx4 a[160:163], v5, s[4:7], s59 offen offset:512 sc1
v_fma_mix_f32 v217, v148, v201, v209 op_sel:[1,0,0] op_sel_hi:[1,0,0]
v_mfma_f32_16x16x32_bf16 v[60:63], a[8:11], a[112:115], v[60:63]
v_cvt_pk_bf16_f32 v220, v216, v217
v_fma_mix_f32 v218, v149, v202, v210 op_sel:[0,0,0] op_sel_hi:[1,0,0]
v_mfma_f32_16x16x32_bf16 v[64:67], a[116:119], a[8:11], v[64:67]
ds_write_b128 v253, v[224:227] offset:40960
v_mfma_f32_16x16x32_bf16 v[68:71], a[104:107], a[12:15], v[68:71]
v_fma_mix_f32 v219, v149, v203, v211 op_sel:[1,0,0] op_sel_hi:[1,0,0]
v_cvt_pk_bf16_f32 v221, v218, v219
v_mfma_f32_16x16x32_bf16 v[72:75], a[108:111], a[12:15], v[72:75]
buffer_load_dwordx4 a[164:167], v6, s[4:7], s59 offen offset:768 sc1
s_add_u32 s59, s59, 16384
v_mfma_f32_16x16x32_bf16 v[76:79], a[12:15], a[112:115], v[76:79]
v_fma_mix_f32 v216, v150, v204, v212 op_sel:[0,0,0] op_sel_hi:[1,0,0]
v_fma_mix_f32 v217, v150, v205, v213 op_sel:[1,0,0] op_sel_hi:[1,0,0]
v_mfma_f32_16x16x32_bf16 v[80:83], a[116:119], a[12:15], v[80:83]
v_cvt_pk_bf16_f32 v222, v216, v217
v_fma_mix_f32 v218, v151, v206, v214 op_sel:[0,0,0] op_sel_hi:[1,0,0]
v_mfma_f32_16x16x32_bf16 v[84:87], a[104:107], a[16:19], v[84:87]
v_fma_mix_f32 v219, v151, v207, v215 op_sel:[1,0,0] op_sel_hi:[1,0,0]
v_cvt_pk_bf16_f32 v223, v218, v219
v_mfma_f32_16x16x32_bf16 v[88:91], a[108:111], a[16:19], v[88:91]
buffer_load_dwordx4 a[168:171], v5, s[4:7], s59 offen offset:0 sc1
v_fma_mix_f32 v216, v168, v200, v208 op_sel:[0,0,0] op_sel_hi:[1,0,0]
v_mfma_f32_16x16x32_bf16 v[92:95], a[16:19], a[112:115], v[92:95]
v_fma_mix_f32 v217, v168, v201, v209 op_sel:[1,0,0] op_sel_hi:[1,0,0]
v_cvt_pk_bf16_f32 v224, v216, v217
v_mfma_f32_16x16x32_bf16 v[96:99], a[116:119], a[16:19], v[96:99]
s_waitcnt vmcnt(10) lgkmcnt(2)
v_fma_mix_f32 v218, v169, v202, v210 op_sel:[0,0,0] op_sel_hi:[1,0,0]
v_fma_mix_f32 v219, v169, v203, v211 op_sel:[1,0,0] op_sel_hi:[1,0,0]
v_mfma_f32_16x16x32_bf16 v[20:23], a[120:123], a[20:23], v[20:23]
ds_read_b128 a[0:3], v8 offset:30720
v_cvt_pk_bf16_f32 v225, v218, v219
v_mfma_f32_16x16x32_bf16 v[24:27], a[124:127], a[20:23], v[24:27]
buffer_load_dwordx4 a[172:175], v5, s[4:7], s59 offen offset:256 sc1
v_fma_mix_f32 v216, v170, v204, v212 op_sel:[0,0,0] op_sel_hi:[1,0,0]
v_mfma_f32_16x16x32_bf16 v[28:31], a[20:23], a[128:131], v[28:31]
ds_read_b128 a[4:7], v8 offset:31744
v_fma_mix_f32 v217, v170, v205, v213 op_sel:[1,0,0] op_sel_hi:[1,0,0]
v_mfma_f32_16x16x32_bf16 v[32:35], a[132:135], a[20:23], v[32:35]
ds_read_b128 a[8:11], v8 offset:32768
v_cvt_pk_bf16_f32 v226, v216, v217
v_mfma_f32_16x16x32_bf16 v[36:39], a[120:123], a[24:27], v[36:39]
ds_read_b128 a[12:15], v8 offset:33792
v_fma_mix_f32 v218, v171, v206, v214 op_sel:[0,0,0] op_sel_hi:[1,0,0]
v_mfma_f32_16x16x32_bf16 v[40:43], a[124:127], a[24:27], v[40:43]
buffer_load_dwordx4 a[176:179], v5, s[4:7], s59 offen offset:512 sc1
v_fma_mix_f32 v219, v171, v207, v215 op_sel:[1,0,0] op_sel_hi:[1,0,0]
v_mfma_f32_16x16x32_bf16 v[44:47], a[24:27], a[128:131], v[44:47]
ds_read_b128 a[16:19], v8 offset:34816
v_cvt_pk_bf16_f32 v227, v218, v219
v_mfma_f32_16x16x32_bf16 v[48:51], a[132:135], a[24:27], v[48:51]
ds_write_b128 v254, v[220:223] offset:40960
v_mfma_f32_16x16x32_bf16 v[52:55], a[120:123], a[28:31], v[52:55]
v_fma_mix_f32 v216, v188, v200, v208 op_sel:[0,0,0] op_sel_hi:[1,0,0]
v_fma_mix_f32 v217, v188, v201, v209 op_sel:[1,0,0] op_sel_hi:[1,0,0]
v_mfma_f32_16x16x32_bf16 v[56:59], a[124:127], a[28:31], v[56:59]
buffer_load_dwordx4 a[180:183], v6, s[4:7], s59 offen offset:768 sc1
s_add_u32 s59, s59, 16384
v_mfma_f32_16x16x32_bf16 v[60:63], a[28:31], a[128:131], v[60:63]
v_cvt_pk_bf16_f32 v220, v216, v217
v_fma_mix_f32 v218, v189, v202, v210 op_sel:[0,0,0] op_sel_hi:[1,0,0]
v_mfma_f32_16x16x32_bf16 v[64:67], a[132:135], a[28:31], v[64:67]
ds_write_b128 v244, v[224:227] offset:40960
v_mfma_f32_16x16x32_bf16 v[68:71], a[120:123], a[32:35], v[68:71]
v_fma_mix_f32 v219, v189, v203, v211 op_sel:[1,0,0] op_sel_hi:[1,0,0]
v_cvt_pk_bf16_f32 v221, v218, v219
v_mfma_f32_16x16x32_bf16 v[72:75], a[124:127], a[32:35], v[72:75]
buffer_load_dwordx4 a[184:187], v5, s[4:7], s59 offen offset:0 sc1
v_fma_mix_f32 v216, v190, v204, v212 op_sel:[0,0,0] op_sel_hi:[1,0,0]
v_mfma_f32_16x16x32_bf16 v[76:79], a[32:35], a[128:131], v[76:79]
v_fma_mix_f32 v217, v190, v205, v213 op_sel:[1,0,0] op_sel_hi:[1,0,0]
v_cvt_pk_bf16_f32 v222, v216, v217
v_mfma_f32_16x16x32_bf16 v[80:83], a[132:135], a[32:35], v[80:83]
v_fma_mix_f32 v218, v191, v206, v214 op_sel:[0,0,0] op_sel_hi:[1,0,0]
v_fma_mix_f32 v219, v191, v207, v215 op_sel:[1,0,0] op_sel_hi:[1,0,0]
v_mfma_f32_16x16x32_bf16 v[84:87], a[120:123], a[36:39], v[84:87]
v_cvt_pk_bf16_f32 v223, v218, v219
v_add_u32 v7, 61440, v7
v_mfma_f32_16x16x32_bf16 v[88:91], a[124:127], a[36:39], v[88:91]
v_add_u32 v253, 61440, v253
v_add_u32 v254, 61440, v254
v_mfma_f32_16x16x32_bf16 v[92:95], a[36:39], a[128:131], v[92:95]
v_add_u32 v244, 61440, v244
v_mfma_f32_16x16x32_bf16 v[96:99], a[132:135], a[36:39], v[96:99]
s_waitcnt vmcnt(9) lgkmcnt(2)
v_mfma_f32_16x16x32_bf16 v[20:23], a[136:139], a[0:3], v[20:23]
ds_read_b128 a[20:23], v9 offset:35840
v_mfma_f32_16x16x32_bf16 v[24:27], a[140:143], a[0:3], v[24:27]
buffer_load_dwordx4 a[188:191], v5, s[4:7], s59 offen offset:256 sc1
v_mfma_f32_16x16x32_bf16 v[28:31], a[0:3], a[144:147], v[28:31]
ds_read_b128 a[24:27], v9 offset:36864
v_mfma_f32_16x16x32_bf16 v[32:35], a[148:151], a[0:3], v[32:35]
ds_read_b128 a[28:31], v9 offset:37888
v_mfma_f32_16x16x32_bf16 v[36:39], a[136:139], a[4:7], v[36:39]
ds_read_b128 a[32:35], v9 offset:38912
v_mfma_f32_16x16x32_bf16 v[40:43], a[140:143], a[4:7], v[40:43]
buffer_load_dwordx4 a[192:195], v5, s[4:7], s59 offen offset:512 sc1
v_mfma_f32_16x16x32_bf16 v[44:47], a[4:7], a[144:147], v[44:47]
ds_read_b128 a[36:39], v9 offset:39936
v_mfma_f32_16x16x32_bf16 v[48:51], a[148:151], a[4:7], v[48:51]
ds_write_b128 v245, v[220:223] offset:40960
v_mfma_f32_16x16x32_bf16 v[52:55], a[136:139], a[8:11], v[52:55]
v_add_u32 v245, 61440, v245
v_mfma_f32_16x16x32_bf16 v[56:59], a[140:143], a[8:11], v[56:59]
buffer_load_dwordx4 a[196:199], v6, s[4:7], s59 offen offset:768 sc1
s_add_u32 s59, s59, 16384
v_mfma_f32_16x16x32_bf16 v[60:63], a[8:11], a[144:147], v[60:63]
v_mfma_f32_16x16x32_bf16 v[64:67], a[148:151], a[8:11], v[64:67]
ds_read_b128 v[200:203], v10 offset:4096
v_mfma_f32_16x16x32_bf16 v[68:71], a[136:139], a[12:15], v[68:71]
ds_read_b128 v[204:207], v10 offset:4112
v_mfma_f32_16x16x32_bf16 v[72:75], a[140:143], a[12:15], v[72:75]
buffer_load_dwordx4 a[200:203], v5, s[4:7], s59 offen offset:0 sc1
v_mfma_f32_16x16x32_bf16 v[76:79], a[12:15], a[144:147], v[76:79]
ds_read_b128 v[208:211], v10 offset:1536
v_mfma_f32_16x16x32_bf16 v[80:83], a[148:151], a[12:15], v[80:83]
ds_read_b128 v[212:215], v10 offset:1552
v_mfma_f32_16x16x32_bf16 v[84:87], a[136:139], a[16:19], v[84:87]
v_mfma_f32_16x16x32_bf16 v[88:91], a[140:143], a[16:19], v[88:91]
v_mfma_f32_16x16x32_bf16 v[92:95], a[16:19], a[144:147], v[92:95]
v_mfma_f32_16x16x32_bf16 v[96:99], a[148:151], a[16:19], v[96:99]
s_waitcnt vmcnt(9) lgkmcnt(4)
s_barrier
s_waitcnt lgkmcnt(0)
v_mfma_f32_16x16x32_bf16 v[20:23], a[152:155], a[20:23], v[20:23]
ds_read_b128 a[0:3], v8 offset:40960
v_fma_mix_f32 v216, v112, v200, v208 op_sel:[0,0,0] op_sel_hi:[1,0,0]
v_mfma_f32_16x16x32_bf16 v[24:27], a[156:159], a[20:23], v[24:27]
buffer_load_dwordx4 a[204:207], v5, s[4:7], s59 offen offset:256 sc1
v_fma_mix_f32 v217, v112, v201, v209 op_sel:[1,0,0] op_sel_hi:[1,0,0]
v_mfma_f32_16x16x32_bf16 v[28:31], a[20:23], a[160:163], v[28:31]
ds_read_b128 a[4:7], v8 offset:41984
v_cvt_pk_bf16_f32 v220, v216, v217
v_mfma_f32_16x16x32_bf16 v[32:35], a[164:167], a[20:23], v[32:35]
ds_read_b128 a[8:11], v8 offset:43008
v_fma_mix_f32 v218, v113, v202, v210 op_sel:[0,0,0] op_sel_hi:[1,0,0]
v_mfma_f32_16x16x32_bf16 v[36:39], a[152:155], a[24:27], v[36:39]
ds_read_b128 a[12:15], v8 offset:44032
v_fma_mix_f32 v219, v113, v203, v211 op_sel:[1,0,0] op_sel_hi:[1,0,0]
v_mfma_f32_16x16x32_bf16 v[40:43], a[156:159], a[24:27], v[40:43]
buffer_load_dwordx4 a[208:211], v5, s[4:7], s59 offen offset:512 sc1
v_cvt_pk_bf16_f32 v221, v218, v219
v_mfma_f32_16x16x32_bf16 v[44:47], a[24:27], a[160:163], v[44:47]
ds_read_b128 a[16:19], v8 offset:45056
v_fma_mix_f32 v216, v114, v204, v212 op_sel:[0,0,0] op_sel_hi:[1,0,0]
v_mfma_f32_16x16x32_bf16 v[48:51], a[164:167], a[24:27], v[48:51]
v_fma_mix_f32 v217, v114, v205, v213 op_sel:[1,0,0] op_sel_hi:[1,0,0]
v_cvt_pk_bf16_f32 v222, v216, v217
v_mfma_f32_16x16x32_bf16 v[52:55], a[152:155], a[28:31], v[52:55]
v_fma_mix_f32 v218, v115, v206, v214 op_sel:[0,0,0] op_sel_hi:[1,0,0]
v_fma_mix_f32 v219, v115, v207, v215 op_sel:[1,0,0] op_sel_hi:[1,0,0]
v_mfma_f32_16x16x32_bf16 v[56:59], a[156:159], a[28:31], v[56:59]
buffer_load_dwordx4 a[212:215], v6, s[4:7], s59 offen offset:768 sc1
s_add_u32 s59, s59, 16384
v_mfma_f32_16x16x32_bf16 v[60:63], a[28:31], a[160:163], v[60:63]
v_cvt_pk_bf16_f32 v223, v218, v219
v_fma_mix_f32 v216, v132, v200, v208 op_sel:[0,0,0] op_sel_hi:[1,0,0]
v_mfma_f32_16x16x32_bf16 v[64:67], a[164:167], a[28:31], v[64:67]
v_fma_mix_f32 v217, v132, v201, v209 op_sel:[1,0,0] op_sel_hi:[1,0,0]
v_cvt_pk_bf16_f32 v224, v216, v217
v_mfma_f32_16x16x32_bf16 v[68:71], a[152:155], a[32:35], v[68:71]
ds_write_b128 v7, v[220:223] offset:0
v_mfma_f32_16x16x32_bf16 v[72:75], a[156:159], a[32:35], v[72:75]
buffer_load_dwordx4 a[216:219], v5, s[4:7], s59 offen offset:0 sc1
v_fma_mix_f32 v218, v133, v202, v210 op_sel:[0,0,0] op_sel_hi:[1,0,0]
v_mfma_f32_16x16x32_bf16 v[76:79], a[32:35], a[160:163], v[76:79]
v_fma_mix_f32 v219, v133, v203, v211 op_sel:[1,0,0] op_sel_hi:[1,0,0]
v_cvt_pk_bf16_f32 v225, v218, v219
v_mfma_f32_16x16x32_bf16 v[80:83], a[164:167], a[32:35], v[80:83]
v_fma_mix_f32 v216, v134, v204, v212 op_sel:[0,0,0] op_sel_hi:[1,0,0]
v_fma_mix_f32 v217, v134, v205, v213 op_sel:[1,0,0] op_sel_hi:[1,0,0]
v_mfma_f32_16x16x32_bf16 v[84:87], a[152:155], a[36:39], v[84:87]
v_cvt_pk_bf16_f32 v226, v216, v217
v_fma_mix_f32 v218, v135, v206, v214 op_sel:[0,0,0] op_sel_hi:[1,0,0]
v_mfma_f32_16x16x32_bf16 v[88:91], a[156:159], a[36:39], v[88:91]
buffer_load_dwordx4 a[220:223], v5, s[4:7], s59 offen offset:256 sc1
v_fma_mix_f32 v219, v135, v207, v215 op_sel:[1,0,0] op_sel_hi:[1,0,0]
v_mfma_f32_16x16x32_bf16 v[92:95], a[36:39], a[160:163], v[92:95]
v_cvt_pk_bf16_f32 v227, v218, v219
v_fma_mix_f32 v216, v152, v200, v208 op_sel:[0,0,0] op_sel_hi:[1,0,0]
v_mfma_f32_16x16x32_bf16 v[96:99], a[164:167], a[36:39], v[96:99]
s_waitcnt vmcnt(10) lgkmcnt(1)
v_fma_mix_f32 v217, v152, v201, v209 op_sel:[1,0,0] op_sel_hi:[1,0,0]
v_cvt_pk_bf16_f32 v220, v216, v217
v_mfma_f32_16x16x32_bf16 v[20:23], a[168:171], a[0:3], v[20:23]
ds_read_b128 a[20:23], v9 offset:46080
v_fma_mix_f32 v218, v153, v202, v210 op_sel:[0,0,0] op_sel_hi:[1,0,0]
v_mfma_f32_16x16x32_bf16 v[24:27], a[172:175], a[0:3], v[24:27]
buffer_load_dwordx4 a[224:227], v5, s[4:7], s59 offen offset:512 sc1
v_fma_mix_f32 v219, v153, v203, v211 op_sel:[1,0,0] op_sel_hi:[1,0,0]
v_mfma_f32_16x16x32_bf16 v[28:31], a[0:3], a[176:179], v[28:31]
ds_read_b128 a[24:27], v9 offset:47104
v_cvt_pk_bf16_f32 v221, v218, v219
v_mfma_f32_16x16x32_bf16 v[32:35], a[180:183], a[0:3], v[32:35]
ds_read_b128 a[28:31], v9 offset:48128
v_fma_mix_f32 v216, v154, v204, v212 op_sel:[0,0,0] op_sel_hi:[1,0,0]
v_mfma_f32_16x16x32_bf16 v[36:39], a[168:171], a[4:7], v[36:39]
ds_read_b128 a[32:35], v9 offset:49152
v_fma_mix_f32 v217, v154, v205, v213 op_sel:[1,0,0] op_sel_hi:[1,0,0]
v_mfma_f32_16x16x32_bf16 v[40:43], a[172:175], a[4:7], v[40:43]
buffer_load_dwordx4 a[228:231], v6, s[4:7], s59 offen offset:768 sc1
s_add_u32 s59, s59, 16384
v_mfma_f32_16x16x32_bf16 v[44:47], a[4:7], a[176:179], v[44:47]
ds_read_b128 a[36:39], v9 offset:50176
v_cvt_pk_bf16_f32 v222, v216, v217
v_mfma_f32_16x16x32_bf16 v[48:51], a[180:183], a[4:7], v[48:51]
ds_write_b128 v253, v[224:227] offset:0
v_mfma_f32_16x16x32_bf16 v[52:55], a[168:171], a[8:11], v[52:55]
v_fma_mix_f32 v218, v155, v206, v214 op_sel:[0,0,0] op_sel_hi:[1,0,0]
v_fma_mix_f32 v219, v155, v207, v215 op_sel:[1,0,0] op_sel_hi:[1,0,0]
v_mfma_f32_16x16x32_bf16 v[56:59], a[172:175], a[8:11], v[56:59]
buffer_load_dwordx4 a[40:43], v5, s[4:7], s59 offen offset:0 sc1
v_cvt_pk_bf16_f32 v223, v218, v219
v_mfma_f32_16x16x32_bf16 v[60:63], a[8:11], a[176:179], v[60:63]
v_fma_mix_f32 v216, v172, v200, v208 op_sel:[0,0,0] op_sel_hi:[1,0,0]
v_fma_mix_f32 v217, v172, v201, v209 op_sel:[1,0,0] op_sel_hi:[1,0,0]
v_mfma_f32_16x16x32_bf16 v[64:67], a[180:183], a[8:11], v[64:67]
ds_write_b128 v254, v[220:223] offset:0
v_mfma_f32_16x16x32_bf16 v[68:71], a[168:171], a[12:15], v[68:71]
v_cvt_pk_bf16_f32 v224, v216, v217
v_fma_mix_f32 v218, v173, v202, v210 op_sel:[0,0,0] op_sel_hi:[1,0,0]
v_mfma_f32_16x16x32_bf16 v[72:75], a[172:175], a[12:15], v[72:75]
buffer_load_dwordx4 a[44:47], v5, s[4:7], s59 offen offset:256 sc1
v_fma_mix_f32 v219, v173, v203, v211 op_sel:[1,0,0] op_sel_hi:[1,0,0]
v_mfma_f32_16x16x32_bf16 v[76:79], a[12:15], a[176:179], v[76:79]
v_cvt_pk_bf16_f32 v225, v218, v219
v_fma_mix_f32 v216, v174, v204, v212 op_sel:[0,0,0] op_sel_hi:[1,0,0]
v_mfma_f32_16x16x32_bf16 v[80:83], a[180:183], a[12:15], v[80:83]
v_fma_mix_f32 v217, v174, v205, v213 op_sel:[1,0,0] op_sel_hi:[1,0,0]
v_cvt_pk_bf16_f32 v226, v216, v217
v_mfma_f32_16x16x32_bf16 v[84:87], a[168:171], a[16:19], v[84:87]
v_fma_mix_f32 v218, v175, v206, v214 op_sel:[0,0,0] op_sel_hi:[1,0,0]
v_fma_mix_f32 v219, v175, v207, v215 op_sel:[1,0,0] op_sel_hi:[1,0,0]
v_mfma_f32_16x16x32_bf16 v[88:91], a[172:175], a[16:19], v[88:91]
v_cvt_pk_bf16_f32 v227, v218, v219
v_fma_mix_f32 v216, v192, v200, v208 op_sel:[0,0,0] op_sel_hi:[1,0,0]
v_mfma_f32_16x16x32_bf16 v[92:95], a[16:19], a[176:179], v[92:95]
v_fma_mix_f32 v217, v192, v201, v209 op_sel:[1,0,0] op_sel_hi:[1,0,0]
v_cvt_pk_bf16_f32 v220, v216, v217
v_mfma_f32_16x16x32_bf16 v[96:99], a[180:183], a[16:19], v[96:99]
s_waitcnt vmcnt(10) lgkmcnt(2)
v_fma_mix_f32 v218, v193, v202, v210 op_sel:[0,0,0] op_sel_hi:[1,0,0]
v_fma_mix_f32 v219, v193, v203, v211 op_sel:[1,0,0] op_sel_hi:[1,0,0]
v_mfma_f32_16x16x32_bf16 v[20:23], a[184:187], a[20:23], v[20:23]
ds_read_b128 a[0:3], v8 offset:51200
v_cvt_pk_bf16_f32 v221, v218, v219
v_mfma_f32_16x16x32_bf16 v[24:27], a[188:191], a[20:23], v[24:27]
buffer_load_dwordx4 a[48:51], v5, s[4:7], s59 offen offset:512 sc1
v_fma_mix_f32 v216, v194, v204, v212 op_sel:[0,0,0] op_sel_hi:[1,0,0]
v_mfma_f32_16x16x32_bf16 v[28:31], a[20:23], a[192:195], v[28:31]
ds_read_b128 a[4:7], v8 offset:52224
v_fma_mix_f32 v217, v194, v205, v213 op_sel:[1,0,0] op_sel_hi:[1,0,0]
v_mfma_f32_16x16x32_bf16 v[32:35], a[196:199], a[20:23], v[32:35]
ds_read_b128 a[8:11], v8 offset:53248
v_cvt_pk_bf16_f32 v222, v216, v217
v_mfma_f32_16x16x32_bf16 v[36:39], a[184:187], a[24:27], v[36:39]
ds_read_b128 a[12:15], v8 offset:54272
v_fma_mix_f32 v218, v195, v206, v214 op_sel:[0,0,0] op_sel_hi:[1,0,0]
v_mfma_f32_16x16x32_bf16 v[40:43], a[188:191], a[24:27], v[40:43]
buffer_load_dwordx4 a[52:55], v6, s[4:7], s59 offen offset:768 sc1
s_add_u32 s59, s59, 16384
v_mfma_f32_16x16x32_bf16 v[44:47], a[24:27], a[192:195], v[44:47]
ds_read_b128 a[16:19], v8 offset:55296
v_fma_mix_f32 v219, v195, v207, v215 op_sel:[1,0,0] op_sel_hi:[1,0,0]
v_mfma_f32_16x16x32_bf16 v[48:51], a[196:199], a[24:27], v[48:51]
ds_write_b128 v244, v[224:227] offset:0
v_mfma_f32_16x16x32_bf16 v[52:55], a[184:187], a[28:31], v[52:55]
v_cvt_pk_bf16_f32 v223, v218, v219
v_mfma_f32_16x16x32_bf16 v[56:59], a[188:191], a[28:31], v[56:59]
buffer_load_dwordx4 a[56:59], v5, s[4:7], s59 offen offset:0 sc1
v_mfma_f32_16x16x32_bf16 v[60:63], a[28:31], a[192:195], v[60:63]
v_mfma_f32_16x16x32_bf16 v[64:67], a[196:199], a[28:31], v[64:67]
ds_write_b128 v245, v[220:223] offset:0
v_mfma_f32_16x16x32_bf16 v[68:71], a[184:187], a[32:35], v[68:71]
v_mfma_f32_16x16x32_bf16 v[72:75], a[188:191], a[32:35], v[72:75]
buffer_load_dwordx4 a[60:63], v5, s[4:7], s59 offen offset:256 sc1
v_mfma_f32_16x16x32_bf16 v[76:79], a[32:35], a[192:195], v[76:79]
v_mfma_f32_16x16x32_bf16 v[80:83], a[196:199], a[32:35], v[80:83]
ds_read_b128 v[200:203], v10 offset:4608
v_mfma_f32_16x16x32_bf16 v[84:87], a[184:187], a[36:39], v[84:87]
ds_read_b128 v[204:207], v10 offset:4624
v_mfma_f32_16x16x32_bf16 v[88:91], a[188:191], a[36:39], v[88:91]
buffer_load_dwordx4 a[64:67], v5, s[4:7], s59 offen offset:512 sc1
v_mfma_f32_16x16x32_bf16 v[92:95], a[36:39], a[192:195], v[92:95]
ds_read_b128 v[208:211], v10 offset:2048
v_mfma_f32_16x16x32_bf16 v[96:99], a[196:199], a[36:39], v[96:99]
s_waitcnt vmcnt(11) lgkmcnt(5)
v_mfma_f32_16x16x32_bf16 v[20:23], a[200:203], a[0:3], v[20:23]
ds_read_b128 a[20:23], v9 offset:56320
v_mfma_f32_16x16x32_bf16 v[24:27], a[204:207], a[0:3], v[24:27]
buffer_load_dwordx4 a[68:71], v6, s[4:7], s59 offen offset:768 sc1
s_add_u32 s59, s59, 16384
v_mfma_f32_16x16x32_bf16 v[28:31], a[0:3], a[208:211], v[28:31]
ds_read_b128 a[24:27], v9 offset:57344
v_mfma_f32_16x16x32_bf16 v[32:35], a[212:215], a[0:3], v[32:35]
ds_read_b128 a[28:31], v9 offset:58368
v_mfma_f32_16x16x32_bf16 v[36:39], a[200:203], a[4:7], v[36:39]
ds_read_b128 a[32:35], v9 offset:59392
v_mfma_f32_16x16x32_bf16 v[40:43], a[204:207], a[4:7], v[40:43]
buffer_load_dwordx4 a[72:75], v5, s[4:7], s59 offen offset:0 sc1
v_mfma_f32_16x16x32_bf16 v[44:47], a[4:7], a[208:211], v[44:47]
ds_read_b128 a[36:39], v9 offset:60416
v_mfma_f32_16x16x32_bf16 v[48:51], a[212:215], a[4:7], v[48:51]
ds_read_b128 v[212:215], v10 offset:2064
v_mfma_f32_16x16x32_bf16 v[52:55], a[200:203], a[8:11], v[52:55]
v_mfma_f32_16x16x32_bf16 v[56:59], a[204:207], a[8:11], v[56:59]
buffer_load_dwordx4 a[76:79], v5, s[4:7], s59 offen offset:256 sc1
v_mfma_f32_16x16x32_bf16 v[60:63], a[8:11], a[208:211], v[60:63]
v_mfma_f32_16x16x32_bf16 v[64:67], a[212:215], a[8:11], v[64:67]
s_waitcnt lgkmcnt(0)
v_fma_mix_f32 v216, v116, v200, v208 op_sel:[0,0,0] op_sel_hi:[1,0,0]
v_fma_mix_f32 v217, v116, v201, v209 op_sel:[1,0,0] op_sel_hi:[1,0,0]
v_mfma_f32_16x16x32_bf16 v[68:71], a[200:203], a[12:15], v[68:71]
v_cvt_pk_bf16_f32 v220, v216, v217
v_fma_mix_f32 v218, v117, v202, v210 op_sel:[0,0,0] op_sel_hi:[1,0,0]
v_mfma_f32_16x16x32_bf16 v[72:75], a[204:207], a[12:15], v[72:75]
buffer_load_dwordx4 a[80:83], v5, s[4:7], s59 offen offset:512 sc1
v_fma_mix_f32 v219, v117, v203, v211 op_sel:[1,0,0] op_sel_hi:[1,0,0]
v_mfma_f32_16x16x32_bf16 v[76:79], a[12:15], a[208:211], v[76:79]
v_cvt_pk_bf16_f32 v221, v218, v219
v_fma_mix_f32 v216, v118, v204, v212 op_sel:[0,0,0] op_sel_hi:[1,0,0]
v_mfma_f32_16x16x32_bf16 v[80:83], a[212:215], a[12:15], v[80:83]
v_fma_mix_f32 v217, v118, v205, v213 op_sel:[1,0,0] op_sel_hi:[1,0,0]
v_cvt_pk_bf16_f32 v222, v216, v217
v_mfma_f32_16x16x32_bf16 v[84:87], a[200:203], a[16:19], v[84:87]
v_fma_mix_f32 v218, v119, v206, v214 op_sel:[0,0,0] op_sel_hi:[1,0,0]
v_fma_mix_f32 v219, v119, v207, v215 op_sel:[1,0,0] op_sel_hi:[1,0,0]
v_mfma_f32_16x16x32_bf16 v[88:91], a[204:207], a[16:19], v[88:91]
v_cvt_pk_bf16_f32 v223, v218, v219
v_fma_mix_f32 v216, v136, v200, v208 op_sel:[0,0,0] op_sel_hi:[1,0,0]
v_mfma_f32_16x16x32_bf16 v[92:95], a[16:19], a[208:211], v[92:95]
v_fma_mix_f32 v217, v136, v201, v209 op_sel:[1,0,0] op_sel_hi:[1,0,0]
v_cvt_pk_bf16_f32 v224, v216, v217
v_mfma_f32_16x16x32_bf16 v[96:99], a[212:215], a[16:19], v[96:99]
s_waitcnt vmcnt(11)
s_barrier
v_fma_mix_f32 v218, v137, v202, v210 op_sel:[0,0,0] op_sel_hi:[1,0,0]
v_mfma_f32_16x16x32_bf16 v[20:23], a[216:219], a[20:23], v[20:23]
ds_read_b128 a[0:3], v4 offset:0
v_fma_mix_f32 v219, v137, v203, v211 op_sel:[1,0,0] op_sel_hi:[1,0,0]
v_mfma_f32_16x16x32_bf16 v[24:27], a[220:223], a[20:23], v[24:27]
buffer_load_dwordx4 a[84:87], v6, s[4:7], s59 offen offset:768 sc1
s_add_u32 s59, s59, 16384
v_mfma_f32_16x16x32_bf16 v[28:31], a[20:23], a[224:227], v[28:31]
ds_read_b128 a[4:7], v4 offset:1024
v_cvt_pk_bf16_f32 v225, v218, v219
v_mfma_f32_16x16x32_bf16 v[32:35], a[228:231], a[20:23], v[32:35]
ds_read_b128 a[8:11], v4 offset:2048
v_fma_mix_f32 v216, v138, v204, v212 op_sel:[0,0,0] op_sel_hi:[1,0,0]
v_mfma_f32_16x16x32_bf16 v[36:39], a[216:219], a[24:27], v[36:39]
ds_read_b128 a[12:15], v4 offset:3072
v_fma_mix_f32 v217, v138, v205, v213 op_sel:[1,0,0] op_sel_hi:[1,0,0]
v_mfma_f32_16x16x32_bf16 v[40:43], a[220:223], a[24:27], v[40:43]
buffer_load_dwordx4 a[88:91], v5, s[4:7], s59 offen offset:0 sc1
v_cvt_pk_bf16_f32 v226, v216, v217
v_mfma_f32_16x16x32_bf16 v[44:47], a[24:27], a[224:227], v[44:47]
ds_read_b128 a[16:19], v4 offset:4096
v_fma_mix_f32 v218, v139, v206, v214 op_sel:[0,0,0] op_sel_hi:[1,0,0]
v_mfma_f32_16x16x32_bf16 v[48:51], a[228:231], a[24:27], v[48:51]
ds_write_b128 v7, v[220:223] offset:20480
v_mfma_f32_16x16x32_bf16 v[52:55], a[216:219], a[28:31], v[52:55]
v_fma_mix_f32 v219, v139, v207, v215 op_sel:[1,0,0] op_sel_hi:[1,0,0]
v_cvt_pk_bf16_f32 v227, v218, v219
v_mfma_f32_16x16x32_bf16 v[56:59], a[220:223], a[28:31], v[56:59]
buffer_load_dwordx4 a[92:95], v5, s[4:7], s59 offen offset:256 sc1
v_fma_mix_f32 v216, v156, v200, v208 op_sel:[0,0,0] op_sel_hi:[1,0,0]
v_mfma_f32_16x16x32_bf16 v[60:63], a[28:31], a[224:227], v[60:63]
v_fma_mix_f32 v217, v156, v201, v209 op_sel:[1,0,0] op_sel_hi:[1,0,0]
v_cvt_pk_bf16_f32 v220, v216, v217
v_mfma_f32_16x16x32_bf16 v[64:67], a[228:231], a[28:31], v[64:67]
ds_write_b128 v253, v[224:227] offset:20480
v_mfma_f32_16x16x32_bf16 v[68:71], a[216:219], a[32:35], v[68:71]
v_fma_mix_f32 v218, v157, v202, v210 op_sel:[0,0,0] op_sel_hi:[1,0,0]
v_fma_mix_f32 v219, v157, v203, v211 op_sel:[1,0,0] op_sel_hi:[1,0,0]
v_mfma_f32_16x16x32_bf16 v[72:75], a[220:223], a[32:35], v[72:75]
buffer_load_dwordx4 a[96:99], v5, s[4:7], s59 offen offset:512 sc1
v_cvt_pk_bf16_f32 v221, v218, v219
v_mfma_f32_16x16x32_bf16 v[76:79], a[32:35], a[224:227], v[76:79]
v_fma_mix_f32 v216, v158, v204, v212 op_sel:[0,0,0] op_sel_hi:[1,0,0]
v_fma_mix_f32 v217, v158, v205, v213 op_sel:[1,0,0] op_sel_hi:[1,0,0]
v_mfma_f32_16x16x32_bf16 v[80:83], a[228:231], a[32:35], v[80:83]
v_cvt_pk_bf16_f32 v222, v216, v217
v_fma_mix_f32 v218, v159, v206, v214 op_sel:[0,0,0] op_sel_hi:[1,0,0]
v_mfma_f32_16x16x32_bf16 v[84:87], a[216:219], a[36:39], v[84:87]
v_fma_mix_f32 v219, v159, v207, v215 op_sel:[1,0,0] op_sel_hi:[1,0,0]
v_cvt_pk_bf16_f32 v223, v218, v219
v_mfma_f32_16x16x32_bf16 v[88:91], a[220:223], a[36:39], v[88:91]
v_fma_mix_f32 v216, v176, v200, v208 op_sel:[0,0,0] op_sel_hi:[1,0,0]
v_fma_mix_f32 v217, v176, v201, v209 op_sel:[1,0,0] op_sel_hi:[1,0,0]
v_mfma_f32_16x16x32_bf16 v[92:95], a[36:39], a[224:227], v[92:95]
v_cvt_pk_bf16_f32 v224, v216, v217
v_fma_mix_f32 v218, v177, v202, v210 op_sel:[0,0,0] op_sel_hi:[1,0,0]
v_mfma_f32_16x16x32_bf16 v[96:99], a[228:231], a[36:39], v[96:99]
s_waitcnt vmcnt(11) lgkmcnt(2)
v_fma_mix_f32 v219, v177, v203, v211 op_sel:[1,0,0] op_sel_hi:[1,0,0]
v_cvt_pk_bf16_f32 v225, v218, v219
v_mfma_f32_16x16x32_bf16 v[20:23], a[40:43], a[0:3], v[20:23]
ds_read_b128 a[20:23], v251 offset:5120
v_fma_mix_f32 v216, v178, v204, v212 op_sel:[0,0,0] op_sel_hi:[1,0,0]
v_mfma_f32_16x16x32_bf16 v[24:27], a[44:47], a[0:3], v[24:27]
buffer_load_dwordx4 a[100:103], v6, s[4:7], s59 offen offset:768 sc1
s_add_u32 s59, s59, 16384
v_mfma_f32_16x16x32_bf16 v[28:31], a[0:3], a[48:51], v[28:31]
ds_read_b128 a[24:27], v251 offset:6144
v_fma_mix_f32 v217, v178, v205, v213 op_sel:[1,0,0] op_sel_hi:[1,0,0]
v_mfma_f32_16x16x32_bf16 v[32:35], a[52:55], a[0:3], v[32:35]
ds_read_b128 a[28:31], v251 offset:7168
v_cvt_pk_bf16_f32 v226, v216, v217
v_mfma_f32_16x16x32_bf16 v[36:39], a[40:43], a[4:7], v[36:39]
ds_read_b128 a[32:35], v251 offset:8192
v_fma_mix_f32 v218, v179, v206, v214 op_sel:[0,0,0] op_sel_hi:[1,0,0]
v_mfma_f32_16x16x32_bf16 v[40:43], a[44:47], a[4:7], v[40:43]
buffer_load_dwordx4 a[104:107], v5, s[4:7], s59 offen offset:0 sc1
v_fma_mix_f32 v219, v179, v207, v215 op_sel:[1,0,0] op_sel_hi:[1,0,0]
v_mfma_f32_16x16x32_bf16 v[44:47], a[4:7], a[48:51], v[44:47]
ds_read_b128 a[36:39], v251 offset:9216
v_cvt_pk_bf16_f32 v227, v218, v219
v_mfma_f32_16x16x32_bf16 v[48:51], a[52:55], a[4:7], v[48:51]
ds_read_b64_tr_b16 a[168:169], v249 offset:0
v_fma_mix_f32 v216, v196, v200, v208 op_sel:[0,0,0] op_sel_hi:[1,0,0]
v_mfma_f32_16x16x32_bf16 v[52:55], a[40:43], a[8:11], v[52:55]
ds_read_b64_tr_b16 a[170:171], v249 offset:768
v_fma_mix_f32 v217, v196, v201, v209 op_sel:[1,0,0] op_sel_hi:[1,0,0]
v_mfma_f32_16x16x32_bf16 v[56:59], a[44:47], a[8:11], v[56:59]
buffer_load_dwordx4 a[108:111], v5, s[4:7], s59 offen offset:256 sc1
v_mfma_f32_16x16x32_bf16 v[60:63], a[8:11], a[48:51], v[60:63]
ds_read_b64_tr_b16 a[172:173], v252 offset:0
v_mfma_f32_16x16x32_bf16 v[64:67], a[52:55], a[8:11], v[64:67]
ds_read_b64_tr_b16 a[174:175], v252 offset:768
v_mfma_f32_16x16x32_bf16 v[68:71], a[40:43], a[12:15], v[68:71]
ds_write_b128 v254, v[220:223] offset:20480
v_mfma_f32_16x16x32_bf16 v[72:75], a[44:47], a[12:15], v[72:75]
buffer_load_dwordx4 a[112:115], v5, s[4:7], s59 offen offset:512 sc1
v_cvt_pk_bf16_f32 v220, v216, v217
v_mfma_f32_16x16x32_bf16 v[76:79], a[12:15], a[48:51], v[76:79]
v_fma_mix_f32 v218, v197, v202, v210 op_sel:[0,0,0] op_sel_hi:[1,0,0]
v_fma_mix_f32 v219, v197, v203, v211 op_sel:[1,0,0] op_sel_hi:[1,0,0]
v_mfma_f32_16x16x32_bf16 v[80:83], a[52:55], a[12:15], v[80:83]
v_cvt_pk_bf16_f32 v221, v218, v219
v_fma_mix_f32 v216, v198, v204, v212 op_sel:[0,0,0] op_sel_hi:[1,0,0]
v_mfma_f32_16x16x32_bf16 v[84:87], a[40:43], a[16:19], v[84:87]
ds_write_b128 v244, v[224:227] offset:20480
v_mfma_f32_16x16x32_bf16 v[88:91], a[44:47], a[16:19], v[88:91]
buffer_load_dwordx4 a[116:119], v6, s[4:7], s59 offen offset:768 sc1
s_add_u32 s59, s59, 16384
v_mfma_f32_16x16x32_bf16 v[92:95], a[16:19], a[48:51], v[92:95]
v_fma_mix_f32 v217, v198, v205, v213 op_sel:[1,0,0] op_sel_hi:[1,0,0]
v_cvt_pk_bf16_f32 v222, v216, v217
v_mfma_f32_16x16x32_bf16 v[96:99], a[52:55], a[16:19], v[96:99]
s_waitcnt vmcnt(12) lgkmcnt(6)
v_fma_mix_f32 v218, v199, v206, v214 op_sel:[0,0,0] op_sel_hi:[1,0,0]
v_fma_mix_f32 v219, v199, v207, v215 op_sel:[1,0,0] op_sel_hi:[1,0,0]
v_mfma_f32_16x16x32_bf16 v[20:23], a[56:59], a[20:23], v[20:23]
ds_read_b128 a[0:3], v4 offset:10240
v_cvt_pk_bf16_f32 v223, v218, v219
v_mfma_f32_16x16x32_bf16 v[24:27], a[60:63], a[20:23], v[24:27]
buffer_load_dwordx4 a[120:123], v5, s[4:7], s59 offen offset:0 sc1
v_add_u32 v253, 61440, v249
v_mfma_f32_16x16x32_bf16 v[28:31], a[20:23], a[64:67], v[28:31]
ds_read_b128 a[4:7], v4 offset:11264
v_add_u32 v254, 61440, v252
v_mfma_f32_16x16x32_bf16 v[32:35], a[68:71], a[20:23], v[32:35]
ds_read_b128 a[8:11], v4 offset:12288
v_lshlrev_b32 v7, 4, v1
v_mfma_f32_16x16x32_bf16 v[36:39], a[56:59], a[24:27], v[36:39]
ds_read_b128 a[12:15], v4 offset:13312
v_lshl_add_u32 v247, v3, 4, s12
v_mfma_f32_16x16x32_bf16 v[40:43], a[60:63], a[24:27], v[40:43]
buffer_load_dwordx4 a[124:127], v5, s[4:7], s59 offen offset:256 sc1
v_mul_u32_u24 v228, 192, v2
v_mfma_f32_16x16x32_bf16 v[44:47], a[24:27], a[64:67], v[44:47]
ds_read_b128 a[16:19], v4 offset:14336
v_lshl_add_u32 v228, v3, 3, v228
v_mfma_f32_16x16x32_bf16 v[48:51], a[68:71], a[24:27], v[48:51]
ds_read_b64_tr_b16 a[176:177], v249 offset:64
v_add_u32 v248, s13, v228
v_mfma_f32_16x16x32_bf16 v[52:55], a[56:59], a[28:31], v[52:55]
ds_read_b64_tr_b16 a[178:179], v249 offset:832
v_add_u32 v250, s13, v7
v_mfma_f32_16x16x32_bf16 v[56:59], a[60:63], a[28:31], v[56:59]
buffer_load_dwordx4 a[128:131], v5, s[4:7], s59 offen offset:512 sc1
v_lshlrev_b32 v0, 2, v1
v_mfma_f32_16x16x32_bf16 v[60:63], a[28:31], a[64:67], v[60:63]
ds_read_b64_tr_b16 a[180:181], v252 offset:64
v_add_u32 v227, s12, v7
v_mfma_f32_16x16x32_bf16 v[64:67], a[68:71], a[28:31], v[64:67]
ds_read_b64_tr_b16 a[182:183], v252 offset:832
v_min_u32 v226, 13, v1
v_mfma_f32_16x16x32_bf16 v[68:71], a[56:59], a[32:35], v[68:71]
ds_write_b128 v245, v[220:223] offset:20480
v_mfma_f32_16x16x32_bf16 v[72:75], a[60:63], a[32:35], v[72:75]
buffer_load_dwordx4 a[132:135], v6, s[4:7], s59 offen offset:768 sc1
s_add_u32 s59, s59, 16384
v_mfma_f32_16x16x32_bf16 v[76:79], a[32:35], a[64:67], v[76:79]
v_lshlrev_b32 v226, 7, v226
v_lshlrev_b32 v181, 2, v3
v_mfma_f32_16x16x32_bf16 v[80:83], a[68:71], a[32:35], v[80:83]
v_sub_u32 v181, v2, v181
v_mov_b32 v168, 0xf0000000
v_mfma_f32_16x16x32_bf16 v[84:87], a[56:59], a[36:39], v[84:87]
v_subrev_u32 v182, 0, v181
v_bfe_i32 v182, v182, 3, 1
v_mfma_f32_16x16x32_bf16 v[88:91], a[60:63], a[36:39], v[88:91]
v_and_b32 v164, v168, v182
v_mov_b32 v176, 0x3f803f80
v_mfma_f32_16x16x32_bf16 v[92:95], a[36:39], a[64:67], v[92:95]
v_subrev_u32 v182, 1, v181
v_bfe_i32 v182, v182, 3, 1
v_mfma_f32_16x16x32_bf16 v[96:99], a[68:71], a[36:39], v[96:99]
s_waitcnt vmcnt(12) lgkmcnt(5)
v_and_b32 v165, v168, v182
v_mov_b32 v177, 0x3f803f80
v_mfma_f32_16x16x32_bf16 v[20:23], a[72:75], a[0:3], v[20:23]
ds_read_b128 a[20:23], v251 offset:15360
v_subrev_u32 v182, 2, v181
v_mfma_f32_16x16x32_bf16 v[24:27], a[76:79], a[0:3], v[24:27]
buffer_load_dwordx4 a[136:139], v5, s[4:7], s59 offen offset:0 sc1
v_bfe_i32 v182, v182, 3, 1
v_mfma_f32_16x16x32_bf16 v[28:31], a[0:3], a[80:83], v[28:31]
ds_read_b128 a[24:27], v251 offset:16384
v_and_b32 v166, v168, v182
v_mfma_f32_16x16x32_bf16 v[32:35], a[84:87], a[0:3], v[32:35]
ds_read_b128 a[28:31], v251 offset:17408
v_mov_b32 v178, 0x3f803f80
v_mfma_f32_16x16x32_bf16 v[36:39], a[72:75], a[4:7], v[36:39]
ds_read_b128 a[32:35], v251 offset:18432
v_subrev_u32 v182, 3, v181
v_mfma_f32_16x16x32_bf16 v[40:43], a[76:79], a[4:7], v[40:43]
buffer_load_dwordx4 a[140:143], v5, s[4:7], s59 offen offset:256 sc1
v_bfe_i32 v182, v182, 3, 1
v_mfma_f32_16x16x32_bf16 v[44:47], a[4:7], a[80:83], v[44:47]
ds_read_b128 a[36:39], v251 offset:19456
v_and_b32 v167, v168, v182
v_mfma_f32_16x16x32_bf16 v[48:51], a[84:87], a[4:7], v[48:51]
ds_read_b64_tr_b16 a[184:185], v249 offset:128
v_mov_b32 v179, 0x3f803f80
v_mfma_f32_16x16x32_bf16 v[52:55], a[72:75], a[8:11], v[52:55]
ds_read_b64_tr_b16 a[186:187], v249 offset:896
v_and_b32 v181, 1, v1
v_mfma_f32_16x16x32_bf16 v[56:59], a[76:79], a[8:11], v[56:59]
buffer_load_dwordx4 a[144:147], v5, s[4:7], s59 offen offset:512 sc1
v_lshlrev_b32 v181, 4, v181
v_mfma_f32_16x16x32_bf16 v[60:63], a[8:11], a[80:83], v[60:63]
ds_read_b64_tr_b16 a[188:189], v252 offset:128
v_mov_b32 v182, 0x3f80
v_mfma_f32_16x16x32_bf16 v[64:67], a[84:87], a[8:11], v[64:67]
ds_read_b64_tr_b16 a[190:191], v252 offset:896
v_lshlrev_b32 v182, v181, v182
v_mfma_f32_16x16x32_bf16 v[68:71], a[72:75], a[12:15], v[68:71]
v_and_b32 v181, 0x32, v1
v_cmp_eq_u32 vcc, 0x30, v181
v_mfma_f32_16x16x32_bf16 v[72:75], a[76:79], a[12:15], v[72:75]
buffer_load_dwordx4 a[148:151], v6, s[4:7], s59 offen offset:768 sc1
s_add_u32 s59, s59, 16384
v_mfma_f32_16x16x32_bf16 v[76:79], a[12:15], a[80:83], v[76:79]
v_cmp_eq_u32 s[62:63], 50, v181
v_mul_u32_u24 v229, 176, v2
v_mfma_f32_16x16x32_bf16 v[80:83], a[84:87], a[12:15], v[80:83]
v_cndmask_b32 v174, 0, v182, vcc
v_cndmask_b32 v175, 0, v182, s[62:63]
v_mfma_f32_16x16x32_bf16 v[84:87], a[72:75], a[16:19], v[84:87]
v_add_u32 v229, s61, v229
v_lshl_add_u32 v228, v3, 3, v229
v_mfma_f32_16x16x32_bf16 v[88:91], a[76:79], a[16:19], v[88:91]
buffer_load_dwordx4 a[152:155], v5, s[4:7], s59 offen offset:0 sc1
v_mov_b32 v122, 0
v_mfma_f32_16x16x32_bf16 v[92:95], a[16:19], a[80:83], v[92:95]
v_mov_b32 v123, 0
v_mov_b32 v126, 0
v_mfma_f32_16x16x32_bf16 v[96:99], a[84:87], a[16:19], v[96:99]
s_waitcnt vmcnt(13) lgkmcnt(4)
s_barrier
v_mov_b32 v127, 0
v_mfma_f32_16x16x32_bf16 v[20:23], a[88:91], a[20:23], v[20:23]
ds_read_b128 a[0:3], v4 offset:20480
v_mov_b32 v130, 0
v_mfma_f32_16x16x32_bf16 v[24:27], a[92:95], a[20:23], v[24:27]
buffer_load_dwordx4 a[156:159], v5, s[4:7], s59 offen offset:256 sc1
v_mov_b32 v131, 0
v_mfma_f32_16x16x32_bf16 v[28:31], a[20:23], a[96:99], v[28:31]
ds_read_b128 a[4:7], v4 offset:21504
v_mov_b32 v134, 0
v_mfma_f32_16x16x32_bf16 v[32:35], a[100:103], a[20:23], v[32:35]
ds_read_b128 a[8:11], v4 offset:22528
v_mov_b32 v135, 0
v_mfma_f32_16x16x32_bf16 v[36:39], a[88:91], a[24:27], v[36:39]
ds_read_b128 a[12:15], v4 offset:23552
v_mov_b32 v138, 0
v_mfma_f32_16x16x32_bf16 v[40:43], a[92:95], a[24:27], v[40:43]
buffer_load_dwordx4 a[160:163], v5, s[4:7], s59 offen offset:512 sc1
v_mov_b32 v139, 0
v_mfma_f32_16x16x32_bf16 v[44:47], a[24:27], a[96:99], v[44:47]
ds_read_b128 a[16:19], v4 offset:24576
v_mfma_f32_16x16x32_bf16 v[48:51], a[100:103], a[24:27], v[48:51]
ds_read_b64_tr_b16 a[192:193], v249 offset:6144
v_mfma_f32_16x16x32_bf16 v[52:55], a[88:91], a[28:31], v[52:55]
ds_read_b64_tr_b16 a[194:195], v249 offset:6912
v_mfma_f32_16x16x32_bf16 v[56:59], a[92:95], a[28:31], v[56:59]
buffer_load_dwordx4 a[164:167], v6, s[4:7], s59 offen offset:768 sc1
s_add_u32 s59, s59, 16384
v_mfma_f32_16x16x32_bf16 v[60:63], a[28:31], a[96:99], v[60:63]
ds_read_b64_tr_b16 a[196:197], v252 offset:6144
v_mfma_f32_16x16x32_bf16 v[64:67], a[100:103], a[28:31], v[64:67]
ds_read_b64_tr_b16 a[198:199], v252 offset:6912
v_mfma_f32_16x16x32_bf16 v[68:71], a[88:91], a[32:35], v[68:71]
ds_read_b64_tr_b16 a[206:207], v252 offset:6976
s_add_u32 m0, s39, 49152
v_mfma_f32_16x16x32_bf16 v[72:75], a[92:95], a[32:35], v[72:75]
buffer_load_dwordx4 v232, s[24:27], s48 offen offset:0 lds
v_mfma_f32_16x16x32_bf16 v[76:79], a[32:35], a[96:99], v[76:79]
ds_read_b64_tr_b16 a[200:201], v249 offset:6208
v_mfma_f32_16x16x32_bf16 v[80:83], a[100:103], a[32:35], v[80:83]
ds_read_b64_tr_b16 a[202:203], v249 offset:6976
v_mfma_f32_16x16x32_bf16 v[84:87], a[88:91], a[36:39], v[84:87]
ds_read_b64_tr_b16 a[208:209], v249 offset:6272
v_mfma_f32_16x16x32_bf16 v[88:91], a[92:95], a[36:39], v[88:91]
v_mfma_f32_16x16x32_bf16 v[92:95], a[36:39], a[96:99], v[92:95]
ds_read_b64_tr_b16 a[204:205], v252 offset:6208
v_mfma_f32_16x16x32_bf16 v[96:99], a[100:103], a[36:39], v[96:99]
s_waitcnt vmcnt(13) lgkmcnt(9)
v_mfma_f32_16x16x32_bf16 v[20:23], a[104:107], a[0:3], v[20:23]
ds_read_b128 a[20:23], v251 offset:25600
v_mfma_f32_16x16x32_bf16 v[24:27], a[108:111], a[0:3], v[24:27]
buffer_load_dwordx4 v233, s[24:27], s48 offen offset:1024 lds
v_mfma_f32_16x16x32_bf16 v[28:31], a[0:3], a[112:115], v[28:31]
ds_read_b128 a[24:27], v251 offset:26624
v_mfma_f32_16x16x32_bf16 v[32:35], a[116:119], a[0:3], v[32:35]
ds_read_b128 a[28:31], v251 offset:27648
v_mfma_f32_16x16x32_bf16 v[36:39], a[104:107], a[4:7], v[36:39]
ds_read_b128 a[32:35], v251 offset:28672
v_mfma_f32_16x16x32_bf16 v[40:43], a[108:111], a[4:7], v[40:43]
buffer_load_dwordx4 v234, s[24:27], s48 offen offset:2048 lds
s_add_u32 s48, s48, 81920
v_mfma_f32_16x16x32_bf16 v[44:47], a[4:7], a[112:115], v[44:47]
ds_read_b128 a[36:39], v251 offset:29696
v_mfma_f32_16x16x32_bf16 v[48:51], a[116:119], a[4:7], v[48:51]
ds_read_b64_tr_b16 a[210:211], v249 offset:7040
v_mfma_f32_16x16x32_bf16 v[52:55], a[104:107], a[8:11], v[52:55]
ds_read_b64_tr_b16 a[212:213], v252 offset:6272
s_add_u32 m0, s39, 61440
v_mfma_f32_16x16x32_bf16 v[56:59], a[108:111], a[8:11], v[56:59]
buffer_load_dwordx4 v232, s[24:27], s48 offen offset:0 lds
v_mfma_f32_16x16x32_bf16 v[60:63], a[8:11], a[112:115], v[60:63]
ds_read_b64_tr_b16 a[214:215], v252 offset:7040
v_mfma_f32_16x16x32_bf16 v[64:67], a[116:119], a[8:11], v[64:67]
ds_read_b64_tr_b16 a[216:217], v249 offset:12288
v_mfma_f32_16x16x32_bf16 v[68:71], a[104:107], a[12:15], v[68:71]
ds_read_b64_tr_b16 a[224:225], v249 offset:12352
v_mfma_f32_16x16x32_bf16 v[72:75], a[108:111], a[12:15], v[72:75]
buffer_load_dwordx4 v233, s[24:27], s48 offen offset:1024 lds
v_mfma_f32_16x16x32_bf16 v[76:79], a[12:15], a[112:115], v[76:79]
ds_read_b64_tr_b16 a[218:219], v249 offset:13056
v_mfma_f32_16x16x32_bf16 v[80:83], a[116:119], a[12:15], v[80:83]
ds_read_b64_tr_b16 a[220:221], v252 offset:12288
v_mfma_f32_16x16x32_bf16 v[84:87], a[104:107], a[16:19], v[84:87]
ds_read_b64_tr_b16 a[226:227], v249 offset:13120
v_mfma_f32_16x16x32_bf16 v[88:91], a[108:111], a[16:19], v[88:91]
v_mfma_f32_16x16x32_bf16 v[92:95], a[16:19], a[112:115], v[92:95]
ds_read_b64_tr_b16 a[222:223], v252 offset:13056
v_mfma_f32_16x16x32_bf16 v[96:99], a[116:119], a[16:19], v[96:99]
s_waitcnt vmcnt(13) lgkmcnt(9)
v_mfma_f32_16x16x32_bf16 v[20:23], a[120:123], a[20:23], v[20:23]
ds_read_b128 a[0:3], v4 offset:30720
v_mfma_f32_16x16x32_bf16 v[24:27], a[124:127], a[20:23], v[24:27]
buffer_load_dwordx4 v234, s[24:27], s48 offen offset:2048 lds
s_add_u32 s48, s48, 81920
v_mfma_f32_16x16x32_bf16 v[28:31], a[20:23], a[128:131], v[28:31]
ds_read_b128 a[4:7], v4 offset:31744
v_mfma_f32_16x16x32_bf16 v[32:35], a[132:135], a[20:23], v[32:35]
ds_read_b128 a[8:11], v4 offset:32768
v_mfma_f32_16x16x32_bf16 v[36:39], a[120:123], a[24:27], v[36:39]
ds_read_b128 a[12:15], v4 offset:33792
s_add_u32 m0, s49, 122880
v_mfma_f32_16x16x32_bf16 v[40:43], a[124:127], a[24:27], v[40:43]
buffer_load_dwordx4 v235, s[8:11], s50 offen offset:0 lds
v_mfma_f32_16x16x32_bf16 v[44:47], a[24:27], a[128:131], v[44:47]
ds_read_b128 a[16:19], v4 offset:34816
v_mfma_f32_16x16x32_bf16 v[48:51], a[132:135], a[24:27], v[48:51]
ds_read_b64_tr_b16 a[228:229], v252 offset:12352
v_mfma_f32_16x16x32_bf16 v[52:55], a[120:123], a[28:31], v[52:55]
ds_read_b64_tr_b16 a[230:231], v252 offset:13120
v_mfma_f32_16x16x32_bf16 v[56:59], a[124:127], a[28:31], v[56:59]
buffer_load_dwordx4 v236, s[8:11], s50 offen offset:1024 lds
v_mfma_f32_16x16x32_bf16 v[60:63], a[28:31], a[128:131], v[60:63]
ds_read_b64_tr_b16 a[232:233], v249 offset:12416
v_mfma_f32_16x16x32_bf16 v[64:67], a[132:135], a[28:31], v[64:67]
ds_read_b64_tr_b16 a[234:235], v249 offset:13184
v_mfma_f32_16x16x32_bf16 v[68:71], a[120:123], a[32:35], v[68:71]
ds_read_b64_tr_b16 a[242:243], v249 offset:19200
v_mfma_f32_16x16x32_bf16 v[72:75], a[124:127], a[32:35], v[72:75]
buffer_load_dwordx4 v237, s[8:11], s50 offen offset:2048 lds
v_mfma_f32_16x16x32_bf16 v[76:79], a[32:35], a[128:131], v[76:79]
ds_read_b64_tr_b16 a[236:237], v252 offset:12416
v_mfma_f32_16x16x32_bf16 v[80:83], a[132:135], a[32:35], v[80:83]
ds_read_b64_tr_b16 a[238:239], v252 offset:13184
v_mfma_f32_16x16x32_bf16 v[84:87], a[120:123], a[36:39], v[84:87]
ds_read_b64_tr_b16 a[244:245], v252 offset:18432
s_add_u32 m0, s39, 73728
v_mfma_f32_16x16x32_bf16 v[88:91], a[124:127], a[36:39], v[88:91]
buffer_load_dwordx4 v232, s[24:27], s48 offen offset:0 lds
v_mfma_f32_16x16x32_bf16 v[92:95], a[36:39], a[128:131], v[92:95]
ds_read_b64_tr_b16 a[240:241], v249 offset:18432
v_mfma_f32_16x16x32_bf16 v[96:99], a[132:135], a[36:39], v[96:99]
s_waitcnt vmcnt(14) lgkmcnt(9)
v_mfma_f32_16x16x32_bf16 v[20:23], a[136:139], a[0:3], v[20:23]
ds_read_b128 a[20:23], v251 offset:35840
v_mfma_f32_16x16x32_bf16 v[24:27], a[140:143], a[0:3], v[24:27]
buffer_load_dwordx4 v233, s[24:27], s48 offen offset:1024 lds
v_mfma_f32_16x16x32_bf16 v[28:31], a[0:3], a[144:147], v[28:31]
ds_read_b128 a[24:27], v251 offset:36864
v_mfma_f32_16x16x32_bf16 v[32:35], a[148:151], a[0:3], v[32:35]
ds_read_b128 a[28:31], v251 offset:37888
v_mfma_f32_16x16x32_bf16 v[36:39], a[136:139], a[4:7], v[36:39]
ds_read_b128 a[32:35], v251 offset:38912
v_mfma_f32_16x16x32_bf16 v[40:43], a[140:143], a[4:7], v[40:43]
buffer_load_dwordx4 v234, s[24:27], s48 offen offset:2048 lds
s_add_u32 s48, s48, 81920
v_mfma_f32_16x16x32_bf16 v[44:47], a[4:7], a[144:147], v[44:47]
ds_read_b128 a[36:39], v251 offset:39936
v_mfma_f32_16x16x32_bf16 v[48:51], a[148:151], a[4:7], v[48:51]
ds_read_b64_tr_b16 a[246:247], v252 offset:19200
v_mfma_f32_16x16x32_bf16 v[52:55], a[136:139], a[8:11], v[52:55]
ds_read_b64_tr_b16 a[248:249], v249 offset:18496
s_add_u32 m0, s39, 86016
v_mfma_f32_16x16x32_bf16 v[56:59], a[140:143], a[8:11], v[56:59]
buffer_load_dwordx4 v232, s[24:27], s48 offen offset:0 lds
v_mfma_f32_16x16x32_bf16 v[60:63], a[8:11], a[144:147], v[60:63]
ds_read_b64_tr_b16 a[250:251], v249 offset:19264
v_mfma_f32_16x16x32_bf16 v[64:67], a[148:151], a[8:11], v[64:67]
ds_read_b64_tr_b16 a[252:253], v252 offset:18496
v_mfma_f32_16x16x32_bf16 v[68:71], a[136:139], a[12:15], v[68:71]
ds_read_b64_tr_b16 a[44:45], v252 offset:18560
v_mfma_f32_16x16x32_bf16 v[72:75], a[140:143], a[12:15], v[72:75]
buffer_load_dwordx4 v233, s[24:27], s48 offen offset:1024 lds
v_mfma_f32_16x16x32_bf16 v[76:79], a[12:15], a[144:147], v[76:79]
ds_read_b64_tr_b16 a[254:255], v252 offset:19264
v_mfma_f32_16x16x32_bf16 v[80:83], a[148:151], a[12:15], v[80:83]
ds_read_b64_tr_b16 a[40:41], v249 offset:18560
v_mfma_f32_16x16x32_bf16 v[84:87], a[136:139], a[16:19], v[84:87]
ds_read_b64_tr_b16 a[46:47], v252 offset:19328
v_mfma_f32_16x16x32_bf16 v[88:91], a[140:143], a[16:19], v[88:91]
v_mfma_f32_16x16x32_bf16 v[92:95], a[16:19], a[144:147], v[92:95]
ds_read_b64_tr_b16 a[42:43], v249 offset:19328
v_mfma_f32_16x16x32_bf16 v[96:99], a[148:151], a[16:19], v[96:99]
s_waitcnt vmcnt(14) lgkmcnt(9)
s_barrier
s_mov_b32 s62, 1051011932
s_mov_b32 s63, 1051011932
s_mov_b32 s20, 0
s_mov_b32 s21, 0x00ff00ff
v_mfma_f32_16x16x32_bf16 v[32:35], a[164:167], a[20:23], v[32:35]
buffer_load_dwordx2 v[194:195], v231, s[4:7], s23 offen sc1
v_mfma_f32_16x16x32_bf16 v[48:51], a[164:167], a[24:27], v[48:51]
v_mfma_f32_16x16x32_bf16 v[64:67], a[164:167], a[28:31], v[64:67]
v_mfma_f32_16x16x32_bf16 v[80:83], a[164:167], a[32:35], v[80:83]
v_mfma_f32_16x16x32_bf16 v[20:23], a[152:155], a[20:23], v[20:23]
v_mfma_f32_16x16x32_bf16 v[24:27], a[156:159], a[20:23], v[24:27]
v_mfma_f32_16x16x32_bf16 v[36:39], a[152:155], a[24:27], v[36:39]
s_nop 0
v_cvt_pk_bf16_f32 v102, v32, v33
v_mfma_f32_16x16x32_bf16 v[40:43], a[156:159], a[24:27], v[40:43]
v_cvt_pk_bf16_f32 v103, v34, v35
v_cvt_pk_bf16_f32 v106, v48, v49
v_mfma_f32_16x16x32_bf16 v[52:55], a[152:155], a[28:31], v[52:55]
v_cvt_pk_bf16_f32 v107, v50, v51
v_cvt_pk_bf16_f32 v110, v64, v65
v_mfma_f32_16x16x32_bf16 v[56:59], a[156:159], a[28:31], v[56:59]
buffer_load_dwordx4 v[240:243], v238, s[4:7], s51 offen sc1
v_cvt_pk_bf16_f32 v111, v66, v67
v_cvt_pk_bf16_f32 v114, v80, v81
v_mfma_f32_16x16x32_bf16 v[68:71], a[152:155], a[32:35], v[68:71]
v_cvt_pk_bf16_f32 v115, v82, v83
v_permlane32_swap_b32 v122, v102
v_mfma_f32_16x16x32_bf16 v[72:75], a[156:159], a[32:35], v[72:75]
v_permlane32_swap_b32 v123, v103
v_permlane32_swap_b32 v126, v106
v_permlane32_swap_b32 v127, v107
v_permlane32_swap_b32 v130, v110
v_permlane32_swap_b32 v131, v111
v_permlane32_swap_b32 v134, v114
v_permlane32_swap_b32 v135, v115
v_cvt_pk_bf16_f32 v100, v24, v25
v_cvt_pk_bf16_f32 v101, v26, v27
v_cvt_pk_bf16_f32 v120, v20, v21
v_cvt_pk_bf16_f32 v121, v22, v23
buffer_load_dwordx4 v[190:193], v238, s[4:7], s22 offen sc1
v_cvt_pk_bf16_f32 v104, v40, v41
v_cvt_pk_bf16_f32 v105, v42, v43
v_cvt_pk_bf16_f32 v124, v36, v37
v_cvt_pk_bf16_f32 v125, v38, v39
v_cvt_pk_bf16_f32 v108, v56, v57
v_cvt_pk_bf16_f32 v109, v58, v59
v_cvt_pk_bf16_f32 v128, v52, v53
v_cvt_pk_bf16_f32 v129, v54, v55
v_cvt_pk_bf16_f32 v112, v72, v73
v_cvt_pk_bf16_f32 v113, v74, v75
v_cvt_pk_bf16_f32 v132, v68, v69
v_cvt_pk_bf16_f32 v133, v70, v71
v_mfma_f32_16x16x32_bf16 v[24:27], v[100:103], v[120:123], v[164:167]
v_mfma_f32_16x16x32_bf16 v[40:43], v[104:107], v[124:127], v[164:167]
buffer_load_dwordx2 v[244:245], v239, s[28:31], s52 offen
v_mfma_f32_16x16x32_bf16 v[36:39], v[100:103], v[124:127], v[164:167]
v_mfma_f32_16x16x32_bf16 v[56:59], v[108:111], v[128:131], v[164:167]
v_mfma_f32_16x16x32_bf16 v[52:55], v[104:107], v[128:131], v[164:167]
v_mfma_f32_16x16x32_bf16 v[72:75], v[112:115], v[132:135], v[164:167]
v_mfma_f32_16x16x32_bf16 v[68:71], v[108:111], v[132:135], v[164:167]
s_nop 0
v_cndmask_b32 v24, v24, v168, s[20:21]
v_cndmask_b32 v25, v25, v168, s[20:21]
v_cndmask_b32 v26, v26, v168, s[20:21]
v_cndmask_b32 v40, v40, v36, s[20:21]
v_cndmask_b32 v41, v41, v37, s[20:21]
v_cndmask_b32 v42, v42, v38, s[20:21]
v_cndmask_b32 v56, v56, v52, s[20:21]
v_cndmask_b32 v57, v57, v53, s[20:21]
v_cndmask_b32 v58, v58, v54, s[20:21]
v_cndmask_b32 v72, v72, v68, s[20:21]
v_cndmask_b32 v73, v73, v69, s[20:21]
v_cndmask_b32 v74, v74, v70, s[20:21]
buffer_load_dword v196, v226, s[4:7], s14 offen sc1
v_cndmask_b32 v27, v27, v168, s[20:21]
v_max3_f32 v180, v24, v25, v26
v_cndmask_b32 v43, v43, v39, s[20:21]
v_max3_f32 v181, v40, v41, v42
v_cndmask_b32 v59, v59, v55, s[20:21]
v_max3_f32 v182, v56, v57, v58
v_cndmask_b32 v75, v75, v71, s[20:21]
v_max3_f32 v183, v72, v73, v74
v_max_f32 v180, v180, v27
v_max_f32 v181, v181, v43
v_max_f32 v182, v182, v59
v_max_f32 v183, v183, v75
v_mfma_f32_16x16x32_bf16 v[96:99], a[164:167], a[36:39], v[96:99]
v_permlane32_swap_b32 v180, v182
v_permlane32_swap_b32 v181, v183
v_max_f32 v180, v180, v182
v_max_f32 v181, v181, v183
buffer_load_dwordx4 v234, s[24:27], s48 offen offset:2048 lds
s_add_u32 s48, s48, 81920
v_mfma_f32_16x16x32_bf16 v[84:87], a[152:155], a[36:39], v[84:87]
v_permlane16_swap_b32 v180, v181
v_max_f32 v181, v180, v181
v_mul_f32 v180, s62, v181
v_mul_f32 v182, s62, v181
v_mfma_f32_16x16x32_bf16 v[88:91], a[156:159], a[36:39], v[88:91]
s_nop 0
v_permlane32_swap_b32 v180, v182
v_mfma_f32_16x16x32_bf16 v[28:31], a[20:23], a[160:163], v[28:31]
v_mov_b32 v181, v180
v_cvt_pk_bf16_f32 v118, v96, v97
v_mfma_f32_16x16x16_bf16 v[32:35], v[102:103], v[174:175], 0
v_cvt_pk_bf16_f32 v119, v98, v99
v_permlane16_swap_b32 v180, v181
s_add_u32 m0, s39, 98304
v_mfma_f32_16x16x32_bf16 v[44:47], a[24:27], a[160:163], v[44:47]
buffer_load_dwordx4 v232, s[24:27], s48 offen offset:0 lds
v_permlane32_swap_b32 v138, v118
v_permlane32_swap_b32 v139, v119
v_cvt_pk_bf16_f32 v116, v88, v89
v_pk_fma_f32 v[24:25], v[24:25], s[62:63], v[180:181] op_sel:[0,0,0] op_sel_hi:[1,0,0] neg_lo:[0,0,1] neg_hi:[0,0,1]
v_pk_fma_f32 v[26:27], v[26:27], s[62:63], v[180:181] op_sel:[0,0,0] op_sel_hi:[1,0,0] neg_lo:[0,0,1] neg_hi:[0,0,1]
v_cvt_pk_bf16_f32 v117, v90, v91
v_cvt_pk_bf16_f32 v136, v84, v85
v_cvt_pk_bf16_f32 v137, v86, v87
v_exp_f32 v24, v24
v_exp_f32 v25, v25
v_exp_f32 v26, v26
v_exp_f32 v27, v27
v_cvt_pk_bf16_f32 v143, v30, v31
v_mfma_f32_16x16x16_bf16 v[48:51], v[106:107], v[174:175], 0
buffer_load_dwordx4 v233, s[24:27], s48 offen offset:1024 lds
v_cvt_pk_bf16_f32 v30, v24, v25
v_cvt_pk_bf16_f32 v31, v26, v27
v_mfma_f32_16x16x32_bf16 v[88:91], v[116:119], v[136:139], v[164:167]
v_cvt_pk_bf16_f32 v154, v32, v33
v_cvt_pk_bf16_f32 v155, v34, v35
v_mfma_f32_16x16x32_bf16 v[84:87], v[112:115], v[136:139], v[164:167]
v_cvt_pk_bf16_f32 v142, v28, v29
v_cvt_pk_bf16_f32 v145, v46, v47
v_mfma_f32_16x16x32_bf16 v[60:63], a[28:31], a[160:163], v[60:63]
v_mov_b32 v183, v182
v_cvt_pk_bf16_f32 v144, v44, v45
v_mfma_f32_16x16x16_bf16 v[32:35], v[176:177], v[30:31], 0
v_permlane16_swap_b32 v182, v183
v_mfma_f32_16x16x16_bf16 v[20:23], v[142:143], v[30:31], 0
buffer_load_dwordx4 v234, s[24:27], s48 offen offset:2048 lds
s_add_u32 s48, s48, 81920
v_cvt_pk_bf16_f32 v156, v48, v49
v_cvt_pk_bf16_f32 v157, v50, v51
v_mfma_f32_16x16x16_bf16 v[64:67], v[110:111], v[174:175], 0
v_cndmask_b32 v88, v88, v84, s[20:21]
v_cndmask_b32 v89, v89, v85, s[20:21]
v_cndmask_b32 v90, v90, v86, s[20:21]
v_mfma_f32_16x16x16_bf16 v[24:27], v[154:155], v[30:31], 0
v_cndmask_b32 v91, v91, v87, s[20:21]
v_max3_f32 v184, v88, v89, v90
v_mfma_f32_16x16x32_bf16 v[76:79], a[32:35], a[160:163], v[76:79]
v_max_f32 v184, v184, v91
v_cvt_pk_bf16_f32 v147, v62, v63
v_mov_b32 v185, v184
v_rcp_f32 v32, v32
v_pk_fma_f32 v[40:41], v[40:41], s[62:63], v[180:181] op_sel:[0,0,1] op_sel_hi:[1,0,1] neg_lo:[0,0,1] neg_hi:[0,0,1]
v_pk_fma_f32 v[42:43], v[42:43], s[62:63], v[180:181] op_sel:[0,0,1] op_sel_hi:[1,0,1] neg_lo:[0,0,1] neg_hi:[0,0,1]
v_exp_f32 v40, v40
v_exp_f32 v41, v41
v_exp_f32 v42, v42
v_exp_f32 v43, v43
v_cvt_pk_bf16_f32 v46, v40, v41
v_cvt_pk_bf16_f32 v47, v42, v43
v_cndmask_b32 v44, 0, v46, s[20:21]
v_cndmask_b32 v45, 0, v47, s[20:21]
v_xor_b32 v46, v44, v46
v_xor_b32 v47, v45, v47
v_pk_fma_f32 v[56:57], v[56:57], s[62:63], v[182:183] op_sel:[0,0,0] op_sel_hi:[1,0,0] neg_lo:[0,0,1] neg_hi:[0,0,1]
v_pk_fma_f32 v[58:59], v[58:59], s[62:63], v[182:183] op_sel:[0,0,0] op_sel_hi:[1,0,0] neg_lo:[0,0,1] neg_hi:[0,0,1]
v_mfma_f32_16x16x32_bf16 v[48:51], v[176:179], v[44:47], 0
v_exp_f32 v56, v56
v_exp_f32 v57, v57
v_exp_f32 v58, v58
v_exp_f32 v59, v59
v_cvt_pk_bf16_f32 v146, v60, v61
v_mfma_f32_16x16x32_bf16 v[36:39], v[142:145], v[44:47], 0
v_cvt_pk_bf16_f32 v62, v56, v57
v_cvt_pk_bf16_f32 v63, v58, v59
v_cndmask_b32 v60, 0, v62, s[20:21]
v_cndmask_b32 v61, 0, v63, s[20:21]
v_mfma_f32_16x16x16_bf16 v[80:83], v[114:115], v[174:175], 0
v_permlane32_swap_b32 v184, v185
v_xor_b32 v62, v60, v62
v_xor_b32 v63, v61, v63
v_cvt_pk_bf16_f32 v158, v64, v65
v_pk_mul_f32 v[20:21], v[20:21], v[32:33] op_sel_hi:[1,0]
v_pk_mul_f32 v[22:23], v[22:23], v[32:33] op_sel_hi:[1,0]
v_cvt_pk_bf16_f32 v20, v20, v21
v_cvt_pk_bf16_f32 v159, v66, v67
v_max_f32 v184, v184, v185
v_cvt_pk_bf16_f32 v21, v22, v23
v_mfma_f32_16x16x32_bf16 v[40:43], v[154:157], v[44:47], 0
ds_write_b64 v228, v[20:21] offset:0
v_mfma_f32_16x16x32_bf16 v[92:95], a[36:39], a[160:163], v[92:95]
v_mov_b32 v185, v184
v_cvt_pk_bf16_f32 v149, v78, v79
v_mfma_f32_16x16x32_bf16 v[64:67], v[176:179], v[60:63], 0
v_rcp_f32 v48, v48
v_cvt_pk_bf16_f32 v148, v76, v77
v_permlane16_swap_b32 v184, v185
v_pk_fma_f32 v[72:73], v[72:73], s[62:63], v[182:183] op_sel:[0,0,1] op_sel_hi:[1,0,1] neg_lo:[0,0,1] neg_hi:[0,0,1]
v_pk_fma_f32 v[74:75], v[74:75], s[62:63], v[182:183] op_sel:[0,0,1] op_sel_hi:[1,0,1] neg_lo:[0,0,1] neg_hi:[0,0,1]
v_exp_f32 v72, v72
v_exp_f32 v73, v73
v_exp_f32 v74, v74
v_exp_f32 v75, v75
v_pk_mul_f32 v[24:25], v[24:25], v[32:33] op_sel_hi:[1,0]
v_pk_mul_f32 v[26:27], v[26:27], v[32:33] op_sel_hi:[1,0]
v_cvt_pk_bf16_f32 v24, v24, v25
v_cvt_pk_bf16_f32 v25, v26, v27
v_mfma_f32_16x16x32_bf16 v[52:55], v[144:147], v[60:63], 0
ds_write_b64 v229, v[24:25] offset:32
v_cvt_pk_bf16_f32 v78, v72, v73
v_cvt_pk_bf16_f32 v79, v74, v75
v_cndmask_b32 v76, 0, v78, s[20:21]
v_cndmask_b32 v77, 0, v79, s[20:21]
v_mfma_f32_16x16x16_bf16 v[96:99], v[118:119], v[174:175], 0
v_max_f32 v184, v184, v185
v_xor_b32 v78, v76, v78
v_xor_b32 v79, v77, v79
v_mul_f32 v184, s62, v184
v_cvt_pk_bf16_f32 v160, v80, v81
v_pk_mul_f32 v[36:37], v[36:37], v[48:49] op_sel_hi:[1,0]
v_pk_mul_f32 v[38:39], v[38:39], v[48:49] op_sel_hi:[1,0]
v_cvt_pk_bf16_f32 v36, v36, v37
v_cvt_pk_bf16_f32 v161, v82, v83
v_cvt_pk_bf16_f32 v37, v38, v39
v_mfma_f32_16x16x32_bf16 v[56:59], v[156:159], v[60:63], 0
ds_write_b64 v228, v[36:37] offset:2816
v_mfma_f32_16x16x32_bf16 v[80:83], v[176:179], v[76:79], 0
v_cvt_pk_bf16_f32 v151, v94, v95
v_rcp_f32 v64, v64
v_cvt_pk_bf16_f32 v150, v92, v93
v_mfma_f32_16x16x32_bf16 v[68:71], v[146:149], v[76:79], 0
v_cvt_pk_bf16_f32 v162, v96, v97
v_cvt_pk_bf16_f32 v163, v98, v99
v_mfma_f32_16x16x32_bf16 v[72:75], v[158:161], v[76:79], 0
s_nop 0
v_rcp_f32 v80, v80
v_pk_fma_f32 v[88:89], v[88:89], s[62:63], v[184:185] op_sel:[0,0,0] op_sel_hi:[1,0,0] neg_lo:[0,0,1] neg_hi:[0,0,1]
v_pk_fma_f32 v[90:91], v[90:91], s[62:63], v[184:185] op_sel:[0,0,0] op_sel_hi:[1,0,0] neg_lo:[0,0,1] neg_hi:[0,0,1]
v_exp_f32 v88, v88
v_exp_f32 v89, v89
v_exp_f32 v90, v90
v_exp_f32 v91, v91
v_pk_mul_f32 v[40:41], v[40:41], v[48:49] op_sel_hi:[1,0]
v_pk_mul_f32 v[42:43], v[42:43], v[48:49] op_sel_hi:[1,0]
v_cvt_pk_bf16_f32 v40, v40, v41
v_cvt_pk_bf16_f32 v41, v42, v43
v_cvt_pk_bf16_f32 v94, v88, v89
v_cvt_pk_bf16_f32 v95, v90, v91
ds_write_b64 v229, v[40:41] offset:2848
v_cndmask_b32 v92, 0, v94, s[20:21]
v_cndmask_b32 v93, 0, v95, s[20:21]
v_pk_mul_f32 v[52:53], v[52:53], v[64:65] op_sel_hi:[1,0]
v_xor_b32 v94, v92, v94
v_xor_b32 v95, v93, v95
v_pk_mul_f32 v[54:55], v[54:55], v[64:65] op_sel_hi:[1,0]
v_cvt_pk_bf16_f32 v52, v52, v53
v_cvt_pk_bf16_f32 v53, v54, v55
ds_write_b64 v228, v[52:53] offset:5632
v_mfma_f32_16x16x32_bf16 v[96:99], v[176:179], v[92:95], 0
v_mfma_f32_16x16x32_bf16 v[84:87], v[148:151], v[92:95], 0
v_mfma_f32_16x16x32_bf16 v[88:91], v[160:163], v[92:95], 0
v_pk_mul_f32 v[56:57], v[56:57], v[64:65] op_sel_hi:[1,0]
v_pk_mul_f32 v[58:59], v[58:59], v[64:65] op_sel_hi:[1,0]
v_cvt_pk_bf16_f32 v56, v56, v57
v_cvt_pk_bf16_f32 v57, v58, v59
ds_write_b64 v229, v[56:57] offset:5664
v_pk_mul_f32 v[68:69], v[68:69], v[80:81] op_sel_hi:[1,0]
v_pk_mul_f32 v[70:71], v[70:71], v[80:81] op_sel_hi:[1,0]
v_cvt_pk_bf16_f32 v68, v68, v69
v_cvt_pk_bf16_f32 v69, v70, v71
ds_write_b64 v228, v[68:69] offset:8448
v_pk_mul_f32 v[72:73], v[72:73], v[80:81] op_sel_hi:[1,0]
v_pk_mul_f32 v[74:75], v[74:75], v[80:81] op_sel_hi:[1,0]
v_cvt_pk_bf16_f32 v72, v72, v73
v_rcp_f32 v96, v96
v_cvt_pk_bf16_f32 v73, v74, v75
ds_write_b64 v229, v[72:73] offset:8480
v_pk_mul_f32 v[84:85], v[84:85], v[96:97] op_sel_hi:[1,0]
v_pk_mul_f32 v[86:87], v[86:87], v[96:97] op_sel_hi:[1,0]
v_cvt_pk_bf16_f32 v84, v84, v85
v_cvt_pk_bf16_f32 v85, v86, v87
ds_write_b64 v228, v[84:85] offset:11264
v_pk_mul_f32 v[88:89], v[88:89], v[96:97] op_sel_hi:[1,0]
v_pk_mul_f32 v[90:91], v[90:91], v[96:97] op_sel_hi:[1,0]
v_cvt_pk_bf16_f32 v88, v88, v89
v_cvt_pk_bf16_f32 v89, v90, v91
ds_write_b64 v229, v[88:89] offset:11296
s_waitcnt vmcnt(17) lgkmcnt(0)
s_barrier
ds_read_b128 v[20:23], v15 offset:0
ds_read_b128 v[24:27], v16 offset:256
ds_read_b128 v[28:31], v17 offset:512
ds_read_b128 v[32:35], v18 offset:768
s_mul_i32 s56, s53, 20480
s_add_u32 s56, s56, 4194304
s_mov_b32 s55, 0x05040100
s_add_u32 s57, s56, 4096
s_add_u32 s58, s56, 8192
s_add_u32 s59, s56, 12288
s_add_u32 s60, s56, 16384
s_waitcnt lgkmcnt(3)
buffer_store_dwordx4 v[20:23], v11, s[4:7], s46 offen sc1
s_waitcnt lgkmcnt(2)
buffer_store_dwordx4 v[24:27], v12, s[4:7], s46 offen sc1
s_waitcnt lgkmcnt(1)
buffer_store_dwordx4 v[28:31], v13, s[4:7], s46 offen sc1
s_waitcnt lgkmcnt(0)
buffer_store_dwordx4 v[32:35], v14, s[4:7], s46 offen sc1
s_waitcnt vmcnt(8)
v_perm_b32 v36, v241, v240, s55
v_perm_b32 v37, v243, v242, s55
v_xor_b32 v36, s40, v36
v_xor_b32 v37, s40, v37
v_or_b32 v38, v36, v37
v_perm_b32 v36, v191, v190, s55
v_perm_b32 v37, v193, v192, s55
v_xor_b32 v36, s40, v36
v_xor_b32 v37, s40, v37
v_or3_b32 v38, v38, v36, v37
v_and_b32 v38, v38, v230
v_xor_b32 v37, s40, v194
v_or_b32 v38, v38, v37
v_cmp_ne_u32 vcc, 0, v38
s_cbranch_vccnz L_mv_retry
L_mv_ok:
v_cmp_ne_u32 vcc, s19, v195
v_and_b32 v240, 0xffff0000, v240
v_and_b32 v241, 0xffff0000, v241
v_and_b32 v242, 0xffff0000, v242
v_and_b32 v243, 0xffff0000, v243
v_and_b32 v190, 0xffff0000, v190
v_and_b32 v191, 0xffff0000, v191
v_and_b32 v192, 0xffff0000, v192
v_and_b32 v193, 0xffff0000, v193
s_lshr_b32 s15, vcc_lo, 16
v_lshlrev_b32 v40, 16, v244
v_and_b32 v41, 0xffff0000, v244
v_lshlrev_b32 v42, 16, v245
v_and_b32 v43, 0xffff0000, v245
v_pk_mul_f32 v[40:41], v[40:41], v[190:191]
v_pk_mul_f32 v[42:43], v[42:43], v[192:193]
s_mov_b32 exec_hi, 0xffff
ds_write_b128 v227, v[40:43] offset:1536
ds_write_b128 v227, v[240:243]
ds_write_b128 v227, v[190:193] offset:768
s_mov_b32 exec_hi, -1
s_add_u32 m0, s39, 110592
s_nop 0
buffer_load_dwordx4 v232, s[24:27], s48 offen offset:0 lds
ds_read_b128 v[204:207], v247 offset:1536
ds_read_b128 v[208:211], v247 offset:1600
ds_read_b128 v[212:215], v247 offset:1664
ds_read_b128 v[216:219], v247 offset:1728
ds_read_b128 v[220:223], v247 offset:1792
ds_read_b128 v[224:227], v247 offset:1856
buffer_load_dwordx4 v233, s[24:27], s48 offen offset:1024 lds
ds_read_b64 v[80:81], v248 offset:0
ds_read_b64 v[82:83], v248 offset:32
ds_read_b64 v[84:85], v248 offset:64
ds_read_b64 v[86:87], v248 offset:96
ds_read_b64 v[88:89], v248 offset:128
ds_read_b64 v[90:91], v248 offset:160
buffer_load_dwordx4 v234, s[24:27], s48 offen offset:2048 lds
s_add_u32 s48, s48, 81920
ds_read_b64_tr_b16 a[48:49], v249 offset:24576
ds_read_b64_tr_b16 a[50:51], v249 offset:25344
ds_read_b64_tr_b16 a[52:53], v252 offset:24576
ds_read_b64_tr_b16 a[54:55], v252 offset:25344
ds_read_b64_tr_b16 a[56:57], v249 offset:24640
ds_read_b64_tr_b16 a[58:59], v249 offset:25408
ds_read_b64_tr_b16 a[60:61], v252 offset:24640
ds_read_b64_tr_b16 a[62:63], v252 offset:25408
ds_read_b64_tr_b16 a[64:65], v249 offset:24704
ds_read_b64_tr_b16 a[66:67], v249 offset:25472
ds_read_b64_tr_b16 a[68:69], v252 offset:24704
ds_read_b64_tr_b16 a[70:71], v252 offset:25472
ds_read_b64_tr_b16 a[72:73], v249 offset:30720
ds_read_b64_tr_b16 a[74:75], v249 offset:31488
ds_read_b64_tr_b16 a[76:77], v252 offset:30720
ds_read_b64_tr_b16 a[78:79], v252 offset:31488
ds_read_b64_tr_b16 a[80:81], v249 offset:30784
ds_read_b64_tr_b16 a[82:83], v249 offset:31552
ds_read_b64_tr_b16 a[84:85], v252 offset:30784
ds_read_b64_tr_b16 a[86:87], v252 offset:31552
ds_read_b64_tr_b16 a[88:89], v249 offset:30848
ds_read_b64_tr_b16 a[90:91], v249 offset:31616
ds_read_b64_tr_b16 a[92:93], v252 offset:30848
ds_read_b64_tr_b16 a[94:95], v252 offset:31616
ds_read_b64_tr_b16 a[96:97], v249 offset:36864
ds_read_b64_tr_b16 a[98:99], v249 offset:37632
ds_read_b64_tr_b16 a[100:101], v252 offset:36864
ds_read_b64_tr_b16 a[102:103], v252 offset:37632
ds_read_b64_tr_b16 a[104:105], v249 offset:36928
ds_read_b64_tr_b16 a[106:107], v249 offset:37696
ds_read_b64_tr_b16 a[108:109], v252 offset:36928
ds_read_b64_tr_b16 a[110:111], v252 offset:37696
ds_read_b64_tr_b16 a[112:113], v249 offset:36992
ds_read_b64_tr_b16 a[114:115], v249 offset:37760
ds_read_b64_tr_b16 a[116:117], v252 offset:36992
ds_read_b64_tr_b16 a[118:119], v252 offset:37760
ds_read_b64_tr_b16 a[120:121], v249 offset:43008
ds_read_b64_tr_b16 a[122:123], v249 offset:43776
ds_read_b64_tr_b16 a[124:125], v252 offset:43008
ds_read_b64_tr_b16 a[126:127], v252 offset:43776
ds_read_b64_tr_b16 a[128:129], v249 offset:43072
ds_read_b64_tr_b16 a[130:131], v249 offset:43840
ds_read_b64_tr_b16 a[132:133], v252 offset:43072
ds_read_b64_tr_b16 a[134:135], v252 offset:43840
ds_read_b64_tr_b16 a[136:137], v249 offset:43136
ds_read_b64_tr_b16 a[138:139], v249 offset:43904
buffer_load_dwordx4 v[100:103], v7, s[4:7], s56 offen offset:0 sc1
ds_read_b64_tr_b16 a[140:141], v252 offset:43136
ds_read_b64_tr_b16 a[142:143], v252 offset:43904
ds_read_b64_tr_b16 a[144:145], v249 offset:49152
ds_read_b64_tr_b16 a[146:147], v249 offset:49920
buffer_load_dwordx4 v[104:107], v7, s[4:7], s56 offen offset:1024 sc1
ds_read_b64_tr_b16 a[148:149], v252 offset:49152
ds_read_b64_tr_b16 a[150:151], v252 offset:49920
ds_read_b64_tr_b16 a[152:153], v249 offset:49216
ds_read_b64_tr_b16 a[154:155], v249 offset:49984
buffer_load_dwordx4 v[108:111], v7, s[4:7], s56 offen offset:2048 sc1
ds_read_b64_tr_b16 a[156:157], v252 offset:49216
ds_read_b64_tr_b16 a[158:159], v252 offset:49984
ds_read_b64_tr_b16 a[160:161], v249 offset:49280
ds_read_b64_tr_b16 a[162:163], v249 offset:50048
buffer_load_dwordx4 v[112:115], v7, s[4:7], s56 offen offset:3072 sc1
ds_read_b64_tr_b16 a[164:165], v252 offset:49280
ds_read_b64_tr_b16 a[166:167], v252 offset:50048
ds_read_b64_tr_b16 a[0:1], v249 offset:55296
ds_read_b64_tr_b16 a[2:3], v249 offset:56064
buffer_load_dwordx4 v[116:119], v7, s[4:7], s57 offen offset:0 sc1
ds_read_b64_tr_b16 a[4:5], v252 offset:55296
ds_read_b64_tr_b16 a[6:7], v252 offset:56064
ds_read_b64_tr_b16 a[8:9], v249 offset:55360
ds_read_b64_tr_b16 a[10:11], v249 offset:56128
buffer_load_dwordx4 v[120:123], v7, s[4:7], s57 offen offset:1024 sc1
ds_read_b64_tr_b16 a[12:13], v252 offset:55360
ds_read_b64_tr_b16 a[14:15], v252 offset:56128
ds_read_b64_tr_b16 a[16:17], v249 offset:55424
ds_read_b64_tr_b16 a[18:19], v249 offset:56192
buffer_load_dwordx4 v[124:127], v7, s[4:7], s57 offen offset:2048 sc1
ds_read_b64_tr_b16 a[20:21], v252 offset:55424
ds_read_b64_tr_b16 a[22:23], v252 offset:56192
ds_read_b64_tr_b16 a[24:25], v253 offset:0
ds_read_b64_tr_b16 a[26:27], v253 offset:768
buffer_load_dwordx4 v[128:131], v7, s[4:7], s57 offen offset:3072 sc1
ds_read_b64_tr_b16 a[28:29], v254 offset:0
ds_read_b64_tr_b16 a[30:31], v254 offset:768
ds_read_b64_tr_b16 a[32:33], v253 offset:64
ds_read_b64_tr_b16 a[34:35], v253 offset:832
buffer_load_dwordx4 v[132:135], v7, s[4:7], s58 offen offset:0 sc1
s_waitcnt lgkmcnt(15)
v_pk_add_f32 v[94:95], v[204:205], v[206:207]
v_pk_add_f32 v[94:95], v[94:95], v[208:209]
v_pk_add_f32 v[94:95], v[94:95], v[210:211]
buffer_load_dwordx4 v[136:139], v7, s[4:7], s58 offen offset:1024 sc1
v_pk_add_f32 v[94:95], v[94:95], v[212:213]
v_pk_add_f32 v[94:95], v[94:95], v[214:215]
v_pk_add_f32 v[94:95], v[94:95], v[216:217]
v_pk_add_f32 v[94:95], v[94:95], v[218:219]
v_pk_add_f32 v[94:95], v[94:95], v[220:221]
v_pk_add_f32 v[94:95], v[94:95], v[222:223]
v_pk_add_f32 v[94:95], v[94:95], v[224:225]
v_pk_add_f32 v[94:95], v[94:95], v[226:227]
v_add_f32 v95, v94, v95
s_waitcnt vmcnt(8) lgkmcnt(0)
v_max3_u32 v92, v100, v101, v102
v_max3_u32 v93, v103, v104, v105
v_max3_u32 v92, v92, v106, v107
v_max_u32 v92, v92, v93
v_cmp_eq_u32 vcc, -1, v92
s_cbranch_vccnz L_o0_retry
L_o0_ok:
v_mfma_f32_16x16x32_bf16 v[20:23], a[168:171], v[100:103], 0
ds_read_b64_tr_b16 a[168:169], v254 offset:64
buffer_load_dwordx4 v[140:143], v7, s[4:7], s58 offen offset:2048 sc1
v_mfma_f32_16x16x32_bf16 v[24:27], a[172:175], v[100:103], 0
ds_read_b64_tr_b16 a[170:171], v254 offset:832
buffer_load_dwordx4 v[144:147], v7, s[4:7], s58 offen offset:3072 sc1
v_mfma_f32_16x16x32_bf16 v[28:31], a[176:179], v[100:103], 0
ds_read_b64_tr_b16 a[172:173], v253 offset:128
s_barrier
v_mfma_f32_16x16x32_bf16 v[32:35], a[180:183], v[100:103], 0
ds_read_b64_tr_b16 a[174:175], v253 offset:896
s_waitcnt vmcnt(8)
v_mfma_f32_16x16x32_bf16 v[36:39], a[184:187], v[100:103], 0
ds_read_b64_tr_b16 a[176:177], v254 offset:128
v_max3_u32 v92, v108, v109, v110
v_mfma_f32_16x16x32_bf16 v[40:43], a[188:191], v[100:103], 0
ds_read_b64_tr_b16 a[178:179], v254 offset:896
v_max3_u32 v93, v111, v112, v113
v_mfma_f32_16x16x32_bf16 v[20:23], a[192:195], v[104:107], v[20:23]
ds_read_b64_tr_b16 a[180:181], v253 offset:6144
v_max3_u32 v92, v92, v114, v115
v_mfma_f32_16x16x32_bf16 v[24:27], a[196:199], v[104:107], v[24:27]
ds_read_b64_tr_b16 a[182:183], v253 offset:6912
v_max_u32 v92, v92, v93
v_mfma_f32_16x16x32_bf16 v[28:31], a[200:203], v[104:107], v[28:31]
ds_read_b64_tr_b16 a[184:185], v254 offset:6144
v_lshlrev_b32 v68, 16, v80
v_mfma_f32_16x16x32_bf16 v[32:35], a[204:207], v[104:107], v[32:35]
ds_read_b64_tr_b16 a[186:187], v254 offset:6912
v_cmp_eq_u32 vcc, -1, v92
v_mfma_f32_16x16x32_bf16 v[36:39], a[208:211], v[104:107], v[36:39]
ds_read_b64_tr_b16 a[188:189], v253 offset:6208
v_and_b32 v69, 0xffff0000, v80
v_mfma_f32_16x16x32_bf16 v[40:43], a[212:215], v[104:107], v[40:43]
ds_read_b64_tr_b16 a[190:191], v253 offset:6976
s_cbranch_vccnz L_o1_retry
L_o1_ok:
v_mfma_f32_16x16x32_bf16 v[20:23], a[216:219], v[108:111], v[20:23]
ds_read_b64_tr_b16 a[192:193], v254 offset:6208
buffer_load_dwordx4 v[148:151], v7, s[4:7], s59 offen offset:0 sc1
v_mfma_f32_16x16x32_bf16 v[24:27], a[220:223], v[108:111], v[24:27]
ds_read_b64_tr_b16 a[194:195], v254 offset:6976
buffer_load_dwordx4 v[152:155], v7, s[4:7], s59 offen offset:1024 sc1
v_mfma_f32_16x16x32_bf16 v[28:31], a[224:227], v[108:111], v[28:31]
ds_read_b64_tr_b16 a[196:197], v253 offset:6272
v_lshlrev_b32 v70, 16, v81
v_mfma_f32_16x16x32_bf16 v[32:35], a[228:231], v[108:111], v[32:35]
ds_read_b64_tr_b16 a[198:199], v253 offset:7040
s_waitcnt vmcnt(8)
v_mfma_f32_16x16x32_bf16 v[36:39], a[232:235], v[108:111], v[36:39]
ds_read_b64_tr_b16 a[200:201], v254 offset:6272
v_max3_u32 v92, v116, v117, v118
v_mfma_f32_16x16x32_bf16 v[40:43], a[236:239], v[108:111], v[40:43]
ds_read_b64_tr_b16 a[202:203], v254 offset:7040
v_max3_u32 v93, v119, v120, v121
v_mfma_f32_16x16x32_bf16 v[20:23], a[240:243], v[112:115], v[20:23]
ds_read_b64_tr_b16 a[204:205], v253 offset:12288
v_max3_u32 v92, v92, v122, v123
v_mfma_f32_16x16x32_bf16 v[24:27], a[244:247], v[112:115], v[24:27]
ds_read_b64_tr_b16 a[206:207], v253 offset:13056
v_max_u32 v92, v92, v93
v_mfma_f32_16x16x32_bf16 v[28:31], a[248:251], v[112:115], v[28:31]
ds_read_b64_tr_b16 a[208:209], v254 offset:12288
v_and_b32 v71, 0xffff0000, v81
v_mfma_f32_16x16x32_bf16 v[32:35], a[252:255], v[112:115], v[32:35]
ds_read_b64_tr_b16 a[210:211], v254 offset:13056
v_cmp_eq_u32 vcc, -1, v92
v_mfma_f32_16x16x32_bf16 v[36:39], a[40:43], v[112:115], v[36:39]
ds_read_b64_tr_b16 a[212:213], v253 offset:12352
v_lshlrev_b32 v72, 16, v82
v_mfma_f32_16x16x32_bf16 v[40:43], a[44:47], v[112:115], v[40:43]
ds_read_b64_tr_b16 a[214:215], v253 offset:13120
s_cbranch_vccnz L_o2_retry
L_o2_ok:
v_mfma_f32_16x16x32_bf16 v[20:23], a[48:51], v[116:119], v[20:23]
ds_read_b64_tr_b16 a[216:217], v254 offset:12352
buffer_load_dwordx4 v[156:159], v7, s[4:7], s59 offen offset:2048 sc1
v_mfma_f32_16x16x32_bf16 v[24:27], a[52:55], v[116:119], v[24:27]
ds_read_b64_tr_b16 a[218:219], v254 offset:13120
buffer_load_dwordx4 v[160:163], v7, s[4:7], s59 offen offset:3072 sc1
v_mfma_f32_16x16x32_bf16 v[28:31], a[56:59], v[116:119], v[28:31]
ds_read_b64_tr_b16 a[220:221], v253 offset:12416
v_and_b32 v73, 0xffff0000, v82
v_mfma_f32_16x16x32_bf16 v[32:35], a[60:63], v[116:119], v[32:35]
ds_read_b64_tr_b16 a[222:223], v253 offset:13184
s_waitcnt vmcnt(8)
v_mfma_f32_16x16x32_bf16 v[36:39], a[64:67], v[116:119], v[36:39]
ds_read_b64_tr_b16 a[224:225], v254 offset:12416
v_max3_u32 v92, v124, v125, v126
v_mfma_f32_16x16x32_bf16 v[40:43], a[68:71], v[116:119], v[40:43]
ds_read_b64_tr_b16 a[226:227], v254 offset:13184
v_max3_u32 v93, v127, v128, v129
v_mfma_f32_16x16x32_bf16 v[20:23], a[72:75], v[120:123], v[20:23]
ds_read_b64_tr_b16 a[228:229], v253 offset:18432
v_max3_u32 v92, v92, v130, v131
v_mfma_f32_16x16x32_bf16 v[24:27], a[76:79], v[120:123], v[24:27]
ds_read_b64_tr_b16 a[230:231], v253 offset:19200
v_max_u32 v92, v92, v93
v_mfma_f32_16x16x32_bf16 v[28:31], a[80:83], v[120:123], v[28:31]
ds_read_b64_tr_b16 a[232:233], v254 offset:18432
v_lshlrev_b32 v74, 16, v83
v_mfma_f32_16x16x32_bf16 v[32:35], a[84:87], v[120:123], v[32:35]
ds_read_b64_tr_b16 a[234:235], v254 offset:19200
v_cmp_eq_u32 vcc, -1, v92
v_mfma_f32_16x16x32_bf16 v[36:39], a[88:91], v[120:123], v[36:39]
ds_read_b64_tr_b16 a[236:237], v253 offset:18496
v_and_b32 v75, 0xffff0000, v83
v_mfma_f32_16x16x32_bf16 v[40:43], a[92:95], v[120:123], v[40:43]
ds_read_b64_tr_b16 a[238:239], v253 offset:19264
s_cbranch_vccnz L_o3_retry
L_o3_ok:
v_mfma_f32_16x16x32_bf16 v[20:23], a[96:99], v[124:127], v[20:23]
ds_read_b64_tr_b16 a[240:241], v254 offset:18496
buffer_load_dwordx4 v[164:167], v7, s[4:7], s60 offen offset:0 sc1
v_mfma_f32_16x16x32_bf16 v[24:27], a[100:103], v[124:127], v[24:27]
ds_read_b64_tr_b16 a[242:243], v254 offset:19264
buffer_load_dwordx4 v[168:171], v7, s[4:7], s60 offen offset:1024 sc1
v_mfma_f32_16x16x32_bf16 v[28:31], a[104:107], v[124:127], v[28:31]
ds_read_b64_tr_b16 a[244:245], v253 offset:18560
v_lshlrev_b32 v76, 16, v84
v_mfma_f32_16x16x32_bf16 v[32:35], a[108:111], v[124:127], v[32:35]
ds_read_b64_tr_b16 a[246:247], v253 offset:19328
s_waitcnt vmcnt(8)
v_mfma_f32_16x16x32_bf16 v[36:39], a[112:115], v[124:127], v[36:39]
ds_read_b64_tr_b16 a[248:249], v254 offset:18560
v_max3_u32 v92, v132, v133, v134
v_mfma_f32_16x16x32_bf16 v[40:43], a[116:119], v[124:127], v[40:43]
ds_read_b64_tr_b16 a[250:251], v254 offset:19328
v_max3_u32 v93, v135, v136, v137
v_mfma_f32_16x16x32_bf16 v[20:23], a[120:123], v[128:131], v[20:23]
ds_read_b64_tr_b16 a[252:253], v253 offset:24576
v_max3_u32 v92, v92, v138, v139
v_mfma_f32_16x16x32_bf16 v[24:27], a[124:127], v[128:131], v[24:27]
ds_read_b64_tr_b16 a[254:255], v253 offset:25344
v_max_u32 v92, v92, v93
v_mfma_f32_16x16x32_bf16 v[28:31], a[128:131], v[128:131], v[28:31]
ds_read_b64_tr_b16 a[40:41], v254 offset:24576
v_and_b32 v77, 0xffff0000, v84
v_mfma_f32_16x16x32_bf16 v[32:35], a[132:135], v[128:131], v[32:35]
ds_read_b64_tr_b16 a[42:43], v254 offset:25344
v_cmp_eq_u32 vcc, -1, v92
v_mfma_f32_16x16x32_bf16 v[36:39], a[136:139], v[128:131], v[36:39]
ds_read_b64_tr_b16 a[44:45], v253 offset:24640
v_lshlrev_b32 v78, 16, v85
v_mfma_f32_16x16x32_bf16 v[40:43], a[140:143], v[128:131], v[40:43]
ds_read_b64_tr_b16 a[46:47], v253 offset:25408
s_cbranch_vccnz L_o4_retry
L_o4_ok:
v_mfma_f32_16x16x32_bf16 v[20:23], a[144:147], v[132:135], v[20:23]
ds_read_b64_tr_b16 a[48:49], v254 offset:24640
buffer_load_dwordx4 v[172:175], v7, s[4:7], s60 offen offset:2048 sc1
v_mfma_f32_16x16x32_bf16 v[24:27], a[148:151], v[132:135], v[24:27]
ds_read_b64_tr_b16 a[50:51], v254 offset:25408
buffer_load_dwordx4 v[176:179], v7, s[4:7], s60 offen offset:3072 sc1
v_mfma_f32_16x16x32_bf16 v[28:31], a[152:155], v[132:135], v[28:31]
ds_read_b64_tr_b16 a[52:53], v253 offset:24704
v_and_b32 v79, 0xffff0000, v85
v_mfma_f32_16x16x32_bf16 v[32:35], a[156:159], v[132:135], v[32:35]
ds_read_b64_tr_b16 a[54:55], v253 offset:25472
s_waitcnt vmcnt(8)
v_mfma_f32_16x16x32_bf16 v[36:39], a[160:163], v[132:135], v[36:39]
ds_read_b64_tr_b16 a[56:57], v254 offset:24704
v_max3_u32 v92, v140, v141, v142
v_mfma_f32_16x16x32_bf16 v[40:43], a[164:167], v[132:135], v[40:43]
ds_read_b64_tr_b16 a[58:59], v254 offset:25472
v_max3_u32 v93, v143, v144, v145
v_mfma_f32_16x16x32_bf16 v[20:23], a[0:3], v[136:139], v[20:23]
ds_read_b64_tr_b16 a[60:61], v253 offset:30720
v_max3_u32 v92, v92, v146, v147
v_mfma_f32_16x16x32_bf16 v[24:27], a[4:7], v[136:139], v[24:27]
ds_read_b64_tr_b16 a[62:63], v253 offset:31488
v_max_u32 v92, v92, v93
v_mfma_f32_16x16x32_bf16 v[28:31], a[8:11], v[136:139], v[28:31]
ds_read_b64_tr_b16 a[64:65], v254 offset:30720
v_lshlrev_b32 v80, 16, v86
v_mfma_f32_16x16x32_bf16 v[32:35], a[12:15], v[136:139], v[32:35]
ds_read_b64_tr_b16 a[66:67], v254 offset:31488
v_cmp_eq_u32 vcc, -1, v92
v_mfma_f32_16x16x32_bf16 v[36:39], a[16:19], v[136:139], v[36:39]
ds_read_b64_tr_b16 a[68:69], v253 offset:30784
v_and_b32 v81, 0xffff0000, v86
v_mfma_f32_16x16x32_bf16 v[40:43], a[20:23], v[136:139], v[40:43]
ds_read_b64_tr_b16 a[70:71], v253 offset:31552
s_cbranch_vccnz L_o5_retry
L_o5_ok:
v_mfma_f32_16x16x32_bf16 v[20:23], a[24:27], v[140:143], v[20:23]
ds_read_b64_tr_b16 a[72:73], v254 offset:30784
v_lshlrev_b32 v82, 16, v87
v_mfma_f32_16x16x32_bf16 v[24:27], a[28:31], v[140:143], v[24:27]
ds_read_b64_tr_b16 a[74:75], v254 offset:31552
v_and_b32 v83, 0xffff0000, v87
v_mfma_f32_16x16x32_bf16 v[28:31], a[32:35], v[140:143], v[28:31]
ds_read_b64_tr_b16 a[76:77], v253 offset:30848
s_waitcnt lgkmcnt(15)
v_mfma_f32_16x16x32_bf16 v[32:35], a[168:171], v[140:143], v[32:35]
ds_read_b64_tr_b16 a[78:79], v253 offset:31616
s_waitcnt vmcnt(6)
v_mfma_f32_16x16x32_bf16 v[36:39], a[172:175], v[140:143], v[36:39]
ds_read_b64_tr_b16 a[80:81], v254 offset:30848
v_max3_u32 v92, v148, v149, v150
v_mfma_f32_16x16x32_bf16 v[40:43], a[176:179], v[140:143], v[40:43]
ds_read_b64_tr_b16 a[82:83], v254 offset:31616
v_max3_u32 v93, v151, v152, v153
v_mfma_f32_16x16x32_bf16 v[20:23], a[180:183], v[144:147], v[20:23]
ds_read_b64_tr_b16 a[84:85], v253 offset:36864
v_max3_u32 v92, v92, v154, v155
v_mfma_f32_16x16x32_bf16 v[24:27], a[184:187], v[144:147], v[24:27]
ds_read_b64_tr_b16 a[86:87], v253 offset:37632
v_max_u32 v92, v92, v93
v_mfma_f32_16x16x32_bf16 v[28:31], a[188:191], v[144:147], v[28:31]
ds_read_b64_tr_b16 a[88:89], v254 offset:36864
v_mfma_f32_16x16x32_bf16 v[32:35], a[192:195], v[144:147], v[32:35]
ds_read_b64_tr_b16 a[90:91], v254 offset:37632
v_cmp_eq_u32 vcc, -1, v92
v_mfma_f32_16x16x32_bf16 v[36:39], a[196:199], v[144:147], v[36:39]
ds_read_b64_tr_b16 a[92:93], v253 offset:36928
v_lshlrev_b32 v84, 16, v88
v_mfma_f32_16x16x32_bf16 v[40:43], a[200:203], v[144:147], v[40:43]
ds_read_b64_tr_b16 a[94:95], v253 offset:37696
s_cbranch_vccnz L_o6_retry
L_o6_ok:
v_mfma_f32_16x16x32_bf16 v[20:23], a[204:207], v[148:151], v[20:23]
ds_read_b64_tr_b16 a[96:97], v254 offset:36928
v_and_b32 v85, 0xffff0000, v88
v_mfma_f32_16x16x32_bf16 v[24:27], a[208:211], v[148:151], v[24:27]
ds_read_b64_tr_b16 a[98:99], v254 offset:37696
v_lshlrev_b32 v86, 16, v89
v_mfma_f32_16x16x32_bf16 v[28:31], a[212:215], v[148:151], v[28:31]
ds_read_b64_tr_b16 a[100:101], v253 offset:36992
v_mfma_f32_16x16x32_bf16 v[32:35], a[216:219], v[148:151], v[32:35]
ds_read_b64_tr_b16 a[102:103], v253 offset:37760
s_waitcnt vmcnt(4)
v_mfma_f32_16x16x32_bf16 v[36:39], a[220:223], v[148:151], v[36:39]
ds_read_b64_tr_b16 a[104:105], v254 offset:36992
v_max3_u32 v92, v156, v157, v158
v_mfma_f32_16x16x32_bf16 v[40:43], a[224:227], v[148:151], v[40:43]
ds_read_b64_tr_b16 a[106:107], v254 offset:37760
v_max3_u32 v93, v159, v160, v161
v_mfma_f32_16x16x32_bf16 v[20:23], a[228:231], v[152:155], v[20:23]
ds_read_b64_tr_b16 a[108:109], v253 offset:43008
v_max3_u32 v92, v92, v162, v163
v_mfma_f32_16x16x32_bf16 v[24:27], a[232:235], v[152:155], v[24:27]
ds_read_b64_tr_b16 a[110:111], v253 offset:43776
v_max_u32 v92, v92, v93
v_mfma_f32_16x16x32_bf16 v[28:31], a[236:239], v[152:155], v[28:31]
ds_read_b64_tr_b16 a[112:113], v254 offset:43008
v_mfma_f32_16x16x32_bf16 v[32:35], a[240:243], v[152:155], v[32:35]
ds_read_b64_tr_b16 a[114:115], v254 offset:43776
v_cmp_eq_u32 vcc, -1, v92
v_mfma_f32_16x16x32_bf16 v[36:39], a[244:247], v[152:155], v[36:39]
ds_read_b64_tr_b16 a[116:117], v253 offset:43072
v_and_b32 v87, 0xffff0000, v89
v_mfma_f32_16x16x32_bf16 v[40:43], a[248:251], v[152:155], v[40:43]
ds_read_b64_tr_b16 a[118:119], v253 offset:43840
s_cbranch_vccnz L_o7_retry
L_o7_ok:
v_mfma_f32_16x16x32_bf16 v[20:23], a[252:255], v[156:159], v[20:23]
ds_read_b64_tr_b16 a[120:121], v254 offset:43072
v_lshlrev_b32 v88, 16, v90
v_mfma_f32_16x16x32_bf16 v[24:27], a[40:43], v[156:159], v[24:27]
ds_read_b64_tr_b16 a[122:123], v254 offset:43840
v_and_b32 v89, 0xffff0000, v90
v_mfma_f32_16x16x32_bf16 v[28:31], a[44:47], v[156:159], v[28:31]
ds_read_b64_tr_b16 a[124:125], v253 offset:43136
s_waitcnt lgkmcnt(15)
v_mfma_f32_16x16x32_bf16 v[32:35], a[48:51], v[156:159], v[32:35]
ds_read_b64_tr_b16 a[126:127], v253 offset:43904
s_waitcnt vmcnt(2)
v_mfma_f32_16x16x32_bf16 v[36:39], a[52:55], v[156:159], v[36:39]
ds_read_b64_tr_b16 a[128:129], v254 offset:43136
v_max3_u32 v92, v164, v165, v166
v_mfma_f32_16x16x32_bf16 v[40:43], a[56:59], v[156:159], v[40:43]
ds_read_b64_tr_b16 a[130:131], v254 offset:43904
v_max3_u32 v93, v167, v168, v169
v_mfma_f32_16x16x32_bf16 v[20:23], a[60:63], v[160:163], v[20:23]
ds_read_b64_tr_b16 a[132:133], v253 offset:49152
v_max3_u32 v92, v92, v170, v171
v_mfma_f32_16x16x32_bf16 v[24:27], a[64:67], v[160:163], v[24:27]
ds_read_b64_tr_b16 a[134:135], v253 offset:49920
v_max_u32 v92, v92, v93
v_mfma_f32_16x16x32_bf16 v[28:31], a[68:71], v[160:163], v[28:31]
ds_read_b64_tr_b16 a[136:137], v254 offset:49152
v_mfma_f32_16x16x32_bf16 v[32:35], a[72:75], v[160:163], v[32:35]
ds_read_b64_tr_b16 a[138:139], v254 offset:49920
v_cmp_eq_u32 vcc, -1, v92
v_mfma_f32_16x16x32_bf16 v[36:39], a[76:79], v[160:163], v[36:39]
ds_read_b64_tr_b16 a[140:141], v253 offset:49216
v_lshlrev_b32 v90, 16, v91
v_mfma_f32_16x16x32_bf16 v[40:43], a[80:83], v[160:163], v[40:43]
ds_read_b64_tr_b16 a[142:143], v253 offset:49984
s_cbranch_vccnz L_o8_retry
L_o8_ok:
v_mfma_f32_16x16x32_bf16 v[20:23], a[84:87], v[164:167], v[20:23]
ds_read_b64_tr_b16 a[144:145], v254 offset:49216
v_and_b32 v91, 0xffff0000, v91
v_mfma_f32_16x16x32_bf16 v[24:27], a[88:91], v[164:167], v[24:27]
ds_read_b64_tr_b16 a[146:147], v254 offset:49984
v_mfma_f32_16x16x32_bf16 v[28:31], a[92:95], v[164:167], v[28:31]
ds_read_b64_tr_b16 a[148:149], v253 offset:49280
s_waitcnt lgkmcnt(15)
v_mfma_f32_16x16x32_bf16 v[32:35], a[96:99], v[164:167], v[32:35]
ds_read_b64_tr_b16 a[150:151], v253 offset:50048
s_waitcnt vmcnt(0)
v_mfma_f32_16x16x32_bf16 v[36:39], a[100:103], v[164:167], v[36:39]
ds_read_b64_tr_b16 a[152:153], v254 offset:49280
v_max3_u32 v92, v172, v173, v174
v_mfma_f32_16x16x32_bf16 v[40:43], a[104:107], v[164:167], v[40:43]
ds_read_b64_tr_b16 a[154:155], v254 offset:50048
v_max3_u32 v93, v175, v176, v177
v_mfma_f32_16x16x32_bf16 v[20:23], a[108:111], v[168:171], v[20:23]
ds_read_b64_tr_b16 a[156:157], v253 offset:55296
v_max3_u32 v92, v92, v178, v179
v_mfma_f32_16x16x32_bf16 v[24:27], a[112:115], v[168:171], v[24:27]
ds_read_b64_tr_b16 a[158:159], v253 offset:56064
v_max_u32 v92, v92, v93
v_mfma_f32_16x16x32_bf16 v[28:31], a[116:119], v[168:171], v[28:31]
ds_read_b64_tr_b16 a[160:161], v254 offset:55296
s_waitcnt lgkmcnt(9)
v_mfma_f32_16x16x32_bf16 v[32:35], a[120:123], v[168:171], v[32:35]
ds_read_b64_tr_b16 a[162:163], v254 offset:56064
v_cmp_eq_u32 vcc, -1, v92
v_mfma_f32_16x16x32_bf16 v[36:39], a[124:127], v[168:171], v[36:39]
ds_read_b64_tr_b16 a[164:165], v253 offset:55360
v_mfma_f32_16x16x32_bf16 v[40:43], a[128:131], v[168:171], v[40:43]
ds_read_b64_tr_b16 a[166:167], v253 offset:56128
s_cbranch_vccnz L_o9_retry
L_o9_ok:
v_mfma_f32_16x16x32_bf16 v[20:23], a[132:135], v[172:175], v[20:23]
ds_read_b64_tr_b16 a[0:1], v254 offset:55360
v_mfma_f32_16x16x32_bf16 v[24:27], a[136:139], v[172:175], v[24:27]
ds_read_b64_tr_b16 a[2:3], v254 offset:56128
v_mfma_f32_16x16x32_bf16 v[28:31], a[140:143], v[172:175], v[28:31]
ds_read_b64_tr_b16 a[4:5], v253 offset:55424
s_waitcnt lgkmcnt(9)
v_mfma_f32_16x16x32_bf16 v[32:35], a[144:147], v[172:175], v[32:35]
ds_read_b64_tr_b16 a[6:7], v253 offset:56192
v_mfma_f32_16x16x32_bf16 v[36:39], a[148:151], v[172:175], v[36:39]
ds_read_b64_tr_b16 a[8:9], v254 offset:55424
v_mfma_f32_16x16x32_bf16 v[40:43], a[152:155], v[172:175], v[40:43]
ds_read_b64_tr_b16 a[10:11], v254 offset:56192
s_waitcnt lgkmcnt(6)
v_mfma_f32_16x16x32_bf16 v[20:23], a[156:159], v[176:179], v[20:23]
ds_read_b128 v[180:183], v247 offset:0
v_mfma_f32_16x16x32_bf16 v[24:27], a[160:163], v[176:179], v[24:27]
ds_read_b128 v[184:187], v247 offset:64
v_mfma_f32_16x16x32_bf16 v[28:31], a[164:167], v[176:179], v[28:31]
ds_read_b128 v[188:191], v247 offset:128
s_waitcnt lgkmcnt(3)
v_mfma_f32_16x16x32_bf16 v[32:35], a[0:3], v[176:179], v[32:35]
ds_read_b128 v[192:195], v247 offset:192
v_mfma_f32_16x16x32_bf16 v[36:39], a[4:7], v[176:179], v[36:39]
ds_read_b128 v[196:199], v247 offset:256
v_mfma_f32_16x16x32_bf16 v[40:43], a[8:11], v[176:179], v[40:43]
ds_read_b128 v[200:203], v247 offset:320
s_lshl_b32 s57, s96, 8
s_add_u32 s57, s57, s14
s_mov_b32 s55, 0xffffff00
s_cmp_eq_u32 s15, 0
s_waitcnt lgkmcnt(4)
v_pk_fma_f32 v[20:21], v[20:21], v[180:181], v[68:69]
v_pk_fma_f32 v[22:23], v[22:23], v[182:183], v[70:71]
v_pk_mul_f32 v[46:47], v[20:21], v[20:21]
v_pk_mul_f32 v[48:49], v[20:21], v[204:205]
v_pk_fma_f32 v[24:25], v[24:25], v[184:185], v[72:73]
v_pk_add_f32 v[44:45], v[20:21], v[22:23]
v_pk_fma_f32 v[46:47], v[22:23], v[22:23], v[46:47]
v_pk_fma_f32 v[48:49], v[22:23], v[206:207], v[48:49]
v_pk_fma_f32 v[26:27], v[26:27], v[186:187], v[74:75]
v_pk_add_f32 v[44:45], v[44:45], v[24:25]
v_pk_fma_f32 v[46:47], v[24:25], v[24:25], v[46:47]
v_pk_fma_f32 v[48:49], v[24:25], v[208:209], v[48:49]
s_waitcnt lgkmcnt(2)
v_pk_fma_f32 v[28:29], v[28:29], v[188:189], v[76:77]
v_pk_add_f32 v[44:45], v[44:45], v[26:27]
v_pk_fma_f32 v[46:47], v[26:27], v[26:27], v[46:47]
v_pk_fma_f32 v[48:49], v[26:27], v[210:211], v[48:49]
v_pk_fma_f32 v[30:31], v[30:31], v[190:191], v[78:79]
v_pk_add_f32 v[44:45], v[44:45], v[28:29]
v_pk_fma_f32 v[46:47], v[28:29], v[28:29], v[46:47]
v_pk_fma_f32 v[48:49], v[28:29], v[212:213], v[48:49]
v_pk_fma_f32 v[32:33], v[32:33], v[192:193], v[80:81]
v_pk_add_f32 v[44:45], v[44:45], v[30:31]
v_pk_fma_f32 v[46:47], v[30:31], v[30:31], v[46:47]
v_pk_fma_f32 v[48:49], v[30:31], v[214:215], v[48:49]
v_pk_fma_f32 v[34:35], v[34:35], v[194:195], v[82:83]
v_pk_add_f32 v[44:45], v[44:45], v[32:33]
v_pk_fma_f32 v[46:47], v[32:33], v[32:33], v[46:47]
v_pk_fma_f32 v[48:49], v[32:33], v[216:217], v[48:49]
s_waitcnt lgkmcnt(0)
v_pk_fma_f32 v[36:37], v[36:37], v[196:197], v[84:85]
v_pk_add_f32 v[44:45], v[44:45], v[34:35]
v_pk_fma_f32 v[46:47], v[34:35], v[34:35], v[46:47]
v_pk_fma_f32 v[48:49], v[34:35], v[218:219], v[48:49]
v_pk_fma_f32 v[38:39], v[38:39], v[198:199], v[86:87]
v_pk_add_f32 v[44:45], v[44:45], v[36:37]
v_pk_fma_f32 v[46:47], v[36:37], v[36:37], v[46:47]
v_pk_fma_f32 v[48:49], v[36:37], v[220:221], v[48:49]
v_pk_fma_f32 v[40:41], v[40:41], v[200:201], v[88:89]
v_pk_add_f32 v[44:45], v[44:45], v[38:39]
v_pk_fma_f32 v[46:47], v[38:39], v[38:39], v[46:47]
v_pk_fma_f32 v[48:49], v[38:39], v[222:223], v[48:49]
v_pk_fma_f32 v[42:43], v[42:43], v[202:203], v[90:91]
v_pk_add_f32 v[44:45], v[44:45], v[40:41]
v_pk_fma_f32 v[46:47], v[40:41], v[40:41], v[46:47]
v_pk_fma_f32 v[48:49], v[40:41], v[224:225], v[48:49]
v_pk_fma_f32 v[48:49], v[42:43], v[226:227], v[48:49]
v_pk_add_f32 v[44:45], v[44:45], v[42:43]
v_pk_fma_f32 v[46:47], v[42:43], v[42:43], v[46:47]
v_add_f32 v48, v48, v49
v_add_f32 v44, v44, v45
v_add_f32 v46, v46, v47
v_permlane32_swap_b32 v48, v95
s_nop 0
v_permlane32_swap_b32 v44, v46
v_add_f32 v48, v48, v95
v_add_f32 v44, v44, v46
s_nop 1
v_permlane16_swap_b32 v44, v48
v_add_f32 v44, v44, v48
v_and_or_b32 v44, v44, s55, v19
s_cbranch_scc0 L_st_slow
buffer_store_dword v44, v0, s[4:7], s57 offen
L_st_j:
ds_read_b128 v[100:103], v247 offset:768
ds_read_b128 v[104:107], v247 offset:832
ds_read_b128 v[108:111], v247 offset:896
ds_read_b128 v[112:115], v247 offset:960
ds_read_b128 v[116:119], v247 offset:1024
ds_read_b128 v[120:123], v247 offset:1088
ds_read_b128 v[124:127], v247 offset:384
ds_read_b128 v[128:131], v247 offset:448
ds_read_b128 v[132:135], v247 offset:512
ds_read_b128 v[136:139], v247 offset:576
ds_read_b128 v[140:143], v247 offset:640
ds_read_b128 v[144:147], v247 offset:704
ds_read_b128 v[148:151], v247 offset:1152
ds_read_b128 v[152:155], v247 offset:1216
ds_read_b128 v[156:159], v247 offset:1280
ds_read_b128 v[160:163], v247 offset:1344
ds_read_b128 v[164:167], v247 offset:1408
ds_read_b128 v[168:171], v247 offset:1472
s_lshl_b32 s57, s3, 2
s_add_u32 s57, s57, 135168
v_mov_b32 v54, s57
v_and_b32 v55, 12, v0
v_add_u32 v55, 135168, v55
v_lshrrev_b32 v65, 3, v1
v_mul_u32_u24 v65, 384, v65
v_lshrrev_b32 v66, 5, v1
v_mul_u32_u24 v66, 6144, v66
v_add3_u32 v65, v65, v66, v7
L_st_p:
buffer_load_dword v180, v0, s[4:7], s14 offen offset:0 sc1
buffer_load_dword v181, v0, s[4:7], s14 offen offset:256 sc1
buffer_load_dword v182, v0, s[4:7], s14 offen offset:512 sc1
buffer_load_dword v183, v0, s[4:7], s14 offen offset:768 sc1
buffer_load_dword v184, v0, s[4:7], s14 offen offset:1024 sc1
buffer_load_dword v185, v0, s[4:7], s14 offen offset:1280 sc1
buffer_load_dword v186, v0, s[4:7], s14 offen offset:1536 sc1
s_waitcnt vmcnt(0)
v_xor_b32 v44, v180, v19
v_xor_b32 v45, v181, v19
v_xor_b32 v46, v182, v19
v_xor_b32 v47, v183, v19
v_xor_b32 v48, v184, v19
v_xor_b32 v49, v185, v19
v_xor_b32 v50, v186, v19
v_or3_b32 v52, v44, v45, v46
v_or3_b32 v53, v47, v48, v49
v_or3_b32 v52, v52, v53, v50
v_and_b32 v52, 0xff, v52
v_cmp_ne_u32 vcc, 0, v52
s_cbranch_vccz L_st_ok
s_add_u32 s97, s97, 1
s_cmp_le_u32 s97, 65536
s_cbranch_scc1 L_st_p
L_st_ok:
v_pk_add_f32 v[44:45], v[44:45], v[46:47]
v_add_f32 v48, v48, v50
v_pk_add_f32 v[44:45], v[44:45], v[48:49]
v_add_f32 v46, v44, v45
v_add_f32 v44, v44, v45
s_nop 1
v_permlane32_swap_b32 v44, v46
v_mov_b32 v45, v44
v_mov_b32 v47, v46
s_nop 0
v_permlane16_swap_b32 v44, v45
v_permlane16_swap_b32 v46, v47
v_mul_f32 v44, 0x3acccccd, v44
v_mul_f32 v46, 0x3acccccd, v46
v_fma_f32 v46, -v44, v44, v46
v_fma_f32 v45, -v44, v47, v45
v_max_f32 v46, 0, v46
v_add_f32 v46, 0x3727c5ac, v46
v_rsq_f32 v48, v46
s_nop 0
v_mul_f32 v45, v45, v48
v_mul_f32 v49, -v44, v48
v_pk_fma_f32 v[68:69], v[20:21], v[48:49], v[48:49] op_sel:[0,0,1] op_sel_hi:[1,0,1]
v_max_f32_dpp v46, v45, v45 row_ror:8 row_mask:0xf bank_mask:0xf
v_pk_fma_f32 v[70:71], v[22:23], v[48:49], v[48:49] op_sel:[0,0,1] op_sel_hi:[1,0,1]
v_pk_fma_f32 v[72:73], v[24:25], v[48:49], v[48:49] op_sel:[0,0,1] op_sel_hi:[1,0,1]
v_max_f32_dpp v46, v46, v46 row_ror:4 row_mask:0xf bank_mask:0xf
v_pk_fma_f32 v[74:75], v[26:27], v[48:49], v[48:49] op_sel:[0,0,1] op_sel_hi:[1,0,1]
v_pk_fma_f32 v[76:77], v[28:29], v[48:49], v[48:49] op_sel:[0,0,1] op_sel_hi:[1,0,1]
v_max_f32_dpp v46, v46, v46 row_ror:2 row_mask:0xf bank_mask:0xf
v_pk_fma_f32 v[78:79], v[30:31], v[48:49], v[48:49] op_sel:[0,0,1] op_sel_hi:[1,0,1]
v_pk_fma_f32 v[80:81], v[32:33], v[48:49], v[48:49] op_sel:[0,0,1] op_sel_hi:[1,0,1]
v_max_f32_dpp v46, v46, v46 row_ror:1 row_mask:0xf bank_mask:0xf
ds_write_b32 v54, v46
v_pk_fma_f32 v[82:83], v[34:35], v[48:49], v[48:49] op_sel:[0,0,1] op_sel_hi:[1,0,1]
v_pk_fma_f32 v[84:85], v[36:37], v[48:49], v[48:49] op_sel:[0,0,1] op_sel_hi:[1,0,1]
v_pk_fma_f32 v[86:87], v[38:39], v[48:49], v[48:49] op_sel:[0,0,1] op_sel_hi:[1,0,1]
v_pk_fma_f32 v[88:89], v[40:41], v[48:49], v[48:49] op_sel:[0,0,1] op_sel_hi:[1,0,1]
v_pk_fma_f32 v[90:91], v[42:43], v[48:49], v[48:49] op_sel:[0,0,1] op_sel_hi:[1,0,1]
s_waitcnt lgkmcnt(0)
s_barrier
ds_read_b32 v52, v55
v_pk_fma_f32 v[68:69], v[68:69], v[100:101], v[124:125]
v_pk_fma_f32 v[70:71], v[70:71], v[102:103], v[126:127]
v_pk_fma_f32 v[72:73], v[72:73], v[104:105], v[128:129]
v_pk_fma_f32 v[74:75], v[74:75], v[106:107], v[130:131]
v_pk_fma_f32 v[76:77], v[76:77], v[108:109], v[132:133]
v_pk_fma_f32 v[78:79], v[78:79], v[110:111], v[134:135]
v_pk_fma_f32 v[80:81], v[80:81], v[112:113], v[136:137]
v_pk_fma_f32 v[82:83], v[82:83], v[114:115], v[138:139]
v_pk_fma_f32 v[84:85], v[84:85], v[116:117], v[140:141]
v_pk_fma_f32 v[86:87], v[86:87], v[118:119], v[142:143]
v_pk_fma_f32 v[88:89], v[88:89], v[120:121], v[144:145]
v_pk_fma_f32 v[90:91], v[90:91], v[122:123], v[146:147]
s_waitcnt lgkmcnt(0)
v_max_f32_dpp v53, v52, v52 quad_perm:[1,0,3,2] row_mask:0xf bank_mask:0xf
s_nop 1
v_max_f32_dpp v53, v53, v53 quad_perm:[2,3,0,1] row_mask:0xf bank_mask:0xf
v_cmp_eq_f32 vcc, v53, v52
v_cmp_eq_f32 s[58:59], v53, v45
s_ff1_i32_b64 s57, vcc
s_and_b32 s57, s57, 3
s_cmp_eq_u32 s57, s3
s_cbranch_scc0 L_nowin
s_ff1_i32_b64 s57, s[58:59]
s_and_b32 s57, s57, 15
s_cmp_eq_u32 s96, 0
s_cbranch_scc0 L_nocand
s_lshl_b32 s58, s57, 1
s_add_u32 s58, s58, s54
v_mov_b32 v56, v53
v_mov_b32 v57, s58
v_mov_b32 v58, s40
v_mov_b32 v59, s53
s_mul_i32 s58, s47, 2048
s_andn2_b32 s59, s58, 8191
s_add_u32 s58, s58, s59
s_add_u32 s58, s58, 7602176
buffer_store_dwordx4 v[56:59], v65, s[4:7], s58 offen sc1
L_nocand:
s_mov_b32 s58, 0x00010001
s_lshl_b32 exec_lo, s58, s57
s_lshl_b32 exec_hi, s58, s57
s_lshl_b32 s58, s47, 11
s_lshl_b32 s59, s96, 8
s_add_u32 s58, s58, s59
s_lshl_b32 s59, s58, 1
s_andn2_b32 s60, s58, 8191
s_add_u32 s58, s58, s60
s_add_u32 s58, s58, 7733248
s_add_u32 s56, s58, 8192
s_add_u32 s59, s59, 524288
v_lshlrev_b32 v54, 3, v3
v_lshlrev_b32 v55, 4, v3
v_cvt_pk_bf16_f32 v172, v68, v69
v_cvt_pk_bf16_f32 v173, v70, v71
buffer_store_dwordx2 v[172:173], v54, s[4:7], s58 offen offset:0 sc1
buffer_store_dwordx2 v[172:173], v54, s[4:7], s56 offen offset:0 sc1
v_cvt_pk_bf16_f32 v174, v72, v73
v_cvt_pk_bf16_f32 v175, v74, v75
buffer_store_dwordx2 v[174:175], v54, s[4:7], s58 offen offset:32 sc1
buffer_store_dwordx2 v[174:175], v54, s[4:7], s56 offen offset:32 sc1
v_cvt_pk_bf16_f32 v176, v76, v77
v_cvt_pk_bf16_f32 v177, v78, v79
buffer_store_dwordx2 v[176:177], v54, s[4:7], s58 offen offset:64 sc1
buffer_store_dwordx2 v[176:177], v54, s[4:7], s56 offen offset:64 sc1
v_cvt_pk_bf16_f32 v178, v80, v81
v_cvt_pk_bf16_f32 v179, v82, v83
buffer_store_dwordx2 v[178:179], v54, s[4:7], s58 offen offset:96 sc1
buffer_store_dwordx2 v[178:179], v54, s[4:7], s56 offen offset:96 sc1
v_cvt_pk_bf16_f32 v172, v84, v85
v_cvt_pk_bf16_f32 v173, v86, v87
buffer_store_dwordx2 v[172:173], v54, s[4:7], s58 offen offset:128 sc1
buffer_store_dwordx2 v[172:173], v54, s[4:7], s56 offen offset:128 sc1
v_cvt_pk_bf16_f32 v174, v88, v89
v_cvt_pk_bf16_f32 v175, v90, v91
buffer_store_dwordx2 v[174:175], v54, s[4:7], s58 offen offset:160 sc1
buffer_store_dwordx2 v[174:175], v54, s[4:7], s56 offen offset:160 sc1
s_and_b32 s60, s40, 0xff
s_bfe_u32 s61, s40, 0x80008
s_bfe_u32 s62, s40, 0x80010
s_lshr_b32 s63, s40, 24
v_mov_b32 v60, s55
v_pk_fma_f32 v[100:101], v[68:69], v[148:149], v[20:21]
v_pk_fma_f32 v[102:103], v[70:71], v[150:151], v[22:23]
v_and_or_b32 v100, v100, v60, s60
v_and_or_b32 v101, v101, v60, s61
v_and_or_b32 v102, v102, v60, s62
v_and_or_b32 v103, v103, v60, s63
buffer_store_dwordx4 v[100:103], v55, s[4:7], s59 offen offset:0 sc1
v_pk_fma_f32 v[104:105], v[72:73], v[152:153], v[24:25]
v_pk_fma_f32 v[106:107], v[74:75], v[154:155], v[26:27]
v_and_or_b32 v104, v104, v60, s60
v_and_or_b32 v105, v105, v60, s61
v_and_or_b32 v106, v106, v60, s62
v_and_or_b32 v107, v107, v60, s63
buffer_store_dwordx4 v[104:107], v55, s[4:7], s59 offen offset:64 sc1
v_pk_fma_f32 v[108:109], v[76:77], v[156:157], v[28:29]
v_pk_fma_f32 v[110:111], v[78:79], v[158:159], v[30:31]
v_and_or_b32 v108, v108, v60, s60
v_and_or_b32 v109, v109, v60, s61
v_and_or_b32 v110, v110, v60, s62
v_and_or_b32 v111, v111, v60, s63
buffer_store_dwordx4 v[108:111], v55, s[4:7], s59 offen offset:128 sc1
v_pk_fma_f32 v[112:113], v[80:81], v[160:161], v[32:33]
v_pk_fma_f32 v[114:115], v[82:83], v[162:163], v[34:35]
v_and_or_b32 v112, v112, v60, s60
v_and_or_b32 v113, v113, v60, s61
v_and_or_b32 v114, v114, v60, s62
v_and_or_b32 v115, v115, v60, s63
buffer_store_dwordx4 v[112:115], v55, s[4:7], s59 offen offset:192 sc1
v_pk_fma_f32 v[116:117], v[84:85], v[164:165], v[36:37]
v_pk_fma_f32 v[118:119], v[86:87], v[166:167], v[38:39]
v_and_or_b32 v116, v116, v60, s60
v_and_or_b32 v117, v117, v60, s61
v_and_or_b32 v118, v118, v60, s62
v_and_or_b32 v119, v119, v60, s63
buffer_store_dwordx4 v[116:119], v55, s[4:7], s59 offen offset:256 sc1
v_pk_fma_f32 v[120:121], v[88:89], v[168:169], v[40:41]
v_pk_fma_f32 v[122:123], v[90:91], v[170:171], v[42:43]
v_and_or_b32 v120, v120, v60, s60
v_and_or_b32 v121, v121, v60, s61
v_and_or_b32 v122, v122, v60, s62
v_and_or_b32 v123, v123, v60, s63
buffer_store_dwordx4 v[120:123], v55, s[4:7], s59 offen offset:320 sc1
s_mov_b64 exec, -1
s_mul_i32 s57, s57, 12
v_subrev_u32 v56, s57, v1
v_add_u32 v56, 0, v56
v_cmp_gt_u32 vcc, 12, v56
s_nop 1
v_cndmask_b32 v235, v235, v255, vcc
v_subrev_u32 v56, s57, v1
v_add_u32 v56, 64, v56
v_cmp_gt_u32 vcc, 12, v56
s_nop 1
v_cndmask_b32 v236, v236, v255, vcc
v_subrev_u32 v56, s57, v1
v_add_u32 v56, 128, v56
v_cmp_gt_u32 vcc, 12, v56
s_nop 1
v_cndmask_b32 v237, v237, v255, vcc
L_nowin:
v_pk_fma_f32 v[20:21], v[68:69], v[148:149], v[20:21]
v_pk_fma_f32 v[22:23], v[70:71], v[150:151], v[22:23]
v_cvt_pk_bf16_f32 v20, v20, v21
v_cvt_pk_bf16_f32 v21, v22, v23
ds_write_b64 v248, v[20:21] offset:0
v_pk_fma_f32 v[24:25], v[72:73], v[152:153], v[24:25]
v_pk_fma_f32 v[26:27], v[74:75], v[154:155], v[26:27]
v_cvt_pk_bf16_f32 v24, v24, v25
v_cvt_pk_bf16_f32 v25, v26, v27
ds_write_b64 v248, v[24:25] offset:32
v_pk_fma_f32 v[28:29], v[76:77], v[156:157], v[28:29]
v_pk_fma_f32 v[30:31], v[78:79], v[158:159], v[30:31]
v_cvt_pk_bf16_f32 v28, v28, v29
v_cvt_pk_bf16_f32 v29, v30, v31
ds_write_b64 v248, v[28:29] offset:64
v_pk_fma_f32 v[32:33], v[80:81], v[160:161], v[32:33]
v_pk_fma_f32 v[34:35], v[82:83], v[162:163], v[34:35]
v_cvt_pk_bf16_f32 v32, v32, v33
v_cvt_pk_bf16_f32 v33, v34, v35
ds_write_b64 v248, v[32:33] offset:96
v_pk_fma_f32 v[36:37], v[84:85], v[164:165], v[36:37]
v_pk_fma_f32 v[38:39], v[86:87], v[166:167], v[38:39]
v_cvt_pk_bf16_f32 v36, v36, v37
v_cvt_pk_bf16_f32 v37, v38, v39
ds_write_b64 v248, v[36:37] offset:128
v_pk_fma_f32 v[40:41], v[88:89], v[168:169], v[40:41]
v_pk_fma_f32 v[42:43], v[90:91], v[170:171], v[42:43]
v_cvt_pk_bf16_f32 v40, v40, v41
v_cvt_pk_bf16_f32 v41, v42, v43
ds_write_b64 v248, v[40:41] offset:160
s_waitcnt lgkmcnt(0)
ds_read_b128 v[44:47], v250 offset:0
ds_read_b128 v[48:51], v250 offset:1024
ds_read_b128 v[52:55], v250 offset:2048
s_waitcnt lgkmcnt(2)
buffer_store_dwordx4 v[44:47], v235, s[32:35], s50 offen offset:0 sc1
s_waitcnt lgkmcnt(1)
buffer_store_dwordx4 v[48:51], v236, s[32:35], s50 offen offset:1024 sc1
s_waitcnt lgkmcnt(0)
buffer_store_dwordx4 v[52:55], v237, s[32:35], s50 offen offset:2048 sc1
s_branch L_fin
L_bodyM:
v_bfe_u32 v32, v1, 2, 2
v_lshrrev_b32 v33, 1, v32
v_and_b32 v34, 1, v3
v_lshl_or_b32 v33, v34, 1, v33
v_xor_b32 v33, s3, v33
v_and_b32 v34, 3, v1
v_lshlrev_b32 v34, 3, v34
v_lshl_add_u32 v33, v33, 5, v34
v_lshl_add_u32 v32, v3, 3, v32
v_lshl_add_u32 v35, v32, 7, v33
s_lshl_b32 s22, s50, 8
s_lshl_b32 s23, s3, 6
s_add_u32 s22, s22, s23
s_add_u32 s22, s22, 4096
s_lshl_b32 s55, s3, 9
s_add_u32 s55, s55, 28672
v_add_u32 v39, s55, v39
v_lshl_add_u32 v37, v3, 4, s55
v_lshlrev_b32 v38, 2, v1
s_cmp_lt_u32 s98, 220
s_cselect_b32 s55, 16, 0
v_cmp_gt_u32 vcc, s55, v1
s_mov_b32 s54, 0xffffff00
s_waitcnt vmcnt(12)
v_cndmask_b32 v38, v255, v38, vcc
v_lshlrev_b32 v44, 16, v40
v_and_b32 v45, 0xffff0000, v40
v_lshlrev_b32 v46, 16, v41
v_and_b32 v47, 0xffff0000, v41
v_mul_f32 v48, 0xbfb8aa3b, v44
v_mul_f32 v49, 0xbfb8aa3b, v45
v_mul_f32 v50, 0xbfb8aa3b, v46
v_mul_f32 v51, 0xbfb8aa3b, v47
v_exp_f32 v48, v48
v_exp_f32 v49, v49
v_exp_f32 v50, v50
v_exp_f32 v51, v51
v_add_f32 v48, 1.0, v48
v_add_f32 v49, 1.0, v49
v_add_f32 v50, 1.0, v50
v_add_f32 v51, 1.0, v51
v_rcp_f32 v48, v48
v_rcp_f32 v49, v49
v_rcp_f32 v50, v50
v_rcp_f32 v51, v51
v_mul_f32 v44, v44, v48
v_mul_f32 v45, v45, v49
v_mul_f32 v46, v46, v50
v_mul_f32 v47, v47, v51
v_cvt_pk_bf16_f32 v40, v44, v45
v_cvt_pk_bf16_f32 v41, v46, v47
ds_write_b64 v39, v[40:41]
s_waitcnt lgkmcnt(0)
ds_read_b128 v[200:203], v37 offset:0
ds_read_b128 v[204:207], v37 offset:64
ds_read_b128 v[208:211], v37 offset:128
ds_read_b128 v[212:215], v37 offset:192
ds_read_b128 v[216:219], v37 offset:256
ds_read_b128 v[220:223], v37 offset:320
ds_read_b128 v[224:227], v37 offset:384
s_waitcnt vmcnt(7)
s_mov_b32 s55, 0x3f803f80
v_mfma_f32_16x16x32_bf16 v[20:23], a[236:239], v[100:103], 0
v_lshlrev_b32 v24, 16, v104
v_and_b32 v25, 0xffff0000, v104
v_mfma_f32_16x16x32_bf16 v[20:23], a[236:239], v[104:107], v[20:23]
v_lshlrev_b32 v26, 16, v105
v_and_b32 v27, 0xffff0000, v105
v_mfma_f32_16x16x32_bf16 v[20:23], a[236:239], v[108:111], v[20:23]
v_lshlrev_b32 v28, 16, v106
v_and_b32 v29, 0xffff0000, v106
v_mfma_f32_16x16x32_bf16 v[20:23], a[236:239], v[112:115], v[20:23]
v_lshlrev_b32 v30, 16, v107
v_and_b32 v31, 0xffff0000, v107
v_mfma_f32_16x16x32_bf16 v[20:23], a[236:239], v[116:119], v[20:23]
v_lshlrev_b32 v88, 16, v100
v_and_b32 v89, 0xffff0000, v100
v_lshlrev_b32 v90, 16, v101
v_and_b32 v91, 0xffff0000, v101
v_dot2_f32_bf16 v96, v100, v100, 0
v_dot2_f32_bf16 v97, v101, v101, 0
v_dot2_f32_bf16 v96, v102, v102, v96
v_dot2_f32_bf16 v97, v103, v103, v97
v_dot2_f32_bf16 v96, v104, v104, v96
v_dot2_f32_bf16 v97, v105, v105, v97
v_dot2_f32_bf16 v96, v106, v106, v96
v_dot2_f32_bf16 v97, v107, v107, v97
v_dot2_f32_bf16 v96, v108, v108, v96
v_dot2_f32_bf16 v97, v109, v109, v97
v_dot2_f32_bf16 v96, v110, v110, v96
v_dot2_f32_bf16 v97, v111, v111, v97
v_dot2_f32_bf16 v96, v112, v112, v96
v_dot2_f32_bf16 v97, v113, v113, v97
v_dot2_f32_bf16 v96, v114, v114, v96
v_dot2_f32_bf16 v97, v115, v115, v97
v_dot2_f32_bf16 v96, v116, v116, v96
v_dot2_f32_bf16 v97, v117, v117, v97
v_dot2_f32_bf16 v96, v118, v118, v96
v_dot2_f32_bf16 v97, v119, v119, v97
v_add_f32_dpp v20, v20, v20 row_ror:8 row_mask:0xf bank_mask:0xf
v_lshlrev_b32 v100, 16, v102
v_and_b32 v101, 0xffff0000, v102
v_add_f32 v96, v96, v97
v_add_f32_dpp v20, v20, v20 row_ror:4 row_mask:0xf bank_mask:0xf
v_lshlrev_b32 v102, 16, v103
v_add_f32_dpp v96, v96, v96 row_ror:8 row_mask:0xf bank_mask:0xf
v_add_f32_dpp v20, v20, v20 row_ror:2 row_mask:0xf bank_mask:0xf
v_and_b32 v103, 0xffff0000, v103
v_add_f32_dpp v96, v96, v96 row_ror:4 row_mask:0xf bank_mask:0xf
v_add_f32_dpp v20, v20, v20 row_ror:1 row_mask:0xf bank_mask:0xf
v_mul_f32 v20, 0x3acccccd, v20
v_add_f32_dpp v96, v96, v96 row_ror:2 row_mask:0xf bank_mask:0xf
s_nop 1
v_add_f32_dpp v96, v96, v96 row_ror:1 row_mask:0xf bank_mask:0xf
v_mul_f32 v96, 0x3acccccd, v96
v_fma_f32 v96, -v20, v20, v96
v_max_f32 v96, 0, v96
v_add_f32 v96, 0x3727c5ac, v96
v_rsq_f32 v96, v96
s_nop 0
v_mul_f32 v97, -v20, v96
buffer_load_dwordx4 v[120:123], v4, s[8:11], s61 offen offset:0
v_pk_fma_f32 v[24:25], v[24:25], v[96:97], v[96:97] op_sel:[0,0,1] op_sel_hi:[1,0,1]
v_pk_fma_f32 v[26:27], v[26:27], v[96:97], v[96:97] op_sel:[0,0,1] op_sel_hi:[1,0,1]
v_pk_fma_f32 v[28:29], v[28:29], v[96:97], v[96:97] op_sel:[0,0,1] op_sel_hi:[1,0,1]
v_pk_fma_f32 v[30:31], v[30:31], v[96:97], v[96:97] op_sel:[0,0,1] op_sel_hi:[1,0,1]
v_cvt_pk_f16_f32 v104, v24, v25
v_cvt_pk_f16_f32 v105, v26, v27
v_cvt_pk_f16_f32 v106, v28, v29
v_cvt_pk_f16_f32 v107, v30, v31
v_lshlrev_b32 v24, 16, v108
v_and_b32 v25, 0xffff0000, v108
v_lshlrev_b32 v26, 16, v109
v_and_b32 v27, 0xffff0000, v109
buffer_load_dwordx4 v[124:127], v4, s[8:11], s61 offen offset:256
v_lshlrev_b32 v28, 16, v110
v_and_b32 v29, 0xffff0000, v110
v_lshlrev_b32 v30, 16, v111
v_and_b32 v31, 0xffff0000, v111
v_pk_fma_f32 v[24:25], v[24:25], v[96:97], v[96:97] op_sel:[0,0,1] op_sel_hi:[1,0,1]
v_pk_fma_f32 v[26:27], v[26:27], v[96:97], v[96:97] op_sel:[0,0,1] op_sel_hi:[1,0,1]
v_pk_fma_f32 v[28:29], v[28:29], v[96:97], v[96:97] op_sel:[0,0,1] op_sel_hi:[1,0,1]
v_pk_fma_f32 v[30:31], v[30:31], v[96:97], v[96:97] op_sel:[0,0,1] op_sel_hi:[1,0,1]
v_cvt_pk_f16_f32 v108, v24, v25
v_cvt_pk_f16_f32 v109, v26, v27
v_cvt_pk_f16_f32 v110, v28, v29
v_cvt_pk_f16_f32 v111, v30, v31
buffer_load_dwordx4 v[128:131], v4, s[8:11], s61 offen offset:512
v_lshlrev_b32 v24, 16, v112
v_and_b32 v25, 0xffff0000, v112
v_lshlrev_b32 v26, 16, v113
v_and_b32 v27, 0xffff0000, v113
v_lshlrev_b32 v28, 16, v114
v_and_b32 v29, 0xffff0000, v114
v_lshlrev_b32 v30, 16, v115
v_and_b32 v31, 0xffff0000, v115
v_pk_fma_f32 v[24:25], v[24:25], v[96:97], v[96:97] op_sel:[0,0,1] op_sel_hi:[1,0,1]
v_pk_fma_f32 v[26:27], v[26:27], v[96:97], v[96:97] op_sel:[0,0,1] op_sel_hi:[1,0,1]
v_pk_fma_f32 v[28:29], v[28:29], v[96:97], v[96:97] op_sel:[0,0,1] op_sel_hi:[1,0,1]
v_pk_fma_f32 v[30:31], v[30:31], v[96:97], v[96:97] op_sel:[0,0,1] op_sel_hi:[1,0,1]
buffer_load_dwordx4 v[132:135], v4, s[8:11], s61 offen offset:768
v_cvt_pk_f16_f32 v112, v24, v25
v_cvt_pk_f16_f32 v113, v26, v27
v_cvt_pk_f16_f32 v114, v28, v29
v_cvt_pk_f16_f32 v115, v30, v31
v_lshlrev_b32 v24, 16, v116
v_and_b32 v25, 0xffff0000, v116
v_lshlrev_b32 v26, 16, v117
v_and_b32 v27, 0xffff0000, v117
v_lshlrev_b32 v28, 16, v118
v_and_b32 v29, 0xffff0000, v118
v_lshlrev_b32 v30, 16, v119
v_and_b32 v31, 0xffff0000, v119
buffer_load_dwordx4 v[136:139], v4, s[8:11], s61 offen offset:1024
s_bfe_u32 s61, s62, 262152
s_mul_i32 s61, s61, 40960
s_add_u32 s61, s61, s45
v_pk_fma_f32 v[24:25], v[24:25], v[96:97], v[96:97] op_sel:[0,0,1] op_sel_hi:[1,0,1]
v_pk_fma_f32 v[26:27], v[26:27], v[96:97], v[96:97] op_sel:[0,0,1] op_sel_hi:[1,0,1]
v_pk_fma_f32 v[28:29], v[28:29], v[96:97], v[96:97] op_sel:[0,0,1] op_sel_hi:[1,0,1]
v_pk_fma_f32 v[30:31], v[30:31], v[96:97], v[96:97] op_sel:[0,0,1] op_sel_hi:[1,0,1]
v_pk_fma_f32 v[88:89], v[88:89], v[96:97], v[96:97] op_sel:[0,0,1] op_sel_hi:[1,0,1]
v_pk_fma_f32 v[90:91], v[90:91], v[96:97], v[96:97] op_sel:[0,0,1] op_sel_hi:[1,0,1]
v_pk_fma_f32 v[100:101], v[100:101], v[96:97], v[96:97] op_sel:[0,0,1] op_sel_hi:[1,0,1]
v_pk_fma_f32 v[102:103], v[102:103], v[96:97], v[96:97] op_sel:[0,0,1] op_sel_hi:[1,0,1]
v_cvt_pk_f16_f32 v116, v24, v25
v_cvt_pk_f16_f32 v117, v26, v27
v_cvt_pk_f16_f32 v118, v28, v29
v_cvt_pk_f16_f32 v119, v30, v31
s_waitcnt vmcnt(5)
v_readfirstlane_b32 s41, v42
s_barrier
ds_read_b64_tr_b16 v[60:61], v35 offset:0
ds_read_b64_tr_b16 v[62:63], v35 offset:512
ds_read_b64_tr_b16 v[64:65], v35 offset:4096
ds_read_b64_tr_b16 v[66:67], v35 offset:4608
ds_read_b64_tr_b16 v[68:69], v35 offset:8192
ds_read_b64_tr_b16 v[70:71], v35 offset:8704
ds_read_b64_tr_b16 v[72:73], v35 offset:12288
ds_read_b64_tr_b16 v[74:75], v35 offset:12800
ds_read_b64_tr_b16 v[76:77], v35 offset:16384
ds_read_b64_tr_b16 v[78:79], v35 offset:16896
ds_read_b64_tr_b16 v[80:81], v35 offset:20480
ds_read_b64_tr_b16 v[82:83], v35 offset:20992
ds_read_b64_tr_b16 v[84:85], v35 offset:24576
ds_read_b64_tr_b16 v[86:87], v35 offset:25088
s_mul_i32 s40, s41, 0x9E3779B1
s_add_u32 s40, s40, 0x85EBCA6B
v_and_b32 v33, 3, v1
v_lshlrev_b32 v33, 3, v33
v_lshrrev_b32 v19, v33, s40
v_and_b32 v19, 0xff, v19
v_mov_b32 v240, s40
v_mov_b32 v241, s19
v_mov_b32 v242, s40
v_mov_b32 v243, s40
s_waitcnt lgkmcnt(12)
v_mfma_f32_16x16x32_bf16 v[56:59], v[200:203], v[60:63], 0
s_waitcnt lgkmcnt(10)
v_mfma_f32_16x16x32_bf16 v[56:59], v[204:207], v[64:67], v[56:59]
s_waitcnt lgkmcnt(8)
v_mfma_f32_16x16x32_bf16 v[56:59], v[208:211], v[68:71], v[56:59]
s_waitcnt lgkmcnt(6)
v_mfma_f32_16x16x32_bf16 v[56:59], v[212:215], v[72:75], v[56:59]
s_waitcnt lgkmcnt(4)
v_mfma_f32_16x16x32_bf16 v[56:59], v[216:219], v[76:79], v[56:59]
s_waitcnt lgkmcnt(2)
v_mfma_f32_16x16x32_bf16 v[56:59], v[220:223], v[80:83], v[56:59]
s_waitcnt lgkmcnt(0)
v_mfma_f32_16x16x32_bf16 v[56:59], v[224:227], v[84:87], v[56:59]
s_nop 7
v_and_or_b32 v56, v56, s54, v19
buffer_store_dword v56, v38, s[4:7], s22 offen sc1
buffer_load_dwordx4 v[140:143], v4, s[8:11], s61 offen offset:0
buffer_load_dwordx4 v[144:147], v4, s[8:11], s61 offen offset:256
buffer_load_dwordx4 v[148:151], v4, s[8:11], s61 offen offset:512
buffer_load_dwordx4 v[152:155], v4, s[8:11], s61 offen offset:768
buffer_load_dwordx4 v[156:159], v4, s[8:11], s61 offen offset:1024
s_bfe_u32 s61, s62, 262156
s_mul_i32 s61, s61, 40960
s_add_u32 s61, s61, s45
s_waitcnt vmcnt(6)
s_mov_b32 s55, 0x3f803f80
buffer_load_dwordx4 v[160:163], v4, s[8:11], s61 offen offset:0
v_mfma_f32_16x16x32_bf16 v[20:23], a[236:239], v[120:123], 0
v_lshlrev_b32 v24, 16, v124
v_and_b32 v25, 0xffff0000, v124
v_mfma_f32_16x16x32_bf16 v[20:23], a[236:239], v[124:127], v[20:23]
v_lshlrev_b32 v26, 16, v125
v_and_b32 v27, 0xffff0000, v125
v_mfma_f32_16x16x32_bf16 v[20:23], a[236:239], v[128:131], v[20:23]
v_lshlrev_b32 v28, 16, v126
v_and_b32 v29, 0xffff0000, v126
v_mfma_f32_16x16x32_bf16 v[20:23], a[236:239], v[132:135], v[20:23]
v_lshlrev_b32 v30, 16, v127
v_and_b32 v31, 0xffff0000, v127
v_mfma_f32_16x16x32_bf16 v[20:23], a[236:239], v[136:139], v[20:23]
v_lshlrev_b32 v92, 16, v120
v_and_b32 v93, 0xffff0000, v120
v_lshlrev_b32 v94, 16, v121
v_and_b32 v95, 0xffff0000, v121
v_dot2_f32_bf16 v98, v120, v120, 0
v_dot2_f32_bf16 v99, v121, v121, 0
v_dot2_f32_bf16 v98, v122, v122, v98
v_dot2_f32_bf16 v99, v123, v123, v99
v_dot2_f32_bf16 v98, v124, v124, v98
v_dot2_f32_bf16 v99, v125, v125, v99
buffer_load_dwordx4 v[164:167], v4, s[8:11], s61 offen offset:256
v_dot2_f32_bf16 v98, v126, v126, v98
v_dot2_f32_bf16 v99, v127, v127, v99
v_dot2_f32_bf16 v98, v128, v128, v98
v_dot2_f32_bf16 v99, v129, v129, v99
v_dot2_f32_bf16 v98, v130, v130, v98
v_dot2_f32_bf16 v99, v131, v131, v99
v_dot2_f32_bf16 v98, v132, v132, v98
v_dot2_f32_bf16 v99, v133, v133, v99
v_dot2_f32_bf16 v98, v134, v134, v98
v_dot2_f32_bf16 v99, v135, v135, v99
v_dot2_f32_bf16 v98, v136, v136, v98
v_dot2_f32_bf16 v99, v137, v137, v99
v_dot2_f32_bf16 v98, v138, v138, v98
v_dot2_f32_bf16 v99, v139, v139, v99
v_add_f32_dpp v20, v20, v20 row_ror:8 row_mask:0xf bank_mask:0xf
v_lshlrev_b32 v120, 16, v122
v_and_b32 v121, 0xffff0000, v122
v_add_f32 v98, v98, v99
v_add_f32_dpp v20, v20, v20 row_ror:4 row_mask:0xf bank_mask:0xf
v_lshlrev_b32 v122, 16, v123
v_add_f32_dpp v98, v98, v98 row_ror:8 row_mask:0xf bank_mask:0xf
v_add_f32_dpp v20, v20, v20 row_ror:2 row_mask:0xf bank_mask:0xf
v_and_b32 v123, 0xffff0000, v123
v_add_f32_dpp v98, v98, v98 row_ror:4 row_mask:0xf bank_mask:0xf
buffer_load_dwordx4 v[168:171], v4, s[8:11], s61 offen offset:512
v_add_f32_dpp v20, v20, v20 row_ror:1 row_mask:0xf bank_mask:0xf
v_mul_f32 v20, 0x3acccccd, v20
v_add_f32_dpp v98, v98, v98 row_ror:2 row_mask:0xf bank_mask:0xf
s_nop 1
v_add_f32_dpp v98, v98, v98 row_ror:1 row_mask:0xf bank_mask:0xf
v_mul_f32 v98, 0x3acccccd, v98
v_fma_f32 v98, -v20, v20, v98
v_max_f32 v98, 0, v98
v_add_f32 v98, 0x3727c5ac, v98
v_rsq_f32 v98, v98
s_nop 0
v_mul_f32 v99, -v20, v98
v_pk_fma_f32 v[24:25], v[24:25], v[98:99], v[98:99] op_sel:[0,0,1] op_sel_hi:[1,0,1]
v_pk_fma_f32 v[26:27], v[26:27], v[98:99], v[98:99] op_sel:[0,0,1] op_sel_hi:[1,0,1]
v_pk_fma_f32 v[28:29], v[28:29], v[98:99], v[98:99] op_sel:[0,0,1] op_sel_hi:[1,0,1]
v_pk_fma_f32 v[30:31], v[30:31], v[98:99], v[98:99] op_sel:[0,0,1] op_sel_hi:[1,0,1]
v_cvt_pk_f16_f32 v124, v24, v25
v_cvt_pk_f16_f32 v125, v26, v27
v_cvt_pk_f16_f32 v126, v28, v29
v_cvt_pk_f16_f32 v127, v30, v31
v_lshlrev_b32 v24, 16, v128
v_and_b32 v25, 0xffff0000, v128
v_lshlrev_b32 v26, 16, v129
v_and_b32 v27, 0xffff0000, v129
v_lshlrev_b32 v28, 16, v130
buffer_load_dwordx4 v[172:175], v4, s[8:11], s61 offen offset:768
v_and_b32 v29, 0xffff0000, v130
v_lshlrev_b32 v30, 16, v131
v_and_b32 v31, 0xffff0000, v131
v_pk_fma_f32 v[24:25], v[24:25], v[98:99], v[98:99] op_sel:[0,0,1] op_sel_hi:[1,0,1]
v_pk_fma_f32 v[26:27], v[26:27], v[98:99], v[98:99] op_sel:[0,0,1] op_sel_hi:[1,0,1]
v_pk_fma_f32 v[28:29], v[28:29], v[98:99], v[98:99] op_sel:[0,0,1] op_sel_hi:[1,0,1]
v_pk_fma_f32 v[30:31], v[30:31], v[98:99], v[98:99] op_sel:[0,0,1] op_sel_hi:[1,0,1]
v_cvt_pk_f16_f32 v128, v24, v25
v_cvt_pk_f16_f32 v129, v26, v27
v_cvt_pk_f16_f32 v130, v28, v29
v_cvt_pk_f16_f32 v131, v30, v31
v_lshlrev_b32 v24, 16, v132
v_and_b32 v25, 0xffff0000, v132
v_lshlrev_b32 v26, 16, v133
v_and_b32 v27, 0xffff0000, v133
v_lshlrev_b32 v28, 16, v134
v_and_b32 v29, 0xffff0000, v134
v_lshlrev_b32 v30, 16, v135
v_and_b32 v31, 0xffff0000, v135
v_pk_fma_f32 v[24:25], v[24:25], v[98:99], v[98:99] op_sel:[0,0,1] op_sel_hi:[1,0,1]
v_pk_fma_f32 v[26:27], v[26:27], v[98:99], v[98:99] op_sel:[0,0,1] op_sel_hi:[1,0,1]
v_pk_fma_f32 v[28:29], v[28:29], v[98:99], v[98:99] op_sel:[0,0,1] op_sel_hi:[1,0,1]
v_pk_fma_f32 v[30:31], v[30:31], v[98:99], v[98:99] op_sel:[0,0,1] op_sel_hi:[1,0,1]
buffer_load_dwordx4 v[176:179], v4, s[8:11], s61 offen offset:1024
s_bfe_u32 s61, s62, 262160
s_mul_i32 s61, s61, 40960
s_add_u32 s61, s61, s45
v_cvt_pk_f16_f32 v132, v24, v25
v_cvt_pk_f16_f32 v133, v26, v27
v_cvt_pk_f16_f32 v134, v28, v29
v_cvt_pk_f16_f32 v135, v30, v31
v_lshlrev_b32 v24, 16, v136
v_and_b32 v25, 0xffff0000, v136
v_lshlrev_b32 v26, 16, v137
v_and_b32 v27, 0xffff0000, v137
v_lshlrev_b32 v28, 16, v138
v_and_b32 v29, 0xffff0000, v138
v_lshlrev_b32 v30, 16, v139
v_and_b32 v31, 0xffff0000, v139
v_pk_fma_f32 v[24:25], v[24:25], v[98:99], v[98:99] op_sel:[0,0,1] op_sel_hi:[1,0,1]
v_pk_fma_f32 v[26:27], v[26:27], v[98:99], v[98:99] op_sel:[0,0,1] op_sel_hi:[1,0,1]
v_pk_fma_f32 v[28:29], v[28:29], v[98:99], v[98:99] op_sel:[0,0,1] op_sel_hi:[1,0,1]
v_pk_fma_f32 v[30:31], v[30:31], v[98:99], v[98:99] op_sel:[0,0,1] op_sel_hi:[1,0,1]
v_pk_fma_f32 v[92:93], v[92:93], v[98:99], v[98:99] op_sel:[0,0,1] op_sel_hi:[1,0,1]
v_pk_fma_f32 v[94:95], v[94:95], v[98:99], v[98:99] op_sel:[0,0,1] op_sel_hi:[1,0,1]
v_pk_fma_f32 v[120:121], v[120:121], v[98:99], v[98:99] op_sel:[0,0,1] op_sel_hi:[1,0,1]
v_pk_fma_f32 v[122:123], v[122:123], v[98:99], v[98:99] op_sel:[0,0,1] op_sel_hi:[1,0,1]
v_cvt_pk_f16_f32 v136, v24, v25
v_cvt_pk_f16_f32 v137, v26, v27
v_cvt_pk_f16_f32 v138, v28, v29
v_cvt_pk_f16_f32 v139, v30, v31
s_barrier
s_waitcnt vmcnt(5)
s_mov_b32 s55, 0x3f803f80
buffer_load_dwordx4 v[180:183], v4, s[8:11], s61 offen offset:0
v_mfma_f32_16x16x32_bf16 v[20:23], a[236:239], v[140:143], 0
v_lshlrev_b32 v24, 16, v144
v_and_b32 v25, 0xffff0000, v144
v_mfma_f32_16x16x32_bf16 v[20:23], a[236:239], v[144:147], v[20:23]
v_lshlrev_b32 v26, 16, v145
v_and_b32 v27, 0xffff0000, v145
v_mfma_f32_16x16x32_bf16 v[20:23], a[236:239], v[148:151], v[20:23]
v_lshlrev_b32 v28, 16, v146
v_and_b32 v29, 0xffff0000, v146
v_mfma_f32_16x16x32_bf16 v[20:23], a[236:239], v[152:155], v[20:23]
buffer_load_dwordx4 v[184:187], v4, s[8:11], s61 offen offset:256
v_lshlrev_b32 v30, 16, v147
v_and_b32 v31, 0xffff0000, v147
v_mfma_f32_16x16x32_bf16 v[20:23], a[236:239], v[156:159], v[20:23]
v_lshlrev_b32 v72, 16, v140
v_and_b32 v73, 0xffff0000, v140
v_lshlrev_b32 v74, 16, v141
v_and_b32 v75, 0xffff0000, v141
v_dot2_f32_bf16 v84, v140, v140, 0
v_dot2_f32_bf16 v85, v141, v141, 0
v_dot2_f32_bf16 v84, v142, v142, v84
v_dot2_f32_bf16 v85, v143, v143, v85
buffer_load_dwordx4 v[188:191], v4, s[8:11], s61 offen offset:512
v_dot2_f32_bf16 v84, v144, v144, v84
v_dot2_f32_bf16 v85, v145, v145, v85
v_dot2_f32_bf16 v84, v146, v146, v84
v_dot2_f32_bf16 v85, v147, v147, v85
v_dot2_f32_bf16 v84, v148, v148, v84
v_dot2_f32_bf16 v85, v149, v149, v85
v_dot2_f32_bf16 v84, v150, v150, v84
v_dot2_f32_bf16 v85, v151, v151, v85
v_dot2_f32_bf16 v84, v152, v152, v84
v_dot2_f32_bf16 v85, v153, v153, v85
v_dot2_f32_bf16 v84, v154, v154, v84
buffer_load_dwordx4 v[192:195], v4, s[8:11], s61 offen offset:768
v_dot2_f32_bf16 v85, v155, v155, v85
v_dot2_f32_bf16 v84, v156, v156, v84
v_dot2_f32_bf16 v85, v157, v157, v85
v_dot2_f32_bf16 v84, v158, v158, v84
v_dot2_f32_bf16 v85, v159, v159, v85
v_add_f32_dpp v20, v20, v20 row_ror:8 row_mask:0xf bank_mask:0xf
v_lshlrev_b32 v140, 16, v142
v_and_b32 v141, 0xffff0000, v142
v_add_f32 v84, v84, v85
v_add_f32_dpp v20, v20, v20 row_ror:4 row_mask:0xf bank_mask:0xf
buffer_load_dwordx4 v[196:199], v4, s[8:11], s61 offen offset:1024
v_lshlrev_b32 v142, 16, v143
v_add_f32_dpp v84, v84, v84 row_ror:8 row_mask:0xf bank_mask:0xf
v_add_f32_dpp v20, v20, v20 row_ror:2 row_mask:0xf bank_mask:0xf
v_and_b32 v143, 0xffff0000, v143
v_add_f32_dpp v84, v84, v84 row_ror:4 row_mask:0xf bank_mask:0xf
v_add_f32_dpp v20, v20, v20 row_ror:1 row_mask:0xf bank_mask:0xf
v_mul_f32 v20, 0x3acccccd, v20
v_add_f32_dpp v84, v84, v84 row_ror:2 row_mask:0xf bank_mask:0xf
s_nop 1
v_add_f32_dpp v84, v84, v84 row_ror:1 row_mask:0xf bank_mask:0xf
v_mul_f32 v84, 0x3acccccd, v84
v_fma_f32 v84, -v20, v20, v84
s_add_u32 m0, s39, 0
s_nop 0
buffer_load_dwordx4 v232, s[24:27], s48 offen offset:0 lds
v_max_f32 v84, 0, v84
v_add_f32 v84, 0x3727c5ac, v84
v_rsq_f32 v84, v84
s_nop 0
v_mul_f32 v85, -v20, v84
v_pk_fma_f32 v[24:25], v[24:25], v[84:85], v[84:85] op_sel:[0,0,1] op_sel_hi:[1,0,1]
v_pk_fma_f32 v[26:27], v[26:27], v[84:85], v[84:85] op_sel:[0,0,1] op_sel_hi:[1,0,1]
v_pk_fma_f32 v[28:29], v[28:29], v[84:85], v[84:85] op_sel:[0,0,1] op_sel_hi:[1,0,1]
v_pk_fma_f32 v[30:31], v[30:31], v[84:85], v[84:85] op_sel:[0,0,1] op_sel_hi:[1,0,1]
v_cvt_pk_f16_f32 v144, v24, v25
v_cvt_pk_f16_f32 v145, v26, v27
buffer_load_dwordx4 v233, s[24:27], s48 offen offset:1024 lds
v_cvt_pk_f16_f32 v146, v28, v29
v_cvt_pk_f16_f32 v147, v30, v31
v_lshlrev_b32 v24, 16, v148
v_and_b32 v25, 0xffff0000, v148
v_lshlrev_b32 v26, 16, v149
v_and_b32 v27, 0xffff0000, v149
v_lshlrev_b32 v28, 16, v150
v_and_b32 v29, 0xffff0000, v150
v_lshlrev_b32 v30, 16, v151
v_and_b32 v31, 0xffff0000, v151
v_pk_fma_f32 v[24:25], v[24:25], v[84:85], v[84:85] op_sel:[0,0,1] op_sel_hi:[1,0,1]
buffer_load_dwordx4 v234, s[24:27], s48 offen offset:2048 lds
s_add_u32 s48, s48, 81920
v_pk_fma_f32 v[26:27], v[26:27], v[84:85], v[84:85] op_sel:[0,0,1] op_sel_hi:[1,0,1]
v_pk_fma_f32 v[28:29], v[28:29], v[84:85], v[84:85] op_sel:[0,0,1] op_sel_hi:[1,0,1]
v_pk_fma_f32 v[30:31], v[30:31], v[84:85], v[84:85] op_sel:[0,0,1] op_sel_hi:[1,0,1]
v_cvt_pk_f16_f32 v148, v24, v25
v_cvt_pk_f16_f32 v149, v26, v27
v_cvt_pk_f16_f32 v150, v28, v29
v_cvt_pk_f16_f32 v151, v30, v31
v_lshlrev_b32 v24, 16, v152
v_and_b32 v25, 0xffff0000, v152
v_lshlrev_b32 v26, 16, v153
v_and_b32 v27, 0xffff0000, v153
s_add_u32 m0, s39, 12288
s_nop 0
buffer_load_dwordx4 v232, s[24:27], s48 offen offset:0 lds
v_lshlrev_b32 v28, 16, v154
v_and_b32 v29, 0xffff0000, v154
v_lshlrev_b32 v30, 16, v155
v_and_b32 v31, 0xffff0000, v155
v_pk_fma_f32 v[24:25], v[24:25], v[84:85], v[84:85] op_sel:[0,0,1] op_sel_hi:[1,0,1]
v_pk_fma_f32 v[26:27], v[26:27], v[84:85], v[84:85] op_sel:[0,0,1] op_sel_hi:[1,0,1]
v_pk_fma_f32 v[28:29], v[28:29], v[84:85], v[84:85] op_sel:[0,0,1] op_sel_hi:[1,0,1]
v_pk_fma_f32 v[30:31], v[30:31], v[84:85], v[84:85] op_sel:[0,0,1] op_sel_hi:[1,0,1]
v_cvt_pk_f16_f32 v152, v24, v25
v_cvt_pk_f16_f32 v153, v26, v27
buffer_load_dwordx4 v233, s[24:27], s48 offen offset:1024 lds
v_cvt_pk_f16_f32 v154, v28, v29
v_cvt_pk_f16_f32 v155, v30, v31
v_lshlrev_b32 v24, 16, v156
v_and_b32 v25, 0xffff0000, v156
v_lshlrev_b32 v26, 16, v157
v_and_b32 v27, 0xffff0000, v157
v_lshlrev_b32 v28, 16, v158
v_and_b32 v29, 0xffff0000, v158
v_lshlrev_b32 v30, 16, v159
v_and_b32 v31, 0xffff0000, v159
v_pk_fma_f32 v[24:25], v[24:25], v[84:85], v[84:85] op_sel:[0,0,1] op_sel_hi:[1,0,1]
buffer_load_dwordx4 v234, s[24:27], s48 offen offset:2048 lds
s_add_u32 s48, s48, 81920
v_pk_fma_f32 v[26:27], v[26:27], v[84:85], v[84:85] op_sel:[0,0,1] op_sel_hi:[1,0,1]
v_pk_fma_f32 v[28:29], v[28:29], v[84:85], v[84:85] op_sel:[0,0,1] op_sel_hi:[1,0,1]
v_pk_fma_f32 v[30:31], v[30:31], v[84:85], v[84:85] op_sel:[0,0,1] op_sel_hi:[1,0,1]
v_pk_fma_f32 v[72:73], v[72:73], v[84:85], v[84:85] op_sel:[0,0,1] op_sel_hi:[1,0,1]
v_pk_fma_f32 v[74:75], v[74:75], v[84:85], v[84:85] op_sel:[0,0,1] op_sel_hi:[1,0,1]
v_pk_fma_f32 v[140:141], v[140:141], v[84:85], v[84:85] op_sel:[0,0,1] op_sel_hi:[1,0,1]
v_pk_fma_f32 v[142:143], v[142:143], v[84:85], v[84:85] op_sel:[0,0,1] op_sel_hi:[1,0,1]
v_cvt_pk_f16_f32 v156, v24, v25
v_cvt_pk_f16_f32 v157, v26, v27
v_cvt_pk_f16_f32 v158, v28, v29
v_cvt_pk_f16_f32 v159, v30, v31
s_waitcnt vmcnt(11)
s_mov_b32 s55, 0x3f803f80
buffer_store_dwordx4 a[232:235], v11, s[4:7], s46 offen sc1
v_mfma_f32_16x16x32_bf16 v[20:23], a[236:239], v[160:163], 0
v_lshlrev_b32 v24, 16, v164
v_and_b32 v25, 0xffff0000, v164
v_mfma_f32_16x16x32_bf16 v[20:23], a[236:239], v[164:167], v[20:23]
v_lshlrev_b32 v26, 16, v165
v_and_b32 v27, 0xffff0000, v165
v_mfma_f32_16x16x32_bf16 v[20:23], a[236:239], v[168:171], v[20:23]
v_lshlrev_b32 v28, 16, v166
v_and_b32 v29, 0xffff0000, v166
v_mfma_f32_16x16x32_bf16 v[20:23], a[236:239], v[172:175], v[20:23]
v_lshlrev_b32 v30, 16, v167
v_and_b32 v31, 0xffff0000, v167
v_mfma_f32_16x16x32_bf16 v[20:23], a[236:239], v[176:179], v[20:23]
v_lshlrev_b32 v76, 16, v160
v_and_b32 v77, 0xffff0000, v160
v_lshlrev_b32 v78, 16, v161
v_and_b32 v79, 0xffff0000, v161
buffer_store_dwordx4 a[232:235], v12, s[4:7], s46 offen sc1
v_dot2_f32_bf16 v86, v160, v160, 0
v_dot2_f32_bf16 v87, v161, v161, 0
v_dot2_f32_bf16 v86, v162, v162, v86
v_dot2_f32_bf16 v87, v163, v163, v87
v_dot2_f32_bf16 v86, v164, v164, v86
v_dot2_f32_bf16 v87, v165, v165, v87
v_dot2_f32_bf16 v86, v166, v166, v86
v_dot2_f32_bf16 v87, v167, v167, v87
v_dot2_f32_bf16 v86, v168, v168, v86
v_dot2_f32_bf16 v87, v169, v169, v87
v_dot2_f32_bf16 v86, v170, v170, v86
v_dot2_f32_bf16 v87, v171, v171, v87
v_dot2_f32_bf16 v86, v172, v172, v86
v_dot2_f32_bf16 v87, v173, v173, v87
v_dot2_f32_bf16 v86, v174, v174, v86
v_dot2_f32_bf16 v87, v175, v175, v87
buffer_store_dwordx4 a[232:235], v13, s[4:7], s46 offen sc1
v_dot2_f32_bf16 v86, v176, v176, v86
v_dot2_f32_bf16 v87, v177, v177, v87
v_dot2_f32_bf16 v86, v178, v178, v86
v_dot2_f32_bf16 v87, v179, v179, v87
v_add_f32_dpp v20, v20, v20 row_ror:8 row_mask:0xf bank_mask:0xf
v_lshlrev_b32 v160, 16, v162
v_and_b32 v161, 0xffff0000, v162
v_add_f32 v86, v86, v87
v_add_f32_dpp v20, v20, v20 row_ror:4 row_mask:0xf bank_mask:0xf
v_lshlrev_b32 v162, 16, v163
v_add_f32_dpp v86, v86, v86 row_ror:8 row_mask:0xf bank_mask:0xf
v_add_f32_dpp v20, v20, v20 row_ror:2 row_mask:0xf bank_mask:0xf
v_and_b32 v163, 0xffff0000, v163
v_add_f32_dpp v86, v86, v86 row_ror:4 row_mask:0xf bank_mask:0xf
v_add_f32_dpp v20, v20, v20 row_ror:1 row_mask:0xf bank_mask:0xf
v_mul_f32 v20, 0x3acccccd, v20
v_add_f32_dpp v86, v86, v86 row_ror:2 row_mask:0xf bank_mask:0xf
buffer_store_dwordx4 a[232:235], v14, s[4:7], s46 offen sc1
s_nop 0
v_add_f32_dpp v86, v86, v86 row_ror:1 row_mask:0xf bank_mask:0xf
v_mul_f32 v86, 0x3acccccd, v86
v_fma_f32 v86, -v20, v20, v86
v_max_f32 v86, 0, v86
v_add_f32 v86, 0x3727c5ac, v86
v_rsq_f32 v86, v86
s_nop 0
v_mul_f32 v87, -v20, v86
v_pk_fma_f32 v[24:25], v[24:25], v[86:87], v[86:87] op_sel:[0,0,1] op_sel_hi:[1,0,1]
v_pk_fma_f32 v[26:27], v[26:27], v[86:87], v[86:87] op_sel:[0,0,1] op_sel_hi:[1,0,1]
v_pk_fma_f32 v[28:29], v[28:29], v[86:87], v[86:87] op_sel:[0,0,1] op_sel_hi:[1,0,1]
v_pk_fma_f32 v[30:31], v[30:31], v[86:87], v[86:87] op_sel:[0,0,1] op_sel_hi:[1,0,1]
v_cvt_pk_f16_f32 v164, v24, v25
v_cvt_pk_f16_f32 v165, v26, v27
v_cvt_pk_f16_f32 v166, v28, v29
v_cvt_pk_f16_f32 v167, v30, v31
v_lshlrev_b32 v24, 16, v168
v_and_b32 v25, 0xffff0000, v168
buffer_store_dwordx4 a[232:235], v246, s[4:7], s18 offen sc1
v_lshlrev_b32 v26, 16, v169
v_and_b32 v27, 0xffff0000, v169
v_lshlrev_b32 v28, 16, v170
v_and_b32 v29, 0xffff0000, v170
v_lshlrev_b32 v30, 16, v171
v_and_b32 v31, 0xffff0000, v171
v_pk_fma_f32 v[24:25], v[24:25], v[86:87], v[86:87] op_sel:[0,0,1] op_sel_hi:[1,0,1]
v_pk_fma_f32 v[26:27], v[26:27], v[86:87], v[86:87] op_sel:[0,0,1] op_sel_hi:[1,0,1]
v_pk_fma_f32 v[28:29], v[28:29], v[86:87], v[86:87] op_sel:[0,0,1] op_sel_hi:[1,0,1]
v_pk_fma_f32 v[30:31], v[30:31], v[86:87], v[86:87] op_sel:[0,0,1] op_sel_hi:[1,0,1]
v_cvt_pk_f16_f32 v168, v24, v25
v_cvt_pk_f16_f32 v169, v26, v27
v_cvt_pk_f16_f32 v170, v28, v29
v_cvt_pk_f16_f32 v171, v30, v31
v_lshlrev_b32 v24, 16, v172
v_and_b32 v25, 0xffff0000, v172
s_add_u32 s37, s18, 8192
buffer_store_dwordx4 a[232:235], v246, s[4:7], s37 offen sc1
v_lshlrev_b32 v26, 16, v173
v_and_b32 v27, 0xffff0000, v173
v_lshlrev_b32 v28, 16, v174
v_and_b32 v29, 0xffff0000, v174
v_lshlrev_b32 v30, 16, v175
v_and_b32 v31, 0xffff0000, v175
v_pk_fma_f32 v[24:25], v[24:25], v[86:87], v[86:87] op_sel:[0,0,1] op_sel_hi:[1,0,1]
v_pk_fma_f32 v[26:27], v[26:27], v[86:87], v[86:87] op_sel:[0,0,1] op_sel_hi:[1,0,1]
v_pk_fma_f32 v[28:29], v[28:29], v[86:87], v[86:87] op_sel:[0,0,1] op_sel_hi:[1,0,1]
v_pk_fma_f32 v[30:31], v[30:31], v[86:87], v[86:87] op_sel:[0,0,1] op_sel_hi:[1,0,1]
v_cvt_pk_f16_f32 v172, v24, v25
v_cvt_pk_f16_f32 v173, v26, v27
v_cvt_pk_f16_f32 v174, v28, v29
v_cvt_pk_f16_f32 v175, v30, v31
v_lshlrev_b32 v24, 16, v176
v_and_b32 v25, 0xffff0000, v176
v_lshlrev_b32 v26, 16, v177
s_lshl_b32 s37, s47, 2
s_add_u32 s37, s37, s3
s_lshl_b32 s37, s37, 3
s_add_u32 s37, s37, s96
s_lshl_b32 s37, s37, 8
s_add_u32 s37, s37, 131072
v_lshlrev_b32 v69, 2, v1
v_xor_b32 v70, 0xff, v19
buffer_store_dword v70, v69, s[4:7], s37 offen sc1
v_and_b32 v27, 0xffff0000, v177
v_lshlrev_b32 v28, 16, v178
v_and_b32 v29, 0xffff0000, v178
v_lshlrev_b32 v30, 16, v179
v_and_b32 v31, 0xffff0000, v179
v_pk_fma_f32 v[24:25], v[24:25], v[86:87], v[86:87] op_sel:[0,0,1] op_sel_hi:[1,0,1]
v_pk_fma_f32 v[26:27], v[26:27], v[86:87], v[86:87] op_sel:[0,0,1] op_sel_hi:[1,0,1]
v_pk_fma_f32 v[28:29], v[28:29], v[86:87], v[86:87] op_sel:[0,0,1] op_sel_hi:[1,0,1]
v_pk_fma_f32 v[30:31], v[30:31], v[86:87], v[86:87] op_sel:[0,0,1] op_sel_hi:[1,0,1]
v_pk_fma_f32 v[76:77], v[76:77], v[86:87], v[86:87] op_sel:[0,0,1] op_sel_hi:[1,0,1]
v_pk_fma_f32 v[78:79], v[78:79], v[86:87], v[86:87] op_sel:[0,0,1] op_sel_hi:[1,0,1]
v_pk_fma_f32 v[160:161], v[160:161], v[86:87], v[86:87] op_sel:[0,0,1] op_sel_hi:[1,0,1]
v_pk_fma_f32 v[162:163], v[162:163], v[86:87], v[86:87] op_sel:[0,0,1] op_sel_hi:[1,0,1]
v_cvt_pk_f16_f32 v176, v24, v25
v_cvt_pk_f16_f32 v177, v26, v27
v_cvt_pk_f16_f32 v178, v28, v29
v_cvt_pk_f16_f32 v179, v30, v31
buffer_load_dwordx4 v[40:43], v248, s[4:7], s56 offen sc1
s_waitcnt vmcnt(14)
s_mov_b32 s55, 0x3f803f80
v_mfma_f32_16x16x32_bf16 v[20:23], a[236:239], v[180:183], 0
v_lshlrev_b32 v24, 16, v184
v_and_b32 v25, 0xffff0000, v184
v_mfma_f32_16x16x32_bf16 v[20:23], a[236:239], v[184:187], v[20:23]
v_lshlrev_b32 v26, 16, v185
v_and_b32 v27, 0xffff0000, v185
v_mfma_f32_16x16x32_bf16 v[20:23], a[236:239], v[188:191], v[20:23]
buffer_load_dwordx4 v[44:47], v248, s[4:7], s57 offen sc1
v_lshlrev_b32 v28, 16, v186
v_and_b32 v29, 0xffff0000, v186
v_mfma_f32_16x16x32_bf16 v[20:23], a[236:239], v[192:195], v[20:23]
v_lshlrev_b32 v30, 16, v187
v_and_b32 v31, 0xffff0000, v187
v_mfma_f32_16x16x32_bf16 v[20:23], a[236:239], v[196:199], v[20:23]
v_lshlrev_b32 v80, 16, v180
v_and_b32 v81, 0xffff0000, v180
v_lshlrev_b32 v82, 16, v181
buffer_load_dwordx4 v[48:51], v248, s[4:7], s58 offen sc1
v_and_b32 v83, 0xffff0000, v181
v_dot2_f32_bf16 v66, v180, v180, 0
v_dot2_f32_bf16 v67, v181, v181, 0
v_dot2_f32_bf16 v66, v182, v182, v66
v_dot2_f32_bf16 v67, v183, v183, v67
v_dot2_f32_bf16 v66, v184, v184, v66
v_dot2_f32_bf16 v67, v185, v185, v67
v_dot2_f32_bf16 v66, v186, v186, v66
v_dot2_f32_bf16 v67, v187, v187, v67
buffer_load_dword v52, v249, s[4:7], s56 offen sc1
v_dot2_f32_bf16 v66, v188, v188, v66
v_dot2_f32_bf16 v67, v189, v189, v67
v_dot2_f32_bf16 v66, v190, v190, v66
v_dot2_f32_bf16 v67, v191, v191, v67
v_dot2_f32_bf16 v66, v192, v192, v66
v_dot2_f32_bf16 v67, v193, v193, v67
v_dot2_f32_bf16 v66, v194, v194, v66
v_dot2_f32_bf16 v67, v195, v195, v67
v_dot2_f32_bf16 v66, v196, v196, v66
buffer_load_dword v53, v249, s[4:7], s57 offen sc1
v_dot2_f32_bf16 v67, v197, v197, v67
v_dot2_f32_bf16 v66, v198, v198, v66
v_dot2_f32_bf16 v67, v199, v199, v67
v_add_f32_dpp v20, v20, v20 row_ror:8 row_mask:0xf bank_mask:0xf
v_lshlrev_b32 v180, 16, v182
v_and_b32 v181, 0xffff0000, v182
v_add_f32 v66, v66, v67
v_add_f32_dpp v20, v20, v20 row_ror:4 row_mask:0xf bank_mask:0xf
v_lshlrev_b32 v182, 16, v183
buffer_load_dword v54, v249, s[4:7], s58 offen sc1
v_add_f32_dpp v66, v66, v66 row_ror:8 row_mask:0xf bank_mask:0xf
v_add_f32_dpp v20, v20, v20 row_ror:2 row_mask:0xf bank_mask:0xf
v_and_b32 v183, 0xffff0000, v183
v_add_f32_dpp v66, v66, v66 row_ror:4 row_mask:0xf bank_mask:0xf
v_add_f32_dpp v20, v20, v20 row_ror:1 row_mask:0xf bank_mask:0xf
v_mul_f32 v20, 0x3acccccd, v20
v_add_f32_dpp v66, v66, v66 row_ror:2 row_mask:0xf bank_mask:0xf
s_nop 1
v_add_f32_dpp v66, v66, v66 row_ror:1 row_mask:0xf bank_mask:0xf
v_mul_f32 v66, 0x3acccccd, v66
buffer_load_dword v71, v247, s[4:7], s60 offen sc1
v_fma_f32 v66, -v20, v20, v66
v_max_f32 v66, 0, v66
v_add_f32 v66, 0x3727c5ac, v66
v_rsq_f32 v66, v66
s_nop 0
v_mul_f32 v67, -v20, v66
v_pk_fma_f32 v[24:25], v[24:25], v[66:67], v[66:67] op_sel:[0,0,1] op_sel_hi:[1,0,1]
v_pk_fma_f32 v[26:27], v[26:27], v[66:67], v[66:67] op_sel:[0,0,1] op_sel_hi:[1,0,1]
v_pk_fma_f32 v[28:29], v[28:29], v[66:67], v[66:67] op_sel:[0,0,1] op_sel_hi:[1,0,1]
v_pk_fma_f32 v[30:31], v[30:31], v[66:67], v[66:67] op_sel:[0,0,1] op_sel_hi:[1,0,1]
v_cvt_pk_f16_f32 v184, v24, v25
s_add_u32 m0, s39, 24576
s_nop 0
buffer_load_dwordx4 v232, s[24:27], s48 offen offset:0 lds
v_cvt_pk_f16_f32 v185, v26, v27
v_cvt_pk_f16_f32 v186, v28, v29
v_cvt_pk_f16_f32 v187, v30, v31
v_lshlrev_b32 v24, 16, v188
v_and_b32 v25, 0xffff0000, v188
v_lshlrev_b32 v26, 16, v189
v_and_b32 v27, 0xffff0000, v189
v_lshlrev_b32 v28, 16, v190
v_and_b32 v29, 0xffff0000, v190
buffer_load_dwordx4 v233, s[24:27], s48 offen offset:1024 lds
v_lshlrev_b32 v30, 16, v191
v_and_b32 v31, 0xffff0000, v191
v_pk_fma_f32 v[24:25], v[24:25], v[66:67], v[66:67] op_sel:[0,0,1] op_sel_hi:[1,0,1]
v_pk_fma_f32 v[26:27], v[26:27], v[66:67], v[66:67] op_sel:[0,0,1] op_sel_hi:[1,0,1]
v_pk_fma_f32 v[28:29], v[28:29], v[66:67], v[66:67] op_sel:[0,0,1] op_sel_hi:[1,0,1]
v_pk_fma_f32 v[30:31], v[30:31], v[66:67], v[66:67] op_sel:[0,0,1] op_sel_hi:[1,0,1]
v_cvt_pk_f16_f32 v188, v24, v25
v_cvt_pk_f16_f32 v189, v26, v27
v_cvt_pk_f16_f32 v190, v28, v29
buffer_load_dwordx4 v234, s[24:27], s48 offen offset:2048 lds
s_add_u32 s48, s48, 81920
v_cvt_pk_f16_f32 v191, v30, v31
v_lshlrev_b32 v24, 16, v192
v_and_b32 v25, 0xffff0000, v192
v_lshlrev_b32 v26, 16, v193
v_and_b32 v27, 0xffff0000, v193
v_lshlrev_b32 v28, 16, v194
v_and_b32 v29, 0xffff0000, v194
v_lshlrev_b32 v30, 16, v195
v_and_b32 v31, 0xffff0000, v195
s_add_u32 m0, s39, 36864
s_nop 0
buffer_load_dwordx4 v232, s[24:27], s48 offen offset:0 lds
v_pk_fma_f32 v[24:25], v[24:25], v[66:67], v[66:67] op_sel:[0,0,1] op_sel_hi:[1,0,1]
v_pk_fma_f32 v[26:27], v[26:27], v[66:67], v[66:67] op_sel:[0,0,1] op_sel_hi:[1,0,1]
v_pk_fma_f32 v[28:29], v[28:29], v[66:67], v[66:67] op_sel:[0,0,1] op_sel_hi:[1,0,1]
v_pk_fma_f32 v[30:31], v[30:31], v[66:67], v[66:67] op_sel:[0,0,1] op_sel_hi:[1,0,1]
v_cvt_pk_f16_f32 v192, v24, v25
v_cvt_pk_f16_f32 v193, v26, v27
v_cvt_pk_f16_f32 v194, v28, v29
v_cvt_pk_f16_f32 v195, v30, v31
v_lshlrev_b32 v24, 16, v196
buffer_load_dwordx4 v233, s[24:27], s48 offen offset:1024 lds
v_and_b32 v25, 0xffff0000, v196
v_lshlrev_b32 v26, 16, v197
v_and_b32 v27, 0xffff0000, v197
v_lshlrev_b32 v28, 16, v198
v_and_b32 v29, 0xffff0000, v198
v_lshlrev_b32 v30, 16, v199
v_and_b32 v31, 0xffff0000, v199
v_pk_fma_f32 v[24:25], v[24:25], v[66:67], v[66:67] op_sel:[0,0,1] op_sel_hi:[1,0,1]
v_pk_fma_f32 v[26:27], v[26:27], v[66:67], v[66:67] op_sel:[0,0,1] op_sel_hi:[1,0,1]
buffer_load_dwordx4 v234, s[24:27], s48 offen offset:2048 lds
s_add_u32 s48, s48, 81920
v_pk_fma_f32 v[28:29], v[28:29], v[66:67], v[66:67] op_sel:[0,0,1] op_sel_hi:[1,0,1]
v_pk_fma_f32 v[30:31], v[30:31], v[66:67], v[66:67] op_sel:[0,0,1] op_sel_hi:[1,0,1]
v_pk_fma_f32 v[80:81], v[80:81], v[66:67], v[66:67] op_sel:[0,0,1] op_sel_hi:[1,0,1]
v_pk_fma_f32 v[82:83], v[82:83], v[66:67], v[66:67] op_sel:[0,0,1] op_sel_hi:[1,0,1]
v_pk_fma_f32 v[180:181], v[180:181], v[66:67], v[66:67] op_sel:[0,0,1] op_sel_hi:[1,0,1]
v_pk_fma_f32 v[182:183], v[182:183], v[66:67], v[66:67] op_sel:[0,0,1] op_sel_hi:[1,0,1]
v_cvt_pk_f16_f32 v196, v24, v25
v_cvt_pk_f16_f32 v197, v26, v27
v_cvt_pk_f16_f32 v198, v28, v29
v_cvt_pk_f16_f32 v199, v30, v31
s_branch L_bodyj
L_ga_retry:
buffer_load_dwordx4 v[40:43], v248, s[4:7], s56 offen sc1
buffer_load_dwordx4 v[44:47], v248, s[4:7], s57 offen sc1
buffer_load_dwordx4 v[48:51], v248, s[4:7], s58 offen sc1
buffer_load_dword v52, v249, s[4:7], s56 offen sc1
buffer_load_dword v53, v249, s[4:7], s57 offen sc1
buffer_load_dword v54, v249, s[4:7], s58 offen sc1
s_waitcnt vmcnt(0)
v_xor_b32 v40, s12, v40
v_xor_b32 v41, s13, v41
v_xor_b32 v42, s14, v42
v_xor_b32 v43, s15, v43
v_xor_b32 v44, s12, v44
v_xor_b32 v45, s13, v45
v_xor_b32 v46, s14, v46
v_xor_b32 v47, s15, v47
v_xor_b32 v48, s12, v48
v_xor_b32 v49, s13, v49
v_xor_b32 v50, s14, v50
v_xor_b32 v51, s15, v51
v_xor_b32 v52, v19, v52
v_xor_b32 v53, v19, v53
v_xor_b32 v54, v19, v54
v_or3_b32 v64, v40, v41, v42
v_or3_b32 v65, v43, v44, v45
v_or3_b32 v64, v64, v46, v47
v_or3_b32 v65, v65, v48, v49
v_or3_b32 v64, v64, v50, v51
v_or3_b32 v65, v65, v52, v53
v_or3_b32 v64, v64, v65, v54
v_and_b32 v64, 0xff, v64
v_cmp_ne_u32 vcc, 0, v64
s_add_u32 s97, s97, 1
s_cmp_gt_u32 s97, 65536
s_cbranch_scc1 L_ga_ok
s_cbranch_vccnz L_ga_retry
s_branch L_ga_ok
L_fg_retry:
buffer_load_dword v71, v247, s[4:7], s60 offen sc1
s_waitcnt vmcnt(0)
v_cmp_ne_u32 vcc, s40, v71
s_add_u32 s97, s97, 1
s_cmp_gt_u32 s97, 65536
s_cbranch_scc1 L_fg_ok
s_cbranch_vccnz L_fg_retry
s_branch L_fg_ok
L_mv_retry:
buffer_load_dwordx2 v[194:195], v231, s[4:7], s23 offen sc1
buffer_load_dwordx4 v[240:243], v238, s[4:7], s51 offen sc1
buffer_load_dwordx4 v[190:193], v238, s[4:7], s22 offen sc1
s_waitcnt vmcnt(0)
v_perm_b32 v36, v241, v240, s55
v_perm_b32 v37, v243, v242, s55
v_xor_b32 v36, s40, v36
v_xor_b32 v37, s40, v37
v_or_b32 v38, v36, v37
v_perm_b32 v36, v191, v190, s55
v_perm_b32 v37, v193, v192, s55
v_xor_b32 v36, s40, v36
v_xor_b32 v37, s40, v37
v_or3_b32 v38, v38, v36, v37
v_and_b32 v38, v38, v230
v_xor_b32 v37, s40, v194
v_or_b32 v38, v38, v37
v_cmp_ne_u32 vcc, 0, v38
s_add_u32 s97, s97, 1
s_cmp_gt_u32 s97, 65536
s_cbranch_scc1 L_mv_ok
s_cbranch_vccnz L_mv_retry
s_branch L_mv_ok
L_o0_retry:
buffer_load_dwordx4 v[100:103], v7, s[4:7], s56 offen offset:0 sc1
buffer_load_dwordx4 v[104:107], v7, s[4:7], s56 offen offset:1024 sc1
buffer_load_dwordx4 v[108:111], v7, s[4:7], s56 offen offset:2048 sc1
buffer_load_dwordx4 v[112:115], v7, s[4:7], s56 offen offset:3072 sc1
buffer_load_dwordx4 v[116:119], v7, s[4:7], s57 offen offset:0 sc1
buffer_load_dwordx4 v[120:123], v7, s[4:7], s57 offen offset:1024 sc1
buffer_load_dwordx4 v[124:127], v7, s[4:7], s57 offen offset:2048 sc1
buffer_load_dwordx4 v[128:131], v7, s[4:7], s57 offen offset:3072 sc1
buffer_load_dwordx4 v[132:135], v7, s[4:7], s58 offen offset:0 sc1
buffer_load_dwordx4 v[136:139], v7, s[4:7], s58 offen offset:1024 sc1
s_waitcnt vmcnt(8)
v_max3_u32 v92, v100, v101, v102
v_max3_u32 v93, v103, v104, v105
v_max3_u32 v92, v92, v106, v107
v_max_u32 v92, v92, v93
v_cmp_eq_u32 vcc, -1, v92
s_add_u32 s97, s97, 1
s_cmp_gt_u32 s97, 65536
s_cbranch_scc1 L_o0_ok
s_cbranch_vccnz L_o0_retry
s_branch L_o0_ok
L_o1_retry:
buffer_load_dwordx4 v[108:111], v7, s[4:7], s56 offen offset:2048 sc1
buffer_load_dwordx4 v[112:115], v7, s[4:7], s56 offen offset:3072 sc1
buffer_load_dwordx4 v[116:119], v7, s[4:7], s57 offen offset:0 sc1
buffer_load_dwordx4 v[120:123], v7, s[4:7], s57 offen offset:1024 sc1
buffer_load_dwordx4 v[124:127], v7, s[4:7], s57 offen offset:2048 sc1
buffer_load_dwordx4 v[128:131], v7, s[4:7], s57 offen offset:3072 sc1
buffer_load_dwordx4 v[132:135], v7, s[4:7], s58 offen offset:0 sc1
buffer_load_dwordx4 v[136:139], v7, s[4:7], s58 offen offset:1024 sc1
buffer_load_dwordx4 v[140:143], v7, s[4:7], s58 offen offset:2048 sc1
buffer_load_dwordx4 v[144:147], v7, s[4:7], s58 offen offset:3072 sc1
s_waitcnt vmcnt(8)
v_max3_u32 v92, v108, v109, v110
v_max3_u32 v93, v111, v112, v113
v_max3_u32 v92, v92, v114, v115
v_max_u32 v92, v92, v93
v_cmp_eq_u32 vcc, -1, v92
s_add_u32 s97, s97, 1
s_cmp_gt_u32 s97, 65536
s_cbranch_scc1 L_o1_ok
s_cbranch_vccnz L_o1_retry
s_branch L_o1_ok
L_o2_retry:
buffer_load_dwordx4 v[116:119], v7, s[4:7], s57 offen offset:0 sc1
buffer_load_dwordx4 v[120:123], v7, s[4:7], s57 offen offset:1024 sc1
buffer_load_dwordx4 v[124:127], v7, s[4:7], s57 offen offset:2048 sc1
buffer_load_dwordx4 v[128:131], v7, s[4:7], s57 offen offset:3072 sc1
buffer_load_dwordx4 v[132:135], v7, s[4:7], s58 offen offset:0 sc1
buffer_load_dwordx4 v[136:139], v7, s[4:7], s58 offen offset:1024 sc1
buffer_load_dwordx4 v[140:143], v7, s[4:7], s58 offen offset:2048 sc1
buffer_load_dwordx4 v[144:147], v7, s[4:7], s58 offen offset:3072 sc1
buffer_load_dwordx4 v[148:151], v7, s[4:7], s59 offen offset:0 sc1
buffer_load_dwordx4 v[152:155], v7, s[4:7], s59 offen offset:1024 sc1
s_waitcnt vmcnt(8)
v_max3_u32 v92, v116, v117, v118
v_max3_u32 v93, v119, v120, v121
v_max3_u32 v92, v92, v122, v123
v_max_u32 v92, v92, v93
v_cmp_eq_u32 vcc, -1, v92
s_add_u32 s97, s97, 1
s_cmp_gt_u32 s97, 65536
s_cbranch_scc1 L_o2_ok
s_cbranch_vccnz L_o2_retry
s_branch L_o2_ok
L_o3_retry:
buffer_load_dwordx4 v[124:127], v7, s[4:7], s57 offen offset:2048 sc1
buffer_load_dwordx4 v[128:131], v7, s[4:7], s57 offen offset:3072 sc1
buffer_load_dwordx4 v[132:135], v7, s[4:7], s58 offen offset:0 sc1
buffer_load_dwordx4 v[136:139], v7, s[4:7], s58 offen offset:1024 sc1
buffer_load_dwordx4 v[140:143], v7, s[4:7], s58 offen offset:2048 sc1
buffer_load_dwordx4 v[144:147], v7, s[4:7], s58 offen offset:3072 sc1
buffer_load_dwordx4 v[148:151], v7, s[4:7], s59 offen offset:0 sc1
buffer_load_dwordx4 v[152:155], v7, s[4:7], s59 offen offset:1024 sc1
buffer_load_dwordx4 v[156:159], v7, s[4:7], s59 offen offset:2048 sc1
buffer_load_dwordx4 v[160:163], v7, s[4:7], s59 offen offset:3072 sc1
s_waitcnt vmcnt(8)
v_max3_u32 v92, v124, v125, v126
v_max3_u32 v93, v127, v128, v129
v_max3_u32 v92, v92, v130, v131
v_max_u32 v92, v92, v93
v_cmp_eq_u32 vcc, -1, v92
s_add_u32 s97, s97, 1
s_cmp_gt_u32 s97, 65536
s_cbranch_scc1 L_o3_ok
s_cbranch_vccnz L_o3_retry
s_branch L_o3_ok
L_o4_retry:
buffer_load_dwordx4 v[132:135], v7, s[4:7], s58 offen offset:0 sc1
buffer_load_dwordx4 v[136:139], v7, s[4:7], s58 offen offset:1024 sc1
buffer_load_dwordx4 v[140:143], v7, s[4:7], s58 offen offset:2048 sc1
buffer_load_dwordx4 v[144:147], v7, s[4:7], s58 offen offset:3072 sc1
buffer_load_dwordx4 v[148:151], v7, s[4:7], s59 offen offset:0 sc1
buffer_load_dwordx4 v[152:155], v7, s[4:7], s59 offen offset:1024 sc1
buffer_load_dwordx4 v[156:159], v7, s[4:7], s59 offen offset:2048 sc1
buffer_load_dwordx4 v[160:163], v7, s[4:7], s59 offen offset:3072 sc1
buffer_load_dwordx4 v[164:167], v7, s[4:7], s60 offen offset:0 sc1
buffer_load_dwordx4 v[168:171], v7, s[4:7], s60 offen offset:1024 sc1
s_waitcnt vmcnt(8)
v_max3_u32 v92, v132, v133, v134
v_max3_u32 v93, v135, v136, v137
v_max3_u32 v92, v92, v138, v139
v_max_u32 v92, v92, v93
v_cmp_eq_u32 vcc, -1, v92
s_add_u32 s97, s97, 1
s_cmp_gt_u32 s97, 65536
s_cbranch_scc1 L_o4_ok
s_cbranch_vccnz L_o4_retry
s_branch L_o4_ok
L_o5_retry:
buffer_load_dwordx4 v[140:143], v7, s[4:7], s58 offen offset:2048 sc1
buffer_load_dwordx4 v[144:147], v7, s[4:7], s58 offen offset:3072 sc1
buffer_load_dwordx4 v[148:151], v7, s[4:7], s59 offen offset:0 sc1
buffer_load_dwordx4 v[152:155], v7, s[4:7], s59 offen offset:1024 sc1
buffer_load_dwordx4 v[156:159], v7, s[4:7], s59 offen offset:2048 sc1
buffer_load_dwordx4 v[160:163], v7, s[4:7], s59 offen offset:3072 sc1
buffer_load_dwordx4 v[164:167], v7, s[4:7], s60 offen offset:0 sc1
buffer_load_dwordx4 v[168:171], v7, s[4:7], s60 offen offset:1024 sc1
buffer_load_dwordx4 v[172:175], v7, s[4:7], s60 offen offset:2048 sc1
buffer_load_dwordx4 v[176:179], v7, s[4:7], s60 offen offset:3072 sc1
s_waitcnt vmcnt(8)
v_max3_u32 v92, v140, v141, v142
v_max3_u32 v93, v143, v144, v145
v_max3_u32 v92, v92, v146, v147
v_max_u32 v92, v92, v93
v_cmp_eq_u32 vcc, -1, v92
s_add_u32 s97, s97, 1
s_cmp_gt_u32 s97, 65536
s_cbranch_scc1 L_o5_ok
s_cbranch_vccnz L_o5_retry
s_branch L_o5_ok
L_o6_retry:
buffer_load_dwordx4 v[148:151], v7, s[4:7], s59 offen offset:0 sc1
buffer_load_dwordx4 v[152:155], v7, s[4:7], s59 offen offset:1024 sc1
buffer_load_dwordx4 v[156:159], v7, s[4:7], s59 offen offset:2048 sc1
buffer_load_dwordx4 v[160:163], v7, s[4:7], s59 offen offset:3072 sc1
buffer_load_dwordx4 v[164:167], v7, s[4:7], s60 offen offset:0 sc1
buffer_load_dwordx4 v[168:171], v7, s[4:7], s60 offen offset:1024 sc1
buffer_load_dwordx4 v[172:175], v7, s[4:7], s60 offen offset:2048 sc1
buffer_load_dwordx4 v[176:179], v7, s[4:7], s60 offen offset:3072 sc1
s_waitcnt vmcnt(6)
v_max3_u32 v92, v148, v149, v150
v_max3_u32 v93, v151, v152, v153
v_max3_u32 v92, v92, v154, v155
v_max_u32 v92, v92, v93
v_cmp_eq_u32 vcc, -1, v92
s_add_u32 s97, s97, 1
s_cmp_gt_u32 s97, 65536
s_cbranch_scc1 L_o6_ok
s_cbranch_vccnz L_o6_retry
s_branch L_o6_ok
L_o7_retry:
buffer_load_dwordx4 v[156:159], v7, s[4:7], s59 offen offset:2048 sc1
buffer_load_dwordx4 v[160:163], v7, s[4:7], s59 offen offset:3072 sc1
buffer_load_dwordx4 v[164:167], v7, s[4:7], s60 offen offset:0 sc1
buffer_load_dwordx4 v[168:171], v7, s[4:7], s60 offen offset:1024 sc1
buffer_load_dwordx4 v[172:175], v7, s[4:7], s60 offen offset:2048 sc1
buffer_load_dwordx4 v[176:179], v7, s[4:7], s60 offen offset:3072 sc1
s_waitcnt vmcnt(4)
v_max3_u32 v92, v156, v157, v158
v_max3_u32 v93, v159, v160, v161
v_max3_u32 v92, v92, v162, v163
v_max_u32 v92, v92, v93
v_cmp_eq_u32 vcc, -1, v92
s_add_u32 s97, s97, 1
s_cmp_gt_u32 s97, 65536
s_cbranch_scc1 L_o7_ok
s_cbranch_vccnz L_o7_retry
s_branch L_o7_ok
L_o8_retry:
buffer_load_dwordx4 v[164:167], v7, s[4:7], s60 offen offset:0 sc1
buffer_load_dwordx4 v[168:171], v7, s[4:7], s60 offen offset:1024 sc1
buffer_load_dwordx4 v[172:175], v7, s[4:7], s60 offen offset:2048 sc1
buffer_load_dwordx4 v[176:179], v7, s[4:7], s60 offen offset:3072 sc1
s_waitcnt vmcnt(2)
v_max3_u32 v92, v164, v165, v166
v_max3_u32 v93, v167, v168, v169
v_max3_u32 v92, v92, v170, v171
v_max_u32 v92, v92, v93
v_cmp_eq_u32 vcc, -1, v92
s_add_u32 s97, s97, 1
s_cmp_gt_u32 s97, 65536
s_cbranch_scc1 L_o8_ok
s_cbranch_vccnz L_o8_retry
s_branch L_o8_ok
L_o9_retry:
buffer_load_dwordx4 v[172:175], v7, s[4:7], s60 offen offset:2048 sc1
buffer_load_dwordx4 v[176:179], v7, s[4:7], s60 offen offset:3072 sc1
s_waitcnt vmcnt(0)
v_max3_u32 v92, v172, v173, v174
v_max3_u32 v93, v175, v176, v177
v_max3_u32 v92, v92, v178, v179
v_max_u32 v92, v92, v93
v_cmp_eq_u32 vcc, -1, v92
s_add_u32 s97, s97, 1
s_cmp_gt_u32 s97, 65536
s_cbranch_scc1 L_o9_ok
s_cbranch_vccnz L_o9_retry
s_branch L_o9_ok
L_st_slow:
buffer_store_dword v44, v0, s[4:7], s57 offen sc1
s_branch L_st_j
L_svc:
s_sub_u32 s44, s2, 224
v_lshlrev_b32 v28, 3, v0
s_waitcnt lgkmcnt(0)
s_mov_b32 s16, s22
s_mov_b32 s17, s23
s_mov_b32 s22, 1280
s_mov_b32 s23, 0x20000
buffer_load_dwordx2 v[40:41], v28, s[20:23], 0 offen
buffer_load_dword v42, v29, s[4:7], 0 offen sc1
s_load_dwordx2 s[8:9], s[0:1], 40
s_load_dwordx2 s[12:13], s[0:1], 48
s_load_dwordx2 s[36:37], s[0:1], 56
s_load_dwordx2 s[24:25], s[0:1], 16
s_load_dwordx2 s[28:29], s[0:1], 32
s_load_dwordx2 s[32:33], s[0:1], 80
s_mov_b32 s18, 4915200
s_mov_b32 s19, 0x20000
s_mov_b32 s26, 819200
s_mov_b32 s27, 0x20000
s_mov_b32 s30, 1280
s_mov_b32 s31, 0x20000
s_mov_b32 s34, 2621440
s_mov_b32 s35, 0x20000
s_mov_b32 s10, 2211840
s_mov_b32 s11, 0x20000
s_mov_b32 s14, 2211840
s_mov_b32 s15, 0x20000
s_mov_b32 s38, 2211840
s_mov_b32 s39, 0x20000
v_bfe_u32 v32, v1, 2, 2
v_lshrrev_b32 v33, 1, v32
v_and_b32 v34, 1, v3
v_lshl_or_b32 v33, v34, 1, v33
v_xor_b32 v33, s3, v33
v_and_b32 v34, 3, v1
v_lshlrev_b32 v34, 3, v34
v_lshl_add_u32 v33, v33, 5, v34
v_lshl_add_u32 v32, v3, 3, v32
v_lshl_add_u32 v6, v32, 7, v33
s_mov_b32 s97, 0
s_mov_b32 s98, 0x0c0c0400
s_mov_b32 s99, 0x04000c0c
v_add_u32 v7, 40960, v6
v_add_u32 v9, 81920, v6
v_add_u32 v10, 81920+40960, v6
s_mul_i32 s55, s3, 320
s_add_u32 s55, s55, 81920
v_mul_u32_u24 v32, 1280, v32
v_add3_u32 v11, v32, v34, s55
s_and_b32 s55, s3, 1
s_lshl_b32 s55, s55, 2
v_and_b32 v30, 1, v3
v_lshl_or_b32 v30, v30, 1, s55
v_and_b32 v31, 7, v1
v_xor_b32 v31, v30, v31
v_lshlrev_b32 v31, 4, v31
v_lshrrev_b32 v30, 3, v1
v_mad_u32_u24 v4, v30, 60, 0
v_lshl_add_u32 v4, v4, 7, v31
v_mad_u32_u24 v5, v30, 27, 0
v_lshl_add_u32 v5, v5, 7, v31
v_lshlrev_b32 v8, 4, v1
v_lshlrev_b32 v12, 2, v1
v_mov_b32 v255, 1073741824
s_lshr_b32 s101, s42, 2
s_xor_b32 s101, s101, 0
s_mul_i32 s101, s101, 8192
s_add_u32 s100, s101, 7733248
s_waitcnt lgkmcnt(0)
s_cmp_ge_u32 s44, 27
s_cbranch_scc1 L_fz
s_lshl_b32 s55, s44, 2
s_add_u32 s55, s55, s3
s_mul_i32 s55, s55, 7680
v_lshlrev_b32 v33, 7, v1
s_mov_b32 exec_hi, 0xfffffff
buffer_load_dword v184, v33, s[24:27], s55 offen
s_mov_b32 exec_hi, -1
s_lshl_b32 s50, s44, 7
s_mul_i32 s55, s3, 61440
s_add_u32 s50, s50, s55
s_add_u32 s50, s50, 2560
s_add_u32 m0, s49, 0
s_nop 0
buffer_load_dwordx4 v4, s[16:19], s50 offen nt lds
s_add_u32 m0, m0, 4096
s_add_u32 s50, s50, 245760
buffer_load_dwordx4 v4, s[16:19], s50 offen nt lds
s_add_u32 m0, m0, 4096
s_add_u32 s50, s50, 245760
buffer_load_dwordx4 v4, s[16:19], s50 offen nt lds
s_add_u32 m0, m0, 4096
s_add_u32 s50, s50, 245760
buffer_load_dwordx4 v4, s[16:19], s50 offen nt lds
s_add_u32 m0, m0, 4096
s_add_u32 s50, s50, 245760
buffer_load_dwordx4 v4, s[16:19], s50 offen nt lds
s_add_u32 m0, m0, 4096
s_add_u32 s50, s50, 245760
buffer_load_dwordx4 v4, s[16:19], s50 offen nt lds
s_add_u32 m0, m0, 4096
s_add_u32 s50, s50, 245760
buffer_load_dwordx4 v4, s[16:19], s50 offen nt lds
s_add_u32 m0, m0, 4096
s_add_u32 s50, s50, 245760
buffer_load_dwordx4 v4, s[16:19], s50 offen nt lds
s_add_u32 m0, m0, 4096
s_add_u32 s50, s50, 245760
buffer_load_dwordx4 v4, s[16:19], s50 offen nt lds
s_add_u32 m0, m0, 4096
s_add_u32 s50, s50, 245760
buffer_load_dwordx4 v4, s[16:19], s50 offen nt lds
s_add_u32 m0, m0, 4096
s_add_u32 s50, s50, 245760
buffer_load_dwordx4 v4, s[16:19], s50 offen nt lds
s_add_u32 m0, m0, 4096
s_add_u32 s50, s50, 245760
buffer_load_dwordx4 v4, s[16:19], s50 offen nt lds
s_add_u32 m0, m0, 4096
s_add_u32 s50, s50, 245760
buffer_load_dwordx4 v4, s[16:19], s50 offen nt lds
s_add_u32 m0, m0, 4096
s_add_u32 s50, s50, 245760
buffer_load_dwordx4 v4, s[16:19], s50 offen nt lds
s_add_u32 m0, m0, 4096
s_add_u32 s50, s50, 245760
buffer_load_dwordx4 v4, s[16:19], s50 offen nt lds
s_add_u32 m0, m0, 4096
s_add_u32 s50, s50, 245760
buffer_load_dwordx4 v4, s[16:19], s50 offen nt lds
s_add_u32 m0, m0, 4096
s_add_u32 s50, s50, 245760
buffer_load_dwordx4 v4, s[16:19], s50 offen nt lds
s_add_u32 m0, m0, 4096
s_add_u32 s50, s50, 245760
buffer_load_dwordx4 v4, s[16:19], s50 offen nt lds
s_add_u32 m0, m0, 4096
s_add_u32 s50, s50, 245760
buffer_load_dwordx4 v4, s[16:19], s50 offen nt lds
s_add_u32 m0, m0, 4096
s_add_u32 s50, s50, 245760
buffer_load_dwordx4 v4, s[16:19], s50 offen nt lds
s_waitcnt vmcnt(21)
v_readfirstlane_b32 s41, v42
v_lshlrev_b32 v44, 16, v40
v_and_b32 v45, 0xffff0000, v40
v_lshlrev_b32 v46, 16, v41
v_and_b32 v47, 0xffff0000, v41
v_mul_f32 v48, 0xbfb8aa3b, v44
v_mul_f32 v49, 0xbfb8aa3b, v45
v_mul_f32 v50, 0xbfb8aa3b, v46
v_mul_f32 v51, 0xbfb8aa3b, v47
v_exp_f32 v48, v48
v_exp_f32 v49, v49
v_exp_f32 v50, v50
v_exp_f32 v51, v51
v_add_f32 v48, 1.0, v48
v_add_f32 v49, 1.0, v49
v_add_f32 v50, 1.0, v50
v_add_f32 v51, 1.0, v51
v_rcp_f32 v48, v48
v_rcp_f32 v49, v49
v_rcp_f32 v50, v50
v_rcp_f32 v51, v51
v_mul_f32 v44, v44, v48
v_mul_f32 v45, v45, v49
v_mul_f32 v46, v46, v50
v_mul_f32 v47, v47, v51
v_cvt_pk_bf16_f32 v40, v44, v45
v_cvt_pk_bf16_f32 v41, v46, v47
v_add_u32 v28, 99840, v28
ds_write_b64 v28, v[40:41]
v_lshlrev_b32 v28, 4, v3
v_add_u32 v28, 99840, v28
s_mul_i32 s40, s41, 0x9E3779B1
s_add_u32 s40, s40, 0x85EBCA6B
v_and_b32 v33, 3, v1
v_lshlrev_b32 v33, 3, v33
v_lshrrev_b32 v19, v33, s40
v_and_b32 v19, 0xff, v19
v_mov_b32 v240, s40
v_mov_b32 v241, s19
v_mov_b32 v242, s40
v_mov_b32 v243, s40
v_and_b32 v30, 1, v1
v_lshlrev_b32 v30, 4, v30
v_lshrrev_b32 v13, v30, s40
v_and_b32 v13, 0xffff, v13
s_waitcnt lgkmcnt(0)
s_barrier
ds_read_b128 v[100:103], v28 offset:0
ds_read_b128 v[104:107], v28 offset:64
ds_read_b128 v[108:111], v28 offset:128
ds_read_b128 v[112:115], v28 offset:192
ds_read_b128 v[116:119], v28 offset:256
ds_read_b128 v[120:123], v28 offset:320
ds_read_b128 v[124:127], v28 offset:384
ds_read_b128 v[128:131], v28 offset:448
ds_read_b128 v[132:135], v28 offset:512
ds_read_b128 v[136:139], v28 offset:576
ds_read_b128 v[140:143], v28 offset:640
ds_read_b128 v[144:147], v28 offset:704
ds_read_b128 v[148:151], v28 offset:768
ds_read_b128 v[152:155], v28 offset:832
ds_read_b128 v[156:159], v28 offset:896
ds_read_b128 v[160:163], v28 offset:960
ds_read_b128 v[164:167], v28 offset:1024
ds_read_b128 v[168:171], v28 offset:1088
ds_read_b128 v[172:175], v28 offset:1152
ds_read_b128 v[176:179], v28 offset:1216
s_waitcnt lgkmcnt(0)
s_barrier
s_lshl_b32 s60, s44, 10
s_andn2_b32 s61, s60, 0x1fff
s_add_u32 s60, s60, s61
s_add_u32 s60, s60, 8126464
s_add_u32 s61, s60, 8192
v_cmp_gt_u32 vcc, 64, v0
s_nop 1
v_cndmask_b32 v30, v255, v8, vcc
buffer_store_dwordx4 v[240:243], v30, s[4:7], s60 offen sc1
buffer_store_dwordx4 v[240:243], v30, s[4:7], s61 offen sc1
s_lshl_b32 s51, s44, 7
s_mul_i32 s55, s3, 27648
s_add_u32 s51, s51, s55
s_mov_b32 s52, s51
s_add_u32 m0, s49, 81920
s_nop 0
buffer_load_dwordx4 v5, s[8:11], s51 offen nt lds
s_add_u32 m0, m0, 4096
s_add_u32 s51, s51, 110592
buffer_load_dwordx4 v5, s[8:11], s51 offen nt lds
s_add_u32 m0, m0, 4096
s_add_u32 s51, s51, 110592
buffer_load_dwordx4 v5, s[8:11], s51 offen nt lds
s_add_u32 m0, m0, 4096
s_add_u32 s51, s51, 110592
buffer_load_dwordx4 v5, s[8:11], s51 offen nt lds
s_add_u32 m0, m0, 4096
s_add_u32 s51, s51, 110592
buffer_load_dwordx4 v5, s[8:11], s51 offen nt lds
s_add_u32 m0, m0, 4096
s_add_u32 s51, s51, 110592
buffer_load_dwordx4 v5, s[8:11], s51 offen nt lds
s_add_u32 m0, m0, 4096
s_add_u32 s51, s51, 110592
buffer_load_dwordx4 v5, s[8:11], s51 offen nt lds
s_add_u32 m0, m0, 4096
s_add_u32 s51, s51, 110592
buffer_load_dwordx4 v5, s[8:11], s51 offen nt lds
s_add_u32 m0, m0, 4096
s_add_u32 s51, s51, 110592
buffer_load_dwordx4 v5, s[8:11], s51 offen nt lds
s_add_u32 m0, m0, 4096
s_add_u32 s51, s51, 110592
buffer_load_dwordx4 v5, s[8:11], s51 offen nt lds
s_add_u32 m0, m0, 4096
s_add_u32 s51, s51, 110592
buffer_load_dwordx4 v5, s[8:11], s51 offen nt lds
s_add_u32 m0, m0, 4096
s_add_u32 s51, s51, 110592
buffer_load_dwordx4 v5, s[8:11], s51 offen nt lds
s_add_u32 m0, m0, 4096
s_add_u32 s51, s51, 110592
buffer_load_dwordx4 v5, s[8:11], s51 offen nt lds
s_add_u32 m0, m0, 4096
s_add_u32 s51, s51, 110592
buffer_load_dwordx4 v5, s[8:11], s51 offen nt lds
s_add_u32 m0, m0, 4096
s_add_u32 s51, s51, 110592
buffer_load_dwordx4 v5, s[8:11], s51 offen nt lds
s_add_u32 m0, m0, 4096
s_add_u32 s51, s51, 110592
buffer_load_dwordx4 v5, s[8:11], s51 offen nt lds
s_add_u32 m0, m0, 4096
s_add_u32 s51, s51, 110592
buffer_load_dwordx4 v5, s[8:11], s51 offen nt lds
s_add_u32 m0, m0, 4096
s_add_u32 s51, s51, 110592
buffer_load_dwordx4 v5, s[8:11], s51 offen nt lds
s_add_u32 m0, m0, 4096
s_add_u32 s51, s51, 110592
buffer_load_dwordx4 v5, s[8:11], s51 offen nt lds
s_add_u32 m0, m0, 4096
s_add_u32 s51, s51, 110592
buffer_load_dwordx4 v5, s[8:11], s51 offen nt lds
s_waitcnt vmcnt(22)
s_barrier
ds_read_b64_tr_b16 v[20:21], v6 offset:0
ds_read_b64_tr_b16 v[22:23], v6 offset:512
ds_read_b64_tr_b16 v[24:25], v6 offset:4096
ds_read_b64_tr_b16 v[26:27], v6 offset:4608
ds_read_b64_tr_b16 v[28:29], v6 offset:8192
ds_read_b64_tr_b16 v[30:31], v6 offset:8704
ds_read_b64_tr_b16 v[32:33], v6 offset:12288
ds_read_b64_tr_b16 v[34:35], v6 offset:12800
ds_read_b64_tr_b16 v[36:37], v6 offset:16384
ds_read_b64_tr_b16 v[38:39], v6 offset:16896
ds_read_b64_tr_b16 v[40:41], v6 offset:20480
ds_read_b64_tr_b16 v[42:43], v6 offset:20992
ds_read_b64_tr_b16 v[44:45], v6 offset:24576
ds_read_b64_tr_b16 v[46:47], v6 offset:25088
ds_read_b64_tr_b16 v[48:49], v6 offset:28672
ds_read_b64_tr_b16 v[50:51], v6 offset:29184
ds_read_b64_tr_b16 v[52:53], v6 offset:32768
ds_read_b64_tr_b16 v[54:55], v6 offset:33280
ds_read_b64_tr_b16 v[56:57], v6 offset:36864
ds_read_b64_tr_b16 v[58:59], v6 offset:37376
ds_read_b64_tr_b16 v[60:61], v7 offset:0
ds_read_b64_tr_b16 v[62:63], v7 offset:512
ds_read_b64_tr_b16 v[64:65], v7 offset:4096
ds_read_b64_tr_b16 v[66:67], v7 offset:4608
ds_read_b64_tr_b16 v[68:69], v7 offset:8192
ds_read_b64_tr_b16 v[70:71], v7 offset:8704
ds_read_b64_tr_b16 v[72:73], v7 offset:12288
ds_read_b64_tr_b16 v[74:75], v7 offset:12800
ds_read_b64_tr_b16 v[76:77], v7 offset:16384
ds_read_b64_tr_b16 v[78:79], v7 offset:16896
ds_read_b64_tr_b16 v[80:81], v7 offset:20480
ds_read_b64_tr_b16 v[82:83], v7 offset:20992
ds_read_b64_tr_b16 v[84:85], v7 offset:24576
ds_read_b64_tr_b16 v[86:87], v7 offset:25088
ds_read_b64_tr_b16 v[88:89], v7 offset:28672
ds_read_b64_tr_b16 v[90:91], v7 offset:29184
ds_read_b64_tr_b16 v[92:93], v7 offset:32768
ds_read_b64_tr_b16 v[94:95], v7 offset:33280
ds_read_b64_tr_b16 v[96:97], v7 offset:36864
ds_read_b64_tr_b16 v[98:99], v7 offset:37376
s_waitcnt lgkmcnt(0)
s_barrier
v_mfma_f32_16x16x32_bf16 v[180:183], v[100:103], v[20:23], 0
v_mfma_f32_16x16x32_bf16 v[180:183], v[104:107], v[24:27], v[180:183]
v_mfma_f32_16x16x32_bf16 v[180:183], v[108:111], v[28:31], v[180:183]
v_mfma_f32_16x16x32_bf16 v[180:183], v[112:115], v[32:35], v[180:183]
v_mfma_f32_16x16x32_bf16 v[180:183], v[116:119], v[36:39], v[180:183]
v_mfma_f32_16x16x32_bf16 v[180:183], v[120:123], v[40:43], v[180:183]
v_mfma_f32_16x16x32_bf16 v[180:183], v[124:127], v[44:47], v[180:183]
v_mfma_f32_16x16x32_bf16 v[180:183], v[128:131], v[48:51], v[180:183]
v_mfma_f32_16x16x32_bf16 v[180:183], v[132:135], v[52:55], v[180:183]
v_mfma_f32_16x16x32_bf16 v[180:183], v[136:139], v[56:59], v[180:183]
v_mfma_f32_16x16x32_bf16 v[180:183], v[140:143], v[60:63], v[180:183]
v_mfma_f32_16x16x32_bf16 v[180:183], v[144:147], v[64:67], v[180:183]
v_mfma_f32_16x16x32_bf16 v[180:183], v[148:151], v[68:71], v[180:183]
v_mfma_f32_16x16x32_bf16 v[180:183], v[152:155], v[72:75], v[180:183]
v_mfma_f32_16x16x32_bf16 v[180:183], v[156:159], v[76:79], v[180:183]
v_mfma_f32_16x16x32_bf16 v[180:183], v[160:163], v[80:83], v[180:183]
v_mfma_f32_16x16x32_bf16 v[180:183], v[164:167], v[84:87], v[180:183]
v_mfma_f32_16x16x32_bf16 v[180:183], v[168:171], v[88:91], v[180:183]
v_mfma_f32_16x16x32_bf16 v[180:183], v[172:175], v[92:95], v[180:183]
v_mfma_f32_16x16x32_bf16 v[180:183], v[176:179], v[96:99], v[180:183]
s_sub_u32 s55, s44, 20
s_cmp_lt_u32 s55, 10
s_cselect_b32 s55, 1.0, 0
s_lshl_b32 s56, s44, 8
s_lshl_b32 s57, s3, 6
s_add_u32 s56, s56, s57
s_add_u32 s56, s56, 65536
s_nop 0
v_cvt_pk_bf16_f32 v180, v180, v180
v_lshlrev_b32 v180, 16, v180
v_add_f32 v180, s55, v180
v_cvt_pk_bf16_f32 v180, v180, v180
v_lshl_or_b32 v180, v180, 16, v13
s_mov_b64 exec, 0xffff
buffer_store_dword v180, v12, s[4:7], s56 offen sc1
s_mov_b64 exec, -1
s_add_u32 m0, s49, 0
s_nop 0
buffer_load_dwordx4 v5, s[12:15], s52 offen nt lds
s_add_u32 m0, m0, 4096
s_add_u32 s52, s52, 110592
buffer_load_dwordx4 v5, s[12:15], s52 offen nt lds
s_add_u32 m0, m0, 4096
s_add_u32 s52, s52, 110592
buffer_load_dwordx4 v5, s[12:15], s52 offen nt lds
s_add_u32 m0, m0, 4096
s_add_u32 s52, s52, 110592
buffer_load_dwordx4 v5, s[12:15], s52 offen nt lds
s_add_u32 m0, m0, 4096
s_add_u32 s52, s52, 110592
buffer_load_dwordx4 v5, s[12:15], s52 offen nt lds
s_add_u32 m0, m0, 4096
s_add_u32 s52, s52, 110592
buffer_load_dwordx4 v5, s[12:15], s52 offen nt lds
s_add_u32 m0, m0, 4096
s_add_u32 s52, s52, 110592
buffer_load_dwordx4 v5, s[12:15], s52 offen nt lds
s_add_u32 m0, m0, 4096
s_add_u32 s52, s52, 110592
buffer_load_dwordx4 v5, s[12:15], s52 offen nt lds
s_add_u32 m0, m0, 4096
s_add_u32 s52, s52, 110592
buffer_load_dwordx4 v5, s[12:15], s52 offen nt lds
s_add_u32 m0, m0, 4096
s_add_u32 s52, s52, 110592
buffer_load_dwordx4 v5, s[12:15], s52 offen nt lds
s_add_u32 m0, m0, 4096
s_add_u32 s52, s52, 110592
buffer_load_dwordx4 v5, s[12:15], s52 offen nt lds
s_add_u32 m0, m0, 4096
s_add_u32 s52, s52, 110592
buffer_load_dwordx4 v5, s[12:15], s52 offen nt lds
s_add_u32 m0, m0, 4096
s_add_u32 s52, s52, 110592
buffer_load_dwordx4 v5, s[12:15], s52 offen nt lds
s_add_u32 m0, m0, 4096
s_add_u32 s52, s52, 110592
buffer_load_dwordx4 v5, s[12:15], s52 offen nt lds
s_add_u32 m0, m0, 4096
s_add_u32 s52, s52, 110592
buffer_load_dwordx4 v5, s[12:15], s52 offen nt lds
s_add_u32 m0, m0, 4096
s_add_u32 s52, s52, 110592
buffer_load_dwordx4 v5, s[12:15], s52 offen nt lds
s_add_u32 m0, m0, 4096
s_add_u32 s52, s52, 110592
buffer_load_dwordx4 v5, s[12:15], s52 offen nt lds
s_add_u32 m0, m0, 4096
s_add_u32 s52, s52, 110592
buffer_load_dwordx4 v5, s[12:15], s52 offen nt lds
s_add_u32 m0, m0, 4096
s_add_u32 s52, s52, 110592
buffer_load_dwordx4 v5, s[12:15], s52 offen nt lds
s_add_u32 m0, m0, 4096
s_add_u32 s52, s52, 110592
buffer_load_dwordx4 v5, s[12:15], s52 offen nt lds
s_waitcnt vmcnt(21)
s_barrier
ds_read_b64_tr_b16 a[0:1], v9 offset:0
ds_read_b64_tr_b16 a[2:3], v9 offset:512
ds_read_b64_tr_b16 a[4:5], v9 offset:4096
ds_read_b64_tr_b16 a[6:7], v9 offset:4608
ds_read_b64_tr_b16 a[8:9], v9 offset:8192
ds_read_b64_tr_b16 a[10:11], v9 offset:8704
ds_read_b64_tr_b16 a[12:13], v9 offset:12288
ds_read_b64_tr_b16 a[14:15], v9 offset:12800
ds_read_b64_tr_b16 a[16:17], v9 offset:16384
ds_read_b64_tr_b16 a[18:19], v9 offset:16896
ds_read_b64_tr_b16 a[20:21], v9 offset:20480
ds_read_b64_tr_b16 a[22:23], v9 offset:20992
ds_read_b64_tr_b16 a[24:25], v9 offset:24576
ds_read_b64_tr_b16 a[26:27], v9 offset:25088
ds_read_b64_tr_b16 a[28:29], v9 offset:28672
ds_read_b64_tr_b16 a[30:31], v9 offset:29184
ds_read_b64_tr_b16 a[32:33], v9 offset:32768
ds_read_b64_tr_b16 a[34:35], v9 offset:33280
ds_read_b64_tr_b16 a[36:37], v9 offset:36864
ds_read_b64_tr_b16 a[38:39], v9 offset:37376
ds_read_b64_tr_b16 a[40:41], v10 offset:0
ds_read_b64_tr_b16 a[42:43], v10 offset:512
ds_read_b64_tr_b16 a[44:45], v10 offset:4096
ds_read_b64_tr_b16 a[46:47], v10 offset:4608
ds_read_b64_tr_b16 a[48:49], v10 offset:8192
ds_read_b64_tr_b16 a[50:51], v10 offset:8704
ds_read_b64_tr_b16 a[52:53], v10 offset:12288
ds_read_b64_tr_b16 a[54:55], v10 offset:12800
ds_read_b64_tr_b16 a[56:57], v10 offset:16384
ds_read_b64_tr_b16 a[58:59], v10 offset:16896
ds_read_b64_tr_b16 a[60:61], v10 offset:20480
ds_read_b64_tr_b16 a[62:63], v10 offset:20992
ds_read_b64_tr_b16 a[64:65], v10 offset:24576
ds_read_b64_tr_b16 a[66:67], v10 offset:25088
ds_read_b64_tr_b16 a[68:69], v10 offset:28672
ds_read_b64_tr_b16 a[70:71], v10 offset:29184
ds_read_b64_tr_b16 a[72:73], v10 offset:32768
ds_read_b64_tr_b16 a[74:75], v10 offset:33280
ds_read_b64_tr_b16 a[76:77], v10 offset:36864
ds_read_b64_tr_b16 a[78:79], v10 offset:37376
s_waitcnt lgkmcnt(0)
s_barrier
s_mul_i32 s51, s44, 81920
s_add_u32 s51, s51, s49
s_add_u32 m0, s49, 81920
s_nop 0
buffer_load_dwordx4 v8, s[36:39], s51 offen nt lds
s_add_u32 m0, m0, 4096
s_add_u32 s51, s51, 4096
buffer_load_dwordx4 v8, s[36:39], s51 offen nt lds
s_add_u32 m0, m0, 4096
s_add_u32 s51, s51, 4096
buffer_load_dwordx4 v8, s[36:39], s51 offen nt lds
s_add_u32 m0, m0, 4096
s_add_u32 s51, s51, 4096
buffer_load_dwordx4 v8, s[36:39], s51 offen nt lds
s_add_u32 m0, m0, 4096
s_add_u32 s51, s51, 4096
buffer_load_dwordx4 v8, s[36:39], s51 offen nt lds
s_add_u32 m0, m0, 4096
s_add_u32 s51, s51, 4096
buffer_load_dwordx4 v8, s[36:39], s51 offen nt lds
s_add_u32 m0, m0, 4096
s_add_u32 s51, s51, 4096
buffer_load_dwordx4 v8, s[36:39], s51 offen nt lds
s_add_u32 m0, m0, 4096
s_add_u32 s51, s51, 4096
buffer_load_dwordx4 v8, s[36:39], s51 offen nt lds
s_add_u32 m0, m0, 4096
s_add_u32 s51, s51, 4096
buffer_load_dwordx4 v8, s[36:39], s51 offen nt lds
s_add_u32 m0, m0, 4096
s_add_u32 s51, s51, 4096
buffer_load_dwordx4 v8, s[36:39], s51 offen nt lds
s_add_u32 m0, m0, 4096
s_add_u32 s51, s51, 4096
buffer_load_dwordx4 v8, s[36:39], s51 offen nt lds
s_add_u32 m0, m0, 4096
s_add_u32 s51, s51, 4096
buffer_load_dwordx4 v8, s[36:39], s51 offen nt lds
s_add_u32 m0, m0, 4096
s_add_u32 s51, s51, 4096
buffer_load_dwordx4 v8, s[36:39], s51 offen nt lds
s_add_u32 m0, m0, 4096
s_add_u32 s51, s51, 4096
buffer_load_dwordx4 v8, s[36:39], s51 offen nt lds
s_add_u32 m0, m0, 4096
s_add_u32 s51, s51, 4096
buffer_load_dwordx4 v8, s[36:39], s51 offen nt lds
s_add_u32 m0, m0, 4096
s_add_u32 s51, s51, 4096
buffer_load_dwordx4 v8, s[36:39], s51 offen nt lds
s_add_u32 m0, m0, 4096
s_add_u32 s51, s51, 4096
buffer_load_dwordx4 v8, s[36:39], s51 offen nt lds
s_add_u32 m0, m0, 4096
s_add_u32 s51, s51, 4096
buffer_load_dwordx4 v8, s[36:39], s51 offen nt lds
s_add_u32 m0, m0, 4096
s_add_u32 s51, s51, 4096
buffer_load_dwordx4 v8, s[36:39], s51 offen nt lds
s_add_u32 m0, m0, 4096
s_add_u32 s51, s51, 4096
buffer_load_dwordx4 v8, s[36:39], s51 offen nt lds
s_mov_b32 s62, 8
s_cmp_lg_u32 s3, 0
s_cbranch_scc1 L_m_nr
s_not_b32 s59, s40
s_waitcnt lgkmcnt(0)
s_mov_b32 s58, s59
s_buffer_load_dword s99, s[4:7], s61
s_buffer_load_dword s58, s[4:7], s60
s_waitcnt lgkmcnt(1)
s_nop 7
s_cmp_lg_u32 s58, s40
s_addc_u32 s62, s62, 0
s_waitcnt lgkmcnt(0)
s_add_u32 s60, s60, 128
s_add_u32 s61, s61, 128
s_mov_b32 s58, s59
s_buffer_load_dword s99, s[4:7], s60
s_buffer_load_dword s58, s[4:7], s61
s_waitcnt lgkmcnt(1)
s_nop 7
s_cmp_lg_u32 s58, s40
s_subb_u32 s62, s62, 0
s_waitcnt lgkmcnt(0)
s_add_u32 s60, s60, 128
s_add_u32 s61, s61, 128
L_m_nr:
s_waitcnt vmcnt(20)
s_barrier
ds_read_b64_tr_b16 a[80:81], v6 offset:0
ds_read_b64_tr_b16 a[82:83], v6 offset:512
ds_read_b64_tr_b16 a[84:85], v6 offset:4096
ds_read_b64_tr_b16 a[86:87], v6 offset:4608
ds_read_b64_tr_b16 a[88:89], v6 offset:8192
ds_read_b64_tr_b16 a[90:91], v6 offset:8704
ds_read_b64_tr_b16 a[92:93], v6 offset:12288
ds_read_b64_tr_b16 a[94:95], v6 offset:12800
ds_read_b64_tr_b16 a[96:97], v6 offset:16384
ds_read_b64_tr_b16 a[98:99], v6 offset:16896
ds_read_b64_tr_b16 a[100:101], v6 offset:20480
ds_read_b64_tr_b16 a[102:103], v6 offset:20992
ds_read_b64_tr_b16 a[104:105], v6 offset:24576
ds_read_b64_tr_b16 a[106:107], v6 offset:25088
ds_read_b64_tr_b16 a[108:109], v6 offset:28672
ds_read_b64_tr_b16 a[110:111], v6 offset:29184
ds_read_b64_tr_b16 a[112:113], v6 offset:32768
ds_read_b64_tr_b16 a[114:115], v6 offset:33280
ds_read_b64_tr_b16 a[116:117], v6 offset:36864
ds_read_b64_tr_b16 a[118:119], v6 offset:37376
ds_read_b64_tr_b16 a[120:121], v7 offset:0
ds_read_b64_tr_b16 a[122:123], v7 offset:512
ds_read_b64_tr_b16 a[124:125], v7 offset:4096
ds_read_b64_tr_b16 a[126:127], v7 offset:4608
ds_read_b64_tr_b16 a[128:129], v7 offset:8192
ds_read_b64_tr_b16 a[130:131], v7 offset:8704
ds_read_b64_tr_b16 a[132:133], v7 offset:12288
ds_read_b64_tr_b16 a[134:135], v7 offset:12800
ds_read_b64_tr_b16 a[136:137], v7 offset:16384
ds_read_b64_tr_b16 a[138:139], v7 offset:16896
ds_read_b64_tr_b16 a[140:141], v7 offset:20480
ds_read_b64_tr_b16 a[142:143], v7 offset:20992
ds_read_b64_tr_b16 a[144:145], v7 offset:24576
ds_read_b64_tr_b16 a[146:147], v7 offset:25088
ds_read_b64_tr_b16 a[148:149], v7 offset:28672
ds_read_b64_tr_b16 a[150:151], v7 offset:29184
ds_read_b64_tr_b16 a[152:153], v7 offset:32768
ds_read_b64_tr_b16 a[154:155], v7 offset:33280
ds_read_b64_tr_b16 a[156:157], v7 offset:36864
ds_read_b64_tr_b16 a[158:159], v7 offset:37376
s_waitcnt vmcnt(0) lgkmcnt(0)
s_barrier
ds_read_b64_tr_b16 a[160:161], v11 offset:0
ds_read_b64_tr_b16 a[162:163], v11 offset:5120
ds_read_b64_tr_b16 a[164:165], v11 offset:40960
ds_read_b64_tr_b16 a[166:167], v11 offset:46080
ds_read_b64_tr_b16 a[168:169], v11 offset:32
ds_read_b64_tr_b16 a[170:171], v11 offset:5152
ds_read_b64_tr_b16 a[172:173], v11 offset:40992
ds_read_b64_tr_b16 a[174:175], v11 offset:46112
ds_read_b64_tr_b16 a[176:177], v11 offset:64
ds_read_b64_tr_b16 a[178:179], v11 offset:5184
ds_read_b64_tr_b16 a[180:181], v11 offset:41024
ds_read_b64_tr_b16 a[182:183], v11 offset:46144
ds_read_b64_tr_b16 a[184:185], v11 offset:96
ds_read_b64_tr_b16 a[186:187], v11 offset:5216
ds_read_b64_tr_b16 a[188:189], v11 offset:41056
ds_read_b64_tr_b16 a[190:191], v11 offset:46176
ds_read_b64_tr_b16 a[192:193], v11 offset:128
ds_read_b64_tr_b16 a[194:195], v11 offset:5248
ds_read_b64_tr_b16 a[196:197], v11 offset:41088
ds_read_b64_tr_b16 a[198:199], v11 offset:46208
ds_read_b64_tr_b16 a[200:201], v11 offset:160
ds_read_b64_tr_b16 a[202:203], v11 offset:5280
ds_read_b64_tr_b16 a[204:205], v11 offset:41120
ds_read_b64_tr_b16 a[206:207], v11 offset:46240
ds_read_b64_tr_b16 a[208:209], v11 offset:192
ds_read_b64_tr_b16 a[210:211], v11 offset:5312
ds_read_b64_tr_b16 a[212:213], v11 offset:41152
ds_read_b64_tr_b16 a[214:215], v11 offset:46272
ds_read_b64_tr_b16 a[216:217], v11 offset:224
ds_read_b64_tr_b16 a[218:219], v11 offset:5344
ds_read_b64_tr_b16 a[220:221], v11 offset:41184
ds_read_b64_tr_b16 a[222:223], v11 offset:46304
ds_read_b64_tr_b16 a[224:225], v11 offset:256
ds_read_b64_tr_b16 a[226:227], v11 offset:5376
ds_read_b64_tr_b16 a[228:229], v11 offset:41216
ds_read_b64_tr_b16 a[230:231], v11 offset:46336
ds_read_b64_tr_b16 a[232:233], v11 offset:288
ds_read_b64_tr_b16 a[234:235], v11 offset:5408
ds_read_b64_tr_b16 a[236:237], v11 offset:41248
ds_read_b64_tr_b16 a[238:239], v11 offset:46368
s_waitcnt lgkmcnt(0)
v_mov_b32 v20, 0
ds_write_b32 v12, v20 offset:8192
v_mul_u32_u24 v30, 5462, v1
v_lshrrev_b32 v30, 16, v30
v_lshl_add_u32 v14, v30, 6, v8
v_add_u32 v31, 64, v1
v_mul_u32_u24 v30, 5462, v31
v_lshrrev_b32 v30, 16, v30
v_lshlrev_b32 v31, 4, v31
v_lshl_add_u32 v15, v30, 6, v31
v_cmp_gt_u32 vcc, 16, v1
s_lshl_b32 s55, s3, 11
v_add_u32 v16, s55, v8
v_cndmask_b32 v15, v255, v15, vcc
v_lshl_add_u32 v17, v3, 4, s55
s_lshl_b32 s55, s3, 5
v_lshl_add_u32 v18, v2, 1, s55
v_lshrrev_b32 v30, 2, v2
v_lshlrev_b32 v31, 4, v3
v_add_u32 v32, 128, v31
v_cmp_eq_u32 vcc, 0, v30
s_nop 1
v_cndmask_b32 v232, v32, v31, vcc
v_cmp_eq_u32 vcc, 1, v30
s_nop 1
v_cndmask_b32 v233, v32, v31, vcc
v_cmp_eq_u32 vcc, 2, v30
s_nop 1
v_cndmask_b32 v234, v32, v31, vcc
v_cmp_eq_u32 vcc, 3, v30
s_nop 1
v_cndmask_b32 v235, v32, v31, vcc
v_lshrrev_b32 v30, 5, v1
v_and_b32 v31, 31, v1
v_lshlrev_b32 v31, 2, v31
v_lshl_add_u32 v236, v30, 12, v31
v_cmp_gt_u32 vcc, 32, v1
s_mul_i32 s46, s3, 20480
s_lshl_b32 s55, s44, 7
s_add_u32 s46, s46, s55
s_add_u32 s46, s46, 7864320
v_cndmask_b32 v237, v255, v236, vcc
s_add_u32 s47, s46, 8192
s_add_u32 s48, s46, 16384
s_mov_b32 s54, 0xffffff00
v_cmp_gt_u32 vcc, 32, v0
s_lshl_b32 s53, s44, 7
s_add_u32 s53, s53, 8060928
v_cndmask_b32 v238, v255, v12, vcc
s_waitcnt lgkmcnt(0)
s_barrier
s_mul_i32 s55, s3, 5
v_add_u32 v30, s55, v30
v_lshlrev_b32 v30, 12, v30
v_and_b32 v32, 0xfe000, v30
v_add3_u32 v236, v30, v32, v31
v_cmp_gt_u32 vcc, 32, v1
s_lshl_b32 s46, s44, 7
s_add_u32 s46, s46, 7864320
v_cndmask_b32 v237, v255, v236, vcc
s_add_u32 s47, s46, 16384
s_add_u32 s48, s46, 32768
s_add_u32 s50, s46, 8192
s_add_u32 s51, s47, 8192
s_add_u32 s52, s48, 8192
v_lshrrev_b32 v32, 5, v1
v_cmp_gt_u32 vcc, 64, v0
v_lshl_add_u32 v32, v32, 13, v31
s_nop 0
v_cndmask_b32 v238, v255, v32, vcc
s_lshl_b32 s55, s3, 11
v_and_b32 v30, 1, v1
v_lshrrev_b32 v31, 1, v1
v_lshlrev_b32 v31, 5, v31
v_lshl_add_u32 v31, v30, 3, v31
v_add_u32 v16, s55, v31
v_add_u32 v239, 1024, v16
v_lshlrev_b32 v31, 5, v3
v_lshl_add_u32 v31, v30, 4, v31
v_add_u32 v17, s55, v31
v_mul_u32_u24 v231, 0xaaaa, v30
v_add_u32 v231, 0x4444, v231
v_add_u32 v32, 128, v31
v_lshrrev_b32 v33, 2, v2
v_cmp_eq_u32 vcc, 0, v33
s_nop 1
v_cndmask_b32 v232, v32, v31, vcc
v_cmp_eq_u32 vcc, 1, v33
s_nop 1
v_cndmask_b32 v233, v32, v31, vcc
v_cmp_eq_u32 vcc, 2, v33
s_nop 1
v_cndmask_b32 v234, v32, v31, vcc
v_cmp_eq_u32 vcc, 3, v33
s_nop 1
v_cndmask_b32 v235, v32, v31, vcc
v_lshlrev_b32 v33, 2, v33
v_lshl_add_u32 v33, v30, 1, v33
v_bfe_u32 v30, v1, 1, 1
v_lshl_add_u32 v33, v30, 4, v33
s_lshl_b32 s55, s3, 5
v_add_u32 v18, s55, v33
v_mov_b32 v72, 0
v_mov_b32 v73, 0
v_mov_b32 v74, 0
v_mov_b32 v75, 0
v_mov_b32 v76, 0
v_mov_b32 v77, 0
v_mov_b32 v78, 0
v_mov_b32 v79, 0
v_mov_b32 v80, 0
v_mov_b32 v81, 0
v_mov_b32 v82, 0
v_mov_b32 v83, 0
v_mov_b32 v84, 0
v_mov_b32 v85, 0
v_mov_b32 v86, 0
v_mov_b32 v87, 0
v_mov_b32 v88, 0
v_mov_b32 v89, 0
v_mov_b32 v90, 0
v_mov_b32 v91, 0
v_mov_b32 v30, s62
v_lshlrev_b32 v31, 2, v0
ds_write_b32 v31, v30 offset:16384
v_mov_b32 v31, 0
s_waitcnt lgkmcnt(0)
s_barrier
ds_read_b32 v30, v31 offset:16384
s_waitcnt lgkmcnt(0)
v_readfirstlane_b32 s62, v30
s_cmp_gt_u32 s62, 8
s_cselect_b32 s101, 8192, 0
s_add_u32 s100, s101, 7733248
s_branch L_pg2
.p2align 12
L_pg2:
v_and_b32 v30, 31, v1
v_lshlrev_b32 v30, 11, v30
v_and_b32 v31, 0xe000, v30
v_add_u32 v30, v30, v31
s_and_b32 s55, s42, 3
s_lshl_b32 s55, s55, 9
s_add_u32 s55, s55, s101
s_add_u32 s55, s55, 7602176
s_mov_b32 exec_hi, 0
L_m_p:
buffer_load_dwordx3 v[200:202], v30, s[4:7], s55 offen sc1
s_waitcnt vmcnt(0)
v_cmp_ne_u32 vcc, s40, v202
v_mov_b32 v20, v200
s_cbranch_vccz L_m_ok
s_add_u32 s97, s97, 1
s_cmp_le_u32 s97, 65536
s_cbranch_scc1 L_m_p
L_m_ok:
v_max_f32_dpp v24, v20, v20 row_ror:8 row_mask:0xf bank_mask:0xf
s_nop 1
v_max_f32_dpp v24, v24, v24 row_ror:4 row_mask:0xf bank_mask:0xf
s_nop 1
v_max_f32_dpp v24, v24, v24 row_ror:2 row_mask:0xf bank_mask:0xf
s_nop 1
v_max_f32_dpp v24, v24, v24 row_ror:1 row_mask:0xf bank_mask:0xf
v_mov_b32 v25, v24
s_nop 1
v_permlane16_swap_b32 v24, v25
v_max_f32 v24, v24, v25
v_cmp_eq_f32 vcc, v24, v20
s_mov_b32 exec_hi, -1
s_ff1_i32_b32 s45, vcc_lo
s_and_b32 s45, s45, 31
s_lshl_b32 s55, s45, 11
s_andn2_b32 s56, s55, 0x1fff
s_add_u32 s55, s55, s56
s_add_u32 s55, s55, s100
L_m_rp:
buffer_load_dwordx4 v[20:23], v14, s[4:7], s55 offen sc1
buffer_load_dwordx4 v[24:27], v15, s[4:7], s55 offen sc1
s_waitcnt vmcnt(0)
ds_write2_b32 v16, v20, v22 offset0:0 offset1:1
ds_write2_b32 v16, v21, v23 offset0:4 offset1:5
ds_write2_b32 v239, v24, v26 offset0:0 offset1:1
ds_write2_b32 v239, v25, v27 offset0:4 offset1:5
v_max3_u32 v28, v20, v21, v22
v_max3_u32 v29, v23, v24, v25
v_max3_u32 v28, v28, v26, v27
v_max_u32 v28, v28, v29
v_cmp_eq_u32 vcc, -1, v28
s_add_u32 s97, s97, 1
s_cmp_gt_u32 s97, 65536
s_cbranch_scc1 L_m_rok
s_cbranch_vccnz L_m_rp
L_m_rok:
ds_read_b128 v[100:103], v17 offset:0
ds_read_b128 v[104:107], v17 offset:128
ds_read_b128 v[108:111], v17 offset:256
ds_read_b128 v[112:115], v17 offset:384
ds_read_b128 v[116:119], v17 offset:512
s_waitcnt lgkmcnt(4)
v_smfmac_f32_16x16x64_bf16 v[72:75], v[100:103], a[0:7], v231
ds_read_b128 v[120:123], v17 offset:640
v_smfmac_f32_16x16x64_bf16 v[76:79], v[100:103], a[80:87], v231
s_waitcnt lgkmcnt(4)
v_smfmac_f32_16x16x64_bf16 v[72:75], v[104:107], a[8:15], v231
ds_read_b128 v[124:127], v17 offset:768
v_smfmac_f32_16x16x64_bf16 v[76:79], v[104:107], a[88:95], v231
s_waitcnt lgkmcnt(4)
v_smfmac_f32_16x16x64_bf16 v[72:75], v[108:111], a[16:23], v231
ds_read_b128 v[128:131], v17 offset:896
v_smfmac_f32_16x16x64_bf16 v[76:79], v[108:111], a[96:103], v231
buffer_store_dword v240, v238, s[4:7], s53 offen sc1
s_waitcnt lgkmcnt(4)
v_smfmac_f32_16x16x64_bf16 v[72:75], v[112:115], a[24:31], v231
ds_read_b128 v[132:135], v17 offset:1024
v_smfmac_f32_16x16x64_bf16 v[76:79], v[112:115], a[104:111], v231
s_waitcnt lgkmcnt(4)
v_smfmac_f32_16x16x64_bf16 v[72:75], v[116:119], a[32:39], v231
ds_read_b128 v[136:139], v17 offset:1152
v_smfmac_f32_16x16x64_bf16 v[76:79], v[116:119], a[112:119], v231
s_waitcnt lgkmcnt(4)
v_smfmac_f32_16x16x64_bf16 v[72:75], v[120:123], a[40:47], v231
v_smfmac_f32_16x16x64_bf16 v[76:79], v[120:123], a[120:127], v231
s_waitcnt lgkmcnt(3)
v_smfmac_f32_16x16x64_bf16 v[72:75], v[124:127], a[48:55], v231
v_smfmac_f32_16x16x64_bf16 v[76:79], v[124:127], a[128:135], v231
s_waitcnt lgkmcnt(2)
v_smfmac_f32_16x16x64_bf16 v[72:75], v[128:131], a[56:63], v231
v_smfmac_f32_16x16x64_bf16 v[76:79], v[128:131], a[136:143], v231
s_waitcnt lgkmcnt(1)
v_smfmac_f32_16x16x64_bf16 v[72:75], v[132:135], a[64:71], v231
v_smfmac_f32_16x16x64_bf16 v[76:79], v[132:135], a[144:151], v231
s_waitcnt lgkmcnt(0)
v_smfmac_f32_16x16x64_bf16 v[72:75], v[136:139], a[72:79], v231
v_smfmac_f32_16x16x64_bf16 v[76:79], v[136:139], a[152:159], v231
s_nop 6
v_add_f32 v72, v72, v73
v_mul_f32 v73, 0xbfb8aa3b, v72
v_exp_f32 v73, v73
v_add_f32 v76, v76, v77
v_add_f32 v73, 1.0, v73
v_rcp_f32 v73, v73
v_mul_f32 v72, v72, v76
v_mul_f32 v72, v72, v73
v_cvt_pk_bf16_f32 v72, v72, v72
ds_write_b16 v18, v72 offset:8192
s_waitcnt lgkmcnt(0)
s_barrier
ds_read_b128 v[40:43], v232 offset:8192
ds_read_b128 v[44:47], v233 offset:8192
ds_read_b128 v[48:51], v234 offset:8192
ds_read_b128 v[52:55], v235 offset:8192
s_waitcnt lgkmcnt(3)
v_smfmac_f32_16x16x64_bf16 v[80:83], v[40:43], a[160:167], v231
s_waitcnt lgkmcnt(2)
v_smfmac_f32_16x16x64_bf16 v[80:83], v[44:47], a[168:175], v231
s_waitcnt lgkmcnt(1)
v_smfmac_f32_16x16x64_bf16 v[80:83], v[48:51], a[176:183], v231
s_waitcnt lgkmcnt(0)
v_smfmac_f32_16x16x64_bf16 v[80:83], v[52:55], a[184:191], v231
v_smfmac_f32_16x16x64_bf16 v[84:87], v[40:43], a[192:199], v231
v_smfmac_f32_16x16x64_bf16 v[84:87], v[44:47], a[200:207], v231
v_smfmac_f32_16x16x64_bf16 v[84:87], v[48:51], a[208:215], v231
v_smfmac_f32_16x16x64_bf16 v[84:87], v[52:55], a[216:223], v231
v_smfmac_f32_16x16x64_bf16 v[88:91], v[40:43], a[224:231], v231
v_smfmac_f32_16x16x64_bf16 v[88:91], v[44:47], a[232:239], v231
s_nop 1
v_add_f32 v80, v80, v81
v_and_or_b32 v80, v80, s54, v19
buffer_store_dword v80, v236, s[4:7], s46 offen sc1
buffer_store_dword v80, v236, s[4:7], s50 offen sc1
v_add_f32 v84, v84, v85
v_and_or_b32 v84, v84, s54, v19
buffer_store_dword v84, v236, s[4:7], s47 offen sc1
buffer_store_dword v84, v236, s[4:7], s51 offen sc1
v_add_f32 v88, v88, v89
v_and_or_b32 v88, v88, s54, v19
buffer_store_dword v88, v237, s[4:7], s48 offen sc1
buffer_store_dword v88, v237, s[4:7], s52 offen sc1
s_branch L_fin
L_fz:
s_add_u32 s46, s44, 5
s_add_u32 s47, s44, 10
s_lshl_b32 s50, s44, 7
s_mul_i32 s55, s3, 61440
s_add_u32 s50, s50, s55
s_add_u32 s50, s50, 2560
s_add_u32 m0, s49, 0
s_nop 0
buffer_load_dwordx4 v4, s[16:19], s50 offen nt lds
s_add_u32 m0, m0, 4096
s_add_u32 s50, s50, 245760
buffer_load_dwordx4 v4, s[16:19], s50 offen nt lds
s_add_u32 m0, m0, 4096
s_add_u32 s50, s50, 245760
buffer_load_dwordx4 v4, s[16:19], s50 offen nt lds
s_add_u32 m0, m0, 4096
s_add_u32 s50, s50, 245760
buffer_load_dwordx4 v4, s[16:19], s50 offen nt lds
s_add_u32 m0, m0, 4096
s_add_u32 s50, s50, 245760
buffer_load_dwordx4 v4, s[16:19], s50 offen nt lds
s_add_u32 m0, m0, 4096
s_add_u32 s50, s50, 245760
buffer_load_dwordx4 v4, s[16:19], s50 offen nt lds
s_add_u32 m0, m0, 4096
s_add_u32 s50, s50, 245760
buffer_load_dwordx4 v4, s[16:19], s50 offen nt lds
s_add_u32 m0, m0, 4096
s_add_u32 s50, s50, 245760
buffer_load_dwordx4 v4, s[16:19], s50 offen nt lds
s_add_u32 m0, m0, 4096
s_add_u32 s50, s50, 245760
buffer_load_dwordx4 v4, s[16:19], s50 offen nt lds
s_add_u32 m0, m0, 4096
s_add_u32 s50, s50, 245760
buffer_load_dwordx4 v4, s[16:19], s50 offen nt lds
s_add_u32 m0, m0, 4096
s_add_u32 s50, s50, 245760
buffer_load_dwordx4 v4, s[16:19], s50 offen nt lds
s_add_u32 m0, m0, 4096
s_add_u32 s50, s50, 245760
buffer_load_dwordx4 v4, s[16:19], s50 offen nt lds
s_add_u32 m0, m0, 4096
s_add_u32 s50, s50, 245760
buffer_load_dwordx4 v4, s[16:19], s50 offen nt lds
s_add_u32 m0, m0, 4096
s_add_u32 s50, s50, 245760
buffer_load_dwordx4 v4, s[16:19], s50 offen nt lds
s_add_u32 m0, m0, 4096
s_add_u32 s50, s50, 245760
buffer_load_dwordx4 v4, s[16:19], s50 offen nt lds
s_add_u32 m0, m0, 4096
s_add_u32 s50, s50, 245760
buffer_load_dwordx4 v4, s[16:19], s50 offen nt lds
s_add_u32 m0, m0, 4096
s_add_u32 s50, s50, 245760
buffer_load_dwordx4 v4, s[16:19], s50 offen nt lds
s_add_u32 m0, m0, 4096
s_add_u32 s50, s50, 245760
buffer_load_dwordx4 v4, s[16:19], s50 offen nt lds
s_add_u32 m0, m0, 4096
s_add_u32 s50, s50, 245760
buffer_load_dwordx4 v4, s[16:19], s50 offen nt lds
s_add_u32 m0, m0, 4096
s_add_u32 s50, s50, 245760
buffer_load_dwordx4 v4, s[16:19], s50 offen nt lds
s_waitcnt vmcnt(20)
v_readfirstlane_b32 s41, v42
v_lshlrev_b32 v44, 16, v40
v_and_b32 v45, 0xffff0000, v40
v_lshlrev_b32 v46, 16, v41
v_and_b32 v47, 0xffff0000, v41
v_mul_f32 v48, 0xbfb8aa3b, v44
v_mul_f32 v49, 0xbfb8aa3b, v45
v_mul_f32 v50, 0xbfb8aa3b, v46
v_mul_f32 v51, 0xbfb8aa3b, v47
v_exp_f32 v48, v48
v_exp_f32 v49, v49
v_exp_f32 v50, v50
v_exp_f32 v51, v51
v_add_f32 v48, 1.0, v48
v_add_f32 v49, 1.0, v49
v_add_f32 v50, 1.0, v50
v_add_f32 v51, 1.0, v51
v_rcp_f32 v48, v48
v_rcp_f32 v49, v49
v_rcp_f32 v50, v50
v_rcp_f32 v51, v51
v_mul_f32 v44, v44, v48
v_mul_f32 v45, v45, v49
v_mul_f32 v46, v46, v50
v_mul_f32 v47, v47, v51
v_cvt_pk_bf16_f32 v40, v44, v45
v_cvt_pk_bf16_f32 v41, v46, v47
v_add_u32 v28, 99840, v28
ds_write_b64 v28, v[40:41]
v_lshlrev_b32 v28, 4, v3
v_add_u32 v28, 99840, v28
s_mul_i32 s40, s41, 0x9E3779B1
s_add_u32 s40, s40, 0x85EBCA6B
v_and_b32 v33, 3, v1
v_lshlrev_b32 v33, 3, v33
v_lshrrev_b32 v19, v33, s40
v_and_b32 v19, 0xff, v19
v_mov_b32 v240, s40
v_mov_b32 v241, s19
v_mov_b32 v242, s40
v_mov_b32 v243, s40
v_and_b32 v30, 1, v1
v_lshlrev_b32 v30, 4, v30
v_lshrrev_b32 v13, v30, s40
v_and_b32 v13, 0xffff, v13
s_waitcnt lgkmcnt(0)
s_barrier
ds_read_b128 v[100:103], v28 offset:0
ds_read_b128 v[104:107], v28 offset:64
ds_read_b128 v[108:111], v28 offset:128
ds_read_b128 v[112:115], v28 offset:192
ds_read_b128 v[116:119], v28 offset:256
ds_read_b128 v[120:123], v28 offset:320
ds_read_b128 v[124:127], v28 offset:384
ds_read_b128 v[128:131], v28 offset:448
ds_read_b128 v[132:135], v28 offset:512
ds_read_b128 v[136:139], v28 offset:576
ds_read_b128 v[140:143], v28 offset:640
ds_read_b128 v[144:147], v28 offset:704
ds_read_b128 v[148:151], v28 offset:768
ds_read_b128 v[152:155], v28 offset:832
ds_read_b128 v[156:159], v28 offset:896
ds_read_b128 v[160:163], v28 offset:960
ds_read_b128 v[164:167], v28 offset:1024
ds_read_b128 v[168:171], v28 offset:1088
ds_read_b128 v[172:175], v28 offset:1152
ds_read_b128 v[176:179], v28 offset:1216
s_waitcnt lgkmcnt(0)
s_barrier
s_lshl_b32 s60, s44, 10
s_andn2_b32 s61, s60, 0x1fff
s_add_u32 s60, s60, s61
s_add_u32 s60, s60, 8126464
s_add_u32 s61, s60, 8192
v_cmp_gt_u32 vcc, 64, v0
s_nop 1
v_cndmask_b32 v30, v255, v8, vcc
buffer_store_dwordx4 v[240:243], v30, s[4:7], s60 offen sc1
buffer_store_dwordx4 v[240:243], v30, s[4:7], s61 offen sc1
s_lshl_b32 s50, s46, 7
s_mul_i32 s55, s3, 61440
s_add_u32 s50, s50, s55
s_add_u32 s50, s50, 2560
s_add_u32 m0, s49, 81920
s_nop 0
buffer_load_dwordx4 v4, s[16:19], s50 offen nt lds
s_add_u32 m0, m0, 4096
s_add_u32 s50, s50, 245760
buffer_load_dwordx4 v4, s[16:19], s50 offen nt lds
s_add_u32 m0, m0, 4096
s_add_u32 s50, s50, 245760
buffer_load_dwordx4 v4, s[16:19], s50 offen nt lds
s_add_u32 m0, m0, 4096
s_add_u32 s50, s50, 245760
buffer_load_dwordx4 v4, s[16:19], s50 offen nt lds
s_add_u32 m0, m0, 4096
s_add_u32 s50, s50, 245760
buffer_load_dwordx4 v4, s[16:19], s50 offen nt lds
s_add_u32 m0, m0, 4096
s_add_u32 s50, s50, 245760
buffer_load_dwordx4 v4, s[16:19], s50 offen nt lds
s_add_u32 m0, m0, 4096
s_add_u32 s50, s50, 245760
buffer_load_dwordx4 v4, s[16:19], s50 offen nt lds
s_add_u32 m0, m0, 4096
s_add_u32 s50, s50, 245760
buffer_load_dwordx4 v4, s[16:19], s50 offen nt lds
s_add_u32 m0, m0, 4096
s_add_u32 s50, s50, 245760
buffer_load_dwordx4 v4, s[16:19], s50 offen nt lds
s_add_u32 m0, m0, 4096
s_add_u32 s50, s50, 245760
buffer_load_dwordx4 v4, s[16:19], s50 offen nt lds
s_add_u32 m0, m0, 4096
s_add_u32 s50, s50, 245760
buffer_load_dwordx4 v4, s[16:19], s50 offen nt lds
s_add_u32 m0, m0, 4096
s_add_u32 s50, s50, 245760
buffer_load_dwordx4 v4, s[16:19], s50 offen nt lds
s_add_u32 m0, m0, 4096
s_add_u32 s50, s50, 245760
buffer_load_dwordx4 v4, s[16:19], s50 offen nt lds
s_add_u32 m0, m0, 4096
s_add_u32 s50, s50, 245760
buffer_load_dwordx4 v4, s[16:19], s50 offen nt lds
s_add_u32 m0, m0, 4096
s_add_u32 s50, s50, 245760
buffer_load_dwordx4 v4, s[16:19], s50 offen nt lds
s_add_u32 m0, m0, 4096
s_add_u32 s50, s50, 245760
buffer_load_dwordx4 v4, s[16:19], s50 offen nt lds
s_add_u32 m0, m0, 4096
s_add_u32 s50, s50, 245760
buffer_load_dwordx4 v4, s[16:19], s50 offen nt lds
s_add_u32 m0, m0, 4096
s_add_u32 s50, s50, 245760
buffer_load_dwordx4 v4, s[16:19], s50 offen nt lds
s_add_u32 m0, m0, 4096
s_add_u32 s50, s50, 245760
buffer_load_dwordx4 v4, s[16:19], s50 offen nt lds
s_add_u32 m0, m0, 4096
s_add_u32 s50, s50, 245760
buffer_load_dwordx4 v4, s[16:19], s50 offen nt lds
s_waitcnt vmcnt(22)
s_barrier
ds_read_b64_tr_b16 v[20:21], v6 offset:0
ds_read_b64_tr_b16 v[22:23], v6 offset:512
ds_read_b64_tr_b16 v[24:25], v6 offset:4096
ds_read_b64_tr_b16 v[26:27], v6 offset:4608
ds_read_b64_tr_b16 v[28:29], v6 offset:8192
ds_read_b64_tr_b16 v[30:31], v6 offset:8704
ds_read_b64_tr_b16 v[32:33], v6 offset:12288
ds_read_b64_tr_b16 v[34:35], v6 offset:12800
ds_read_b64_tr_b16 v[36:37], v6 offset:16384
ds_read_b64_tr_b16 v[38:39], v6 offset:16896
ds_read_b64_tr_b16 v[40:41], v6 offset:20480
ds_read_b64_tr_b16 v[42:43], v6 offset:20992
ds_read_b64_tr_b16 v[44:45], v6 offset:24576
ds_read_b64_tr_b16 v[46:47], v6 offset:25088
ds_read_b64_tr_b16 v[48:49], v6 offset:28672
ds_read_b64_tr_b16 v[50:51], v6 offset:29184
ds_read_b64_tr_b16 v[52:53], v6 offset:32768
ds_read_b64_tr_b16 v[54:55], v6 offset:33280
ds_read_b64_tr_b16 v[56:57], v6 offset:36864
ds_read_b64_tr_b16 v[58:59], v6 offset:37376
ds_read_b64_tr_b16 v[60:61], v7 offset:0
ds_read_b64_tr_b16 v[62:63], v7 offset:512
ds_read_b64_tr_b16 v[64:65], v7 offset:4096
ds_read_b64_tr_b16 v[66:67], v7 offset:4608
ds_read_b64_tr_b16 v[68:69], v7 offset:8192
ds_read_b64_tr_b16 v[70:71], v7 offset:8704
ds_read_b64_tr_b16 v[72:73], v7 offset:12288
ds_read_b64_tr_b16 v[74:75], v7 offset:12800
ds_read_b64_tr_b16 v[76:77], v7 offset:16384
ds_read_b64_tr_b16 v[78:79], v7 offset:16896
ds_read_b64_tr_b16 v[80:81], v7 offset:20480
ds_read_b64_tr_b16 v[82:83], v7 offset:20992
ds_read_b64_tr_b16 v[84:85], v7 offset:24576
ds_read_b64_tr_b16 v[86:87], v7 offset:25088
ds_read_b64_tr_b16 v[88:89], v7 offset:28672
ds_read_b64_tr_b16 v[90:91], v7 offset:29184
ds_read_b64_tr_b16 v[92:93], v7 offset:32768
ds_read_b64_tr_b16 v[94:95], v7 offset:33280
ds_read_b64_tr_b16 v[96:97], v7 offset:36864
ds_read_b64_tr_b16 v[98:99], v7 offset:37376
s_waitcnt lgkmcnt(0)
s_barrier
v_mfma_f32_16x16x32_bf16 v[180:183], v[100:103], v[20:23], 0
v_mfma_f32_16x16x32_bf16 v[180:183], v[104:107], v[24:27], v[180:183]
v_mfma_f32_16x16x32_bf16 v[180:183], v[108:111], v[28:31], v[180:183]
v_mfma_f32_16x16x32_bf16 v[180:183], v[112:115], v[32:35], v[180:183]
v_mfma_f32_16x16x32_bf16 v[180:183], v[116:119], v[36:39], v[180:183]
v_mfma_f32_16x16x32_bf16 v[180:183], v[120:123], v[40:43], v[180:183]
v_mfma_f32_16x16x32_bf16 v[180:183], v[124:127], v[44:47], v[180:183]
v_mfma_f32_16x16x32_bf16 v[180:183], v[128:131], v[48:51], v[180:183]
v_mfma_f32_16x16x32_bf16 v[180:183], v[132:135], v[52:55], v[180:183]
v_mfma_f32_16x16x32_bf16 v[180:183], v[136:139], v[56:59], v[180:183]
v_mfma_f32_16x16x32_bf16 v[180:183], v[140:143], v[60:63], v[180:183]
v_mfma_f32_16x16x32_bf16 v[180:183], v[144:147], v[64:67], v[180:183]
v_mfma_f32_16x16x32_bf16 v[180:183], v[148:151], v[68:71], v[180:183]
v_mfma_f32_16x16x32_bf16 v[180:183], v[152:155], v[72:75], v[180:183]
v_mfma_f32_16x16x32_bf16 v[180:183], v[156:159], v[76:79], v[180:183]
v_mfma_f32_16x16x32_bf16 v[180:183], v[160:163], v[80:83], v[180:183]
v_mfma_f32_16x16x32_bf16 v[180:183], v[164:167], v[84:87], v[180:183]
v_mfma_f32_16x16x32_bf16 v[180:183], v[168:171], v[88:91], v[180:183]
v_mfma_f32_16x16x32_bf16 v[180:183], v[172:175], v[92:95], v[180:183]
v_mfma_f32_16x16x32_bf16 v[180:183], v[176:179], v[96:99], v[180:183]
s_sub_u32 s55, s44, 20
s_cmp_lt_u32 s55, 10
s_cselect_b32 s55, 1.0, 0
s_lshl_b32 s56, s44, 8
s_lshl_b32 s57, s3, 6
s_add_u32 s56, s56, s57
s_add_u32 s56, s56, 65536
s_nop 0
v_cvt_pk_bf16_f32 v180, v180, v180
v_lshlrev_b32 v180, 16, v180
v_add_f32 v180, s55, v180
v_cvt_pk_bf16_f32 v180, v180, v180
v_lshl_or_b32 v180, v180, 16, v13
s_mov_b64 exec, 0xffff
buffer_store_dword v180, v12, s[4:7], s56 offen sc1
s_mov_b64 exec, -1
s_cmp_lt_u32 s47, 40
s_cselect_b32 s18, s18, 0
s_lshl_b32 s50, s47, 7
s_mul_i32 s55, s3, 61440
s_add_u32 s50, s50, s55
s_add_u32 s50, s50, 2560
s_add_u32 m0, s49, 0
s_nop 0
buffer_load_dwordx4 v4, s[16:19], s50 offen nt lds
s_add_u32 m0, m0, 4096
s_add_u32 s50, s50, 245760
buffer_load_dwordx4 v4, s[16:19], s50 offen nt lds
s_add_u32 m0, m0, 4096
s_add_u32 s50, s50, 245760
buffer_load_dwordx4 v4, s[16:19], s50 offen nt lds
s_add_u32 m0, m0, 4096
s_add_u32 s50, s50, 245760
buffer_load_dwordx4 v4, s[16:19], s50 offen nt lds
s_add_u32 m0, m0, 4096
s_add_u32 s50, s50, 245760
buffer_load_dwordx4 v4, s[16:19], s50 offen nt lds
s_add_u32 m0, m0, 4096
s_add_u32 s50, s50, 245760
buffer_load_dwordx4 v4, s[16:19], s50 offen nt lds
s_add_u32 m0, m0, 4096
s_add_u32 s50, s50, 245760
buffer_load_dwordx4 v4, s[16:19], s50 offen nt lds
s_add_u32 m0, m0, 4096
s_add_u32 s50, s50, 245760
buffer_load_dwordx4 v4, s[16:19], s50 offen nt lds
s_add_u32 m0, m0, 4096
s_add_u32 s50, s50, 245760
buffer_load_dwordx4 v4, s[16:19], s50 offen nt lds
s_add_u32 m0, m0, 4096
s_add_u32 s50, s50, 245760
buffer_load_dwordx4 v4, s[16:19], s50 offen nt lds
s_add_u32 m0, m0, 4096
s_add_u32 s50, s50, 245760
buffer_load_dwordx4 v4, s[16:19], s50 offen nt lds
s_add_u32 m0, m0, 4096
s_add_u32 s50, s50, 245760
buffer_load_dwordx4 v4, s[16:19], s50 offen nt lds
s_add_u32 m0, m0, 4096
s_add_u32 s50, s50, 245760
buffer_load_dwordx4 v4, s[16:19], s50 offen nt lds
s_add_u32 m0, m0, 4096
s_add_u32 s50, s50, 245760
buffer_load_dwordx4 v4, s[16:19], s50 offen nt lds
s_add_u32 m0, m0, 4096
s_add_u32 s50, s50, 245760
buffer_load_dwordx4 v4, s[16:19], s50 offen nt lds
s_add_u32 m0, m0, 4096
s_add_u32 s50, s50, 245760
buffer_load_dwordx4 v4, s[16:19], s50 offen nt lds
s_add_u32 m0, m0, 4096
s_add_u32 s50, s50, 245760
buffer_load_dwordx4 v4, s[16:19], s50 offen nt lds
s_add_u32 m0, m0, 4096
s_add_u32 s50, s50, 245760
buffer_load_dwordx4 v4, s[16:19], s50 offen nt lds
s_add_u32 m0, m0, 4096
s_add_u32 s50, s50, 245760
buffer_load_dwordx4 v4, s[16:19], s50 offen nt lds
s_add_u32 m0, m0, 4096
s_add_u32 s50, s50, 245760
buffer_load_dwordx4 v4, s[16:19], s50 offen nt lds
s_waitcnt vmcnt(21)
s_barrier
ds_read_b64_tr_b16 v[20:21], v9 offset:0
ds_read_b64_tr_b16 v[22:23], v9 offset:512
ds_read_b64_tr_b16 v[24:25], v9 offset:4096
ds_read_b64_tr_b16 v[26:27], v9 offset:4608
ds_read_b64_tr_b16 v[28:29], v9 offset:8192
ds_read_b64_tr_b16 v[30:31], v9 offset:8704
ds_read_b64_tr_b16 v[32:33], v9 offset:12288
ds_read_b64_tr_b16 v[34:35], v9 offset:12800
ds_read_b64_tr_b16 v[36:37], v9 offset:16384
ds_read_b64_tr_b16 v[38:39], v9 offset:16896
ds_read_b64_tr_b16 v[40:41], v9 offset:20480
ds_read_b64_tr_b16 v[42:43], v9 offset:20992
ds_read_b64_tr_b16 v[44:45], v9 offset:24576
ds_read_b64_tr_b16 v[46:47], v9 offset:25088
ds_read_b64_tr_b16 v[48:49], v9 offset:28672
ds_read_b64_tr_b16 v[50:51], v9 offset:29184
ds_read_b64_tr_b16 v[52:53], v9 offset:32768
ds_read_b64_tr_b16 v[54:55], v9 offset:33280
ds_read_b64_tr_b16 v[56:57], v9 offset:36864
ds_read_b64_tr_b16 v[58:59], v9 offset:37376
ds_read_b64_tr_b16 v[60:61], v10 offset:0
ds_read_b64_tr_b16 v[62:63], v10 offset:512
ds_read_b64_tr_b16 v[64:65], v10 offset:4096
ds_read_b64_tr_b16 v[66:67], v10 offset:4608
ds_read_b64_tr_b16 v[68:69], v10 offset:8192
ds_read_b64_tr_b16 v[70:71], v10 offset:8704
ds_read_b64_tr_b16 v[72:73], v10 offset:12288
ds_read_b64_tr_b16 v[74:75], v10 offset:12800
ds_read_b64_tr_b16 v[76:77], v10 offset:16384
ds_read_b64_tr_b16 v[78:79], v10 offset:16896
ds_read_b64_tr_b16 v[80:81], v10 offset:20480
ds_read_b64_tr_b16 v[82:83], v10 offset:20992
ds_read_b64_tr_b16 v[84:85], v10 offset:24576
ds_read_b64_tr_b16 v[86:87], v10 offset:25088
ds_read_b64_tr_b16 v[88:89], v10 offset:28672
ds_read_b64_tr_b16 v[90:91], v10 offset:29184
ds_read_b64_tr_b16 v[92:93], v10 offset:32768
ds_read_b64_tr_b16 v[94:95], v10 offset:33280
ds_read_b64_tr_b16 v[96:97], v10 offset:36864
ds_read_b64_tr_b16 v[98:99], v10 offset:37376
s_waitcnt lgkmcnt(0)
s_barrier
v_mfma_f32_16x16x32_bf16 v[180:183], v[100:103], v[20:23], 0
v_mfma_f32_16x16x32_bf16 v[180:183], v[104:107], v[24:27], v[180:183]
v_mfma_f32_16x16x32_bf16 v[180:183], v[108:111], v[28:31], v[180:183]
v_mfma_f32_16x16x32_bf16 v[180:183], v[112:115], v[32:35], v[180:183]
v_mfma_f32_16x16x32_bf16 v[180:183], v[116:119], v[36:39], v[180:183]
v_mfma_f32_16x16x32_bf16 v[180:183], v[120:123], v[40:43], v[180:183]
v_mfma_f32_16x16x32_bf16 v[180:183], v[124:127], v[44:47], v[180:183]
v_mfma_f32_16x16x32_bf16 v[180:183], v[128:131], v[48:51], v[180:183]
v_mfma_f32_16x16x32_bf16 v[180:183], v[132:135], v[52:55], v[180:183]
v_mfma_f32_16x16x32_bf16 v[180:183], v[136:139], v[56:59], v[180:183]
v_mfma_f32_16x16x32_bf16 v[180:183], v[140:143], v[60:63], v[180:183]
v_mfma_f32_16x16x32_bf16 v[180:183], v[144:147], v[64:67], v[180:183]
v_mfma_f32_16x16x32_bf16 v[180:183], v[148:151], v[68:71], v[180:183]
v_mfma_f32_16x16x32_bf16 v[180:183], v[152:155], v[72:75], v[180:183]
v_mfma_f32_16x16x32_bf16 v[180:183], v[156:159], v[76:79], v[180:183]
v_mfma_f32_16x16x32_bf16 v[180:183], v[160:163], v[80:83], v[180:183]
v_mfma_f32_16x16x32_bf16 v[180:183], v[164:167], v[84:87], v[180:183]
v_mfma_f32_16x16x32_bf16 v[180:183], v[168:171], v[88:91], v[180:183]
v_mfma_f32_16x16x32_bf16 v[180:183], v[172:175], v[92:95], v[180:183]
v_mfma_f32_16x16x32_bf16 v[180:183], v[176:179], v[96:99], v[180:183]
s_sub_u32 s55, s46, 20
s_cmp_lt_u32 s55, 10
s_cselect_b32 s55, 1.0, 0
s_lshl_b32 s56, s46, 8
s_lshl_b32 s57, s3, 6
s_add_u32 s56, s56, s57
s_add_u32 s56, s56, 65536
s_nop 0
v_cvt_pk_bf16_f32 v180, v180, v180
v_lshlrev_b32 v180, 16, v180
v_add_f32 v180, s55, v180
v_cvt_pk_bf16_f32 v180, v180, v180
v_lshl_or_b32 v180, v180, 16, v13
s_mov_b64 exec, 0xffff
buffer_store_dword v180, v12, s[4:7], s56 offen sc1
s_mov_b64 exec, -1
s_cmp_lt_u32 s47, 40
s_cbranch_scc0 L_fz_u
s_waitcnt vmcnt(1)
s_barrier
ds_read_b64_tr_b16 v[20:21], v6 offset:0
ds_read_b64_tr_b16 v[22:23], v6 offset:512
ds_read_b64_tr_b16 v[24:25], v6 offset:4096
ds_read_b64_tr_b16 v[26:27], v6 offset:4608
ds_read_b64_tr_b16 v[28:29], v6 offset:8192
ds_read_b64_tr_b16 v[30:31], v6 offset:8704
ds_read_b64_tr_b16 v[32:33], v6 offset:12288
ds_read_b64_tr_b16 v[34:35], v6 offset:12800
ds_read_b64_tr_b16 v[36:37], v6 offset:16384
ds_read_b64_tr_b16 v[38:39], v6 offset:16896
ds_read_b64_tr_b16 v[40:41], v6 offset:20480
ds_read_b64_tr_b16 v[42:43], v6 offset:20992
ds_read_b64_tr_b16 v[44:45], v6 offset:24576
ds_read_b64_tr_b16 v[46:47], v6 offset:25088
ds_read_b64_tr_b16 v[48:49], v6 offset:28672
ds_read_b64_tr_b16 v[50:51], v6 offset:29184
ds_read_b64_tr_b16 v[52:53], v6 offset:32768
ds_read_b64_tr_b16 v[54:55], v6 offset:33280
ds_read_b64_tr_b16 v[56:57], v6 offset:36864
ds_read_b64_tr_b16 v[58:59], v6 offset:37376
ds_read_b64_tr_b16 v[60:61], v7 offset:0
ds_read_b64_tr_b16 v[62:63], v7 offset:512
ds_read_b64_tr_b16 v[64:65], v7 offset:4096
ds_read_b64_tr_b16 v[66:67], v7 offset:4608
ds_read_b64_tr_b16 v[68:69], v7 offset:8192
ds_read_b64_tr_b16 v[70:71], v7 offset:8704
ds_read_b64_tr_b16 v[72:73], v7 offset:12288
ds_read_b64_tr_b16 v[74:75], v7 offset:12800
ds_read_b64_tr_b16 v[76:77], v7 offset:16384
ds_read_b64_tr_b16 v[78:79], v7 offset:16896
ds_read_b64_tr_b16 v[80:81], v7 offset:20480
ds_read_b64_tr_b16 v[82:83], v7 offset:20992
ds_read_b64_tr_b16 v[84:85], v7 offset:24576
ds_read_b64_tr_b16 v[86:87], v7 offset:25088
ds_read_b64_tr_b16 v[88:89], v7 offset:28672
ds_read_b64_tr_b16 v[90:91], v7 offset:29184
ds_read_b64_tr_b16 v[92:93], v7 offset:32768
ds_read_b64_tr_b16 v[94:95], v7 offset:33280
ds_read_b64_tr_b16 v[96:97], v7 offset:36864
ds_read_b64_tr_b16 v[98:99], v7 offset:37376
s_waitcnt lgkmcnt(0)
s_barrier
v_mfma_f32_16x16x32_bf16 v[180:183], v[100:103], v[20:23], 0
v_mfma_f32_16x16x32_bf16 v[180:183], v[104:107], v[24:27], v[180:183]
v_mfma_f32_16x16x32_bf16 v[180:183], v[108:111], v[28:31], v[180:183]
v_mfma_f32_16x16x32_bf16 v[180:183], v[112:115], v[32:35], v[180:183]
v_mfma_f32_16x16x32_bf16 v[180:183], v[116:119], v[36:39], v[180:183]
v_mfma_f32_16x16x32_bf16 v[180:183], v[120:123], v[40:43], v[180:183]
v_mfma_f32_16x16x32_bf16 v[180:183], v[124:127], v[44:47], v[180:183]
v_mfma_f32_16x16x32_bf16 v[180:183], v[128:131], v[48:51], v[180:183]
v_mfma_f32_16x16x32_bf16 v[180:183], v[132:135], v[52:55], v[180:183]
v_mfma_f32_16x16x32_bf16 v[180:183], v[136:139], v[56:59], v[180:183]
v_mfma_f32_16x16x32_bf16 v[180:183], v[140:143], v[60:63], v[180:183]
v_mfma_f32_16x16x32_bf16 v[180:183], v[144:147], v[64:67], v[180:183]
v_mfma_f32_16x16x32_bf16 v[180:183], v[148:151], v[68:71], v[180:183]
v_mfma_f32_16x16x32_bf16 v[180:183], v[152:155], v[72:75], v[180:183]
v_mfma_f32_16x16x32_bf16 v[180:183], v[156:159], v[76:79], v[180:183]
v_mfma_f32_16x16x32_bf16 v[180:183], v[160:163], v[80:83], v[180:183]
v_mfma_f32_16x16x32_bf16 v[180:183], v[164:167], v[84:87], v[180:183]
v_mfma_f32_16x16x32_bf16 v[180:183], v[168:171], v[88:91], v[180:183]
v_mfma_f32_16x16x32_bf16 v[180:183], v[172:175], v[92:95], v[180:183]
v_mfma_f32_16x16x32_bf16 v[180:183], v[176:179], v[96:99], v[180:183]
s_sub_u32 s55, s47, 20
s_cmp_lt_u32 s55, 10
s_cselect_b32 s55, 1.0, 0
s_lshl_b32 s56, s47, 8
s_lshl_b32 s57, s3, 6
s_add_u32 s56, s56, s57
s_add_u32 s56, s56, 65536
s_nop 0
v_cvt_pk_bf16_f32 v180, v180, v180
v_lshlrev_b32 v180, 16, v180
v_add_f32 v180, s55, v180
v_cvt_pk_bf16_f32 v180, v180, v180
v_lshl_or_b32 v180, v180, 16, v13
s_mov_b64 exec, 0xffff
buffer_store_dword v180, v12, s[4:7], s56 offen sc1
s_mov_b64 exec, -1
L_fz_u:
buffer_load_dword v191, v12, s[32:35], 0 offen
s_mov_b32 s55, 2621184
buffer_load_dword v192, v12, s[32:35], s55 offen
s_sub_u32 s46, s44, 27
s_lshl_b32 s46, s46, 2
s_add_u32 s46, s46, s3
v_cmp_gt_u32 vcc, 32, v1
v_lshlrev_b32 v14, 3, v1
v_and_b32 v15, 7, v1
v_cndmask_b32 v16, v255, v8, vcc
v_cndmask_b32 v250, 0, -1, vcc
v_lshlrev_b32 v15, 4, v15
s_mov_b32 s55, 68096
s_lshl_b32 s56, s46, 7
s_add_u32 s56, s56, 73216
s_mov_b32 s57, 0x05040100
buffer_load_dwordx2 v[44:45], v14, s[28:31], 0 offen
buffer_load_dwordx2 v[46:47], v14, s[28:31], 0 offen offset:512
buffer_load_dwordx2 v[48:49], v14, s[28:31], 0 offen offset:1024
L_fz_mp:
buffer_load_dwordx4 v[20:23], v8, s[4:7], s55 offen sc1
buffer_load_dwordx4 v[24:27], v8, s[4:7], s55 offen offset:1024 sc1
buffer_load_dwordx4 v[28:31], v16, s[4:7], s55 offen offset:2048 sc1
buffer_load_dwordx4 v[56:59], v15, s[4:7], s56 offen sc1
s_waitcnt vmcnt(0)
v_perm_b32 v32, v29, v28, s57
v_perm_b32 v33, v31, v30, s57
v_xor_b32 v32, s40, v32
v_xor_b32 v33, s40, v33
v_or_b32 v34, v32, v33
v_and_b32 v34, v34, v250
v_perm_b32 v32, v21, v20, s57
v_perm_b32 v33, v23, v22, s57
v_xor_b32 v32, s40, v32
v_xor_b32 v33, s40, v33
v_or3_b32 v34, v34, v32, v33
v_perm_b32 v32, v25, v24, s57
v_perm_b32 v33, v27, v26, s57
v_xor_b32 v32, s40, v32
v_xor_b32 v33, s40, v33
v_or3_b32 v34, v34, v32, v33
v_perm_b32 v32, v57, v56, s57
v_perm_b32 v33, v59, v58, s57
v_xor_b32 v32, s40, v32
v_xor_b32 v33, s40, v33
v_or3_b32 v34, v34, v32, v33
v_cmp_ne_u32 vcc, 0, v34
s_sleep 4
s_add_u32 s97, s97, 1
s_cmp_gt_u32 s97, 65536
s_cbranch_scc1 L_fz_mok
s_cbranch_vccnz L_fz_mp
L_fz_mok:
v_mov_b32 v60, 0
v_and_b32 v56, 0xffff0000, v56
v_and_b32 v57, 0xffff0000, v57
v_and_b32 v58, 0xffff0000, v58
v_and_b32 v59, 0xffff0000, v59
v_and_b32 v20, 0xffff0000, v20
v_lshlrev_b32 v32, 16, v44
v_fmac_f32 v60, v20, v32
v_and_b32 v21, 0xffff0000, v21
v_and_b32 v32, 0xffff0000, v44
v_fmac_f32 v60, v21, v32
v_and_b32 v22, 0xffff0000, v22
v_lshlrev_b32 v32, 16, v45
v_fmac_f32 v60, v22, v32
v_and_b32 v23, 0xffff0000, v23
v_and_b32 v32, 0xffff0000, v45
v_fmac_f32 v60, v23, v32
v_and_b32 v24, 0xffff0000, v24
v_lshlrev_b32 v32, 16, v46
v_fmac_f32 v60, v24, v32
v_and_b32 v25, 0xffff0000, v25
v_and_b32 v32, 0xffff0000, v46
v_fmac_f32 v60, v25, v32
v_and_b32 v26, 0xffff0000, v26
v_lshlrev_b32 v32, 16, v47
v_fmac_f32 v60, v26, v32
v_and_b32 v27, 0xffff0000, v27
v_and_b32 v32, 0xffff0000, v47
v_fmac_f32 v60, v27, v32
v_and_b32 v28, 0xffff0000, v28
v_lshlrev_b32 v32, 16, v48
v_fmac_f32 v60, v28, v32
v_and_b32 v29, 0xffff0000, v29
v_and_b32 v32, 0xffff0000, v48
v_fmac_f32 v60, v29, v32
v_and_b32 v30, 0xffff0000, v30
v_lshlrev_b32 v32, 16, v49
v_fmac_f32 v60, v30, v32
v_and_b32 v31, 0xffff0000, v31
v_and_b32 v32, 0xffff0000, v49
v_fmac_f32 v60, v31, v32
s_nop 1
v_add_f32_dpp v60, v60, v60 row_ror:8 row_mask:0xf bank_mask:0xf
s_nop 1
v_add_f32_dpp v60, v60, v60 row_ror:4 row_mask:0xf bank_mask:0xf
s_nop 1
v_add_f32_dpp v60, v60, v60 row_ror:2 row_mask:0xf bank_mask:0xf
s_nop 1
v_add_f32_dpp v60, v60, v60 row_ror:1 row_mask:0xf bank_mask:0xf
v_mov_b32 v61, v60
s_nop 1
v_permlane16_swap_b32 v60, v61
v_add_f32 v60, v60, v61
v_mov_b32 v61, v60
s_nop 1
v_permlane32_swap_b32 v60, v61
v_add_f32 v60, v60, v61
s_mov_b32 s62, 8
s_cmp_lg_u32 s3, 0
s_cbranch_scc1 L_f_nr
s_not_b32 s59, s40
s_waitcnt lgkmcnt(0)
s_mov_b32 s58, s59
s_buffer_load_dword s99, s[4:7], s61
s_buffer_load_dword s58, s[4:7], s60
s_waitcnt lgkmcnt(1)
s_nop 7
s_cmp_lg_u32 s58, s40
s_addc_u32 s62, s62, 0
s_waitcnt lgkmcnt(0)
s_add_u32 s60, s60, 128
s_add_u32 s61, s61, 128
s_mov_b32 s58, s59
s_buffer_load_dword s99, s[4:7], s60
s_buffer_load_dword s58, s[4:7], s61
s_waitcnt lgkmcnt(1)
s_nop 7
s_cmp_lg_u32 s58, s40
s_subb_u32 s62, s62, 0
s_waitcnt lgkmcnt(0)
s_add_u32 s60, s60, 128
s_add_u32 s61, s61, 128
L_f_nr:
v_mov_b32 v30, s62
v_lshlrev_b32 v31, 2, v0
ds_write_b32 v31, v30 offset:16384
v_mov_b32 v31, 0
s_waitcnt lgkmcnt(0)
s_barrier
ds_read_b32 v30, v31 offset:16384
s_waitcnt lgkmcnt(0)
v_readfirstlane_b32 s62, v30
s_cmp_gt_u32 s62, 8
s_cselect_b32 s101, 8192, 0
s_add_u32 s100, s101, 7733248
v_cmp_gt_u32 vcc, 24, v1
s_mul_i32 s47, s46, 86
s_lshr_b32 s47, s47, 8
v_cndmask_b32 v17, v255, v8, vcc
v_cndmask_b32 v250, 0, -1, vcc
s_lshl_b32 s48, s46, 12
s_andn2_b32 s55, s48, 8191
s_add_u32 s48, s48, s55
s_add_u32 s48, s48, s101
s_add_u32 s48, s48, 7864320
v_mov_b32 v18, 0
s_and_b32 s60, s40, 0xff
s_bfe_u32 s61, s40, 0x80008
s_bfe_u32 s62, s40, 0x80010
s_lshr_b32 s63, s40, 24
v_and_b32 v64, s60, v250
v_and_b32 v65, s61, v250
v_and_b32 v66, s62, v250
v_and_b32 v67, s63, v250
v_lshrrev_b32 v70, 3, v1
v_lshl_add_u32 v71, v70, 12, v15
v_lshlrev_b32 v70, 2, v70
v_lshrrev_b32 v77, 1, v15
s_add_u32 s51, s46, s47
s_lshl_b32 s51, s51, 7
s_add_u32 s51, s51, 524288
s_add_u32 s52, s51, 32768
s_add_u32 s53, s51, 65536
s_add_u32 s54, s51, 98304
s_branch L_pg3
.p2align 12
L_pg3:
v_and_b32 v30, 31, v1
v_lshlrev_b32 v30, 11, v30
v_and_b32 v31, 0xe000, v30
v_add_u32 v30, v30, v31
s_and_b32 s55, s42, 3
s_lshl_b32 s55, s55, 9
s_add_u32 s55, s55, s101
s_add_u32 s55, s55, 7602176
s_mov_b32 exec_hi, 0
L_f_p:
buffer_load_dwordx3 v[200:202], v30, s[4:7], s55 offen sc1
s_waitcnt vmcnt(0)
v_cmp_ne_u32 vcc, s40, v202
v_mov_b32 v20, v200
v_mov_b32 v21, v201
s_cbranch_vccz L_f_ok
s_add_u32 s97, s97, 1
s_cmp_le_u32 s97, 65536
s_cbranch_scc1 L_f_p
L_f_ok:
v_max_f32_dpp v24, v20, v20 row_ror:8 row_mask:0xf bank_mask:0xf
s_nop 1
v_max_f32_dpp v24, v24, v24 row_ror:4 row_mask:0xf bank_mask:0xf
s_nop 1
v_max_f32_dpp v24, v24, v24 row_ror:2 row_mask:0xf bank_mask:0xf
s_nop 1
v_max_f32_dpp v24, v24, v24 row_ror:1 row_mask:0xf bank_mask:0xf
v_mov_b32 v25, v24
s_nop 1
v_permlane16_swap_b32 v24, v25
v_max_f32 v24, v24, v25
v_cmp_eq_f32 vcc, v24, v20
s_mov_b32 exec_hi, -1
s_ff1_i32_b32 s45, vcc_lo
s_and_b32 s45, s45, 31
v_readlane_b32 s50, v21, s45
s_lshl_b32 s55, s45, 12
s_add_u32 s55, s55, s51
buffer_load_dwordx4 v[52:55], v15, s[4:7], s55 offen sc1
buffer_load_dwordx4 v[80:83], v71, s[4:7], s51 offen sc1
buffer_load_dwordx4 v[84:87], v71, s[4:7], s52 offen sc1
buffer_load_dwordx4 v[88:91], v71, s[4:7], s53 offen sc1
buffer_load_dwordx4 v[92:95], v71, s[4:7], s54 offen sc1
ds_bpermute_b32 v72, v70, v21 offset:0
ds_bpermute_b32 v73, v70, v21 offset:32
ds_bpermute_b32 v74, v70, v21 offset:64
ds_bpermute_b32 v75, v70, v21 offset:96
v_readlane_b32 s58, v24, 0
s_nop 1
v_add_f32 v60, s58, v60
v_cvt_pk_bf16_f32 v60, v60, v60
v_lshlrev_b32 v60, 16, v60
v_mul_f32 v60, 0xbfb8aa3b, v60
v_exp_f32 v60, v60
s_and_b32 s50, s50, 2047
s_mul_i32 s50, s50, 1280
v_add_f32 v60, 1.0, v60
v_rcp_f32 v60, v60
s_lshl_b32 s57, s46, 6
s_add_u32 s50, s50, s57
s_lshl_b32 s58, s45, 2
v_mul_f32 v56, v56, v60
v_mul_f32 v57, v57, v60
v_mul_f32 v58, v58, v60
v_mul_f32 v59, v59, v60
s_mov_b32 s59, 1280
s_waitcnt lgkmcnt(0)
v_and_b32 v72, 2047, v72
v_add_u32 v76, 0, v70
v_cmp_eq_u32 vcc, s58, v76
v_mad_u32_u24 v72, v72, s59, v77
s_nop 0
v_cndmask_b32 v72, v72, v255, vcc
v_and_b32 v73, 2047, v73
v_add_u32 v76, 32, v70
v_cmp_eq_u32 vcc, s58, v76
v_mad_u32_u24 v73, v73, s59, v77
s_nop 0
v_cndmask_b32 v73, v73, v255, vcc
v_and_b32 v74, 2047, v74
v_add_u32 v76, 64, v70
v_cmp_eq_u32 vcc, s58, v76
v_mad_u32_u24 v74, v74, s59, v77
s_nop 0
v_cndmask_b32 v74, v74, v255, vcc
v_and_b32 v75, 2047, v75
v_add_u32 v76, 96, v70
v_cmp_eq_u32 vcc, s58, v76
v_mad_u32_u24 v75, v75, s59, v77
s_nop 0
v_cndmask_b32 v75, v75, v255, vcc
s_waitcnt vmcnt(0)
v_xor_b32 v52, s60, v52
v_xor_b32 v53, s61, v53
v_xor_b32 v54, s62, v54
v_xor_b32 v55, s63, v55
v_xor_b32 v80, s60, v80
v_xor_b32 v81, s61, v81
v_xor_b32 v82, s62, v82
v_xor_b32 v83, s63, v83
v_xor_b32 v84, s60, v84
v_xor_b32 v85, s61, v85
v_xor_b32 v86, s62, v86
v_xor_b32 v87, s63, v87
v_xor_b32 v88, s60, v88
v_xor_b32 v89, s61, v89
v_xor_b32 v90, s62, v90
v_xor_b32 v91, s63, v91
v_xor_b32 v92, s60, v92
v_xor_b32 v93, s61, v93
v_xor_b32 v94, s62, v94
v_xor_b32 v95, s63, v95
v_or_b32 v32, v52, v53
v_or3_b32 v32, v32, v54, v55
v_or3_b32 v32, v32, v80, v81
v_or3_b32 v32, v32, v82, v83
v_or3_b32 v32, v32, v84, v85
v_or3_b32 v32, v32, v86, v87
v_or3_b32 v32, v32, v88, v89
v_or3_b32 v32, v32, v90, v91
v_or3_b32 v32, v32, v92, v93
v_or3_b32 v32, v32, v94, v95
v_and_b32 v32, 0xff, v32
v_cmp_ne_u32 vcc, 0, v32
s_cbranch_vccnz L_fb_retry
L_fb_ok:
v_cvt_pk_bf16_f32 v80, v80, v81
v_cvt_pk_bf16_f32 v81, v82, v83
buffer_store_dwordx2 v[80:81], v72, s[32:35], s57 offen
v_cvt_pk_bf16_f32 v84, v84, v85
v_cvt_pk_bf16_f32 v85, v86, v87
buffer_store_dwordx2 v[84:85], v73, s[32:35], s57 offen
v_cvt_pk_bf16_f32 v88, v88, v89
v_cvt_pk_bf16_f32 v89, v90, v91
buffer_store_dwordx2 v[88:89], v74, s[32:35], s57 offen
v_cvt_pk_bf16_f32 v92, v92, v93
v_cvt_pk_bf16_f32 v93, v94, v95
buffer_store_dwordx2 v[92:93], v75, s[32:35], s57 offen
s_cmp_eq_u32 s46, 0
s_cbranch_scc0 L_fz_e
s_add_u32 s55, s41, 1
v_mov_b32 v22, s55
s_mov_b64 exec, 1
buffer_store_dword v22, v18, s[4:7], 0 offen
s_mov_b64 exec, -1
L_fz_e:
v_min_u32 v68, 26, v1
v_lshlrev_b32 v68, 7, v68
s_add_u32 s57, s101, 8060928
L_ys_p:
buffer_load_dword v69, v68, s[4:7], s57 offen sc1
s_waitcnt vmcnt(0)
v_cmp_ne_u32 vcc, s40, v69
s_cbranch_vccz L_ys_ok
s_add_u32 s97, s97, 1
s_cmp_le_u32 s97, 65536
s_cbranch_scc1 L_ys_p
L_ys_ok:
L_fy_p:
buffer_load_dwordx4 v[100:103], v8, s[4:7], s48 offen offset:0 sc1
buffer_load_dwordx4 v[104:107], v8, s[4:7], s48 offen offset:1024 sc1
buffer_load_dwordx4 v[108:111], v8, s[4:7], s48 offen offset:2048 sc1
buffer_load_dwordx4 v[112:115], v17, s[4:7], s48 offen offset:3072 sc1
s_waitcnt vmcnt(0)
v_xor_b32 v20, s60, v100
v_xor_b32 v21, s61, v101
v_xor_b32 v22, s62, v102
v_xor_b32 v23, s63, v103
v_xor_b32 v24, s60, v104
v_xor_b32 v25, s61, v105
v_xor_b32 v26, s62, v106
v_xor_b32 v27, s63, v107
v_xor_b32 v28, s60, v108
v_xor_b32 v29, s61, v109
v_xor_b32 v30, s62, v110
v_xor_b32 v31, s63, v111
v_xor_b32 v32, v64, v112
v_xor_b32 v33, v65, v113
v_xor_b32 v34, v66, v114
v_xor_b32 v35, v67, v115
v_or3_b32 v36, v20, v21, v22
v_or3_b32 v37, v23, v24, v25
v_or3_b32 v36, v36, v26, v27
v_or3_b32 v37, v37, v28, v29
v_or3_b32 v36, v36, v30, v31
v_or3_b32 v37, v37, v32, v33
v_or3_b32 v36, v36, v34, v35
v_or_b32 v36, v36, v37
v_and_b32 v36, 0xff, v36
v_cmp_ne_u32 vcc, 0, v36
s_cbranch_vccz L_fy_ok
s_add_u32 s97, s97, 1
s_cmp_le_u32 s97, 65536
s_cbranch_scc1 L_fy_p
L_fy_ok:
v_pk_add_f32 v[20:21], v[20:21], v[24:25]
v_pk_add_f32 v[22:23], v[22:23], v[26:27]
v_pk_add_f32 v[28:29], v[28:29], v[32:33]
v_pk_add_f32 v[30:31], v[30:31], v[34:35]
v_pk_add_f32 v[20:21], v[20:21], v[28:29]
v_pk_add_f32 v[22:23], v[22:23], v[30:31]
s_nop 0
v_add_f32_dpp v20, v20, v20 row_ror:8 row_mask:0xf bank_mask:0xf
v_add_f32_dpp v21, v21, v21 row_ror:8 row_mask:0xf bank_mask:0xf
v_add_f32_dpp v22, v22, v22 row_ror:8 row_mask:0xf bank_mask:0xf
v_add_f32_dpp v23, v23, v23 row_ror:8 row_mask:0xf bank_mask:0xf
v_mov_b32 v24, v20
v_mov_b32 v25, v21
v_mov_b32 v26, v22
v_mov_b32 v27, v23
v_permlane16_swap_b32 v20, v24
v_permlane16_swap_b32 v21, v25
v_permlane16_swap_b32 v22, v26
v_permlane16_swap_b32 v23, v27
v_pk_add_f32 v[20:21], v[20:21], v[24:25]
v_pk_add_f32 v[22:23], v[22:23], v[26:27]
v_mov_b32 v24, v20
v_mov_b32 v25, v21
v_mov_b32 v26, v22
v_mov_b32 v27, v23
v_permlane32_swap_b32 v20, v24
v_permlane32_swap_b32 v21, v25
v_permlane32_swap_b32 v22, v26
v_permlane32_swap_b32 v23, v27
v_pk_add_f32 v[20:21], v[20:21], v[24:25]
v_pk_add_f32 v[22:23], v[22:23], v[26:27]
v_pk_fma_f32 v[20:21], v[20:21], v[56:57], v[52:53]
v_pk_fma_f32 v[22:23], v[22:23], v[58:59], v[54:55]
v_cvt_pk_bf16_f32 v20, v20, v21
v_cvt_pk_bf16_f32 v21, v22, v23
s_mov_b64 exec, 0xff
buffer_store_dwordx2 v[20:21], v14, s[32:35], s50 offen
s_mov_b64 exec, -1
L_fin:
L_end:
s_endpgm
L_fb_retry:
buffer_load_dwordx4 v[52:55], v15, s[4:7], s55 offen sc1
buffer_load_dwordx4 v[80:83], v71, s[4:7], s51 offen sc1
buffer_load_dwordx4 v[84:87], v71, s[4:7], s52 offen sc1
buffer_load_dwordx4 v[88:91], v71, s[4:7], s53 offen sc1
buffer_load_dwordx4 v[92:95], v71, s[4:7], s54 offen sc1
s_waitcnt vmcnt(0)
v_xor_b32 v52, s60, v52
v_xor_b32 v53, s61, v53
v_xor_b32 v54, s62, v54
v_xor_b32 v55, s63, v55
v_xor_b32 v80, s60, v80
v_xor_b32 v81, s61, v81
v_xor_b32 v82, s62, v82
v_xor_b32 v83, s63, v83
v_xor_b32 v84, s60, v84
v_xor_b32 v85, s61, v85
v_xor_b32 v86, s62, v86
v_xor_b32 v87, s63, v87
v_xor_b32 v88, s60, v88
v_xor_b32 v89, s61, v89
v_xor_b32 v90, s62, v90
v_xor_b32 v91, s63, v91
v_xor_b32 v92, s60, v92
v_xor_b32 v93, s61, v93
v_xor_b32 v94, s62, v94
v_xor_b32 v95, s63, v95
v_or_b32 v32, v52, v53
v_or3_b32 v32, v32, v54, v55
v_or3_b32 v32, v32, v80, v81
v_or3_b32 v32, v32, v82, v83
v_or3_b32 v32, v32, v84, v85
v_or3_b32 v32, v32, v86, v87
v_or3_b32 v32, v32, v88, v89
v_or3_b32 v32, v32, v90, v91
v_or3_b32 v32, v32, v92, v93
v_or3_b32 v32, v32, v94, v95
v_and_b32 v32, 0xff, v32
v_cmp_ne_u32 vcc, 0, v32
s_add_u32 s97, s97, 1
s_cmp_gt_u32 s97, 65536
s_cbranch_scc1 L_fb_ok
s_cbranch_vccnz L_fb_retry
s_branch L_fb_ok
.fill (adaLN_cond__sliding_local_dilated__moe_arch_mod__prompt_kernel + 66048 - .) / 4, 4, 0xbf800000
.section .rodata,"a"
.p2align 6
.amdhsa_kernel adaLN_cond__sliding_local_dilated__moe_arch_mod__prompt_kernel
  .amdhsa_next_free_vgpr 512
  .amdhsa_next_free_sgpr 102
  .amdhsa_accum_offset 256
  .amdhsa_group_segment_fixed_size 0
  .amdhsa_kernarg_size 104
  .amdhsa_user_sgpr_count 2
  .amdhsa_user_sgpr_kernarg_segment_ptr 1
  .amdhsa_system_sgpr_workgroup_id_x 1
  .amdhsa_float_denorm_mode_32 3
  .amdhsa_float_denorm_mode_16_64 3
.end_amdhsa_kernel
```

```asm
; @launch grid=(256,1,1) block=(256,1,1) lds=163840
.amdgcn_target "amdgcn-amd-amdhsa--gfx950"
.text
.globl adaLN_cond__sliding_local_dilated__moe_arch_mod__prompt_kernel
.p2align 12
.type adaLN_cond__sliding_local_dilated__moe_arch_mod__prompt_kernel,@function
adaLN_cond__sliding_local_dilated__moe_arch_mod__prompt_kernel:
s_cmp_ge_u32 s2, 256
s_cbranch_scc1 L_end
s_load_dwordx4 s[8:11], s[0:1], 0
s_load_dwordx4 s[20:23], s[0:1], 64
s_load_dwordx2 s[4:5], s[0:1], 96
s_getpc_b64 s[48:49]
v_lshrrev_b32 v4, 6, v0
v_and_b32 v1, 63, v0
s_lshr_b32 s43, s2, 3
v_readfirstlane_b32 s3, v4
v_lshl_add_u32 v5, v4, 2, v1
s_lshl_b32 s50, s43, 11
v_lshl_add_u32 v5, v5, 7, s50
s_mov_b64 exec, 15
global_load_dword v19, v5, s[48:49]
s_mov_b64 exec, -1
s_and_b32 s42, s2, 7
v_and_b32 v2, 15, v1
v_lshrrev_b32 v3, 4, v1
v_mov_b32 v29, 0
s_mov_b32 s6, 8388608
s_mov_b32 s7, 0x20000
s_lshl_b32 s49, s3, 10
s_cmp_ge_u32 s2, 224
s_cbranch_scc1 L_svc
s_mov_b32 m0, s49
s_mov_b32 s15, 0x20000
s_lshr_b32 s55, s42, 2
s_bfe_u32 s56, s42, 0x10001
s_mul_i32 s56, s56, 7
s_lshr_b32 s57, s43, 2
s_and_b32 s44, s42, 1
s_lshl_b32 s44, s44, 2
s_and_b32 s58, s43, 3
s_add_u32 s44, s44, s58
s_add_u32 s56, s56, s57
s_mul_i32 s57, s56, 73
s_lshl_b32 s45, s57, 1
s_add_u32 s45, s45, s55
s_mul_i32 s45, s45, 1280
s_mul_i32 s58, s43, 37
s_lshr_b32 s58, s58, 8
s_mul_i32 s60, s58, 7
s_sub_u32 s96, s43, s60
s_lshl_b32 s47, s42, 2
s_add_u32 s47, s47, s58
s_lshl_b32 s60, s96, 2
s_lshr_b32 s60, 0x4932180, s60
s_and_b32 s60, s60, 15
s_cmp_ge_u32 s60, 8
s_cselect_b32 s61, 2, 5
s_cselect_b32 s63, 12, 0
s_mul_i32 s58, s58, s61
s_add_u32 s58, s58, s60
s_add_u32 s58, s58, s63
s_lshl_b32 s58, s58, 3
s_add_u32 s98, s58, s42
s_and_b32 s63, s44, 3
s_mov_b32 s62, 274960
s_cmp_eq_u32 s63, 1
s_cselect_b32 s62, 213025, s62
s_cmp_eq_u32 s63, 2
s_cselect_b32 s62, 274690, s62
s_cmp_eq_u32 s63, 3
s_cselect_b32 s62, 213520, s62
s_bfe_u32 s61, s62, 262144
s_mul_i32 s61, s61, 40960
s_add_u32 s61, s61, s45
v_lshrrev_b32 v5, 4, v0
v_mul_u32_u24 v4, 2560, v5
v_lshl_add_u32 v4, v2, 4, v4
s_cmp_lt_u32 s98, 160
s_cbranch_scc1 L_roleW
s_sub_u32 s50, s98, 160
s_mul_i32 s52, s50, 13
s_lshr_b32 s52, s52, 8
s_mul_i32 s53, s52, 20
s_sub_u32 s53, s50, s53
s_mul_i32 s51, s52, 28
s_add_u32 s51, s51, s3
s_mul_i32 s51, s51, 61440
s_lshl_b32 s54, s53, 7
s_add_u32 s51, s51, s54
s_mul_i32 s54, s52, 448
s_and_b32 s58, s3, 1
s_lshl_b32 s58, s58, 2
v_and_b32 v20, 1, v3
v_lshl_or_b32 v20, v20, 1, s58
v_and_b32 v21, 7, v1
v_xor_b32 v20, v20, v21
v_lshrrev_b32 v21, 3, v1
v_mul_u32_u24 v21, 480, v21
v_add_lshl_u32 v20, v20, v21, 4
v_lshlrev_b32 v39, 3, v1
s_mov_b32 s14, 4915200
s_waitcnt lgkmcnt(0)
s_mov_b32 s12, s22
s_mov_b32 s13, s23
s_mov_b32 s22, 1280
s_mov_b32 s23, 0x20000
s_mov_b32 s10, 2621440
s_mov_b32 s11, 0x20000
buffer_load_dword v42, v29, s[4:7], 0 offen sc1
buffer_load_dwordx2 v[40:41], v39, s[20:23], s54 offen
buffer_load_dwordx4 v[100:103], v4, s[8:11], s61 offen offset:0
buffer_load_dwordx4 v[104:107], v4, s[8:11], s61 offen offset:256
buffer_load_dwordx4 v[108:111], v4, s[8:11], s61 offen offset:512
buffer_load_dwordx4 v[112:115], v4, s[8:11], s61 offen offset:768
buffer_load_dwordx4 v[116:119], v4, s[8:11], s61 offen offset:1024
s_bfe_u32 s61, s62, 262148
s_mul_i32 s61, s61, 40960
s_add_u32 s61, s61, s45
buffer_load_dwordx4 v20, s[12:15], s51 offen nt lds
s_add_u32 m0, m0, 4096
s_add_u32 s51, s51, 245760
buffer_load_dwordx4 v20, s[12:15], s51 offen nt lds
s_add_u32 m0, m0, 4096
s_add_u32 s51, s51, 245760
buffer_load_dwordx4 v20, s[12:15], s51 offen nt lds
s_add_u32 m0, m0, 4096
s_add_u32 s51, s51, 245760
buffer_load_dwordx4 v20, s[12:15], s51 offen nt lds
s_add_u32 m0, m0, 4096
s_add_u32 s51, s51, 245760
buffer_load_dwordx4 v20, s[12:15], s51 offen nt lds
s_add_u32 m0, m0, 4096
s_add_u32 s51, s51, 245760
buffer_load_dwordx4 v20, s[12:15], s51 offen nt lds
s_add_u32 m0, m0, 4096
s_add_u32 s51, s51, 245760
buffer_load_dwordx4 v20, s[12:15], s51 offen nt lds
s_branch L_rolej
L_roleW:
s_mov_b32 s58, 640
v_lshlrev_b32 v24, 4, v0
v_mul_u32_u24 v26, 1639, v0
v_lshrrev_b32 v26, 16, v26
v_mad_u32_u24 v20, v26, s58, v24
v_add_u32 v25, 256, v0
v_add_u32 v24, 4096, v24
v_mul_u32_u24 v26, 1639, v25
v_lshrrev_b32 v26, 16, v26
v_mad_u32_u24 v21, v26, s58, v24
v_add_u32 v25, 512, v0
v_add_u32 v24, 4096, v24
v_mul_u32_u24 v26, 1639, v25
v_lshrrev_b32 v26, 16, v26
v_mad_u32_u24 v22, v26, s58, v24
v_add_u32 v25, 768, v0
v_add_u32 v24, 4096, v24
v_mul_u32_u24 v26, 1639, v25
v_lshrrev_b32 v26, 16, v26
v_mad_u32_u24 v23, v26, s58, v24
s_lshr_b32 s50, s98, 1
s_and_b32 s52, s98, 1
s_mul_i32 s51, s50, 30720
s_mul_i32 s53, s52, 640
s_add_u32 s51, s51, s53
s_cmp_eq_u32 s3, 3
s_cselect_b32 s53, 1073741824, s51
s_mov_b32 s14, 2457600
s_waitcnt lgkmcnt(0)
s_mov_b32 s12, s10
s_mov_b32 s13, s11
s_mov_b32 s10, 2621440
s_mov_b32 s11, 0x20000
buffer_load_dword v42, v29, s[4:7], 0 offen sc1
buffer_load_dwordx4 v[100:103], v4, s[8:11], s61 offen offset:0
buffer_load_dwordx4 v[104:107], v4, s[8:11], s61 offen offset:256
buffer_load_dwordx4 v[108:111], v4, s[8:11], s61 offen offset:512
buffer_load_dwordx4 v[112:115], v4, s[8:11], s61 offen offset:768
buffer_load_dwordx4 v[116:119], v4, s[8:11], s61 offen offset:1024
s_bfe_u32 s61, s62, 262148
s_mul_i32 s61, s61, 40960
s_add_u32 s61, s61, s45
buffer_load_dwordx4 v20, s[12:15], s51 offen nt lds
s_add_u32 m0, m0, 4096
s_nop 0
buffer_load_dwordx4 v21, s[12:15], s51 offen nt lds
s_add_u32 m0, m0, 4096
s_nop 0
buffer_load_dwordx4 v22, s[12:15], s51 offen nt lds
s_add_u32 m0, m0, 4096
s_nop 0
buffer_load_dwordx4 v23, s[12:15], s53 offen nt lds
L_rolej:
s_load_dwordx2 s[24:25], s[0:1], 16
s_load_dwordx2 s[28:29], s[0:1], 32
s_load_dwordx2 s[32:33], s[0:1], 80
s_mov_b32 s26, 819200
s_mov_b32 s27, 0x20000
s_mov_b32 s30, 1280
s_mov_b32 s31, 0x20000
s_mov_b32 s34, 2621440
s_mov_b32 s35, 0x20000
s_mov_b32 s97, 0
v_mov_b32 v255, 1073741824
v_lshlrev_b32 v36, 4, v1
s_mul_i32 s36, s55, 14
s_add_u32 s100, s36, s56
s_cmp_eq_u32 s56, 0
s_cselect_b32 s58, 0, 7
s_add_u32 s58, s58, s57
s_add_u32 s60, s57, 80
s_min_u32 s60, s60, 1024
s_sub_u32 s60, s60, s58
s_andn2_b32 s59, s58, 15
s_mul_i32 s54, s55, 1024
s_add_u32 s54, s54, s59
s_lshl_b32 s46, s44, 1
s_add_u32 s46, s46, s54
s_mul_i32 s46, s46, 1280
s_add_u32 s46, s46, 4194304
s_sub_u32 s54, s59, s58
s_sub_u32 s59, s59, s57
s_mul_i32 s59, s59, 176
s_add_u32 s59, s59, 138240
v_add_u32 v33, s54, v2
v_mul_u32_u24 v34, 175, v2
v_add3_u32 v34, v34, v0, s59
s_mov_b32 s54, 2656
s_mov_b32 s58, 1120
v_mul_u32_u24 v31, 410, v0
v_lshrrev_b32 v31, 16, v31
v_lshl_add_u32 v32, v31, 4, v33
v_cmp_gt_u32 vcc, s60, v32
v_mad_u32_u24 v32, v31, s58, v0
v_mad_u32_u24 v15, v31, s54, v34
v_lshlrev_b32 v32, 4, v32
v_cndmask_b32 v11, v255, v32, vcc
v_add_u32 v30, 256, v0
v_mul_u32_u24 v31, 410, v30
v_lshrrev_b32 v31, 16, v31
v_lshl_add_u32 v32, v31, 4, v33
v_cmp_gt_u32 vcc, s60, v32
v_mad_u32_u24 v32, v31, s58, v30
v_mad_u32_u24 v16, v31, s54, v34
v_lshlrev_b32 v32, 4, v32
v_cndmask_b32 v12, v255, v32, vcc
v_add_u32 v30, 512, v0
v_mul_u32_u24 v31, 410, v30
v_lshrrev_b32 v31, 16, v31
v_lshl_add_u32 v32, v31, 4, v33
v_cmp_gt_u32 vcc, s60, v32
v_mad_u32_u24 v32, v31, s58, v30
v_mad_u32_u24 v17, v31, s54, v34
v_lshlrev_b32 v32, 4, v32
v_cndmask_b32 v13, v255, v32, vcc
v_add_u32 v30, 768, v0
v_mul_u32_u24 v31, 410, v30
v_lshrrev_b32 v31, 16, v31
v_lshl_add_u32 v32, v31, 4, v33
v_cmp_gt_u32 vcc, s60, v32
v_mad_u32_u24 v32, v31, s58, v30
v_mad_u32_u24 v18, v31, s54, v34
v_lshlrev_b32 v32, 4, v32
v_cndmask_b32 v14, v255, v32, vcc
s_mul_i32 s58, s3, 80
v_add_u32 v30, s58, v1
s_mul_i32 s58, s3, 1280
s_add_u32 s58, s58, 1024
v_lshlrev_b32 v248, 4, v30
v_lshl_add_u32 v249, v1, 2, s58
v_add_u32 v251, 158720, v248
v_add_u32 v250, 158720, v249
v_cmp_le_u32 vcc, 160, v30
v_min_u32 v247, 19, v1
v_lshlrev_b32 v247, 6, v247
v_cndmask_b32 v252, 0, 1.0, vcc
v_cmp_gt_u32 vcc, 4, v1
s_mov_b32 s56, 4096
s_mov_b32 s57, 9216
v_cndmask_b32 v246, v255, v36, vcc
s_mul_i32 s60, s44, 5120
s_mul_i32 s58, s3, 1280
s_add_u32 s60, s60, s58
s_add_u32 s60, s60, 851968
s_mov_b32 s58, 14336
v_lshlrev_b32 v30, 12, v3
v_lshl_add_u32 v30, v2, 4, v30
v_add_u32 v5, s49, v30
v_lshrrev_b32 v32, 2, v2
v_cmp_ne_u32 vcc, 1, v32
v_lshrrev_b32 v30, 4, v0
v_and_b32 v31, 7, v2
v_cndmask_b32 v6, v255, v5, vcc
v_xor_b32 v30, v30, v31
v_lshlrev_b32 v30, 4, v30
v_and_b32 v33, 3, v2
v_lshl_add_u32 v30, v33, 8, v30
v_mul_u32_u24 v32, 5120, v32
s_mov_b32 s54, 56320
v_add3_u32 v30, v30, v32, s54
s_bfe_u32 s63, s62, 262144
s_lshl_b32 s63, s63, 10
v_add_u32 v7, s63, v30
s_bfe_u32 s63, s62, 262148
s_lshl_b32 s63, s63, 10
v_add_u32 v253, s63, v30
s_bfe_u32 s63, s62, 262152
s_lshl_b32 s63, s63, 10
v_add_u32 v254, s63, v30
s_bfe_u32 s63, s62, 262156
s_lshl_b32 s63, s63, 10
v_add_u32 v244, s63, v30
s_bfe_u32 s63, s62, 262160
s_lshl_b32 s63, s63, 10
v_add_u32 v245, s63, v30
v_xor_b32 v30, v2, v3
v_lshlrev_b32 v30, 4, v30
v_lshl_add_u32 v8, v3, 8, v30
v_xor_b32 v9, 64, v8
v_add_u32 v8, s54, v8
v_add_u32 v9, s54, v9
v_lshlrev_b32 v10, 5, v2
v_add_u32 v10, 158720, v10
s_mul_i32 s59, s44, 327680
s_add_u32 s59, s59, 1048576
s_cmp_eq_u32 s96, 6
s_cselect_b32 s16, 0x80, 0
s_cselect_b32 s17, 16, 24
s_mov_b32 s37, 2368
s_mov_b32 s38, 1088
v_mul_u32_u24 v31, 5462, v1
v_lshrrev_b32 v31, 16, v31
v_mad_u32_u24 v32, v31, s37, v36
v_mad_u32_u24 v33, v31, s38, v36
v_lshlrev_b32 v31, 2, v31
v_and_b32 v34, s16, v32
v_bitop3_b32 v33, v33, v31, 32 bitop3:0x78
v_lshl_or_b32 v235, v34, 23, v32
v_lshl_or_b32 v232, v34, 23, v33
v_add_u32 v30, 64, v1
v_mul_u32_u24 v31, 5462, v30
v_lshrrev_b32 v31, 16, v31
v_mad_u32_u24 v32, v31, s37, v36
v_mad_u32_u24 v33, v31, s38, v36
v_lshlrev_b32 v31, 2, v31
v_and_b32 v34, s16, v32
v_bitop3_b32 v33, v33, v31, 32 bitop3:0x78
v_lshl_or_b32 v236, v34, 23, v32
v_lshl_or_b32 v233, v34, 23, v33
v_add_u32 v30, 128, v1
v_mul_u32_u24 v31, 5462, v30
v_lshrrev_b32 v31, 16, v31
v_mad_u32_u24 v32, v31, s37, v36
v_mad_u32_u24 v33, v31, s38, v36
v_lshlrev_b32 v31, 2, v31
v_and_b32 v34, s16, v32
v_bitop3_b32 v33, v33, v31, 32 bitop3:0x78
v_lshl_or_b32 v237, v34, 23, v32
v_lshl_or_b32 v234, v34, 23, v33
s_lshl_b32 s100, s100, 3
s_add_u32 s100, s100, s44
s_lshl_b32 s100, s100, 6
s_add_u32 s100, s100, 917504
s_and_b32 s37, s47, 15
s_lshl_b32 s37, s37, 6
s_max_u32 s37, s37, 7
s_sub_u32 s37, s37, 7
s_mul_i32 s37, s37, 899
s_lshr_b32 s37, s37, 16
s_min_u32 s37, s37, 12
s_add_u32 s37, s37, s36
s_lshl_b32 s101, s37, 3
s_bfe_u32 s37, s42, 0x10001
s_mul_i32 s37, s37, 7
s_add_u32 s37, s37, s36
s_lshl_b32 s37, s37, 3
s_and_b32 s38, s42, 1
s_mul_i32 s38, s38, 4
s_add_u32 s21, s37, s38
s_sub_u32 s20, s43, s96
s_getreg_b32 s19, hwreg(HW_REG_XCC_ID, 0, 4)
v_cmp_le_u32 vcc, 24, v1
v_subrev_u32 v30, 24, v1
v_mov_b32 v32, 0xa00
v_cndmask_b32 v30, v1, v30, vcc
v_cndmask_b32 v32, 0, v32, vcc
v_cmp_gt_u32 vcc, s17, v30
v_lshl_add_u32 v32, v30, 4, v32
v_lshlrev_b32 v31, 3, v30
v_cndmask_b32 v238, v255, v32, vcc
v_cndmask_b32 v239, v255, v31, vcc
v_cndmask_b32 v230, 0, -1, vcc
v_min_u32 v30, 6, v2
v_add_u32 v30, s20, v30
v_and_b32 v31, 3, v30
v_lshrrev_b32 v30, 2, v30
v_lshl_add_u32 v30, v30, 3, v31
v_cmp_gt_u32 vcc, 16, v1
v_add_u32 v30, s21, v30
v_add_u32 v31, s101, v1
v_cndmask_b32 v30, v30, v31, vcc
v_lshlrev_b32 v231, 6, v30
s_mul_i32 s37, s96, 192
s_mul_i32 s48, s3, 20480
s_add_u32 s48, s48, s37
s_and_b32 s99, s47, 0
s_mul_i32 s99, s99, 0
s_mul_i32 s37, s99, 163840
s_add_u32 s48, s48, s37
s_mul_i32 s39, s3, 3072
s_lshl_b32 s18, s47, 11
s_andn2_b32 s37, s18, 8191
s_add_u32 s18, s18, s37
s_lshl_b32 s37, s96, 8
s_add_u32 s18, s18, s37
s_lshl_b32 s37, s3, 6
s_add_u32 s18, s18, s37
s_add_u32 s18, s18, 7733248
v_accvgpr_write_b32 a232, -1
v_accvgpr_write_b32 a233, -1
v_accvgpr_write_b32 a234, -1
v_accvgpr_write_b32 a235, -1
v_lshrrev_b32 v30, 2, v2
v_cmp_eq_u32 vcc, v30, v3
v_mov_b32 v31, 0x3f803f80
v_mov_b32 v30, 0
v_cndmask_b32 v30, v30, v31, vcc
v_accvgpr_write_b32 a236, v30
v_accvgpr_write_b32 a237, v30
v_accvgpr_write_b32 a238, v30
v_accvgpr_write_b32 a239, v30
s_cmp_ge_u32 s98, 160
s_cbranch_scc1 L_bodyM
v_bfe_u32 v30, v1, 2, 2
v_and_b32 v31, 3, v1
v_max_u32 v32, 1, v31
v_add_u32 v32, -1, v32
v_cmp_eq_u32 vcc, 3, v3
v_lshlrev_b32 v33, 3, v31
v_mul_u32_u24 v30, 3, v30
v_cndmask_b32 v32, v3, v32, vcc
v_cndmask_b32 v33, v33, 32, vcc
v_add_u32 v30, v30, v32
v_mul_u32_u24 v30, 640, v30
s_mul_i32 s54, s3, 160
v_add3_u32 v35, v30, v33, s54
s_lshl_b32 s52, s52, 2
s_add_u32 s52, s52, s3
s_mul_i32 s52, s52, 80
s_add_u32 s52, s52, s50
s_lshl_b32 s51, s52, 12
s_add_u32 s51, s51, 1048576
s_lshl_b32 s53, s52, 6
s_add_u32 s53, s53, 851968
s_waitcnt vmcnt(4)
s_mov_b32 s55, 0x3f803f80
buffer_load_dwordx4 v[120:123], v4, s[8:11], s61 offen offset:0
v_mfma_f32_16x16x32_bf16 v[20:23], a[236:239], v[100:103], 0
v_lshlrev_b32 v24, 16, v104
v_and_b32 v25, 0xffff0000, v104
v_mfma_f32_16x16x32_bf16 v[20:23], a[236:239], v[104:107], v[20:23]
v_lshlrev_b32 v26, 16, v105
v_and_b32 v27, 0xffff0000, v105
v_mfma_f32_16x16x32_bf16 v[20:23], a[236:239], v[108:111], v[20:23]
v_lshlrev_b32 v28, 16, v106
v_and_b32 v29, 0xffff0000, v106
buffer_load_dwordx4 v[124:127], v4, s[8:11], s61 offen offset:256
v_mfma_f32_16x16x32_bf16 v[20:23], a[236:239], v[112:115], v[20:23]
v_lshlrev_b32 v30, 16, v107
v_and_b32 v31, 0xffff0000, v107
v_mfma_f32_16x16x32_bf16 v[20:23], a[236:239], v[116:119], v[20:23]
v_lshlrev_b32 v88, 16, v100
v_and_b32 v89, 0xffff0000, v100
v_lshlrev_b32 v90, 16, v101
v_and_b32 v91, 0xffff0000, v101
v_dot2_f32_bf16 v96, v100, v100, 0
buffer_load_dwordx4 v[128:131], v4, s[8:11], s61 offen offset:512
v_dot2_f32_bf16 v97, v101, v101, 0
v_dot2_f32_bf16 v96, v102, v102, v96
v_dot2_f32_bf16 v97, v103, v103, v97
v_dot2_f32_bf16 v96, v104, v104, v96
v_dot2_f32_bf16 v97, v105, v105, v97
v_dot2_f32_bf16 v96, v106, v106, v96
v_dot2_f32_bf16 v97, v107, v107, v97
v_dot2_f32_bf16 v96, v108, v108, v96
v_dot2_f32_bf16 v97, v109, v109, v97
buffer_load_dwordx4 v[132:135], v4, s[8:11], s61 offen offset:768
v_dot2_f32_bf16 v96, v110, v110, v96
v_dot2_f32_bf16 v97, v111, v111, v97
v_dot2_f32_bf16 v96, v112, v112, v96
v_dot2_f32_bf16 v97, v113, v113, v97
v_dot2_f32_bf16 v96, v114, v114, v96
v_dot2_f32_bf16 v97, v115, v115, v97
v_dot2_f32_bf16 v96, v116, v116, v96
v_dot2_f32_bf16 v97, v117, v117, v97
v_dot2_f32_bf16 v96, v118, v118, v96
buffer_load_dwordx4 v[136:139], v4, s[8:11], s61 offen offset:1024
s_bfe_u32 s61, s62, 262152
s_mul_i32 s61, s61, 40960
s_add_u32 s61, s61, s45
v_dot2_f32_bf16 v97, v119, v119, v97
v_add_f32_dpp v20, v20, v20 row_ror:8 row_mask:0xf bank_mask:0xf
v_lshlrev_b32 v100, 16, v102
v_and_b32 v101, 0xffff0000, v102
v_add_f32 v96, v96, v97
v_add_f32_dpp v20, v20, v20 row_ror:4 row_mask:0xf bank_mask:0xf
v_lshlrev_b32 v102, 16, v103
v_add_f32_dpp v96, v96, v96 row_ror:8 row_mask:0xf bank_mask:0xf
v_add_f32_dpp v20, v20, v20 row_ror:2 row_mask:0xf bank_mask:0xf
v_and_b32 v103, 0xffff0000, v103
v_add_f32_dpp v96, v96, v96 row_ror:4 row_mask:0xf bank_mask:0xf
v_add_f32_dpp v20, v20, v20 row_ror:1 row_mask:0xf bank_mask:0xf
v_mul_f32 v20, 0x3acccccd, v20
v_add_f32_dpp v96, v96, v96 row_ror:2 row_mask:0xf bank_mask:0xf
s_nop 1
v_add_f32_dpp v96, v96, v96 row_ror:1 row_mask:0xf bank_mask:0xf
v_mul_f32 v96, 0x3acccccd, v96
v_fma_f32 v96, -v20, v20, v96
v_max_f32 v96, 0, v96
v_add_f32 v96, 0x3727c5ac, v96
v_rsq_f32 v96, v96
s_nop 0
v_mul_f32 v97, -v20, v96
v_pk_fma_f32 v[24:25], v[24:25], v[96:97], v[96:97] op_sel:[0,0,1] op_sel_hi:[1,0,1]
v_pk_fma_f32 v[26:27], v[26:27], v[96:97], v[96:97] op_sel:[0,0,1] op_sel_hi:[1,0,1]
v_pk_fma_f32 v[28:29], v[28:29], v[96:97], v[96:97] op_sel:[0,0,1] op_sel_hi:[1,0,1]
v_pk_fma_f32 v[30:31], v[30:31], v[96:97], v[96:97] op_sel:[0,0,1] op_sel_hi:[1,0,1]
v_cvt_pk_f16_f32 v104, v24, v25
v_cvt_pk_f16_f32 v105, v26, v27
v_cvt_pk_f16_f32 v106, v28, v29
v_cvt_pk_f16_f32 v107, v30, v31
v_lshlrev_b32 v24, 16, v108
v_and_b32 v25, 0xffff0000, v108
v_lshlrev_b32 v26, 16, v109
v_and_b32 v27, 0xffff0000, v109
v_lshlrev_b32 v28, 16, v110
v_and_b32 v29, 0xffff0000, v110
v_lshlrev_b32 v30, 16, v111
v_and_b32 v31, 0xffff0000, v111
v_pk_fma_f32 v[24:25], v[24:25], v[96:97], v[96:97] op_sel:[0,0,1] op_sel_hi:[1,0,1]
v_pk_fma_f32 v[26:27], v[26:27], v[96:97], v[96:97] op_sel:[0,0,1] op_sel_hi:[1,0,1]
v_pk_fma_f32 v[28:29], v[28:29], v[96:97], v[96:97] op_sel:[0,0,1] op_sel_hi:[1,0,1]
v_pk_fma_f32 v[30:31], v[30:31], v[96:97], v[96:97] op_sel:[0,0,1] op_sel_hi:[1,0,1]
v_cvt_pk_f16_f32 v108, v24, v25
v_cvt_pk_f16_f32 v109, v26, v27
v_cvt_pk_f16_f32 v110, v28, v29
v_cvt_pk_f16_f32 v111, v30, v31
v_lshlrev_b32 v24, 16, v112
v_and_b32 v25, 0xffff0000, v112
v_lshlrev_b32 v26, 16, v113
v_and_b32 v27, 0xffff0000, v113
v_lshlrev_b32 v28, 16, v114
v_and_b32 v29, 0xffff0000, v114
v_lshlrev_b32 v30, 16, v115
v_and_b32 v31, 0xffff0000, v115
v_pk_fma_f32 v[24:25], v[24:25], v[96:97], v[96:97] op_sel:[0,0,1] op_sel_hi:[1,0,1]
v_pk_fma_f32 v[26:27], v[26:27], v[96:97], v[96:97] op_sel:[0,0,1] op_sel_hi:[1,0,1]
v_pk_fma_f32 v[28:29], v[28:29], v[96:97], v[96:97] op_sel:[0,0,1] op_sel_hi:[1,0,1]
v_pk_fma_f32 v[30:31], v[30:31], v[96:97], v[96:97] op_sel:[0,0,1] op_sel_hi:[1,0,1]
v_cvt_pk_f16_f32 v112, v24, v25
v_cvt_pk_f16_f32 v113, v26, v27
v_cvt_pk_f16_f32 v114, v28, v29
v_cvt_pk_f16_f32 v115, v30, v31
v_lshlrev_b32 v24, 16, v116
v_and_b32 v25, 0xffff0000, v116
v_lshlrev_b32 v26, 16, v117
v_and_b32 v27, 0xffff0000, v117
v_lshlrev_b32 v28, 16, v118
v_and_b32 v29, 0xffff0000, v118
v_lshlrev_b32 v30, 16, v119
v_and_b32 v31, 0xffff0000, v119
v_pk_fma_f32 v[24:25], v[24:25], v[96:97], v[96:97] op_sel:[0,0,1] op_sel_hi:[1,0,1]
v_pk_fma_f32 v[26:27], v[26:27], v[96:97], v[96:97] op_sel:[0,0,1] op_sel_hi:[1,0,1]
v_pk_fma_f32 v[28:29], v[28:29], v[96:97], v[96:97] op_sel:[0,0,1] op_sel_hi:[1,0,1]
v_pk_fma_f32 v[30:31], v[30:31], v[96:97], v[96:97] op_sel:[0,0,1] op_sel_hi:[1,0,1]
v_pk_fma_f32 v[88:89], v[88:89], v[96:97], v[96:97] op_sel:[0,0,1] op_sel_hi:[1,0,1]
v_pk_fma_f32 v[90:91], v[90:91], v[96:97], v[96:97] op_sel:[0,0,1] op_sel_hi:[1,0,1]
v_pk_fma_f32 v[100:101], v[100:101], v[96:97], v[96:97] op_sel:[0,0,1] op_sel_hi:[1,0,1]
v_pk_fma_f32 v[102:103], v[102:103], v[96:97], v[96:97] op_sel:[0,0,1] op_sel_hi:[1,0,1]
v_cvt_pk_f16_f32 v116, v24, v25
v_cvt_pk_f16_f32 v117, v26, v27
v_cvt_pk_f16_f32 v118, v28, v29
v_cvt_pk_f16_f32 v119, v30, v31
buffer_load_dwordx4 v[140:143], v4, s[8:11], s61 offen offset:0
buffer_load_dwordx4 v[144:147], v4, s[8:11], s61 offen offset:256
buffer_load_dwordx4 v[148:151], v4, s[8:11], s61 offen offset:512
s_waitcnt vmcnt(8)
v_readfirstlane_b32 s41, v42
s_waitcnt lgkmcnt(0)
s_barrier
ds_read_b64_tr_b16 v[44:45], v35 offset:0
ds_read_b64_tr_b16 v[46:47], v35 offset:7680
ds_read_b64_tr_b16 v[48:49], v35 offset:40
ds_read_b64_tr_b16 v[50:51], v35 offset:7720
ds_read_b64_tr_b16 v[52:53], v35 offset:80
ds_read_b64_tr_b16 v[54:55], v35 offset:7760
ds_read_b64_tr_b16 v[56:57], v35 offset:120
ds_read_b64_tr_b16 v[58:59], v35 offset:7800
s_mul_i32 s40, s41, 0x9E3779B1
s_add_u32 s40, s40, 0x85EBCA6B
v_and_b32 v33, 3, v1
v_lshlrev_b32 v33, 3, v33
v_lshrrev_b32 v19, v33, s40
v_and_b32 v19, 0xff, v19
v_mov_b32 v240, s40
v_mov_b32 v241, s19
v_mov_b32 v242, s40
v_mov_b32 v243, s40
s_waitcnt lgkmcnt(6)
buffer_store_dwordx4 v[44:47], v36, s[4:7], s51 offen offset:0 sc1
s_waitcnt lgkmcnt(4)
buffer_store_dwordx4 v[48:51], v36, s[4:7], s51 offen offset:1024 sc1
s_waitcnt lgkmcnt(2)
buffer_store_dwordx4 v[52:55], v36, s[4:7], s51 offen offset:2048 sc1
s_waitcnt lgkmcnt(0)
buffer_store_dwordx4 v[56:59], v36, s[4:7], s51 offen offset:3072 sc1
buffer_load_dwordx4 v[152:155], v4, s[8:11], s61 offen offset:768
buffer_load_dwordx4 v[156:159], v4, s[8:11], s61 offen offset:1024
s_bfe_u32 s61, s62, 262156
s_mul_i32 s61, s61, 40960
s_add_u32 s61, s61, s45
s_waitcnt vmcnt(9)
s_mov_b32 s55, 0x3f803f80
buffer_load_dwordx4 v[160:163], v4, s[8:11], s61 offen offset:0
v_mfma_f32_16x16x32_bf16 v[20:23], a[236:239], v[120:123], 0
v_lshlrev_b32 v24, 16, v124
v_and_b32 v25, 0xffff0000, v124
v_mfma_f32_16x16x32_bf16 v[20:23], a[236:239], v[124:127], v[20:23]
v_lshlrev_b32 v26, 16, v125
v_and_b32 v27, 0xffff0000, v125
v_mfma_f32_16x16x32_bf16 v[20:23], a[236:239], v[128:131], v[20:23]
v_lshlrev_b32 v28, 16, v126
v_and_b32 v29, 0xffff0000, v126
v_mfma_f32_16x16x32_bf16 v[20:23], a[236:239], v[132:135], v[20:23]
v_lshlrev_b32 v30, 16, v127
v_and_b32 v31, 0xffff0000, v127
v_mfma_f32_16x16x32_bf16 v[20:23], a[236:239], v[136:139], v[20:23]
v_lshlrev_b32 v92, 16, v120
v_and_b32 v93, 0xffff0000, v120
v_lshlrev_b32 v94, 16, v121
v_and_b32 v95, 0xffff0000, v121
v_dot2_f32_bf16 v98, v120, v120, 0
v_dot2_f32_bf16 v99, v121, v121, 0
v_dot2_f32_bf16 v98, v122, v122, v98
v_dot2_f32_bf16 v99, v123, v123, v99
v_dot2_f32_bf16 v98, v124, v124, v98
v_dot2_f32_bf16 v99, v125, v125, v99
buffer_load_dwordx4 v[164:167], v4, s[8:11], s61 offen offset:256
v_dot2_f32_bf16 v98, v126, v126, v98
v_dot2_f32_bf16 v99, v127, v127, v99
v_dot2_f32_bf16 v98, v128, v128, v98
v_dot2_f32_bf16 v99, v129, v129, v99
v_dot2_f32_bf16 v98, v130, v130, v98
v_dot2_f32_bf16 v99, v131, v131, v99
v_dot2_f32_bf16 v98, v132, v132, v98
v_dot2_f32_bf16 v99, v133, v133, v99
v_dot2_f32_bf16 v98, v134, v134, v98
v_dot2_f32_bf16 v99, v135, v135, v99
v_dot2_f32_bf16 v98, v136, v136, v98
v_dot2_f32_bf16 v99, v137, v137, v99
v_dot2_f32_bf16 v98, v138, v138, v98
v_dot2_f32_bf16 v99, v139, v139, v99
v_add_f32_dpp v20, v20, v20 row_ror:8 row_mask:0xf bank_mask:0xf
v_lshlrev_b32 v120, 16, v122
v_and_b32 v121, 0xffff0000, v122
v_add_f32 v98, v98, v99
v_add_f32_dpp v20, v20, v20 row_ror:4 row_mask:0xf bank_mask:0xf
v_lshlrev_b32 v122, 16, v123
v_add_f32_dpp v98, v98, v98 row_ror:8 row_mask:0xf bank_mask:0xf
v_add_f32_dpp v20, v20, v20 row_ror:2 row_mask:0xf bank_mask:0xf
v_and_b32 v123, 0xffff0000, v123
v_add_f32_dpp v98, v98, v98 row_ror:4 row_mask:0xf bank_mask:0xf
buffer_load_dwordx4 v[168:171], v4, s[8:11], s61 offen offset:512
v_add_f32_dpp v20, v20, v20 row_ror:1 row_mask:0xf bank_mask:0xf
v_mul_f32 v20, 0x3acccccd, v20
v_add_f32_dpp v98, v98, v98 row_ror:2 row_mask:0xf bank_mask:0xf
s_nop 1
v_add_f32_dpp v98, v98, v98 row_ror:1 row_mask:0xf bank_mask:0xf
v_mul_f32 v98, 0x3acccccd, v98
v_fma_f32 v98, -v20, v20, v98
v_max_f32 v98, 0, v98
v_add_f32 v98, 0x3727c5ac, v98
v_rsq_f32 v98, v98
s_nop 0
v_mul_f32 v99, -v20, v98
v_pk_fma_f32 v[24:25], v[24:25], v[98:99], v[98:99] op_sel:[0,0,1] op_sel_hi:[1,0,1]
v_pk_fma_f32 v[26:27], v[26:27], v[98:99], v[98:99] op_sel:[0,0,1] op_sel_hi:[1,0,1]
v_pk_fma_f32 v[28:29], v[28:29], v[98:99], v[98:99] op_sel:[0,0,1] op_sel_hi:[1,0,1]
v_pk_fma_f32 v[30:31], v[30:31], v[98:99], v[98:99] op_sel:[0,0,1] op_sel_hi:[1,0,1]
v_cvt_pk_f16_f32 v124, v24, v25
v_cvt_pk_f16_f32 v125, v26, v27
v_cvt_pk_f16_f32 v126, v28, v29
v_cvt_pk_f16_f32 v127, v30, v31
v_lshlrev_b32 v24, 16, v128
v_and_b32 v25, 0xffff0000, v128
v_lshlrev_b32 v26, 16, v129
v_and_b32 v27, 0xffff0000, v129
v_lshlrev_b32 v28, 16, v130
buffer_load_dwordx4 v[172:175], v4, s[8:11], s61 offen offset:768
v_and_b32 v29, 0xffff0000, v130
v_lshlrev_b32 v30, 16, v131
v_and_b32 v31, 0xffff0000, v131
v_pk_fma_f32 v[24:25], v[24:25], v[98:99], v[98:99] op_sel:[0,0,1] op_sel_hi:[1,0,1]
v_pk_fma_f32 v[26:27], v[26:27], v[98:99], v[98:99] op_sel:[0,0,1] op_sel_hi:[1,0,1]
v_pk_fma_f32 v[28:29], v[28:29], v[98:99], v[98:99] op_sel:[0,0,1] op_sel_hi:[1,0,1]
v_pk_fma_f32 v[30:31], v[30:31], v[98:99], v[98:99] op_sel:[0,0,1] op_sel_hi:[1,0,1]
v_cvt_pk_f16_f32 v128, v24, v25
v_cvt_pk_f16_f32 v129, v26, v27
v_cvt_pk_f16_f32 v130, v28, v29
v_cvt_pk_f16_f32 v131, v30, v31
v_lshlrev_b32 v24, 16, v132
v_and_b32 v25, 0xffff0000, v132
v_lshlrev_b32 v26, 16, v133
v_and_b32 v27, 0xffff0000, v133
v_lshlrev_b32 v28, 16, v134
v_and_b32 v29, 0xffff0000, v134
v_lshlrev_b32 v30, 16, v135
v_and_b32 v31, 0xffff0000, v135
v_pk_fma_f32 v[24:25], v[24:25], v[98:99], v[98:99] op_sel:[0,0,1] op_sel_hi:[1,0,1]
v_pk_fma_f32 v[26:27], v[26:27], v[98:99], v[98:99] op_sel:[0,0,1] op_sel_hi:[1,0,1]
v_pk_fma_f32 v[28:29], v[28:29], v[98:99], v[98:99] op_sel:[0,0,1] op_sel_hi:[1,0,1]
v_pk_fma_f32 v[30:31], v[30:31], v[98:99], v[98:99] op_sel:[0,0,1] op_sel_hi:[1,0,1]
buffer_load_dwordx4 v[176:179], v4, s[8:11], s61 offen offset:1024
s_bfe_u32 s61, s62, 262160
s_mul_i32 s61, s61, 40960
s_add_u32 s61, s61, s45
v_cvt_pk_f16_f32 v132, v24, v25
v_cvt_pk_f16_f32 v133, v26, v27
v_cvt_pk_f16_f32 v134, v28, v29
v_cvt_pk_f16_f32 v135, v30, v31
v_lshlrev_b32 v24, 16, v136
v_and_b32 v25, 0xffff0000, v136
v_lshlrev_b32 v26, 16, v137
v_and_b32 v27, 0xffff0000, v137
v_lshlrev_b32 v28, 16, v138
v_and_b32 v29, 0xffff0000, v138
v_lshlrev_b32 v30, 16, v139
v_and_b32 v31, 0xffff0000, v139
v_pk_fma_f32 v[24:25], v[24:25], v[98:99], v[98:99] op_sel:[0,0,1] op_sel_hi:[1,0,1]
v_pk_fma_f32 v[26:27], v[26:27], v[98:99], v[98:99] op_sel:[0,0,1] op_sel_hi:[1,0,1]
v_pk_fma_f32 v[28:29], v[28:29], v[98:99], v[98:99] op_sel:[0,0,1] op_sel_hi:[1,0,1]
v_pk_fma_f32 v[30:31], v[30:31], v[98:99], v[98:99] op_sel:[0,0,1] op_sel_hi:[1,0,1]
v_pk_fma_f32 v[92:93], v[92:93], v[98:99], v[98:99] op_sel:[0,0,1] op_sel_hi:[1,0,1]
v_pk_fma_f32 v[94:95], v[94:95], v[98:99], v[98:99] op_sel:[0,0,1] op_sel_hi:[1,0,1]
v_pk_fma_f32 v[120:121], v[120:121], v[98:99], v[98:99] op_sel:[0,0,1] op_sel_hi:[1,0,1]
v_pk_fma_f32 v[122:123], v[122:123], v[98:99], v[98:99] op_sel:[0,0,1] op_sel_hi:[1,0,1]
v_cvt_pk_f16_f32 v136, v24, v25
v_cvt_pk_f16_f32 v137, v26, v27
v_cvt_pk_f16_f32 v138, v28, v29
v_cvt_pk_f16_f32 v139, v30, v31
s_waitcnt vmcnt(7)
buffer_store_dwordx4 v[240:243], v246, s[4:7], s53 offen sc1
s_barrier
s_waitcnt vmcnt(6)
s_mov_b32 s55, 0x3f803f80
buffer_load_dwordx4 v[180:183], v4, s[8:11], s61 offen offset:0
v_mfma_f32_16x16x32_bf16 v[20:23], a[236:239], v[140:143], 0
v_lshlrev_b32 v24, 16, v144
v_and_b32 v25, 0xffff0000, v144
v_mfma_f32_16x16x32_bf16 v[20:23], a[236:239], v[144:147], v[20:23]
v_lshlrev_b32 v26, 16, v145
v_and_b32 v27, 0xffff0000, v145
v_mfma_f32_16x16x32_bf16 v[20:23], a[236:239], v[148:151], v[20:23]
v_lshlrev_b32 v28, 16, v146
v_and_b32 v29, 0xffff0000, v146
v_mfma_f32_16x16x32_bf16 v[20:23], a[236:239], v[152:155], v[20:23]
buffer_load_dwordx4 v[184:187], v4, s[8:11], s61 offen offset:256
v_lshlrev_b32 v30, 16, v147
v_and_b32 v31, 0xffff0000, v147
v_mfma_f32_16x16x32_bf16 v[20:23], a[236:239], v[156:159], v[20:23]
v_lshlrev_b32 v72, 16, v140
v_and_b32 v73, 0xffff0000, v140
v_lshlrev_b32 v74, 16, v141
v_and_b32 v75, 0xffff0000, v141
v_dot2_f32_bf16 v84, v140, v140, 0
v_dot2_f32_bf16 v85, v141, v141, 0
v_dot2_f32_bf16 v84, v142, v142, v84
v_dot2_f32_bf16 v85, v143, v143, v85
buffer_load_dwordx4 v[188:191], v4, s[8:11], s61 offen offset:512
v_dot2_f32_bf16 v84, v144, v144, v84
v_dot2_f32_bf16 v85, v145, v145, v85
v_dot2_f32_bf16 v84, v146, v146, v84
v_dot2_f32_bf16 v85, v147, v147, v85
v_dot2_f32_bf16 v84, v148, v148, v84
v_dot2_f32_bf16 v85, v149, v149, v85
v_dot2_f32_bf16 v84, v150, v150, v84
v_dot2_f32_bf16 v85, v151, v151, v85
v_dot2_f32_bf16 v84, v152, v152, v84
v_dot2_f32_bf16 v85, v153, v153, v85
v_dot2_f32_bf16 v84, v154, v154, v84
buffer_load_dwordx4 v[192:195], v4, s[8:11], s61 offen offset:768
v_dot2_f32_bf16 v85, v155, v155, v85
v_dot2_f32_bf16 v84, v156, v156, v84
v_dot2_f32_bf16 v85, v157, v157, v85
v_dot2_f32_bf16 v84, v158, v158, v84
v_dot2_f32_bf16 v85, v159, v159, v85
v_add_f32_dpp v20, v20, v20 row_ror:8 row_mask:0xf bank_mask:0xf
v_lshlrev_b32 v140, 16, v142
v_and_b32 v141, 0xffff0000, v142
v_add_f32 v84, v84, v85
v_add_f32_dpp v20, v20, v20 row_ror:4 row_mask:0xf bank_mask:0xf
buffer_load_dwordx4 v[196:199], v4, s[8:11], s61 offen offset:1024
v_lshlrev_b32 v142, 16, v143
v_add_f32_dpp v84, v84, v84 row_ror:8 row_mask:0xf bank_mask:0xf
v_add_f32_dpp v20, v20, v20 row_ror:2 row_mask:0xf bank_mask:0xf
v_and_b32 v143, 0xffff0000, v143
v_add_f32_dpp v84, v84, v84 row_ror:4 row_mask:0xf bank_mask:0xf
v_add_f32_dpp v20, v20, v20 row_ror:1 row_mask:0xf bank_mask:0xf
v_mul_f32 v20, 0x3acccccd, v20
v_add_f32_dpp v84, v84, v84 row_ror:2 row_mask:0xf bank_mask:0xf
s_nop 1
v_add_f32_dpp v84, v84, v84 row_ror:1 row_mask:0xf bank_mask:0xf
v_mul_f32 v84, 0x3acccccd, v84
v_fma_f32 v84, -v20, v20, v84
s_add_u32 m0, s39, 0
s_nop 0
buffer_load_dwordx4 v232, s[24:27], s48 offen offset:0 lds
v_max_f32 v84, 0, v84
v_add_f32 v84, 0x3727c5ac, v84
v_rsq_f32 v84, v84
s_nop 0
v_mul_f32 v85, -v20, v84
v_pk_fma_f32 v[24:25], v[24:25], v[84:85], v[84:85] op_sel:[0,0,1] op_sel_hi:[1,0,1]
v_pk_fma_f32 v[26:27], v[26:27], v[84:85], v[84:85] op_sel:[0,0,1] op_sel_hi:[1,0,1]
v_pk_fma_f32 v[28:29], v[28:29], v[84:85], v[84:85] op_sel:[0,0,1] op_sel_hi:[1,0,1]
v_pk_fma_f32 v[30:31], v[30:31], v[84:85], v[84:85] op_sel:[0,0,1] op_sel_hi:[1,0,1]
v_cvt_pk_f16_f32 v144, v24, v25
v_cvt_pk_f16_f32 v145, v26, v27
buffer_load_dwordx4 v233, s[24:27], s48 offen offset:1024 lds
v_cvt_pk_f16_f32 v146, v28, v29
v_cvt_pk_f16_f32 v147, v30, v31
v_lshlrev_b32 v24, 16, v148
v_and_b32 v25, 0xffff0000, v148
v_lshlrev_b32 v26, 16, v149
v_and_b32 v27, 0xffff0000, v149
v_lshlrev_b32 v28, 16, v150
v_and_b32 v29, 0xffff0000, v150
v_lshlrev_b32 v30, 16, v151
v_and_b32 v31, 0xffff0000, v151
v_pk_fma_f32 v[24:25], v[24:25], v[84:85], v[84:85] op_sel:[0,0,1] op_sel_hi:[1,0,1]
buffer_load_dwordx4 v234, s[24:27], s48 offen offset:2048 lds
s_add_u32 s48, s48, 81920
v_pk_fma_f32 v[26:27], v[26:27], v[84:85], v[84:85] op_sel:[0,0,1] op_sel_hi:[1,0,1]
v_pk_fma_f32 v[28:29], v[28:29], v[84:85], v[84:85] op_sel:[0,0,1] op_sel_hi:[1,0,1]
v_pk_fma_f32 v[30:31], v[30:31], v[84:85], v[84:85] op_sel:[0,0,1] op_sel_hi:[1,0,1]
v_cvt_pk_f16_f32 v148, v24, v25
v_cvt_pk_f16_f32 v149, v26, v27
v_cvt_pk_f16_f32 v150, v28, v29
v_cvt_pk_f16_f32 v151, v30, v31
v_lshlrev_b32 v24, 16, v152
v_and_b32 v25, 0xffff0000, v152
v_lshlrev_b32 v26, 16, v153
v_and_b32 v27, 0xffff0000, v153
s_add_u32 m0, s39, 12288
s_nop 0
buffer_load_dwordx4 v232, s[24:27], s48 offen offset:0 lds
v_lshlrev_b32 v28, 16, v154
v_and_b32 v29, 0xffff0000, v154
v_lshlrev_b32 v30, 16, v155
v_and_b32 v31, 0xffff0000, v155
v_pk_fma_f32 v[24:25], v[24:25], v[84:85], v[84:85] op_sel:[0,0,1] op_sel_hi:[1,0,1]
v_pk_fma_f32 v[26:27], v[26:27], v[84:85], v[84:85] op_sel:[0,0,1] op_sel_hi:[1,0,1]
v_pk_fma_f32 v[28:29], v[28:29], v[84:85], v[84:85] op_sel:[0,0,1] op_sel_hi:[1,0,1]
v_pk_fma_f32 v[30:31], v[30:31], v[84:85], v[84:85] op_sel:[0,0,1] op_sel_hi:[1,0,1]
v_cvt_pk_f16_f32 v152, v24, v25
v_cvt_pk_f16_f32 v153, v26, v27
buffer_load_dwordx4 v233, s[24:27], s48 offen offset:1024 lds
v_cvt_pk_f16_f32 v154, v28, v29
v_cvt_pk_f16_f32 v155, v30, v31
v_lshlrev_b32 v24, 16, v156
v_and_b32 v25, 0xffff0000, v156
v_lshlrev_b32 v26, 16, v157
v_and_b32 v27, 0xffff0000, v157
v_lshlrev_b32 v28, 16, v158
v_and_b32 v29, 0xffff0000, v158
v_lshlrev_b32 v30, 16, v159
v_and_b32 v31, 0xffff0000, v159
v_pk_fma_f32 v[24:25], v[24:25], v[84:85], v[84:85] op_sel:[0,0,1] op_sel_hi:[1,0,1]
buffer_load_dwordx4 v234, s[24:27], s48 offen offset:2048 lds
s_add_u32 s48, s48, 81920
v_pk_fma_f32 v[26:27], v[26:27], v[84:85], v[84:85] op_sel:[0,0,1] op_sel_hi:[1,0,1]
v_pk_fma_f32 v[28:29], v[28:29], v[84:85], v[84:85] op_sel:[0,0,1] op_sel_hi:[1,0,1]
v_pk_fma_f32 v[30:31], v[30:31], v[84:85], v[84:85] op_sel:[0,0,1] op_sel_hi:[1,0,1]
v_pk_fma_f32 v[72:73], v[72:73], v[84:85], v[84:85] op_sel:[0,0,1] op_sel_hi:[1,0,1]
v_pk_fma_f32 v[74:75], v[74:75], v[84:85], v[84:85] op_sel:[0,0,1] op_sel_hi:[1,0,1]
v_pk_fma_f32 v[140:141], v[140:141], v[84:85], v[84:85] op_sel:[0,0,1] op_sel_hi:[1,0,1]
v_pk_fma_f32 v[142:143], v[142:143], v[84:85], v[84:85] op_sel:[0,0,1] op_sel_hi:[1,0,1]
v_cvt_pk_f16_f32 v156, v24, v25
v_cvt_pk_f16_f32 v157, v26, v27
v_cvt_pk_f16_f32 v158, v28, v29
v_cvt_pk_f16_f32 v159, v30, v31
s_waitcnt vmcnt(12)
s_mov_b32 s55, 0x3f803f80
buffer_store_dwordx4 a[232:235], v11, s[4:7], s46 offen sc1
v_mfma_f32_16x16x32_bf16 v[20:23], a[236:239], v[160:163], 0
v_lshlrev_b32 v24, 16, v164
v_and_b32 v25, 0xffff0000, v164
v_mfma_f32_16x16x32_bf16 v[20:23], a[236:239], v[164:167], v[20:23]
v_lshlrev_b32 v26, 16, v165
v_and_b32 v27, 0xffff0000, v165
v_mfma_f32_16x16x32_bf16 v[20:23], a[236:239], v[168:171], v[20:23]
v_lshlrev_b32 v28, 16, v166
v_and_b32 v29, 0xffff0000, v166
v_mfma_f32_16x16x32_bf16 v[20:23], a[236:239], v[172:175], v[20:23]
v_lshlrev_b32 v30, 16, v167
v_and_b32 v31, 0xffff0000, v167
v_mfma_f32_16x16x32_bf16 v[20:23], a[236:239], v[176:179], v[20:23]
v_lshlrev_b32 v76, 16, v160
v_and_b32 v77, 0xffff0000, v160
v_lshlrev_b32 v78, 16, v161
v_and_b32 v79, 0xffff0000, v161
buffer_store_dwordx4 a[232:235], v12, s[4:7], s46 offen sc1
v_dot2_f32_bf16 v86, v160, v160, 0
v_dot2_f32_bf16 v87, v161, v161, 0
v_dot2_f32_bf16 v86, v162, v162, v86
v_dot2_f32_bf16 v87, v163, v163, v87
v_dot2_f32_bf16 v86, v164, v164, v86
v_dot2_f32_bf16 v87, v165, v165, v87
v_dot2_f32_bf16 v86, v166, v166, v86
v_dot2_f32_bf16 v87, v167, v167, v87
v_dot2_f32_bf16 v86, v168, v168, v86
v_dot2_f32_bf16 v87, v169, v169, v87
v_dot2_f32_bf16 v86, v170, v170, v86
v_dot2_f32_bf16 v87, v171, v171, v87
v_dot2_f32_bf16 v86, v172, v172, v86
v_dot2_f32_bf16 v87, v173, v173, v87
v_dot2_f32_bf16 v86, v174, v174, v86
v_dot2_f32_bf16 v87, v175, v175, v87
buffer_store_dwordx4 a[232:235], v13, s[4:7], s46 offen sc1
v_dot2_f32_bf16 v86, v176, v176, v86
v_dot2_f32_bf16 v87, v177, v177, v87
v_dot2_f32_bf16 v86, v178, v178, v86
v_dot2_f32_bf16 v87, v179, v179, v87
v_add_f32_dpp v20, v20, v20 row_ror:8 row_mask:0xf bank_mask:0xf
v_lshlrev_b32 v160, 16, v162
v_and_b32 v161, 0xffff0000, v162
v_add_f32 v86, v86, v87
v_add_f32_dpp v20, v20, v20 row_ror:4 row_mask:0xf bank_mask:0xf
v_lshlrev_b32 v162, 16, v163
v_add_f32_dpp v86, v86, v86 row_ror:8 row_mask:0xf bank_mask:0xf
v_add_f32_dpp v20, v20, v20 row_ror:2 row_mask:0xf bank_mask:0xf
v_and_b32 v163, 0xffff0000, v163
v_add_f32_dpp v86, v86, v86 row_ror:4 row_mask:0xf bank_mask:0xf
v_add_f32_dpp v20, v20, v20 row_ror:1 row_mask:0xf bank_mask:0xf
v_mul_f32 v20, 0x3acccccd, v20
v_add_f32_dpp v86, v86, v86 row_ror:2 row_mask:0xf bank_mask:0xf
buffer_store_dwordx4 a[232:235], v14, s[4:7], s46 offen sc1
s_nop 0
v_add_f32_dpp v86, v86, v86 row_ror:1 row_mask:0xf bank_mask:0xf
v_mul_f32 v86, 0x3acccccd, v86
v_fma_f32 v86, -v20, v20, v86
v_max_f32 v86, 0, v86
v_add_f32 v86, 0x3727c5ac, v86
v_rsq_f32 v86, v86
s_nop 0
v_mul_f32 v87, -v20, v86
v_pk_fma_f32 v[24:25], v[24:25], v[86:87], v[86:87] op_sel:[0,0,1] op_sel_hi:[1,0,1]
v_pk_fma_f32 v[26:27], v[26:27], v[86:87], v[86:87] op_sel:[0,0,1] op_sel_hi:[1,0,1]
v_pk_fma_f32 v[28:29], v[28:29], v[86:87], v[86:87] op_sel:[0,0,1] op_sel_hi:[1,0,1]
v_pk_fma_f32 v[30:31], v[30:31], v[86:87], v[86:87] op_sel:[0,0,1] op_sel_hi:[1,0,1]
v_cvt_pk_f16_f32 v164, v24, v25
v_cvt_pk_f16_f32 v165, v26, v27
v_cvt_pk_f16_f32 v166, v28, v29
v_cvt_pk_f16_f32 v167, v30, v31
v_lshlrev_b32 v24, 16, v168
v_and_b32 v25, 0xffff0000, v168
buffer_store_dwordx4 a[232:235], v246, s[4:7], s18 offen sc1
v_lshlrev_b32 v26, 16, v169
v_and_b32 v27, 0xffff0000, v169
v_lshlrev_b32 v28, 16, v170
v_and_b32 v29, 0xffff0000, v170
v_lshlrev_b32 v30, 16, v171
v_and_b32 v31, 0xffff0000, v171
v_pk_fma_f32 v[24:25], v[24:25], v[86:87], v[86:87] op_sel:[0,0,1] op_sel_hi:[1,0,1]
v_pk_fma_f32 v[26:27], v[26:27], v[86:87], v[86:87] op_sel:[0,0,1] op_sel_hi:[1,0,1]
v_pk_fma_f32 v[28:29], v[28:29], v[86:87], v[86:87] op_sel:[0,0,1] op_sel_hi:[1,0,1]
v_pk_fma_f32 v[30:31], v[30:31], v[86:87], v[86:87] op_sel:[0,0,1] op_sel_hi:[1,0,1]
v_cvt_pk_f16_f32 v168, v24, v25
v_cvt_pk_f16_f32 v169, v26, v27
v_cvt_pk_f16_f32 v170, v28, v29
v_cvt_pk_f16_f32 v171, v30, v31
v_lshlrev_b32 v24, 16, v172
v_and_b32 v25, 0xffff0000, v172
s_add_u32 s37, s18, 8192
buffer_store_dwordx4 a[232:235], v246, s[4:7], s37 offen sc1
v_lshlrev_b32 v26, 16, v173
v_and_b32 v27, 0xffff0000, v173
v_lshlrev_b32 v28, 16, v174
v_and_b32 v29, 0xffff0000, v174
v_lshlrev_b32 v30, 16, v175
v_and_b32 v31, 0xffff0000, v175
v_pk_fma_f32 v[24:25], v[24:25], v[86:87], v[86:87] op_sel:[0,0,1] op_sel_hi:[1,0,1]
v_pk_fma_f32 v[26:27], v[26:27], v[86:87], v[86:87] op_sel:[0,0,1] op_sel_hi:[1,0,1]
v_pk_fma_f32 v[28:29], v[28:29], v[86:87], v[86:87] op_sel:[0,0,1] op_sel_hi:[1,0,1]
v_pk_fma_f32 v[30:31], v[30:31], v[86:87], v[86:87] op_sel:[0,0,1] op_sel_hi:[1,0,1]
v_cvt_pk_f16_f32 v172, v24, v25
v_cvt_pk_f16_f32 v173, v26, v27
v_cvt_pk_f16_f32 v174, v28, v29
v_cvt_pk_f16_f32 v175, v30, v31
v_lshlrev_b32 v24, 16, v176
v_and_b32 v25, 0xffff0000, v176
v_lshlrev_b32 v26, 16, v177
s_lshl_b32 s37, s47, 2
s_add_u32 s37, s37, s3
s_lshl_b32 s37, s37, 3
s_add_u32 s37, s37, s96
s_lshl_b32 s37, s37, 8
s_add_u32 s37, s37, 131072
v_lshlrev_b32 v69, 2, v1
v_xor_b32 v70, 0xff, v19
buffer_store_dword v70, v69, s[4:7], s37 offen sc1
v_and_b32 v27, 0xffff0000, v177
v_lshlrev_b32 v28, 16, v178
v_and_b32 v29, 0xffff0000, v178
v_lshlrev_b32 v30, 16, v179
v_and_b32 v31, 0xffff0000, v179
v_pk_fma_f32 v[24:25], v[24:25], v[86:87], v[86:87] op_sel:[0,0,1] op_sel_hi:[1,0,1]
v_pk_fma_f32 v[26:27], v[26:27], v[86:87], v[86:87] op_sel:[0,0,1] op_sel_hi:[1,0,1]
v_pk_fma_f32 v[28:29], v[28:29], v[86:87], v[86:87] op_sel:[0,0,1] op_sel_hi:[1,0,1]
v_pk_fma_f32 v[30:31], v[30:31], v[86:87], v[86:87] op_sel:[0,0,1] op_sel_hi:[1,0,1]
v_pk_fma_f32 v[76:77], v[76:77], v[86:87], v[86:87] op_sel:[0,0,1] op_sel_hi:[1,0,1]
v_pk_fma_f32 v[78:79], v[78:79], v[86:87], v[86:87] op_sel:[0,0,1] op_sel_hi:[1,0,1]
v_pk_fma_f32 v[160:161], v[160:161], v[86:87], v[86:87] op_sel:[0,0,1] op_sel_hi:[1,0,1]
v_pk_fma_f32 v[162:163], v[162:163], v[86:87], v[86:87] op_sel:[0,0,1] op_sel_hi:[1,0,1]
v_cvt_pk_f16_f32 v176, v24, v25
v_cvt_pk_f16_f32 v177, v26, v27
v_cvt_pk_f16_f32 v178, v28, v29
v_cvt_pk_f16_f32 v179, v30, v31
buffer_load_dwordx4 v[40:43], v248, s[4:7], s56 offen sc1
s_waitcnt vmcnt(14)
s_mov_b32 s55, 0x3f803f80
v_mfma_f32_16x16x32_bf16 v[20:23], a[236:239], v[180:183], 0
v_lshlrev_b32 v24, 16, v184
v_and_b32 v25, 0xffff0000, v184
v_mfma_f32_16x16x32_bf16 v[20:23], a[236:239], v[184:187], v[20:23]
v_lshlrev_b32 v26, 16, v185
v_and_b32 v27, 0xffff0000, v185
v_mfma_f32_16x16x32_bf16 v[20:23], a[236:239], v[188:191], v[20:23]
buffer_load_dwordx4 v[44:47], v248, s[4:7], s57 offen sc1
v_lshlrev_b32 v28, 16, v186
v_and_b32 v29, 0xffff0000, v186
v_mfma_f32_16x16x32_bf16 v[20:23], a[236:239], v[192:195], v[20:23]
v_lshlrev_b32 v30, 16, v187
v_and_b32 v31, 0xffff0000, v187
v_mfma_f32_16x16x32_bf16 v[20:23], a[236:239], v[196:199], v[20:23]
v_lshlrev_b32 v80, 16, v180
v_and_b32 v81, 0xffff0000, v180
v_lshlrev_b32 v82, 16, v181
buffer_load_dwordx4 v[48:51], v248, s[4:7], s58 offen sc1
v_and_b32 v83, 0xffff0000, v181
v_dot2_f32_bf16 v66, v180, v180, 0
v_dot2_f32_bf16 v67, v181, v181, 0
v_dot2_f32_bf16 v66, v182, v182, v66
v_dot2_f32_bf16 v67, v183, v183, v67
v_dot2_f32_bf16 v66, v184, v184, v66
v_dot2_f32_bf16 v67, v185, v185, v67
v_dot2_f32_bf16 v66, v186, v186, v66
v_dot2_f32_bf16 v67, v187, v187, v67
buffer_load_dword v52, v249, s[4:7], s56 offen sc1
v_dot2_f32_bf16 v66, v188, v188, v66
v_dot2_f32_bf16 v67, v189, v189, v67
v_dot2_f32_bf16 v66, v190, v190, v66
v_dot2_f32_bf16 v67, v191, v191, v67
v_dot2_f32_bf16 v66, v192, v192, v66
v_dot2_f32_bf16 v67, v193, v193, v67
v_dot2_f32_bf16 v66, v194, v194, v66
v_dot2_f32_bf16 v67, v195, v195, v67
v_dot2_f32_bf16 v66, v196, v196, v66
buffer_load_dword v53, v249, s[4:7], s57 offen sc1
v_dot2_f32_bf16 v67, v197, v197, v67
v_dot2_f32_bf16 v66, v198, v198, v66
v_dot2_f32_bf16 v67, v199, v199, v67
v_add_f32_dpp v20, v20, v20 row_ror:8 row_mask:0xf bank_mask:0xf
v_lshlrev_b32 v180, 16, v182
v_and_b32 v181, 0xffff0000, v182
v_add_f32 v66, v66, v67
v_add_f32_dpp v20, v20, v20 row_ror:4 row_mask:0xf bank_mask:0xf
v_lshlrev_b32 v182, 16, v183
buffer_load_dword v54, v249, s[4:7], s58 offen sc1
v_add_f32_dpp v66, v66, v66 row_ror:8 row_mask:0xf bank_mask:0xf
v_add_f32_dpp v20, v20, v20 row_ror:2 row_mask:0xf bank_mask:0xf
v_and_b32 v183, 0xffff0000, v183
v_add_f32_dpp v66, v66, v66 row_ror:4 row_mask:0xf bank_mask:0xf
v_add_f32_dpp v20, v20, v20 row_ror:1 row_mask:0xf bank_mask:0xf
v_mul_f32 v20, 0x3acccccd, v20
v_add_f32_dpp v66, v66, v66 row_ror:2 row_mask:0xf bank_mask:0xf
s_nop 1
v_add_f32_dpp v66, v66, v66 row_ror:1 row_mask:0xf bank_mask:0xf
v_mul_f32 v66, 0x3acccccd, v66
buffer_load_dword v71, v247, s[4:7], s60 offen sc1
v_fma_f32 v66, -v20, v20, v66
v_max_f32 v66, 0, v66
v_add_f32 v66, 0x3727c5ac, v66
v_rsq_f32 v66, v66
s_nop 0
v_mul_f32 v67, -v20, v66
v_pk_fma_f32 v[24:25], v[24:25], v[66:67], v[66:67] op_sel:[0,0,1] op_sel_hi:[1,0,1]
v_pk_fma_f32 v[26:27], v[26:27], v[66:67], v[66:67] op_sel:[0,0,1] op_sel_hi:[1,0,1]
v_pk_fma_f32 v[28:29], v[28:29], v[66:67], v[66:67] op_sel:[0,0,1] op_sel_hi:[1,0,1]
v_pk_fma_f32 v[30:31], v[30:31], v[66:67], v[66:67] op_sel:[0,0,1] op_sel_hi:[1,0,1]
v_cvt_pk_f16_f32 v184, v24, v25
s_add_u32 m0, s39, 24576
s_nop 0
buffer_load_dwordx4 v232, s[24:27], s48 offen offset:0 lds
v_cvt_pk_f16_f32 v185, v26, v27
v_cvt_pk_f16_f32 v186, v28, v29
v_cvt_pk_f16_f32 v187, v30, v31
v_lshlrev_b32 v24, 16, v188
v_and_b32 v25, 0xffff0000, v188
v_lshlrev_b32 v26, 16, v189
v_and_b32 v27, 0xffff0000, v189
v_lshlrev_b32 v28, 16, v190
v_and_b32 v29, 0xffff0000, v190
buffer_load_dwordx4 v233, s[24:27], s48 offen offset:1024 lds
v_lshlrev_b32 v30, 16, v191
v_and_b32 v31, 0xffff0000, v191
v_pk_fma_f32 v[24:25], v[24:25], v[66:67], v[66:67] op_sel:[0,0,1] op_sel_hi:[1,0,1]
v_pk_fma_f32 v[26:27], v[26:27], v[66:67], v[66:67] op_sel:[0,0,1] op_sel_hi:[1,0,1]
v_pk_fma_f32 v[28:29], v[28:29], v[66:67], v[66:67] op_sel:[0,0,1] op_sel_hi:[1,0,1]
v_pk_fma_f32 v[30:31], v[30:31], v[66:67], v[66:67] op_sel:[0,0,1] op_sel_hi:[1,0,1]
v_cvt_pk_f16_f32 v188, v24, v25
v_cvt_pk_f16_f32 v189, v26, v27
v_cvt_pk_f16_f32 v190, v28, v29
buffer_load_dwordx4 v234, s[24:27], s48 offen offset:2048 lds
s_add_u32 s48, s48, 81920
v_cvt_pk_f16_f32 v191, v30, v31
v_lshlrev_b32 v24, 16, v192
v_and_b32 v25, 0xffff0000, v192
v_lshlrev_b32 v26, 16, v193
v_and_b32 v27, 0xffff0000, v193
v_lshlrev_b32 v28, 16, v194
v_and_b32 v29, 0xffff0000, v194
v_lshlrev_b32 v30, 16, v195
v_and_b32 v31, 0xffff0000, v195
s_add_u32 m0, s39, 36864
s_nop 0
buffer_load_dwordx4 v232, s[24:27], s48 offen offset:0 lds
v_pk_fma_f32 v[24:25], v[24:25], v[66:67], v[66:67] op_sel:[0,0,1] op_sel_hi:[1,0,1]
v_pk_fma_f32 v[26:27], v[26:27], v[66:67], v[66:67] op_sel:[0,0,1] op_sel_hi:[1,0,1]
v_pk_fma_f32 v[28:29], v[28:29], v[66:67], v[66:67] op_sel:[0,0,1] op_sel_hi:[1,0,1]
v_pk_fma_f32 v[30:31], v[30:31], v[66:67], v[66:67] op_sel:[0,0,1] op_sel_hi:[1,0,1]
v_cvt_pk_f16_f32 v192, v24, v25
v_cvt_pk_f16_f32 v193, v26, v27
v_cvt_pk_f16_f32 v194, v28, v29
v_cvt_pk_f16_f32 v195, v30, v31
v_lshlrev_b32 v24, 16, v196
buffer_load_dwordx4 v233, s[24:27], s48 offen offset:1024 lds
v_and_b32 v25, 0xffff0000, v196
v_lshlrev_b32 v26, 16, v197
v_and_b32 v27, 0xffff0000, v197
v_lshlrev_b32 v28, 16, v198
v_and_b32 v29, 0xffff0000, v198
v_lshlrev_b32 v30, 16, v199
v_and_b32 v31, 0xffff0000, v199
v_pk_fma_f32 v[24:25], v[24:25], v[66:67], v[66:67] op_sel:[0,0,1] op_sel_hi:[1,0,1]
v_pk_fma_f32 v[26:27], v[26:27], v[66:67], v[66:67] op_sel:[0,0,1] op_sel_hi:[1,0,1]
buffer_load_dwordx4 v234, s[24:27], s48 offen offset:2048 lds
s_add_u32 s48, s48, 81920
v_pk_fma_f32 v[28:29], v[28:29], v[66:67], v[66:67] op_sel:[0,0,1] op_sel_hi:[1,0,1]
v_pk_fma_f32 v[30:31], v[30:31], v[66:67], v[66:67] op_sel:[0,0,1] op_sel_hi:[1,0,1]
v_pk_fma_f32 v[80:81], v[80:81], v[66:67], v[66:67] op_sel:[0,0,1] op_sel_hi:[1,0,1]
v_pk_fma_f32 v[82:83], v[82:83], v[66:67], v[66:67] op_sel:[0,0,1] op_sel_hi:[1,0,1]
v_pk_fma_f32 v[180:181], v[180:181], v[66:67], v[66:67] op_sel:[0,0,1] op_sel_hi:[1,0,1]
v_pk_fma_f32 v[182:183], v[182:183], v[66:67], v[66:67] op_sel:[0,0,1] op_sel_hi:[1,0,1]
v_cvt_pk_f16_f32 v196, v24, v25
v_cvt_pk_f16_f32 v197, v26, v27
v_cvt_pk_f16_f32 v198, v28, v29
v_cvt_pk_f16_f32 v199, v30, v31
L_bodyj:
s_and_b32 s12, s40, 0xff
s_bfe_u32 s13, s40, 0x80008
s_bfe_u32 s14, s40, 0x80010
s_lshr_b32 s15, s40, 24
s_waitcnt vmcnt(7)
v_xor_b32 v40, s12, v40
v_xor_b32 v41, s13, v41
v_xor_b32 v42, s14, v42
v_xor_b32 v43, s15, v43
v_xor_b32 v44, s12, v44
v_xor_b32 v45, s13, v45
v_xor_b32 v46, s14, v46
v_xor_b32 v47, s15, v47
v_xor_b32 v48, s12, v48
v_xor_b32 v49, s13, v49
v_xor_b32 v50, s14, v50
v_xor_b32 v51, s15, v51
v_xor_b32 v52, v19, v52
v_xor_b32 v53, v19, v53
v_xor_b32 v54, v19, v54
v_or3_b32 v64, v40, v41, v42
v_or3_b32 v65, v43, v44, v45
v_or3_b32 v64, v64, v46, v47
v_or3_b32 v65, v65, v48, v49
v_or3_b32 v64, v64, v50, v51
v_or3_b32 v65, v65, v52, v53
v_or3_b32 v64, v64, v65, v54
v_and_b32 v64, 0xff, v64
v_cmp_ne_u32 vcc, 0, v64
s_cbranch_vccnz L_ga_retry
L_ga_ok:
v_pk_add_f32 v[40:41], v[40:41], v[44:45]
v_pk_add_f32 v[42:43], v[42:43], v[46:47]
v_add_f32 v52, v52, v53
v_pk_add_f32 v[40:41], v[40:41], v[48:49]
v_pk_add_f32 v[42:43], v[42:43], v[50:51]
v_add_f32 v52, v52, v54
v_cvt_pk_bf16_f32 v44, v40, v41
v_cvt_pk_bf16_f32 v45, v42, v43
v_cvt_pk_bf16_f32 v52, v52, v52
v_lshlrev_b32 v40, 16, v44
v_and_b32 v41, 0xffff0000, v44
v_lshlrev_b32 v42, 16, v45
v_and_b32 v43, 0xffff0000, v45
v_lshlrev_b32 v52, 16, v52
v_pk_add_f32 v[40:41], v[40:41], v[252:253] op_sel_hi:[1,0]
v_pk_add_f32 v[42:43], v[42:43], v[252:253] op_sel_hi:[1,0]
v_add_f32 v52, v52, v252
v_cvt_pk_bf16_f32 v44, v40, v41
v_cvt_pk_bf16_f32 v45, v42, v43
v_cvt_pk_bf16_f32 v52, v52, v52
v_lshlrev_b32 v40, 16, v44
v_and_b32 v41, 0xffff0000, v44
v_lshlrev_b32 v42, 16, v45
v_and_b32 v43, 0xffff0000, v45
v_lshlrev_b32 v52, 16, v52
ds_write_b128 v251, v[40:43]
ds_write_b32 v250, v52
s_waitcnt vmcnt(6)
v_cmp_ne_u32 vcc, s40, v71
s_cbranch_vccnz L_fg_retry
L_fg_ok:
s_waitcnt lgkmcnt(0)
s_barrier
buffer_load_dwordx4 a[40:43], v5, s[4:7], s59 offen offset:0 sc1
ds_read_b128 v[200:203], v10 offset:2560
ds_read_b128 v[204:207], v10 offset:2576
ds_read_b128 v[208:211], v10 offset:0
ds_read_b128 v[212:215], v10 offset:16
buffer_load_dwordx4 a[44:47], v5, s[4:7], s59 offen offset:256 sc1
s_mul_i32 s52, s96, 192
s_mul_i32 s49, s3, 3072
s_lshl_b32 s53, s47, 2
s_add_u32 s53, s53, s3
s_and_b32 s50, s53, 63
buffer_load_dwordx4 a[48:51], v5, s[4:7], s59 offen offset:512 sc1
s_waitcnt lgkmcnt(0)
v_pk_fma_f32 v[216:217], v[88:89], v[200:201], v[208:209]
v_cvt_pk_bf16_f32 v220, v216, v217
v_pk_fma_f32 v[218:219], v[90:91], v[202:203], v[210:211]
v_cvt_pk_bf16_f32 v221, v218, v219
buffer_load_dwordx4 a[52:55], v6, s[4:7], s59 offen offset:768 sc1
s_add_u32 s59, s59, 16384
v_pk_fma_f32 v[216:217], v[100:101], v[204:205], v[212:213]
v_cvt_pk_bf16_f32 v222, v216, v217
v_pk_fma_f32 v[218:219], v[102:103], v[206:207], v[214:215]
v_cvt_pk_bf16_f32 v223, v218, v219
ds_write_b128 v7, v[220:223] offset:0
buffer_load_dwordx4 a[56:59], v5, s[4:7], s59 offen offset:0 sc1
v_pk_fma_f32 v[216:217], v[92:93], v[200:201], v[208:209]
v_cvt_pk_bf16_f32 v224, v216, v217
v_pk_fma_f32 v[218:219], v[94:95], v[202:203], v[210:211]
v_cvt_pk_bf16_f32 v225, v218, v219
v_pk_fma_f32 v[216:217], v[120:121], v[204:205], v[212:213]
buffer_load_dwordx4 a[60:63], v5, s[4:7], s59 offen offset:256 sc1
v_cvt_pk_bf16_f32 v226, v216, v217
v_pk_fma_f32 v[218:219], v[122:123], v[206:207], v[214:215]
v_cvt_pk_bf16_f32 v227, v218, v219
ds_write_b128 v253, v[224:227] offset:0
v_pk_fma_f32 v[216:217], v[72:73], v[200:201], v[208:209]
buffer_load_dwordx4 a[64:67], v5, s[4:7], s59 offen offset:512 sc1
v_cvt_pk_bf16_f32 v220, v216, v217
v_pk_fma_f32 v[218:219], v[74:75], v[202:203], v[210:211]
v_cvt_pk_bf16_f32 v221, v218, v219
v_pk_fma_f32 v[216:217], v[140:141], v[204:205], v[212:213]
v_cvt_pk_bf16_f32 v222, v216, v217
buffer_load_dwordx4 a[68:71], v6, s[4:7], s59 offen offset:768 sc1
s_add_u32 s59, s59, 16384
v_pk_fma_f32 v[218:219], v[142:143], v[206:207], v[214:215]
v_cvt_pk_bf16_f32 v223, v218, v219
ds_write_b128 v254, v[220:223] offset:0
v_pk_fma_f32 v[216:217], v[76:77], v[200:201], v[208:209]
v_cvt_pk_bf16_f32 v224, v216, v217
buffer_load_dwordx4 a[72:75], v5, s[4:7], s59 offen offset:0 sc1
v_pk_fma_f32 v[218:219], v[78:79], v[202:203], v[210:211]
v_cvt_pk_bf16_f32 v225, v218, v219
v_pk_fma_f32 v[216:217], v[160:161], v[204:205], v[212:213]
v_cvt_pk_bf16_f32 v226, v216, v217
v_pk_fma_f32 v[218:219], v[162:163], v[206:207], v[214:215]
buffer_load_dwordx4 a[76:79], v5, s[4:7], s59 offen offset:256 sc1
v_cvt_pk_bf16_f32 v227, v218, v219
ds_write_b128 v244, v[224:227] offset:0
v_pk_fma_f32 v[216:217], v[80:81], v[200:201], v[208:209]
v_cvt_pk_bf16_f32 v220, v216, v217
v_pk_fma_f32 v[218:219], v[82:83], v[202:203], v[210:211]
buffer_load_dwordx4 a[80:83], v5, s[4:7], s59 offen offset:512 sc1
v_cvt_pk_bf16_f32 v221, v218, v219
v_pk_fma_f32 v[216:217], v[180:181], v[204:205], v[212:213]
v_cvt_pk_bf16_f32 v222, v216, v217
v_pk_fma_f32 v[218:219], v[182:183], v[206:207], v[214:215]
v_cvt_pk_bf16_f32 v223, v218, v219
buffer_load_dwordx4 a[84:87], v6, s[4:7], s59 offen offset:768 sc1
s_add_u32 s59, s59, 16384
ds_write_b128 v245, v[220:223] offset:0
ds_read_b128 v[200:203], v10 offset:3072
ds_read_b128 v[204:207], v10 offset:3088
ds_read_b128 v[208:211], v10 offset:512
ds_read_b128 v[212:215], v10 offset:528
s_lshl_b32 s50, s50, 5
s_lshr_b32 s54, s53, 6
s_add_u32 s54, s50, s54
s_mul_i32 s50, s54, 1280
s_add_u32 s50, s50, s52
s_lshl_b32 s51, s52, 1
s_add_u32 s51, s51, 65536
s_add_u32 s22, s51, 5120
s_mov_b32 s23, 917504
s_mul_i32 s12, s3, 2304
s_add_u32 s12, s12, 152320
s_add_u32 s13, s49, 122880
s_waitcnt lgkmcnt(4)
s_barrier
ds_read_b128 a[0:3], v8 offset:0
ds_read_b128 a[4:7], v8 offset:1024
ds_read_b128 a[8:11], v8 offset:2048
ds_read_b128 a[12:15], v8 offset:3072
ds_read_b128 a[16:19], v8 offset:4096
s_lshl_b32 s14, s53, 11
s_add_u32 s14, s14, 131072
s_mul_i32 s61, s3, 40
s_add_u32 s61, s61, 138240
s_waitcnt vmcnt(8) lgkmcnt(0)
v_mfma_f32_16x16x32_bf16 v[20:23], a[40:43], a[0:3], 0
ds_read_b128 a[20:23], v9 offset:5120
v_fma_mix_f32 v216, v104, v200, v208 op_sel:[0,0,0] op_sel_hi:[1,0,0]
v_mfma_f32_16x16x32_bf16 v[24:27], a[44:47], a[0:3], 0
buffer_load_dwordx4 a[88:91], v5, s[4:7], s59 offen offset:0 sc1
v_fma_mix_f32 v217, v104, v201, v209 op_sel:[1,0,0] op_sel_hi:[1,0,0]
v_mfma_f32_16x16x32_bf16 v[28:31], a[0:3], a[48:51], 0
ds_read_b128 a[24:27], v9 offset:6144
v_cvt_pk_bf16_f32 v220, v216, v217
v_mfma_f32_16x16x32_bf16 v[32:35], a[52:55], a[0:3], 0
ds_read_b128 a[28:31], v9 offset:7168
v_fma_mix_f32 v218, v105, v202, v210 op_sel:[0,0,0] op_sel_hi:[1,0,0]
v_mfma_f32_16x16x32_bf16 v[36:39], a[40:43], a[4:7], 0
ds_read_b128 a[32:35], v9 offset:8192
v_fma_mix_f32 v219, v105, v203, v211 op_sel:[1,0,0] op_sel_hi:[1,0,0]
v_mfma_f32_16x16x32_bf16 v[40:43], a[44:47], a[4:7], 0
buffer_load_dwordx4 a[92:95], v5, s[4:7], s59 offen offset:256 sc1
v_cvt_pk_bf16_f32 v221, v218, v219
v_mfma_f32_16x16x32_bf16 v[44:47], a[4:7], a[48:51], 0
ds_read_b128 a[36:39], v9 offset:9216
v_fma_mix_f32 v216, v106, v204, v212 op_sel:[0,0,0] op_sel_hi:[1,0,0]
v_mfma_f32_16x16x32_bf16 v[48:51], a[52:55], a[4:7], 0
v_fma_mix_f32 v217, v106, v205, v213 op_sel:[1,0,0] op_sel_hi:[1,0,0]
v_cvt_pk_bf16_f32 v222, v216, v217
v_mfma_f32_16x16x32_bf16 v[52:55], a[40:43], a[8:11], 0
v_fma_mix_f32 v218, v107, v206, v214 op_sel:[0,0,0] op_sel_hi:[1,0,0]
v_fma_mix_f32 v219, v107, v207, v215 op_sel:[1,0,0] op_sel_hi:[1,0,0]
v_mfma_f32_16x16x32_bf16 v[56:59], a[44:47], a[8:11], 0
buffer_load_dwordx4 a[96:99], v5, s[4:7], s59 offen offset:512 sc1
v_cvt_pk_bf16_f32 v223, v218, v219
v_mfma_f32_16x16x32_bf16 v[60:63], a[8:11], a[48:51], 0
v_fma_mix_f32 v216, v124, v200, v208 op_sel:[0,0,0] op_sel_hi:[1,0,0]
v_fma_mix_f32 v217, v124, v201, v209 op_sel:[1,0,0] op_sel_hi:[1,0,0]
v_mfma_f32_16x16x32_bf16 v[64:67], a[52:55], a[8:11], 0
ds_write_b128 v7, v[220:223] offset:20480
v_mfma_f32_16x16x32_bf16 v[68:71], a[40:43], a[12:15], 0
v_cvt_pk_bf16_f32 v224, v216, v217
v_fma_mix_f32 v218, v125, v202, v210 op_sel:[0,0,0] op_sel_hi:[1,0,0]
v_mfma_f32_16x16x32_bf16 v[72:75], a[44:47], a[12:15], 0
buffer_load_dwordx4 a[100:103], v6, s[4:7], s59 offen offset:768 sc1
s_add_u32 s59, s59, 16384
v_mfma_f32_16x16x32_bf16 v[76:79], a[12:15], a[48:51], 0
v_fma_mix_f32 v219, v125, v203, v211 op_sel:[1,0,0] op_sel_hi:[1,0,0]
v_cvt_pk_bf16_f32 v225, v218, v219
v_mfma_f32_16x16x32_bf16 v[80:83], a[52:55], a[12:15], 0
v_fma_mix_f32 v216, v126, v204, v212 op_sel:[0,0,0] op_sel_hi:[1,0,0]
v_fma_mix_f32 v217, v126, v205, v213 op_sel:[1,0,0] op_sel_hi:[1,0,0]
v_mfma_f32_16x16x32_bf16 v[84:87], a[40:43], a[16:19], 0
v_cvt_pk_bf16_f32 v226, v216, v217
v_fma_mix_f32 v218, v127, v206, v214 op_sel:[0,0,0] op_sel_hi:[1,0,0]
v_mfma_f32_16x16x32_bf16 v[88:91], a[44:47], a[16:19], 0
v_fma_mix_f32 v219, v127, v207, v215 op_sel:[1,0,0] op_sel_hi:[1,0,0]
v_cvt_pk_bf16_f32 v227, v218, v219
v_mfma_f32_16x16x32_bf16 v[92:95], a[16:19], a[48:51], 0
v_fma_mix_f32 v216, v144, v200, v208 op_sel:[0,0,0] op_sel_hi:[1,0,0]
v_fma_mix_f32 v217, v144, v201, v209 op_sel:[1,0,0] op_sel_hi:[1,0,0]
v_mfma_f32_16x16x32_bf16 v[96:99], a[52:55], a[16:19], 0
s_waitcnt vmcnt(8) lgkmcnt(1)
v_cvt_pk_bf16_f32 v220, v216, v217
v_fma_mix_f32 v218, v145, v202, v210 op_sel:[0,0,0] op_sel_hi:[1,0,0]
v_mfma_f32_16x16x32_bf16 v[20:23], a[56:59], a[20:23], v[20:23]
ds_read_b128 a[0:3], v8 offset:10240
v_fma_mix_f32 v219, v145, v203, v211 op_sel:[1,0,0] op_sel_hi:[1,0,0]
v_mfma_f32_16x16x32_bf16 v[24:27], a[60:63], a[20:23], v[24:27]
buffer_load_dwordx4 a[104:107], v5, s[4:7], s59 offen offset:0 sc1
v_cvt_pk_bf16_f32 v221, v218, v219
v_mfma_f32_16x16x32_bf16 v[28:31], a[20:23], a[64:67], v[28:31]
ds_read_b128 a[4:7], v8 offset:11264
v_fma_mix_f32 v216, v146, v204, v212 op_sel:[0,0,0] op_sel_hi:[1,0,0]
v_mfma_f32_16x16x32_bf16 v[32:35], a[68:71], a[20:23], v[32:35]
ds_read_b128 a[8:11], v8 offset:12288
v_fma_mix_f32 v217, v146, v205, v213 op_sel:[1,0,0] op_sel_hi:[1,0,0]
v_mfma_f32_16x16x32_bf16 v[36:39], a[56:59], a[24:27], v[36:39]
ds_read_b128 a[12:15], v8 offset:13312
v_cvt_pk_bf16_f32 v222, v216, v217
v_mfma_f32_16x16x32_bf16 v[40:43], a[60:63], a[24:27], v[40:43]
buffer_load_dwordx4 a[108:111], v5, s[4:7], s59 offen offset:256 sc1
v_fma_mix_f32 v218, v147, v206, v214 op_sel:[0,0,0] op_sel_hi:[1,0,0]
v_mfma_f32_16x16x32_bf16 v[44:47], a[24:27], a[64:67], v[44:47]
ds_read_b128 a[16:19], v8 offset:14336
v_fma_mix_f32 v219, v147, v207, v215 op_sel:[1,0,0] op_sel_hi:[1,0,0]
v_mfma_f32_16x16x32_bf16 v[48:51], a[68:71], a[24:27], v[48:51]
ds_write_b128 v253, v[224:227] offset:20480
v_mfma_f32_16x16x32_bf16 v[52:55], a[56:59], a[28:31], v[52:55]
v_cvt_pk_bf16_f32 v223, v218, v219
v_fma_mix_f32 v216, v164, v200, v208 op_sel:[0,0,0] op_sel_hi:[1,0,0]
v_mfma_f32_16x16x32_bf16 v[56:59], a[60:63], a[28:31], v[56:59]
buffer_load_dwordx4 a[112:115], v5, s[4:7], s59 offen offset:512 sc1
v_fma_mix_f32 v217, v164, v201, v209 op_sel:[1,0,0] op_sel_hi:[1,0,0]
v_mfma_f32_16x16x32_bf16 v[60:63], a[28:31], a[64:67], v[60:63]
v_cvt_pk_bf16_f32 v224, v216, v217
v_fma_mix_f32 v218, v165, v202, v210 op_sel:[0,0,0] op_sel_hi:[1,0,0]
v_mfma_f32_16x16x32_bf16 v[64:67], a[68:71], a[28:31], v[64:67]
ds_write_b128 v254, v[220:223] offset:20480
v_mfma_f32_16x16x32_bf16 v[68:71], a[56:59], a[32:35], v[68:71]
v_fma_mix_f32 v219, v165, v203, v211 op_sel:[1,0,0] op_sel_hi:[1,0,0]
v_cvt_pk_bf16_f32 v225, v218, v219
v_mfma_f32_16x16x32_bf16 v[72:75], a[60:63], a[32:35], v[72:75]
buffer_load_dwordx4 a[116:119], v6, s[4:7], s59 offen offset:768 sc1
s_add_u32 s59, s59, 16384
v_mfma_f32_16x16x32_bf16 v[76:79], a[32:35], a[64:67], v[76:79]
v_fma_mix_f32 v216, v166, v204, v212 op_sel:[0,0,0] op_sel_hi:[1,0,0]
v_fma_mix_f32 v217, v166, v205, v213 op_sel:[1,0,0] op_sel_hi:[1,0,0]
v_mfma_f32_16x16x32_bf16 v[80:83], a[68:71], a[32:35], v[80:83]
v_cvt_pk_bf16_f32 v226, v216, v217
v_fma_mix_f32 v218, v167, v206, v214 op_sel:[0,0,0] op_sel_hi:[1,0,0]
v_mfma_f32_16x16x32_bf16 v[84:87], a[56:59], a[36:39], v[84:87]
v_fma_mix_f32 v219, v167, v207, v215 op_sel:[1,0,0] op_sel_hi:[1,0,0]
v_cvt_pk_bf16_f32 v227, v218, v219
v_mfma_f32_16x16x32_bf16 v[88:91], a[60:63], a[36:39], v[88:91]
v_fma_mix_f32 v216, v184, v200, v208 op_sel:[0,0,0] op_sel_hi:[1,0,0]
v_fma_mix_f32 v217, v184, v201, v209 op_sel:[1,0,0] op_sel_hi:[1,0,0]
v_mfma_f32_16x16x32_bf16 v[92:95], a[36:39], a[64:67], v[92:95]
v_cvt_pk_bf16_f32 v220, v216, v217
v_fma_mix_f32 v218, v185, v202, v210 op_sel:[0,0,0] op_sel_hi:[1,0,0]
v_mfma_f32_16x16x32_bf16 v[96:99], a[68:71], a[36:39], v[96:99]
s_waitcnt vmcnt(8) lgkmcnt(2)
v_fma_mix_f32 v219, v185, v203, v211 op_sel:[1,0,0] op_sel_hi:[1,0,0]
v_cvt_pk_bf16_f32 v221, v218, v219
v_mfma_f32_16x16x32_bf16 v[20:23], a[72:75], a[0:3], v[20:23]
ds_read_b128 a[20:23], v9 offset:15360
v_fma_mix_f32 v216, v186, v204, v212 op_sel:[0,0,0] op_sel_hi:[1,0,0]
v_mfma_f32_16x16x32_bf16 v[24:27], a[76:79], a[0:3], v[24:27]
buffer_load_dwordx4 a[120:123], v5, s[4:7], s59 offen offset:0 sc1
v_fma_mix_f32 v217, v186, v205, v213 op_sel:[1,0,0] op_sel_hi:[1,0,0]
v_mfma_f32_16x16x32_bf16 v[28:31], a[0:3], a[80:83], v[28:31]
ds_read_b128 a[24:27], v9 offset:16384
v_cvt_pk_bf16_f32 v222, v216, v217
v_mfma_f32_16x16x32_bf16 v[32:35], a[84:87], a[0:3], v[32:35]
ds_read_b128 a[28:31], v9 offset:17408
v_fma_mix_f32 v218, v187, v206, v214 op_sel:[0,0,0] op_sel_hi:[1,0,0]
v_mfma_f32_16x16x32_bf16 v[36:39], a[72:75], a[4:7], v[36:39]
ds_read_b128 a[32:35], v9 offset:18432
v_fma_mix_f32 v219, v187, v207, v215 op_sel:[1,0,0] op_sel_hi:[1,0,0]
v_mfma_f32_16x16x32_bf16 v[40:43], a[76:79], a[4:7], v[40:43]
buffer_load_dwordx4 a[124:127], v5, s[4:7], s59 offen offset:256 sc1
v_cvt_pk_bf16_f32 v223, v218, v219
v_mfma_f32_16x16x32_bf16 v[44:47], a[4:7], a[80:83], v[44:47]
ds_read_b128 a[36:39], v9 offset:19456
v_bfe_u32 v228, v1, 2, 2
v_mfma_f32_16x16x32_bf16 v[48:51], a[84:87], a[4:7], v[48:51]
ds_write_b128 v244, v[224:227] offset:20480
v_mfma_f32_16x16x32_bf16 v[52:55], a[72:75], a[8:11], v[52:55]
v_lshl_add_u32 v228, v3, 3, v228
v_mul_u32_u24 v228, 192, v228
v_mfma_f32_16x16x32_bf16 v[56:59], a[76:79], a[8:11], v[56:59]
buffer_load_dwordx4 a[128:131], v5, s[4:7], s59 offen offset:512 sc1
v_and_b32 v229, 3, v1
v_mfma_f32_16x16x32_bf16 v[60:63], a[8:11], a[80:83], v[60:63]
v_lshl_add_u32 v228, v229, 3, v228
v_and_b32 v229, 1, v3
v_mfma_f32_16x16x32_bf16 v[64:67], a[84:87], a[8:11], v[64:67]
ds_write_b128 v245, v[220:223] offset:20480
v_mfma_f32_16x16x32_bf16 v[68:71], a[72:75], a[12:15], v[68:71]
v_lshl_add_u32 v249, v229, 5, v228
v_xor_b32 v229, 1, v229
v_mfma_f32_16x16x32_bf16 v[72:75], a[76:79], a[12:15], v[72:75]
buffer_load_dwordx4 a[132:135], v6, s[4:7], s59 offen offset:768 sc1
s_add_u32 s59, s59, 16384
v_mfma_f32_16x16x32_bf16 v[76:79], a[12:15], a[80:83], v[76:79]
v_lshl_add_u32 v252, v229, 5, v228
v_add_u32 v4, 61440, v8
v_mfma_f32_16x16x32_bf16 v[80:83], a[84:87], a[12:15], v[80:83]
ds_read_b128 v[200:203], v10 offset:3584
v_add_u32 v251, 61440, v9
v_mfma_f32_16x16x32_bf16 v[84:87], a[72:75], a[16:19], v[84:87]
ds_read_b128 v[204:207], v10 offset:3600
v_mfma_f32_16x16x32_bf16 v[88:91], a[76:79], a[16:19], v[88:91]
buffer_load_dwordx4 a[136:139], v5, s[4:7], s59 offen offset:0 sc1
v_mfma_f32_16x16x32_bf16 v[92:95], a[16:19], a[80:83], v[92:95]
ds_read_b128 v[208:211], v10 offset:1024
v_mfma_f32_16x16x32_bf16 v[96:99], a[84:87], a[16:19], v[96:99]
s_waitcnt vmcnt(9) lgkmcnt(3)
s_barrier
v_mfma_f32_16x16x32_bf16 v[20:23], a[88:91], a[20:23], v[20:23]
ds_read_b128 a[0:3], v8 offset:20480
v_mfma_f32_16x16x32_bf16 v[24:27], a[92:95], a[20:23], v[24:27]
buffer_load_dwordx4 a[140:143], v5, s[4:7], s59 offen offset:256 sc1
v_mfma_f32_16x16x32_bf16 v[28:31], a[20:23], a[96:99], v[28:31]
ds_read_b128 a[4:7], v8 offset:21504
v_mfma_f32_16x16x32_bf16 v[32:35], a[100:103], a[20:23], v[32:35]
ds_read_b128 a[8:11], v8 offset:22528
v_mfma_f32_16x16x32_bf16 v[36:39], a[88:91], a[24:27], v[36:39]
ds_read_b128 a[12:15], v8 offset:23552
v_mfma_f32_16x16x32_bf16 v[40:43], a[92:95], a[24:27], v[40:43]
buffer_load_dwordx4 a[144:147], v5, s[4:7], s59 offen offset:512 sc1
v_mfma_f32_16x16x32_bf16 v[44:47], a[24:27], a[96:99], v[44:47]
ds_read_b128 a[16:19], v8 offset:24576
v_mfma_f32_16x16x32_bf16 v[48:51], a[100:103], a[24:27], v[48:51]
ds_read_b128 v[212:215], v10 offset:1040
v_mfma_f32_16x16x32_bf16 v[52:55], a[88:91], a[28:31], v[52:55]
v_mfma_f32_16x16x32_bf16 v[56:59], a[92:95], a[28:31], v[56:59]
buffer_store_dwordx4 v[240:243], v246, s[4:7], s100 offen sc1
v_mfma_f32_16x16x32_bf16 v[60:63], a[28:31], a[96:99], v[60:63]
v_mfma_f32_16x16x32_bf16 v[64:67], a[100:103], a[28:31], v[64:67]
s_waitcnt lgkmcnt(0)
v_fma_mix_f32 v216, v108, v200, v208 op_sel:[0,0,0] op_sel_hi:[1,0,0]
v_fma_mix_f32 v217, v108, v201, v209 op_sel:[1,0,0] op_sel_hi:[1,0,0]
v_mfma_f32_16x16x32_bf16 v[68:71], a[88:91], a[32:35], v[68:71]
v_cvt_pk_bf16_f32 v220, v216, v217
v_fma_mix_f32 v218, v109, v202, v210 op_sel:[0,0,0] op_sel_hi:[1,0,0]
v_mfma_f32_16x16x32_bf16 v[72:75], a[92:95], a[32:35], v[72:75]
buffer_load_dwordx4 a[148:151], v6, s[4:7], s59 offen offset:768 sc1
s_add_u32 s59, s59, 16384
v_mfma_f32_16x16x32_bf16 v[76:79], a[32:35], a[96:99], v[76:79]
v_fma_mix_f32 v219, v109, v203, v211 op_sel:[1,0,0] op_sel_hi:[1,0,0]
v_cvt_pk_bf16_f32 v221, v218, v219
v_mfma_f32_16x16x32_bf16 v[80:83], a[100:103], a[32:35], v[80:83]
v_fma_mix_f32 v216, v110, v204, v212 op_sel:[0,0,0] op_sel_hi:[1,0,0]
v_fma_mix_f32 v217, v110, v205, v213 op_sel:[1,0,0] op_sel_hi:[1,0,0]
v_mfma_f32_16x16x32_bf16 v[84:87], a[88:91], a[36:39], v[84:87]
v_cvt_pk_bf16_f32 v222, v216, v217
v_fma_mix_f32 v218, v111, v206, v214 op_sel:[0,0,0] op_sel_hi:[1,0,0]
v_mfma_f32_16x16x32_bf16 v[88:91], a[92:95], a[36:39], v[88:91]
v_fma_mix_f32 v219, v111, v207, v215 op_sel:[1,0,0] op_sel_hi:[1,0,0]
v_cvt_pk_bf16_f32 v223, v218, v219
v_mfma_f32_16x16x32_bf16 v[92:95], a[36:39], a[96:99], v[92:95]
v_fma_mix_f32 v216, v128, v200, v208 op_sel:[0,0,0] op_sel_hi:[1,0,0]
v_fma_mix_f32 v217, v128, v201, v209 op_sel:[1,0,0] op_sel_hi:[1,0,0]
v_mfma_f32_16x16x32_bf16 v[96:99], a[100:103], a[36:39], v[96:99]
s_waitcnt vmcnt(9)
v_cvt_pk_bf16_f32 v224, v216, v217
v_fma_mix_f32 v218, v129, v202, v210 op_sel:[0,0,0] op_sel_hi:[1,0,0]
v_mfma_f32_16x16x32_bf16 v[20:23], a[104:107], a[0:3], v[20:23]
ds_read_b128 a[20:23], v9 offset:25600
v_fma_mix_f32 v219, v129, v203, v211 op_sel:[1,0,0] op_sel_hi:[1,0,0]
v_mfma_f32_16x16x32_bf16 v[24:27], a[108:111], a[0:3], v[24:27]
buffer_load_dwordx4 a[152:155], v5, s[4:7], s59 offen offset:0 sc1
v_cvt_pk_bf16_f32 v225, v218, v219
v_mfma_f32_16x16x32_bf16 v[28:31], a[0:3], a[112:115], v[28:31]
ds_read_b128 a[24:27], v9 offset:26624
v_fma_mix_f32 v216, v130, v204, v212 op_sel:[0,0,0] op_sel_hi:[1,0,0]
v_mfma_f32_16x16x32_bf16 v[32:35], a[116:119], a[0:3], v[32:35]
ds_read_b128 a[28:31], v9 offset:27648
v_fma_mix_f32 v217, v130, v205, v213 op_sel:[1,0,0] op_sel_hi:[1,0,0]
v_mfma_f32_16x16x32_bf16 v[36:39], a[104:107], a[4:7], v[36:39]
ds_read_b128 a[32:35], v9 offset:28672
v_cvt_pk_bf16_f32 v226, v216, v217
v_mfma_f32_16x16x32_bf16 v[40:43], a[108:111], a[4:7], v[40:43]
buffer_load_dwordx4 a[156:159], v5, s[4:7], s59 offen offset:256 sc1
v_fma_mix_f32 v218, v131, v206, v214 op_sel:[0,0,0] op_sel_hi:[1,0,0]
v_mfma_f32_16x16x32_bf16 v[44:47], a[4:7], a[112:115], v[44:47]
ds_read_b128 a[36:39], v9 offset:29696
v_fma_mix_f32 v219, v131, v207, v215 op_sel:[1,0,0] op_sel_hi:[1,0,0]
v_mfma_f32_16x16x32_bf16 v[48:51], a[116:119], a[4:7], v[48:51]
ds_write_b128 v7, v[220:223] offset:40960
v_mfma_f32_16x16x32_bf16 v[52:55], a[104:107], a[8:11], v[52:55]
v_cvt_pk_bf16_f32 v227, v218, v219
v_fma_mix_f32 v216, v148, v200, v208 op_sel:[0,0,0] op_sel_hi:[1,0,0]
v_mfma_f32_16x16x32_bf16 v[56:59], a[108:111], a[8:11], v[56:59]
buffer_load_dwordx4 a[160:163], v5, s[4:7], s59 offen offset:512 sc1
v_fma_mix_f32 v217, v148, v201, v209 op_sel:[1,0,0] op_sel_hi:[1,0,0]
v_mfma_f32_16x16x32_bf16 v[60:63], a[8:11], a[112:115], v[60:63]
v_cvt_pk_bf16_f32 v220, v216, v217
v_fma_mix_f32 v218, v149, v202, v210 op_sel:[0,0,0] op_sel_hi:[1,0,0]
v_mfma_f32_16x16x32_bf16 v[64:67], a[116:119], a[8:11], v[64:67]
ds_write_b128 v253, v[224:227] offset:40960
v_mfma_f32_16x16x32_bf16 v[68:71], a[104:107], a[12:15], v[68:71]
v_fma_mix_f32 v219, v149, v203, v211 op_sel:[1,0,0] op_sel_hi:[1,0,0]
v_cvt_pk_bf16_f32 v221, v218, v219
v_mfma_f32_16x16x32_bf16 v[72:75], a[108:111], a[12:15], v[72:75]
buffer_load_dwordx4 a[164:167], v6, s[4:7], s59 offen offset:768 sc1
s_add_u32 s59, s59, 16384
v_mfma_f32_16x16x32_bf16 v[76:79], a[12:15], a[112:115], v[76:79]
v_fma_mix_f32 v216, v150, v204, v212 op_sel:[0,0,0] op_sel_hi:[1,0,0]
v_fma_mix_f32 v217, v150, v205, v213 op_sel:[1,0,0] op_sel_hi:[1,0,0]
v_mfma_f32_16x16x32_bf16 v[80:83], a[116:119], a[12:15], v[80:83]
v_cvt_pk_bf16_f32 v222, v216, v217
v_fma_mix_f32 v218, v151, v206, v214 op_sel:[0,0,0] op_sel_hi:[1,0,0]
v_mfma_f32_16x16x32_bf16 v[84:87], a[104:107], a[16:19], v[84:87]
v_fma_mix_f32 v219, v151, v207, v215 op_sel:[1,0,0] op_sel_hi:[1,0,0]
v_cvt_pk_bf16_f32 v223, v218, v219
v_mfma_f32_16x16x32_bf16 v[88:91], a[108:111], a[16:19], v[88:91]
buffer_load_dwordx4 a[168:171], v5, s[4:7], s59 offen offset:0 sc1
v_fma_mix_f32 v216, v168, v200, v208 op_sel:[0,0,0] op_sel_hi:[1,0,0]
v_mfma_f32_16x16x32_bf16 v[92:95], a[16:19], a[112:115], v[92:95]
v_fma_mix_f32 v217, v168, v201, v209 op_sel:[1,0,0] op_sel_hi:[1,0,0]
v_cvt_pk_bf16_f32 v224, v216, v217
v_mfma_f32_16x16x32_bf16 v[96:99], a[116:119], a[16:19], v[96:99]
s_waitcnt vmcnt(10) lgkmcnt(2)
v_fma_mix_f32 v218, v169, v202, v210 op_sel:[0,0,0] op_sel_hi:[1,0,0]
v_fma_mix_f32 v219, v169, v203, v211 op_sel:[1,0,0] op_sel_hi:[1,0,0]
v_mfma_f32_16x16x32_bf16 v[20:23], a[120:123], a[20:23], v[20:23]
ds_read_b128 a[0:3], v8 offset:30720
v_cvt_pk_bf16_f32 v225, v218, v219
v_mfma_f32_16x16x32_bf16 v[24:27], a[124:127], a[20:23], v[24:27]
buffer_load_dwordx4 a[172:175], v5, s[4:7], s59 offen offset:256 sc1
v_fma_mix_f32 v216, v170, v204, v212 op_sel:[0,0,0] op_sel_hi:[1,0,0]
v_mfma_f32_16x16x32_bf16 v[28:31], a[20:23], a[128:131], v[28:31]
ds_read_b128 a[4:7], v8 offset:31744
v_fma_mix_f32 v217, v170, v205, v213 op_sel:[1,0,0] op_sel_hi:[1,0,0]
v_mfma_f32_16x16x32_bf16 v[32:35], a[132:135], a[20:23], v[32:35]
ds_read_b128 a[8:11], v8 offset:32768
v_cvt_pk_bf16_f32 v226, v216, v217
v_mfma_f32_16x16x32_bf16 v[36:39], a[120:123], a[24:27], v[36:39]
ds_read_b128 a[12:15], v8 offset:33792
v_fma_mix_f32 v218, v171, v206, v214 op_sel:[0,0,0] op_sel_hi:[1,0,0]
v_mfma_f32_16x16x32_bf16 v[40:43], a[124:127], a[24:27], v[40:43]
buffer_load_dwordx4 a[176:179], v5, s[4:7], s59 offen offset:512 sc1
v_fma_mix_f32 v219, v171, v207, v215 op_sel:[1,0,0] op_sel_hi:[1,0,0]
v_mfma_f32_16x16x32_bf16 v[44:47], a[24:27], a[128:131], v[44:47]
ds_read_b128 a[16:19], v8 offset:34816
v_cvt_pk_bf16_f32 v227, v218, v219
v_mfma_f32_16x16x32_bf16 v[48:51], a[132:135], a[24:27], v[48:51]
ds_write_b128 v254, v[220:223] offset:40960
v_mfma_f32_16x16x32_bf16 v[52:55], a[120:123], a[28:31], v[52:55]
v_fma_mix_f32 v216, v188, v200, v208 op_sel:[0,0,0] op_sel_hi:[1,0,0]
v_fma_mix_f32 v217, v188, v201, v209 op_sel:[1,0,0] op_sel_hi:[1,0,0]
v_mfma_f32_16x16x32_bf16 v[56:59], a[124:127], a[28:31], v[56:59]
buffer_load_dwordx4 a[180:183], v6, s[4:7], s59 offen offset:768 sc1
s_add_u32 s59, s59, 16384
v_mfma_f32_16x16x32_bf16 v[60:63], a[28:31], a[128:131], v[60:63]
v_cvt_pk_bf16_f32 v220, v216, v217
v_fma_mix_f32 v218, v189, v202, v210 op_sel:[0,0,0] op_sel_hi:[1,0,0]
v_mfma_f32_16x16x32_bf16 v[64:67], a[132:135], a[28:31], v[64:67]
ds_write_b128 v244, v[224:227] offset:40960
v_mfma_f32_16x16x32_bf16 v[68:71], a[120:123], a[32:35], v[68:71]
v_fma_mix_f32 v219, v189, v203, v211 op_sel:[1,0,0] op_sel_hi:[1,0,0]
v_cvt_pk_bf16_f32 v221, v218, v219
v_mfma_f32_16x16x32_bf16 v[72:75], a[124:127], a[32:35], v[72:75]
buffer_load_dwordx4 a[184:187], v5, s[4:7], s59 offen offset:0 sc1
v_fma_mix_f32 v216, v190, v204, v212 op_sel:[0,0,0] op_sel_hi:[1,0,0]
v_mfma_f32_16x16x32_bf16 v[76:79], a[32:35], a[128:131], v[76:79]
v_fma_mix_f32 v217, v190, v205, v213 op_sel:[1,0,0] op_sel_hi:[1,0,0]
v_cvt_pk_bf16_f32 v222, v216, v217
v_mfma_f32_16x16x32_bf16 v[80:83], a[132:135], a[32:35], v[80:83]
v_fma_mix_f32 v218, v191, v206, v214 op_sel:[0,0,0] op_sel_hi:[1,0,0]
v_fma_mix_f32 v219, v191, v207, v215 op_sel:[1,0,0] op_sel_hi:[1,0,0]
v_mfma_f32_16x16x32_bf16 v[84:87], a[120:123], a[36:39], v[84:87]
v_cvt_pk_bf16_f32 v223, v218, v219
v_add_u32 v7, 61440, v7
v_mfma_f32_16x16x32_bf16 v[88:91], a[124:127], a[36:39], v[88:91]
v_add_u32 v253, 61440, v253
v_add_u32 v254, 61440, v254
v_mfma_f32_16x16x32_bf16 v[92:95], a[36:39], a[128:131], v[92:95]
v_add_u32 v244, 61440, v244
v_mfma_f32_16x16x32_bf16 v[96:99], a[132:135], a[36:39], v[96:99]
s_waitcnt vmcnt(9) lgkmcnt(2)
v_mfma_f32_16x16x32_bf16 v[20:23], a[136:139], a[0:3], v[20:23]
ds_read_b128 a[20:23], v9 offset:35840
v_mfma_f32_16x16x32_bf16 v[24:27], a[140:143], a[0:3], v[24:27]
buffer_load_dwordx4 a[188:191], v5, s[4:7], s59 offen offset:256 sc1
v_mfma_f32_16x16x32_bf16 v[28:31], a[0:3], a[144:147], v[28:31]
ds_read_b128 a[24:27], v9 offset:36864
v_mfma_f32_16x16x32_bf16 v[32:35], a[148:151], a[0:3], v[32:35]
ds_read_b128 a[28:31], v9 offset:37888
v_mfma_f32_16x16x32_bf16 v[36:39], a[136:139], a[4:7], v[36:39]
ds_read_b128 a[32:35], v9 offset:38912
v_mfma_f32_16x16x32_bf16 v[40:43], a[140:143], a[4:7], v[40:43]
buffer_load_dwordx4 a[192:195], v5, s[4:7], s59 offen offset:512 sc1
v_mfma_f32_16x16x32_bf16 v[44:47], a[4:7], a[144:147], v[44:47]
ds_read_b128 a[36:39], v9 offset:39936
v_mfma_f32_16x16x32_bf16 v[48:51], a[148:151], a[4:7], v[48:51]
ds_write_b128 v245, v[220:223] offset:40960
v_mfma_f32_16x16x32_bf16 v[52:55], a[136:139], a[8:11], v[52:55]
v_add_u32 v245, 61440, v245
v_mfma_f32_16x16x32_bf16 v[56:59], a[140:143], a[8:11], v[56:59]
buffer_load_dwordx4 a[196:199], v6, s[4:7], s59 offen offset:768 sc1
s_add_u32 s59, s59, 16384
v_mfma_f32_16x16x32_bf16 v[60:63], a[8:11], a[144:147], v[60:63]
v_mfma_f32_16x16x32_bf16 v[64:67], a[148:151], a[8:11], v[64:67]
ds_read_b128 v[200:203], v10 offset:4096
v_mfma_f32_16x16x32_bf16 v[68:71], a[136:139], a[12:15], v[68:71]
ds_read_b128 v[204:207], v10 offset:4112
v_mfma_f32_16x16x32_bf16 v[72:75], a[140:143], a[12:15], v[72:75]
buffer_load_dwordx4 a[200:203], v5, s[4:7], s59 offen offset:0 sc1
v_mfma_f32_16x16x32_bf16 v[76:79], a[12:15], a[144:147], v[76:79]
ds_read_b128 v[208:211], v10 offset:1536
v_mfma_f32_16x16x32_bf16 v[80:83], a[148:151], a[12:15], v[80:83]
ds_read_b128 v[212:215], v10 offset:1552
v_mfma_f32_16x16x32_bf16 v[84:87], a[136:139], a[16:19], v[84:87]
v_mfma_f32_16x16x32_bf16 v[88:91], a[140:143], a[16:19], v[88:91]
v_mfma_f32_16x16x32_bf16 v[92:95], a[16:19], a[144:147], v[92:95]
v_mfma_f32_16x16x32_bf16 v[96:99], a[148:151], a[16:19], v[96:99]
s_waitcnt vmcnt(9) lgkmcnt(4)
s_barrier
s_waitcnt lgkmcnt(0)
v_mfma_f32_16x16x32_bf16 v[20:23], a[152:155], a[20:23], v[20:23]
ds_read_b128 a[0:3], v8 offset:40960
v_fma_mix_f32 v216, v112, v200, v208 op_sel:[0,0,0] op_sel_hi:[1,0,0]
v_mfma_f32_16x16x32_bf16 v[24:27], a[156:159], a[20:23], v[24:27]
buffer_load_dwordx4 a[204:207], v5, s[4:7], s59 offen offset:256 sc1
v_fma_mix_f32 v217, v112, v201, v209 op_sel:[1,0,0] op_sel_hi:[1,0,0]
v_mfma_f32_16x16x32_bf16 v[28:31], a[20:23], a[160:163], v[28:31]
ds_read_b128 a[4:7], v8 offset:41984
v_cvt_pk_bf16_f32 v220, v216, v217
v_mfma_f32_16x16x32_bf16 v[32:35], a[164:167], a[20:23], v[32:35]
ds_read_b128 a[8:11], v8 offset:43008
v_fma_mix_f32 v218, v113, v202, v210 op_sel:[0,0,0] op_sel_hi:[1,0,0]
v_mfma_f32_16x16x32_bf16 v[36:39], a[152:155], a[24:27], v[36:39]
ds_read_b128 a[12:15], v8 offset:44032
v_fma_mix_f32 v219, v113, v203, v211 op_sel:[1,0,0] op_sel_hi:[1,0,0]
v_mfma_f32_16x16x32_bf16 v[40:43], a[156:159], a[24:27], v[40:43]
buffer_load_dwordx4 a[208:211], v5, s[4:7], s59 offen offset:512 sc1
v_cvt_pk_bf16_f32 v221, v218, v219
v_mfma_f32_16x16x32_bf16 v[44:47], a[24:27], a[160:163], v[44:47]
ds_read_b128 a[16:19], v8 offset:45056
v_fma_mix_f32 v216, v114, v204, v212 op_sel:[0,0,0] op_sel_hi:[1,0,0]
v_mfma_f32_16x16x32_bf16 v[48:51], a[164:167], a[24:27], v[48:51]
v_fma_mix_f32 v217, v114, v205, v213 op_sel:[1,0,0] op_sel_hi:[1,0,0]
v_cvt_pk_bf16_f32 v222, v216, v217
v_mfma_f32_16x16x32_bf16 v[52:55], a[152:155], a[28:31], v[52:55]
v_fma_mix_f32 v218, v115, v206, v214 op_sel:[0,0,0] op_sel_hi:[1,0,0]
v_fma_mix_f32 v219, v115, v207, v215 op_sel:[1,0,0] op_sel_hi:[1,0,0]
v_mfma_f32_16x16x32_bf16 v[56:59], a[156:159], a[28:31], v[56:59]
buffer_load_dwordx4 a[212:215], v6, s[4:7], s59 offen offset:768 sc1
s_add_u32 s59, s59, 16384
v_mfma_f32_16x16x32_bf16 v[60:63], a[28:31], a[160:163], v[60:63]
v_cvt_pk_bf16_f32 v223, v218, v219
v_fma_mix_f32 v216, v132, v200, v208 op_sel:[0,0,0] op_sel_hi:[1,0,0]
v_mfma_f32_16x16x32_bf16 v[64:67], a[164:167], a[28:31], v[64:67]
v_fma_mix_f32 v217, v132, v201, v209 op_sel:[1,0,0] op_sel_hi:[1,0,0]
v_cvt_pk_bf16_f32 v224, v216, v217
v_mfma_f32_16x16x32_bf16 v[68:71], a[152:155], a[32:35], v[68:71]
ds_write_b128 v7, v[220:223] offset:0
v_mfma_f32_16x16x32_bf16 v[72:75], a[156:159], a[32:35], v[72:75]
buffer_load_dwordx4 a[216:219], v5, s[4:7], s59 offen offset:0 sc1
v_fma_mix_f32 v218, v133, v202, v210 op_sel:[0,0,0] op_sel_hi:[1,0,0]
v_mfma_f32_16x16x32_bf16 v[76:79], a[32:35], a[160:163], v[76:79]
v_fma_mix_f32 v219, v133, v203, v211 op_sel:[1,0,0] op_sel_hi:[1,0,0]
v_cvt_pk_bf16_f32 v225, v218, v219
v_mfma_f32_16x16x32_bf16 v[80:83], a[164:167], a[32:35], v[80:83]
v_fma_mix_f32 v216, v134, v204, v212 op_sel:[0,0,0] op_sel_hi:[1,0,0]
v_fma_mix_f32 v217, v134, v205, v213 op_sel:[1,0,0] op_sel_hi:[1,0,0]
v_mfma_f32_16x16x32_bf16 v[84:87], a[152:155], a[36:39], v[84:87]
v_cvt_pk_bf16_f32 v226, v216, v217
v_fma_mix_f32 v218, v135, v206, v214 op_sel:[0,0,0] op_sel_hi:[1,0,0]
v_mfma_f32_16x16x32_bf16 v[88:91], a[156:159], a[36:39], v[88:91]
buffer_load_dwordx4 a[220:223], v5, s[4:7], s59 offen offset:256 sc1
v_fma_mix_f32 v219, v135, v207, v215 op_sel:[1,0,0] op_sel_hi:[1,0,0]
v_mfma_f32_16x16x32_bf16 v[92:95], a[36:39], a[160:163], v[92:95]
v_cvt_pk_bf16_f32 v227, v218, v219
v_fma_mix_f32 v216, v152, v200, v208 op_sel:[0,0,0] op_sel_hi:[1,0,0]
v_mfma_f32_16x16x32_bf16 v[96:99], a[164:167], a[36:39], v[96:99]
s_waitcnt vmcnt(10) lgkmcnt(1)
v_fma_mix_f32 v217, v152, v201, v209 op_sel:[1,0,0] op_sel_hi:[1,0,0]
v_cvt_pk_bf16_f32 v220, v216, v217
v_mfma_f32_16x16x32_bf16 v[20:23], a[168:171], a[0:3], v[20:23]
ds_read_b128 a[20:23], v9 offset:46080
v_fma_mix_f32 v218, v153, v202, v210 op_sel:[0,0,0] op_sel_hi:[1,0,0]
v_mfma_f32_16x16x32_bf16 v[24:27], a[172:175], a[0:3], v[24:27]
buffer_load_dwordx4 a[224:227], v5, s[4:7], s59 offen offset:512 sc1
v_fma_mix_f32 v219, v153, v203, v211 op_sel:[1,0,0] op_sel_hi:[1,0,0]
v_mfma_f32_16x16x32_bf16 v[28:31], a[0:3], a[176:179], v[28:31]
ds_read_b128 a[24:27], v9 offset:47104
v_cvt_pk_bf16_f32 v221, v218, v219
v_mfma_f32_16x16x32_bf16 v[32:35], a[180:183], a[0:3], v[32:35]
ds_read_b128 a[28:31], v9 offset:48128
v_fma_mix_f32 v216, v154, v204, v212 op_sel:[0,0,0] op_sel_hi:[1,0,0]
v_mfma_f32_16x16x32_bf16 v[36:39], a[168:171], a[4:7], v[36:39]
ds_read_b128 a[32:35], v9 offset:49152
v_fma_mix_f32 v217, v154, v205, v213 op_sel:[1,0,0] op_sel_hi:[1,0,0]
v_mfma_f32_16x16x32_bf16 v[40:43], a[172:175], a[4:7], v[40:43]
buffer_load_dwordx4 a[228:231], v6, s[4:7], s59 offen offset:768 sc1
s_add_u32 s59, s59, 16384
v_mfma_f32_16x16x32_bf16 v[44:47], a[4:7], a[176:179], v[44:47]
ds_read_b128 a[36:39], v9 offset:50176
v_cvt_pk_bf16_f32 v222, v216, v217
v_mfma_f32_16x16x32_bf16 v[48:51], a[180:183], a[4:7], v[48:51]
ds_write_b128 v253, v[224:227] offset:0
v_mfma_f32_16x16x32_bf16 v[52:55], a[168:171], a[8:11], v[52:55]
v_fma_mix_f32 v218, v155, v206, v214 op_sel:[0,0,0] op_sel_hi:[1,0,0]
v_fma_mix_f32 v219, v155, v207, v215 op_sel:[1,0,0] op_sel_hi:[1,0,0]
v_mfma_f32_16x16x32_bf16 v[56:59], a[172:175], a[8:11], v[56:59]
buffer_load_dwordx4 a[40:43], v5, s[4:7], s59 offen offset:0 sc1
v_cvt_pk_bf16_f32 v223, v218, v219
v_mfma_f32_16x16x32_bf16 v[60:63], a[8:11], a[176:179], v[60:63]
v_fma_mix_f32 v216, v172, v200, v208 op_sel:[0,0,0] op_sel_hi:[1,0,0]
v_fma_mix_f32 v217, v172, v201, v209 op_sel:[1,0,0] op_sel_hi:[1,0,0]
v_mfma_f32_16x16x32_bf16 v[64:67], a[180:183], a[8:11], v[64:67]
ds_write_b128 v254, v[220:223] offset:0
v_mfma_f32_16x16x32_bf16 v[68:71], a[168:171], a[12:15], v[68:71]
v_cvt_pk_bf16_f32 v224, v216, v217
v_fma_mix_f32 v218, v173, v202, v210 op_sel:[0,0,0] op_sel_hi:[1,0,0]
v_mfma_f32_16x16x32_bf16 v[72:75], a[172:175], a[12:15], v[72:75]
buffer_load_dwordx4 a[44:47], v5, s[4:7], s59 offen offset:256 sc1
v_fma_mix_f32 v219, v173, v203, v211 op_sel:[1,0,0] op_sel_hi:[1,0,0]
v_mfma_f32_16x16x32_bf16 v[76:79], a[12:15], a[176:179], v[76:79]
v_cvt_pk_bf16_f32 v225, v218, v219
v_fma_mix_f32 v216, v174, v204, v212 op_sel:[0,0,0] op_sel_hi:[1,0,0]
v_mfma_f32_16x16x32_bf16 v[80:83], a[180:183], a[12:15], v[80:83]
v_fma_mix_f32 v217, v174, v205, v213 op_sel:[1,0,0] op_sel_hi:[1,0,0]
v_cvt_pk_bf16_f32 v226, v216, v217
v_mfma_f32_16x16x32_bf16 v[84:87], a[168:171], a[16:19], v[84:87]
v_fma_mix_f32 v218, v175, v206, v214 op_sel:[0,0,0] op_sel_hi:[1,0,0]
v_fma_mix_f32 v219, v175, v207, v215 op_sel:[1,0,0] op_sel_hi:[1,0,0]
v_mfma_f32_16x16x32_bf16 v[88:91], a[172:175], a[16:19], v[88:91]
v_cvt_pk_bf16_f32 v227, v218, v219
v_fma_mix_f32 v216, v192, v200, v208 op_sel:[0,0,0] op_sel_hi:[1,0,0]
v_mfma_f32_16x16x32_bf16 v[92:95], a[16:19], a[176:179], v[92:95]
v_fma_mix_f32 v217, v192, v201, v209 op_sel:[1,0,0] op_sel_hi:[1,0,0]
v_cvt_pk_bf16_f32 v220, v216, v217
v_mfma_f32_16x16x32_bf16 v[96:99], a[180:183], a[16:19], v[96:99]
s_waitcnt vmcnt(10) lgkmcnt(2)
v_fma_mix_f32 v218, v193, v202, v210 op_sel:[0,0,0] op_sel_hi:[1,0,0]
v_fma_mix_f32 v219, v193, v203, v211 op_sel:[1,0,0] op_sel_hi:[1,0,0]
v_mfma_f32_16x16x32_bf16 v[20:23], a[184:187], a[20:23], v[20:23]
ds_read_b128 a[0:3], v8 offset:51200
v_cvt_pk_bf16_f32 v221, v218, v219
v_mfma_f32_16x16x32_bf16 v[24:27], a[188:191], a[20:23], v[24:27]
buffer_load_dwordx4 a[48:51], v5, s[4:7], s59 offen offset:512 sc1
v_fma_mix_f32 v216, v194, v204, v212 op_sel:[0,0,0] op_sel_hi:[1,0,0]
v_mfma_f32_16x16x32_bf16 v[28:31], a[20:23], a[192:195], v[28:31]
ds_read_b128 a[4:7], v8 offset:52224
v_fma_mix_f32 v217, v194, v205, v213 op_sel:[1,0,0] op_sel_hi:[1,0,0]
v_mfma_f32_16x16x32_bf16 v[32:35], a[196:199], a[20:23], v[32:35]
ds_read_b128 a[8:11], v8 offset:53248
v_cvt_pk_bf16_f32 v222, v216, v217
v_mfma_f32_16x16x32_bf16 v[36:39], a[184:187], a[24:27], v[36:39]
ds_read_b128 a[12:15], v8 offset:54272
v_fma_mix_f32 v218, v195, v206, v214 op_sel:[0,0,0] op_sel_hi:[1,0,0]
v_mfma_f32_16x16x32_bf16 v[40:43], a[188:191], a[24:27], v[40:43]
buffer_load_dwordx4 a[52:55], v6, s[4:7], s59 offen offset:768 sc1
s_add_u32 s59, s59, 16384
v_mfma_f32_16x16x32_bf16 v[44:47], a[24:27], a[192:195], v[44:47]
ds_read_b128 a[16:19], v8 offset:55296
v_fma_mix_f32 v219, v195, v207, v215 op_sel:[1,0,0] op_sel_hi:[1,0,0]
v_mfma_f32_16x16x32_bf16 v[48:51], a[196:199], a[24:27], v[48:51]
ds_write_b128 v244, v[224:227] offset:0
v_mfma_f32_16x16x32_bf16 v[52:55], a[184:187], a[28:31], v[52:55]
v_cvt_pk_bf16_f32 v223, v218, v219
v_mfma_f32_16x16x32_bf16 v[56:59], a[188:191], a[28:31], v[56:59]
buffer_load_dwordx4 a[56:59], v5, s[4:7], s59 offen offset:0 sc1
v_mfma_f32_16x16x32_bf16 v[60:63], a[28:31], a[192:195], v[60:63]
v_mfma_f32_16x16x32_bf16 v[64:67], a[196:199], a[28:31], v[64:67]
ds_write_b128 v245, v[220:223] offset:0
v_mfma_f32_16x16x32_bf16 v[68:71], a[184:187], a[32:35], v[68:71]
v_mfma_f32_16x16x32_bf16 v[72:75], a[188:191], a[32:35], v[72:75]
buffer_load_dwordx4 a[60:63], v5, s[4:7], s59 offen offset:256 sc1
v_mfma_f32_16x16x32_bf16 v[76:79], a[32:35], a[192:195], v[76:79]
v_mfma_f32_16x16x32_bf16 v[80:83], a[196:199], a[32:35], v[80:83]
ds_read_b128 v[200:203], v10 offset:4608
v_mfma_f32_16x16x32_bf16 v[84:87], a[184:187], a[36:39], v[84:87]
ds_read_b128 v[204:207], v10 offset:4624
v_mfma_f32_16x16x32_bf16 v[88:91], a[188:191], a[36:39], v[88:91]
buffer_load_dwordx4 a[64:67], v5, s[4:7], s59 offen offset:512 sc1
v_mfma_f32_16x16x32_bf16 v[92:95], a[36:39], a[192:195], v[92:95]
ds_read_b128 v[208:211], v10 offset:2048
v_mfma_f32_16x16x32_bf16 v[96:99], a[196:199], a[36:39], v[96:99]
s_waitcnt vmcnt(11) lgkmcnt(5)
v_mfma_f32_16x16x32_bf16 v[20:23], a[200:203], a[0:3], v[20:23]
ds_read_b128 a[20:23], v9 offset:56320
v_mfma_f32_16x16x32_bf16 v[24:27], a[204:207], a[0:3], v[24:27]
buffer_load_dwordx4 a[68:71], v6, s[4:7], s59 offen offset:768 sc1
s_add_u32 s59, s59, 16384
v_mfma_f32_16x16x32_bf16 v[28:31], a[0:3], a[208:211], v[28:31]
ds_read_b128 a[24:27], v9 offset:57344
v_mfma_f32_16x16x32_bf16 v[32:35], a[212:215], a[0:3], v[32:35]
ds_read_b128 a[28:31], v9 offset:58368
v_mfma_f32_16x16x32_bf16 v[36:39], a[200:203], a[4:7], v[36:39]
ds_read_b128 a[32:35], v9 offset:59392
v_mfma_f32_16x16x32_bf16 v[40:43], a[204:207], a[4:7], v[40:43]
buffer_load_dwordx4 a[72:75], v5, s[4:7], s59 offen offset:0 sc1
v_mfma_f32_16x16x32_bf16 v[44:47], a[4:7], a[208:211], v[44:47]
ds_read_b128 a[36:39], v9 offset:60416
v_mfma_f32_16x16x32_bf16 v[48:51], a[212:215], a[4:7], v[48:51]
ds_read_b128 v[212:215], v10 offset:2064
v_mfma_f32_16x16x32_bf16 v[52:55], a[200:203], a[8:11], v[52:55]
v_mfma_f32_16x16x32_bf16 v[56:59], a[204:207], a[8:11], v[56:59]
buffer_load_dwordx4 a[76:79], v5, s[4:7], s59 offen offset:256 sc1
v_mfma_f32_16x16x32_bf16 v[60:63], a[8:11], a[208:211], v[60:63]
v_mfma_f32_16x16x32_bf16 v[64:67], a[212:215], a[8:11], v[64:67]
s_waitcnt lgkmcnt(0)
v_fma_mix_f32 v216, v116, v200, v208 op_sel:[0,0,0] op_sel_hi:[1,0,0]
v_fma_mix_f32 v217, v116, v201, v209 op_sel:[1,0,0] op_sel_hi:[1,0,0]
v_mfma_f32_16x16x32_bf16 v[68:71], a[200:203], a[12:15], v[68:71]
v_cvt_pk_bf16_f32 v220, v216, v217
v_fma_mix_f32 v218, v117, v202, v210 op_sel:[0,0,0] op_sel_hi:[1,0,0]
v_mfma_f32_16x16x32_bf16 v[72:75], a[204:207], a[12:15], v[72:75]
buffer_load_dwordx4 a[80:83], v5, s[4:7], s59 offen offset:512 sc1
v_fma_mix_f32 v219, v117, v203, v211 op_sel:[1,0,0] op_sel_hi:[1,0,0]
v_mfma_f32_16x16x32_bf16 v[76:79], a[12:15], a[208:211], v[76:79]
v_cvt_pk_bf16_f32 v221, v218, v219
v_fma_mix_f32 v216, v118, v204, v212 op_sel:[0,0,0] op_sel_hi:[1,0,0]
v_mfma_f32_16x16x32_bf16 v[80:83], a[212:215], a[12:15], v[80:83]
v_fma_mix_f32 v217, v118, v205, v213 op_sel:[1,0,0] op_sel_hi:[1,0,0]
v_cvt_pk_bf16_f32 v222, v216, v217
v_mfma_f32_16x16x32_bf16 v[84:87], a[200:203], a[16:19], v[84:87]
v_fma_mix_f32 v218, v119, v206, v214 op_sel:[0,0,0] op_sel_hi:[1,0,0]
v_fma_mix_f32 v219, v119, v207, v215 op_sel:[1,0,0] op_sel_hi:[1,0,0]
v_mfma_f32_16x16x32_bf16 v[88:91], a[204:207], a[16:19], v[88:91]
v_cvt_pk_bf16_f32 v223, v218, v219
v_fma_mix_f32 v216, v136, v200, v208 op_sel:[0,0,0] op_sel_hi:[1,0,0]
v_mfma_f32_16x16x32_bf16 v[92:95], a[16:19], a[208:211], v[92:95]
v_fma_mix_f32 v217, v136, v201, v209 op_sel:[1,0,0] op_sel_hi:[1,0,0]
v_cvt_pk_bf16_f32 v224, v216, v217
v_mfma_f32_16x16x32_bf16 v[96:99], a[212:215], a[16:19], v[96:99]
s_waitcnt vmcnt(11)
s_barrier
v_fma_mix_f32 v218, v137, v202, v210 op_sel:[0,0,0] op_sel_hi:[1,0,0]
v_mfma_f32_16x16x32_bf16 v[20:23], a[216:219], a[20:23], v[20:23]
ds_read_b128 a[0:3], v4 offset:0
v_fma_mix_f32 v219, v137, v203, v211 op_sel:[1,0,0] op_sel_hi:[1,0,0]
v_mfma_f32_16x16x32_bf16 v[24:27], a[220:223], a[20:23], v[24:27]
buffer_load_dwordx4 a[84:87], v6, s[4:7], s59 offen offset:768 sc1
s_add_u32 s59, s59, 16384
v_mfma_f32_16x16x32_bf16 v[28:31], a[20:23], a[224:227], v[28:31]
ds_read_b128 a[4:7], v4 offset:1024
v_cvt_pk_bf16_f32 v225, v218, v219
v_mfma_f32_16x16x32_bf16 v[32:35], a[228:231], a[20:23], v[32:35]
ds_read_b128 a[8:11], v4 offset:2048
v_fma_mix_f32 v216, v138, v204, v212 op_sel:[0,0,0] op_sel_hi:[1,0,0]
v_mfma_f32_16x16x32_bf16 v[36:39], a[216:219], a[24:27], v[36:39]
ds_read_b128 a[12:15], v4 offset:3072
v_fma_mix_f32 v217, v138, v205, v213 op_sel:[1,0,0] op_sel_hi:[1,0,0]
v_mfma_f32_16x16x32_bf16 v[40:43], a[220:223], a[24:27], v[40:43]
buffer_load_dwordx4 a[88:91], v5, s[4:7], s59 offen offset:0 sc1
v_cvt_pk_bf16_f32 v226, v216, v217
v_mfma_f32_16x16x32_bf16 v[44:47], a[24:27], a[224:227], v[44:47]
ds_read_b128 a[16:19], v4 offset:4096
v_fma_mix_f32 v218, v139, v206, v214 op_sel:[0,0,0] op_sel_hi:[1,0,0]
v_mfma_f32_16x16x32_bf16 v[48:51], a[228:231], a[24:27], v[48:51]
ds_write_b128 v7, v[220:223] offset:20480
v_mfma_f32_16x16x32_bf16 v[52:55], a[216:219], a[28:31], v[52:55]
v_fma_mix_f32 v219, v139, v207, v215 op_sel:[1,0,0] op_sel_hi:[1,0,0]
v_cvt_pk_bf16_f32 v227, v218, v219
v_mfma_f32_16x16x32_bf16 v[56:59], a[220:223], a[28:31], v[56:59]
buffer_load_dwordx4 a[92:95], v5, s[4:7], s59 offen offset:256 sc1
v_fma_mix_f32 v216, v156, v200, v208 op_sel:[0,0,0] op_sel_hi:[1,0,0]
v_mfma_f32_16x16x32_bf16 v[60:63], a[28:31], a[224:227], v[60:63]
v_fma_mix_f32 v217, v156, v201, v209 op_sel:[1,0,0] op_sel_hi:[1,0,0]
v_cvt_pk_bf16_f32 v220, v216, v217
v_mfma_f32_16x16x32_bf16 v[64:67], a[228:231], a[28:31], v[64:67]
ds_write_b128 v253, v[224:227] offset:20480
v_mfma_f32_16x16x32_bf16 v[68:71], a[216:219], a[32:35], v[68:71]
v_fma_mix_f32 v218, v157, v202, v210 op_sel:[0,0,0] op_sel_hi:[1,0,0]
v_fma_mix_f32 v219, v157, v203, v211 op_sel:[1,0,0] op_sel_hi:[1,0,0]
v_mfma_f32_16x16x32_bf16 v[72:75], a[220:223], a[32:35], v[72:75]
buffer_load_dwordx4 a[96:99], v5, s[4:7], s59 offen offset:512 sc1
v_cvt_pk_bf16_f32 v221, v218, v219
v_mfma_f32_16x16x32_bf16 v[76:79], a[32:35], a[224:227], v[76:79]
v_fma_mix_f32 v216, v158, v204, v212 op_sel:[0,0,0] op_sel_hi:[1,0,0]
v_fma_mix_f32 v217, v158, v205, v213 op_sel:[1,0,0] op_sel_hi:[1,0,0]
v_mfma_f32_16x16x32_bf16 v[80:83], a[228:231], a[32:35], v[80:83]
v_cvt_pk_bf16_f32 v222, v216, v217
v_fma_mix_f32 v218, v159, v206, v214 op_sel:[0,0,0] op_sel_hi:[1,0,0]
v_mfma_f32_16x16x32_bf16 v[84:87], a[216:219], a[36:39], v[84:87]
v_fma_mix_f32 v219, v159, v207, v215 op_sel:[1,0,0] op_sel_hi:[1,0,0]
v_cvt_pk_bf16_f32 v223, v218, v219
v_mfma_f32_16x16x32_bf16 v[88:91], a[220:223], a[36:39], v[88:91]
v_fma_mix_f32 v216, v176, v200, v208 op_sel:[0,0,0] op_sel_hi:[1,0,0]
v_fma_mix_f32 v217, v176, v201, v209 op_sel:[1,0,0] op_sel_hi:[1,0,0]
v_mfma_f32_16x16x32_bf16 v[92:95], a[36:39], a[224:227], v[92:95]
v_cvt_pk_bf16_f32 v224, v216, v217
v_fma_mix_f32 v218, v177, v202, v210 op_sel:[0,0,0] op_sel_hi:[1,0,0]
v_mfma_f32_16x16x32_bf16 v[96:99], a[228:231], a[36:39], v[96:99]
s_waitcnt vmcnt(11) lgkmcnt(2)
v_fma_mix_f32 v219, v177, v203, v211 op_sel:[1,0,0] op_sel_hi:[1,0,0]
v_cvt_pk_bf16_f32 v225, v218, v219
v_mfma_f32_16x16x32_bf16 v[20:23], a[40:43], a[0:3], v[20:23]
ds_read_b128 a[20:23], v251 offset:5120
v_fma_mix_f32 v216, v178, v204, v212 op_sel:[0,0,0] op_sel_hi:[1,0,0]
v_mfma_f32_16x16x32_bf16 v[24:27], a[44:47], a[0:3], v[24:27]
buffer_load_dwordx4 a[100:103], v6, s[4:7], s59 offen offset:768 sc1
s_add_u32 s59, s59, 16384
v_mfma_f32_16x16x32_bf16 v[28:31], a[0:3], a[48:51], v[28:31]
ds_read_b128 a[24:27], v251 offset:6144
v_fma_mix_f32 v217, v178, v205, v213 op_sel:[1,0,0] op_sel_hi:[1,0,0]
v_mfma_f32_16x16x32_bf16 v[32:35], a[52:55], a[0:3], v[32:35]
ds_read_b128 a[28:31], v251 offset:7168
v_cvt_pk_bf16_f32 v226, v216, v217
v_mfma_f32_16x16x32_bf16 v[36:39], a[40:43], a[4:7], v[36:39]
ds_read_b128 a[32:35], v251 offset:8192
v_fma_mix_f32 v218, v179, v206, v214 op_sel:[0,0,0] op_sel_hi:[1,0,0]
v_mfma_f32_16x16x32_bf16 v[40:43], a[44:47], a[4:7], v[40:43]
buffer_load_dwordx4 a[104:107], v5, s[4:7], s59 offen offset:0 sc1
v_fma_mix_f32 v219, v179, v207, v215 op_sel:[1,0,0] op_sel_hi:[1,0,0]
v_mfma_f32_16x16x32_bf16 v[44:47], a[4:7], a[48:51], v[44:47]
ds_read_b128 a[36:39], v251 offset:9216
v_cvt_pk_bf16_f32 v227, v218, v219
v_mfma_f32_16x16x32_bf16 v[48:51], a[52:55], a[4:7], v[48:51]
ds_read_b64_tr_b16 a[168:169], v249 offset:0
v_fma_mix_f32 v216, v196, v200, v208 op_sel:[0,0,0] op_sel_hi:[1,0,0]
v_mfma_f32_16x16x32_bf16 v[52:55], a[40:43], a[8:11], v[52:55]
ds_read_b64_tr_b16 a[170:171], v249 offset:768
v_fma_mix_f32 v217, v196, v201, v209 op_sel:[1,0,0] op_sel_hi:[1,0,0]
v_mfma_f32_16x16x32_bf16 v[56:59], a[44:47], a[8:11], v[56:59]
buffer_load_dwordx4 a[108:111], v5, s[4:7], s59 offen offset:256 sc1
v_mfma_f32_16x16x32_bf16 v[60:63], a[8:11], a[48:51], v[60:63]
ds_read_b64_tr_b16 a[172:173], v252 offset:0
v_mfma_f32_16x16x32_bf16 v[64:67], a[52:55], a[8:11], v[64:67]
ds_read_b64_tr_b16 a[174:175], v252 offset:768
v_mfma_f32_16x16x32_bf16 v[68:71], a[40:43], a[12:15], v[68:71]
ds_write_b128 v254, v[220:223] offset:20480
v_mfma_f32_16x16x32_bf16 v[72:75], a[44:47], a[12:15], v[72:75]
buffer_load_dwordx4 a[112:115], v5, s[4:7], s59 offen offset:512 sc1
v_cvt_pk_bf16_f32 v220, v216, v217
v_mfma_f32_16x16x32_bf16 v[76:79], a[12:15], a[48:51], v[76:79]
v_fma_mix_f32 v218, v197, v202, v210 op_sel:[0,0,0] op_sel_hi:[1,0,0]
v_fma_mix_f32 v219, v197, v203, v211 op_sel:[1,0,0] op_sel_hi:[1,0,0]
v_mfma_f32_16x16x32_bf16 v[80:83], a[52:55], a[12:15], v[80:83]
v_cvt_pk_bf16_f32 v221, v218, v219
v_fma_mix_f32 v216, v198, v204, v212 op_sel:[0,0,0] op_sel_hi:[1,0,0]
v_mfma_f32_16x16x32_bf16 v[84:87], a[40:43], a[16:19], v[84:87]
ds_write_b128 v244, v[224:227] offset:20480
v_mfma_f32_16x16x32_bf16 v[88:91], a[44:47], a[16:19], v[88:91]
buffer_load_dwordx4 a[116:119], v6, s[4:7], s59 offen offset:768 sc1
s_add_u32 s59, s59, 16384
v_mfma_f32_16x16x32_bf16 v[92:95], a[16:19], a[48:51], v[92:95]
v_fma_mix_f32 v217, v198, v205, v213 op_sel:[1,0,0] op_sel_hi:[1,0,0]
v_cvt_pk_bf16_f32 v222, v216, v217
v_mfma_f32_16x16x32_bf16 v[96:99], a[52:55], a[16:19], v[96:99]
s_waitcnt vmcnt(12) lgkmcnt(6)
v_fma_mix_f32 v218, v199, v206, v214 op_sel:[0,0,0] op_sel_hi:[1,0,0]
v_fma_mix_f32 v219, v199, v207, v215 op_sel:[1,0,0] op_sel_hi:[1,0,0]
v_mfma_f32_16x16x32_bf16 v[20:23], a[56:59], a[20:23], v[20:23]
ds_read_b128 a[0:3], v4 offset:10240
v_cvt_pk_bf16_f32 v223, v218, v219
v_mfma_f32_16x16x32_bf16 v[24:27], a[60:63], a[20:23], v[24:27]
buffer_load_dwordx4 a[120:123], v5, s[4:7], s59 offen offset:0 sc1
v_add_u32 v253, 61440, v249
v_mfma_f32_16x16x32_bf16 v[28:31], a[20:23], a[64:67], v[28:31]
ds_read_b128 a[4:7], v4 offset:11264
v_add_u32 v254, 61440, v252
v_mfma_f32_16x16x32_bf16 v[32:35], a[68:71], a[20:23], v[32:35]
ds_read_b128 a[8:11], v4 offset:12288
v_lshlrev_b32 v7, 4, v1
v_mfma_f32_16x16x32_bf16 v[36:39], a[56:59], a[24:27], v[36:39]
ds_read_b128 a[12:15], v4 offset:13312
v_lshl_add_u32 v247, v3, 4, s12
v_mfma_f32_16x16x32_bf16 v[40:43], a[60:63], a[24:27], v[40:43]
buffer_load_dwordx4 a[124:127], v5, s[4:7], s59 offen offset:256 sc1
v_mul_u32_u24 v228, 192, v2
v_mfma_f32_16x16x32_bf16 v[44:47], a[24:27], a[64:67], v[44:47]
ds_read_b128 a[16:19], v4 offset:14336
v_lshl_add_u32 v228, v3, 3, v228
v_mfma_f32_16x16x32_bf16 v[48:51], a[68:71], a[24:27], v[48:51]
ds_read_b64_tr_b16 a[176:177], v249 offset:64
v_add_u32 v248, s13, v228
v_mfma_f32_16x16x32_bf16 v[52:55], a[56:59], a[28:31], v[52:55]
ds_read_b64_tr_b16 a[178:179], v249 offset:832
v_add_u32 v250, s13, v7
v_mfma_f32_16x16x32_bf16 v[56:59], a[60:63], a[28:31], v[56:59]
buffer_load_dwordx4 a[128:131], v5, s[4:7], s59 offen offset:512 sc1
v_lshlrev_b32 v0, 2, v1
v_mfma_f32_16x16x32_bf16 v[60:63], a[28:31], a[64:67], v[60:63]
ds_read_b64_tr_b16 a[180:181], v252 offset:64
v_add_u32 v227, s12, v7
v_mfma_f32_16x16x32_bf16 v[64:67], a[68:71], a[28:31], v[64:67]
ds_read_b64_tr_b16 a[182:183], v252 offset:832
v_min_u32 v226, 13, v1
v_mfma_f32_16x16x32_bf16 v[68:71], a[56:59], a[32:35], v[68:71]
ds_write_b128 v245, v[220:223] offset:20480
v_mfma_f32_16x16x32_bf16 v[72:75], a[60:63], a[32:35], v[72:75]
buffer_load_dwordx4 a[132:135], v6, s[4:7], s59 offen offset:768 sc1
s_add_u32 s59, s59, 16384
v_mfma_f32_16x16x32_bf16 v[76:79], a[32:35], a[64:67], v[76:79]
v_lshlrev_b32 v226, 7, v226
v_lshlrev_b32 v181, 2, v3
v_mfma_f32_16x16x32_bf16 v[80:83], a[68:71], a[32:35], v[80:83]
v_sub_u32 v181, v2, v181
v_mov_b32 v168, 0xf0000000
v_mfma_f32_16x16x32_bf16 v[84:87], a[56:59], a[36:39], v[84:87]
v_subrev_u32 v182, 0, v181
v_bfe_i32 v182, v182, 3, 1
v_mfma_f32_16x16x32_bf16 v[88:91], a[60:63], a[36:39], v[88:91]
v_and_b32 v164, v168, v182
v_mov_b32 v176, 0x3f803f80
v_mfma_f32_16x16x32_bf16 v[92:95], a[36:39], a[64:67], v[92:95]
v_subrev_u32 v182, 1, v181
v_bfe_i32 v182, v182, 3, 1
v_mfma_f32_16x16x32_bf16 v[96:99], a[68:71], a[36:39], v[96:99]
s_waitcnt vmcnt(12) lgkmcnt(5)
v_and_b32 v165, v168, v182
v_mov_b32 v177, 0x3f803f80
v_mfma_f32_16x16x32_bf16 v[20:23], a[72:75], a[0:3], v[20:23]
ds_read_b128 a[20:23], v251 offset:15360
v_subrev_u32 v182, 2, v181
v_mfma_f32_16x16x32_bf16 v[24:27], a[76:79], a[0:3], v[24:27]
buffer_load_dwordx4 a[136:139], v5, s[4:7], s59 offen offset:0 sc1
v_bfe_i32 v182, v182, 3, 1
v_mfma_f32_16x16x32_bf16 v[28:31], a[0:3], a[80:83], v[28:31]
ds_read_b128 a[24:27], v251 offset:16384
v_and_b32 v166, v168, v182
v_mfma_f32_16x16x32_bf16 v[32:35], a[84:87], a[0:3], v[32:35]
ds_read_b128 a[28:31], v251 offset:17408
v_mov_b32 v178, 0x3f803f80
v_mfma_f32_16x16x32_bf16 v[36:39], a[72:75], a[4:7], v[36:39]
ds_read_b128 a[32:35], v251 offset:18432
v_subrev_u32 v182, 3, v181
v_mfma_f32_16x16x32_bf16 v[40:43], a[76:79], a[4:7], v[40:43]
buffer_load_dwordx4 a[140:143], v5, s[4:7], s59 offen offset:256 sc1
v_bfe_i32 v182, v182, 3, 1
v_mfma_f32_16x16x32_bf16 v[44:47], a[4:7], a[80:83], v[44:47]
ds_read_b128 a[36:39], v251 offset:19456
v_and_b32 v167, v168, v182
v_mfma_f32_16x16x32_bf16 v[48:51], a[84:87], a[4:7], v[48:51]
ds_read_b64_tr_b16 a[184:185], v249 offset:128
v_mov_b32 v179, 0x3f803f80
v_mfma_f32_16x16x32_bf16 v[52:55], a[72:75], a[8:11], v[52:55]
ds_read_b64_tr_b16 a[186:187], v249 offset:896
v_and_b32 v181, 1, v1
v_mfma_f32_16x16x32_bf16 v[56:59], a[76:79], a[8:11], v[56:59]
buffer_load_dwordx4 a[144:147], v5, s[4:7], s59 offen offset:512 sc1
v_lshlrev_b32 v181, 4, v181
v_mfma_f32_16x16x32_bf16 v[60:63], a[8:11], a[80:83], v[60:63]
ds_read_b64_tr_b16 a[188:189], v252 offset:128
v_mov_b32 v182, 0x3f80
v_mfma_f32_16x16x32_bf16 v[64:67], a[84:87], a[8:11], v[64:67]
ds_read_b64_tr_b16 a[190:191], v252 offset:896
v_lshlrev_b32 v182, v181, v182
v_mfma_f32_16x16x32_bf16 v[68:71], a[72:75], a[12:15], v[68:71]
v_and_b32 v181, 0x32, v1
v_cmp_eq_u32 vcc, 0x30, v181
v_mfma_f32_16x16x32_bf16 v[72:75], a[76:79], a[12:15], v[72:75]
buffer_load_dwordx4 a[148:151], v6, s[4:7], s59 offen offset:768 sc1
s_add_u32 s59, s59, 16384
v_mfma_f32_16x16x32_bf16 v[76:79], a[12:15], a[80:83], v[76:79]
v_cmp_eq_u32 s[62:63], 50, v181
v_mul_u32_u24 v229, 176, v2
v_mfma_f32_16x16x32_bf16 v[80:83], a[84:87], a[12:15], v[80:83]
v_cndmask_b32 v174, 0, v182, vcc
v_cndmask_b32 v175, 0, v182, s[62:63]
v_mfma_f32_16x16x32_bf16 v[84:87], a[72:75], a[16:19], v[84:87]
v_add_u32 v229, s61, v229
v_lshl_add_u32 v228, v3, 3, v229
v_mfma_f32_16x16x32_bf16 v[88:91], a[76:79], a[16:19], v[88:91]
buffer_load_dwordx4 a[152:155], v5, s[4:7], s59 offen offset:0 sc1
v_mov_b32 v122, 0
v_mfma_f32_16x16x32_bf16 v[92:95], a[16:19], a[80:83], v[92:95]
v_mov_b32 v123, 0
v_mov_b32 v126, 0
v_mfma_f32_16x16x32_bf16 v[96:99], a[84:87], a[16:19], v[96:99]
s_waitcnt vmcnt(13) lgkmcnt(4)
s_barrier
v_mov_b32 v127, 0
v_mfma_f32_16x16x32_bf16 v[20:23], a[88:91], a[20:23], v[20:23]
ds_read_b128 a[0:3], v4 offset:20480
v_mov_b32 v130, 0
v_mfma_f32_16x16x32_bf16 v[24:27], a[92:95], a[20:23], v[24:27]
buffer_load_dwordx4 a[156:159], v5, s[4:7], s59 offen offset:256 sc1
v_mov_b32 v131, 0
v_mfma_f32_16x16x32_bf16 v[28:31], a[20:23], a[96:99], v[28:31]
ds_read_b128 a[4:7], v4 offset:21504
v_mov_b32 v134, 0
v_mfma_f32_16x16x32_bf16 v[32:35], a[100:103], a[20:23], v[32:35]
ds_read_b128 a[8:11], v4 offset:22528
v_mov_b32 v135, 0
v_mfma_f32_16x16x32_bf16 v[36:39], a[88:91], a[24:27], v[36:39]
ds_read_b128 a[12:15], v4 offset:23552
v_mov_b32 v138, 0
v_mfma_f32_16x16x32_bf16 v[40:43], a[92:95], a[24:27], v[40:43]
buffer_load_dwordx4 a[160:163], v5, s[4:7], s59 offen offset:512 sc1
v_mov_b32 v139, 0
v_mfma_f32_16x16x32_bf16 v[44:47], a[24:27], a[96:99], v[44:47]
ds_read_b128 a[16:19], v4 offset:24576
v_mfma_f32_16x16x32_bf16 v[48:51], a[100:103], a[24:27], v[48:51]
ds_read_b64_tr_b16 a[192:193], v249 offset:6144
v_mfma_f32_16x16x32_bf16 v[52:55], a[88:91], a[28:31], v[52:55]
ds_read_b64_tr_b16 a[194:195], v249 offset:6912
v_mfma_f32_16x16x32_bf16 v[56:59], a[92:95], a[28:31], v[56:59]
buffer_load_dwordx4 a[164:167], v6, s[4:7], s59 offen offset:768 sc1
s_add_u32 s59, s59, 16384
v_mfma_f32_16x16x32_bf16 v[60:63], a[28:31], a[96:99], v[60:63]
ds_read_b64_tr_b16 a[196:197], v252 offset:6144
v_mfma_f32_16x16x32_bf16 v[64:67], a[100:103], a[28:31], v[64:67]
ds_read_b64_tr_b16 a[198:199], v252 offset:6912
v_mfma_f32_16x16x32_bf16 v[68:71], a[88:91], a[32:35], v[68:71]
ds_read_b64_tr_b16 a[206:207], v252 offset:6976
s_add_u32 m0, s39, 49152
v_mfma_f32_16x16x32_bf16 v[72:75], a[92:95], a[32:35], v[72:75]
buffer_load_dwordx4 v232, s[24:27], s48 offen offset:0 lds
v_mfma_f32_16x16x32_bf16 v[76:79], a[32:35], a[96:99], v[76:79]
ds_read_b64_tr_b16 a[200:201], v249 offset:6208
v_mfma_f32_16x16x32_bf16 v[80:83], a[100:103], a[32:35], v[80:83]
ds_read_b64_tr_b16 a[202:203], v249 offset:6976
v_mfma_f32_16x16x32_bf16 v[84:87], a[88:91], a[36:39], v[84:87]
ds_read_b64_tr_b16 a[208:209], v249 offset:6272
v_mfma_f32_16x16x32_bf16 v[88:91], a[92:95], a[36:39], v[88:91]
v_mfma_f32_16x16x32_bf16 v[92:95], a[36:39], a[96:99], v[92:95]
ds_read_b64_tr_b16 a[204:205], v252 offset:6208
v_mfma_f32_16x16x32_bf16 v[96:99], a[100:103], a[36:39], v[96:99]
s_waitcnt vmcnt(13) lgkmcnt(9)
v_mfma_f32_16x16x32_bf16 v[20:23], a[104:107], a[0:3], v[20:23]
ds_read_b128 a[20:23], v251 offset:25600
v_mfma_f32_16x16x32_bf16 v[24:27], a[108:111], a[0:3], v[24:27]
buffer_load_dwordx4 v233, s[24:27], s48 offen offset:1024 lds
v_mfma_f32_16x16x32_bf16 v[28:31], a[0:3], a[112:115], v[28:31]
ds_read_b128 a[24:27], v251 offset:26624
v_mfma_f32_16x16x32_bf16 v[32:35], a[116:119], a[0:3], v[32:35]
ds_read_b128 a[28:31], v251 offset:27648
v_mfma_f32_16x16x32_bf16 v[36:39], a[104:107], a[4:7], v[36:39]
ds_read_b128 a[32:35], v251 offset:28672
v_mfma_f32_16x16x32_bf16 v[40:43], a[108:111], a[4:7], v[40:43]
buffer_load_dwordx4 v234, s[24:27], s48 offen offset:2048 lds
s_add_u32 s48, s48, 81920
v_mfma_f32_16x16x32_bf16 v[44:47], a[4:7], a[112:115], v[44:47]
ds_read_b128 a[36:39], v251 offset:29696
v_mfma_f32_16x16x32_bf16 v[48:51], a[116:119], a[4:7], v[48:51]
ds_read_b64_tr_b16 a[210:211], v249 offset:7040
v_mfma_f32_16x16x32_bf16 v[52:55], a[104:107], a[8:11], v[52:55]
ds_read_b64_tr_b16 a[212:213], v252 offset:6272
s_add_u32 m0, s39, 61440
v_mfma_f32_16x16x32_bf16 v[56:59], a[108:111], a[8:11], v[56:59]
buffer_load_dwordx4 v232, s[24:27], s48 offen offset:0 lds
v_mfma_f32_16x16x32_bf16 v[60:63], a[8:11], a[112:115], v[60:63]
ds_read_b64_tr_b16 a[214:215], v252 offset:7040
v_mfma_f32_16x16x32_bf16 v[64:67], a[116:119], a[8:11], v[64:67]
ds_read_b64_tr_b16 a[216:217], v249 offset:12288
v_mfma_f32_16x16x32_bf16 v[68:71], a[104:107], a[12:15], v[68:71]
ds_read_b64_tr_b16 a[224:225], v249 offset:12352
v_mfma_f32_16x16x32_bf16 v[72:75], a[108:111], a[12:15], v[72:75]
buffer_load_dwordx4 v233, s[24:27], s48 offen offset:1024 lds
v_mfma_f32_16x16x32_bf16 v[76:79], a[12:15], a[112:115], v[76:79]
ds_read_b64_tr_b16 a[218:219], v249 offset:13056
v_mfma_f32_16x16x32_bf16 v[80:83], a[116:119], a[12:15], v[80:83]
ds_read_b64_tr_b16 a[220:221], v252 offset:12288
v_mfma_f32_16x16x32_bf16 v[84:87], a[104:107], a[16:19], v[84:87]
ds_read_b64_tr_b16 a[226:227], v249 offset:13120
v_mfma_f32_16x16x32_bf16 v[88:91], a[108:111], a[16:19], v[88:91]
v_mfma_f32_16x16x32_bf16 v[92:95], a[16:19], a[112:115], v[92:95]
ds_read_b64_tr_b16 a[222:223], v252 offset:13056
v_mfma_f32_16x16x32_bf16 v[96:99], a[116:119], a[16:19], v[96:99]
s_waitcnt vmcnt(13) lgkmcnt(9)
v_mfma_f32_16x16x32_bf16 v[20:23], a[120:123], a[20:23], v[20:23]
ds_read_b128 a[0:3], v4 offset:30720
v_mfma_f32_16x16x32_bf16 v[24:27], a[124:127], a[20:23], v[24:27]
buffer_load_dwordx4 v234, s[24:27], s48 offen offset:2048 lds
s_add_u32 s48, s48, 81920
v_mfma_f32_16x16x32_bf16 v[28:31], a[20:23], a[128:131], v[28:31]
ds_read_b128 a[4:7], v4 offset:31744
v_mfma_f32_16x16x32_bf16 v[32:35], a[132:135], a[20:23], v[32:35]
ds_read_b128 a[8:11], v4 offset:32768
v_mfma_f32_16x16x32_bf16 v[36:39], a[120:123], a[24:27], v[36:39]
ds_read_b128 a[12:15], v4 offset:33792
s_add_u32 m0, s49, 122880
v_mfma_f32_16x16x32_bf16 v[40:43], a[124:127], a[24:27], v[40:43]
buffer_load_dwordx4 v235, s[8:11], s50 offen offset:0 lds
v_mfma_f32_16x16x32_bf16 v[44:47], a[24:27], a[128:131], v[44:47]
ds_read_b128 a[16:19], v4 offset:34816
v_mfma_f32_16x16x32_bf16 v[48:51], a[132:135], a[24:27], v[48:51]
ds_read_b64_tr_b16 a[228:229], v252 offset:12352
v_mfma_f32_16x16x32_bf16 v[52:55], a[120:123], a[28:31], v[52:55]
ds_read_b64_tr_b16 a[230:231], v252 offset:13120
v_mfma_f32_16x16x32_bf16 v[56:59], a[124:127], a[28:31], v[56:59]
buffer_load_dwordx4 v236, s[8:11], s50 offen offset:1024 lds
v_mfma_f32_16x16x32_bf16 v[60:63], a[28:31], a[128:131], v[60:63]
ds_read_b64_tr_b16 a[232:233], v249 offset:12416
v_mfma_f32_16x16x32_bf16 v[64:67], a[132:135], a[28:31], v[64:67]
ds_read_b64_tr_b16 a[234:235], v249 offset:13184
v_mfma_f32_16x16x32_bf16 v[68:71], a[120:123], a[32:35], v[68:71]
ds_read_b64_tr_b16 a[242:243], v249 offset:19200
v_mfma_f32_16x16x32_bf16 v[72:75], a[124:127], a[32:35], v[72:75]
buffer_load_dwordx4 v237, s[8:11], s50 offen offset:2048 lds
v_mfma_f32_16x16x32_bf16 v[76:79], a[32:35], a[128:131], v[76:79]
ds_read_b64_tr_b16 a[236:237], v252 offset:12416
v_mfma_f32_16x16x32_bf16 v[80:83], a[132:135], a[32:35], v[80:83]
ds_read_b64_tr_b16 a[238:239], v252 offset:13184
v_mfma_f32_16x16x32_bf16 v[84:87], a[120:123], a[36:39], v[84:87]
ds_read_b64_tr_b16 a[244:245], v252 offset:18432
s_add_u32 m0, s39, 73728
v_mfma_f32_16x16x32_bf16 v[88:91], a[124:127], a[36:39], v[88:91]
buffer_load_dwordx4 v232, s[24:27], s48 offen offset:0 lds
v_mfma_f32_16x16x32_bf16 v[92:95], a[36:39], a[128:131], v[92:95]
ds_read_b64_tr_b16 a[240:241], v249 offset:18432
v_mfma_f32_16x16x32_bf16 v[96:99], a[132:135], a[36:39], v[96:99]
s_waitcnt vmcnt(14) lgkmcnt(9)
v_mfma_f32_16x16x32_bf16 v[20:23], a[136:139], a[0:3], v[20:23]
ds_read_b128 a[20:23], v251 offset:35840
v_mfma_f32_16x16x32_bf16 v[24:27], a[140:143], a[0:3], v[24:27]
buffer_load_dwordx4 v233, s[24:27], s48 offen offset:1024 lds
v_mfma_f32_16x16x32_bf16 v[28:31], a[0:3], a[144:147], v[28:31]
ds_read_b128 a[24:27], v251 offset:36864
v_mfma_f32_16x16x32_bf16 v[32:35], a[148:151], a[0:3], v[32:35]
ds_read_b128 a[28:31], v251 offset:37888
v_mfma_f32_16x16x32_bf16 v[36:39], a[136:139], a[4:7], v[36:39]
ds_read_b128 a[32:35], v251 offset:38912
v_mfma_f32_16x16x32_bf16 v[40:43], a[140:143], a[4:7], v[40:43]
buffer_load_dwordx4 v234, s[24:27], s48 offen offset:2048 lds
s_add_u32 s48, s48, 81920
v_mfma_f32_16x16x32_bf16 v[44:47], a[4:7], a[144:147], v[44:47]
ds_read_b128 a[36:39], v251 offset:39936
v_mfma_f32_16x16x32_bf16 v[48:51], a[148:151], a[4:7], v[48:51]
ds_read_b64_tr_b16 a[246:247], v252 offset:19200
v_mfma_f32_16x16x32_bf16 v[52:55], a[136:139], a[8:11], v[52:55]
ds_read_b64_tr_b16 a[248:249], v249 offset:18496
s_add_u32 m0, s39, 86016
v_mfma_f32_16x16x32_bf16 v[56:59], a[140:143], a[8:11], v[56:59]
buffer_load_dwordx4 v232, s[24:27], s48 offen offset:0 lds
v_mfma_f32_16x16x32_bf16 v[60:63], a[8:11], a[144:147], v[60:63]
ds_read_b64_tr_b16 a[250:251], v249 offset:19264
v_mfma_f32_16x16x32_bf16 v[64:67], a[148:151], a[8:11], v[64:67]
ds_read_b64_tr_b16 a[252:253], v252 offset:18496
v_mfma_f32_16x16x32_bf16 v[68:71], a[136:139], a[12:15], v[68:71]
ds_read_b64_tr_b16 a[44:45], v252 offset:18560
v_mfma_f32_16x16x32_bf16 v[72:75], a[140:143], a[12:15], v[72:75]
buffer_load_dwordx4 v233, s[24:27], s48 offen offset:1024 lds
v_mfma_f32_16x16x32_bf16 v[76:79], a[12:15], a[144:147], v[76:79]
ds_read_b64_tr_b16 a[254:255], v252 offset:19264
v_mfma_f32_16x16x32_bf16 v[80:83], a[148:151], a[12:15], v[80:83]
ds_read_b64_tr_b16 a[40:41], v249 offset:18560
v_mfma_f32_16x16x32_bf16 v[84:87], a[136:139], a[16:19], v[84:87]
ds_read_b64_tr_b16 a[46:47], v252 offset:19328
v_mfma_f32_16x16x32_bf16 v[88:91], a[140:143], a[16:19], v[88:91]
v_mfma_f32_16x16x32_bf16 v[92:95], a[16:19], a[144:147], v[92:95]
ds_read_b64_tr_b16 a[42:43], v249 offset:19328
v_mfma_f32_16x16x32_bf16 v[96:99], a[148:151], a[16:19], v[96:99]
s_waitcnt vmcnt(14) lgkmcnt(9)
s_barrier
s_mov_b32 s62, 1051011932
s_mov_b32 s63, 1051011932
s_mov_b32 s20, 0
s_mov_b32 s21, 0x00ff00ff
v_mfma_f32_16x16x32_bf16 v[32:35], a[164:167], a[20:23], v[32:35]
buffer_load_dwordx2 v[194:195], v231, s[4:7], s23 offen sc1
v_mfma_f32_16x16x32_bf16 v[48:51], a[164:167], a[24:27], v[48:51]
v_mfma_f32_16x16x32_bf16 v[64:67], a[164:167], a[28:31], v[64:67]
v_mfma_f32_16x16x32_bf16 v[80:83], a[164:167], a[32:35], v[80:83]
v_mfma_f32_16x16x32_bf16 v[20:23], a[152:155], a[20:23], v[20:23]
v_mfma_f32_16x16x32_bf16 v[24:27], a[156:159], a[20:23], v[24:27]
v_mfma_f32_16x16x32_bf16 v[36:39], a[152:155], a[24:27], v[36:39]
s_nop 0
v_cvt_pk_bf16_f32 v102, v32, v33
v_mfma_f32_16x16x32_bf16 v[40:43], a[156:159], a[24:27], v[40:43]
v_cvt_pk_bf16_f32 v103, v34, v35
v_cvt_pk_bf16_f32 v106, v48, v49
v_mfma_f32_16x16x32_bf16 v[52:55], a[152:155], a[28:31], v[52:55]
v_cvt_pk_bf16_f32 v107, v50, v51
v_cvt_pk_bf16_f32 v110, v64, v65
v_mfma_f32_16x16x32_bf16 v[56:59], a[156:159], a[28:31], v[56:59]
buffer_load_dwordx4 v[240:243], v238, s[4:7], s51 offen sc1
v_cvt_pk_bf16_f32 v111, v66, v67
v_cvt_pk_bf16_f32 v114, v80, v81
v_mfma_f32_16x16x32_bf16 v[68:71], a[152:155], a[32:35], v[68:71]
v_cvt_pk_bf16_f32 v115, v82, v83
v_permlane32_swap_b32 v122, v102
v_mfma_f32_16x16x32_bf16 v[72:75], a[156:159], a[32:35], v[72:75]
v_permlane32_swap_b32 v123, v103
v_permlane32_swap_b32 v126, v106
v_permlane32_swap_b32 v127, v107
v_permlane32_swap_b32 v130, v110
v_permlane32_swap_b32 v131, v111
v_permlane32_swap_b32 v134, v114
v_permlane32_swap_b32 v135, v115
v_cvt_pk_bf16_f32 v100, v24, v25
v_cvt_pk_bf16_f32 v101, v26, v27
v_cvt_pk_bf16_f32 v120, v20, v21
v_cvt_pk_bf16_f32 v121, v22, v23
buffer_load_dwordx4 v[190:193], v238, s[4:7], s22 offen sc1
v_cvt_pk_bf16_f32 v104, v40, v41
v_cvt_pk_bf16_f32 v105, v42, v43
v_cvt_pk_bf16_f32 v124, v36, v37
v_cvt_pk_bf16_f32 v125, v38, v39
v_cvt_pk_bf16_f32 v108, v56, v57
v_cvt_pk_bf16_f32 v109, v58, v59
v_cvt_pk_bf16_f32 v128, v52, v53
v_cvt_pk_bf16_f32 v129, v54, v55
v_cvt_pk_bf16_f32 v112, v72, v73
v_cvt_pk_bf16_f32 v113, v74, v75
v_cvt_pk_bf16_f32 v132, v68, v69
v_cvt_pk_bf16_f32 v133, v70, v71
v_mfma_f32_16x16x32_bf16 v[24:27], v[100:103], v[120:123], v[164:167]
v_mfma_f32_16x16x32_bf16 v[40:43], v[104:107], v[124:127], v[164:167]
buffer_load_dwordx2 v[244:245], v239, s[28:31], s52 offen
v_mfma_f32_16x16x32_bf16 v[36:39], v[100:103], v[124:127], v[164:167]
v_mfma_f32_16x16x32_bf16 v[56:59], v[108:111], v[128:131], v[164:167]
v_mfma_f32_16x16x32_bf16 v[52:55], v[104:107], v[128:131], v[164:167]
v_mfma_f32_16x16x32_bf16 v[72:75], v[112:115], v[132:135], v[164:167]
v_mfma_f32_16x16x32_bf16 v[68:71], v[108:111], v[132:135], v[164:167]
s_nop 0
v_cndmask_b32 v24, v24, v168, s[20:21]
v_cndmask_b32 v25, v25, v168, s[20:21]
v_cndmask_b32 v26, v26, v168, s[20:21]
v_cndmask_b32 v40, v40, v36, s[20:21]
v_cndmask_b32 v41, v41, v37, s[20:21]
v_cndmask_b32 v42, v42, v38, s[20:21]
v_cndmask_b32 v56, v56, v52, s[20:21]
v_cndmask_b32 v57, v57, v53, s[20:21]
v_cndmask_b32 v58, v58, v54, s[20:21]
v_cndmask_b32 v72, v72, v68, s[20:21]
v_cndmask_b32 v73, v73, v69, s[20:21]
v_cndmask_b32 v74, v74, v70, s[20:21]
buffer_load_dword v196, v226, s[4:7], s14 offen sc1
v_cndmask_b32 v27, v27, v168, s[20:21]
v_max3_f32 v180, v24, v25, v26
v_cndmask_b32 v43, v43, v39, s[20:21]
v_max3_f32 v181, v40, v41, v42
v_cndmask_b32 v59, v59, v55, s[20:21]
v_max3_f32 v182, v56, v57, v58
v_cndmask_b32 v75, v75, v71, s[20:21]
v_max3_f32 v183, v72, v73, v74
v_max_f32 v180, v180, v27
v_max_f32 v181, v181, v43
v_max_f32 v182, v182, v59
v_max_f32 v183, v183, v75
v_mfma_f32_16x16x32_bf16 v[96:99], a[164:167], a[36:39], v[96:99]
v_permlane32_swap_b32 v180, v182
v_permlane32_swap_b32 v181, v183
v_max_f32 v180, v180, v182
v_max_f32 v181, v181, v183
buffer_load_dwordx4 v234, s[24:27], s48 offen offset:2048 lds
s_add_u32 s48, s48, 81920
v_mfma_f32_16x16x32_bf16 v[84:87], a[152:155], a[36:39], v[84:87]
v_permlane16_swap_b32 v180, v181
v_max_f32 v181, v180, v181
v_mul_f32 v180, s62, v181
v_mul_f32 v182, s62, v181
v_mfma_f32_16x16x32_bf16 v[88:91], a[156:159], a[36:39], v[88:91]
s_nop 0
v_permlane32_swap_b32 v180, v182
v_mfma_f32_16x16x32_bf16 v[28:31], a[20:23], a[160:163], v[28:31]
v_mov_b32 v181, v180
v_cvt_pk_bf16_f32 v118, v96, v97
v_mfma_f32_16x16x16_bf16 v[32:35], v[102:103], v[174:175], 0
v_cvt_pk_bf16_f32 v119, v98, v99
v_permlane16_swap_b32 v180, v181
s_add_u32 m0, s39, 98304
v_mfma_f32_16x16x32_bf16 v[44:47], a[24:27], a[160:163], v[44:47]
buffer_load_dwordx4 v232, s[24:27], s48 offen offset:0 lds
v_permlane32_swap_b32 v138, v118
v_permlane32_swap_b32 v139, v119
v_cvt_pk_bf16_f32 v116, v88, v89
v_pk_fma_f32 v[24:25], v[24:25], s[62:63], v[180:181] op_sel:[0,0,0] op_sel_hi:[1,0,0] neg_lo:[0,0,1] neg_hi:[0,0,1]
v_pk_fma_f32 v[26:27], v[26:27], s[62:63], v[180:181] op_sel:[0,0,0] op_sel_hi:[1,0,0] neg_lo:[0,0,1] neg_hi:[0,0,1]
v_cvt_pk_bf16_f32 v117, v90, v91
v_cvt_pk_bf16_f32 v136, v84, v85
v_cvt_pk_bf16_f32 v137, v86, v87
v_exp_f32 v24, v24
v_exp_f32 v25, v25
v_exp_f32 v26, v26
v_exp_f32 v27, v27
v_cvt_pk_bf16_f32 v143, v30, v31
v_mfma_f32_16x16x16_bf16 v[48:51], v[106:107], v[174:175], 0
buffer_load_dwordx4 v233, s[24:27], s48 offen offset:1024 lds
v_cvt_pk_bf16_f32 v30, v24, v25
v_cvt_pk_bf16_f32 v31, v26, v27
v_mfma_f32_16x16x32_bf16 v[88:91], v[116:119], v[136:139], v[164:167]
v_cvt_pk_bf16_f32 v154, v32, v33
v_cvt_pk_bf16_f32 v155, v34, v35
v_mfma_f32_16x16x32_bf16 v[84:87], v[112:115], v[136:139], v[164:167]
v_cvt_pk_bf16_f32 v142, v28, v29
v_cvt_pk_bf16_f32 v145, v46, v47
v_mfma_f32_16x16x32_bf16 v[60:63], a[28:31], a[160:163], v[60:63]
v_mov_b32 v183, v182
v_cvt_pk_bf16_f32 v144, v44, v45
v_mfma_f32_16x16x16_bf16 v[32:35], v[176:177], v[30:31], 0
v_permlane16_swap_b32 v182, v183
v_mfma_f32_16x16x16_bf16 v[20:23], v[142:143], v[30:31], 0
buffer_load_dwordx4 v234, s[24:27], s48 offen offset:2048 lds
s_add_u32 s48, s48, 81920
v_cvt_pk_bf16_f32 v156, v48, v49
v_cvt_pk_bf16_f32 v157, v50, v51
v_mfma_f32_16x16x16_bf16 v[64:67], v[110:111], v[174:175], 0
v_cndmask_b32 v88, v88, v84, s[20:21]
v_cndmask_b32 v89, v89, v85, s[20:21]
v_cndmask_b32 v90, v90, v86, s[20:21]
v_mfma_f32_16x16x16_bf16 v[24:27], v[154:155], v[30:31], 0
v_cndmask_b32 v91, v91, v87, s[20:21]
v_max3_f32 v184, v88, v89, v90
v_mfma_f32_16x16x32_bf16 v[76:79], a[32:35], a[160:163], v[76:79]
v_max_f32 v184, v184, v91
v_cvt_pk_bf16_f32 v147, v62, v63
v_mov_b32 v185, v184
v_rcp_f32 v32, v32
v_pk_fma_f32 v[40:41], v[40:41], s[62:63], v[180:181] op_sel:[0,0,1] op_sel_hi:[1,0,1] neg_lo:[0,0,1] neg_hi:[0,0,1]
v_pk_fma_f32 v[42:43], v[42:43], s[62:63], v[180:181] op_sel:[0,0,1] op_sel_hi:[1,0,1] neg_lo:[0,0,1] neg_hi:[0,0,1]
v_exp_f32 v40, v40
v_exp_f32 v41, v41
v_exp_f32 v42, v42
v_exp_f32 v43, v43
v_cvt_pk_bf16_f32 v46, v40, v41
v_cvt_pk_bf16_f32 v47, v42, v43
v_cndmask_b32 v44, 0, v46, s[20:21]
v_cndmask_b32 v45, 0, v47, s[20:21]
v_xor_b32 v46, v44, v46
v_xor_b32 v47, v45, v47
v_pk_fma_f32 v[56:57], v[56:57], s[62:63], v[182:183] op_sel:[0,0,0] op_sel_hi:[1,0,0] neg_lo:[0,0,1] neg_hi:[0,0,1]
v_pk_fma_f32 v[58:59], v[58:59], s[62:63], v[182:183] op_sel:[0,0,0] op_sel_hi:[1,0,0] neg_lo:[0,0,1] neg_hi:[0,0,1]
v_mfma_f32_16x16x32_bf16 v[48:51], v[176:179], v[44:47], 0
v_exp_f32 v56, v56
v_exp_f32 v57, v57
v_exp_f32 v58, v58
v_exp_f32 v59, v59
v_cvt_pk_bf16_f32 v146, v60, v61
v_mfma_f32_16x16x32_bf16 v[36:39], v[142:145], v[44:47], 0
v_cvt_pk_bf16_f32 v62, v56, v57
v_cvt_pk_bf16_f32 v63, v58, v59
v_cndmask_b32 v60, 0, v62, s[20:21]
v_cndmask_b32 v61, 0, v63, s[20:21]
v_mfma_f32_16x16x16_bf16 v[80:83], v[114:115], v[174:175], 0
v_permlane32_swap_b32 v184, v185
v_xor_b32 v62, v60, v62
v_xor_b32 v63, v61, v63
v_cvt_pk_bf16_f32 v158, v64, v65
v_pk_mul_f32 v[20:21], v[20:21], v[32:33] op_sel_hi:[1,0]
v_pk_mul_f32 v[22:23], v[22:23], v[32:33] op_sel_hi:[1,0]
v_cvt_pk_bf16_f32 v20, v20, v21
v_cvt_pk_bf16_f32 v159, v66, v67
v_max_f32 v184, v184, v185
v_cvt_pk_bf16_f32 v21, v22, v23
v_mfma_f32_16x16x32_bf16 v[40:43], v[154:157], v[44:47], 0
ds_write_b64 v228, v[20:21] offset:0
v_mfma_f32_16x16x32_bf16 v[92:95], a[36:39], a[160:163], v[92:95]
v_mov_b32 v185, v184
v_cvt_pk_bf16_f32 v149, v78, v79
v_mfma_f32_16x16x32_bf16 v[64:67], v[176:179], v[60:63], 0
v_rcp_f32 v48, v48
v_cvt_pk_bf16_f32 v148, v76, v77
v_permlane16_swap_b32 v184, v185
v_pk_fma_f32 v[72:73], v[72:73], s[62:63], v[182:183] op_sel:[0,0,1] op_sel_hi:[1,0,1] neg_lo:[0,0,1] neg_hi:[0,0,1]
v_pk_fma_f32 v[74:75], v[74:75], s[62:63], v[182:183] op_sel:[0,0,1] op_sel_hi:[1,0,1] neg_lo:[0,0,1] neg_hi:[0,0,1]
v_exp_f32 v72, v72
v_exp_f32 v73, v73
v_exp_f32 v74, v74
v_exp_f32 v75, v75
v_pk_mul_f32 v[24:25], v[24:25], v[32:33] op_sel_hi:[1,0]
v_pk_mul_f32 v[26:27], v[26:27], v[32:33] op_sel_hi:[1,0]
v_cvt_pk_bf16_f32 v24, v24, v25
v_cvt_pk_bf16_f32 v25, v26, v27
v_mfma_f32_16x16x32_bf16 v[52:55], v[144:147], v[60:63], 0
ds_write_b64 v229, v[24:25] offset:32
v_cvt_pk_bf16_f32 v78, v72, v73
v_cvt_pk_bf16_f32 v79, v74, v75
v_cndmask_b32 v76, 0, v78, s[20:21]
v_cndmask_b32 v77, 0, v79, s[20:21]
v_mfma_f32_16x16x16_bf16 v[96:99], v[118:119], v[174:175], 0
v_max_f32 v184, v184, v185
v_xor_b32 v78, v76, v78
v_xor_b32 v79, v77, v79
v_mul_f32 v184, s62, v184
v_cvt_pk_bf16_f32 v160, v80, v81
v_pk_mul_f32 v[36:37], v[36:37], v[48:49] op_sel_hi:[1,0]
v_pk_mul_f32 v[38:39], v[38:39], v[48:49] op_sel_hi:[1,0]
v_cvt_pk_bf16_f32 v36, v36, v37
v_cvt_pk_bf16_f32 v161, v82, v83
v_cvt_pk_bf16_f32 v37, v38, v39
v_mfma_f32_16x16x32_bf16 v[56:59], v[156:159], v[60:63], 0
ds_write_b64 v228, v[36:37] offset:2816
v_mfma_f32_16x16x32_bf16 v[80:83], v[176:179], v[76:79], 0
v_cvt_pk_bf16_f32 v151, v94, v95
v_rcp_f32 v64, v64
v_cvt_pk_bf16_f32 v150, v92, v93
v_mfma_f32_16x16x32_bf16 v[68:71], v[146:149], v[76:79], 0
v_cvt_pk_bf16_f32 v162, v96, v97
v_cvt_pk_bf16_f32 v163, v98, v99
v_mfma_f32_16x16x32_bf16 v[72:75], v[158:161], v[76:79], 0
s_nop 0
v_rcp_f32 v80, v80
v_pk_fma_f32 v[88:89], v[88:89], s[62:63], v[184:185] op_sel:[0,0,0] op_sel_hi:[1,0,0] neg_lo:[0,0,1] neg_hi:[0,0,1]
v_pk_fma_f32 v[90:91], v[90:91], s[62:63], v[184:185] op_sel:[0,0,0] op_sel_hi:[1,0,0] neg_lo:[0,0,1] neg_hi:[0,0,1]
v_exp_f32 v88, v88
v_exp_f32 v89, v89
v_exp_f32 v90, v90
v_exp_f32 v91, v91
v_pk_mul_f32 v[40:41], v[40:41], v[48:49] op_sel_hi:[1,0]
v_pk_mul_f32 v[42:43], v[42:43], v[48:49] op_sel_hi:[1,0]
v_cvt_pk_bf16_f32 v40, v40, v41
v_cvt_pk_bf16_f32 v41, v42, v43
v_cvt_pk_bf16_f32 v94, v88, v89
v_cvt_pk_bf16_f32 v95, v90, v91
ds_write_b64 v229, v[40:41] offset:2848
v_cndmask_b32 v92, 0, v94, s[20:21]
v_cndmask_b32 v93, 0, v95, s[20:21]
v_pk_mul_f32 v[52:53], v[52:53], v[64:65] op_sel_hi:[1,0]
v_xor_b32 v94, v92, v94
v_xor_b32 v95, v93, v95
v_pk_mul_f32 v[54:55], v[54:55], v[64:65] op_sel_hi:[1,0]
v_cvt_pk_bf16_f32 v52, v52, v53
v_cvt_pk_bf16_f32 v53, v54, v55
ds_write_b64 v228, v[52:53] offset:5632
v_mfma_f32_16x16x32_bf16 v[96:99], v[176:179], v[92:95], 0
v_mfma_f32_16x16x32_bf16 v[84:87], v[148:151], v[92:95], 0
v_mfma_f32_16x16x32_bf16 v[88:91], v[160:163], v[92:95], 0
v_pk_mul_f32 v[56:57], v[56:57], v[64:65] op_sel_hi:[1,0]
v_pk_mul_f32 v[58:59], v[58:59], v[64:65] op_sel_hi:[1,0]
v_cvt_pk_bf16_f32 v56, v56, v57
v_cvt_pk_bf16_f32 v57, v58, v59
ds_write_b64 v229, v[56:57] offset:5664
v_pk_mul_f32 v[68:69], v[68:69], v[80:81] op_sel_hi:[1,0]
v_pk_mul_f32 v[70:71], v[70:71], v[80:81] op_sel_hi:[1,0]
v_cvt_pk_bf16_f32 v68, v68, v69
v_cvt_pk_bf16_f32 v69, v70, v71
ds_write_b64 v228, v[68:69] offset:8448
v_pk_mul_f32 v[72:73], v[72:73], v[80:81] op_sel_hi:[1,0]
v_pk_mul_f32 v[74:75], v[74:75], v[80:81] op_sel_hi:[1,0]
v_cvt_pk_bf16_f32 v72, v72, v73
v_rcp_f32 v96, v96
v_cvt_pk_bf16_f32 v73, v74, v75
ds_write_b64 v229, v[72:73] offset:8480
v_pk_mul_f32 v[84:85], v[84:85], v[96:97] op_sel_hi:[1,0]
v_pk_mul_f32 v[86:87], v[86:87], v[96:97] op_sel_hi:[1,0]
v_cvt_pk_bf16_f32 v84, v84, v85
v_cvt_pk_bf16_f32 v85, v86, v87
ds_write_b64 v228, v[84:85] offset:11264
v_pk_mul_f32 v[88:89], v[88:89], v[96:97] op_sel_hi:[1,0]
v_pk_mul_f32 v[90:91], v[90:91], v[96:97] op_sel_hi:[1,0]
v_cvt_pk_bf16_f32 v88, v88, v89
v_cvt_pk_bf16_f32 v89, v90, v91
ds_write_b64 v229, v[88:89] offset:11296
s_waitcnt vmcnt(17) lgkmcnt(0)
s_barrier
ds_read_b128 v[20:23], v15 offset:0
ds_read_b128 v[24:27], v16 offset:256
ds_read_b128 v[28:31], v17 offset:512
ds_read_b128 v[32:35], v18 offset:768
s_mul_i32 s56, s53, 20480
s_add_u32 s56, s56, 4194304
s_mov_b32 s55, 0x05040100
s_add_u32 s57, s56, 4096
s_add_u32 s58, s56, 8192
s_add_u32 s59, s56, 12288
s_add_u32 s60, s56, 16384
s_waitcnt lgkmcnt(3)
buffer_store_dwordx4 v[20:23], v11, s[4:7], s46 offen sc1
s_waitcnt lgkmcnt(2)
buffer_store_dwordx4 v[24:27], v12, s[4:7], s46 offen sc1
s_waitcnt lgkmcnt(1)
buffer_store_dwordx4 v[28:31], v13, s[4:7], s46 offen sc1
s_waitcnt lgkmcnt(0)
buffer_store_dwordx4 v[32:35], v14, s[4:7], s46 offen sc1
s_waitcnt vmcnt(8)
v_perm_b32 v36, v241, v240, s55
v_perm_b32 v37, v243, v242, s55
v_xor_b32 v36, s40, v36
v_xor_b32 v37, s40, v37
v_or_b32 v38, v36, v37
v_perm_b32 v36, v191, v190, s55
v_perm_b32 v37, v193, v192, s55
v_xor_b32 v36, s40, v36
v_xor_b32 v37, s40, v37
v_or3_b32 v38, v38, v36, v37
v_and_b32 v38, v38, v230
v_xor_b32 v37, s40, v194
v_or_b32 v38, v38, v37
v_cmp_ne_u32 vcc, 0, v38
s_cbranch_vccnz L_mv_retry
L_mv_ok:
v_cmp_ne_u32 vcc, s19, v195
v_and_b32 v240, 0xffff0000, v240
v_and_b32 v241, 0xffff0000, v241
v_and_b32 v242, 0xffff0000, v242
v_and_b32 v243, 0xffff0000, v243
v_and_b32 v190, 0xffff0000, v190
v_and_b32 v191, 0xffff0000, v191
v_and_b32 v192, 0xffff0000, v192
v_and_b32 v193, 0xffff0000, v193
s_lshr_b32 s15, vcc_lo, 16
v_lshlrev_b32 v40, 16, v244
v_and_b32 v41, 0xffff0000, v244
v_lshlrev_b32 v42, 16, v245
v_and_b32 v43, 0xffff0000, v245
v_pk_mul_f32 v[40:41], v[40:41], v[190:191]
v_pk_mul_f32 v[42:43], v[42:43], v[192:193]
s_mov_b32 exec_hi, 0xffff
ds_write_b128 v227, v[40:43] offset:1536
ds_write_b128 v227, v[240:243]
ds_write_b128 v227, v[190:193] offset:768
s_mov_b32 exec_hi, -1
s_add_u32 m0, s39, 110592
s_nop 0
buffer_load_dwordx4 v232, s[24:27], s48 offen offset:0 lds
ds_read_b128 v[204:207], v247 offset:1536
ds_read_b128 v[208:211], v247 offset:1600
ds_read_b128 v[212:215], v247 offset:1664
ds_read_b128 v[216:219], v247 offset:1728
ds_read_b128 v[220:223], v247 offset:1792
ds_read_b128 v[224:227], v247 offset:1856
buffer_load_dwordx4 v233, s[24:27], s48 offen offset:1024 lds
ds_read_b64 v[80:81], v248 offset:0
ds_read_b64 v[82:83], v248 offset:32
ds_read_b64 v[84:85], v248 offset:64
ds_read_b64 v[86:87], v248 offset:96
ds_read_b64 v[88:89], v248 offset:128
ds_read_b64 v[90:91], v248 offset:160
buffer_load_dwordx4 v234, s[24:27], s48 offen offset:2048 lds
s_add_u32 s48, s48, 81920
ds_read_b64_tr_b16 a[48:49], v249 offset:24576
ds_read_b64_tr_b16 a[50:51], v249 offset:25344
ds_read_b64_tr_b16 a[52:53], v252 offset:24576
ds_read_b64_tr_b16 a[54:55], v252 offset:25344
ds_read_b64_tr_b16 a[56:57], v249 offset:24640
ds_read_b64_tr_b16 a[58:59], v249 offset:25408
ds_read_b64_tr_b16 a[60:61], v252 offset:24640
ds_read_b64_tr_b16 a[62:63], v252 offset:25408
ds_read_b64_tr_b16 a[64:65], v249 offset:24704
ds_read_b64_tr_b16 a[66:67], v249 offset:25472
ds_read_b64_tr_b16 a[68:69], v252 offset:24704
ds_read_b64_tr_b16 a[70:71], v252 offset:25472
ds_read_b64_tr_b16 a[72:73], v249 offset:30720
ds_read_b64_tr_b16 a[74:75], v249 offset:31488
ds_read_b64_tr_b16 a[76:77], v252 offset:30720
ds_read_b64_tr_b16 a[78:79], v252 offset:31488
ds_read_b64_tr_b16 a[80:81], v249 offset:30784
ds_read_b64_tr_b16 a[82:83], v249 offset:31552
ds_read_b64_tr_b16 a[84:85], v252 offset:30784
ds_read_b64_tr_b16 a[86:87], v252 offset:31552
ds_read_b64_tr_b16 a[88:89], v249 offset:30848
ds_read_b64_tr_b16 a[90:91], v249 offset:31616
ds_read_b64_tr_b16 a[92:93], v252 offset:30848
ds_read_b64_tr_b16 a[94:95], v252 offset:31616
ds_read_b64_tr_b16 a[96:97], v249 offset:36864
ds_read_b64_tr_b16 a[98:99], v249 offset:37632
ds_read_b64_tr_b16 a[100:101], v252 offset:36864
ds_read_b64_tr_b16 a[102:103], v252 offset:37632
ds_read_b64_tr_b16 a[104:105], v249 offset:36928
ds_read_b64_tr_b16 a[106:107], v249 offset:37696
ds_read_b64_tr_b16 a[108:109], v252 offset:36928
ds_read_b64_tr_b16 a[110:111], v252 offset:37696
ds_read_b64_tr_b16 a[112:113], v249 offset:36992
ds_read_b64_tr_b16 a[114:115], v249 offset:37760
ds_read_b64_tr_b16 a[116:117], v252 offset:36992
ds_read_b64_tr_b16 a[118:119], v252 offset:37760
ds_read_b64_tr_b16 a[120:121], v249 offset:43008
ds_read_b64_tr_b16 a[122:123], v249 offset:43776
ds_read_b64_tr_b16 a[124:125], v252 offset:43008
ds_read_b64_tr_b16 a[126:127], v252 offset:43776
ds_read_b64_tr_b16 a[128:129], v249 offset:43072
ds_read_b64_tr_b16 a[130:131], v249 offset:43840
ds_read_b64_tr_b16 a[132:133], v252 offset:43072
ds_read_b64_tr_b16 a[134:135], v252 offset:43840
ds_read_b64_tr_b16 a[136:137], v249 offset:43136
ds_read_b64_tr_b16 a[138:139], v249 offset:43904
buffer_load_dwordx4 v[100:103], v7, s[4:7], s56 offen offset:0 sc1
ds_read_b64_tr_b16 a[140:141], v252 offset:43136
ds_read_b64_tr_b16 a[142:143], v252 offset:43904
ds_read_b64_tr_b16 a[144:145], v249 offset:49152
ds_read_b64_tr_b16 a[146:147], v249 offset:49920
buffer_load_dwordx4 v[104:107], v7, s[4:7], s56 offen offset:1024 sc1
ds_read_b64_tr_b16 a[148:149], v252 offset:49152
ds_read_b64_tr_b16 a[150:151], v252 offset:49920
ds_read_b64_tr_b16 a[152:153], v249 offset:49216
ds_read_b64_tr_b16 a[154:155], v249 offset:49984
buffer_load_dwordx4 v[108:111], v7, s[4:7], s56 offen offset:2048 sc1
ds_read_b64_tr_b16 a[156:157], v252 offset:49216
ds_read_b64_tr_b16 a[158:159], v252 offset:49984
ds_read_b64_tr_b16 a[160:161], v249 offset:49280
ds_read_b64_tr_b16 a[162:163], v249 offset:50048
buffer_load_dwordx4 v[112:115], v7, s[4:7], s56 offen offset:3072 sc1
ds_read_b64_tr_b16 a[164:165], v252 offset:49280
ds_read_b64_tr_b16 a[166:167], v252 offset:50048
ds_read_b64_tr_b16 a[0:1], v249 offset:55296
ds_read_b64_tr_b16 a[2:3], v249 offset:56064
buffer_load_dwordx4 v[116:119], v7, s[4:7], s57 offen offset:0 sc1
ds_read_b64_tr_b16 a[4:5], v252 offset:55296
ds_read_b64_tr_b16 a[6:7], v252 offset:56064
ds_read_b64_tr_b16 a[8:9], v249 offset:55360
ds_read_b64_tr_b16 a[10:11], v249 offset:56128
buffer_load_dwordx4 v[120:123], v7, s[4:7], s57 offen offset:1024 sc1
ds_read_b64_tr_b16 a[12:13], v252 offset:55360
ds_read_b64_tr_b16 a[14:15], v252 offset:56128
ds_read_b64_tr_b16 a[16:17], v249 offset:55424
ds_read_b64_tr_b16 a[18:19], v249 offset:56192
buffer_load_dwordx4 v[124:127], v7, s[4:7], s57 offen offset:2048 sc1
ds_read_b64_tr_b16 a[20:21], v252 offset:55424
ds_read_b64_tr_b16 a[22:23], v252 offset:56192
ds_read_b64_tr_b16 a[24:25], v253 offset:0
ds_read_b64_tr_b16 a[26:27], v253 offset:768
buffer_load_dwordx4 v[128:131], v7, s[4:7], s57 offen offset:3072 sc1
ds_read_b64_tr_b16 a[28:29], v254 offset:0
ds_read_b64_tr_b16 a[30:31], v254 offset:768
ds_read_b64_tr_b16 a[32:33], v253 offset:64
ds_read_b64_tr_b16 a[34:35], v253 offset:832
buffer_load_dwordx4 v[132:135], v7, s[4:7], s58 offen offset:0 sc1
s_waitcnt lgkmcnt(15)
v_pk_add_f32 v[94:95], v[204:205], v[206:207]
v_pk_add_f32 v[94:95], v[94:95], v[208:209]
v_pk_add_f32 v[94:95], v[94:95], v[210:211]
buffer_load_dwordx4 v[136:139], v7, s[4:7], s58 offen offset:1024 sc1
v_pk_add_f32 v[94:95], v[94:95], v[212:213]
v_pk_add_f32 v[94:95], v[94:95], v[214:215]
v_pk_add_f32 v[94:95], v[94:95], v[216:217]
v_pk_add_f32 v[94:95], v[94:95], v[218:219]
v_pk_add_f32 v[94:95], v[94:95], v[220:221]
v_pk_add_f32 v[94:95], v[94:95], v[222:223]
v_pk_add_f32 v[94:95], v[94:95], v[224:225]
v_pk_add_f32 v[94:95], v[94:95], v[226:227]
v_add_f32 v95, v94, v95
s_waitcnt vmcnt(8) lgkmcnt(0)
v_max3_u32 v92, v100, v101, v102
v_max3_u32 v93, v103, v104, v105
v_max3_u32 v92, v92, v106, v107
v_max_u32 v92, v92, v93
v_cmp_eq_u32 vcc, -1, v92
s_cbranch_vccnz L_o0_retry
L_o0_ok:
v_mfma_f32_16x16x32_bf16 v[20:23], a[168:171], v[100:103], 0
ds_read_b64_tr_b16 a[168:169], v254 offset:64
buffer_load_dwordx4 v[140:143], v7, s[4:7], s58 offen offset:2048 sc1
v_mfma_f32_16x16x32_bf16 v[24:27], a[172:175], v[100:103], 0
ds_read_b64_tr_b16 a[170:171], v254 offset:832
buffer_load_dwordx4 v[144:147], v7, s[4:7], s58 offen offset:3072 sc1
v_mfma_f32_16x16x32_bf16 v[28:31], a[176:179], v[100:103], 0
ds_read_b64_tr_b16 a[172:173], v253 offset:128
s_barrier
v_mfma_f32_16x16x32_bf16 v[32:35], a[180:183], v[100:103], 0
ds_read_b64_tr_b16 a[174:175], v253 offset:896
s_waitcnt vmcnt(8)
v_mfma_f32_16x16x32_bf16 v[36:39], a[184:187], v[100:103], 0
ds_read_b64_tr_b16 a[176:177], v254 offset:128
v_max3_u32 v92, v108, v109, v110
v_mfma_f32_16x16x32_bf16 v[40:43], a[188:191], v[100:103], 0
ds_read_b64_tr_b16 a[178:179], v254 offset:896
v_max3_u32 v93, v111, v112, v113
v_mfma_f32_16x16x32_bf16 v[20:23], a[192:195], v[104:107], v[20:23]
ds_read_b64_tr_b16 a[180:181], v253 offset:6144
v_max3_u32 v92, v92, v114, v115
v_mfma_f32_16x16x32_bf16 v[24:27], a[196:199], v[104:107], v[24:27]
ds_read_b64_tr_b16 a[182:183], v253 offset:6912
v_max_u32 v92, v92, v93
v_mfma_f32_16x16x32_bf16 v[28:31], a[200:203], v[104:107], v[28:31]
ds_read_b64_tr_b16 a[184:185], v254 offset:6144
v_lshlrev_b32 v68, 16, v80
v_mfma_f32_16x16x32_bf16 v[32:35], a[204:207], v[104:107], v[32:35]
ds_read_b64_tr_b16 a[186:187], v254 offset:6912
v_cmp_eq_u32 vcc, -1, v92
v_mfma_f32_16x16x32_bf16 v[36:39], a[208:211], v[104:107], v[36:39]
ds_read_b64_tr_b16 a[188:189], v253 offset:6208
v_and_b32 v69, 0xffff0000, v80
v_mfma_f32_16x16x32_bf16 v[40:43], a[212:215], v[104:107], v[40:43]
ds_read_b64_tr_b16 a[190:191], v253 offset:6976
s_cbranch_vccnz L_o1_retry
L_o1_ok:
v_mfma_f32_16x16x32_bf16 v[20:23], a[216:219], v[108:111], v[20:23]
ds_read_b64_tr_b16 a[192:193], v254 offset:6208
buffer_load_dwordx4 v[148:151], v7, s[4:7], s59 offen offset:0 sc1
v_mfma_f32_16x16x32_bf16 v[24:27], a[220:223], v[108:111], v[24:27]
ds_read_b64_tr_b16 a[194:195], v254 offset:6976
buffer_load_dwordx4 v[152:155], v7, s[4:7], s59 offen offset:1024 sc1
v_mfma_f32_16x16x32_bf16 v[28:31], a[224:227], v[108:111], v[28:31]
ds_read_b64_tr_b16 a[196:197], v253 offset:6272
v_lshlrev_b32 v70, 16, v81
v_mfma_f32_16x16x32_bf16 v[32:35], a[228:231], v[108:111], v[32:35]
ds_read_b64_tr_b16 a[198:199], v253 offset:7040
s_waitcnt vmcnt(8)
v_mfma_f32_16x16x32_bf16 v[36:39], a[232:235], v[108:111], v[36:39]
ds_read_b64_tr_b16 a[200:201], v254 offset:6272
v_max3_u32 v92, v116, v117, v118
v_mfma_f32_16x16x32_bf16 v[40:43], a[236:239], v[108:111], v[40:43]
ds_read_b64_tr_b16 a[202:203], v254 offset:7040
v_max3_u32 v93, v119, v120, v121
v_mfma_f32_16x16x32_bf16 v[20:23], a[240:243], v[112:115], v[20:23]
ds_read_b64_tr_b16 a[204:205], v253 offset:12288
v_max3_u32 v92, v92, v122, v123
v_mfma_f32_16x16x32_bf16 v[24:27], a[244:247], v[112:115], v[24:27]
ds_read_b64_tr_b16 a[206:207], v253 offset:13056
v_max_u32 v92, v92, v93
v_mfma_f32_16x16x32_bf16 v[28:31], a[248:251], v[112:115], v[28:31]
ds_read_b64_tr_b16 a[208:209], v254 offset:12288
v_and_b32 v71, 0xffff0000, v81
v_mfma_f32_16x16x32_bf16 v[32:35], a[252:255], v[112:115], v[32:35]
ds_read_b64_tr_b16 a[210:211], v254 offset:13056
v_cmp_eq_u32 vcc, -1, v92
v_mfma_f32_16x16x32_bf16 v[36:39], a[40:43], v[112:115], v[36:39]
ds_read_b64_tr_b16 a[212:213], v253 offset:12352
v_lshlrev_b32 v72, 16, v82
v_mfma_f32_16x16x32_bf16 v[40:43], a[44:47], v[112:115], v[40:43]
ds_read_b64_tr_b16 a[214:215], v253 offset:13120
s_cbranch_vccnz L_o2_retry
L_o2_ok:
v_mfma_f32_16x16x32_bf16 v[20:23], a[48:51], v[116:119], v[20:23]
ds_read_b64_tr_b16 a[216:217], v254 offset:12352
buffer_load_dwordx4 v[156:159], v7, s[4:7], s59 offen offset:2048 sc1
v_mfma_f32_16x16x32_bf16 v[24:27], a[52:55], v[116:119], v[24:27]
ds_read_b64_tr_b16 a[218:219], v254 offset:13120
buffer_load_dwordx4 v[160:163], v7, s[4:7], s59 offen offset:3072 sc1
v_mfma_f32_16x16x32_bf16 v[28:31], a[56:59], v[116:119], v[28:31]
ds_read_b64_tr_b16 a[220:221], v253 offset:12416
v_and_b32 v73, 0xffff0000, v82
v_mfma_f32_16x16x32_bf16 v[32:35], a[60:63], v[116:119], v[32:35]
ds_read_b64_tr_b16 a[222:223], v253 offset:13184
s_waitcnt vmcnt(8)
v_mfma_f32_16x16x32_bf16 v[36:39], a[64:67], v[116:119], v[36:39]
ds_read_b64_tr_b16 a[224:225], v254 offset:12416
v_max3_u32 v92, v124, v125, v126
v_mfma_f32_16x16x32_bf16 v[40:43], a[68:71], v[116:119], v[40:43]
ds_read_b64_tr_b16 a[226:227], v254 offset:13184
v_max3_u32 v93, v127, v128, v129
v_mfma_f32_16x16x32_bf16 v[20:23], a[72:75], v[120:123], v[20:23]
ds_read_b64_tr_b16 a[228:229], v253 offset:18432
v_max3_u32 v92, v92, v130, v131
v_mfma_f32_16x16x32_bf16 v[24:27], a[76:79], v[120:123], v[24:27]
ds_read_b64_tr_b16 a[230:231], v253 offset:19200
v_max_u32 v92, v92, v93
v_mfma_f32_16x16x32_bf16 v[28:31], a[80:83], v[120:123], v[28:31]
ds_read_b64_tr_b16 a[232:233], v254 offset:18432
v_lshlrev_b32 v74, 16, v83
v_mfma_f32_16x16x32_bf16 v[32:35], a[84:87], v[120:123], v[32:35]
ds_read_b64_tr_b16 a[234:235], v254 offset:19200
v_cmp_eq_u32 vcc, -1, v92
v_mfma_f32_16x16x32_bf16 v[36:39], a[88:91], v[120:123], v[36:39]
ds_read_b64_tr_b16 a[236:237], v253 offset:18496
v_and_b32 v75, 0xffff0000, v83
v_mfma_f32_16x16x32_bf16 v[40:43], a[92:95], v[120:123], v[40:43]
ds_read_b64_tr_b16 a[238:239], v253 offset:19264
s_cbranch_vccnz L_o3_retry
L_o3_ok:
v_mfma_f32_16x16x32_bf16 v[20:23], a[96:99], v[124:127], v[20:23]
ds_read_b64_tr_b16 a[240:241], v254 offset:18496
buffer_load_dwordx4 v[164:167], v7, s[4:7], s60 offen offset:0 sc1
v_mfma_f32_16x16x32_bf16 v[24:27], a[100:103], v[124:127], v[24:27]
ds_read_b64_tr_b16 a[242:243], v254 offset:19264
buffer_load_dwordx4 v[168:171], v7, s[4:7], s60 offen offset:1024 sc1
v_mfma_f32_16x16x32_bf16 v[28:31], a[104:107], v[124:127], v[28:31]
ds_read_b64_tr_b16 a[244:245], v253 offset:18560
v_lshlrev_b32 v76, 16, v84
v_mfma_f32_16x16x32_bf16 v[32:35], a[108:111], v[124:127], v[32:35]
ds_read_b64_tr_b16 a[246:247], v253 offset:19328
s_waitcnt vmcnt(8)
v_mfma_f32_16x16x32_bf16 v[36:39], a[112:115], v[124:127], v[36:39]
ds_read_b64_tr_b16 a[248:249], v254 offset:18560
v_max3_u32 v92, v132, v133, v134
v_mfma_f32_16x16x32_bf16 v[40:43], a[116:119], v[124:127], v[40:43]
ds_read_b64_tr_b16 a[250:251], v254 offset:19328
v_max3_u32 v93, v135, v136, v137
v_mfma_f32_16x16x32_bf16 v[20:23], a[120:123], v[128:131], v[20:23]
ds_read_b64_tr_b16 a[252:253], v253 offset:24576
v_max3_u32 v92, v92, v138, v139
v_mfma_f32_16x16x32_bf16 v[24:27], a[124:127], v[128:131], v[24:27]
ds_read_b64_tr_b16 a[254:255], v253 offset:25344
v_max_u32 v92, v92, v93
v_mfma_f32_16x16x32_bf16 v[28:31], a[128:131], v[128:131], v[28:31]
ds_read_b64_tr_b16 a[40:41], v254 offset:24576
v_and_b32 v77, 0xffff0000, v84
v_mfma_f32_16x16x32_bf16 v[32:35], a[132:135], v[128:131], v[32:35]
ds_read_b64_tr_b16 a[42:43], v254 offset:25344
v_cmp_eq_u32 vcc, -1, v92
v_mfma_f32_16x16x32_bf16 v[36:39], a[136:139], v[128:131], v[36:39]
ds_read_b64_tr_b16 a[44:45], v253 offset:24640
v_lshlrev_b32 v78, 16, v85
v_mfma_f32_16x16x32_bf16 v[40:43], a[140:143], v[128:131], v[40:43]
ds_read_b64_tr_b16 a[46:47], v253 offset:25408
s_cbranch_vccnz L_o4_retry
L_o4_ok:
v_mfma_f32_16x16x32_bf16 v[20:23], a[144:147], v[132:135], v[20:23]
ds_read_b64_tr_b16 a[48:49], v254 offset:24640
buffer_load_dwordx4 v[172:175], v7, s[4:7], s60 offen offset:2048 sc1
v_mfma_f32_16x16x32_bf16 v[24:27], a[148:151], v[132:135], v[24:27]
ds_read_b64_tr_b16 a[50:51], v254 offset:25408
buffer_load_dwordx4 v[176:179], v7, s[4:7], s60 offen offset:3072 sc1
v_mfma_f32_16x16x32_bf16 v[28:31], a[152:155], v[132:135], v[28:31]
ds_read_b64_tr_b16 a[52:53], v253 offset:24704
v_and_b32 v79, 0xffff0000, v85
v_mfma_f32_16x16x32_bf16 v[32:35], a[156:159], v[132:135], v[32:35]
ds_read_b64_tr_b16 a[54:55], v253 offset:25472
s_waitcnt vmcnt(8)
v_mfma_f32_16x16x32_bf16 v[36:39], a[160:163], v[132:135], v[36:39]
ds_read_b64_tr_b16 a[56:57], v254 offset:24704
v_max3_u32 v92, v140, v141, v142
v_mfma_f32_16x16x32_bf16 v[40:43], a[164:167], v[132:135], v[40:43]
ds_read_b64_tr_b16 a[58:59], v254 offset:25472
v_max3_u32 v93, v143, v144, v145
v_mfma_f32_16x16x32_bf16 v[20:23], a[0:3], v[136:139], v[20:23]
ds_read_b64_tr_b16 a[60:61], v253 offset:30720
v_max3_u32 v92, v92, v146, v147
v_mfma_f32_16x16x32_bf16 v[24:27], a[4:7], v[136:139], v[24:27]
ds_read_b64_tr_b16 a[62:63], v253 offset:31488
v_max_u32 v92, v92, v93
v_mfma_f32_16x16x32_bf16 v[28:31], a[8:11], v[136:139], v[28:31]
ds_read_b64_tr_b16 a[64:65], v254 offset:30720
v_lshlrev_b32 v80, 16, v86
v_mfma_f32_16x16x32_bf16 v[32:35], a[12:15], v[136:139], v[32:35]
ds_read_b64_tr_b16 a[66:67], v254 offset:31488
v_cmp_eq_u32 vcc, -1, v92
v_mfma_f32_16x16x32_bf16 v[36:39], a[16:19], v[136:139], v[36:39]
ds_read_b64_tr_b16 a[68:69], v253 offset:30784
v_and_b32 v81, 0xffff0000, v86
v_mfma_f32_16x16x32_bf16 v[40:43], a[20:23], v[136:139], v[40:43]
ds_read_b64_tr_b16 a[70:71], v253 offset:31552
s_cbranch_vccnz L_o5_retry
L_o5_ok:
v_mfma_f32_16x16x32_bf16 v[20:23], a[24:27], v[140:143], v[20:23]
ds_read_b64_tr_b16 a[72:73], v254 offset:30784
v_lshlrev_b32 v82, 16, v87
v_mfma_f32_16x16x32_bf16 v[24:27], a[28:31], v[140:143], v[24:27]
ds_read_b64_tr_b16 a[74:75], v254 offset:31552
v_and_b32 v83, 0xffff0000, v87
v_mfma_f32_16x16x32_bf16 v[28:31], a[32:35], v[140:143], v[28:31]
ds_read_b64_tr_b16 a[76:77], v253 offset:30848
s_waitcnt lgkmcnt(15)
v_mfma_f32_16x16x32_bf16 v[32:35], a[168:171], v[140:143], v[32:35]
ds_read_b64_tr_b16 a[78:79], v253 offset:31616
s_waitcnt vmcnt(6)
v_mfma_f32_16x16x32_bf16 v[36:39], a[172:175], v[140:143], v[36:39]
ds_read_b64_tr_b16 a[80:81], v254 offset:30848
v_max3_u32 v92, v148, v149, v150
v_mfma_f32_16x16x32_bf16 v[40:43], a[176:179], v[140:143], v[40:43]
ds_read_b64_tr_b16 a[82:83], v254 offset:31616
v_max3_u32 v93, v151, v152, v153
v_mfma_f32_16x16x32_bf16 v[20:23], a[180:183], v[144:147], v[20:23]
ds_read_b64_tr_b16 a[84:85], v253 offset:36864
v_max3_u32 v92, v92, v154, v155
v_mfma_f32_16x16x32_bf16 v[24:27], a[184:187], v[144:147], v[24:27]
ds_read_b64_tr_b16 a[86:87], v253 offset:37632
v_max_u32 v92, v92, v93
v_mfma_f32_16x16x32_bf16 v[28:31], a[188:191], v[144:147], v[28:31]
ds_read_b64_tr_b16 a[88:89], v254 offset:36864
v_mfma_f32_16x16x32_bf16 v[32:35], a[192:195], v[144:147], v[32:35]
ds_read_b64_tr_b16 a[90:91], v254 offset:37632
v_cmp_eq_u32 vcc, -1, v92
v_mfma_f32_16x16x32_bf16 v[36:39], a[196:199], v[144:147], v[36:39]
ds_read_b64_tr_b16 a[92:93], v253 offset:36928
v_lshlrev_b32 v84, 16, v88
v_mfma_f32_16x16x32_bf16 v[40:43], a[200:203], v[144:147], v[40:43]
ds_read_b64_tr_b16 a[94:95], v253 offset:37696
s_cbranch_vccnz L_o6_retry
L_o6_ok:
v_mfma_f32_16x16x32_bf16 v[20:23], a[204:207], v[148:151], v[20:23]
ds_read_b64_tr_b16 a[96:97], v254 offset:36928
v_and_b32 v85, 0xffff0000, v88
v_mfma_f32_16x16x32_bf16 v[24:27], a[208:211], v[148:151], v[24:27]
ds_read_b64_tr_b16 a[98:99], v254 offset:37696
v_lshlrev_b32 v86, 16, v89
v_mfma_f32_16x16x32_bf16 v[28:31], a[212:215], v[148:151], v[28:31]
ds_read_b64_tr_b16 a[100:101], v253 offset:36992
v_mfma_f32_16x16x32_bf16 v[32:35], a[216:219], v[148:151], v[32:35]
ds_read_b64_tr_b16 a[102:103], v253 offset:37760
s_waitcnt vmcnt(4)
v_mfma_f32_16x16x32_bf16 v[36:39], a[220:223], v[148:151], v[36:39]
ds_read_b64_tr_b16 a[104:105], v254 offset:36992
v_max3_u32 v92, v156, v157, v158
v_mfma_f32_16x16x32_bf16 v[40:43], a[224:227], v[148:151], v[40:43]
ds_read_b64_tr_b16 a[106:107], v254 offset:37760
v_max3_u32 v93, v159, v160, v161
v_mfma_f32_16x16x32_bf16 v[20:23], a[228:231], v[152:155], v[20:23]
ds_read_b64_tr_b16 a[108:109], v253 offset:43008
v_max3_u32 v92, v92, v162, v163
v_mfma_f32_16x16x32_bf16 v[24:27], a[232:235], v[152:155], v[24:27]
ds_read_b64_tr_b16 a[110:111], v253 offset:43776
v_max_u32 v92, v92, v93
v_mfma_f32_16x16x32_bf16 v[28:31], a[236:239], v[152:155], v[28:31]
ds_read_b64_tr_b16 a[112:113], v254 offset:43008
v_mfma_f32_16x16x32_bf16 v[32:35], a[240:243], v[152:155], v[32:35]
ds_read_b64_tr_b16 a[114:115], v254 offset:43776
v_cmp_eq_u32 vcc, -1, v92
v_mfma_f32_16x16x32_bf16 v[36:39], a[244:247], v[152:155], v[36:39]
ds_read_b64_tr_b16 a[116:117], v253 offset:43072
v_and_b32 v87, 0xffff0000, v89
v_mfma_f32_16x16x32_bf16 v[40:43], a[248:251], v[152:155], v[40:43]
ds_read_b64_tr_b16 a[118:119], v253 offset:43840
s_cbranch_vccnz L_o7_retry
L_o7_ok:
v_mfma_f32_16x16x32_bf16 v[20:23], a[252:255], v[156:159], v[20:23]
ds_read_b64_tr_b16 a[120:121], v254 offset:43072
v_lshlrev_b32 v88, 16, v90
v_mfma_f32_16x16x32_bf16 v[24:27], a[40:43], v[156:159], v[24:27]
ds_read_b64_tr_b16 a[122:123], v254 offset:43840
v_and_b32 v89, 0xffff0000, v90
v_mfma_f32_16x16x32_bf16 v[28:31], a[44:47], v[156:159], v[28:31]
ds_read_b64_tr_b16 a[124:125], v253 offset:43136
s_waitcnt lgkmcnt(15)
v_mfma_f32_16x16x32_bf16 v[32:35], a[48:51], v[156:159], v[32:35]
ds_read_b64_tr_b16 a[126:127], v253 offset:43904
s_waitcnt vmcnt(2)
v_mfma_f32_16x16x32_bf16 v[36:39], a[52:55], v[156:159], v[36:39]
ds_read_b64_tr_b16 a[128:129], v254 offset:43136
v_max3_u32 v92, v164, v165, v166
v_mfma_f32_16x16x32_bf16 v[40:43], a[56:59], v[156:159], v[40:43]
ds_read_b64_tr_b16 a[130:131], v254 offset:43904
v_max3_u32 v93, v167, v168, v169
v_mfma_f32_16x16x32_bf16 v[20:23], a[60:63], v[160:163], v[20:23]
ds_read_b64_tr_b16 a[132:133], v253 offset:49152
v_max3_u32 v92, v92, v170, v171
v_mfma_f32_16x16x32_bf16 v[24:27], a[64:67], v[160:163], v[24:27]
ds_read_b64_tr_b16 a[134:135], v253 offset:49920
v_max_u32 v92, v92, v93
v_mfma_f32_16x16x32_bf16 v[28:31], a[68:71], v[160:163], v[28:31]
ds_read_b64_tr_b16 a[136:137], v254 offset:49152
v_mfma_f32_16x16x32_bf16 v[32:35], a[72:75], v[160:163], v[32:35]
ds_read_b64_tr_b16 a[138:139], v254 offset:49920
v_cmp_eq_u32 vcc, -1, v92
v_mfma_f32_16x16x32_bf16 v[36:39], a[76:79], v[160:163], v[36:39]
ds_read_b64_tr_b16 a[140:141], v253 offset:49216
v_lshlrev_b32 v90, 16, v91
v_mfma_f32_16x16x32_bf16 v[40:43], a[80:83], v[160:163], v[40:43]
ds_read_b64_tr_b16 a[142:143], v253 offset:49984
s_cbranch_vccnz L_o8_retry
L_o8_ok:
v_mfma_f32_16x16x32_bf16 v[20:23], a[84:87], v[164:167], v[20:23]
ds_read_b64_tr_b16 a[144:145], v254 offset:49216
v_and_b32 v91, 0xffff0000, v91
v_mfma_f32_16x16x32_bf16 v[24:27], a[88:91], v[164:167], v[24:27]
ds_read_b64_tr_b16 a[146:147], v254 offset:49984
v_mfma_f32_16x16x32_bf16 v[28:31], a[92:95], v[164:167], v[28:31]
ds_read_b64_tr_b16 a[148:149], v253 offset:49280
s_waitcnt lgkmcnt(15)
v_mfma_f32_16x16x32_bf16 v[32:35], a[96:99], v[164:167], v[32:35]
ds_read_b64_tr_b16 a[150:151], v253 offset:50048
s_waitcnt vmcnt(0)
v_mfma_f32_16x16x32_bf16 v[36:39], a[100:103], v[164:167], v[36:39]
ds_read_b64_tr_b16 a[152:153], v254 offset:49280
v_max3_u32 v92, v172, v173, v174
v_mfma_f32_16x16x32_bf16 v[40:43], a[104:107], v[164:167], v[40:43]
ds_read_b64_tr_b16 a[154:155], v254 offset:50048
v_max3_u32 v93, v175, v176, v177
v_mfma_f32_16x16x32_bf16 v[20:23], a[108:111], v[168:171], v[20:23]
ds_read_b64_tr_b16 a[156:157], v253 offset:55296
v_max3_u32 v92, v92, v178, v179
v_mfma_f32_16x16x32_bf16 v[24:27], a[112:115], v[168:171], v[24:27]
ds_read_b64_tr_b16 a[158:159], v253 offset:56064
v_max_u32 v92, v92, v93
v_mfma_f32_16x16x32_bf16 v[28:31], a[116:119], v[168:171], v[28:31]
ds_read_b64_tr_b16 a[160:161], v254 offset:55296
s_waitcnt lgkmcnt(9)
v_mfma_f32_16x16x32_bf16 v[32:35], a[120:123], v[168:171], v[32:35]
ds_read_b64_tr_b16 a[162:163], v254 offset:56064
v_cmp_eq_u32 vcc, -1, v92
v_mfma_f32_16x16x32_bf16 v[36:39], a[124:127], v[168:171], v[36:39]
ds_read_b64_tr_b16 a[164:165], v253 offset:55360
v_mfma_f32_16x16x32_bf16 v[40:43], a[128:131], v[168:171], v[40:43]
ds_read_b64_tr_b16 a[166:167], v253 offset:56128
s_cbranch_vccnz L_o9_retry
L_o9_ok:
v_mfma_f32_16x16x32_bf16 v[20:23], a[132:135], v[172:175], v[20:23]
ds_read_b64_tr_b16 a[0:1], v254 offset:55360
v_mfma_f32_16x16x32_bf16 v[24:27], a[136:139], v[172:175], v[24:27]
ds_read_b64_tr_b16 a[2:3], v254 offset:56128
v_mfma_f32_16x16x32_bf16 v[28:31], a[140:143], v[172:175], v[28:31]
ds_read_b64_tr_b16 a[4:5], v253 offset:55424
s_waitcnt lgkmcnt(9)
v_mfma_f32_16x16x32_bf16 v[32:35], a[144:147], v[172:175], v[32:35]
ds_read_b64_tr_b16 a[6:7], v253 offset:56192
v_mfma_f32_16x16x32_bf16 v[36:39], a[148:151], v[172:175], v[36:39]
ds_read_b64_tr_b16 a[8:9], v254 offset:55424
v_mfma_f32_16x16x32_bf16 v[40:43], a[152:155], v[172:175], v[40:43]
ds_read_b64_tr_b16 a[10:11], v254 offset:56192
s_waitcnt lgkmcnt(6)
v_mfma_f32_16x16x32_bf16 v[20:23], a[156:159], v[176:179], v[20:23]
ds_read_b128 v[180:183], v247 offset:0
v_mfma_f32_16x16x32_bf16 v[24:27], a[160:163], v[176:179], v[24:27]
ds_read_b128 v[184:187], v247 offset:64
v_mfma_f32_16x16x32_bf16 v[28:31], a[164:167], v[176:179], v[28:31]
ds_read_b128 v[188:191], v247 offset:128
s_waitcnt lgkmcnt(3)
v_mfma_f32_16x16x32_bf16 v[32:35], a[0:3], v[176:179], v[32:35]
ds_read_b128 v[192:195], v247 offset:192
v_mfma_f32_16x16x32_bf16 v[36:39], a[4:7], v[176:179], v[36:39]
ds_read_b128 v[196:199], v247 offset:256
v_mfma_f32_16x16x32_bf16 v[40:43], a[8:11], v[176:179], v[40:43]
ds_read_b128 v[200:203], v247 offset:320
s_lshl_b32 s57, s96, 8
s_add_u32 s57, s57, s14
s_mov_b32 s55, 0xffffff00
s_cmp_eq_u32 s15, 0
s_waitcnt lgkmcnt(4)
v_pk_fma_f32 v[20:21], v[20:21], v[180:181], v[68:69]
v_pk_fma_f32 v[22:23], v[22:23], v[182:183], v[70:71]
v_pk_mul_f32 v[46:47], v[20:21], v[20:21]
v_pk_mul_f32 v[48:49], v[20:21], v[204:205]
v_pk_fma_f32 v[24:25], v[24:25], v[184:185], v[72:73]
v_pk_add_f32 v[44:45], v[20:21], v[22:23]
v_pk_fma_f32 v[46:47], v[22:23], v[22:23], v[46:47]
v_pk_fma_f32 v[48:49], v[22:23], v[206:207], v[48:49]
v_pk_fma_f32 v[26:27], v[26:27], v[186:187], v[74:75]
v_pk_add_f32 v[44:45], v[44:45], v[24:25]
v_pk_fma_f32 v[46:47], v[24:25], v[24:25], v[46:47]
v_pk_fma_f32 v[48:49], v[24:25], v[208:209], v[48:49]
s_waitcnt lgkmcnt(2)
v_pk_fma_f32 v[28:29], v[28:29], v[188:189], v[76:77]
v_pk_add_f32 v[44:45], v[44:45], v[26:27]
v_pk_fma_f32 v[46:47], v[26:27], v[26:27], v[46:47]
v_pk_fma_f32 v[48:49], v[26:27], v[210:211], v[48:49]
v_pk_fma_f32 v[30:31], v[30:31], v[190:191], v[78:79]
v_pk_add_f32 v[44:45], v[44:45], v[28:29]
v_pk_fma_f32 v[46:47], v[28:29], v[28:29], v[46:47]
v_pk_fma_f32 v[48:49], v[28:29], v[212:213], v[48:49]
v_pk_fma_f32 v[32:33], v[32:33], v[192:193], v[80:81]
v_pk_add_f32 v[44:45], v[44:45], v[30:31]
v_pk_fma_f32 v[46:47], v[30:31], v[30:31], v[46:47]
v_pk_fma_f32 v[48:49], v[30:31], v[214:215], v[48:49]
v_pk_fma_f32 v[34:35], v[34:35], v[194:195], v[82:83]
v_pk_add_f32 v[44:45], v[44:45], v[32:33]
v_pk_fma_f32 v[46:47], v[32:33], v[32:33], v[46:47]
v_pk_fma_f32 v[48:49], v[32:33], v[216:217], v[48:49]
s_waitcnt lgkmcnt(0)
v_pk_fma_f32 v[36:37], v[36:37], v[196:197], v[84:85]
v_pk_add_f32 v[44:45], v[44:45], v[34:35]
v_pk_fma_f32 v[46:47], v[34:35], v[34:35], v[46:47]
v_pk_fma_f32 v[48:49], v[34:35], v[218:219], v[48:49]
v_pk_fma_f32 v[38:39], v[38:39], v[198:199], v[86:87]
v_pk_add_f32 v[44:45], v[44:45], v[36:37]
v_pk_fma_f32 v[46:47], v[36:37], v[36:37], v[46:47]
v_pk_fma_f32 v[48:49], v[36:37], v[220:221], v[48:49]
v_pk_fma_f32 v[40:41], v[40:41], v[200:201], v[88:89]
v_pk_add_f32 v[44:45], v[44:45], v[38:39]
v_pk_fma_f32 v[46:47], v[38:39], v[38:39], v[46:47]
v_pk_fma_f32 v[48:49], v[38:39], v[222:223], v[48:49]
v_pk_fma_f32 v[42:43], v[42:43], v[202:203], v[90:91]
v_pk_add_f32 v[44:45], v[44:45], v[40:41]
v_pk_fma_f32 v[46:47], v[40:41], v[40:41], v[46:47]
v_pk_fma_f32 v[48:49], v[40:41], v[224:225], v[48:49]
v_pk_fma_f32 v[48:49], v[42:43], v[226:227], v[48:49]
v_pk_add_f32 v[44:45], v[44:45], v[42:43]
v_pk_fma_f32 v[46:47], v[42:43], v[42:43], v[46:47]
v_add_f32 v48, v48, v49
v_add_f32 v44, v44, v45
v_add_f32 v46, v46, v47
v_permlane32_swap_b32 v48, v95
s_nop 0
v_permlane32_swap_b32 v44, v46
v_add_f32 v48, v48, v95
v_add_f32 v44, v44, v46
s_nop 1
v_permlane16_swap_b32 v44, v48
v_add_f32 v44, v44, v48
v_and_or_b32 v44, v44, s55, v19
s_cbranch_scc0 L_st_slow
buffer_store_dword v44, v0, s[4:7], s57 offen
L_st_j:
ds_read_b128 v[100:103], v247 offset:768
ds_read_b128 v[104:107], v247 offset:832
ds_read_b128 v[108:111], v247 offset:896
ds_read_b128 v[112:115], v247 offset:960
ds_read_b128 v[116:119], v247 offset:1024
ds_read_b128 v[120:123], v247 offset:1088
ds_read_b128 v[124:127], v247 offset:384
ds_read_b128 v[128:131], v247 offset:448
ds_read_b128 v[132:135], v247 offset:512
ds_read_b128 v[136:139], v247 offset:576
ds_read_b128 v[140:143], v247 offset:640
ds_read_b128 v[144:147], v247 offset:704
ds_read_b128 v[148:151], v247 offset:1152
ds_read_b128 v[152:155], v247 offset:1216
ds_read_b128 v[156:159], v247 offset:1280
ds_read_b128 v[160:163], v247 offset:1344
ds_read_b128 v[164:167], v247 offset:1408
ds_read_b128 v[168:171], v247 offset:1472
s_lshl_b32 s57, s3, 2
s_add_u32 s57, s57, 135168
v_mov_b32 v54, s57
v_and_b32 v55, 12, v0
v_add_u32 v55, 135168, v55
v_lshrrev_b32 v65, 3, v1
v_mul_u32_u24 v65, 384, v65
v_lshrrev_b32 v66, 5, v1
v_mul_u32_u24 v66, 6144, v66
v_add3_u32 v65, v65, v66, v7
L_st_p:
buffer_load_dword v180, v0, s[4:7], s14 offen offset:0 sc1
buffer_load_dword v181, v0, s[4:7], s14 offen offset:256 sc1
buffer_load_dword v182, v0, s[4:7], s14 offen offset:512 sc1
buffer_load_dword v183, v0, s[4:7], s14 offen offset:768 sc1
buffer_load_dword v184, v0, s[4:7], s14 offen offset:1024 sc1
buffer_load_dword v185, v0, s[4:7], s14 offen offset:1280 sc1
buffer_load_dword v186, v0, s[4:7], s14 offen offset:1536 sc1
s_waitcnt vmcnt(0)
v_xor_b32 v44, v180, v19
v_xor_b32 v45, v181, v19
v_xor_b32 v46, v182, v19
v_xor_b32 v47, v183, v19
v_xor_b32 v48, v184, v19
v_xor_b32 v49, v185, v19
v_xor_b32 v50, v186, v19
v_or3_b32 v52, v44, v45, v46
v_or3_b32 v53, v47, v48, v49
v_or3_b32 v52, v52, v53, v50
v_and_b32 v52, 0xff, v52
v_cmp_ne_u32 vcc, 0, v52
s_cbranch_vccz L_st_ok
s_add_u32 s97, s97, 1
s_cmp_le_u32 s97, 65536
s_cbranch_scc1 L_st_p
L_st_ok:
v_pk_add_f32 v[44:45], v[44:45], v[46:47]
v_add_f32 v48, v48, v50
v_pk_add_f32 v[44:45], v[44:45], v[48:49]
v_add_f32 v46, v44, v45
v_add_f32 v44, v44, v45
s_nop 1
v_permlane32_swap_b32 v44, v46
v_mov_b32 v45, v44
v_mov_b32 v47, v46
s_nop 0
v_permlane16_swap_b32 v44, v45
v_permlane16_swap_b32 v46, v47
v_mul_f32 v44, 0x3acccccd, v44
v_mul_f32 v46, 0x3acccccd, v46
v_fma_f32 v46, -v44, v44, v46
v_fma_f32 v45, -v44, v47, v45
v_max_f32 v46, 0, v46
v_add_f32 v46, 0x3727c5ac, v46
v_rsq_f32 v48, v46
s_nop 0
v_mul_f32 v45, v45, v48
v_mul_f32 v49, -v44, v48
v_pk_fma_f32 v[68:69], v[20:21], v[48:49], v[48:49] op_sel:[0,0,1] op_sel_hi:[1,0,1]
v_max_f32_dpp v46, v45, v45 row_ror:8 row_mask:0xf bank_mask:0xf
v_pk_fma_f32 v[70:71], v[22:23], v[48:49], v[48:49] op_sel:[0,0,1] op_sel_hi:[1,0,1]
v_pk_fma_f32 v[72:73], v[24:25], v[48:49], v[48:49] op_sel:[0,0,1] op_sel_hi:[1,0,1]
v_max_f32_dpp v46, v46, v46 row_ror:4 row_mask:0xf bank_mask:0xf
v_pk_fma_f32 v[74:75], v[26:27], v[48:49], v[48:49] op_sel:[0,0,1] op_sel_hi:[1,0,1]
v_pk_fma_f32 v[76:77], v[28:29], v[48:49], v[48:49] op_sel:[0,0,1] op_sel_hi:[1,0,1]
v_max_f32_dpp v46, v46, v46 row_ror:2 row_mask:0xf bank_mask:0xf
v_pk_fma_f32 v[78:79], v[30:31], v[48:49], v[48:49] op_sel:[0,0,1] op_sel_hi:[1,0,1]
v_pk_fma_f32 v[80:81], v[32:33], v[48:49], v[48:49] op_sel:[0,0,1] op_sel_hi:[1,0,1]
v_max_f32_dpp v46, v46, v46 row_ror:1 row_mask:0xf bank_mask:0xf
ds_write_b32 v54, v46
v_pk_fma_f32 v[82:83], v[34:35], v[48:49], v[48:49] op_sel:[0,0,1] op_sel_hi:[1,0,1]
v_pk_fma_f32 v[84:85], v[36:37], v[48:49], v[48:49] op_sel:[0,0,1] op_sel_hi:[1,0,1]
v_pk_fma_f32 v[86:87], v[38:39], v[48:49], v[48:49] op_sel:[0,0,1] op_sel_hi:[1,0,1]
v_pk_fma_f32 v[88:89], v[40:41], v[48:49], v[48:49] op_sel:[0,0,1] op_sel_hi:[1,0,1]
v_pk_fma_f32 v[90:91], v[42:43], v[48:49], v[48:49] op_sel:[0,0,1] op_sel_hi:[1,0,1]
s_waitcnt lgkmcnt(0)
s_barrier
ds_read_b32 v52, v55
v_pk_fma_f32 v[68:69], v[68:69], v[100:101], v[124:125]
v_pk_fma_f32 v[70:71], v[70:71], v[102:103], v[126:127]
v_pk_fma_f32 v[72:73], v[72:73], v[104:105], v[128:129]
v_pk_fma_f32 v[74:75], v[74:75], v[106:107], v[130:131]
v_pk_fma_f32 v[76:77], v[76:77], v[108:109], v[132:133]
v_pk_fma_f32 v[78:79], v[78:79], v[110:111], v[134:135]
v_pk_fma_f32 v[80:81], v[80:81], v[112:113], v[136:137]
v_pk_fma_f32 v[82:83], v[82:83], v[114:115], v[138:139]
v_pk_fma_f32 v[84:85], v[84:85], v[116:117], v[140:141]
v_pk_fma_f32 v[86:87], v[86:87], v[118:119], v[142:143]
v_pk_fma_f32 v[88:89], v[88:89], v[120:121], v[144:145]
v_pk_fma_f32 v[90:91], v[90:91], v[122:123], v[146:147]
s_waitcnt lgkmcnt(0)
v_max_f32_dpp v53, v52, v52 quad_perm:[1,0,3,2] row_mask:0xf bank_mask:0xf
s_nop 1
v_max_f32_dpp v53, v53, v53 quad_perm:[2,3,0,1] row_mask:0xf bank_mask:0xf
v_cmp_eq_f32 vcc, v53, v52
v_cmp_eq_f32 s[58:59], v53, v45
s_ff1_i32_b64 s57, vcc
s_and_b32 s57, s57, 3
s_cmp_eq_u32 s57, s3
s_cbranch_scc0 L_nowin
s_ff1_i32_b64 s57, s[58:59]
s_and_b32 s57, s57, 15
s_cmp_eq_u32 s96, 0
s_cbranch_scc0 L_nocand
s_lshl_b32 s58, s57, 1
s_add_u32 s58, s58, s54
v_mov_b32 v56, v53
v_mov_b32 v57, s58
v_mov_b32 v58, s40
v_mov_b32 v59, s53
s_mul_i32 s58, s47, 2048
s_andn2_b32 s59, s58, 8191
s_add_u32 s58, s58, s59
s_add_u32 s58, s58, 7602176
buffer_store_dwordx4 v[56:59], v65, s[4:7], s58 offen sc1
L_nocand:
s_mov_b32 s58, 0x00010001
s_lshl_b32 exec_lo, s58, s57
s_lshl_b32 exec_hi, s58, s57
s_lshl_b32 s58, s47, 11
s_lshl_b32 s59, s96, 8
s_add_u32 s58, s58, s59
s_lshl_b32 s59, s58, 1
s_andn2_b32 s60, s58, 8191
s_add_u32 s58, s58, s60
s_add_u32 s58, s58, 7733248
s_add_u32 s56, s58, 8192
s_add_u32 s59, s59, 524288
v_lshlrev_b32 v54, 3, v3
v_lshlrev_b32 v55, 4, v3
v_cvt_pk_bf16_f32 v172, v68, v69
v_cvt_pk_bf16_f32 v173, v70, v71
buffer_store_dwordx2 v[172:173], v54, s[4:7], s58 offen offset:0 sc1
buffer_store_dwordx2 v[172:173], v54, s[4:7], s56 offen offset:0 sc1
v_cvt_pk_bf16_f32 v174, v72, v73
v_cvt_pk_bf16_f32 v175, v74, v75
buffer_store_dwordx2 v[174:175], v54, s[4:7], s58 offen offset:32 sc1
buffer_store_dwordx2 v[174:175], v54, s[4:7], s56 offen offset:32 sc1
v_cvt_pk_bf16_f32 v176, v76, v77
v_cvt_pk_bf16_f32 v177, v78, v79
buffer_store_dwordx2 v[176:177], v54, s[4:7], s58 offen offset:64 sc1
buffer_store_dwordx2 v[176:177], v54, s[4:7], s56 offen offset:64 sc1
v_cvt_pk_bf16_f32 v178, v80, v81
v_cvt_pk_bf16_f32 v179, v82, v83
buffer_store_dwordx2 v[178:179], v54, s[4:7], s58 offen offset:96 sc1
buffer_store_dwordx2 v[178:179], v54, s[4:7], s56 offen offset:96 sc1
v_cvt_pk_bf16_f32 v172, v84, v85
v_cvt_pk_bf16_f32 v173, v86, v87
buffer_store_dwordx2 v[172:173], v54, s[4:7], s58 offen offset:128 sc1
buffer_store_dwordx2 v[172:173], v54, s[4:7], s56 offen offset:128 sc1
v_cvt_pk_bf16_f32 v174, v88, v89
v_cvt_pk_bf16_f32 v175, v90, v91
buffer_store_dwordx2 v[174:175], v54, s[4:7], s58 offen offset:160 sc1
buffer_store_dwordx2 v[174:175], v54, s[4:7], s56 offen offset:160 sc1
s_and_b32 s60, s40, 0xff
s_bfe_u32 s61, s40, 0x80008
s_bfe_u32 s62, s40, 0x80010
s_lshr_b32 s63, s40, 24
v_mov_b32 v60, s55
v_pk_fma_f32 v[100:101], v[68:69], v[148:149], v[20:21]
v_pk_fma_f32 v[102:103], v[70:71], v[150:151], v[22:23]
v_and_or_b32 v100, v100, v60, s60
v_and_or_b32 v101, v101, v60, s61
v_and_or_b32 v102, v102, v60, s62
v_and_or_b32 v103, v103, v60, s63
buffer_store_dwordx4 v[100:103], v55, s[4:7], s59 offen offset:0 sc1
v_pk_fma_f32 v[104:105], v[72:73], v[152:153], v[24:25]
v_pk_fma_f32 v[106:107], v[74:75], v[154:155], v[26:27]
v_and_or_b32 v104, v104, v60, s60
v_and_or_b32 v105, v105, v60, s61
v_and_or_b32 v106, v106, v60, s62
v_and_or_b32 v107, v107, v60, s63
buffer_store_dwordx4 v[104:107], v55, s[4:7], s59 offen offset:64 sc1
v_pk_fma_f32 v[108:109], v[76:77], v[156:157], v[28:29]
v_pk_fma_f32 v[110:111], v[78:79], v[158:159], v[30:31]
v_and_or_b32 v108, v108, v60, s60
v_and_or_b32 v109, v109, v60, s61
v_and_or_b32 v110, v110, v60, s62
v_and_or_b32 v111, v111, v60, s63
buffer_store_dwordx4 v[108:111], v55, s[4:7], s59 offen offset:128 sc1
v_pk_fma_f32 v[112:113], v[80:81], v[160:161], v[32:33]
v_pk_fma_f32 v[114:115], v[82:83], v[162:163], v[34:35]
v_and_or_b32 v112, v112, v60, s60
v_and_or_b32 v113, v113, v60, s61
v_and_or_b32 v114, v114, v60, s62
v_and_or_b32 v115, v115, v60, s63
buffer_store_dwordx4 v[112:115], v55, s[4:7], s59 offen offset:192 sc1
v_pk_fma_f32 v[116:117], v[84:85], v[164:165], v[36:37]
v_pk_fma_f32 v[118:119], v[86:87], v[166:167], v[38:39]
v_and_or_b32 v116, v116, v60, s60
v_and_or_b32 v117, v117, v60, s61
v_and_or_b32 v118, v118, v60, s62
v_and_or_b32 v119, v119, v60, s63
buffer_store_dwordx4 v[116:119], v55, s[4:7], s59 offen offset:256 sc1
v_pk_fma_f32 v[120:121], v[88:89], v[168:169], v[40:41]
v_pk_fma_f32 v[122:123], v[90:91], v[170:171], v[42:43]
v_and_or_b32 v120, v120, v60, s60
v_and_or_b32 v121, v121, v60, s61
v_and_or_b32 v122, v122, v60, s62
v_and_or_b32 v123, v123, v60, s63
buffer_store_dwordx4 v[120:123], v55, s[4:7], s59 offen offset:320 sc1
s_mov_b64 exec, -1
s_mul_i32 s57, s57, 12
v_subrev_u32 v56, s57, v1
v_add_u32 v56, 0, v56
v_cmp_gt_u32 vcc, 12, v56
s_nop 1
v_cndmask_b32 v235, v235, v255, vcc
v_subrev_u32 v56, s57, v1
v_add_u32 v56, 64, v56
v_cmp_gt_u32 vcc, 12, v56
s_nop 1
v_cndmask_b32 v236, v236, v255, vcc
v_subrev_u32 v56, s57, v1
v_add_u32 v56, 128, v56
v_cmp_gt_u32 vcc, 12, v56
s_nop 1
v_cndmask_b32 v237, v237, v255, vcc
L_nowin:
v_pk_fma_f32 v[20:21], v[68:69], v[148:149], v[20:21]
v_pk_fma_f32 v[22:23], v[70:71], v[150:151], v[22:23]
v_cvt_pk_bf16_f32 v20, v20, v21
v_cvt_pk_bf16_f32 v21, v22, v23
ds_write_b64 v248, v[20:21] offset:0
v_pk_fma_f32 v[24:25], v[72:73], v[152:153], v[24:25]
v_pk_fma_f32 v[26:27], v[74:75], v[154:155], v[26:27]
v_cvt_pk_bf16_f32 v24, v24, v25
v_cvt_pk_bf16_f32 v25, v26, v27
ds_write_b64 v248, v[24:25] offset:32
v_pk_fma_f32 v[28:29], v[76:77], v[156:157], v[28:29]
v_pk_fma_f32 v[30:31], v[78:79], v[158:159], v[30:31]
v_cvt_pk_bf16_f32 v28, v28, v29
v_cvt_pk_bf16_f32 v29, v30, v31
ds_write_b64 v248, v[28:29] offset:64
v_pk_fma_f32 v[32:33], v[80:81], v[160:161], v[32:33]
v_pk_fma_f32 v[34:35], v[82:83], v[162:163], v[34:35]
v_cvt_pk_bf16_f32 v32, v32, v33
v_cvt_pk_bf16_f32 v33, v34, v35
ds_write_b64 v248, v[32:33] offset:96
v_pk_fma_f32 v[36:37], v[84:85], v[164:165], v[36:37]
v_pk_fma_f32 v[38:39], v[86:87], v[166:167], v[38:39]
v_cvt_pk_bf16_f32 v36, v36, v37
v_cvt_pk_bf16_f32 v37, v38, v39
ds_write_b64 v248, v[36:37] offset:128
v_pk_fma_f32 v[40:41], v[88:89], v[168:169], v[40:41]
v_pk_fma_f32 v[42:43], v[90:91], v[170:171], v[42:43]
v_cvt_pk_bf16_f32 v40, v40, v41
v_cvt_pk_bf16_f32 v41, v42, v43
ds_write_b64 v248, v[40:41] offset:160
s_waitcnt lgkmcnt(0)
ds_read_b128 v[44:47], v250 offset:0
ds_read_b128 v[48:51], v250 offset:1024
ds_read_b128 v[52:55], v250 offset:2048
s_waitcnt lgkmcnt(2)
buffer_store_dwordx4 v[44:47], v235, s[32:35], s50 offen offset:0 sc1
s_waitcnt lgkmcnt(1)
buffer_store_dwordx4 v[48:51], v236, s[32:35], s50 offen offset:1024 sc1
s_waitcnt lgkmcnt(0)
buffer_store_dwordx4 v[52:55], v237, s[32:35], s50 offen offset:2048 sc1
s_branch L_fin
L_bodyM:
v_bfe_u32 v32, v1, 2, 2
v_lshrrev_b32 v33, 1, v32
v_and_b32 v34, 1, v3
v_lshl_or_b32 v33, v34, 1, v33
v_xor_b32 v33, s3, v33
v_and_b32 v34, 3, v1
v_lshlrev_b32 v34, 3, v34
v_lshl_add_u32 v33, v33, 5, v34
v_lshl_add_u32 v32, v3, 3, v32
v_lshl_add_u32 v35, v32, 7, v33
s_lshl_b32 s22, s50, 8
s_lshl_b32 s23, s3, 6
s_add_u32 s22, s22, s23
s_add_u32 s22, s22, 4096
s_lshl_b32 s55, s3, 9
s_add_u32 s55, s55, 28672
v_add_u32 v39, s55, v39
v_lshl_add_u32 v37, v3, 4, s55
v_lshlrev_b32 v38, 2, v1
s_cmp_lt_u32 s98, 220
s_cselect_b32 s55, 16, 0
v_cmp_gt_u32 vcc, s55, v1
s_mov_b32 s54, 0xffffff00
s_waitcnt vmcnt(12)
v_cndmask_b32 v38, v255, v38, vcc
v_lshlrev_b32 v44, 16, v40
v_and_b32 v45, 0xffff0000, v40
v_lshlrev_b32 v46, 16, v41
v_and_b32 v47, 0xffff0000, v41
v_mul_f32 v48, 0xbfb8aa3b, v44
v_mul_f32 v49, 0xbfb8aa3b, v45
v_mul_f32 v50, 0xbfb8aa3b, v46
v_mul_f32 v51, 0xbfb8aa3b, v47
v_exp_f32 v48, v48
v_exp_f32 v49, v49
v_exp_f32 v50, v50
v_exp_f32 v51, v51
v_add_f32 v48, 1.0, v48
v_add_f32 v49, 1.0, v49
v_add_f32 v50, 1.0, v50
v_add_f32 v51, 1.0, v51
v_rcp_f32 v48, v48
v_rcp_f32 v49, v49
v_rcp_f32 v50, v50
v_rcp_f32 v51, v51
v_mul_f32 v44, v44, v48
v_mul_f32 v45, v45, v49
v_mul_f32 v46, v46, v50
v_mul_f32 v47, v47, v51
v_cvt_pk_bf16_f32 v40, v44, v45
v_cvt_pk_bf16_f32 v41, v46, v47
ds_write_b64 v39, v[40:41]
s_waitcnt lgkmcnt(0)
ds_read_b128 v[200:203], v37 offset:0
ds_read_b128 v[204:207], v37 offset:64
ds_read_b128 v[208:211], v37 offset:128
ds_read_b128 v[212:215], v37 offset:192
ds_read_b128 v[216:219], v37 offset:256
ds_read_b128 v[220:223], v37 offset:320
ds_read_b128 v[224:227], v37 offset:384
s_waitcnt vmcnt(7)
s_mov_b32 s55, 0x3f803f80
v_mfma_f32_16x16x32_bf16 v[20:23], a[236:239], v[100:103], 0
v_lshlrev_b32 v24, 16, v104
v_and_b32 v25, 0xffff0000, v104
v_mfma_f32_16x16x32_bf16 v[20:23], a[236:239], v[104:107], v[20:23]
v_lshlrev_b32 v26, 16, v105
v_and_b32 v27, 0xffff0000, v105
v_mfma_f32_16x16x32_bf16 v[20:23], a[236:239], v[108:111], v[20:23]
v_lshlrev_b32 v28, 16, v106
v_and_b32 v29, 0xffff0000, v106
v_mfma_f32_16x16x32_bf16 v[20:23], a[236:239], v[112:115], v[20:23]
v_lshlrev_b32 v30, 16, v107
v_and_b32 v31, 0xffff0000, v107
v_mfma_f32_16x16x32_bf16 v[20:23], a[236:239], v[116:119], v[20:23]
v_lshlrev_b32 v88, 16, v100
v_and_b32 v89, 0xffff0000, v100
v_lshlrev_b32 v90, 16, v101
v_and_b32 v91, 0xffff0000, v101
v_dot2_f32_bf16 v96, v100, v100, 0
v_dot2_f32_bf16 v97, v101, v101, 0
v_dot2_f32_bf16 v96, v102, v102, v96
v_dot2_f32_bf16 v97, v103, v103, v97
v_dot2_f32_bf16 v96, v104, v104, v96
v_dot2_f32_bf16 v97, v105, v105, v97
v_dot2_f32_bf16 v96, v106, v106, v96
v_dot2_f32_bf16 v97, v107, v107, v97
v_dot2_f32_bf16 v96, v108, v108, v96
v_dot2_f32_bf16 v97, v109, v109, v97
v_dot2_f32_bf16 v96, v110, v110, v96
v_dot2_f32_bf16 v97, v111, v111, v97
v_dot2_f32_bf16 v96, v112, v112, v96
v_dot2_f32_bf16 v97, v113, v113, v97
v_dot2_f32_bf16 v96, v114, v114, v96
v_dot2_f32_bf16 v97, v115, v115, v97
v_dot2_f32_bf16 v96, v116, v116, v96
v_dot2_f32_bf16 v97, v117, v117, v97
v_dot2_f32_bf16 v96, v118, v118, v96
v_dot2_f32_bf16 v97, v119, v119, v97
v_add_f32_dpp v20, v20, v20 row_ror:8 row_mask:0xf bank_mask:0xf
v_lshlrev_b32 v100, 16, v102
v_and_b32 v101, 0xffff0000, v102
v_add_f32 v96, v96, v97
v_add_f32_dpp v20, v20, v20 row_ror:4 row_mask:0xf bank_mask:0xf
v_lshlrev_b32 v102, 16, v103
v_add_f32_dpp v96, v96, v96 row_ror:8 row_mask:0xf bank_mask:0xf
v_add_f32_dpp v20, v20, v20 row_ror:2 row_mask:0xf bank_mask:0xf
v_and_b32 v103, 0xffff0000, v103
v_add_f32_dpp v96, v96, v96 row_ror:4 row_mask:0xf bank_mask:0xf
v_add_f32_dpp v20, v20, v20 row_ror:1 row_mask:0xf bank_mask:0xf
v_mul_f32 v20, 0x3acccccd, v20
v_add_f32_dpp v96, v96, v96 row_ror:2 row_mask:0xf bank_mask:0xf
s_nop 1
v_add_f32_dpp v96, v96, v96 row_ror:1 row_mask:0xf bank_mask:0xf
v_mul_f32 v96, 0x3acccccd, v96
v_fma_f32 v96, -v20, v20, v96
v_max_f32 v96, 0, v96
v_add_f32 v96, 0x3727c5ac, v96
v_rsq_f32 v96, v96
s_nop 0
v_mul_f32 v97, -v20, v96
buffer_load_dwordx4 v[120:123], v4, s[8:11], s61 offen offset:0
v_pk_fma_f32 v[24:25], v[24:25], v[96:97], v[96:97] op_sel:[0,0,1] op_sel_hi:[1,0,1]
v_pk_fma_f32 v[26:27], v[26:27], v[96:97], v[96:97] op_sel:[0,0,1] op_sel_hi:[1,0,1]
v_pk_fma_f32 v[28:29], v[28:29], v[96:97], v[96:97] op_sel:[0,0,1] op_sel_hi:[1,0,1]
v_pk_fma_f32 v[30:31], v[30:31], v[96:97], v[96:97] op_sel:[0,0,1] op_sel_hi:[1,0,1]
v_cvt_pk_f16_f32 v104, v24, v25
v_cvt_pk_f16_f32 v105, v26, v27
v_cvt_pk_f16_f32 v106, v28, v29
v_cvt_pk_f16_f32 v107, v30, v31
v_lshlrev_b32 v24, 16, v108
v_and_b32 v25, 0xffff0000, v108
v_lshlrev_b32 v26, 16, v109
v_and_b32 v27, 0xffff0000, v109
buffer_load_dwordx4 v[124:127], v4, s[8:11], s61 offen offset:256
v_lshlrev_b32 v28, 16, v110
v_and_b32 v29, 0xffff0000, v110
v_lshlrev_b32 v30, 16, v111
v_and_b32 v31, 0xffff0000, v111
v_pk_fma_f32 v[24:25], v[24:25], v[96:97], v[96:97] op_sel:[0,0,1] op_sel_hi:[1,0,1]
v_pk_fma_f32 v[26:27], v[26:27], v[96:97], v[96:97] op_sel:[0,0,1] op_sel_hi:[1,0,1]
v_pk_fma_f32 v[28:29], v[28:29], v[96:97], v[96:97] op_sel:[0,0,1] op_sel_hi:[1,0,1]
v_pk_fma_f32 v[30:31], v[30:31], v[96:97], v[96:97] op_sel:[0,0,1] op_sel_hi:[1,0,1]
v_cvt_pk_f16_f32 v108, v24, v25
v_cvt_pk_f16_f32 v109, v26, v27
v_cvt_pk_f16_f32 v110, v28, v29
v_cvt_pk_f16_f32 v111, v30, v31
buffer_load_dwordx4 v[128:131], v4, s[8:11], s61 offen offset:512
v_lshlrev_b32 v24, 16, v112
v_and_b32 v25, 0xffff0000, v112
v_lshlrev_b32 v26, 16, v113
v_and_b32 v27, 0xffff0000, v113
v_lshlrev_b32 v28, 16, v114
v_and_b32 v29, 0xffff0000, v114
v_lshlrev_b32 v30, 16, v115
v_and_b32 v31, 0xffff0000, v115
v_pk_fma_f32 v[24:25], v[24:25], v[96:97], v[96:97] op_sel:[0,0,1] op_sel_hi:[1,0,1]
v_pk_fma_f32 v[26:27], v[26:27], v[96:97], v[96:97] op_sel:[0,0,1] op_sel_hi:[1,0,1]
v_pk_fma_f32 v[28:29], v[28:29], v[96:97], v[96:97] op_sel:[0,0,1] op_sel_hi:[1,0,1]
v_pk_fma_f32 v[30:31], v[30:31], v[96:97], v[96:97] op_sel:[0,0,1] op_sel_hi:[1,0,1]
buffer_load_dwordx4 v[132:135], v4, s[8:11], s61 offen offset:768
v_cvt_pk_f16_f32 v112, v24, v25
v_cvt_pk_f16_f32 v113, v26, v27
v_cvt_pk_f16_f32 v114, v28, v29
v_cvt_pk_f16_f32 v115, v30, v31
v_lshlrev_b32 v24, 16, v116
v_and_b32 v25, 0xffff0000, v116
v_lshlrev_b32 v26, 16, v117
v_and_b32 v27, 0xffff0000, v117
v_lshlrev_b32 v28, 16, v118
v_and_b32 v29, 0xffff0000, v118
v_lshlrev_b32 v30, 16, v119
v_and_b32 v31, 0xffff0000, v119
buffer_load_dwordx4 v[136:139], v4, s[8:11], s61 offen offset:1024
s_bfe_u32 s61, s62, 262152
s_mul_i32 s61, s61, 40960
s_add_u32 s61, s61, s45
v_pk_fma_f32 v[24:25], v[24:25], v[96:97], v[96:97] op_sel:[0,0,1] op_sel_hi:[1,0,1]
v_pk_fma_f32 v[26:27], v[26:27], v[96:97], v[96:97] op_sel:[0,0,1] op_sel_hi:[1,0,1]
v_pk_fma_f32 v[28:29], v[28:29], v[96:97], v[96:97] op_sel:[0,0,1] op_sel_hi:[1,0,1]
v_pk_fma_f32 v[30:31], v[30:31], v[96:97], v[96:97] op_sel:[0,0,1] op_sel_hi:[1,0,1]
v_pk_fma_f32 v[88:89], v[88:89], v[96:97], v[96:97] op_sel:[0,0,1] op_sel_hi:[1,0,1]
v_pk_fma_f32 v[90:91], v[90:91], v[96:97], v[96:97] op_sel:[0,0,1] op_sel_hi:[1,0,1]
v_pk_fma_f32 v[100:101], v[100:101], v[96:97], v[96:97] op_sel:[0,0,1] op_sel_hi:[1,0,1]
v_pk_fma_f32 v[102:103], v[102:103], v[96:97], v[96:97] op_sel:[0,0,1] op_sel_hi:[1,0,1]
v_cvt_pk_f16_f32 v116, v24, v25
v_cvt_pk_f16_f32 v117, v26, v27
v_cvt_pk_f16_f32 v118, v28, v29
v_cvt_pk_f16_f32 v119, v30, v31
s_waitcnt vmcnt(5)
v_readfirstlane_b32 s41, v42
s_barrier
ds_read_b64_tr_b16 v[60:61], v35 offset:0
ds_read_b64_tr_b16 v[62:63], v35 offset:512
ds_read_b64_tr_b16 v[64:65], v35 offset:4096
ds_read_b64_tr_b16 v[66:67], v35 offset:4608
ds_read_b64_tr_b16 v[68:69], v35 offset:8192
ds_read_b64_tr_b16 v[70:71], v35 offset:8704
ds_read_b64_tr_b16 v[72:73], v35 offset:12288
ds_read_b64_tr_b16 v[74:75], v35 offset:12800
ds_read_b64_tr_b16 v[76:77], v35 offset:16384
ds_read_b64_tr_b16 v[78:79], v35 offset:16896
ds_read_b64_tr_b16 v[80:81], v35 offset:20480
ds_read_b64_tr_b16 v[82:83], v35 offset:20992
ds_read_b64_tr_b16 v[84:85], v35 offset:24576
ds_read_b64_tr_b16 v[86:87], v35 offset:25088
s_mul_i32 s40, s41, 0x9E3779B1
s_add_u32 s40, s40, 0x85EBCA6B
v_and_b32 v33, 3, v1
v_lshlrev_b32 v33, 3, v33
v_lshrrev_b32 v19, v33, s40
v_and_b32 v19, 0xff, v19
v_mov_b32 v240, s40
v_mov_b32 v241, s19
v_mov_b32 v242, s40
v_mov_b32 v243, s40
s_waitcnt lgkmcnt(12)
v_mfma_f32_16x16x32_bf16 v[56:59], v[200:203], v[60:63], 0
s_waitcnt lgkmcnt(10)
v_mfma_f32_16x16x32_bf16 v[56:59], v[204:207], v[64:67], v[56:59]
s_waitcnt lgkmcnt(8)
v_mfma_f32_16x16x32_bf16 v[56:59], v[208:211], v[68:71], v[56:59]
s_waitcnt lgkmcnt(6)
v_mfma_f32_16x16x32_bf16 v[56:59], v[212:215], v[72:75], v[56:59]
s_waitcnt lgkmcnt(4)
v_mfma_f32_16x16x32_bf16 v[56:59], v[216:219], v[76:79], v[56:59]
s_waitcnt lgkmcnt(2)
v_mfma_f32_16x16x32_bf16 v[56:59], v[220:223], v[80:83], v[56:59]
s_waitcnt lgkmcnt(0)
v_mfma_f32_16x16x32_bf16 v[56:59], v[224:227], v[84:87], v[56:59]
s_nop 7
v_and_or_b32 v56, v56, s54, v19
buffer_store_dword v56, v38, s[4:7], s22 offen sc1
buffer_load_dwordx4 v[140:143], v4, s[8:11], s61 offen offset:0
buffer_load_dwordx4 v[144:147], v4, s[8:11], s61 offen offset:256
buffer_load_dwordx4 v[148:151], v4, s[8:11], s61 offen offset:512
buffer_load_dwordx4 v[152:155], v4, s[8:11], s61 offen offset:768
buffer_load_dwordx4 v[156:159], v4, s[8:11], s61 offen offset:1024
s_bfe_u32 s61, s62, 262156
s_mul_i32 s61, s61, 40960
s_add_u32 s61, s61, s45
s_waitcnt vmcnt(6)
s_mov_b32 s55, 0x3f803f80
buffer_load_dwordx4 v[160:163], v4, s[8:11], s61 offen offset:0
v_mfma_f32_16x16x32_bf16 v[20:23], a[236:239], v[120:123], 0
v_lshlrev_b32 v24, 16, v124
v_and_b32 v25, 0xffff0000, v124
v_mfma_f32_16x16x32_bf16 v[20:23], a[236:239], v[124:127], v[20:23]
v_lshlrev_b32 v26, 16, v125
v_and_b32 v27, 0xffff0000, v125
v_mfma_f32_16x16x32_bf16 v[20:23], a[236:239], v[128:131], v[20:23]
v_lshlrev_b32 v28, 16, v126
v_and_b32 v29, 0xffff0000, v126
v_mfma_f32_16x16x32_bf16 v[20:23], a[236:239], v[132:135], v[20:23]
v_lshlrev_b32 v30, 16, v127
v_and_b32 v31, 0xffff0000, v127
v_mfma_f32_16x16x32_bf16 v[20:23], a[236:239], v[136:139], v[20:23]
v_lshlrev_b32 v92, 16, v120
v_and_b32 v93, 0xffff0000, v120
v_lshlrev_b32 v94, 16, v121
v_and_b32 v95, 0xffff0000, v121
v_dot2_f32_bf16 v98, v120, v120, 0
v_dot2_f32_bf16 v99, v121, v121, 0
v_dot2_f32_bf16 v98, v122, v122, v98
v_dot2_f32_bf16 v99, v123, v123, v99
v_dot2_f32_bf16 v98, v124, v124, v98
v_dot2_f32_bf16 v99, v125, v125, v99
buffer_load_dwordx4 v[164:167], v4, s[8:11], s61 offen offset:256
v_dot2_f32_bf16 v98, v126, v126, v98
v_dot2_f32_bf16 v99, v127, v127, v99
v_dot2_f32_bf16 v98, v128, v128, v98
v_dot2_f32_bf16 v99, v129, v129, v99
v_dot2_f32_bf16 v98, v130, v130, v98
v_dot2_f32_bf16 v99, v131, v131, v99
v_dot2_f32_bf16 v98, v132, v132, v98
v_dot2_f32_bf16 v99, v133, v133, v99
v_dot2_f32_bf16 v98, v134, v134, v98
v_dot2_f32_bf16 v99, v135, v135, v99
v_dot2_f32_bf16 v98, v136, v136, v98
v_dot2_f32_bf16 v99, v137, v137, v99
v_dot2_f32_bf16 v98, v138, v138, v98
v_dot2_f32_bf16 v99, v139, v139, v99
v_add_f32_dpp v20, v20, v20 row_ror:8 row_mask:0xf bank_mask:0xf
v_lshlrev_b32 v120, 16, v122
v_and_b32 v121, 0xffff0000, v122
v_add_f32 v98, v98, v99
v_add_f32_dpp v20, v20, v20 row_ror:4 row_mask:0xf bank_mask:0xf
v_lshlrev_b32 v122, 16, v123
v_add_f32_dpp v98, v98, v98 row_ror:8 row_mask:0xf bank_mask:0xf
v_add_f32_dpp v20, v20, v20 row_ror:2 row_mask:0xf bank_mask:0xf
v_and_b32 v123, 0xffff0000, v123
v_add_f32_dpp v98, v98, v98 row_ror:4 row_mask:0xf bank_mask:0xf
buffer_load_dwordx4 v[168:171], v4, s[8:11], s61 offen offset:512
v_add_f32_dpp v20, v20, v20 row_ror:1 row_mask:0xf bank_mask:0xf
v_mul_f32 v20, 0x3acccccd, v20
v_add_f32_dpp v98, v98, v98 row_ror:2 row_mask:0xf bank_mask:0xf
s_nop 1
v_add_f32_dpp v98, v98, v98 row_ror:1 row_mask:0xf bank_mask:0xf
v_mul_f32 v98, 0x3acccccd, v98
v_fma_f32 v98, -v20, v20, v98
v_max_f32 v98, 0, v98
v_add_f32 v98, 0x3727c5ac, v98
v_rsq_f32 v98, v98
s_nop 0
v_mul_f32 v99, -v20, v98
v_pk_fma_f32 v[24:25], v[24:25], v[98:99], v[98:99] op_sel:[0,0,1] op_sel_hi:[1,0,1]
v_pk_fma_f32 v[26:27], v[26:27], v[98:99], v[98:99] op_sel:[0,0,1] op_sel_hi:[1,0,1]
v_pk_fma_f32 v[28:29], v[28:29], v[98:99], v[98:99] op_sel:[0,0,1] op_sel_hi:[1,0,1]
v_pk_fma_f32 v[30:31], v[30:31], v[98:99], v[98:99] op_sel:[0,0,1] op_sel_hi:[1,0,1]
v_cvt_pk_f16_f32 v124, v24, v25
v_cvt_pk_f16_f32 v125, v26, v27
v_cvt_pk_f16_f32 v126, v28, v29
v_cvt_pk_f16_f32 v127, v30, v31
v_lshlrev_b32 v24, 16, v128
v_and_b32 v25, 0xffff0000, v128
v_lshlrev_b32 v26, 16, v129
v_and_b32 v27, 0xffff0000, v129
v_lshlrev_b32 v28, 16, v130
buffer_load_dwordx4 v[172:175], v4, s[8:11], s61 offen offset:768
v_and_b32 v29, 0xffff0000, v130
v_lshlrev_b32 v30, 16, v131
v_and_b32 v31, 0xffff0000, v131
v_pk_fma_f32 v[24:25], v[24:25], v[98:99], v[98:99] op_sel:[0,0,1] op_sel_hi:[1,0,1]
v_pk_fma_f32 v[26:27], v[26:27], v[98:99], v[98:99] op_sel:[0,0,1] op_sel_hi:[1,0,1]
v_pk_fma_f32 v[28:29], v[28:29], v[98:99], v[98:99] op_sel:[0,0,1] op_sel_hi:[1,0,1]
v_pk_fma_f32 v[30:31], v[30:31], v[98:99], v[98:99] op_sel:[0,0,1] op_sel_hi:[1,0,1]
v_cvt_pk_f16_f32 v128, v24, v25
v_cvt_pk_f16_f32 v129, v26, v27
v_cvt_pk_f16_f32 v130, v28, v29
v_cvt_pk_f16_f32 v131, v30, v31
v_lshlrev_b32 v24, 16, v132
v_and_b32 v25, 0xffff0000, v132
v_lshlrev_b32 v26, 16, v133
v_and_b32 v27, 0xffff0000, v133
v_lshlrev_b32 v28, 16, v134
v_and_b32 v29, 0xffff0000, v134
v_lshlrev_b32 v30, 16, v135
v_and_b32 v31, 0xffff0000, v135
v_pk_fma_f32 v[24:25], v[24:25], v[98:99], v[98:99] op_sel:[0,0,1] op_sel_hi:[1,0,1]
v_pk_fma_f32 v[26:27], v[26:27], v[98:99], v[98:99] op_sel:[0,0,1] op_sel_hi:[1,0,1]
v_pk_fma_f32 v[28:29], v[28:29], v[98:99], v[98:99] op_sel:[0,0,1] op_sel_hi:[1,0,1]
v_pk_fma_f32 v[30:31], v[30:31], v[98:99], v[98:99] op_sel:[0,0,1] op_sel_hi:[1,0,1]
buffer_load_dwordx4 v[176:179], v4, s[8:11], s61 offen offset:1024
s_bfe_u32 s61, s62, 262160
s_mul_i32 s61, s61, 40960
s_add_u32 s61, s61, s45
v_cvt_pk_f16_f32 v132, v24, v25
v_cvt_pk_f16_f32 v133, v26, v27
v_cvt_pk_f16_f32 v134, v28, v29
v_cvt_pk_f16_f32 v135, v30, v31
v_lshlrev_b32 v24, 16, v136
v_and_b32 v25, 0xffff0000, v136
v_lshlrev_b32 v26, 16, v137
v_and_b32 v27, 0xffff0000, v137
v_lshlrev_b32 v28, 16, v138
v_and_b32 v29, 0xffff0000, v138
v_lshlrev_b32 v30, 16, v139
v_and_b32 v31, 0xffff0000, v139
v_pk_fma_f32 v[24:25], v[24:25], v[98:99], v[98:99] op_sel:[0,0,1] op_sel_hi:[1,0,1]
v_pk_fma_f32 v[26:27], v[26:27], v[98:99], v[98:99] op_sel:[0,0,1] op_sel_hi:[1,0,1]
v_pk_fma_f32 v[28:29], v[28:29], v[98:99], v[98:99] op_sel:[0,0,1] op_sel_hi:[1,0,1]
v_pk_fma_f32 v[30:31], v[30:31], v[98:99], v[98:99] op_sel:[0,0,1] op_sel_hi:[1,0,1]
v_pk_fma_f32 v[92:93], v[92:93], v[98:99], v[98:99] op_sel:[0,0,1] op_sel_hi:[1,0,1]
v_pk_fma_f32 v[94:95], v[94:95], v[98:99], v[98:99] op_sel:[0,0,1] op_sel_hi:[1,0,1]
v_pk_fma_f32 v[120:121], v[120:121], v[98:99], v[98:99] op_sel:[0,0,1] op_sel_hi:[1,0,1]
v_pk_fma_f32 v[122:123], v[122:123], v[98:99], v[98:99] op_sel:[0,0,1] op_sel_hi:[1,0,1]
v_cvt_pk_f16_f32 v136, v24, v25
v_cvt_pk_f16_f32 v137, v26, v27
v_cvt_pk_f16_f32 v138, v28, v29
v_cvt_pk_f16_f32 v139, v30, v31
s_barrier
s_waitcnt vmcnt(5)
s_mov_b32 s55, 0x3f803f80
buffer_load_dwordx4 v[180:183], v4, s[8:11], s61 offen offset:0
v_mfma_f32_16x16x32_bf16 v[20:23], a[236:239], v[140:143], 0
v_lshlrev_b32 v24, 16, v144
v_and_b32 v25, 0xffff0000, v144
v_mfma_f32_16x16x32_bf16 v[20:23], a[236:239], v[144:147], v[20:23]
v_lshlrev_b32 v26, 16, v145
v_and_b32 v27, 0xffff0000, v145
v_mfma_f32_16x16x32_bf16 v[20:23], a[236:239], v[148:151], v[20:23]
v_lshlrev_b32 v28, 16, v146
v_and_b32 v29, 0xffff0000, v146
v_mfma_f32_16x16x32_bf16 v[20:23], a[236:239], v[152:155], v[20:23]
buffer_load_dwordx4 v[184:187], v4, s[8:11], s61 offen offset:256
v_lshlrev_b32 v30, 16, v147
v_and_b32 v31, 0xffff0000, v147
v_mfma_f32_16x16x32_bf16 v[20:23], a[236:239], v[156:159], v[20:23]
v_lshlrev_b32 v72, 16, v140
v_and_b32 v73, 0xffff0000, v140
v_lshlrev_b32 v74, 16, v141
v_and_b32 v75, 0xffff0000, v141
v_dot2_f32_bf16 v84, v140, v140, 0
v_dot2_f32_bf16 v85, v141, v141, 0
v_dot2_f32_bf16 v84, v142, v142, v84
v_dot2_f32_bf16 v85, v143, v143, v85
buffer_load_dwordx4 v[188:191], v4, s[8:11], s61 offen offset:512
v_dot2_f32_bf16 v84, v144, v144, v84
v_dot2_f32_bf16 v85, v145, v145, v85
v_dot2_f32_bf16 v84, v146, v146, v84
v_dot2_f32_bf16 v85, v147, v147, v85
v_dot2_f32_bf16 v84, v148, v148, v84
v_dot2_f32_bf16 v85, v149, v149, v85
v_dot2_f32_bf16 v84, v150, v150, v84
v_dot2_f32_bf16 v85, v151, v151, v85
v_dot2_f32_bf16 v84, v152, v152, v84
v_dot2_f32_bf16 v85, v153, v153, v85
v_dot2_f32_bf16 v84, v154, v154, v84
buffer_load_dwordx4 v[192:195], v4, s[8:11], s61 offen offset:768
v_dot2_f32_bf16 v85, v155, v155, v85
v_dot2_f32_bf16 v84, v156, v156, v84
v_dot2_f32_bf16 v85, v157, v157, v85
v_dot2_f32_bf16 v84, v158, v158, v84
v_dot2_f32_bf16 v85, v159, v159, v85
v_add_f32_dpp v20, v20, v20 row_ror:8 row_mask:0xf bank_mask:0xf
v_lshlrev_b32 v140, 16, v142
v_and_b32 v141, 0xffff0000, v142
v_add_f32 v84, v84, v85
v_add_f32_dpp v20, v20, v20 row_ror:4 row_mask:0xf bank_mask:0xf
buffer_load_dwordx4 v[196:199], v4, s[8:11], s61 offen offset:1024
v_lshlrev_b32 v142, 16, v143
v_add_f32_dpp v84, v84, v84 row_ror:8 row_mask:0xf bank_mask:0xf
v_add_f32_dpp v20, v20, v20 row_ror:2 row_mask:0xf bank_mask:0xf
v_and_b32 v143, 0xffff0000, v143
v_add_f32_dpp v84, v84, v84 row_ror:4 row_mask:0xf bank_mask:0xf
v_add_f32_dpp v20, v20, v20 row_ror:1 row_mask:0xf bank_mask:0xf
v_mul_f32 v20, 0x3acccccd, v20
v_add_f32_dpp v84, v84, v84 row_ror:2 row_mask:0xf bank_mask:0xf
s_nop 1
v_add_f32_dpp v84, v84, v84 row_ror:1 row_mask:0xf bank_mask:0xf
v_mul_f32 v84, 0x3acccccd, v84
v_fma_f32 v84, -v20, v20, v84
s_add_u32 m0, s39, 0
s_nop 0
buffer_load_dwordx4 v232, s[24:27], s48 offen offset:0 lds
v_max_f32 v84, 0, v84
v_add_f32 v84, 0x3727c5ac, v84
v_rsq_f32 v84, v84
s_nop 0
v_mul_f32 v85, -v20, v84
v_pk_fma_f32 v[24:25], v[24:25], v[84:85], v[84:85] op_sel:[0,0,1] op_sel_hi:[1,0,1]
v_pk_fma_f32 v[26:27], v[26:27], v[84:85], v[84:85] op_sel:[0,0,1] op_sel_hi:[1,0,1]
v_pk_fma_f32 v[28:29], v[28:29], v[84:85], v[84:85] op_sel:[0,0,1] op_sel_hi:[1,0,1]
v_pk_fma_f32 v[30:31], v[30:31], v[84:85], v[84:85] op_sel:[0,0,1] op_sel_hi:[1,0,1]
v_cvt_pk_f16_f32 v144, v24, v25
v_cvt_pk_f16_f32 v145, v26, v27
buffer_load_dwordx4 v233, s[24:27], s48 offen offset:1024 lds
v_cvt_pk_f16_f32 v146, v28, v29
v_cvt_pk_f16_f32 v147, v30, v31
v_lshlrev_b32 v24, 16, v148
v_and_b32 v25, 0xffff0000, v148
v_lshlrev_b32 v26, 16, v149
v_and_b32 v27, 0xffff0000, v149
v_lshlrev_b32 v28, 16, v150
v_and_b32 v29, 0xffff0000, v150
v_lshlrev_b32 v30, 16, v151
v_and_b32 v31, 0xffff0000, v151
v_pk_fma_f32 v[24:25], v[24:25], v[84:85], v[84:85] op_sel:[0,0,1] op_sel_hi:[1,0,1]
buffer_load_dwordx4 v234, s[24:27], s48 offen offset:2048 lds
s_add_u32 s48, s48, 81920
v_pk_fma_f32 v[26:27], v[26:27], v[84:85], v[84:85] op_sel:[0,0,1] op_sel_hi:[1,0,1]
v_pk_fma_f32 v[28:29], v[28:29], v[84:85], v[84:85] op_sel:[0,0,1] op_sel_hi:[1,0,1]
v_pk_fma_f32 v[30:31], v[30:31], v[84:85], v[84:85] op_sel:[0,0,1] op_sel_hi:[1,0,1]
v_cvt_pk_f16_f32 v148, v24, v25
v_cvt_pk_f16_f32 v149, v26, v27
v_cvt_pk_f16_f32 v150, v28, v29
v_cvt_pk_f16_f32 v151, v30, v31
v_lshlrev_b32 v24, 16, v152
v_and_b32 v25, 0xffff0000, v152
v_lshlrev_b32 v26, 16, v153
v_and_b32 v27, 0xffff0000, v153
s_add_u32 m0, s39, 12288
s_nop 0
buffer_load_dwordx4 v232, s[24:27], s48 offen offset:0 lds
v_lshlrev_b32 v28, 16, v154
v_and_b32 v29, 0xffff0000, v154
v_lshlrev_b32 v30, 16, v155
v_and_b32 v31, 0xffff0000, v155
v_pk_fma_f32 v[24:25], v[24:25], v[84:85], v[84:85] op_sel:[0,0,1] op_sel_hi:[1,0,1]
v_pk_fma_f32 v[26:27], v[26:27], v[84:85], v[84:85] op_sel:[0,0,1] op_sel_hi:[1,0,1]
v_pk_fma_f32 v[28:29], v[28:29], v[84:85], v[84:85] op_sel:[0,0,1] op_sel_hi:[1,0,1]
v_pk_fma_f32 v[30:31], v[30:31], v[84:85], v[84:85] op_sel:[0,0,1] op_sel_hi:[1,0,1]
v_cvt_pk_f16_f32 v152, v24, v25
v_cvt_pk_f16_f32 v153, v26, v27
buffer_load_dwordx4 v233, s[24:27], s48 offen offset:1024 lds
v_cvt_pk_f16_f32 v154, v28, v29
v_cvt_pk_f16_f32 v155, v30, v31
v_lshlrev_b32 v24, 16, v156
v_and_b32 v25, 0xffff0000, v156
v_lshlrev_b32 v26, 16, v157
v_and_b32 v27, 0xffff0000, v157
v_lshlrev_b32 v28, 16, v158
v_and_b32 v29, 0xffff0000, v158
v_lshlrev_b32 v30, 16, v159
v_and_b32 v31, 0xffff0000, v159
v_pk_fma_f32 v[24:25], v[24:25], v[84:85], v[84:85] op_sel:[0,0,1] op_sel_hi:[1,0,1]
buffer_load_dwordx4 v234, s[24:27], s48 offen offset:2048 lds
s_add_u32 s48, s48, 81920
v_pk_fma_f32 v[26:27], v[26:27], v[84:85], v[84:85] op_sel:[0,0,1] op_sel_hi:[1,0,1]
v_pk_fma_f32 v[28:29], v[28:29], v[84:85], v[84:85] op_sel:[0,0,1] op_sel_hi:[1,0,1]
v_pk_fma_f32 v[30:31], v[30:31], v[84:85], v[84:85] op_sel:[0,0,1] op_sel_hi:[1,0,1]
v_pk_fma_f32 v[72:73], v[72:73], v[84:85], v[84:85] op_sel:[0,0,1] op_sel_hi:[1,0,1]
v_pk_fma_f32 v[74:75], v[74:75], v[84:85], v[84:85] op_sel:[0,0,1] op_sel_hi:[1,0,1]
v_pk_fma_f32 v[140:141], v[140:141], v[84:85], v[84:85] op_sel:[0,0,1] op_sel_hi:[1,0,1]
v_pk_fma_f32 v[142:143], v[142:143], v[84:85], v[84:85] op_sel:[0,0,1] op_sel_hi:[1,0,1]
v_cvt_pk_f16_f32 v156, v24, v25
v_cvt_pk_f16_f32 v157, v26, v27
v_cvt_pk_f16_f32 v158, v28, v29
v_cvt_pk_f16_f32 v159, v30, v31
s_waitcnt vmcnt(11)
s_mov_b32 s55, 0x3f803f80
buffer_store_dwordx4 a[232:235], v11, s[4:7], s46 offen sc1
v_mfma_f32_16x16x32_bf16 v[20:23], a[236:239], v[160:163], 0
v_lshlrev_b32 v24, 16, v164
v_and_b32 v25, 0xffff0000, v164
v_mfma_f32_16x16x32_bf16 v[20:23], a[236:239], v[164:167], v[20:23]
v_lshlrev_b32 v26, 16, v165
v_and_b32 v27, 0xffff0000, v165
v_mfma_f32_16x16x32_bf16 v[20:23], a[236:239], v[168:171], v[20:23]
v_lshlrev_b32 v28, 16, v166
v_and_b32 v29, 0xffff0000, v166
v_mfma_f32_16x16x32_bf16 v[20:23], a[236:239], v[172:175], v[20:23]
v_lshlrev_b32 v30, 16, v167
v_and_b32 v31, 0xffff0000, v167
v_mfma_f32_16x16x32_bf16 v[20:23], a[236:239], v[176:179], v[20:23]
v_lshlrev_b32 v76, 16, v160
v_and_b32 v77, 0xffff0000, v160
v_lshlrev_b32 v78, 16, v161
v_and_b32 v79, 0xffff0000, v161
buffer_store_dwordx4 a[232:235], v12, s[4:7], s46 offen sc1
v_dot2_f32_bf16 v86, v160, v160, 0
v_dot2_f32_bf16 v87, v161, v161, 0
v_dot2_f32_bf16 v86, v162, v162, v86
v_dot2_f32_bf16 v87, v163, v163, v87
v_dot2_f32_bf16 v86, v164, v164, v86
v_dot2_f32_bf16 v87, v165, v165, v87
v_dot2_f32_bf16 v86, v166, v166, v86
v_dot2_f32_bf16 v87, v167, v167, v87
v_dot2_f32_bf16 v86, v168, v168, v86
v_dot2_f32_bf16 v87, v169, v169, v87
v_dot2_f32_bf16 v86, v170, v170, v86
v_dot2_f32_bf16 v87, v171, v171, v87
v_dot2_f32_bf16 v86, v172, v172, v86
v_dot2_f32_bf16 v87, v173, v173, v87
v_dot2_f32_bf16 v86, v174, v174, v86
v_dot2_f32_bf16 v87, v175, v175, v87
buffer_store_dwordx4 a[232:235], v13, s[4:7], s46 offen sc1
v_dot2_f32_bf16 v86, v176, v176, v86
v_dot2_f32_bf16 v87, v177, v177, v87
v_dot2_f32_bf16 v86, v178, v178, v86
v_dot2_f32_bf16 v87, v179, v179, v87
v_add_f32_dpp v20, v20, v20 row_ror:8 row_mask:0xf bank_mask:0xf
v_lshlrev_b32 v160, 16, v162
v_and_b32 v161, 0xffff0000, v162
v_add_f32 v86, v86, v87
v_add_f32_dpp v20, v20, v20 row_ror:4 row_mask:0xf bank_mask:0xf
v_lshlrev_b32 v162, 16, v163
v_add_f32_dpp v86, v86, v86 row_ror:8 row_mask:0xf bank_mask:0xf
v_add_f32_dpp v20, v20, v20 row_ror:2 row_mask:0xf bank_mask:0xf
v_and_b32 v163, 0xffff0000, v163
v_add_f32_dpp v86, v86, v86 row_ror:4 row_mask:0xf bank_mask:0xf
v_add_f32_dpp v20, v20, v20 row_ror:1 row_mask:0xf bank_mask:0xf
v_mul_f32 v20, 0x3acccccd, v20
v_add_f32_dpp v86, v86, v86 row_ror:2 row_mask:0xf bank_mask:0xf
buffer_store_dwordx4 a[232:235], v14, s[4:7], s46 offen sc1
s_nop 0
v_add_f32_dpp v86, v86, v86 row_ror:1 row_mask:0xf bank_mask:0xf
v_mul_f32 v86, 0x3acccccd, v86
v_fma_f32 v86, -v20, v20, v86
v_max_f32 v86, 0, v86
v_add_f32 v86, 0x3727c5ac, v86
v_rsq_f32 v86, v86
s_nop 0
v_mul_f32 v87, -v20, v86
v_pk_fma_f32 v[24:25], v[24:25], v[86:87], v[86:87] op_sel:[0,0,1] op_sel_hi:[1,0,1]
v_pk_fma_f32 v[26:27], v[26:27], v[86:87], v[86:87] op_sel:[0,0,1] op_sel_hi:[1,0,1]
v_pk_fma_f32 v[28:29], v[28:29], v[86:87], v[86:87] op_sel:[0,0,1] op_sel_hi:[1,0,1]
v_pk_fma_f32 v[30:31], v[30:31], v[86:87], v[86:87] op_sel:[0,0,1] op_sel_hi:[1,0,1]
v_cvt_pk_f16_f32 v164, v24, v25
v_cvt_pk_f16_f32 v165, v26, v27
v_cvt_pk_f16_f32 v166, v28, v29
v_cvt_pk_f16_f32 v167, v30, v31
v_lshlrev_b32 v24, 16, v168
v_and_b32 v25, 0xffff0000, v168
buffer_store_dwordx4 a[232:235], v246, s[4:7], s18 offen sc1
v_lshlrev_b32 v26, 16, v169
v_and_b32 v27, 0xffff0000, v169
v_lshlrev_b32 v28, 16, v170
v_and_b32 v29, 0xffff0000, v170
v_lshlrev_b32 v30, 16, v171
v_and_b32 v31, 0xffff0000, v171
v_pk_fma_f32 v[24:25], v[24:25], v[86:87], v[86:87] op_sel:[0,0,1] op_sel_hi:[1,0,1]
v_pk_fma_f32 v[26:27], v[26:27], v[86:87], v[86:87] op_sel:[0,0,1] op_sel_hi:[1,0,1]
v_pk_fma_f32 v[28:29], v[28:29], v[86:87], v[86:87] op_sel:[0,0,1] op_sel_hi:[1,0,1]
v_pk_fma_f32 v[30:31], v[30:31], v[86:87], v[86:87] op_sel:[0,0,1] op_sel_hi:[1,0,1]
v_cvt_pk_f16_f32 v168, v24, v25
v_cvt_pk_f16_f32 v169, v26, v27
v_cvt_pk_f16_f32 v170, v28, v29
v_cvt_pk_f16_f32 v171, v30, v31
v_lshlrev_b32 v24, 16, v172
v_and_b32 v25, 0xffff0000, v172
s_add_u32 s37, s18, 8192
buffer_store_dwordx4 a[232:235], v246, s[4:7], s37 offen sc1
v_lshlrev_b32 v26, 16, v173
v_and_b32 v27, 0xffff0000, v173
v_lshlrev_b32 v28, 16, v174
v_and_b32 v29, 0xffff0000, v174
v_lshlrev_b32 v30, 16, v175
v_and_b32 v31, 0xffff0000, v175
v_pk_fma_f32 v[24:25], v[24:25], v[86:87], v[86:87] op_sel:[0,0,1] op_sel_hi:[1,0,1]
v_pk_fma_f32 v[26:27], v[26:27], v[86:87], v[86:87] op_sel:[0,0,1] op_sel_hi:[1,0,1]
v_pk_fma_f32 v[28:29], v[28:29], v[86:87], v[86:87] op_sel:[0,0,1] op_sel_hi:[1,0,1]
v_pk_fma_f32 v[30:31], v[30:31], v[86:87], v[86:87] op_sel:[0,0,1] op_sel_hi:[1,0,1]
v_cvt_pk_f16_f32 v172, v24, v25
v_cvt_pk_f16_f32 v173, v26, v27
v_cvt_pk_f16_f32 v174, v28, v29
v_cvt_pk_f16_f32 v175, v30, v31
v_lshlrev_b32 v24, 16, v176
v_and_b32 v25, 0xffff0000, v176
v_lshlrev_b32 v26, 16, v177
s_lshl_b32 s37, s47, 2
s_add_u32 s37, s37, s3
s_lshl_b32 s37, s37, 3
s_add_u32 s37, s37, s96
s_lshl_b32 s37, s37, 8
s_add_u32 s37, s37, 131072
v_lshlrev_b32 v69, 2, v1
v_xor_b32 v70, 0xff, v19
buffer_store_dword v70, v69, s[4:7], s37 offen sc1
v_and_b32 v27, 0xffff0000, v177
v_lshlrev_b32 v28, 16, v178
v_and_b32 v29, 0xffff0000, v178
v_lshlrev_b32 v30, 16, v179
v_and_b32 v31, 0xffff0000, v179
v_pk_fma_f32 v[24:25], v[24:25], v[86:87], v[86:87] op_sel:[0,0,1] op_sel_hi:[1,0,1]
v_pk_fma_f32 v[26:27], v[26:27], v[86:87], v[86:87] op_sel:[0,0,1] op_sel_hi:[1,0,1]
v_pk_fma_f32 v[28:29], v[28:29], v[86:87], v[86:87] op_sel:[0,0,1] op_sel_hi:[1,0,1]
v_pk_fma_f32 v[30:31], v[30:31], v[86:87], v[86:87] op_sel:[0,0,1] op_sel_hi:[1,0,1]
v_pk_fma_f32 v[76:77], v[76:77], v[86:87], v[86:87] op_sel:[0,0,1] op_sel_hi:[1,0,1]
v_pk_fma_f32 v[78:79], v[78:79], v[86:87], v[86:87] op_sel:[0,0,1] op_sel_hi:[1,0,1]
v_pk_fma_f32 v[160:161], v[160:161], v[86:87], v[86:87] op_sel:[0,0,1] op_sel_hi:[1,0,1]
v_pk_fma_f32 v[162:163], v[162:163], v[86:87], v[86:87] op_sel:[0,0,1] op_sel_hi:[1,0,1]
v_cvt_pk_f16_f32 v176, v24, v25
v_cvt_pk_f16_f32 v177, v26, v27
v_cvt_pk_f16_f32 v178, v28, v29
v_cvt_pk_f16_f32 v179, v30, v31
buffer_load_dwordx4 v[40:43], v248, s[4:7], s56 offen sc1
s_waitcnt vmcnt(14)
s_mov_b32 s55, 0x3f803f80
v_mfma_f32_16x16x32_bf16 v[20:23], a[236:239], v[180:183], 0
v_lshlrev_b32 v24, 16, v184
v_and_b32 v25, 0xffff0000, v184
v_mfma_f32_16x16x32_bf16 v[20:23], a[236:239], v[184:187], v[20:23]
v_lshlrev_b32 v26, 16, v185
v_and_b32 v27, 0xffff0000, v185
v_mfma_f32_16x16x32_bf16 v[20:23], a[236:239], v[188:191], v[20:23]
buffer_load_dwordx4 v[44:47], v248, s[4:7], s57 offen sc1
v_lshlrev_b32 v28, 16, v186
v_and_b32 v29, 0xffff0000, v186
v_mfma_f32_16x16x32_bf16 v[20:23], a[236:239], v[192:195], v[20:23]
v_lshlrev_b32 v30, 16, v187
v_and_b32 v31, 0xffff0000, v187
v_mfma_f32_16x16x32_bf16 v[20:23], a[236:239], v[196:199], v[20:23]
v_lshlrev_b32 v80, 16, v180
v_and_b32 v81, 0xffff0000, v180
v_lshlrev_b32 v82, 16, v181
buffer_load_dwordx4 v[48:51], v248, s[4:7], s58 offen sc1
v_and_b32 v83, 0xffff0000, v181
v_dot2_f32_bf16 v66, v180, v180, 0
v_dot2_f32_bf16 v67, v181, v181, 0
v_dot2_f32_bf16 v66, v182, v182, v66
v_dot2_f32_bf16 v67, v183, v183, v67
v_dot2_f32_bf16 v66, v184, v184, v66
v_dot2_f32_bf16 v67, v185, v185, v67
v_dot2_f32_bf16 v66, v186, v186, v66
v_dot2_f32_bf16 v67, v187, v187, v67
buffer_load_dword v52, v249, s[4:7], s56 offen sc1
v_dot2_f32_bf16 v66, v188, v188, v66
v_dot2_f32_bf16 v67, v189, v189, v67
v_dot2_f32_bf16 v66, v190, v190, v66
v_dot2_f32_bf16 v67, v191, v191, v67
v_dot2_f32_bf16 v66, v192, v192, v66
v_dot2_f32_bf16 v67, v193, v193, v67
v_dot2_f32_bf16 v66, v194, v194, v66
v_dot2_f32_bf16 v67, v195, v195, v67
v_dot2_f32_bf16 v66, v196, v196, v66
buffer_load_dword v53, v249, s[4:7], s57 offen sc1
v_dot2_f32_bf16 v67, v197, v197, v67
v_dot2_f32_bf16 v66, v198, v198, v66
v_dot2_f32_bf16 v67, v199, v199, v67
v_add_f32_dpp v20, v20, v20 row_ror:8 row_mask:0xf bank_mask:0xf
v_lshlrev_b32 v180, 16, v182
v_and_b32 v181, 0xffff0000, v182
v_add_f32 v66, v66, v67
v_add_f32_dpp v20, v20, v20 row_ror:4 row_mask:0xf bank_mask:0xf
v_lshlrev_b32 v182, 16, v183
buffer_load_dword v54, v249, s[4:7], s58 offen sc1
v_add_f32_dpp v66, v66, v66 row_ror:8 row_mask:0xf bank_mask:0xf
v_add_f32_dpp v20, v20, v20 row_ror:2 row_mask:0xf bank_mask:0xf
v_and_b32 v183, 0xffff0000, v183
v_add_f32_dpp v66, v66, v66 row_ror:4 row_mask:0xf bank_mask:0xf
v_add_f32_dpp v20, v20, v20 row_ror:1 row_mask:0xf bank_mask:0xf
v_mul_f32 v20, 0x3acccccd, v20
v_add_f32_dpp v66, v66, v66 row_ror:2 row_mask:0xf bank_mask:0xf
s_nop 1
v_add_f32_dpp v66, v66, v66 row_ror:1 row_mask:0xf bank_mask:0xf
v_mul_f32 v66, 0x3acccccd, v66
buffer_load_dword v71, v247, s[4:7], s60 offen sc1
v_fma_f32 v66, -v20, v20, v66
v_max_f32 v66, 0, v66
v_add_f32 v66, 0x3727c5ac, v66
v_rsq_f32 v66, v66
s_nop 0
v_mul_f32 v67, -v20, v66
v_pk_fma_f32 v[24:25], v[24:25], v[66:67], v[66:67] op_sel:[0,0,1] op_sel_hi:[1,0,1]
v_pk_fma_f32 v[26:27], v[26:27], v[66:67], v[66:67] op_sel:[0,0,1] op_sel_hi:[1,0,1]
v_pk_fma_f32 v[28:29], v[28:29], v[66:67], v[66:67] op_sel:[0,0,1] op_sel_hi:[1,0,1]
v_pk_fma_f32 v[30:31], v[30:31], v[66:67], v[66:67] op_sel:[0,0,1] op_sel_hi:[1,0,1]
v_cvt_pk_f16_f32 v184, v24, v25
s_add_u32 m0, s39, 24576
s_nop 0
buffer_load_dwordx4 v232, s[24:27], s48 offen offset:0 lds
v_cvt_pk_f16_f32 v185, v26, v27
v_cvt_pk_f16_f32 v186, v28, v29
v_cvt_pk_f16_f32 v187, v30, v31
v_lshlrev_b32 v24, 16, v188
v_and_b32 v25, 0xffff0000, v188
v_lshlrev_b32 v26, 16, v189
v_and_b32 v27, 0xffff0000, v189
v_lshlrev_b32 v28, 16, v190
v_and_b32 v29, 0xffff0000, v190
buffer_load_dwordx4 v233, s[24:27], s48 offen offset:1024 lds
v_lshlrev_b32 v30, 16, v191
v_and_b32 v31, 0xffff0000, v191
v_pk_fma_f32 v[24:25], v[24:25], v[66:67], v[66:67] op_sel:[0,0,1] op_sel_hi:[1,0,1]
v_pk_fma_f32 v[26:27], v[26:27], v[66:67], v[66:67] op_sel:[0,0,1] op_sel_hi:[1,0,1]
v_pk_fma_f32 v[28:29], v[28:29], v[66:67], v[66:67] op_sel:[0,0,1] op_sel_hi:[1,0,1]
v_pk_fma_f32 v[30:31], v[30:31], v[66:67], v[66:67] op_sel:[0,0,1] op_sel_hi:[1,0,1]
v_cvt_pk_f16_f32 v188, v24, v25
v_cvt_pk_f16_f32 v189, v26, v27
v_cvt_pk_f16_f32 v190, v28, v29
buffer_load_dwordx4 v234, s[24:27], s48 offen offset:2048 lds
s_add_u32 s48, s48, 81920
v_cvt_pk_f16_f32 v191, v30, v31
v_lshlrev_b32 v24, 16, v192
v_and_b32 v25, 0xffff0000, v192
v_lshlrev_b32 v26, 16, v193
v_and_b32 v27, 0xffff0000, v193
v_lshlrev_b32 v28, 16, v194
v_and_b32 v29, 0xffff0000, v194
v_lshlrev_b32 v30, 16, v195
v_and_b32 v31, 0xffff0000, v195
s_add_u32 m0, s39, 36864
s_nop 0
buffer_load_dwordx4 v232, s[24:27], s48 offen offset:0 lds
v_pk_fma_f32 v[24:25], v[24:25], v[66:67], v[66:67] op_sel:[0,0,1] op_sel_hi:[1,0,1]
v_pk_fma_f32 v[26:27], v[26:27], v[66:67], v[66:67] op_sel:[0,0,1] op_sel_hi:[1,0,1]
v_pk_fma_f32 v[28:29], v[28:29], v[66:67], v[66:67] op_sel:[0,0,1] op_sel_hi:[1,0,1]
v_pk_fma_f32 v[30:31], v[30:31], v[66:67], v[66:67] op_sel:[0,0,1] op_sel_hi:[1,0,1]
v_cvt_pk_f16_f32 v192, v24, v25
v_cvt_pk_f16_f32 v193, v26, v27
v_cvt_pk_f16_f32 v194, v28, v29
v_cvt_pk_f16_f32 v195, v30, v31
v_lshlrev_b32 v24, 16, v196
buffer_load_dwordx4 v233, s[24:27], s48 offen offset:1024 lds
v_and_b32 v25, 0xffff0000, v196
v_lshlrev_b32 v26, 16, v197
v_and_b32 v27, 0xffff0000, v197
v_lshlrev_b32 v28, 16, v198
v_and_b32 v29, 0xffff0000, v198
v_lshlrev_b32 v30, 16, v199
v_and_b32 v31, 0xffff0000, v199
v_pk_fma_f32 v[24:25], v[24:25], v[66:67], v[66:67] op_sel:[0,0,1] op_sel_hi:[1,0,1]
v_pk_fma_f32 v[26:27], v[26:27], v[66:67], v[66:67] op_sel:[0,0,1] op_sel_hi:[1,0,1]
buffer_load_dwordx4 v234, s[24:27], s48 offen offset:2048 lds
s_add_u32 s48, s48, 81920
v_pk_fma_f32 v[28:29], v[28:29], v[66:67], v[66:67] op_sel:[0,0,1] op_sel_hi:[1,0,1]
v_pk_fma_f32 v[30:31], v[30:31], v[66:67], v[66:67] op_sel:[0,0,1] op_sel_hi:[1,0,1]
v_pk_fma_f32 v[80:81], v[80:81], v[66:67], v[66:67] op_sel:[0,0,1] op_sel_hi:[1,0,1]
v_pk_fma_f32 v[82:83], v[82:83], v[66:67], v[66:67] op_sel:[0,0,1] op_sel_hi:[1,0,1]
v_pk_fma_f32 v[180:181], v[180:181], v[66:67], v[66:67] op_sel:[0,0,1] op_sel_hi:[1,0,1]
v_pk_fma_f32 v[182:183], v[182:183], v[66:67], v[66:67] op_sel:[0,0,1] op_sel_hi:[1,0,1]
v_cvt_pk_f16_f32 v196, v24, v25
v_cvt_pk_f16_f32 v197, v26, v27
v_cvt_pk_f16_f32 v198, v28, v29
v_cvt_pk_f16_f32 v199, v30, v31
s_branch L_bodyj
L_ga_retry:
buffer_load_dwordx4 v[40:43], v248, s[4:7], s56 offen sc1
buffer_load_dwordx4 v[44:47], v248, s[4:7], s57 offen sc1
buffer_load_dwordx4 v[48:51], v248, s[4:7], s58 offen sc1
buffer_load_dword v52, v249, s[4:7], s56 offen sc1
buffer_load_dword v53, v249, s[4:7], s57 offen sc1
buffer_load_dword v54, v249, s[4:7], s58 offen sc1
s_waitcnt vmcnt(0)
v_xor_b32 v40, s12, v40
v_xor_b32 v41, s13, v41
v_xor_b32 v42, s14, v42
v_xor_b32 v43, s15, v43
v_xor_b32 v44, s12, v44
v_xor_b32 v45, s13, v45
v_xor_b32 v46, s14, v46
v_xor_b32 v47, s15, v47
v_xor_b32 v48, s12, v48
v_xor_b32 v49, s13, v49
v_xor_b32 v50, s14, v50
v_xor_b32 v51, s15, v51
v_xor_b32 v52, v19, v52
v_xor_b32 v53, v19, v53
v_xor_b32 v54, v19, v54
v_or3_b32 v64, v40, v41, v42
v_or3_b32 v65, v43, v44, v45
v_or3_b32 v64, v64, v46, v47
v_or3_b32 v65, v65, v48, v49
v_or3_b32 v64, v64, v50, v51
v_or3_b32 v65, v65, v52, v53
v_or3_b32 v64, v64, v65, v54
v_and_b32 v64, 0xff, v64
v_cmp_ne_u32 vcc, 0, v64
s_add_u32 s97, s97, 1
s_cmp_gt_u32 s97, 65536
s_cbranch_scc1 L_ga_ok
s_cbranch_vccnz L_ga_retry
s_branch L_ga_ok
L_fg_retry:
buffer_load_dword v71, v247, s[4:7], s60 offen sc1
s_waitcnt vmcnt(0)
v_cmp_ne_u32 vcc, s40, v71
s_add_u32 s97, s97, 1
s_cmp_gt_u32 s97, 65536
s_cbranch_scc1 L_fg_ok
s_cbranch_vccnz L_fg_retry
s_branch L_fg_ok
L_mv_retry:
buffer_load_dwordx2 v[194:195], v231, s[4:7], s23 offen sc1
buffer_load_dwordx4 v[240:243], v238, s[4:7], s51 offen sc1
buffer_load_dwordx4 v[190:193], v238, s[4:7], s22 offen sc1
s_waitcnt vmcnt(0)
v_perm_b32 v36, v241, v240, s55
v_perm_b32 v37, v243, v242, s55
v_xor_b32 v36, s40, v36
v_xor_b32 v37, s40, v37
v_or_b32 v38, v36, v37
v_perm_b32 v36, v191, v190, s55
v_perm_b32 v37, v193, v192, s55
v_xor_b32 v36, s40, v36
v_xor_b32 v37, s40, v37
v_or3_b32 v38, v38, v36, v37
v_and_b32 v38, v38, v230
v_xor_b32 v37, s40, v194
v_or_b32 v38, v38, v37
v_cmp_ne_u32 vcc, 0, v38
s_add_u32 s97, s97, 1
s_cmp_gt_u32 s97, 65536
s_cbranch_scc1 L_mv_ok
s_cbranch_vccnz L_mv_retry
s_branch L_mv_ok
L_o0_retry:
buffer_load_dwordx4 v[100:103], v7, s[4:7], s56 offen offset:0 sc1
buffer_load_dwordx4 v[104:107], v7, s[4:7], s56 offen offset:1024 sc1
buffer_load_dwordx4 v[108:111], v7, s[4:7], s56 offen offset:2048 sc1
buffer_load_dwordx4 v[112:115], v7, s[4:7], s56 offen offset:3072 sc1
buffer_load_dwordx4 v[116:119], v7, s[4:7], s57 offen offset:0 sc1
buffer_load_dwordx4 v[120:123], v7, s[4:7], s57 offen offset:1024 sc1
buffer_load_dwordx4 v[124:127], v7, s[4:7], s57 offen offset:2048 sc1
buffer_load_dwordx4 v[128:131], v7, s[4:7], s57 offen offset:3072 sc1
buffer_load_dwordx4 v[132:135], v7, s[4:7], s58 offen offset:0 sc1
buffer_load_dwordx4 v[136:139], v7, s[4:7], s58 offen offset:1024 sc1
s_waitcnt vmcnt(8)
v_max3_u32 v92, v100, v101, v102
v_max3_u32 v93, v103, v104, v105
v_max3_u32 v92, v92, v106, v107
v_max_u32 v92, v92, v93
v_cmp_eq_u32 vcc, -1, v92
s_add_u32 s97, s97, 1
s_cmp_gt_u32 s97, 65536
s_cbranch_scc1 L_o0_ok
s_cbranch_vccnz L_o0_retry
s_branch L_o0_ok
L_o1_retry:
buffer_load_dwordx4 v[108:111], v7, s[4:7], s56 offen offset:2048 sc1
buffer_load_dwordx4 v[112:115], v7, s[4:7], s56 offen offset:3072 sc1
buffer_load_dwordx4 v[116:119], v7, s[4:7], s57 offen offset:0 sc1
buffer_load_dwordx4 v[120:123], v7, s[4:7], s57 offen offset:1024 sc1
buffer_load_dwordx4 v[124:127], v7, s[4:7], s57 offen offset:2048 sc1
buffer_load_dwordx4 v[128:131], v7, s[4:7], s57 offen offset:3072 sc1
buffer_load_dwordx4 v[132:135], v7, s[4:7], s58 offen offset:0 sc1
buffer_load_dwordx4 v[136:139], v7, s[4:7], s58 offen offset:1024 sc1
buffer_load_dwordx4 v[140:143], v7, s[4:7], s58 offen offset:2048 sc1
buffer_load_dwordx4 v[144:147], v7, s[4:7], s58 offen offset:3072 sc1
s_waitcnt vmcnt(8)
v_max3_u32 v92, v108, v109, v110
v_max3_u32 v93, v111, v112, v113
v_max3_u32 v92, v92, v114, v115
v_max_u32 v92, v92, v93
v_cmp_eq_u32 vcc, -1, v92
s_add_u32 s97, s97, 1
s_cmp_gt_u32 s97, 65536
s_cbranch_scc1 L_o1_ok
s_cbranch_vccnz L_o1_retry
s_branch L_o1_ok
L_o2_retry:
buffer_load_dwordx4 v[116:119], v7, s[4:7], s57 offen offset:0 sc1
buffer_load_dwordx4 v[120:123], v7, s[4:7], s57 offen offset:1024 sc1
buffer_load_dwordx4 v[124:127], v7, s[4:7], s57 offen offset:2048 sc1
buffer_load_dwordx4 v[128:131], v7, s[4:7], s57 offen offset:3072 sc1
buffer_load_dwordx4 v[132:135], v7, s[4:7], s58 offen offset:0 sc1
buffer_load_dwordx4 v[136:139], v7, s[4:7], s58 offen offset:1024 sc1
buffer_load_dwordx4 v[140:143], v7, s[4:7], s58 offen offset:2048 sc1
buffer_load_dwordx4 v[144:147], v7, s[4:7], s58 offen offset:3072 sc1
buffer_load_dwordx4 v[148:151], v7, s[4:7], s59 offen offset:0 sc1
buffer_load_dwordx4 v[152:155], v7, s[4:7], s59 offen offset:1024 sc1
s_waitcnt vmcnt(8)
v_max3_u32 v92, v116, v117, v118
v_max3_u32 v93, v119, v120, v121
v_max3_u32 v92, v92, v122, v123
v_max_u32 v92, v92, v93
v_cmp_eq_u32 vcc, -1, v92
s_add_u32 s97, s97, 1
s_cmp_gt_u32 s97, 65536
s_cbranch_scc1 L_o2_ok
s_cbranch_vccnz L_o2_retry
s_branch L_o2_ok
L_o3_retry:
buffer_load_dwordx4 v[124:127], v7, s[4:7], s57 offen offset:2048 sc1
buffer_load_dwordx4 v[128:131], v7, s[4:7], s57 offen offset:3072 sc1
buffer_load_dwordx4 v[132:135], v7, s[4:7], s58 offen offset:0 sc1
buffer_load_dwordx4 v[136:139], v7, s[4:7], s58 offen offset:1024 sc1
buffer_load_dwordx4 v[140:143], v7, s[4:7], s58 offen offset:2048 sc1
buffer_load_dwordx4 v[144:147], v7, s[4:7], s58 offen offset:3072 sc1
buffer_load_dwordx4 v[148:151], v7, s[4:7], s59 offen offset:0 sc1
buffer_load_dwordx4 v[152:155], v7, s[4:7], s59 offen offset:1024 sc1
buffer_load_dwordx4 v[156:159], v7, s[4:7], s59 offen offset:2048 sc1
buffer_load_dwordx4 v[160:163], v7, s[4:7], s59 offen offset:3072 sc1
s_waitcnt vmcnt(8)
v_max3_u32 v92, v124, v125, v126
v_max3_u32 v93, v127, v128, v129
v_max3_u32 v92, v92, v130, v131
v_max_u32 v92, v92, v93
v_cmp_eq_u32 vcc, -1, v92
s_add_u32 s97, s97, 1
s_cmp_gt_u32 s97, 65536
s_cbranch_scc1 L_o3_ok
s_cbranch_vccnz L_o3_retry
s_branch L_o3_ok
L_o4_retry:
buffer_load_dwordx4 v[132:135], v7, s[4:7], s58 offen offset:0 sc1
buffer_load_dwordx4 v[136:139], v7, s[4:7], s58 offen offset:1024 sc1
buffer_load_dwordx4 v[140:143], v7, s[4:7], s58 offen offset:2048 sc1
buffer_load_dwordx4 v[144:147], v7, s[4:7], s58 offen offset:3072 sc1
buffer_load_dwordx4 v[148:151], v7, s[4:7], s59 offen offset:0 sc1
buffer_load_dwordx4 v[152:155], v7, s[4:7], s59 offen offset:1024 sc1
buffer_load_dwordx4 v[156:159], v7, s[4:7], s59 offen offset:2048 sc1
buffer_load_dwordx4 v[160:163], v7, s[4:7], s59 offen offset:3072 sc1
buffer_load_dwordx4 v[164:167], v7, s[4:7], s60 offen offset:0 sc1
buffer_load_dwordx4 v[168:171], v7, s[4:7], s60 offen offset:1024 sc1
s_waitcnt vmcnt(8)
v_max3_u32 v92, v132, v133, v134
v_max3_u32 v93, v135, v136, v137
v_max3_u32 v92, v92, v138, v139
v_max_u32 v92, v92, v93
v_cmp_eq_u32 vcc, -1, v92
s_add_u32 s97, s97, 1
s_cmp_gt_u32 s97, 65536
s_cbranch_scc1 L_o4_ok
s_cbranch_vccnz L_o4_retry
s_branch L_o4_ok
L_o5_retry:
buffer_load_dwordx4 v[140:143], v7, s[4:7], s58 offen offset:2048 sc1
buffer_load_dwordx4 v[144:147], v7, s[4:7], s58 offen offset:3072 sc1
buffer_load_dwordx4 v[148:151], v7, s[4:7], s59 offen offset:0 sc1
buffer_load_dwordx4 v[152:155], v7, s[4:7], s59 offen offset:1024 sc1
buffer_load_dwordx4 v[156:159], v7, s[4:7], s59 offen offset:2048 sc1
buffer_load_dwordx4 v[160:163], v7, s[4:7], s59 offen offset:3072 sc1
buffer_load_dwordx4 v[164:167], v7, s[4:7], s60 offen offset:0 sc1
buffer_load_dwordx4 v[168:171], v7, s[4:7], s60 offen offset:1024 sc1
buffer_load_dwordx4 v[172:175], v7, s[4:7], s60 offen offset:2048 sc1
buffer_load_dwordx4 v[176:179], v7, s[4:7], s60 offen offset:3072 sc1
s_waitcnt vmcnt(8)
v_max3_u32 v92, v140, v141, v142
v_max3_u32 v93, v143, v144, v145
v_max3_u32 v92, v92, v146, v147
v_max_u32 v92, v92, v93
v_cmp_eq_u32 vcc, -1, v92
s_add_u32 s97, s97, 1
s_cmp_gt_u32 s97, 65536
s_cbranch_scc1 L_o5_ok
s_cbranch_vccnz L_o5_retry
s_branch L_o5_ok
L_o6_retry:
buffer_load_dwordx4 v[148:151], v7, s[4:7], s59 offen offset:0 sc1
buffer_load_dwordx4 v[152:155], v7, s[4:7], s59 offen offset:1024 sc1
buffer_load_dwordx4 v[156:159], v7, s[4:7], s59 offen offset:2048 sc1
buffer_load_dwordx4 v[160:163], v7, s[4:7], s59 offen offset:3072 sc1
buffer_load_dwordx4 v[164:167], v7, s[4:7], s60 offen offset:0 sc1
buffer_load_dwordx4 v[168:171], v7, s[4:7], s60 offen offset:1024 sc1
buffer_load_dwordx4 v[172:175], v7, s[4:7], s60 offen offset:2048 sc1
buffer_load_dwordx4 v[176:179], v7, s[4:7], s60 offen offset:3072 sc1
s_waitcnt vmcnt(6)
v_max3_u32 v92, v148, v149, v150
v_max3_u32 v93, v151, v152, v153
v_max3_u32 v92, v92, v154, v155
v_max_u32 v92, v92, v93
v_cmp_eq_u32 vcc, -1, v92
s_add_u32 s97, s97, 1
s_cmp_gt_u32 s97, 65536
s_cbranch_scc1 L_o6_ok
s_cbranch_vccnz L_o6_retry
s_branch L_o6_ok
L_o7_retry:
buffer_load_dwordx4 v[156:159], v7, s[4:7], s59 offen offset:2048 sc1
buffer_load_dwordx4 v[160:163], v7, s[4:7], s59 offen offset:3072 sc1
buffer_load_dwordx4 v[164:167], v7, s[4:7], s60 offen offset:0 sc1
buffer_load_dwordx4 v[168:171], v7, s[4:7], s60 offen offset:1024 sc1
buffer_load_dwordx4 v[172:175], v7, s[4:7], s60 offen offset:2048 sc1
buffer_load_dwordx4 v[176:179], v7, s[4:7], s60 offen offset:3072 sc1
s_waitcnt vmcnt(4)
v_max3_u32 v92, v156, v157, v158
v_max3_u32 v93, v159, v160, v161
v_max3_u32 v92, v92, v162, v163
v_max_u32 v92, v92, v93
v_cmp_eq_u32 vcc, -1, v92
s_add_u32 s97, s97, 1
s_cmp_gt_u32 s97, 65536
s_cbranch_scc1 L_o7_ok
s_cbranch_vccnz L_o7_retry
s_branch L_o7_ok
L_o8_retry:
buffer_load_dwordx4 v[164:167], v7, s[4:7], s60 offen offset:0 sc1
buffer_load_dwordx4 v[168:171], v7, s[4:7], s60 offen offset:1024 sc1
buffer_load_dwordx4 v[172:175], v7, s[4:7], s60 offen offset:2048 sc1
buffer_load_dwordx4 v[176:179], v7, s[4:7], s60 offen offset:3072 sc1
s_waitcnt vmcnt(2)
v_max3_u32 v92, v164, v165, v166
v_max3_u32 v93, v167, v168, v169
v_max3_u32 v92, v92, v170, v171
v_max_u32 v92, v92, v93
v_cmp_eq_u32 vcc, -1, v92
s_add_u32 s97, s97, 1
s_cmp_gt_u32 s97, 65536
s_cbranch_scc1 L_o8_ok
s_cbranch_vccnz L_o8_retry
s_branch L_o8_ok
L_o9_retry:
buffer_load_dwordx4 v[172:175], v7, s[4:7], s60 offen offset:2048 sc1
buffer_load_dwordx4 v[176:179], v7, s[4:7], s60 offen offset:3072 sc1
s_waitcnt vmcnt(0)
v_max3_u32 v92, v172, v173, v174
v_max3_u32 v93, v175, v176, v177
v_max3_u32 v92, v92, v178, v179
v_max_u32 v92, v92, v93
v_cmp_eq_u32 vcc, -1, v92
s_add_u32 s97, s97, 1
s_cmp_gt_u32 s97, 65536
s_cbranch_scc1 L_o9_ok
s_cbranch_vccnz L_o9_retry
s_branch L_o9_ok
L_st_slow:
buffer_store_dword v44, v0, s[4:7], s57 offen sc1
s_branch L_st_j
L_svc:
s_sub_u32 s44, s2, 224
v_lshlrev_b32 v28, 3, v0
s_waitcnt lgkmcnt(0)
s_mov_b32 s16, s22
s_mov_b32 s17, s23
s_mov_b32 s22, 1280
s_mov_b32 s23, 0x20000
buffer_load_dwordx2 v[40:41], v28, s[20:23], 0 offen
buffer_load_dword v42, v29, s[4:7], 0 offen sc1
s_load_dwordx2 s[8:9], s[0:1], 40
s_load_dwordx2 s[12:13], s[0:1], 48
s_load_dwordx2 s[36:37], s[0:1], 56
s_load_dwordx2 s[24:25], s[0:1], 16
s_load_dwordx2 s[28:29], s[0:1], 32
s_load_dwordx2 s[32:33], s[0:1], 80
s_mov_b32 s18, 4915200
s_mov_b32 s19, 0x20000
s_mov_b32 s26, 819200
s_mov_b32 s27, 0x20000
s_mov_b32 s30, 1280
s_mov_b32 s31, 0x20000
s_mov_b32 s34, 2621440
s_mov_b32 s35, 0x20000
s_mov_b32 s10, 2211840
s_mov_b32 s11, 0x20000
s_mov_b32 s14, 2211840
s_mov_b32 s15, 0x20000
s_mov_b32 s38, 2211840
s_mov_b32 s39, 0x20000
v_bfe_u32 v32, v1, 2, 2
v_lshrrev_b32 v33, 1, v32
v_and_b32 v34, 1, v3
v_lshl_or_b32 v33, v34, 1, v33
v_xor_b32 v33, s3, v33
v_and_b32 v34, 3, v1
v_lshlrev_b32 v34, 3, v34
v_lshl_add_u32 v33, v33, 5, v34
v_lshl_add_u32 v32, v3, 3, v32
v_lshl_add_u32 v6, v32, 7, v33
s_mov_b32 s97, 0
s_mov_b32 s98, 0x0c0c0400
s_mov_b32 s99, 0x04000c0c
v_add_u32 v7, 40960, v6
v_add_u32 v9, 81920, v6
v_add_u32 v10, 81920+40960, v6
s_mul_i32 s55, s3, 320
s_add_u32 s55, s55, 81920
v_mul_u32_u24 v32, 1280, v32
v_add3_u32 v11, v32, v34, s55
s_and_b32 s55, s3, 1
s_lshl_b32 s55, s55, 2
v_and_b32 v30, 1, v3
v_lshl_or_b32 v30, v30, 1, s55
v_and_b32 v31, 7, v1
v_xor_b32 v31, v30, v31
v_lshlrev_b32 v31, 4, v31
v_lshrrev_b32 v30, 3, v1
v_mad_u32_u24 v4, v30, 60, 0
v_lshl_add_u32 v4, v4, 7, v31
v_mad_u32_u24 v5, v30, 27, 0
v_lshl_add_u32 v5, v5, 7, v31
v_lshlrev_b32 v8, 4, v1
v_lshlrev_b32 v12, 2, v1
v_mov_b32 v255, 1073741824
s_lshr_b32 s101, s42, 2
s_xor_b32 s101, s101, 0
s_mul_i32 s101, s101, 8192
s_add_u32 s100, s101, 7733248
s_waitcnt lgkmcnt(0)
s_cmp_ge_u32 s44, 27
s_cbranch_scc1 L_fz
s_lshl_b32 s55, s44, 2
s_add_u32 s55, s55, s3
s_mul_i32 s55, s55, 7680
v_lshlrev_b32 v33, 7, v1
s_mov_b32 exec_hi, 0xfffffff
buffer_load_dword v184, v33, s[24:27], s55 offen
s_mov_b32 exec_hi, -1
s_lshl_b32 s50, s44, 7
s_mul_i32 s55, s3, 61440
s_add_u32 s50, s50, s55
s_add_u32 s50, s50, 2560
s_add_u32 m0, s49, 0
s_nop 0
buffer_load_dwordx4 v4, s[16:19], s50 offen nt lds
s_add_u32 m0, m0, 4096
s_add_u32 s50, s50, 245760
buffer_load_dwordx4 v4, s[16:19], s50 offen nt lds
s_add_u32 m0, m0, 4096
s_add_u32 s50, s50, 245760
buffer_load_dwordx4 v4, s[16:19], s50 offen nt lds
s_add_u32 m0, m0, 4096
s_add_u32 s50, s50, 245760
buffer_load_dwordx4 v4, s[16:19], s50 offen nt lds
s_add_u32 m0, m0, 4096
s_add_u32 s50, s50, 245760
buffer_load_dwordx4 v4, s[16:19], s50 offen nt lds
s_add_u32 m0, m0, 4096
s_add_u32 s50, s50, 245760
buffer_load_dwordx4 v4, s[16:19], s50 offen nt lds
s_add_u32 m0, m0, 4096
s_add_u32 s50, s50, 245760
buffer_load_dwordx4 v4, s[16:19], s50 offen nt lds
s_add_u32 m0, m0, 4096
s_add_u32 s50, s50, 245760
buffer_load_dwordx4 v4, s[16:19], s50 offen nt lds
s_add_u32 m0, m0, 4096
s_add_u32 s50, s50, 245760
buffer_load_dwordx4 v4, s[16:19], s50 offen nt lds
s_add_u32 m0, m0, 4096
s_add_u32 s50, s50, 245760
buffer_load_dwordx4 v4, s[16:19], s50 offen nt lds
s_add_u32 m0, m0, 4096
s_add_u32 s50, s50, 245760
buffer_load_dwordx4 v4, s[16:19], s50 offen nt lds
s_add_u32 m0, m0, 4096
s_add_u32 s50, s50, 245760
buffer_load_dwordx4 v4, s[16:19], s50 offen nt lds
s_add_u32 m0, m0, 4096
s_add_u32 s50, s50, 245760
buffer_load_dwordx4 v4, s[16:19], s50 offen nt lds
s_add_u32 m0, m0, 4096
s_add_u32 s50, s50, 245760
buffer_load_dwordx4 v4, s[16:19], s50 offen nt lds
s_add_u32 m0, m0, 4096
s_add_u32 s50, s50, 245760
buffer_load_dwordx4 v4, s[16:19], s50 offen nt lds
s_add_u32 m0, m0, 4096
s_add_u32 s50, s50, 245760
buffer_load_dwordx4 v4, s[16:19], s50 offen nt lds
s_add_u32 m0, m0, 4096
s_add_u32 s50, s50, 245760
buffer_load_dwordx4 v4, s[16:19], s50 offen nt lds
s_add_u32 m0, m0, 4096
s_add_u32 s50, s50, 245760
buffer_load_dwordx4 v4, s[16:19], s50 offen nt lds
s_add_u32 m0, m0, 4096
s_add_u32 s50, s50, 245760
buffer_load_dwordx4 v4, s[16:19], s50 offen nt lds
s_add_u32 m0, m0, 4096
s_add_u32 s50, s50, 245760
buffer_load_dwordx4 v4, s[16:19], s50 offen nt lds
s_waitcnt vmcnt(21)
v_readfirstlane_b32 s41, v42
v_lshlrev_b32 v44, 16, v40
v_and_b32 v45, 0xffff0000, v40
v_lshlrev_b32 v46, 16, v41
v_and_b32 v47, 0xffff0000, v41
v_mul_f32 v48, 0xbfb8aa3b, v44
v_mul_f32 v49, 0xbfb8aa3b, v45
v_mul_f32 v50, 0xbfb8aa3b, v46
v_mul_f32 v51, 0xbfb8aa3b, v47
v_exp_f32 v48, v48
v_exp_f32 v49, v49
v_exp_f32 v50, v50
v_exp_f32 v51, v51
v_add_f32 v48, 1.0, v48
v_add_f32 v49, 1.0, v49
v_add_f32 v50, 1.0, v50
v_add_f32 v51, 1.0, v51
v_rcp_f32 v48, v48
v_rcp_f32 v49, v49
v_rcp_f32 v50, v50
v_rcp_f32 v51, v51
v_mul_f32 v44, v44, v48
v_mul_f32 v45, v45, v49
v_mul_f32 v46, v46, v50
v_mul_f32 v47, v47, v51
v_cvt_pk_bf16_f32 v40, v44, v45
v_cvt_pk_bf16_f32 v41, v46, v47
v_add_u32 v28, 99840, v28
ds_write_b64 v28, v[40:41]
v_lshlrev_b32 v28, 4, v3
v_add_u32 v28, 99840, v28
s_mul_i32 s40, s41, 0x9E3779B1
s_add_u32 s40, s40, 0x85EBCA6B
v_and_b32 v33, 3, v1
v_lshlrev_b32 v33, 3, v33
v_lshrrev_b32 v19, v33, s40
v_and_b32 v19, 0xff, v19
v_mov_b32 v240, s40
v_mov_b32 v241, s19
v_mov_b32 v242, s40
v_mov_b32 v243, s40
v_and_b32 v30, 1, v1
v_lshlrev_b32 v30, 4, v30
v_lshrrev_b32 v13, v30, s40
v_and_b32 v13, 0xffff, v13
s_waitcnt lgkmcnt(0)
s_barrier
ds_read_b128 v[100:103], v28 offset:0
ds_read_b128 v[104:107], v28 offset:64
ds_read_b128 v[108:111], v28 offset:128
ds_read_b128 v[112:115], v28 offset:192
ds_read_b128 v[116:119], v28 offset:256
ds_read_b128 v[120:123], v28 offset:320
ds_read_b128 v[124:127], v28 offset:384
ds_read_b128 v[128:131], v28 offset:448
ds_read_b128 v[132:135], v28 offset:512
ds_read_b128 v[136:139], v28 offset:576
ds_read_b128 v[140:143], v28 offset:640
ds_read_b128 v[144:147], v28 offset:704
ds_read_b128 v[148:151], v28 offset:768
ds_read_b128 v[152:155], v28 offset:832
ds_read_b128 v[156:159], v28 offset:896
ds_read_b128 v[160:163], v28 offset:960
ds_read_b128 v[164:167], v28 offset:1024
ds_read_b128 v[168:171], v28 offset:1088
ds_read_b128 v[172:175], v28 offset:1152
ds_read_b128 v[176:179], v28 offset:1216
s_waitcnt lgkmcnt(0)
s_barrier
s_lshl_b32 s60, s44, 10
s_andn2_b32 s61, s60, 0x1fff
s_add_u32 s60, s60, s61
s_add_u32 s60, s60, 8126464
s_add_u32 s61, s60, 8192
v_cmp_gt_u32 vcc, 64, v0
s_nop 1
v_cndmask_b32 v30, v255, v8, vcc
buffer_store_dwordx4 v[240:243], v30, s[4:7], s60 offen sc1
buffer_store_dwordx4 v[240:243], v30, s[4:7], s61 offen sc1
s_lshl_b32 s51, s44, 7
s_mul_i32 s55, s3, 27648
s_add_u32 s51, s51, s55
s_mov_b32 s52, s51
s_add_u32 m0, s49, 81920
s_nop 0
buffer_load_dwordx4 v5, s[8:11], s51 offen nt lds
s_add_u32 m0, m0, 4096
s_add_u32 s51, s51, 110592
buffer_load_dwordx4 v5, s[8:11], s51 offen nt lds
s_add_u32 m0, m0, 4096
s_add_u32 s51, s51, 110592
buffer_load_dwordx4 v5, s[8:11], s51 offen nt lds
s_add_u32 m0, m0, 4096
s_add_u32 s51, s51, 110592
buffer_load_dwordx4 v5, s[8:11], s51 offen nt lds
s_add_u32 m0, m0, 4096
s_add_u32 s51, s51, 110592
buffer_load_dwordx4 v5, s[8:11], s51 offen nt lds
s_add_u32 m0, m0, 4096
s_add_u32 s51, s51, 110592
buffer_load_dwordx4 v5, s[8:11], s51 offen nt lds
s_add_u32 m0, m0, 4096
s_add_u32 s51, s51, 110592
buffer_load_dwordx4 v5, s[8:11], s51 offen nt lds
s_add_u32 m0, m0, 4096
s_add_u32 s51, s51, 110592
buffer_load_dwordx4 v5, s[8:11], s51 offen nt lds
s_add_u32 m0, m0, 4096
s_add_u32 s51, s51, 110592
buffer_load_dwordx4 v5, s[8:11], s51 offen nt lds
s_add_u32 m0, m0, 4096
s_add_u32 s51, s51, 110592
buffer_load_dwordx4 v5, s[8:11], s51 offen nt lds
s_add_u32 m0, m0, 4096
s_add_u32 s51, s51, 110592
buffer_load_dwordx4 v5, s[8:11], s51 offen nt lds
s_add_u32 m0, m0, 4096
s_add_u32 s51, s51, 110592
buffer_load_dwordx4 v5, s[8:11], s51 offen nt lds
s_add_u32 m0, m0, 4096
s_add_u32 s51, s51, 110592
buffer_load_dwordx4 v5, s[8:11], s51 offen nt lds
s_add_u32 m0, m0, 4096
s_add_u32 s51, s51, 110592
buffer_load_dwordx4 v5, s[8:11], s51 offen nt lds
s_add_u32 m0, m0, 4096
s_add_u32 s51, s51, 110592
buffer_load_dwordx4 v5, s[8:11], s51 offen nt lds
s_add_u32 m0, m0, 4096
s_add_u32 s51, s51, 110592
buffer_load_dwordx4 v5, s[8:11], s51 offen nt lds
s_add_u32 m0, m0, 4096
s_add_u32 s51, s51, 110592
buffer_load_dwordx4 v5, s[8:11], s51 offen nt lds
s_add_u32 m0, m0, 4096
s_add_u32 s51, s51, 110592
buffer_load_dwordx4 v5, s[8:11], s51 offen nt lds
s_add_u32 m0, m0, 4096
s_add_u32 s51, s51, 110592
buffer_load_dwordx4 v5, s[8:11], s51 offen nt lds
s_add_u32 m0, m0, 4096
s_add_u32 s51, s51, 110592
buffer_load_dwordx4 v5, s[8:11], s51 offen nt lds
s_waitcnt vmcnt(22)
s_barrier
ds_read_b64_tr_b16 v[20:21], v6 offset:0
ds_read_b64_tr_b16 v[22:23], v6 offset:512
ds_read_b64_tr_b16 v[24:25], v6 offset:4096
ds_read_b64_tr_b16 v[26:27], v6 offset:4608
ds_read_b64_tr_b16 v[28:29], v6 offset:8192
ds_read_b64_tr_b16 v[30:31], v6 offset:8704
ds_read_b64_tr_b16 v[32:33], v6 offset:12288
ds_read_b64_tr_b16 v[34:35], v6 offset:12800
ds_read_b64_tr_b16 v[36:37], v6 offset:16384
ds_read_b64_tr_b16 v[38:39], v6 offset:16896
ds_read_b64_tr_b16 v[40:41], v6 offset:20480
ds_read_b64_tr_b16 v[42:43], v6 offset:20992
ds_read_b64_tr_b16 v[44:45], v6 offset:24576
ds_read_b64_tr_b16 v[46:47], v6 offset:25088
ds_read_b64_tr_b16 v[48:49], v6 offset:28672
ds_read_b64_tr_b16 v[50:51], v6 offset:29184
ds_read_b64_tr_b16 v[52:53], v6 offset:32768
ds_read_b64_tr_b16 v[54:55], v6 offset:33280
ds_read_b64_tr_b16 v[56:57], v6 offset:36864
ds_read_b64_tr_b16 v[58:59], v6 offset:37376
ds_read_b64_tr_b16 v[60:61], v7 offset:0
ds_read_b64_tr_b16 v[62:63], v7 offset:512
ds_read_b64_tr_b16 v[64:65], v7 offset:4096
ds_read_b64_tr_b16 v[66:67], v7 offset:4608
ds_read_b64_tr_b16 v[68:69], v7 offset:8192
ds_read_b64_tr_b16 v[70:71], v7 offset:8704
ds_read_b64_tr_b16 v[72:73], v7 offset:12288
ds_read_b64_tr_b16 v[74:75], v7 offset:12800
ds_read_b64_tr_b16 v[76:77], v7 offset:16384
ds_read_b64_tr_b16 v[78:79], v7 offset:16896
ds_read_b64_tr_b16 v[80:81], v7 offset:20480
ds_read_b64_tr_b16 v[82:83], v7 offset:20992
ds_read_b64_tr_b16 v[84:85], v7 offset:24576
ds_read_b64_tr_b16 v[86:87], v7 offset:25088
ds_read_b64_tr_b16 v[88:89], v7 offset:28672
ds_read_b64_tr_b16 v[90:91], v7 offset:29184
ds_read_b64_tr_b16 v[92:93], v7 offset:32768
ds_read_b64_tr_b16 v[94:95], v7 offset:33280
ds_read_b64_tr_b16 v[96:97], v7 offset:36864
ds_read_b64_tr_b16 v[98:99], v7 offset:37376
s_waitcnt lgkmcnt(0)
s_barrier
v_mfma_f32_16x16x32_bf16 v[180:183], v[100:103], v[20:23], 0
v_mfma_f32_16x16x32_bf16 v[180:183], v[104:107], v[24:27], v[180:183]
v_mfma_f32_16x16x32_bf16 v[180:183], v[108:111], v[28:31], v[180:183]
v_mfma_f32_16x16x32_bf16 v[180:183], v[112:115], v[32:35], v[180:183]
v_mfma_f32_16x16x32_bf16 v[180:183], v[116:119], v[36:39], v[180:183]
v_mfma_f32_16x16x32_bf16 v[180:183], v[120:123], v[40:43], v[180:183]
v_mfma_f32_16x16x32_bf16 v[180:183], v[124:127], v[44:47], v[180:183]
v_mfma_f32_16x16x32_bf16 v[180:183], v[128:131], v[48:51], v[180:183]
v_mfma_f32_16x16x32_bf16 v[180:183], v[132:135], v[52:55], v[180:183]
v_mfma_f32_16x16x32_bf16 v[180:183], v[136:139], v[56:59], v[180:183]
v_mfma_f32_16x16x32_bf16 v[180:183], v[140:143], v[60:63], v[180:183]
v_mfma_f32_16x16x32_bf16 v[180:183], v[144:147], v[64:67], v[180:183]
v_mfma_f32_16x16x32_bf16 v[180:183], v[148:151], v[68:71], v[180:183]
v_mfma_f32_16x16x32_bf16 v[180:183], v[152:155], v[72:75], v[180:183]
v_mfma_f32_16x16x32_bf16 v[180:183], v[156:159], v[76:79], v[180:183]
v_mfma_f32_16x16x32_bf16 v[180:183], v[160:163], v[80:83], v[180:183]
v_mfma_f32_16x16x32_bf16 v[180:183], v[164:167], v[84:87], v[180:183]
v_mfma_f32_16x16x32_bf16 v[180:183], v[168:171], v[88:91], v[180:183]
v_mfma_f32_16x16x32_bf16 v[180:183], v[172:175], v[92:95], v[180:183]
v_mfma_f32_16x16x32_bf16 v[180:183], v[176:179], v[96:99], v[180:183]
s_sub_u32 s55, s44, 20
s_cmp_lt_u32 s55, 10
s_cselect_b32 s55, 1.0, 0
s_lshl_b32 s56, s44, 8
s_lshl_b32 s57, s3, 6
s_add_u32 s56, s56, s57
s_add_u32 s56, s56, 65536
s_nop 0
v_cvt_pk_bf16_f32 v180, v180, v180
v_lshlrev_b32 v180, 16, v180
v_add_f32 v180, s55, v180
v_cvt_pk_bf16_f32 v180, v180, v180
v_lshl_or_b32 v180, v180, 16, v13
s_mov_b64 exec, 0xffff
buffer_store_dword v180, v12, s[4:7], s56 offen sc1
s_mov_b64 exec, -1
s_add_u32 m0, s49, 0
s_nop 0
buffer_load_dwordx4 v5, s[12:15], s52 offen nt lds
s_add_u32 m0, m0, 4096
s_add_u32 s52, s52, 110592
buffer_load_dwordx4 v5, s[12:15], s52 offen nt lds
s_add_u32 m0, m0, 4096
s_add_u32 s52, s52, 110592
buffer_load_dwordx4 v5, s[12:15], s52 offen nt lds
s_add_u32 m0, m0, 4096
s_add_u32 s52, s52, 110592
buffer_load_dwordx4 v5, s[12:15], s52 offen nt lds
s_add_u32 m0, m0, 4096
s_add_u32 s52, s52, 110592
buffer_load_dwordx4 v5, s[12:15], s52 offen nt lds
s_add_u32 m0, m0, 4096
s_add_u32 s52, s52, 110592
buffer_load_dwordx4 v5, s[12:15], s52 offen nt lds
s_add_u32 m0, m0, 4096
s_add_u32 s52, s52, 110592
buffer_load_dwordx4 v5, s[12:15], s52 offen nt lds
s_add_u32 m0, m0, 4096
s_add_u32 s52, s52, 110592
buffer_load_dwordx4 v5, s[12:15], s52 offen nt lds
s_add_u32 m0, m0, 4096
s_add_u32 s52, s52, 110592
buffer_load_dwordx4 v5, s[12:15], s52 offen nt lds
s_add_u32 m0, m0, 4096
s_add_u32 s52, s52, 110592
buffer_load_dwordx4 v5, s[12:15], s52 offen nt lds
s_add_u32 m0, m0, 4096
s_add_u32 s52, s52, 110592
buffer_load_dwordx4 v5, s[12:15], s52 offen nt lds
s_add_u32 m0, m0, 4096
s_add_u32 s52, s52, 110592
buffer_load_dwordx4 v5, s[12:15], s52 offen nt lds
s_add_u32 m0, m0, 4096
s_add_u32 s52, s52, 110592
buffer_load_dwordx4 v5, s[12:15], s52 offen nt lds
s_add_u32 m0, m0, 4096
s_add_u32 s52, s52, 110592
buffer_load_dwordx4 v5, s[12:15], s52 offen nt lds
s_add_u32 m0, m0, 4096
s_add_u32 s52, s52, 110592
buffer_load_dwordx4 v5, s[12:15], s52 offen nt lds
s_add_u32 m0, m0, 4096
s_add_u32 s52, s52, 110592
buffer_load_dwordx4 v5, s[12:15], s52 offen nt lds
s_add_u32 m0, m0, 4096
s_add_u32 s52, s52, 110592
buffer_load_dwordx4 v5, s[12:15], s52 offen nt lds
s_add_u32 m0, m0, 4096
s_add_u32 s52, s52, 110592
buffer_load_dwordx4 v5, s[12:15], s52 offen nt lds
s_add_u32 m0, m0, 4096
s_add_u32 s52, s52, 110592
buffer_load_dwordx4 v5, s[12:15], s52 offen nt lds
s_add_u32 m0, m0, 4096
s_add_u32 s52, s52, 110592
buffer_load_dwordx4 v5, s[12:15], s52 offen nt lds
s_waitcnt vmcnt(21)
s_barrier
ds_read_b64_tr_b16 a[0:1], v9 offset:0
ds_read_b64_tr_b16 a[2:3], v9 offset:512
ds_read_b64_tr_b16 a[4:5], v9 offset:4096
ds_read_b64_tr_b16 a[6:7], v9 offset:4608
ds_read_b64_tr_b16 a[8:9], v9 offset:8192
ds_read_b64_tr_b16 a[10:11], v9 offset:8704
ds_read_b64_tr_b16 a[12:13], v9 offset:12288
ds_read_b64_tr_b16 a[14:15], v9 offset:12800
ds_read_b64_tr_b16 a[16:17], v9 offset:16384
ds_read_b64_tr_b16 a[18:19], v9 offset:16896
ds_read_b64_tr_b16 a[20:21], v9 offset:20480
ds_read_b64_tr_b16 a[22:23], v9 offset:20992
ds_read_b64_tr_b16 a[24:25], v9 offset:24576
ds_read_b64_tr_b16 a[26:27], v9 offset:25088
ds_read_b64_tr_b16 a[28:29], v9 offset:28672
ds_read_b64_tr_b16 a[30:31], v9 offset:29184
ds_read_b64_tr_b16 a[32:33], v9 offset:32768
ds_read_b64_tr_b16 a[34:35], v9 offset:33280
ds_read_b64_tr_b16 a[36:37], v9 offset:36864
ds_read_b64_tr_b16 a[38:39], v9 offset:37376
ds_read_b64_tr_b16 a[40:41], v10 offset:0
ds_read_b64_tr_b16 a[42:43], v10 offset:512
ds_read_b64_tr_b16 a[44:45], v10 offset:4096
ds_read_b64_tr_b16 a[46:47], v10 offset:4608
ds_read_b64_tr_b16 a[48:49], v10 offset:8192
ds_read_b64_tr_b16 a[50:51], v10 offset:8704
ds_read_b64_tr_b16 a[52:53], v10 offset:12288
ds_read_b64_tr_b16 a[54:55], v10 offset:12800
ds_read_b64_tr_b16 a[56:57], v10 offset:16384
ds_read_b64_tr_b16 a[58:59], v10 offset:16896
ds_read_b64_tr_b16 a[60:61], v10 offset:20480
ds_read_b64_tr_b16 a[62:63], v10 offset:20992
ds_read_b64_tr_b16 a[64:65], v10 offset:24576
ds_read_b64_tr_b16 a[66:67], v10 offset:25088
ds_read_b64_tr_b16 a[68:69], v10 offset:28672
ds_read_b64_tr_b16 a[70:71], v10 offset:29184
ds_read_b64_tr_b16 a[72:73], v10 offset:32768
ds_read_b64_tr_b16 a[74:75], v10 offset:33280
ds_read_b64_tr_b16 a[76:77], v10 offset:36864
ds_read_b64_tr_b16 a[78:79], v10 offset:37376
s_waitcnt lgkmcnt(0)
s_barrier
s_mul_i32 s51, s44, 81920
s_add_u32 s51, s51, s49
s_add_u32 m0, s49, 81920
s_nop 0
buffer_load_dwordx4 v8, s[36:39], s51 offen nt lds
s_add_u32 m0, m0, 4096
s_add_u32 s51, s51, 4096
buffer_load_dwordx4 v8, s[36:39], s51 offen nt lds
s_add_u32 m0, m0, 4096
s_add_u32 s51, s51, 4096
buffer_load_dwordx4 v8, s[36:39], s51 offen nt lds
s_add_u32 m0, m0, 4096
s_add_u32 s51, s51, 4096
buffer_load_dwordx4 v8, s[36:39], s51 offen nt lds
s_add_u32 m0, m0, 4096
s_add_u32 s51, s51, 4096
buffer_load_dwordx4 v8, s[36:39], s51 offen nt lds
s_add_u32 m0, m0, 4096
s_add_u32 s51, s51, 4096
buffer_load_dwordx4 v8, s[36:39], s51 offen nt lds
s_add_u32 m0, m0, 4096
s_add_u32 s51, s51, 4096
buffer_load_dwordx4 v8, s[36:39], s51 offen nt lds
s_add_u32 m0, m0, 4096
s_add_u32 s51, s51, 4096
buffer_load_dwordx4 v8, s[36:39], s51 offen nt lds
s_add_u32 m0, m0, 4096
s_add_u32 s51, s51, 4096
buffer_load_dwordx4 v8, s[36:39], s51 offen nt lds
s_add_u32 m0, m0, 4096
s_add_u32 s51, s51, 4096
buffer_load_dwordx4 v8, s[36:39], s51 offen nt lds
s_add_u32 m0, m0, 4096
s_add_u32 s51, s51, 4096
buffer_load_dwordx4 v8, s[36:39], s51 offen nt lds
s_add_u32 m0, m0, 4096
s_add_u32 s51, s51, 4096
buffer_load_dwordx4 v8, s[36:39], s51 offen nt lds
s_add_u32 m0, m0, 4096
s_add_u32 s51, s51, 4096
buffer_load_dwordx4 v8, s[36:39], s51 offen nt lds
s_add_u32 m0, m0, 4096
s_add_u32 s51, s51, 4096
buffer_load_dwordx4 v8, s[36:39], s51 offen nt lds
s_add_u32 m0, m0, 4096
s_add_u32 s51, s51, 4096
buffer_load_dwordx4 v8, s[36:39], s51 offen nt lds
s_add_u32 m0, m0, 4096
s_add_u32 s51, s51, 4096
buffer_load_dwordx4 v8, s[36:39], s51 offen nt lds
s_add_u32 m0, m0, 4096
s_add_u32 s51, s51, 4096
buffer_load_dwordx4 v8, s[36:39], s51 offen nt lds
s_add_u32 m0, m0, 4096
s_add_u32 s51, s51, 4096
buffer_load_dwordx4 v8, s[36:39], s51 offen nt lds
s_add_u32 m0, m0, 4096
s_add_u32 s51, s51, 4096
buffer_load_dwordx4 v8, s[36:39], s51 offen nt lds
s_add_u32 m0, m0, 4096
s_add_u32 s51, s51, 4096
buffer_load_dwordx4 v8, s[36:39], s51 offen nt lds
s_mov_b32 s62, 8
s_cmp_lg_u32 s3, 0
s_cbranch_scc1 L_m_nr
s_not_b32 s59, s40
s_waitcnt lgkmcnt(0)
s_mov_b32 s58, s59
s_buffer_load_dword s99, s[4:7], s61
s_buffer_load_dword s58, s[4:7], s60
s_waitcnt lgkmcnt(1)
s_nop 7
s_cmp_lg_u32 s58, s40
s_addc_u32 s62, s62, 0
s_waitcnt lgkmcnt(0)
s_add_u32 s60, s60, 128
s_add_u32 s61, s61, 128
s_mov_b32 s58, s59
s_buffer_load_dword s99, s[4:7], s60
s_buffer_load_dword s58, s[4:7], s61
s_waitcnt lgkmcnt(1)
s_nop 7
s_cmp_lg_u32 s58, s40
s_subb_u32 s62, s62, 0
s_waitcnt lgkmcnt(0)
s_add_u32 s60, s60, 128
s_add_u32 s61, s61, 128
L_m_nr:
s_waitcnt vmcnt(20)
s_barrier
ds_read_b64_tr_b16 a[80:81], v6 offset:0
ds_read_b64_tr_b16 a[82:83], v6 offset:512
ds_read_b64_tr_b16 a[84:85], v6 offset:4096
ds_read_b64_tr_b16 a[86:87], v6 offset:4608
ds_read_b64_tr_b16 a[88:89], v6 offset:8192
ds_read_b64_tr_b16 a[90:91], v6 offset:8704
ds_read_b64_tr_b16 a[92:93], v6 offset:12288
ds_read_b64_tr_b16 a[94:95], v6 offset:12800
ds_read_b64_tr_b16 a[96:97], v6 offset:16384
ds_read_b64_tr_b16 a[98:99], v6 offset:16896
ds_read_b64_tr_b16 a[100:101], v6 offset:20480
ds_read_b64_tr_b16 a[102:103], v6 offset:20992
ds_read_b64_tr_b16 a[104:105], v6 offset:24576
ds_read_b64_tr_b16 a[106:107], v6 offset:25088
ds_read_b64_tr_b16 a[108:109], v6 offset:28672
ds_read_b64_tr_b16 a[110:111], v6 offset:29184
ds_read_b64_tr_b16 a[112:113], v6 offset:32768
ds_read_b64_tr_b16 a[114:115], v6 offset:33280
ds_read_b64_tr_b16 a[116:117], v6 offset:36864
ds_read_b64_tr_b16 a[118:119], v6 offset:37376
ds_read_b64_tr_b16 a[120:121], v7 offset:0
ds_read_b64_tr_b16 a[122:123], v7 offset:512
ds_read_b64_tr_b16 a[124:125], v7 offset:4096
ds_read_b64_tr_b16 a[126:127], v7 offset:4608
ds_read_b64_tr_b16 a[128:129], v7 offset:8192
ds_read_b64_tr_b16 a[130:131], v7 offset:8704
ds_read_b64_tr_b16 a[132:133], v7 offset:12288
ds_read_b64_tr_b16 a[134:135], v7 offset:12800
ds_read_b64_tr_b16 a[136:137], v7 offset:16384
ds_read_b64_tr_b16 a[138:139], v7 offset:16896
ds_read_b64_tr_b16 a[140:141], v7 offset:20480
ds_read_b64_tr_b16 a[142:143], v7 offset:20992
ds_read_b64_tr_b16 a[144:145], v7 offset:24576
ds_read_b64_tr_b16 a[146:147], v7 offset:25088
ds_read_b64_tr_b16 a[148:149], v7 offset:28672
ds_read_b64_tr_b16 a[150:151], v7 offset:29184
ds_read_b64_tr_b16 a[152:153], v7 offset:32768
ds_read_b64_tr_b16 a[154:155], v7 offset:33280
ds_read_b64_tr_b16 a[156:157], v7 offset:36864
ds_read_b64_tr_b16 a[158:159], v7 offset:37376
s_waitcnt vmcnt(0) lgkmcnt(0)
s_barrier
ds_read_b64_tr_b16 a[160:161], v11 offset:0
ds_read_b64_tr_b16 a[162:163], v11 offset:5120
ds_read_b64_tr_b16 a[164:165], v11 offset:40960
ds_read_b64_tr_b16 a[166:167], v11 offset:46080
ds_read_b64_tr_b16 a[168:169], v11 offset:32
ds_read_b64_tr_b16 a[170:171], v11 offset:5152
ds_read_b64_tr_b16 a[172:173], v11 offset:40992
ds_read_b64_tr_b16 a[174:175], v11 offset:46112
ds_read_b64_tr_b16 a[176:177], v11 offset:64
ds_read_b64_tr_b16 a[178:179], v11 offset:5184
ds_read_b64_tr_b16 a[180:181], v11 offset:41024
ds_read_b64_tr_b16 a[182:183], v11 offset:46144
ds_read_b64_tr_b16 a[184:185], v11 offset:96
ds_read_b64_tr_b16 a[186:187], v11 offset:5216
ds_read_b64_tr_b16 a[188:189], v11 offset:41056
ds_read_b64_tr_b16 a[190:191], v11 offset:46176
ds_read_b64_tr_b16 a[192:193], v11 offset:128
ds_read_b64_tr_b16 a[194:195], v11 offset:5248
ds_read_b64_tr_b16 a[196:197], v11 offset:41088
ds_read_b64_tr_b16 a[198:199], v11 offset:46208
ds_read_b64_tr_b16 a[200:201], v11 offset:160
ds_read_b64_tr_b16 a[202:203], v11 offset:5280
ds_read_b64_tr_b16 a[204:205], v11 offset:41120
ds_read_b64_tr_b16 a[206:207], v11 offset:46240
ds_read_b64_tr_b16 a[208:209], v11 offset:192
ds_read_b64_tr_b16 a[210:211], v11 offset:5312
ds_read_b64_tr_b16 a[212:213], v11 offset:41152
ds_read_b64_tr_b16 a[214:215], v11 offset:46272
ds_read_b64_tr_b16 a[216:217], v11 offset:224
ds_read_b64_tr_b16 a[218:219], v11 offset:5344
ds_read_b64_tr_b16 a[220:221], v11 offset:41184
ds_read_b64_tr_b16 a[222:223], v11 offset:46304
ds_read_b64_tr_b16 a[224:225], v11 offset:256
ds_read_b64_tr_b16 a[226:227], v11 offset:5376
ds_read_b64_tr_b16 a[228:229], v11 offset:41216
ds_read_b64_tr_b16 a[230:231], v11 offset:46336
ds_read_b64_tr_b16 a[232:233], v11 offset:288
ds_read_b64_tr_b16 a[234:235], v11 offset:5408
ds_read_b64_tr_b16 a[236:237], v11 offset:41248
ds_read_b64_tr_b16 a[238:239], v11 offset:46368
s_waitcnt lgkmcnt(0)
v_mov_b32 v20, 0
ds_write_b32 v12, v20 offset:8192
v_mul_u32_u24 v30, 5462, v1
v_lshrrev_b32 v30, 16, v30
v_lshl_add_u32 v14, v30, 6, v8
v_add_u32 v31, 64, v1
v_mul_u32_u24 v30, 5462, v31
v_lshrrev_b32 v30, 16, v30
v_lshlrev_b32 v31, 4, v31
v_lshl_add_u32 v15, v30, 6, v31
v_cmp_gt_u32 vcc, 16, v1
s_lshl_b32 s55, s3, 11
v_add_u32 v16, s55, v8
v_cndmask_b32 v15, v255, v15, vcc
v_lshl_add_u32 v17, v3, 4, s55
s_lshl_b32 s55, s3, 5
v_lshl_add_u32 v18, v2, 1, s55
v_lshrrev_b32 v30, 2, v2
v_lshlrev_b32 v31, 4, v3
v_add_u32 v32, 128, v31
v_cmp_eq_u32 vcc, 0, v30
s_nop 1
v_cndmask_b32 v232, v32, v31, vcc
v_cmp_eq_u32 vcc, 1, v30
s_nop 1
v_cndmask_b32 v233, v32, v31, vcc
v_cmp_eq_u32 vcc, 2, v30
s_nop 1
v_cndmask_b32 v234, v32, v31, vcc
v_cmp_eq_u32 vcc, 3, v30
s_nop 1
v_cndmask_b32 v235, v32, v31, vcc
v_lshrrev_b32 v30, 5, v1
v_and_b32 v31, 31, v1
v_lshlrev_b32 v31, 2, v31
v_lshl_add_u32 v236, v30, 12, v31
v_cmp_gt_u32 vcc, 32, v1
s_mul_i32 s46, s3, 20480
s_lshl_b32 s55, s44, 7
s_add_u32 s46, s46, s55
s_add_u32 s46, s46, 7864320
v_cndmask_b32 v237, v255, v236, vcc
s_add_u32 s47, s46, 8192
s_add_u32 s48, s46, 16384
s_mov_b32 s54, 0xffffff00
v_cmp_gt_u32 vcc, 32, v0
s_lshl_b32 s53, s44, 7
s_add_u32 s53, s53, 8060928
v_cndmask_b32 v238, v255, v12, vcc
s_waitcnt lgkmcnt(0)
s_barrier
s_mul_i32 s55, s3, 5
v_add_u32 v30, s55, v30
v_lshlrev_b32 v30, 12, v30
v_and_b32 v32, 0xfe000, v30
v_add3_u32 v236, v30, v32, v31
v_cmp_gt_u32 vcc, 32, v1
s_lshl_b32 s46, s44, 7
s_add_u32 s46, s46, 7864320
v_cndmask_b32 v237, v255, v236, vcc
s_add_u32 s47, s46, 16384
s_add_u32 s48, s46, 32768
s_add_u32 s50, s46, 8192
s_add_u32 s51, s47, 8192
s_add_u32 s52, s48, 8192
v_lshrrev_b32 v32, 5, v1
v_cmp_gt_u32 vcc, 64, v0
v_lshl_add_u32 v32, v32, 13, v31
s_nop 0
v_cndmask_b32 v238, v255, v32, vcc
s_lshl_b32 s55, s3, 11
v_and_b32 v30, 1, v1
v_lshrrev_b32 v31, 1, v1
v_lshlrev_b32 v31, 5, v31
v_lshl_add_u32 v31, v30, 3, v31
v_add_u32 v16, s55, v31
v_add_u32 v239, 1024, v16
v_lshlrev_b32 v31, 5, v3
v_lshl_add_u32 v31, v30, 4, v31
v_add_u32 v17, s55, v31
v_mul_u32_u24 v231, 0xaaaa, v30
v_add_u32 v231, 0x4444, v231
v_add_u32 v32, 128, v31
v_lshrrev_b32 v33, 2, v2
v_cmp_eq_u32 vcc, 0, v33
s_nop 1
v_cndmask_b32 v232, v32, v31, vcc
v_cmp_eq_u32 vcc, 1, v33
s_nop 1
v_cndmask_b32 v233, v32, v31, vcc
v_cmp_eq_u32 vcc, 2, v33
s_nop 1
v_cndmask_b32 v234, v32, v31, vcc
v_cmp_eq_u32 vcc, 3, v33
s_nop 1
v_cndmask_b32 v235, v32, v31, vcc
v_lshlrev_b32 v33, 2, v33
v_lshl_add_u32 v33, v30, 1, v33
v_bfe_u32 v30, v1, 1, 1
v_lshl_add_u32 v33, v30, 4, v33
s_lshl_b32 s55, s3, 5
v_add_u32 v18, s55, v33
v_mov_b32 v72, 0
v_mov_b32 v73, 0
v_mov_b32 v74, 0
v_mov_b32 v75, 0
v_mov_b32 v76, 0
v_mov_b32 v77, 0
v_mov_b32 v78, 0
v_mov_b32 v79, 0
v_mov_b32 v80, 0
v_mov_b32 v81, 0
v_mov_b32 v82, 0
v_mov_b32 v83, 0
v_mov_b32 v84, 0
v_mov_b32 v85, 0
v_mov_b32 v86, 0
v_mov_b32 v87, 0
v_mov_b32 v88, 0
v_mov_b32 v89, 0
v_mov_b32 v90, 0
v_mov_b32 v91, 0
v_mov_b32 v30, s62
v_lshlrev_b32 v31, 2, v0
ds_write_b32 v31, v30 offset:16384
v_mov_b32 v31, 0
s_waitcnt lgkmcnt(0)
s_barrier
ds_read_b32 v30, v31 offset:16384
s_waitcnt lgkmcnt(0)
v_readfirstlane_b32 s62, v30
s_cmp_gt_u32 s62, 8
s_cselect_b32 s101, 8192, 0
s_add_u32 s100, s101, 7733248
s_branch L_pg2
.p2align 12
L_pg2:
v_and_b32 v30, 31, v1
v_lshlrev_b32 v30, 11, v30
v_and_b32 v31, 0xe000, v30
v_add_u32 v30, v30, v31
s_and_b32 s55, s42, 3
s_lshl_b32 s55, s55, 9
s_add_u32 s55, s55, s101
s_add_u32 s55, s55, 7602176
s_mov_b32 exec_hi, 0
L_m_p:
buffer_load_dwordx3 v[200:202], v30, s[4:7], s55 offen sc1
s_waitcnt vmcnt(0)
v_cmp_ne_u32 vcc, s40, v202
v_mov_b32 v20, v200
s_cbranch_vccz L_m_ok
s_add_u32 s97, s97, 1
s_cmp_le_u32 s97, 65536
s_cbranch_scc1 L_m_p
L_m_ok:
v_max_f32_dpp v24, v20, v20 row_ror:8 row_mask:0xf bank_mask:0xf
s_nop 1
v_max_f32_dpp v24, v24, v24 row_ror:4 row_mask:0xf bank_mask:0xf
s_nop 1
v_max_f32_dpp v24, v24, v24 row_ror:2 row_mask:0xf bank_mask:0xf
s_nop 1
v_max_f32_dpp v24, v24, v24 row_ror:1 row_mask:0xf bank_mask:0xf
v_mov_b32 v25, v24
s_nop 1
v_permlane16_swap_b32 v24, v25
v_max_f32 v24, v24, v25
v_cmp_eq_f32 vcc, v24, v20
s_mov_b32 exec_hi, -1
s_ff1_i32_b32 s45, vcc_lo
s_and_b32 s45, s45, 31
s_lshl_b32 s55, s45, 11
s_andn2_b32 s56, s55, 0x1fff
s_add_u32 s55, s55, s56
s_add_u32 s55, s55, s100
L_m_rp:
buffer_load_dwordx4 v[20:23], v14, s[4:7], s55 offen sc1
buffer_load_dwordx4 v[24:27], v15, s[4:7], s55 offen sc1
s_waitcnt vmcnt(0)
ds_write2_b32 v16, v20, v22 offset0:0 offset1:1
ds_write2_b32 v16, v21, v23 offset0:4 offset1:5
ds_write2_b32 v239, v24, v26 offset0:0 offset1:1
ds_write2_b32 v239, v25, v27 offset0:4 offset1:5
v_max3_u32 v28, v20, v21, v22
v_max3_u32 v29, v23, v24, v25
v_max3_u32 v28, v28, v26, v27
v_max_u32 v28, v28, v29
v_cmp_eq_u32 vcc, -1, v28
s_add_u32 s97, s97, 1
s_cmp_gt_u32 s97, 65536
s_cbranch_scc1 L_m_rok
s_cbranch_vccnz L_m_rp
L_m_rok:
ds_read_b128 v[100:103], v17 offset:0
ds_read_b128 v[104:107], v17 offset:128
ds_read_b128 v[108:111], v17 offset:256
ds_read_b128 v[112:115], v17 offset:384
ds_read_b128 v[116:119], v17 offset:512
s_waitcnt lgkmcnt(4)
v_smfmac_f32_16x16x64_bf16 v[72:75], v[100:103], a[0:7], v231
ds_read_b128 v[120:123], v17 offset:640
v_smfmac_f32_16x16x64_bf16 v[76:79], v[100:103], a[80:87], v231
s_waitcnt lgkmcnt(4)
v_smfmac_f32_16x16x64_bf16 v[72:75], v[104:107], a[8:15], v231
ds_read_b128 v[124:127], v17 offset:768
v_smfmac_f32_16x16x64_bf16 v[76:79], v[104:107], a[88:95], v231
s_waitcnt lgkmcnt(4)
v_smfmac_f32_16x16x64_bf16 v[72:75], v[108:111], a[16:23], v231
ds_read_b128 v[128:131], v17 offset:896
v_smfmac_f32_16x16x64_bf16 v[76:79], v[108:111], a[96:103], v231
buffer_store_dword v240, v238, s[4:7], s53 offen sc1
s_waitcnt lgkmcnt(4)
v_smfmac_f32_16x16x64_bf16 v[72:75], v[112:115], a[24:31], v231
ds_read_b128 v[132:135], v17 offset:1024
v_smfmac_f32_16x16x64_bf16 v[76:79], v[112:115], a[104:111], v231
s_waitcnt lgkmcnt(4)
v_smfmac_f32_16x16x64_bf16 v[72:75], v[116:119], a[32:39], v231
ds_read_b128 v[136:139], v17 offset:1152
v_smfmac_f32_16x16x64_bf16 v[76:79], v[116:119], a[112:119], v231
s_waitcnt lgkmcnt(4)
v_smfmac_f32_16x16x64_bf16 v[72:75], v[120:123], a[40:47], v231
v_smfmac_f32_16x16x64_bf16 v[76:79], v[120:123], a[120:127], v231
s_waitcnt lgkmcnt(3)
v_smfmac_f32_16x16x64_bf16 v[72:75], v[124:127], a[48:55], v231
v_smfmac_f32_16x16x64_bf16 v[76:79], v[124:127], a[128:135], v231
s_waitcnt lgkmcnt(2)
v_smfmac_f32_16x16x64_bf16 v[72:75], v[128:131], a[56:63], v231
v_smfmac_f32_16x16x64_bf16 v[76:79], v[128:131], a[136:143], v231
s_waitcnt lgkmcnt(1)
v_smfmac_f32_16x16x64_bf16 v[72:75], v[132:135], a[64:71], v231
v_smfmac_f32_16x16x64_bf16 v[76:79], v[132:135], a[144:151], v231
s_waitcnt lgkmcnt(0)
v_smfmac_f32_16x16x64_bf16 v[72:75], v[136:139], a[72:79], v231
v_smfmac_f32_16x16x64_bf16 v[76:79], v[136:139], a[152:159], v231
s_nop 6
v_add_f32 v72, v72, v73
v_mul_f32 v73, 0xbfb8aa3b, v72
v_exp_f32 v73, v73
v_add_f32 v76, v76, v77
v_add_f32 v73, 1.0, v73
v_rcp_f32 v73, v73
v_mul_f32 v72, v72, v76
v_mul_f32 v72, v72, v73
v_cvt_pk_bf16_f32 v72, v72, v72
ds_write_b16 v18, v72 offset:8192
s_waitcnt lgkmcnt(0)
s_barrier
ds_read_b128 v[40:43], v232 offset:8192
ds_read_b128 v[44:47], v233 offset:8192
ds_read_b128 v[48:51], v234 offset:8192
ds_read_b128 v[52:55], v235 offset:8192
s_waitcnt lgkmcnt(3)
v_smfmac_f32_16x16x64_bf16 v[80:83], v[40:43], a[160:167], v231
s_waitcnt lgkmcnt(2)
v_smfmac_f32_16x16x64_bf16 v[80:83], v[44:47], a[168:175], v231
s_waitcnt lgkmcnt(1)
v_smfmac_f32_16x16x64_bf16 v[80:83], v[48:51], a[176:183], v231
s_waitcnt lgkmcnt(0)
v_smfmac_f32_16x16x64_bf16 v[80:83], v[52:55], a[184:191], v231
v_smfmac_f32_16x16x64_bf16 v[84:87], v[40:43], a[192:199], v231
v_smfmac_f32_16x16x64_bf16 v[84:87], v[44:47], a[200:207], v231
v_smfmac_f32_16x16x64_bf16 v[84:87], v[48:51], a[208:215], v231
v_smfmac_f32_16x16x64_bf16 v[84:87], v[52:55], a[216:223], v231
v_smfmac_f32_16x16x64_bf16 v[88:91], v[40:43], a[224:231], v231
v_smfmac_f32_16x16x64_bf16 v[88:91], v[44:47], a[232:239], v231
s_nop 1
v_add_f32 v80, v80, v81
v_and_or_b32 v80, v80, s54, v19
buffer_store_dword v80, v236, s[4:7], s46 offen sc1
buffer_store_dword v80, v236, s[4:7], s50 offen sc1
v_add_f32 v84, v84, v85
v_and_or_b32 v84, v84, s54, v19
buffer_store_dword v84, v236, s[4:7], s47 offen sc1
buffer_store_dword v84, v236, s[4:7], s51 offen sc1
v_add_f32 v88, v88, v89
v_and_or_b32 v88, v88, s54, v19
buffer_store_dword v88, v237, s[4:7], s48 offen sc1
buffer_store_dword v88, v237, s[4:7], s52 offen sc1
s_branch L_fin
L_fz:
s_add_u32 s46, s44, 5
s_add_u32 s47, s44, 10
s_lshl_b32 s50, s44, 7
s_mul_i32 s55, s3, 61440
s_add_u32 s50, s50, s55
s_add_u32 s50, s50, 2560
s_add_u32 m0, s49, 0
s_nop 0
buffer_load_dwordx4 v4, s[16:19], s50 offen nt lds
s_add_u32 m0, m0, 4096
s_add_u32 s50, s50, 245760
buffer_load_dwordx4 v4, s[16:19], s50 offen nt lds
s_add_u32 m0, m0, 4096
s_add_u32 s50, s50, 245760
buffer_load_dwordx4 v4, s[16:19], s50 offen nt lds
s_add_u32 m0, m0, 4096
s_add_u32 s50, s50, 245760
buffer_load_dwordx4 v4, s[16:19], s50 offen nt lds
s_add_u32 m0, m0, 4096
s_add_u32 s50, s50, 245760
buffer_load_dwordx4 v4, s[16:19], s50 offen nt lds
s_add_u32 m0, m0, 4096
s_add_u32 s50, s50, 245760
buffer_load_dwordx4 v4, s[16:19], s50 offen nt lds
s_add_u32 m0, m0, 4096
s_add_u32 s50, s50, 245760
buffer_load_dwordx4 v4, s[16:19], s50 offen nt lds
s_add_u32 m0, m0, 4096
s_add_u32 s50, s50, 245760
buffer_load_dwordx4 v4, s[16:19], s50 offen nt lds
s_add_u32 m0, m0, 4096
s_add_u32 s50, s50, 245760
buffer_load_dwordx4 v4, s[16:19], s50 offen nt lds
s_add_u32 m0, m0, 4096
s_add_u32 s50, s50, 245760
buffer_load_dwordx4 v4, s[16:19], s50 offen nt lds
s_add_u32 m0, m0, 4096
s_add_u32 s50, s50, 245760
buffer_load_dwordx4 v4, s[16:19], s50 offen nt lds
s_add_u32 m0, m0, 4096
s_add_u32 s50, s50, 245760
buffer_load_dwordx4 v4, s[16:19], s50 offen nt lds
s_add_u32 m0, m0, 4096
s_add_u32 s50, s50, 245760
buffer_load_dwordx4 v4, s[16:19], s50 offen nt lds
s_add_u32 m0, m0, 4096
s_add_u32 s50, s50, 245760
buffer_load_dwordx4 v4, s[16:19], s50 offen nt lds
s_add_u32 m0, m0, 4096
s_add_u32 s50, s50, 245760
buffer_load_dwordx4 v4, s[16:19], s50 offen nt lds
s_add_u32 m0, m0, 4096
s_add_u32 s50, s50, 245760
buffer_load_dwordx4 v4, s[16:19], s50 offen nt lds
s_add_u32 m0, m0, 4096
s_add_u32 s50, s50, 245760
buffer_load_dwordx4 v4, s[16:19], s50 offen nt lds
s_add_u32 m0, m0, 4096
s_add_u32 s50, s50, 245760
buffer_load_dwordx4 v4, s[16:19], s50 offen nt lds
s_add_u32 m0, m0, 4096
s_add_u32 s50, s50, 245760
buffer_load_dwordx4 v4, s[16:19], s50 offen nt lds
s_add_u32 m0, m0, 4096
s_add_u32 s50, s50, 245760
buffer_load_dwordx4 v4, s[16:19], s50 offen nt lds
s_waitcnt vmcnt(20)
v_readfirstlane_b32 s41, v42
v_lshlrev_b32 v44, 16, v40
v_and_b32 v45, 0xffff0000, v40
v_lshlrev_b32 v46, 16, v41
v_and_b32 v47, 0xffff0000, v41
v_mul_f32 v48, 0xbfb8aa3b, v44
v_mul_f32 v49, 0xbfb8aa3b, v45
v_mul_f32 v50, 0xbfb8aa3b, v46
v_mul_f32 v51, 0xbfb8aa3b, v47
v_exp_f32 v48, v48
v_exp_f32 v49, v49
v_exp_f32 v50, v50
v_exp_f32 v51, v51
v_add_f32 v48, 1.0, v48
v_add_f32 v49, 1.0, v49
v_add_f32 v50, 1.0, v50
v_add_f32 v51, 1.0, v51
v_rcp_f32 v48, v48
v_rcp_f32 v49, v49
v_rcp_f32 v50, v50
v_rcp_f32 v51, v51
v_mul_f32 v44, v44, v48
v_mul_f32 v45, v45, v49
v_mul_f32 v46, v46, v50
v_mul_f32 v47, v47, v51
v_cvt_pk_bf16_f32 v40, v44, v45
v_cvt_pk_bf16_f32 v41, v46, v47
v_add_u32 v28, 99840, v28
ds_write_b64 v28, v[40:41]
v_lshlrev_b32 v28, 4, v3
v_add_u32 v28, 99840, v28
s_mul_i32 s40, s41, 0x9E3779B1
s_add_u32 s40, s40, 0x85EBCA6B
v_and_b32 v33, 3, v1
v_lshlrev_b32 v33, 3, v33
v_lshrrev_b32 v19, v33, s40
v_and_b32 v19, 0xff, v19
v_mov_b32 v240, s40
v_mov_b32 v241, s19
v_mov_b32 v242, s40
v_mov_b32 v243, s40
v_and_b32 v30, 1, v1
v_lshlrev_b32 v30, 4, v30
v_lshrrev_b32 v13, v30, s40
v_and_b32 v13, 0xffff, v13
s_waitcnt lgkmcnt(0)
s_barrier
ds_read_b128 v[100:103], v28 offset:0
ds_read_b128 v[104:107], v28 offset:64
ds_read_b128 v[108:111], v28 offset:128
ds_read_b128 v[112:115], v28 offset:192
ds_read_b128 v[116:119], v28 offset:256
ds_read_b128 v[120:123], v28 offset:320
ds_read_b128 v[124:127], v28 offset:384
ds_read_b128 v[128:131], v28 offset:448
ds_read_b128 v[132:135], v28 offset:512
ds_read_b128 v[136:139], v28 offset:576
ds_read_b128 v[140:143], v28 offset:640
ds_read_b128 v[144:147], v28 offset:704
ds_read_b128 v[148:151], v28 offset:768
ds_read_b128 v[152:155], v28 offset:832
ds_read_b128 v[156:159], v28 offset:896
ds_read_b128 v[160:163], v28 offset:960
ds_read_b128 v[164:167], v28 offset:1024
ds_read_b128 v[168:171], v28 offset:1088
ds_read_b128 v[172:175], v28 offset:1152
ds_read_b128 v[176:179], v28 offset:1216
s_waitcnt lgkmcnt(0)
s_barrier
s_lshl_b32 s60, s44, 10
s_andn2_b32 s61, s60, 0x1fff
s_add_u32 s60, s60, s61
s_add_u32 s60, s60, 8126464
s_add_u32 s61, s60, 8192
v_cmp_gt_u32 vcc, 64, v0
s_nop 1
v_cndmask_b32 v30, v255, v8, vcc
buffer_store_dwordx4 v[240:243], v30, s[4:7], s60 offen sc1
buffer_store_dwordx4 v[240:243], v30, s[4:7], s61 offen sc1
s_lshl_b32 s50, s46, 7
s_mul_i32 s55, s3, 61440
s_add_u32 s50, s50, s55
s_add_u32 s50, s50, 2560
s_add_u32 m0, s49, 81920
s_nop 0
buffer_load_dwordx4 v4, s[16:19], s50 offen nt lds
s_add_u32 m0, m0, 4096
s_add_u32 s50, s50, 245760
buffer_load_dwordx4 v4, s[16:19], s50 offen nt lds
s_add_u32 m0, m0, 4096
s_add_u32 s50, s50, 245760
buffer_load_dwordx4 v4, s[16:19], s50 offen nt lds
s_add_u32 m0, m0, 4096
s_add_u32 s50, s50, 245760
buffer_load_dwordx4 v4, s[16:19], s50 offen nt lds
s_add_u32 m0, m0, 4096
s_add_u32 s50, s50, 245760
buffer_load_dwordx4 v4, s[16:19], s50 offen nt lds
s_add_u32 m0, m0, 4096
s_add_u32 s50, s50, 245760
buffer_load_dwordx4 v4, s[16:19], s50 offen nt lds
s_add_u32 m0, m0, 4096
s_add_u32 s50, s50, 245760
buffer_load_dwordx4 v4, s[16:19], s50 offen nt lds
s_add_u32 m0, m0, 4096
s_add_u32 s50, s50, 245760
buffer_load_dwordx4 v4, s[16:19], s50 offen nt lds
s_add_u32 m0, m0, 4096
s_add_u32 s50, s50, 245760
buffer_load_dwordx4 v4, s[16:19], s50 offen nt lds
s_add_u32 m0, m0, 4096
s_add_u32 s50, s50, 245760
buffer_load_dwordx4 v4, s[16:19], s50 offen nt lds
s_add_u32 m0, m0, 4096
s_add_u32 s50, s50, 245760
buffer_load_dwordx4 v4, s[16:19], s50 offen nt lds
s_add_u32 m0, m0, 4096
s_add_u32 s50, s50, 245760
buffer_load_dwordx4 v4, s[16:19], s50 offen nt lds
s_add_u32 m0, m0, 4096
s_add_u32 s50, s50, 245760
buffer_load_dwordx4 v4, s[16:19], s50 offen nt lds
s_add_u32 m0, m0, 4096
s_add_u32 s50, s50, 245760
buffer_load_dwordx4 v4, s[16:19], s50 offen nt lds
s_add_u32 m0, m0, 4096
s_add_u32 s50, s50, 245760
buffer_load_dwordx4 v4, s[16:19], s50 offen nt lds
s_add_u32 m0, m0, 4096
s_add_u32 s50, s50, 245760
buffer_load_dwordx4 v4, s[16:19], s50 offen nt lds
s_add_u32 m0, m0, 4096
s_add_u32 s50, s50, 245760
buffer_load_dwordx4 v4, s[16:19], s50 offen nt lds
s_add_u32 m0, m0, 4096
s_add_u32 s50, s50, 245760
buffer_load_dwordx4 v4, s[16:19], s50 offen nt lds
s_add_u32 m0, m0, 4096
s_add_u32 s50, s50, 245760
buffer_load_dwordx4 v4, s[16:19], s50 offen nt lds
s_add_u32 m0, m0, 4096
s_add_u32 s50, s50, 245760
buffer_load_dwordx4 v4, s[16:19], s50 offen nt lds
s_waitcnt vmcnt(22)
s_barrier
ds_read_b64_tr_b16 v[20:21], v6 offset:0
ds_read_b64_tr_b16 v[22:23], v6 offset:512
ds_read_b64_tr_b16 v[24:25], v6 offset:4096
ds_read_b64_tr_b16 v[26:27], v6 offset:4608
ds_read_b64_tr_b16 v[28:29], v6 offset:8192
ds_read_b64_tr_b16 v[30:31], v6 offset:8704
ds_read_b64_tr_b16 v[32:33], v6 offset:12288
ds_read_b64_tr_b16 v[34:35], v6 offset:12800
ds_read_b64_tr_b16 v[36:37], v6 offset:16384
ds_read_b64_tr_b16 v[38:39], v6 offset:16896
ds_read_b64_tr_b16 v[40:41], v6 offset:20480
ds_read_b64_tr_b16 v[42:43], v6 offset:20992
ds_read_b64_tr_b16 v[44:45], v6 offset:24576
ds_read_b64_tr_b16 v[46:47], v6 offset:25088
ds_read_b64_tr_b16 v[48:49], v6 offset:28672
ds_read_b64_tr_b16 v[50:51], v6 offset:29184
ds_read_b64_tr_b16 v[52:53], v6 offset:32768
ds_read_b64_tr_b16 v[54:55], v6 offset:33280
ds_read_b64_tr_b16 v[56:57], v6 offset:36864
ds_read_b64_tr_b16 v[58:59], v6 offset:37376
ds_read_b64_tr_b16 v[60:61], v7 offset:0
ds_read_b64_tr_b16 v[62:63], v7 offset:512
ds_read_b64_tr_b16 v[64:65], v7 offset:4096
ds_read_b64_tr_b16 v[66:67], v7 offset:4608
ds_read_b64_tr_b16 v[68:69], v7 offset:8192
ds_read_b64_tr_b16 v[70:71], v7 offset:8704
ds_read_b64_tr_b16 v[72:73], v7 offset:12288
ds_read_b64_tr_b16 v[74:75], v7 offset:12800
ds_read_b64_tr_b16 v[76:77], v7 offset:16384
ds_read_b64_tr_b16 v[78:79], v7 offset:16896
ds_read_b64_tr_b16 v[80:81], v7 offset:20480
ds_read_b64_tr_b16 v[82:83], v7 offset:20992
ds_read_b64_tr_b16 v[84:85], v7 offset:24576
ds_read_b64_tr_b16 v[86:87], v7 offset:25088
ds_read_b64_tr_b16 v[88:89], v7 offset:28672
ds_read_b64_tr_b16 v[90:91], v7 offset:29184
ds_read_b64_tr_b16 v[92:93], v7 offset:32768
ds_read_b64_tr_b16 v[94:95], v7 offset:33280
ds_read_b64_tr_b16 v[96:97], v7 offset:36864
ds_read_b64_tr_b16 v[98:99], v7 offset:37376
s_waitcnt lgkmcnt(0)
s_barrier
v_mfma_f32_16x16x32_bf16 v[180:183], v[100:103], v[20:23], 0
v_mfma_f32_16x16x32_bf16 v[180:183], v[104:107], v[24:27], v[180:183]
v_mfma_f32_16x16x32_bf16 v[180:183], v[108:111], v[28:31], v[180:183]
v_mfma_f32_16x16x32_bf16 v[180:183], v[112:115], v[32:35], v[180:183]
v_mfma_f32_16x16x32_bf16 v[180:183], v[116:119], v[36:39], v[180:183]
v_mfma_f32_16x16x32_bf16 v[180:183], v[120:123], v[40:43], v[180:183]
v_mfma_f32_16x16x32_bf16 v[180:183], v[124:127], v[44:47], v[180:183]
v_mfma_f32_16x16x32_bf16 v[180:183], v[128:131], v[48:51], v[180:183]
v_mfma_f32_16x16x32_bf16 v[180:183], v[132:135], v[52:55], v[180:183]
v_mfma_f32_16x16x32_bf16 v[180:183], v[136:139], v[56:59], v[180:183]
v_mfma_f32_16x16x32_bf16 v[180:183], v[140:143], v[60:63], v[180:183]
v_mfma_f32_16x16x32_bf16 v[180:183], v[144:147], v[64:67], v[180:183]
v_mfma_f32_16x16x32_bf16 v[180:183], v[148:151], v[68:71], v[180:183]
v_mfma_f32_16x16x32_bf16 v[180:183], v[152:155], v[72:75], v[180:183]
v_mfma_f32_16x16x32_bf16 v[180:183], v[156:159], v[76:79], v[180:183]
v_mfma_f32_16x16x32_bf16 v[180:183], v[160:163], v[80:83], v[180:183]
v_mfma_f32_16x16x32_bf16 v[180:183], v[164:167], v[84:87], v[180:183]
v_mfma_f32_16x16x32_bf16 v[180:183], v[168:171], v[88:91], v[180:183]
v_mfma_f32_16x16x32_bf16 v[180:183], v[172:175], v[92:95], v[180:183]
v_mfma_f32_16x16x32_bf16 v[180:183], v[176:179], v[96:99], v[180:183]
s_sub_u32 s55, s44, 20
s_cmp_lt_u32 s55, 10
s_cselect_b32 s55, 1.0, 0
s_lshl_b32 s56, s44, 8
s_lshl_b32 s57, s3, 6
s_add_u32 s56, s56, s57
s_add_u32 s56, s56, 65536
s_nop 0
v_cvt_pk_bf16_f32 v180, v180, v180
v_lshlrev_b32 v180, 16, v180
v_add_f32 v180, s55, v180
v_cvt_pk_bf16_f32 v180, v180, v180
v_lshl_or_b32 v180, v180, 16, v13
s_mov_b64 exec, 0xffff
buffer_store_dword v180, v12, s[4:7], s56 offen sc1
s_mov_b64 exec, -1
s_cmp_lt_u32 s47, 40
s_cselect_b32 s18, s18, 0
s_lshl_b32 s50, s47, 7
s_mul_i32 s55, s3, 61440
s_add_u32 s50, s50, s55
s_add_u32 s50, s50, 2560
s_add_u32 m0, s49, 0
s_nop 0
buffer_load_dwordx4 v4, s[16:19], s50 offen nt lds
s_add_u32 m0, m0, 4096
s_add_u32 s50, s50, 245760
buffer_load_dwordx4 v4, s[16:19], s50 offen nt lds
s_add_u32 m0, m0, 4096
s_add_u32 s50, s50, 245760
buffer_load_dwordx4 v4, s[16:19], s50 offen nt lds
s_add_u32 m0, m0, 4096
s_add_u32 s50, s50, 245760
buffer_load_dwordx4 v4, s[16:19], s50 offen nt lds
s_add_u32 m0, m0, 4096
s_add_u32 s50, s50, 245760
buffer_load_dwordx4 v4, s[16:19], s50 offen nt lds
s_add_u32 m0, m0, 4096
s_add_u32 s50, s50, 245760
buffer_load_dwordx4 v4, s[16:19], s50 offen nt lds
s_add_u32 m0, m0, 4096
s_add_u32 s50, s50, 245760
buffer_load_dwordx4 v4, s[16:19], s50 offen nt lds
s_add_u32 m0, m0, 4096
s_add_u32 s50, s50, 245760
buffer_load_dwordx4 v4, s[16:19], s50 offen nt lds
s_add_u32 m0, m0, 4096
s_add_u32 s50, s50, 245760
buffer_load_dwordx4 v4, s[16:19], s50 offen nt lds
s_add_u32 m0, m0, 4096
s_add_u32 s50, s50, 245760
buffer_load_dwordx4 v4, s[16:19], s50 offen nt lds
s_add_u32 m0, m0, 4096
s_add_u32 s50, s50, 245760
buffer_load_dwordx4 v4, s[16:19], s50 offen nt lds
s_add_u32 m0, m0, 4096
s_add_u32 s50, s50, 245760
buffer_load_dwordx4 v4, s[16:19], s50 offen nt lds
s_add_u32 m0, m0, 4096
s_add_u32 s50, s50, 245760
buffer_load_dwordx4 v4, s[16:19], s50 offen nt lds
s_add_u32 m0, m0, 4096
s_add_u32 s50, s50, 245760
buffer_load_dwordx4 v4, s[16:19], s50 offen nt lds
s_add_u32 m0, m0, 4096
s_add_u32 s50, s50, 245760
buffer_load_dwordx4 v4, s[16:19], s50 offen nt lds
s_add_u32 m0, m0, 4096
s_add_u32 s50, s50, 245760
buffer_load_dwordx4 v4, s[16:19], s50 offen nt lds
s_add_u32 m0, m0, 4096
s_add_u32 s50, s50, 245760
buffer_load_dwordx4 v4, s[16:19], s50 offen nt lds
s_add_u32 m0, m0, 4096
s_add_u32 s50, s50, 245760
buffer_load_dwordx4 v4, s[16:19], s50 offen nt lds
s_add_u32 m0, m0, 4096
s_add_u32 s50, s50, 245760
buffer_load_dwordx4 v4, s[16:19], s50 offen nt lds
s_add_u32 m0, m0, 4096
s_add_u32 s50, s50, 245760
buffer_load_dwordx4 v4, s[16:19], s50 offen nt lds
s_waitcnt vmcnt(21)
s_barrier
ds_read_b64_tr_b16 v[20:21], v9 offset:0
ds_read_b64_tr_b16 v[22:23], v9 offset:512
ds_read_b64_tr_b16 v[24:25], v9 offset:4096
ds_read_b64_tr_b16 v[26:27], v9 offset:4608
ds_read_b64_tr_b16 v[28:29], v9 offset:8192
ds_read_b64_tr_b16 v[30:31], v9 offset:8704
ds_read_b64_tr_b16 v[32:33], v9 offset:12288
ds_read_b64_tr_b16 v[34:35], v9 offset:12800
ds_read_b64_tr_b16 v[36:37], v9 offset:16384
ds_read_b64_tr_b16 v[38:39], v9 offset:16896
ds_read_b64_tr_b16 v[40:41], v9 offset:20480
ds_read_b64_tr_b16 v[42:43], v9 offset:20992
ds_read_b64_tr_b16 v[44:45], v9 offset:24576
ds_read_b64_tr_b16 v[46:47], v9 offset:25088
ds_read_b64_tr_b16 v[48:49], v9 offset:28672
ds_read_b64_tr_b16 v[50:51], v9 offset:29184
ds_read_b64_tr_b16 v[52:53], v9 offset:32768
ds_read_b64_tr_b16 v[54:55], v9 offset:33280
ds_read_b64_tr_b16 v[56:57], v9 offset:36864
ds_read_b64_tr_b16 v[58:59], v9 offset:37376
ds_read_b64_tr_b16 v[60:61], v10 offset:0
ds_read_b64_tr_b16 v[62:63], v10 offset:512
ds_read_b64_tr_b16 v[64:65], v10 offset:4096
ds_read_b64_tr_b16 v[66:67], v10 offset:4608
ds_read_b64_tr_b16 v[68:69], v10 offset:8192
ds_read_b64_tr_b16 v[70:71], v10 offset:8704
ds_read_b64_tr_b16 v[72:73], v10 offset:12288
ds_read_b64_tr_b16 v[74:75], v10 offset:12800
ds_read_b64_tr_b16 v[76:77], v10 offset:16384
ds_read_b64_tr_b16 v[78:79], v10 offset:16896
ds_read_b64_tr_b16 v[80:81], v10 offset:20480
ds_read_b64_tr_b16 v[82:83], v10 offset:20992
ds_read_b64_tr_b16 v[84:85], v10 offset:24576
ds_read_b64_tr_b16 v[86:87], v10 offset:25088
ds_read_b64_tr_b16 v[88:89], v10 offset:28672
ds_read_b64_tr_b16 v[90:91], v10 offset:29184
ds_read_b64_tr_b16 v[92:93], v10 offset:32768
ds_read_b64_tr_b16 v[94:95], v10 offset:33280
ds_read_b64_tr_b16 v[96:97], v10 offset:36864
ds_read_b64_tr_b16 v[98:99], v10 offset:37376
s_waitcnt lgkmcnt(0)
s_barrier
v_mfma_f32_16x16x32_bf16 v[180:183], v[100:103], v[20:23], 0
v_mfma_f32_16x16x32_bf16 v[180:183], v[104:107], v[24:27], v[180:183]
v_mfma_f32_16x16x32_bf16 v[180:183], v[108:111], v[28:31], v[180:183]
v_mfma_f32_16x16x32_bf16 v[180:183], v[112:115], v[32:35], v[180:183]
v_mfma_f32_16x16x32_bf16 v[180:183], v[116:119], v[36:39], v[180:183]
v_mfma_f32_16x16x32_bf16 v[180:183], v[120:123], v[40:43], v[180:183]
v_mfma_f32_16x16x32_bf16 v[180:183], v[124:127], v[44:47], v[180:183]
v_mfma_f32_16x16x32_bf16 v[180:183], v[128:131], v[48:51], v[180:183]
v_mfma_f32_16x16x32_bf16 v[180:183], v[132:135], v[52:55], v[180:183]
v_mfma_f32_16x16x32_bf16 v[180:183], v[136:139], v[56:59], v[180:183]
v_mfma_f32_16x16x32_bf16 v[180:183], v[140:143], v[60:63], v[180:183]
v_mfma_f32_16x16x32_bf16 v[180:183], v[144:147], v[64:67], v[180:183]
v_mfma_f32_16x16x32_bf16 v[180:183], v[148:151], v[68:71], v[180:183]
v_mfma_f32_16x16x32_bf16 v[180:183], v[152:155], v[72:75], v[180:183]
v_mfma_f32_16x16x32_bf16 v[180:183], v[156:159], v[76:79], v[180:183]
v_mfma_f32_16x16x32_bf16 v[180:183], v[160:163], v[80:83], v[180:183]
v_mfma_f32_16x16x32_bf16 v[180:183], v[164:167], v[84:87], v[180:183]
v_mfma_f32_16x16x32_bf16 v[180:183], v[168:171], v[88:91], v[180:183]
v_mfma_f32_16x16x32_bf16 v[180:183], v[172:175], v[92:95], v[180:183]
v_mfma_f32_16x16x32_bf16 v[180:183], v[176:179], v[96:99], v[180:183]
s_sub_u32 s55, s46, 20
s_cmp_lt_u32 s55, 10
s_cselect_b32 s55, 1.0, 0
s_lshl_b32 s56, s46, 8
s_lshl_b32 s57, s3, 6
s_add_u32 s56, s56, s57
s_add_u32 s56, s56, 65536
s_nop 0
v_cvt_pk_bf16_f32 v180, v180, v180
v_lshlrev_b32 v180, 16, v180
v_add_f32 v180, s55, v180
v_cvt_pk_bf16_f32 v180, v180, v180
v_lshl_or_b32 v180, v180, 16, v13
s_mov_b64 exec, 0xffff
buffer_store_dword v180, v12, s[4:7], s56 offen sc1
s_mov_b64 exec, -1
s_cmp_lt_u32 s47, 40
s_cbranch_scc0 L_fz_u
s_waitcnt vmcnt(1)
s_barrier
ds_read_b64_tr_b16 v[20:21], v6 offset:0
ds_read_b64_tr_b16 v[22:23], v6 offset:512
ds_read_b64_tr_b16 v[24:25], v6 offset:4096
ds_read_b64_tr_b16 v[26:27], v6 offset:4608
ds_read_b64_tr_b16 v[28:29], v6 offset:8192
ds_read_b64_tr_b16 v[30:31], v6 offset:8704
ds_read_b64_tr_b16 v[32:33], v6 offset:12288
ds_read_b64_tr_b16 v[34:35], v6 offset:12800
ds_read_b64_tr_b16 v[36:37], v6 offset:16384
ds_read_b64_tr_b16 v[38:39], v6 offset:16896
ds_read_b64_tr_b16 v[40:41], v6 offset:20480
ds_read_b64_tr_b16 v[42:43], v6 offset:20992
ds_read_b64_tr_b16 v[44:45], v6 offset:24576
ds_read_b64_tr_b16 v[46:47], v6 offset:25088
ds_read_b64_tr_b16 v[48:49], v6 offset:28672
ds_read_b64_tr_b16 v[50:51], v6 offset:29184
ds_read_b64_tr_b16 v[52:53], v6 offset:32768
ds_read_b64_tr_b16 v[54:55], v6 offset:33280
ds_read_b64_tr_b16 v[56:57], v6 offset:36864
ds_read_b64_tr_b16 v[58:59], v6 offset:37376
ds_read_b64_tr_b16 v[60:61], v7 offset:0
ds_read_b64_tr_b16 v[62:63], v7 offset:512
ds_read_b64_tr_b16 v[64:65], v7 offset:4096
ds_read_b64_tr_b16 v[66:67], v7 offset:4608
ds_read_b64_tr_b16 v[68:69], v7 offset:8192
ds_read_b64_tr_b16 v[70:71], v7 offset:8704
ds_read_b64_tr_b16 v[72:73], v7 offset:12288
ds_read_b64_tr_b16 v[74:75], v7 offset:12800
ds_read_b64_tr_b16 v[76:77], v7 offset:16384
ds_read_b64_tr_b16 v[78:79], v7 offset:16896
ds_read_b64_tr_b16 v[80:81], v7 offset:20480
ds_read_b64_tr_b16 v[82:83], v7 offset:20992
ds_read_b64_tr_b16 v[84:85], v7 offset:24576
ds_read_b64_tr_b16 v[86:87], v7 offset:25088
ds_read_b64_tr_b16 v[88:89], v7 offset:28672
ds_read_b64_tr_b16 v[90:91], v7 offset:29184
ds_read_b64_tr_b16 v[92:93], v7 offset:32768
ds_read_b64_tr_b16 v[94:95], v7 offset:33280
ds_read_b64_tr_b16 v[96:97], v7 offset:36864
ds_read_b64_tr_b16 v[98:99], v7 offset:37376
s_waitcnt lgkmcnt(0)
s_barrier
v_mfma_f32_16x16x32_bf16 v[180:183], v[100:103], v[20:23], 0
v_mfma_f32_16x16x32_bf16 v[180:183], v[104:107], v[24:27], v[180:183]
v_mfma_f32_16x16x32_bf16 v[180:183], v[108:111], v[28:31], v[180:183]
v_mfma_f32_16x16x32_bf16 v[180:183], v[112:115], v[32:35], v[180:183]
v_mfma_f32_16x16x32_bf16 v[180:183], v[116:119], v[36:39], v[180:183]
v_mfma_f32_16x16x32_bf16 v[180:183], v[120:123], v[40:43], v[180:183]
v_mfma_f32_16x16x32_bf16 v[180:183], v[124:127], v[44:47], v[180:183]
v_mfma_f32_16x16x32_bf16 v[180:183], v[128:131], v[48:51], v[180:183]
v_mfma_f32_16x16x32_bf16 v[180:183], v[132:135], v[52:55], v[180:183]
v_mfma_f32_16x16x32_bf16 v[180:183], v[136:139], v[56:59], v[180:183]
v_mfma_f32_16x16x32_bf16 v[180:183], v[140:143], v[60:63], v[180:183]
v_mfma_f32_16x16x32_bf16 v[180:183], v[144:147], v[64:67], v[180:183]
v_mfma_f32_16x16x32_bf16 v[180:183], v[148:151], v[68:71], v[180:183]
v_mfma_f32_16x16x32_bf16 v[180:183], v[152:155], v[72:75], v[180:183]
v_mfma_f32_16x16x32_bf16 v[180:183], v[156:159], v[76:79], v[180:183]
v_mfma_f32_16x16x32_bf16 v[180:183], v[160:163], v[80:83], v[180:183]
v_mfma_f32_16x16x32_bf16 v[180:183], v[164:167], v[84:87], v[180:183]
v_mfma_f32_16x16x32_bf16 v[180:183], v[168:171], v[88:91], v[180:183]
v_mfma_f32_16x16x32_bf16 v[180:183], v[172:175], v[92:95], v[180:183]
v_mfma_f32_16x16x32_bf16 v[180:183], v[176:179], v[96:99], v[180:183]
s_sub_u32 s55, s47, 20
s_cmp_lt_u32 s55, 10
s_cselect_b32 s55, 1.0, 0
s_lshl_b32 s56, s47, 8
s_lshl_b32 s57, s3, 6
s_add_u32 s56, s56, s57
s_add_u32 s56, s56, 65536
s_nop 0
v_cvt_pk_bf16_f32 v180, v180, v180
v_lshlrev_b32 v180, 16, v180
v_add_f32 v180, s55, v180
v_cvt_pk_bf16_f32 v180, v180, v180
v_lshl_or_b32 v180, v180, 16, v13
s_mov_b64 exec, 0xffff
buffer_store_dword v180, v12, s[4:7], s56 offen sc1
s_mov_b64 exec, -1
L_fz_u:
buffer_load_dword v191, v12, s[32:35], 0 offen
s_mov_b32 s55, 2621184
buffer_load_dword v192, v12, s[32:35], s55 offen
s_sub_u32 s46, s44, 27
s_lshl_b32 s46, s46, 2
s_add_u32 s46, s46, s3
v_cmp_gt_u32 vcc, 32, v1
v_lshlrev_b32 v14, 3, v1
v_and_b32 v15, 7, v1
v_cndmask_b32 v16, v255, v8, vcc
v_cndmask_b32 v250, 0, -1, vcc
v_lshlrev_b32 v15, 4, v15
s_mov_b32 s55, 68096
s_lshl_b32 s56, s46, 7
s_add_u32 s56, s56, 73216
s_mov_b32 s57, 0x05040100
buffer_load_dwordx2 v[44:45], v14, s[28:31], 0 offen
buffer_load_dwordx2 v[46:47], v14, s[28:31], 0 offen offset:512
buffer_load_dwordx2 v[48:49], v14, s[28:31], 0 offen offset:1024
L_fz_mp:
buffer_load_dwordx4 v[20:23], v8, s[4:7], s55 offen sc1
buffer_load_dwordx4 v[24:27], v8, s[4:7], s55 offen offset:1024 sc1
buffer_load_dwordx4 v[28:31], v16, s[4:7], s55 offen offset:2048 sc1
buffer_load_dwordx4 v[56:59], v15, s[4:7], s56 offen sc1
s_waitcnt vmcnt(0)
v_perm_b32 v32, v29, v28, s57
v_perm_b32 v33, v31, v30, s57
v_xor_b32 v32, s40, v32
v_xor_b32 v33, s40, v33
v_or_b32 v34, v32, v33
v_and_b32 v34, v34, v250
v_perm_b32 v32, v21, v20, s57
v_perm_b32 v33, v23, v22, s57
v_xor_b32 v32, s40, v32
v_xor_b32 v33, s40, v33
v_or3_b32 v34, v34, v32, v33
v_perm_b32 v32, v25, v24, s57
v_perm_b32 v33, v27, v26, s57
v_xor_b32 v32, s40, v32
v_xor_b32 v33, s40, v33
v_or3_b32 v34, v34, v32, v33
v_perm_b32 v32, v57, v56, s57
v_perm_b32 v33, v59, v58, s57
v_xor_b32 v32, s40, v32
v_xor_b32 v33, s40, v33
v_or3_b32 v34, v34, v32, v33
v_cmp_ne_u32 vcc, 0, v34
s_sleep 4
s_add_u32 s97, s97, 1
s_cmp_gt_u32 s97, 65536
s_cbranch_scc1 L_fz_mok
s_cbranch_vccnz L_fz_mp
L_fz_mok:
v_mov_b32 v60, 0
v_and_b32 v56, 0xffff0000, v56
v_and_b32 v57, 0xffff0000, v57
v_and_b32 v58, 0xffff0000, v58
v_and_b32 v59, 0xffff0000, v59
v_and_b32 v20, 0xffff0000, v20
v_lshlrev_b32 v32, 16, v44
v_fmac_f32 v60, v20, v32
v_and_b32 v21, 0xffff0000, v21
v_and_b32 v32, 0xffff0000, v44
v_fmac_f32 v60, v21, v32
v_and_b32 v22, 0xffff0000, v22
v_lshlrev_b32 v32, 16, v45
v_fmac_f32 v60, v22, v32
v_and_b32 v23, 0xffff0000, v23
v_and_b32 v32, 0xffff0000, v45
v_fmac_f32 v60, v23, v32
v_and_b32 v24, 0xffff0000, v24
v_lshlrev_b32 v32, 16, v46
v_fmac_f32 v60, v24, v32
v_and_b32 v25, 0xffff0000, v25
v_and_b32 v32, 0xffff0000, v46
v_fmac_f32 v60, v25, v32
v_and_b32 v26, 0xffff0000, v26
v_lshlrev_b32 v32, 16, v47
v_fmac_f32 v60, v26, v32
v_and_b32 v27, 0xffff0000, v27
v_and_b32 v32, 0xffff0000, v47
v_fmac_f32 v60, v27, v32
v_and_b32 v28, 0xffff0000, v28
v_lshlrev_b32 v32, 16, v48
v_fmac_f32 v60, v28, v32
v_and_b32 v29, 0xffff0000, v29
v_and_b32 v32, 0xffff0000, v48
v_fmac_f32 v60, v29, v32
v_and_b32 v30, 0xffff0000, v30
v_lshlrev_b32 v32, 16, v49
v_fmac_f32 v60, v30, v32
v_and_b32 v31, 0xffff0000, v31
v_and_b32 v32, 0xffff0000, v49
v_fmac_f32 v60, v31, v32
s_nop 1
v_add_f32_dpp v60, v60, v60 row_ror:8 row_mask:0xf bank_mask:0xf
s_nop 1
v_add_f32_dpp v60, v60, v60 row_ror:4 row_mask:0xf bank_mask:0xf
s_nop 1
v_add_f32_dpp v60, v60, v60 row_ror:2 row_mask:0xf bank_mask:0xf
s_nop 1
v_add_f32_dpp v60, v60, v60 row_ror:1 row_mask:0xf bank_mask:0xf
v_mov_b32 v61, v60
s_nop 1
v_permlane16_swap_b32 v60, v61
v_add_f32 v60, v60, v61
v_mov_b32 v61, v60
s_nop 1
v_permlane32_swap_b32 v60, v61
v_add_f32 v60, v60, v61
s_mov_b32 s62, 8
s_cmp_lg_u32 s3, 0
s_cbranch_scc1 L_f_nr
s_not_b32 s59, s40
s_waitcnt lgkmcnt(0)
s_mov_b32 s58, s59
s_buffer_load_dword s99, s[4:7], s61
s_buffer_load_dword s58, s[4:7], s60
s_waitcnt lgkmcnt(1)
s_nop 7
s_cmp_lg_u32 s58, s40
s_addc_u32 s62, s62, 0
s_waitcnt lgkmcnt(0)
s_add_u32 s60, s60, 128
s_add_u32 s61, s61, 128
s_mov_b32 s58, s59
s_buffer_load_dword s99, s[4:7], s60
s_buffer_load_dword s58, s[4:7], s61
s_waitcnt lgkmcnt(1)
s_nop 7
s_cmp_lg_u32 s58, s40
s_subb_u32 s62, s62, 0
s_waitcnt lgkmcnt(0)
s_add_u32 s60, s60, 128
s_add_u32 s61, s61, 128
L_f_nr:
v_mov_b32 v30, s62
v_lshlrev_b32 v31, 2, v0
ds_write_b32 v31, v30 offset:16384
v_mov_b32 v31, 0
s_waitcnt lgkmcnt(0)
s_barrier
ds_read_b32 v30, v31 offset:16384
s_waitcnt lgkmcnt(0)
v_readfirstlane_b32 s62, v30
s_cmp_gt_u32 s62, 8
s_cselect_b32 s101, 8192, 0
s_add_u32 s100, s101, 7733248
v_cmp_gt_u32 vcc, 24, v1
s_mul_i32 s47, s46, 86
s_lshr_b32 s47, s47, 8
v_cndmask_b32 v17, v255, v8, vcc
v_cndmask_b32 v250, 0, -1, vcc
s_lshl_b32 s48, s46, 12
s_andn2_b32 s55, s48, 8191
s_add_u32 s48, s48, s55
s_add_u32 s48, s48, s101
s_add_u32 s48, s48, 7864320
v_mov_b32 v18, 0
s_and_b32 s60, s40, 0xff
s_bfe_u32 s61, s40, 0x80008
s_bfe_u32 s62, s40, 0x80010
s_lshr_b32 s63, s40, 24
v_and_b32 v64, s60, v250
v_and_b32 v65, s61, v250
v_and_b32 v66, s62, v250
v_and_b32 v67, s63, v250
v_lshrrev_b32 v70, 3, v1
v_lshl_add_u32 v71, v70, 12, v15
v_lshlrev_b32 v70, 2, v70
v_lshrrev_b32 v77, 1, v15
s_add_u32 s51, s46, s47
s_lshl_b32 s51, s51, 7
s_add_u32 s51, s51, 524288
s_add_u32 s52, s51, 32768
s_add_u32 s53, s51, 65536
s_add_u32 s54, s51, 98304
s_branch L_pg3
.p2align 12
L_pg3:
v_and_b32 v30, 31, v1
v_lshlrev_b32 v30, 11, v30
v_and_b32 v31, 0xe000, v30
v_add_u32 v30, v30, v31
s_and_b32 s55, s42, 3
s_lshl_b32 s55, s55, 9
s_add_u32 s55, s55, s101
s_add_u32 s55, s55, 7602176
s_mov_b32 exec_hi, 0
L_f_p:
buffer_load_dwordx3 v[200:202], v30, s[4:7], s55 offen sc1
s_waitcnt vmcnt(0)
v_cmp_ne_u32 vcc, s40, v202
v_mov_b32 v20, v200
v_mov_b32 v21, v201
s_cbranch_vccz L_f_ok
s_add_u32 s97, s97, 1
s_cmp_le_u32 s97, 65536
s_cbranch_scc1 L_f_p
L_f_ok:
v_max_f32_dpp v24, v20, v20 row_ror:8 row_mask:0xf bank_mask:0xf
s_nop 1
v_max_f32_dpp v24, v24, v24 row_ror:4 row_mask:0xf bank_mask:0xf
s_nop 1
v_max_f32_dpp v24, v24, v24 row_ror:2 row_mask:0xf bank_mask:0xf
s_nop 1
v_max_f32_dpp v24, v24, v24 row_ror:1 row_mask:0xf bank_mask:0xf
v_mov_b32 v25, v24
s_nop 1
v_permlane16_swap_b32 v24, v25
v_max_f32 v24, v24, v25
v_cmp_eq_f32 vcc, v24, v20
s_mov_b32 exec_hi, -1
s_ff1_i32_b32 s45, vcc_lo
s_and_b32 s45, s45, 31
v_readlane_b32 s50, v21, s45
s_lshl_b32 s55, s45, 12
s_add_u32 s55, s55, s51
buffer_load_dwordx4 v[52:55], v15, s[4:7], s55 offen sc1
buffer_load_dwordx4 v[80:83], v71, s[4:7], s51 offen sc1
buffer_load_dwordx4 v[84:87], v71, s[4:7], s52 offen sc1
buffer_load_dwordx4 v[88:91], v71, s[4:7], s53 offen sc1
buffer_load_dwordx4 v[92:95], v71, s[4:7], s54 offen sc1
ds_bpermute_b32 v72, v70, v21 offset:0
ds_bpermute_b32 v73, v70, v21 offset:32
ds_bpermute_b32 v74, v70, v21 offset:64
ds_bpermute_b32 v75, v70, v21 offset:96
v_readlane_b32 s58, v24, 0
s_nop 1
v_add_f32 v60, s58, v60
v_cvt_pk_bf16_f32 v60, v60, v60
v_lshlrev_b32 v60, 16, v60
v_mul_f32 v60, 0xbfb8aa3b, v60
v_exp_f32 v60, v60
s_and_b32 s50, s50, 2047
s_mul_i32 s50, s50, 1280
v_add_f32 v60, 1.0, v60
v_rcp_f32 v60, v60
s_lshl_b32 s57, s46, 6
s_add_u32 s50, s50, s57
s_lshl_b32 s58, s45, 2
v_mul_f32 v56, v56, v60
v_mul_f32 v57, v57, v60
v_mul_f32 v58, v58, v60
v_mul_f32 v59, v59, v60
s_mov_b32 s59, 1280
s_waitcnt lgkmcnt(0)
v_and_b32 v72, 2047, v72
v_add_u32 v76, 0, v70
v_cmp_eq_u32 vcc, s58, v76
v_mad_u32_u24 v72, v72, s59, v77
s_nop 0
v_cndmask_b32 v72, v72, v255, vcc
v_and_b32 v73, 2047, v73
v_add_u32 v76, 32, v70
v_cmp_eq_u32 vcc, s58, v76
v_mad_u32_u24 v73, v73, s59, v77
s_nop 0
v_cndmask_b32 v73, v73, v255, vcc
v_and_b32 v74, 2047, v74
v_add_u32 v76, 64, v70
v_cmp_eq_u32 vcc, s58, v76
v_mad_u32_u24 v74, v74, s59, v77
s_nop 0
v_cndmask_b32 v74, v74, v255, vcc
v_and_b32 v75, 2047, v75
v_add_u32 v76, 96, v70
v_cmp_eq_u32 vcc, s58, v76
v_mad_u32_u24 v75, v75, s59, v77
s_nop 0
v_cndmask_b32 v75, v75, v255, vcc
s_waitcnt vmcnt(0)
v_xor_b32 v52, s60, v52
v_xor_b32 v53, s61, v53
v_xor_b32 v54, s62, v54
v_xor_b32 v55, s63, v55
v_xor_b32 v80, s60, v80
v_xor_b32 v81, s61, v81
v_xor_b32 v82, s62, v82
v_xor_b32 v83, s63, v83
v_xor_b32 v84, s60, v84
v_xor_b32 v85, s61, v85
v_xor_b32 v86, s62, v86
v_xor_b32 v87, s63, v87
v_xor_b32 v88, s60, v88
v_xor_b32 v89, s61, v89
v_xor_b32 v90, s62, v90
v_xor_b32 v91, s63, v91
v_xor_b32 v92, s60, v92
v_xor_b32 v93, s61, v93
v_xor_b32 v94, s62, v94
v_xor_b32 v95, s63, v95
v_or_b32 v32, v52, v53
v_or3_b32 v32, v32, v54, v55
v_or3_b32 v32, v32, v80, v81
v_or3_b32 v32, v32, v82, v83
v_or3_b32 v32, v32, v84, v85
v_or3_b32 v32, v32, v86, v87
v_or3_b32 v32, v32, v88, v89
v_or3_b32 v32, v32, v90, v91
v_or3_b32 v32, v32, v92, v93
v_or3_b32 v32, v32, v94, v95
v_and_b32 v32, 0xff, v32
v_cmp_ne_u32 vcc, 0, v32
s_cbranch_vccnz L_fb_retry
L_fb_ok:
v_cvt_pk_bf16_f32 v80, v80, v81
v_cvt_pk_bf16_f32 v81, v82, v83
buffer_store_dwordx2 v[80:81], v72, s[32:35], s57 offen
v_cvt_pk_bf16_f32 v84, v84, v85
v_cvt_pk_bf16_f32 v85, v86, v87
buffer_store_dwordx2 v[84:85], v73, s[32:35], s57 offen
v_cvt_pk_bf16_f32 v88, v88, v89
v_cvt_pk_bf16_f32 v89, v90, v91
buffer_store_dwordx2 v[88:89], v74, s[32:35], s57 offen
v_cvt_pk_bf16_f32 v92, v92, v93
v_cvt_pk_bf16_f32 v93, v94, v95
buffer_store_dwordx2 v[92:93], v75, s[32:35], s57 offen
s_cmp_eq_u32 s46, 0
s_cbranch_scc0 L_fz_e
s_add_u32 s55, s41, 1
v_mov_b32 v22, s55
s_mov_b64 exec, 1
buffer_store_dword v22, v18, s[4:7], 0 offen
s_mov_b64 exec, -1
L_fz_e:
v_min_u32 v68, 26, v1
v_lshlrev_b32 v68, 7, v68
s_add_u32 s57, s101, 8060928
L_ys_p:
buffer_load_dword v69, v68, s[4:7], s57 offen sc1
s_waitcnt vmcnt(0)
v_cmp_ne_u32 vcc, s40, v69
s_cbranch_vccz L_ys_ok
s_add_u32 s97, s97, 1
s_cmp_le_u32 s97, 65536
s_cbranch_scc1 L_ys_p
L_ys_ok:
L_fy_p:
buffer_load_dwordx4 v[100:103], v8, s[4:7], s48 offen offset:0 sc1
buffer_load_dwordx4 v[104:107], v8, s[4:7], s48 offen offset:1024 sc1
buffer_load_dwordx4 v[108:111], v8, s[4:7], s48 offen offset:2048 sc1
buffer_load_dwordx4 v[112:115], v17, s[4:7], s48 offen offset:3072 sc1
s_waitcnt vmcnt(0)
v_xor_b32 v20, s60, v100
v_xor_b32 v21, s61, v101
v_xor_b32 v22, s62, v102
v_xor_b32 v23, s63, v103
v_xor_b32 v24, s60, v104
v_xor_b32 v25, s61, v105
v_xor_b32 v26, s62, v106
v_xor_b32 v27, s63, v107
v_xor_b32 v28, s60, v108
v_xor_b32 v29, s61, v109
v_xor_b32 v30, s62, v110
v_xor_b32 v31, s63, v111
v_xor_b32 v32, v64, v112
v_xor_b32 v33, v65, v113
v_xor_b32 v34, v66, v114
v_xor_b32 v35, v67, v115
v_or3_b32 v36, v20, v21, v22
v_or3_b32 v37, v23, v24, v25
v_or3_b32 v36, v36, v26, v27
v_or3_b32 v37, v37, v28, v29
v_or3_b32 v36, v36, v30, v31
v_or3_b32 v37, v37, v32, v33
v_or3_b32 v36, v36, v34, v35
v_or_b32 v36, v36, v37
v_and_b32 v36, 0xff, v36
v_cmp_ne_u32 vcc, 0, v36
s_cbranch_vccz L_fy_ok
s_add_u32 s97, s97, 1
s_cmp_le_u32 s97, 65536
s_cbranch_scc1 L_fy_p
L_fy_ok:
v_pk_add_f32 v[20:21], v[20:21], v[24:25]
v_pk_add_f32 v[22:23], v[22:23], v[26:27]
v_pk_add_f32 v[28:29], v[28:29], v[32:33]
v_pk_add_f32 v[30:31], v[30:31], v[34:35]
v_pk_add_f32 v[20:21], v[20:21], v[28:29]
v_pk_add_f32 v[22:23], v[22:23], v[30:31]
s_nop 0
v_add_f32_dpp v20, v20, v20 row_ror:8 row_mask:0xf bank_mask:0xf
v_add_f32_dpp v21, v21, v21 row_ror:8 row_mask:0xf bank_mask:0xf
v_add_f32_dpp v22, v22, v22 row_ror:8 row_mask:0xf bank_mask:0xf
v_add_f32_dpp v23, v23, v23 row_ror:8 row_mask:0xf bank_mask:0xf
v_mov_b32 v24, v20
v_mov_b32 v25, v21
v_mov_b32 v26, v22
v_mov_b32 v27, v23
v_permlane16_swap_b32 v20, v24
v_permlane16_swap_b32 v21, v25
v_permlane16_swap_b32 v22, v26
v_permlane16_swap_b32 v23, v27
v_pk_add_f32 v[20:21], v[20:21], v[24:25]
v_pk_add_f32 v[22:23], v[22:23], v[26:27]
v_mov_b32 v24, v20
v_mov_b32 v25, v21
v_mov_b32 v26, v22
v_mov_b32 v27, v23
v_permlane32_swap_b32 v20, v24
v_permlane32_swap_b32 v21, v25
v_permlane32_swap_b32 v22, v26
v_permlane32_swap_b32 v23, v27
v_pk_add_f32 v[20:21], v[20:21], v[24:25]
v_pk_add_f32 v[22:23], v[22:23], v[26:27]
v_pk_fma_f32 v[20:21], v[20:21], v[56:57], v[52:53]
v_pk_fma_f32 v[22:23], v[22:23], v[58:59], v[54:55]
v_cvt_pk_bf16_f32 v20, v20, v21
v_cvt_pk_bf16_f32 v21, v22, v23
s_mov_b64 exec, 0xff
buffer_store_dwordx2 v[20:21], v14, s[32:35], s50 offen
s_mov_b64 exec, -1
L_fin:
L_end:
s_endpgm
L_fb_retry:
buffer_load_dwordx4 v[52:55], v15, s[4:7], s55 offen sc1
buffer_load_dwordx4 v[80:83], v71, s[4:7], s51 offen sc1
buffer_load_dwordx4 v[84:87], v71, s[4:7], s52 offen sc1
buffer_load_dwordx4 v[88:91], v71, s[4:7], s53 offen sc1
buffer_load_dwordx4 v[92:95], v71, s[4:7], s54 offen sc1
s_waitcnt vmcnt(0)
v_xor_b32 v52, s60, v52
v_xor_b32 v53, s61, v53
v_xor_b32 v54, s62, v54
v_xor_b32 v55, s63, v55
v_xor_b32 v80, s60, v80
v_xor_b32 v81, s61, v81
v_xor_b32 v82, s62, v82
v_xor_b32 v83, s63, v83
v_xor_b32 v84, s60, v84
v_xor_b32 v85, s61, v85
v_xor_b32 v86, s62, v86
v_xor_b32 v87, s63, v87
v_xor_b32 v88, s60, v88
v_xor_b32 v89, s61, v89
v_xor_b32 v90, s62, v90
v_xor_b32 v91, s63, v91
v_xor_b32 v92, s60, v92
v_xor_b32 v93, s61, v93
v_xor_b32 v94, s62, v94
v_xor_b32 v95, s63, v95
v_or_b32 v32, v52, v53
v_or3_b32 v32, v32, v54, v55
v_or3_b32 v32, v32, v80, v81
v_or3_b32 v32, v32, v82, v83
v_or3_b32 v32, v32, v84, v85
v_or3_b32 v32, v32, v86, v87
v_or3_b32 v32, v32, v88, v89
v_or3_b32 v32, v32, v90, v91
v_or3_b32 v32, v32, v92, v93
v_or3_b32 v32, v32, v94, v95
v_and_b32 v32, 0xff, v32
v_cmp_ne_u32 vcc, 0, v32
s_add_u32 s97, s97, 1
s_cmp_gt_u32 s97, 65536
s_cbranch_scc1 L_fb_ok
s_cbranch_vccnz L_fb_retry
s_branch L_fb_ok
.fill (adaLN_cond__sliding_local_dilated__moe_arch_mod__prompt_kernel + 66048 - .) / 4, 4, 0xbf800000
.section .rodata,"a"
.p2align 6
.amdhsa_kernel adaLN_cond__sliding_local_dilated__moe_arch_mod__prompt_kernel
  .amdhsa_next_free_vgpr 512
  .amdhsa_next_free_sgpr 102
  .amdhsa_accum_offset 256
  .amdhsa_group_segment_fixed_size 0
  .amdhsa_kernarg_size 104
  .amdhsa_user_sgpr_count 2
  .amdhsa_user_sgpr_kernarg_segment_ptr 1
  .amdhsa_system_sgpr_workgroup_id_x 1
  .amdhsa_float_denorm_mode_32 3
  .amdhsa_float_denorm_mode_16_64 3
.end_amdhsa_kernel
```

```asm
; @launch grid=(256,1,1) block=(256,1,1) lds=163840
.amdgcn_target "amdgcn-amd-amdhsa--gfx950"
.text
.globl adaLN_cond__sliding_local_dilated__moe_arch_mod__prompt_kernel
.p2align 12
.type adaLN_cond__sliding_local_dilated__moe_arch_mod__prompt_kernel,@function
adaLN_cond__sliding_local_dilated__moe_arch_mod__prompt_kernel:
s_cmp_ge_u32 s2, 256
s_cbranch_scc1 L_end
s_load_dwordx4 s[8:11], s[0:1], 0
s_load_dwordx4 s[20:23], s[0:1], 64
s_load_dwordx2 s[4:5], s[0:1], 96
s_getpc_b64 s[48:49]
v_lshrrev_b32 v4, 6, v0
v_and_b32 v1, 63, v0
s_lshr_b32 s43, s2, 3
v_readfirstlane_b32 s3, v4
v_lshl_add_u32 v5, v4, 2, v1
s_lshl_b32 s50, s43, 11
v_lshl_add_u32 v5, v5, 7, s50
s_mov_b64 exec, 15
global_load_dword v19, v5, s[48:49]
s_mov_b64 exec, -1
s_and_b32 s42, s2, 7
s_lshr_b32 s50, s42, 2
s_lshl_b32 s42, s42, 1
s_and_b32 s42, s42, 6
s_or_b32 s42, s42, s50
v_and_b32 v2, 15, v1
v_lshrrev_b32 v3, 4, v1
v_mov_b32 v29, 0
s_mov_b32 s6, 8388608
s_mov_b32 s7, 0x20000
s_lshl_b32 s49, s3, 10
s_cmp_ge_u32 s2, 224
s_cbranch_scc1 L_svc
s_mov_b32 m0, s49
s_mov_b32 s15, 0x20000
s_lshr_b32 s55, s42, 2
s_bfe_u32 s56, s42, 0x10001
s_mul_i32 s56, s56, 7
s_lshr_b32 s57, s43, 2
s_and_b32 s44, s42, 1
s_lshl_b32 s44, s44, 2
s_and_b32 s58, s43, 3
s_add_u32 s44, s44, s58
s_add_u32 s56, s56, s57
s_mul_i32 s57, s56, 73
s_lshl_b32 s45, s57, 1
s_add_u32 s45, s45, s55
s_mul_i32 s45, s45, 1280
s_mul_i32 s58, s43, 37
s_lshr_b32 s58, s58, 8
s_mul_i32 s60, s58, 7
s_sub_u32 s96, s43, s60
s_lshl_b32 s47, s42, 2
s_add_u32 s47, s47, s58
s_lshl_b32 s60, s96, 2
s_lshr_b32 s60, 0x4932180, s60
s_and_b32 s60, s60, 15
s_cmp_ge_u32 s60, 8
s_cselect_b32 s61, 2, 5
s_cselect_b32 s63, 12, 0
s_mul_i32 s58, s58, s61
s_add_u32 s58, s58, s60
s_add_u32 s58, s58, s63
s_lshl_b32 s58, s58, 3
s_add_u32 s98, s58, s42
s_and_b32 s63, s44, 3
s_mov_b32 s62, 274960
s_cmp_eq_u32 s63, 1
s_cselect_b32 s62, 213025, s62
s_cmp_eq_u32 s63, 2
s_cselect_b32 s62, 274690, s62
s_cmp_eq_u32 s63, 3
s_cselect_b32 s62, 213520, s62
s_bfe_u32 s61, s62, 262144
s_mul_i32 s61, s61, 40960
s_add_u32 s61, s61, s45
v_lshrrev_b32 v5, 4, v0
v_mul_u32_u24 v4, 2560, v5
v_lshl_add_u32 v4, v2, 4, v4
s_cmp_lt_u32 s98, 160
s_cbranch_scc1 L_roleW
s_sub_u32 s50, s98, 160
s_mul_i32 s52, s50, 13
s_lshr_b32 s52, s52, 8
s_mul_i32 s53, s52, 20
s_sub_u32 s53, s50, s53
s_mul_i32 s51, s52, 28
s_add_u32 s51, s51, s3
s_mul_i32 s51, s51, 61440
s_lshl_b32 s54, s53, 7
s_add_u32 s51, s51, s54
s_mul_i32 s54, s52, 448
s_and_b32 s58, s3, 1
s_lshl_b32 s58, s58, 2
v_and_b32 v20, 1, v3
v_lshl_or_b32 v20, v20, 1, s58
v_and_b32 v21, 7, v1
v_xor_b32 v20, v20, v21
v_lshrrev_b32 v21, 3, v1
v_mul_u32_u24 v21, 480, v21
v_add_lshl_u32 v20, v20, v21, 4
v_lshlrev_b32 v39, 3, v1
s_mov_b32 s14, 4915200
s_waitcnt lgkmcnt(0)
s_mov_b32 s12, s22
s_mov_b32 s13, s23
s_mov_b32 s22, 1280
s_mov_b32 s23, 0x20000
s_mov_b32 s10, 2621440
s_mov_b32 s11, 0x20000
buffer_load_dword v42, v29, s[4:7], 0 offen sc1
buffer_load_dwordx2 v[40:41], v39, s[20:23], s54 offen
buffer_load_dwordx4 v[100:103], v4, s[8:11], s61 offen offset:0
buffer_load_dwordx4 v[104:107], v4, s[8:11], s61 offen offset:256
buffer_load_dwordx4 v[108:111], v4, s[8:11], s61 offen offset:512
buffer_load_dwordx4 v[112:115], v4, s[8:11], s61 offen offset:768
buffer_load_dwordx4 v[116:119], v4, s[8:11], s61 offen offset:1024
s_bfe_u32 s61, s62, 262148
s_mul_i32 s61, s61, 40960
s_add_u32 s61, s61, s45
buffer_load_dwordx4 v20, s[12:15], s51 offen nt lds
s_add_u32 m0, m0, 4096
s_add_u32 s51, s51, 245760
buffer_load_dwordx4 v20, s[12:15], s51 offen nt lds
s_add_u32 m0, m0, 4096
s_add_u32 s51, s51, 245760
buffer_load_dwordx4 v20, s[12:15], s51 offen nt lds
s_add_u32 m0, m0, 4096
s_add_u32 s51, s51, 245760
buffer_load_dwordx4 v20, s[12:15], s51 offen nt lds
s_add_u32 m0, m0, 4096
s_add_u32 s51, s51, 245760
buffer_load_dwordx4 v20, s[12:15], s51 offen nt lds
s_add_u32 m0, m0, 4096
s_add_u32 s51, s51, 245760
buffer_load_dwordx4 v20, s[12:15], s51 offen nt lds
s_add_u32 m0, m0, 4096
s_add_u32 s51, s51, 245760
buffer_load_dwordx4 v20, s[12:15], s51 offen nt lds
s_branch L_rolej
L_roleW:
s_mov_b32 s58, 640
v_lshlrev_b32 v24, 4, v0
v_mul_u32_u24 v26, 1639, v0
v_lshrrev_b32 v26, 16, v26
v_mad_u32_u24 v20, v26, s58, v24
v_add_u32 v25, 256, v0
v_add_u32 v24, 4096, v24
v_mul_u32_u24 v26, 1639, v25
v_lshrrev_b32 v26, 16, v26
v_mad_u32_u24 v21, v26, s58, v24
v_add_u32 v25, 512, v0
v_add_u32 v24, 4096, v24
v_mul_u32_u24 v26, 1639, v25
v_lshrrev_b32 v26, 16, v26
v_mad_u32_u24 v22, v26, s58, v24
v_add_u32 v25, 768, v0
v_add_u32 v24, 4096, v24
v_mul_u32_u24 v26, 1639, v25
v_lshrrev_b32 v26, 16, v26
v_mad_u32_u24 v23, v26, s58, v24
s_lshr_b32 s50, s98, 1
s_and_b32 s52, s98, 1
s_mul_i32 s51, s50, 30720
s_mul_i32 s53, s52, 640
s_add_u32 s51, s51, s53
s_cmp_eq_u32 s3, 3
s_cselect_b32 s53, 1073741824, s51
s_mov_b32 s14, 2457600
s_waitcnt lgkmcnt(0)
s_mov_b32 s12, s10
s_mov_b32 s13, s11
s_mov_b32 s10, 2621440
s_mov_b32 s11, 0x20000
buffer_load_dword v42, v29, s[4:7], 0 offen sc1
buffer_load_dwordx4 v20, s[12:15], s51 offen nt lds
s_add_u32 m0, m0, 4096
s_nop 0
buffer_load_dwordx4 v21, s[12:15], s51 offen nt lds
s_add_u32 m0, m0, 4096
s_nop 0
buffer_load_dwordx4 v22, s[12:15], s51 offen nt lds
s_add_u32 m0, m0, 4096
s_nop 0
buffer_load_dwordx4 v23, s[12:15], s53 offen nt lds
buffer_load_dwordx4 v[100:103], v4, s[8:11], s61 offen offset:0
buffer_load_dwordx4 v[104:107], v4, s[8:11], s61 offen offset:256
buffer_load_dwordx4 v[108:111], v4, s[8:11], s61 offen offset:512
buffer_load_dwordx4 v[112:115], v4, s[8:11], s61 offen offset:768
buffer_load_dwordx4 v[116:119], v4, s[8:11], s61 offen offset:1024
s_bfe_u32 s61, s62, 262148
s_mul_i32 s61, s61, 40960
s_add_u32 s61, s61, s45
L_rolej:
s_load_dwordx2 s[24:25], s[0:1], 16
s_load_dwordx2 s[28:29], s[0:1], 32
s_load_dwordx2 s[32:33], s[0:1], 80
s_mov_b32 s26, 819200
s_mov_b32 s27, 0x20000
s_mov_b32 s30, 1280
s_mov_b32 s31, 0x20000
s_mov_b32 s34, 2621440
s_mov_b32 s35, 0x20000
s_mov_b32 s97, 0
v_mov_b32 v255, 1073741824
v_lshlrev_b32 v36, 4, v1
s_mul_i32 s36, s55, 14
s_add_u32 s100, s36, s56
s_cmp_eq_u32 s56, 0
s_cselect_b32 s58, 0, 7
s_add_u32 s58, s58, s57
s_add_u32 s60, s57, 80
s_min_u32 s60, s60, 1024
s_sub_u32 s60, s60, s58
s_andn2_b32 s59, s58, 15
s_mul_i32 s54, s55, 1024
s_add_u32 s54, s54, s59
s_lshl_b32 s46, s44, 1
s_add_u32 s46, s46, s54
s_mul_i32 s46, s46, 1280
s_add_u32 s46, s46, 4194304
s_sub_u32 s54, s59, s58
s_sub_u32 s59, s59, s57
s_mul_i32 s59, s59, 176
s_add_u32 s59, s59, 138240
v_add_u32 v33, s54, v2
v_mul_u32_u24 v34, 175, v2
v_add3_u32 v34, v34, v0, s59
s_mov_b32 s54, 2656
s_mov_b32 s58, 1120
v_mul_u32_u24 v31, 410, v0
v_lshrrev_b32 v31, 16, v31
v_lshl_add_u32 v32, v31, 4, v33
v_cmp_gt_u32 vcc, s60, v32
v_mad_u32_u24 v32, v31, s58, v0
v_mad_u32_u24 v15, v31, s54, v34
v_lshlrev_b32 v32, 4, v32
v_cndmask_b32 v11, v255, v32, vcc
v_add_u32 v30, 256, v0
v_mul_u32_u24 v31, 410, v30
v_lshrrev_b32 v31, 16, v31
v_lshl_add_u32 v32, v31, 4, v33
v_cmp_gt_u32 vcc, s60, v32
v_mad_u32_u24 v32, v31, s58, v30
v_mad_u32_u24 v16, v31, s54, v34
v_lshlrev_b32 v32, 4, v32
v_cndmask_b32 v12, v255, v32, vcc
v_add_u32 v30, 512, v0
v_mul_u32_u24 v31, 410, v30
v_lshrrev_b32 v31, 16, v31
v_lshl_add_u32 v32, v31, 4, v33
v_cmp_gt_u32 vcc, s60, v32
v_mad_u32_u24 v32, v31, s58, v30
v_mad_u32_u24 v17, v31, s54, v34
v_lshlrev_b32 v32, 4, v32
v_cndmask_b32 v13, v255, v32, vcc
v_add_u32 v30, 768, v0
v_mul_u32_u24 v31, 410, v30
v_lshrrev_b32 v31, 16, v31
v_lshl_add_u32 v32, v31, 4, v33
v_cmp_gt_u32 vcc, s60, v32
v_mad_u32_u24 v32, v31, s58, v30
v_mad_u32_u24 v18, v31, s54, v34
v_lshlrev_b32 v32, 4, v32
v_cndmask_b32 v14, v255, v32, vcc
s_mul_i32 s58, s3, 80
v_add_u32 v30, s58, v1
s_mul_i32 s58, s3, 1280
s_add_u32 s58, s58, 1024
v_lshlrev_b32 v248, 4, v30
v_lshl_add_u32 v249, v1, 2, s58
v_add_u32 v251, 158720, v248
v_add_u32 v250, 158720, v249
v_cmp_le_u32 vcc, 160, v30
v_min_u32 v247, 19, v1
v_lshlrev_b32 v247, 6, v247
v_cndmask_b32 v252, 0, 1.0, vcc
v_cmp_gt_u32 vcc, 4, v1
s_mov_b32 s56, 4096
s_mov_b32 s57, 9216
v_cndmask_b32 v246, v255, v36, vcc
s_mul_i32 s60, s44, 5120
s_mul_i32 s58, s3, 1280
s_add_u32 s60, s60, s58
s_add_u32 s60, s60, 851968
s_mov_b32 s58, 14336
v_lshlrev_b32 v30, 12, v3
v_lshl_add_u32 v30, v2, 4, v30
v_add_u32 v5, s49, v30
v_lshrrev_b32 v32, 2, v2
v_cmp_ne_u32 vcc, 1, v32
v_lshrrev_b32 v30, 4, v0
v_and_b32 v31, 7, v2
v_cndmask_b32 v6, v255, v5, vcc
v_xor_b32 v30, v30, v31
v_lshlrev_b32 v30, 4, v30
v_and_b32 v33, 3, v2
v_lshl_add_u32 v30, v33, 8, v30
v_mul_u32_u24 v32, 5120, v32
s_mov_b32 s54, 56320
v_add3_u32 v30, v30, v32, s54
s_bfe_u32 s63, s62, 262144
s_lshl_b32 s63, s63, 10
v_add_u32 v7, s63, v30
s_bfe_u32 s63, s62, 262148
s_lshl_b32 s63, s63, 10
v_add_u32 v253, s63, v30
s_bfe_u32 s63, s62, 262152
s_lshl_b32 s63, s63, 10
v_add_u32 v254, s63, v30
s_bfe_u32 s63, s62, 262156
s_lshl_b32 s63, s63, 10
v_add_u32 v244, s63, v30
s_bfe_u32 s63, s62, 262160
s_lshl_b32 s63, s63, 10
v_add_u32 v245, s63, v30
v_xor_b32 v30, v2, v3
v_lshlrev_b32 v30, 4, v30
v_lshl_add_u32 v8, v3, 8, v30
v_xor_b32 v9, 64, v8
v_add_u32 v8, s54, v8
v_add_u32 v9, s54, v9
v_lshlrev_b32 v10, 5, v2
v_add_u32 v10, 158720, v10
s_mul_i32 s59, s44, 327680
s_add_u32 s59, s59, 1048576
s_cmp_eq_u32 s96, 6
s_cselect_b32 s16, 0x80, 0
s_cselect_b32 s17, 16, 24
s_mov_b32 s37, 2368
s_mov_b32 s38, 1088
v_mul_u32_u24 v31, 5462, v1
v_lshrrev_b32 v31, 16, v31
v_mad_u32_u24 v32, v31, s37, v36
v_mad_u32_u24 v33, v31, s38, v36
v_lshlrev_b32 v31, 2, v31
v_and_b32 v34, s16, v32
v_bitop3_b32 v33, v33, v31, 32 bitop3:0x78
v_lshl_or_b32 v235, v34, 23, v32
v_lshl_or_b32 v232, v34, 23, v33
v_add_u32 v30, 64, v1
v_mul_u32_u24 v31, 5462, v30
v_lshrrev_b32 v31, 16, v31
v_mad_u32_u24 v32, v31, s37, v36
v_mad_u32_u24 v33, v31, s38, v36
v_lshlrev_b32 v31, 2, v31
v_and_b32 v34, s16, v32
v_bitop3_b32 v33, v33, v31, 32 bitop3:0x78
v_lshl_or_b32 v236, v34, 23, v32
v_lshl_or_b32 v233, v34, 23, v33
v_add_u32 v30, 128, v1
v_mul_u32_u24 v31, 5462, v30
v_lshrrev_b32 v31, 16, v31
v_mad_u32_u24 v32, v31, s37, v36
v_mad_u32_u24 v33, v31, s38, v36
v_lshlrev_b32 v31, 2, v31
v_and_b32 v34, s16, v32
v_bitop3_b32 v33, v33, v31, 32 bitop3:0x78
v_lshl_or_b32 v237, v34, 23, v32
v_lshl_or_b32 v234, v34, 23, v33
s_lshl_b32 s100, s100, 3
s_add_u32 s100, s100, s44
s_lshl_b32 s100, s100, 6
s_add_u32 s100, s100, 917504
s_and_b32 s37, s47, 15
s_lshl_b32 s37, s37, 6
s_max_u32 s37, s37, 7
s_sub_u32 s37, s37, 7
s_mul_i32 s37, s37, 899
s_lshr_b32 s37, s37, 16
s_min_u32 s37, s37, 12
s_add_u32 s37, s37, s36
s_lshl_b32 s101, s37, 3
s_bfe_u32 s37, s42, 0x10001
s_mul_i32 s37, s37, 7
s_add_u32 s37, s37, s36
s_lshl_b32 s37, s37, 3
s_and_b32 s38, s42, 1
s_mul_i32 s38, s38, 4
s_add_u32 s21, s37, s38
s_sub_u32 s20, s43, s96
s_getreg_b32 s19, hwreg(HW_REG_XCC_ID, 0, 4)
v_cmp_le_u32 vcc, 24, v1
v_subrev_u32 v30, 24, v1
v_mov_b32 v32, 0xa00
v_cndmask_b32 v30, v1, v30, vcc
v_cndmask_b32 v32, 0, v32, vcc
v_cmp_gt_u32 vcc, s17, v30
v_lshl_add_u32 v32, v30, 4, v32
v_lshlrev_b32 v31, 3, v30
v_cndmask_b32 v238, v255, v32, vcc
v_cndmask_b32 v239, v255, v31, vcc
v_cndmask_b32 v230, 0, -1, vcc
v_min_u32 v30, 6, v2
v_add_u32 v30, s20, v30
v_and_b32 v31, 3, v30
v_lshrrev_b32 v30, 2, v30
v_lshl_add_u32 v30, v30, 3, v31
v_cmp_gt_u32 vcc, 16, v1
v_add_u32 v30, s21, v30
v_add_u32 v31, s101, v1
v_cndmask_b32 v30, v30, v31, vcc
v_lshlrev_b32 v231, 6, v30
s_mul_i32 s37, s96, 192
s_mul_i32 s48, s3, 20480
s_add_u32 s48, s48, s37
s_and_b32 s99, s47, 0
s_mul_i32 s99, s99, 0
s_mul_i32 s37, s99, 163840
s_add_u32 s48, s48, s37
s_mul_i32 s39, s3, 3072
s_lshl_b32 s18, s47, 11
s_andn2_b32 s37, s18, 8191
s_add_u32 s18, s18, s37
s_lshl_b32 s37, s96, 8
s_add_u32 s18, s18, s37
s_lshl_b32 s37, s3, 6
s_add_u32 s18, s18, s37
s_add_u32 s18, s18, 7733248
v_accvgpr_write_b32 a232, -1
v_accvgpr_write_b32 a233, -1
v_accvgpr_write_b32 a234, -1
v_accvgpr_write_b32 a235, -1
v_lshrrev_b32 v30, 2, v2
v_cmp_eq_u32 vcc, v30, v3
v_mov_b32 v31, 0x3f803f80
v_mov_b32 v30, 0
v_cndmask_b32 v30, v30, v31, vcc
v_accvgpr_write_b32 a236, v30
v_accvgpr_write_b32 a237, v30
v_accvgpr_write_b32 a238, v30
v_accvgpr_write_b32 a239, v30
s_cmp_ge_u32 s98, 160
s_cbranch_scc1 L_bodyM
v_bfe_u32 v30, v1, 2, 2
v_and_b32 v31, 3, v1
v_max_u32 v32, 1, v31
v_add_u32 v32, -1, v32
v_cmp_eq_u32 vcc, 3, v3
v_lshlrev_b32 v33, 3, v31
v_mul_u32_u24 v30, 3, v30
v_cndmask_b32 v32, v3, v32, vcc
v_cndmask_b32 v33, v33, 32, vcc
v_add_u32 v30, v30, v32
v_mul_u32_u24 v30, 640, v30
s_mul_i32 s54, s3, 160
v_add3_u32 v35, v30, v33, s54
s_lshl_b32 s52, s52, 2
s_add_u32 s52, s52, s3
s_mul_i32 s52, s52, 80
s_add_u32 s52, s52, s50
s_lshl_b32 s51, s52, 12
s_add_u32 s51, s51, 1048576
s_lshl_b32 s53, s52, 6
s_add_u32 s53, s53, 851968
buffer_load_dwordx4 v[120:123], v4, s[8:11], s61 offen offset:0
buffer_load_dwordx4 v[124:127], v4, s[8:11], s61 offen offset:256
buffer_load_dwordx4 v[128:131], v4, s[8:11], s61 offen offset:512
buffer_load_dwordx4 v[132:135], v4, s[8:11], s61 offen offset:768
buffer_load_dwordx4 v[136:139], v4, s[8:11], s61 offen offset:1024
s_bfe_u32 s61, s62, 262152
s_mul_i32 s61, s61, 40960
s_add_u32 s61, s61, s45
buffer_load_dwordx4 v[140:143], v4, s[8:11], s61 offen offset:0
buffer_load_dwordx4 v[144:147], v4, s[8:11], s61 offen offset:256
buffer_load_dwordx4 v[148:151], v4, s[8:11], s61 offen offset:512
s_waitcnt vmcnt(13)
v_readfirstlane_b32 s41, v42
s_waitcnt lgkmcnt(0)
s_barrier
ds_read_b64_tr_b16 v[44:45], v35 offset:0
ds_read_b64_tr_b16 v[46:47], v35 offset:7680
ds_read_b64_tr_b16 v[48:49], v35 offset:40
ds_read_b64_tr_b16 v[50:51], v35 offset:7720
ds_read_b64_tr_b16 v[52:53], v35 offset:80
ds_read_b64_tr_b16 v[54:55], v35 offset:7760
ds_read_b64_tr_b16 v[56:57], v35 offset:120
ds_read_b64_tr_b16 v[58:59], v35 offset:7800
s_mul_i32 s40, s41, 0x9E3779B1
s_add_u32 s40, s40, 0x85EBCA6B
v_and_b32 v33, 3, v1
v_lshlrev_b32 v33, 3, v33
v_lshrrev_b32 v19, v33, s40
v_and_b32 v19, 0xff, v19
v_mov_b32 v240, s40
v_mov_b32 v241, s19
v_mov_b32 v242, s40
v_mov_b32 v243, s40
s_waitcnt lgkmcnt(6)
buffer_store_dwordx4 v[44:47], v36, s[4:7], s51 offen offset:0 sc1
s_waitcnt lgkmcnt(4)
buffer_store_dwordx4 v[48:51], v36, s[4:7], s51 offen offset:1024 sc1
s_waitcnt lgkmcnt(2)
buffer_store_dwordx4 v[52:55], v36, s[4:7], s51 offen offset:2048 sc1
s_waitcnt lgkmcnt(0)
buffer_store_dwordx4 v[56:59], v36, s[4:7], s51 offen offset:3072 sc1
buffer_load_dwordx4 v[152:155], v4, s[8:11], s61 offen offset:768
buffer_load_dwordx4 v[156:159], v4, s[8:11], s61 offen offset:1024
s_bfe_u32 s61, s62, 262156
s_mul_i32 s61, s61, 40960
s_add_u32 s61, s61, s45
s_waitcnt vmcnt(14)
s_mov_b32 s55, 0x3f803f80
buffer_load_dwordx4 v[160:163], v4, s[8:11], s61 offen offset:0
v_mfma_f32_16x16x32_bf16 v[20:23], a[236:239], v[100:103], 0
v_lshlrev_b32 v24, 16, v104
v_and_b32 v25, 0xffff0000, v104
v_mfma_f32_16x16x32_bf16 v[20:23], a[236:239], v[104:107], v[20:23]
v_lshlrev_b32 v26, 16, v105
v_and_b32 v27, 0xffff0000, v105
v_mfma_f32_16x16x32_bf16 v[20:23], a[236:239], v[108:111], v[20:23]
v_lshlrev_b32 v28, 16, v106
v_and_b32 v29, 0xffff0000, v106
v_mfma_f32_16x16x32_bf16 v[20:23], a[236:239], v[112:115], v[20:23]
v_lshlrev_b32 v30, 16, v107
v_and_b32 v31, 0xffff0000, v107
v_mfma_f32_16x16x32_bf16 v[20:23], a[236:239], v[116:119], v[20:23]
v_lshlrev_b32 v88, 16, v100
v_and_b32 v89, 0xffff0000, v100
v_lshlrev_b32 v90, 16, v101
v_and_b32 v91, 0xffff0000, v101
v_dot2_f32_bf16 v96, v100, v100, 0
v_dot2_f32_bf16 v97, v101, v101, 0
v_dot2_f32_bf16 v96, v102, v102, v96
v_dot2_f32_bf16 v97, v103, v103, v97
v_dot2_f32_bf16 v96, v104, v104, v96
v_dot2_f32_bf16 v97, v105, v105, v97
buffer_load_dwordx4 v[164:167], v4, s[8:11], s61 offen offset:256
v_dot2_f32_bf16 v96, v106, v106, v96
v_dot2_f32_bf16 v97, v107, v107, v97
v_dot2_f32_bf16 v96, v108, v108, v96
v_dot2_f32_bf16 v97, v109, v109, v97
v_dot2_f32_bf16 v96, v110, v110, v96
v_dot2_f32_bf16 v97, v111, v111, v97
v_dot2_f32_bf16 v96, v112, v112, v96
v_dot2_f32_bf16 v97, v113, v113, v97
v_dot2_f32_bf16 v96, v114, v114, v96
v_dot2_f32_bf16 v97, v115, v115, v97
v_dot2_f32_bf16 v96, v116, v116, v96
v_dot2_f32_bf16 v97, v117, v117, v97
v_dot2_f32_bf16 v96, v118, v118, v96
v_dot2_f32_bf16 v97, v119, v119, v97
v_add_f32_dpp v20, v20, v20 row_ror:8 row_mask:0xf bank_mask:0xf
v_lshlrev_b32 v100, 16, v102
v_and_b32 v101, 0xffff0000, v102
v_add_f32 v96, v96, v97
v_add_f32_dpp v20, v20, v20 row_ror:4 row_mask:0xf bank_mask:0xf
v_lshlrev_b32 v102, 16, v103
v_add_f32_dpp v96, v96, v96 row_ror:8 row_mask:0xf bank_mask:0xf
v_add_f32_dpp v20, v20, v20 row_ror:2 row_mask:0xf bank_mask:0xf
v_and_b32 v103, 0xffff0000, v103
v_add_f32_dpp v96, v96, v96 row_ror:4 row_mask:0xf bank_mask:0xf
buffer_load_dwordx4 v[168:171], v4, s[8:11], s61 offen offset:512
v_add_f32_dpp v20, v20, v20 row_ror:1 row_mask:0xf bank_mask:0xf
v_mul_f32 v20, 0x3acccccd, v20
v_add_f32_dpp v96, v96, v96 row_ror:2 row_mask:0xf bank_mask:0xf
s_nop 1
v_add_f32_dpp v96, v96, v96 row_ror:1 row_mask:0xf bank_mask:0xf
v_mul_f32 v96, 0x3acccccd, v96
v_fma_f32 v96, -v20, v20, v96
v_max_f32 v96, 0, v96
v_add_f32 v96, 0x3727c5ac, v96
v_rsq_f32 v96, v96
s_nop 0
v_mul_f32 v97, -v20, v96
v_pk_fma_f32 v[24:25], v[24:25], v[96:97], v[96:97] op_sel:[0,0,1] op_sel_hi:[1,0,1]
v_pk_fma_f32 v[26:27], v[26:27], v[96:97], v[96:97] op_sel:[0,0,1] op_sel_hi:[1,0,1]
v_pk_fma_f32 v[28:29], v[28:29], v[96:97], v[96:97] op_sel:[0,0,1] op_sel_hi:[1,0,1]
v_pk_fma_f32 v[30:31], v[30:31], v[96:97], v[96:97] op_sel:[0,0,1] op_sel_hi:[1,0,1]
v_cvt_pk_f16_f32 v104, v24, v25
v_cvt_pk_f16_f32 v105, v26, v27
v_cvt_pk_f16_f32 v106, v28, v29
v_cvt_pk_f16_f32 v107, v30, v31
v_lshlrev_b32 v24, 16, v108
v_and_b32 v25, 0xffff0000, v108
v_lshlrev_b32 v26, 16, v109
v_and_b32 v27, 0xffff0000, v109
v_lshlrev_b32 v28, 16, v110
buffer_load_dwordx4 v[172:175], v4, s[8:11], s61 offen offset:768
v_and_b32 v29, 0xffff0000, v110
v_lshlrev_b32 v30, 16, v111
v_and_b32 v31, 0xffff0000, v111
v_pk_fma_f32 v[24:25], v[24:25], v[96:97], v[96:97] op_sel:[0,0,1] op_sel_hi:[1,0,1]
v_pk_fma_f32 v[26:27], v[26:27], v[96:97], v[96:97] op_sel:[0,0,1] op_sel_hi:[1,0,1]
v_pk_fma_f32 v[28:29], v[28:29], v[96:97], v[96:97] op_sel:[0,0,1] op_sel_hi:[1,0,1]
v_pk_fma_f32 v[30:31], v[30:31], v[96:97], v[96:97] op_sel:[0,0,1] op_sel_hi:[1,0,1]
v_cvt_pk_f16_f32 v108, v24, v25
v_cvt_pk_f16_f32 v109, v26, v27
v_cvt_pk_f16_f32 v110, v28, v29
v_cvt_pk_f16_f32 v111, v30, v31
v_lshlrev_b32 v24, 16, v112
v_and_b32 v25, 0xffff0000, v112
v_lshlrev_b32 v26, 16, v113
v_and_b32 v27, 0xffff0000, v113
v_lshlrev_b32 v28, 16, v114
v_and_b32 v29, 0xffff0000, v114
v_lshlrev_b32 v30, 16, v115
v_and_b32 v31, 0xffff0000, v115
v_pk_fma_f32 v[24:25], v[24:25], v[96:97], v[96:97] op_sel:[0,0,1] op_sel_hi:[1,0,1]
v_pk_fma_f32 v[26:27], v[26:27], v[96:97], v[96:97] op_sel:[0,0,1] op_sel_hi:[1,0,1]
v_pk_fma_f32 v[28:29], v[28:29], v[96:97], v[96:97] op_sel:[0,0,1] op_sel_hi:[1,0,1]
v_pk_fma_f32 v[30:31], v[30:31], v[96:97], v[96:97] op_sel:[0,0,1] op_sel_hi:[1,0,1]
buffer_load_dwordx4 v[176:179], v4, s[8:11], s61 offen offset:1024
s_bfe_u32 s61, s62, 262160
s_mul_i32 s61, s61, 40960
s_add_u32 s61, s61, s45
v_cvt_pk_f16_f32 v112, v24, v25
v_cvt_pk_f16_f32 v113, v26, v27
v_cvt_pk_f16_f32 v114, v28, v29
v_cvt_pk_f16_f32 v115, v30, v31
v_lshlrev_b32 v24, 16, v116
v_and_b32 v25, 0xffff0000, v116
v_lshlrev_b32 v26, 16, v117
v_and_b32 v27, 0xffff0000, v117
v_lshlrev_b32 v28, 16, v118
v_and_b32 v29, 0xffff0000, v118
v_lshlrev_b32 v30, 16, v119
v_and_b32 v31, 0xffff0000, v119
v_pk_fma_f32 v[24:25], v[24:25], v[96:97], v[96:97] op_sel:[0,0,1] op_sel_hi:[1,0,1]
v_pk_fma_f32 v[26:27], v[26:27], v[96:97], v[96:97] op_sel:[0,0,1] op_sel_hi:[1,0,1]
v_pk_fma_f32 v[28:29], v[28:29], v[96:97], v[96:97] op_sel:[0,0,1] op_sel_hi:[1,0,1]
v_pk_fma_f32 v[30:31], v[30:31], v[96:97], v[96:97] op_sel:[0,0,1] op_sel_hi:[1,0,1]
v_pk_fma_f32 v[88:89], v[88:89], v[96:97], v[96:97] op_sel:[0,0,1] op_sel_hi:[1,0,1]
v_pk_fma_f32 v[90:91], v[90:91], v[96:97], v[96:97] op_sel:[0,0,1] op_sel_hi:[1,0,1]
v_pk_fma_f32 v[100:101], v[100:101], v[96:97], v[96:97] op_sel:[0,0,1] op_sel_hi:[1,0,1]
v_pk_fma_f32 v[102:103], v[102:103], v[96:97], v[96:97] op_sel:[0,0,1] op_sel_hi:[1,0,1]
v_cvt_pk_f16_f32 v116, v24, v25
v_cvt_pk_f16_f32 v117, v26, v27
v_cvt_pk_f16_f32 v118, v28, v29
v_cvt_pk_f16_f32 v119, v30, v31
s_waitcnt vmcnt(14)
s_mov_b32 s55, 0x3f803f80
v_mfma_f32_16x16x32_bf16 v[20:23], a[236:239], v[120:123], 0
v_lshlrev_b32 v24, 16, v124
v_and_b32 v25, 0xffff0000, v124
v_mfma_f32_16x16x32_bf16 v[20:23], a[236:239], v[124:127], v[20:23]
v_lshlrev_b32 v26, 16, v125
v_and_b32 v27, 0xffff0000, v125
v_mfma_f32_16x16x32_bf16 v[20:23], a[236:239], v[128:131], v[20:23]
v_lshlrev_b32 v28, 16, v126
v_and_b32 v29, 0xffff0000, v126
v_mfma_f32_16x16x32_bf16 v[20:23], a[236:239], v[132:135], v[20:23]
v_lshlrev_b32 v30, 16, v127
v_and_b32 v31, 0xffff0000, v127
v_mfma_f32_16x16x32_bf16 v[20:23], a[236:239], v[136:139], v[20:23]
v_lshlrev_b32 v92, 16, v120
v_and_b32 v93, 0xffff0000, v120
v_lshlrev_b32 v94, 16, v121
v_and_b32 v95, 0xffff0000, v121
v_dot2_f32_bf16 v98, v120, v120, 0
v_dot2_f32_bf16 v99, v121, v121, 0
v_dot2_f32_bf16 v98, v122, v122, v98
v_dot2_f32_bf16 v99, v123, v123, v99
v_dot2_f32_bf16 v98, v124, v124, v98
v_dot2_f32_bf16 v99, v125, v125, v99
v_dot2_f32_bf16 v98, v126, v126, v98
v_dot2_f32_bf16 v99, v127, v127, v99
v_dot2_f32_bf16 v98, v128, v128, v98
v_dot2_f32_bf16 v99, v129, v129, v99
v_dot2_f32_bf16 v98, v130, v130, v98
v_dot2_f32_bf16 v99, v131, v131, v99
v_dot2_f32_bf16 v98, v132, v132, v98
v_dot2_f32_bf16 v99, v133, v133, v99
v_dot2_f32_bf16 v98, v134, v134, v98
v_dot2_f32_bf16 v99, v135, v135, v99
v_dot2_f32_bf16 v98, v136, v136, v98
v_dot2_f32_bf16 v99, v137, v137, v99
v_dot2_f32_bf16 v98, v138, v138, v98
v_dot2_f32_bf16 v99, v139, v139, v99
v_add_f32_dpp v20, v20, v20 row_ror:8 row_mask:0xf bank_mask:0xf
v_lshlrev_b32 v120, 16, v122
v_and_b32 v121, 0xffff0000, v122
v_add_f32 v98, v98, v99
v_add_f32_dpp v20, v20, v20 row_ror:4 row_mask:0xf bank_mask:0xf
v_lshlrev_b32 v122, 16, v123
v_add_f32_dpp v98, v98, v98 row_ror:8 row_mask:0xf bank_mask:0xf
v_add_f32_dpp v20, v20, v20 row_ror:2 row_mask:0xf bank_mask:0xf
v_and_b32 v123, 0xffff0000, v123
v_add_f32_dpp v98, v98, v98 row_ror:4 row_mask:0xf bank_mask:0xf
v_add_f32_dpp v20, v20, v20 row_ror:1 row_mask:0xf bank_mask:0xf
v_mul_f32 v20, 0x3acccccd, v20
v_add_f32_dpp v98, v98, v98 row_ror:2 row_mask:0xf bank_mask:0xf
s_nop 1
v_add_f32_dpp v98, v98, v98 row_ror:1 row_mask:0xf bank_mask:0xf
v_mul_f32 v98, 0x3acccccd, v98
v_fma_f32 v98, -v20, v20, v98
v_max_f32 v98, 0, v98
v_add_f32 v98, 0x3727c5ac, v98
v_rsq_f32 v98, v98
s_nop 0
v_mul_f32 v99, -v20, v98
v_pk_fma_f32 v[24:25], v[24:25], v[98:99], v[98:99] op_sel:[0,0,1] op_sel_hi:[1,0,1]
v_pk_fma_f32 v[26:27], v[26:27], v[98:99], v[98:99] op_sel:[0,0,1] op_sel_hi:[1,0,1]
v_pk_fma_f32 v[28:29], v[28:29], v[98:99], v[98:99] op_sel:[0,0,1] op_sel_hi:[1,0,1]
v_pk_fma_f32 v[30:31], v[30:31], v[98:99], v[98:99] op_sel:[0,0,1] op_sel_hi:[1,0,1]
v_cvt_pk_f16_f32 v124, v24, v25
v_cvt_pk_f16_f32 v125, v26, v27
v_cvt_pk_f16_f32 v126, v28, v29
v_cvt_pk_f16_f32 v127, v30, v31
v_lshlrev_b32 v24, 16, v128
v_and_b32 v25, 0xffff0000, v128
v_lshlrev_b32 v26, 16, v129
v_and_b32 v27, 0xffff0000, v129
v_lshlrev_b32 v28, 16, v130
v_and_b32 v29, 0xffff0000, v130
v_lshlrev_b32 v30, 16, v131
v_and_b32 v31, 0xffff0000, v131
v_pk_fma_f32 v[24:25], v[24:25], v[98:99], v[98:99] op_sel:[0,0,1] op_sel_hi:[1,0,1]
v_pk_fma_f32 v[26:27], v[26:27], v[98:99], v[98:99] op_sel:[0,0,1] op_sel_hi:[1,0,1]
v_pk_fma_f32 v[28:29], v[28:29], v[98:99], v[98:99] op_sel:[0,0,1] op_sel_hi:[1,0,1]
v_pk_fma_f32 v[30:31], v[30:31], v[98:99], v[98:99] op_sel:[0,0,1] op_sel_hi:[1,0,1]
v_cvt_pk_f16_f32 v128, v24, v25
v_cvt_pk_f16_f32 v129, v26, v27
v_cvt_pk_f16_f32 v130, v28, v29
v_cvt_pk_f16_f32 v131, v30, v31
v_lshlrev_b32 v24, 16, v132
v_and_b32 v25, 0xffff0000, v132
v_lshlrev_b32 v26, 16, v133
v_and_b32 v27, 0xffff0000, v133
v_lshlrev_b32 v28, 16, v134
v_and_b32 v29, 0xffff0000, v134
v_lshlrev_b32 v30, 16, v135
v_and_b32 v31, 0xffff0000, v135
v_pk_fma_f32 v[24:25], v[24:25], v[98:99], v[98:99] op_sel:[0,0,1] op_sel_hi:[1,0,1]
v_pk_fma_f32 v[26:27], v[26:27], v[98:99], v[98:99] op_sel:[0,0,1] op_sel_hi:[1,0,1]
v_pk_fma_f32 v[28:29], v[28:29], v[98:99], v[98:99] op_sel:[0,0,1] op_sel_hi:[1,0,1]
v_pk_fma_f32 v[30:31], v[30:31], v[98:99], v[98:99] op_sel:[0,0,1] op_sel_hi:[1,0,1]
v_cvt_pk_f16_f32 v132, v24, v25
v_cvt_pk_f16_f32 v133, v26, v27
v_cvt_pk_f16_f32 v134, v28, v29
v_cvt_pk_f16_f32 v135, v30, v31
v_lshlrev_b32 v24, 16, v136
v_and_b32 v25, 0xffff0000, v136
v_lshlrev_b32 v26, 16, v137
v_and_b32 v27, 0xffff0000, v137
v_lshlrev_b32 v28, 16, v138
v_and_b32 v29, 0xffff0000, v138
v_lshlrev_b32 v30, 16, v139
v_and_b32 v31, 0xffff0000, v139
v_pk_fma_f32 v[24:25], v[24:25], v[98:99], v[98:99] op_sel:[0,0,1] op_sel_hi:[1,0,1]
v_pk_fma_f32 v[26:27], v[26:27], v[98:99], v[98:99] op_sel:[0,0,1] op_sel_hi:[1,0,1]
v_pk_fma_f32 v[28:29], v[28:29], v[98:99], v[98:99] op_sel:[0,0,1] op_sel_hi:[1,0,1]
v_pk_fma_f32 v[30:31], v[30:31], v[98:99], v[98:99] op_sel:[0,0,1] op_sel_hi:[1,0,1]
v_pk_fma_f32 v[92:93], v[92:93], v[98:99], v[98:99] op_sel:[0,0,1] op_sel_hi:[1,0,1]
v_pk_fma_f32 v[94:95], v[94:95], v[98:99], v[98:99] op_sel:[0,0,1] op_sel_hi:[1,0,1]
v_pk_fma_f32 v[120:121], v[120:121], v[98:99], v[98:99] op_sel:[0,0,1] op_sel_hi:[1,0,1]
v_pk_fma_f32 v[122:123], v[122:123], v[98:99], v[98:99] op_sel:[0,0,1] op_sel_hi:[1,0,1]
v_cvt_pk_f16_f32 v136, v24, v25
v_cvt_pk_f16_f32 v137, v26, v27
v_cvt_pk_f16_f32 v138, v28, v29
v_cvt_pk_f16_f32 v139, v30, v31
s_waitcnt vmcnt(7)
buffer_store_dwordx4 v[240:243], v246, s[4:7], s53 offen sc1
s_barrier
s_waitcnt vmcnt(6)
s_mov_b32 s55, 0x3f803f80
buffer_load_dwordx4 v[180:183], v4, s[8:11], s61 offen offset:0
v_mfma_f32_16x16x32_bf16 v[20:23], a[236:239], v[140:143], 0
v_lshlrev_b32 v24, 16, v144
v_and_b32 v25, 0xffff0000, v144
v_mfma_f32_16x16x32_bf16 v[20:23], a[236:239], v[144:147], v[20:23]
v_lshlrev_b32 v26, 16, v145
v_and_b32 v27, 0xffff0000, v145
v_mfma_f32_16x16x32_bf16 v[20:23], a[236:239], v[148:151], v[20:23]
v_lshlrev_b32 v28, 16, v146
v_and_b32 v29, 0xffff0000, v146
v_mfma_f32_16x16x32_bf16 v[20:23], a[236:239], v[152:155], v[20:23]
buffer_load_dwordx4 v[184:187], v4, s[8:11], s61 offen offset:256
v_lshlrev_b32 v30, 16, v147
v_and_b32 v31, 0xffff0000, v147
v_mfma_f32_16x16x32_bf16 v[20:23], a[236:239], v[156:159], v[20:23]
v_lshlrev_b32 v72, 16, v140
v_and_b32 v73, 0xffff0000, v140
v_lshlrev_b32 v74, 16, v141
v_and_b32 v75, 0xffff0000, v141
v_dot2_f32_bf16 v84, v140, v140, 0
v_dot2_f32_bf16 v85, v141, v141, 0
buffer_load_dwordx4 v[188:191], v4, s[8:11], s61 offen offset:512
v_dot2_f32_bf16 v84, v142, v142, v84
v_dot2_f32_bf16 v85, v143, v143, v85
v_dot2_f32_bf16 v84, v144, v144, v84
v_dot2_f32_bf16 v85, v145, v145, v85
v_dot2_f32_bf16 v84, v146, v146, v84
v_dot2_f32_bf16 v85, v147, v147, v85
v_dot2_f32_bf16 v84, v148, v148, v84
v_dot2_f32_bf16 v85, v149, v149, v85
v_dot2_f32_bf16 v84, v150, v150, v84
v_dot2_f32_bf16 v85, v151, v151, v85
buffer_load_dwordx4 v[192:195], v4, s[8:11], s61 offen offset:768
v_dot2_f32_bf16 v84, v152, v152, v84
v_dot2_f32_bf16 v85, v153, v153, v85
v_dot2_f32_bf16 v84, v154, v154, v84
v_dot2_f32_bf16 v85, v155, v155, v85
v_dot2_f32_bf16 v84, v156, v156, v84
v_dot2_f32_bf16 v85, v157, v157, v85
v_dot2_f32_bf16 v84, v158, v158, v84
v_dot2_f32_bf16 v85, v159, v159, v85
v_add_f32_dpp v20, v20, v20 row_ror:8 row_mask:0xf bank_mask:0xf
v_lshlrev_b32 v140, 16, v142
buffer_load_dwordx4 v[196:199], v4, s[8:11], s61 offen offset:1024
v_and_b32 v141, 0xffff0000, v142
v_add_f32 v84, v84, v85
v_add_f32_dpp v20, v20, v20 row_ror:4 row_mask:0xf bank_mask:0xf
v_lshlrev_b32 v142, 16, v143
v_add_f32_dpp v84, v84, v84 row_ror:8 row_mask:0xf bank_mask:0xf
v_add_f32_dpp v20, v20, v20 row_ror:2 row_mask:0xf bank_mask:0xf
v_and_b32 v143, 0xffff0000, v143
v_add_f32_dpp v84, v84, v84 row_ror:4 row_mask:0xf bank_mask:0xf
v_add_f32_dpp v20, v20, v20 row_ror:1 row_mask:0xf bank_mask:0xf
buffer_store_dwordx4 a[232:235], v11, s[4:7], s46 offen sc1
v_mul_f32 v20, 0x3acccccd, v20
v_add_f32_dpp v84, v84, v84 row_ror:2 row_mask:0xf bank_mask:0xf
s_nop 1
v_add_f32_dpp v84, v84, v84 row_ror:1 row_mask:0xf bank_mask:0xf
v_mul_f32 v84, 0x3acccccd, v84
v_fma_f32 v84, -v20, v20, v84
v_max_f32 v84, 0, v84
v_add_f32 v84, 0x3727c5ac, v84
v_rsq_f32 v84, v84
s_nop 0
v_mul_f32 v85, -v20, v84
v_pk_fma_f32 v[24:25], v[24:25], v[84:85], v[84:85] op_sel:[0,0,1] op_sel_hi:[1,0,1]
buffer_store_dwordx4 a[232:235], v12, s[4:7], s46 offen sc1
v_pk_fma_f32 v[26:27], v[26:27], v[84:85], v[84:85] op_sel:[0,0,1] op_sel_hi:[1,0,1]
v_pk_fma_f32 v[28:29], v[28:29], v[84:85], v[84:85] op_sel:[0,0,1] op_sel_hi:[1,0,1]
v_pk_fma_f32 v[30:31], v[30:31], v[84:85], v[84:85] op_sel:[0,0,1] op_sel_hi:[1,0,1]
v_cvt_pk_f16_f32 v144, v24, v25
v_cvt_pk_f16_f32 v145, v26, v27
v_cvt_pk_f16_f32 v146, v28, v29
v_cvt_pk_f16_f32 v147, v30, v31
v_lshlrev_b32 v24, 16, v148
v_and_b32 v25, 0xffff0000, v148
v_lshlrev_b32 v26, 16, v149
buffer_store_dwordx4 a[232:235], v13, s[4:7], s46 offen sc1
v_and_b32 v27, 0xffff0000, v149
v_lshlrev_b32 v28, 16, v150
v_and_b32 v29, 0xffff0000, v150
v_lshlrev_b32 v30, 16, v151
v_and_b32 v31, 0xffff0000, v151
v_pk_fma_f32 v[24:25], v[24:25], v[84:85], v[84:85] op_sel:[0,0,1] op_sel_hi:[1,0,1]
v_pk_fma_f32 v[26:27], v[26:27], v[84:85], v[84:85] op_sel:[0,0,1] op_sel_hi:[1,0,1]
v_pk_fma_f32 v[28:29], v[28:29], v[84:85], v[84:85] op_sel:[0,0,1] op_sel_hi:[1,0,1]
v_pk_fma_f32 v[30:31], v[30:31], v[84:85], v[84:85] op_sel:[0,0,1] op_sel_hi:[1,0,1]
v_cvt_pk_f16_f32 v148, v24, v25
buffer_store_dwordx4 a[232:235], v14, s[4:7], s46 offen sc1
v_cvt_pk_f16_f32 v149, v26, v27
v_cvt_pk_f16_f32 v150, v28, v29
v_cvt_pk_f16_f32 v151, v30, v31
v_lshlrev_b32 v24, 16, v152
v_and_b32 v25, 0xffff0000, v152
v_lshlrev_b32 v26, 16, v153
v_and_b32 v27, 0xffff0000, v153
v_lshlrev_b32 v28, 16, v154
v_and_b32 v29, 0xffff0000, v154
buffer_store_dwordx4 a[232:235], v246, s[4:7], s18 offen sc1
v_lshlrev_b32 v30, 16, v155
v_and_b32 v31, 0xffff0000, v155
v_pk_fma_f32 v[24:25], v[24:25], v[84:85], v[84:85] op_sel:[0,0,1] op_sel_hi:[1,0,1]
v_pk_fma_f32 v[26:27], v[26:27], v[84:85], v[84:85] op_sel:[0,0,1] op_sel_hi:[1,0,1]
v_pk_fma_f32 v[28:29], v[28:29], v[84:85], v[84:85] op_sel:[0,0,1] op_sel_hi:[1,0,1]
v_pk_fma_f32 v[30:31], v[30:31], v[84:85], v[84:85] op_sel:[0,0,1] op_sel_hi:[1,0,1]
v_cvt_pk_f16_f32 v152, v24, v25
v_cvt_pk_f16_f32 v153, v26, v27
v_cvt_pk_f16_f32 v154, v28, v29
v_cvt_pk_f16_f32 v155, v30, v31
s_add_u32 s37, s18, 8192
buffer_store_dwordx4 a[232:235], v246, s[4:7], s37 offen sc1
v_lshlrev_b32 v24, 16, v156
v_and_b32 v25, 0xffff0000, v156
v_lshlrev_b32 v26, 16, v157
v_and_b32 v27, 0xffff0000, v157
v_lshlrev_b32 v28, 16, v158
v_and_b32 v29, 0xffff0000, v158
v_lshlrev_b32 v30, 16, v159
v_and_b32 v31, 0xffff0000, v159
v_pk_fma_f32 v[24:25], v[24:25], v[84:85], v[84:85] op_sel:[0,0,1] op_sel_hi:[1,0,1]
v_pk_fma_f32 v[26:27], v[26:27], v[84:85], v[84:85] op_sel:[0,0,1] op_sel_hi:[1,0,1]
s_lshl_b32 s37, s47, 2
s_add_u32 s37, s37, s3
s_lshl_b32 s37, s37, 3
s_add_u32 s37, s37, s96
s_lshl_b32 s37, s37, 8
s_add_u32 s37, s37, 131072
v_lshlrev_b32 v69, 2, v1
v_xor_b32 v70, 0xff, v19
buffer_store_dword v70, v69, s[4:7], s37 offen sc1
v_pk_fma_f32 v[28:29], v[28:29], v[84:85], v[84:85] op_sel:[0,0,1] op_sel_hi:[1,0,1]
v_pk_fma_f32 v[30:31], v[30:31], v[84:85], v[84:85] op_sel:[0,0,1] op_sel_hi:[1,0,1]
v_pk_fma_f32 v[72:73], v[72:73], v[84:85], v[84:85] op_sel:[0,0,1] op_sel_hi:[1,0,1]
v_pk_fma_f32 v[74:75], v[74:75], v[84:85], v[84:85] op_sel:[0,0,1] op_sel_hi:[1,0,1]
v_pk_fma_f32 v[140:141], v[140:141], v[84:85], v[84:85] op_sel:[0,0,1] op_sel_hi:[1,0,1]
v_pk_fma_f32 v[142:143], v[142:143], v[84:85], v[84:85] op_sel:[0,0,1] op_sel_hi:[1,0,1]
v_cvt_pk_f16_f32 v156, v24, v25
v_cvt_pk_f16_f32 v157, v26, v27
v_cvt_pk_f16_f32 v158, v28, v29
v_cvt_pk_f16_f32 v159, v30, v31
s_waitcnt vmcnt(13)
s_mov_b32 s55, 0x3f803f80
v_mfma_f32_16x16x32_bf16 v[20:23], a[236:239], v[160:163], 0
v_lshlrev_b32 v24, 16, v164
v_and_b32 v25, 0xffff0000, v164
v_mfma_f32_16x16x32_bf16 v[20:23], a[236:239], v[164:167], v[20:23]
v_lshlrev_b32 v26, 16, v165
v_and_b32 v27, 0xffff0000, v165
v_mfma_f32_16x16x32_bf16 v[20:23], a[236:239], v[168:171], v[20:23]
v_lshlrev_b32 v28, 16, v166
v_and_b32 v29, 0xffff0000, v166
v_mfma_f32_16x16x32_bf16 v[20:23], a[236:239], v[172:175], v[20:23]
v_lshlrev_b32 v30, 16, v167
v_and_b32 v31, 0xffff0000, v167
v_mfma_f32_16x16x32_bf16 v[20:23], a[236:239], v[176:179], v[20:23]
v_lshlrev_b32 v76, 16, v160
v_and_b32 v77, 0xffff0000, v160
v_lshlrev_b32 v78, 16, v161
v_and_b32 v79, 0xffff0000, v161
v_dot2_f32_bf16 v86, v160, v160, 0
v_dot2_f32_bf16 v87, v161, v161, 0
v_dot2_f32_bf16 v86, v162, v162, v86
v_dot2_f32_bf16 v87, v163, v163, v87
v_dot2_f32_bf16 v86, v164, v164, v86
v_dot2_f32_bf16 v87, v165, v165, v87
v_dot2_f32_bf16 v86, v166, v166, v86
v_dot2_f32_bf16 v87, v167, v167, v87
v_dot2_f32_bf16 v86, v168, v168, v86
v_dot2_f32_bf16 v87, v169, v169, v87
v_dot2_f32_bf16 v86, v170, v170, v86
v_dot2_f32_bf16 v87, v171, v171, v87
v_dot2_f32_bf16 v86, v172, v172, v86
v_dot2_f32_bf16 v87, v173, v173, v87
v_dot2_f32_bf16 v86, v174, v174, v86
v_dot2_f32_bf16 v87, v175, v175, v87
v_dot2_f32_bf16 v86, v176, v176, v86
v_dot2_f32_bf16 v87, v177, v177, v87
v_dot2_f32_bf16 v86, v178, v178, v86
v_dot2_f32_bf16 v87, v179, v179, v87
v_add_f32_dpp v20, v20, v20 row_ror:8 row_mask:0xf bank_mask:0xf
v_lshlrev_b32 v160, 16, v162
v_and_b32 v161, 0xffff0000, v162
v_add_f32 v86, v86, v87
v_add_f32_dpp v20, v20, v20 row_ror:4 row_mask:0xf bank_mask:0xf
v_lshlrev_b32 v162, 16, v163
v_add_f32_dpp v86, v86, v86 row_ror:8 row_mask:0xf bank_mask:0xf
v_add_f32_dpp v20, v20, v20 row_ror:2 row_mask:0xf bank_mask:0xf
v_and_b32 v163, 0xffff0000, v163
v_add_f32_dpp v86, v86, v86 row_ror:4 row_mask:0xf bank_mask:0xf
v_add_f32_dpp v20, v20, v20 row_ror:1 row_mask:0xf bank_mask:0xf
v_mul_f32 v20, 0x3acccccd, v20
v_add_f32_dpp v86, v86, v86 row_ror:2 row_mask:0xf bank_mask:0xf
s_nop 1
v_add_f32_dpp v86, v86, v86 row_ror:1 row_mask:0xf bank_mask:0xf
v_mul_f32 v86, 0x3acccccd, v86
v_fma_f32 v86, -v20, v20, v86
v_max_f32 v86, 0, v86
v_add_f32 v86, 0x3727c5ac, v86
v_rsq_f32 v86, v86
s_nop 0
v_mul_f32 v87, -v20, v86
v_pk_fma_f32 v[24:25], v[24:25], v[86:87], v[86:87] op_sel:[0,0,1] op_sel_hi:[1,0,1]
v_pk_fma_f32 v[26:27], v[26:27], v[86:87], v[86:87] op_sel:[0,0,1] op_sel_hi:[1,0,1]
v_pk_fma_f32 v[28:29], v[28:29], v[86:87], v[86:87] op_sel:[0,0,1] op_sel_hi:[1,0,1]
v_pk_fma_f32 v[30:31], v[30:31], v[86:87], v[86:87] op_sel:[0,0,1] op_sel_hi:[1,0,1]
v_cvt_pk_f16_f32 v164, v24, v25
v_cvt_pk_f16_f32 v165, v26, v27
v_cvt_pk_f16_f32 v166, v28, v29
v_cvt_pk_f16_f32 v167, v30, v31
v_lshlrev_b32 v24, 16, v168
v_and_b32 v25, 0xffff0000, v168
v_lshlrev_b32 v26, 16, v169
v_and_b32 v27, 0xffff0000, v169
v_lshlrev_b32 v28, 16, v170
v_and_b32 v29, 0xffff0000, v170
v_lshlrev_b32 v30, 16, v171
v_and_b32 v31, 0xffff0000, v171
v_pk_fma_f32 v[24:25], v[24:25], v[86:87], v[86:87] op_sel:[0,0,1] op_sel_hi:[1,0,1]
v_pk_fma_f32 v[26:27], v[26:27], v[86:87], v[86:87] op_sel:[0,0,1] op_sel_hi:[1,0,1]
v_pk_fma_f32 v[28:29], v[28:29], v[86:87], v[86:87] op_sel:[0,0,1] op_sel_hi:[1,0,1]
v_pk_fma_f32 v[30:31], v[30:31], v[86:87], v[86:87] op_sel:[0,0,1] op_sel_hi:[1,0,1]
v_cvt_pk_f16_f32 v168, v24, v25
v_cvt_pk_f16_f32 v169, v26, v27
v_cvt_pk_f16_f32 v170, v28, v29
v_cvt_pk_f16_f32 v171, v30, v31
v_lshlrev_b32 v24, 16, v172
v_and_b32 v25, 0xffff0000, v172
v_lshlrev_b32 v26, 16, v173
v_and_b32 v27, 0xffff0000, v173
v_lshlrev_b32 v28, 16, v174
v_and_b32 v29, 0xffff0000, v174
v_lshlrev_b32 v30, 16, v175
v_and_b32 v31, 0xffff0000, v175
v_pk_fma_f32 v[24:25], v[24:25], v[86:87], v[86:87] op_sel:[0,0,1] op_sel_hi:[1,0,1]
v_pk_fma_f32 v[26:27], v[26:27], v[86:87], v[86:87] op_sel:[0,0,1] op_sel_hi:[1,0,1]
v_pk_fma_f32 v[28:29], v[28:29], v[86:87], v[86:87] op_sel:[0,0,1] op_sel_hi:[1,0,1]
v_pk_fma_f32 v[30:31], v[30:31], v[86:87], v[86:87] op_sel:[0,0,1] op_sel_hi:[1,0,1]
v_cvt_pk_f16_f32 v172, v24, v25
v_cvt_pk_f16_f32 v173, v26, v27
v_cvt_pk_f16_f32 v174, v28, v29
v_cvt_pk_f16_f32 v175, v30, v31
v_lshlrev_b32 v24, 16, v176
v_and_b32 v25, 0xffff0000, v176
v_lshlrev_b32 v26, 16, v177
v_and_b32 v27, 0xffff0000, v177
v_lshlrev_b32 v28, 16, v178
v_and_b32 v29, 0xffff0000, v178
v_lshlrev_b32 v30, 16, v179
v_and_b32 v31, 0xffff0000, v179
v_pk_fma_f32 v[24:25], v[24:25], v[86:87], v[86:87] op_sel:[0,0,1] op_sel_hi:[1,0,1]
v_pk_fma_f32 v[26:27], v[26:27], v[86:87], v[86:87] op_sel:[0,0,1] op_sel_hi:[1,0,1]
v_pk_fma_f32 v[28:29], v[28:29], v[86:87], v[86:87] op_sel:[0,0,1] op_sel_hi:[1,0,1]
v_pk_fma_f32 v[30:31], v[30:31], v[86:87], v[86:87] op_sel:[0,0,1] op_sel_hi:[1,0,1]
v_pk_fma_f32 v[76:77], v[76:77], v[86:87], v[86:87] op_sel:[0,0,1] op_sel_hi:[1,0,1]
v_pk_fma_f32 v[78:79], v[78:79], v[86:87], v[86:87] op_sel:[0,0,1] op_sel_hi:[1,0,1]
v_pk_fma_f32 v[160:161], v[160:161], v[86:87], v[86:87] op_sel:[0,0,1] op_sel_hi:[1,0,1]
v_pk_fma_f32 v[162:163], v[162:163], v[86:87], v[86:87] op_sel:[0,0,1] op_sel_hi:[1,0,1]
v_cvt_pk_f16_f32 v176, v24, v25
v_cvt_pk_f16_f32 v177, v26, v27
v_cvt_pk_f16_f32 v178, v28, v29
v_cvt_pk_f16_f32 v179, v30, v31
buffer_load_dwordx4 v[40:43], v248, s[4:7], s56 offen sc1
s_waitcnt vmcnt(8)
s_mov_b32 s55, 0x3f803f80
v_mfma_f32_16x16x32_bf16 v[20:23], a[236:239], v[180:183], 0
v_lshlrev_b32 v24, 16, v184
v_and_b32 v25, 0xffff0000, v184
v_mfma_f32_16x16x32_bf16 v[20:23], a[236:239], v[184:187], v[20:23]
v_lshlrev_b32 v26, 16, v185
v_and_b32 v27, 0xffff0000, v185
v_mfma_f32_16x16x32_bf16 v[20:23], a[236:239], v[188:191], v[20:23]
buffer_load_dwordx4 v[44:47], v248, s[4:7], s57 offen sc1
v_lshlrev_b32 v28, 16, v186
v_and_b32 v29, 0xffff0000, v186
v_mfma_f32_16x16x32_bf16 v[20:23], a[236:239], v[192:195], v[20:23]
v_lshlrev_b32 v30, 16, v187
v_and_b32 v31, 0xffff0000, v187
v_mfma_f32_16x16x32_bf16 v[20:23], a[236:239], v[196:199], v[20:23]
v_lshlrev_b32 v80, 16, v180
v_and_b32 v81, 0xffff0000, v180
v_lshlrev_b32 v82, 16, v181
buffer_load_dwordx4 v[48:51], v248, s[4:7], s58 offen sc1
v_and_b32 v83, 0xffff0000, v181
v_dot2_f32_bf16 v66, v180, v180, 0
v_dot2_f32_bf16 v67, v181, v181, 0
v_dot2_f32_bf16 v66, v182, v182, v66
v_dot2_f32_bf16 v67, v183, v183, v67
v_dot2_f32_bf16 v66, v184, v184, v66
v_dot2_f32_bf16 v67, v185, v185, v67
v_dot2_f32_bf16 v66, v186, v186, v66
v_dot2_f32_bf16 v67, v187, v187, v67
buffer_load_dword v52, v249, s[4:7], s56 offen sc1
v_dot2_f32_bf16 v66, v188, v188, v66
v_dot2_f32_bf16 v67, v189, v189, v67
v_dot2_f32_bf16 v66, v190, v190, v66
v_dot2_f32_bf16 v67, v191, v191, v67
v_dot2_f32_bf16 v66, v192, v192, v66
v_dot2_f32_bf16 v67, v193, v193, v67
v_dot2_f32_bf16 v66, v194, v194, v66
v_dot2_f32_bf16 v67, v195, v195, v67
v_dot2_f32_bf16 v66, v196, v196, v66
buffer_load_dword v53, v249, s[4:7], s57 offen sc1
v_dot2_f32_bf16 v67, v197, v197, v67
v_dot2_f32_bf16 v66, v198, v198, v66
v_dot2_f32_bf16 v67, v199, v199, v67
v_add_f32_dpp v20, v20, v20 row_ror:8 row_mask:0xf bank_mask:0xf
v_lshlrev_b32 v180, 16, v182
v_and_b32 v181, 0xffff0000, v182
v_add_f32 v66, v66, v67
v_add_f32_dpp v20, v20, v20 row_ror:4 row_mask:0xf bank_mask:0xf
v_lshlrev_b32 v182, 16, v183
buffer_load_dword v54, v249, s[4:7], s58 offen sc1
v_add_f32_dpp v66, v66, v66 row_ror:8 row_mask:0xf bank_mask:0xf
v_add_f32_dpp v20, v20, v20 row_ror:2 row_mask:0xf bank_mask:0xf
v_and_b32 v183, 0xffff0000, v183
v_add_f32_dpp v66, v66, v66 row_ror:4 row_mask:0xf bank_mask:0xf
v_add_f32_dpp v20, v20, v20 row_ror:1 row_mask:0xf bank_mask:0xf
v_mul_f32 v20, 0x3acccccd, v20
v_add_f32_dpp v66, v66, v66 row_ror:2 row_mask:0xf bank_mask:0xf
s_nop 1
v_add_f32_dpp v66, v66, v66 row_ror:1 row_mask:0xf bank_mask:0xf
v_mul_f32 v66, 0x3acccccd, v66
buffer_load_dword v71, v247, s[4:7], s60 offen sc1
v_fma_f32 v66, -v20, v20, v66
v_max_f32 v66, 0, v66
v_add_f32 v66, 0x3727c5ac, v66
v_rsq_f32 v66, v66
s_nop 0
v_mul_f32 v67, -v20, v66
v_pk_fma_f32 v[24:25], v[24:25], v[66:67], v[66:67] op_sel:[0,0,1] op_sel_hi:[1,0,1]
v_pk_fma_f32 v[26:27], v[26:27], v[66:67], v[66:67] op_sel:[0,0,1] op_sel_hi:[1,0,1]
v_pk_fma_f32 v[28:29], v[28:29], v[66:67], v[66:67] op_sel:[0,0,1] op_sel_hi:[1,0,1]
v_pk_fma_f32 v[30:31], v[30:31], v[66:67], v[66:67] op_sel:[0,0,1] op_sel_hi:[1,0,1]
v_cvt_pk_f16_f32 v184, v24, v25
s_add_u32 m0, s39, 0
s_nop 0
buffer_load_dwordx4 v232, s[24:27], s48 offen offset:0 lds
v_cvt_pk_f16_f32 v185, v26, v27
v_cvt_pk_f16_f32 v186, v28, v29
v_cvt_pk_f16_f32 v187, v30, v31
v_lshlrev_b32 v24, 16, v188
v_and_b32 v25, 0xffff0000, v188
v_lshlrev_b32 v26, 16, v189
v_and_b32 v27, 0xffff0000, v189
v_lshlrev_b32 v28, 16, v190
v_and_b32 v29, 0xffff0000, v190
buffer_load_dwordx4 v233, s[24:27], s48 offen offset:1024 lds
v_lshlrev_b32 v30, 16, v191
v_and_b32 v31, 0xffff0000, v191
v_pk_fma_f32 v[24:25], v[24:25], v[66:67], v[66:67] op_sel:[0,0,1] op_sel_hi:[1,0,1]
v_pk_fma_f32 v[26:27], v[26:27], v[66:67], v[66:67] op_sel:[0,0,1] op_sel_hi:[1,0,1]
v_pk_fma_f32 v[28:29], v[28:29], v[66:67], v[66:67] op_sel:[0,0,1] op_sel_hi:[1,0,1]
v_pk_fma_f32 v[30:31], v[30:31], v[66:67], v[66:67] op_sel:[0,0,1] op_sel_hi:[1,0,1]
v_cvt_pk_f16_f32 v188, v24, v25
v_cvt_pk_f16_f32 v189, v26, v27
v_cvt_pk_f16_f32 v190, v28, v29
buffer_load_dwordx4 v234, s[24:27], s48 offen offset:2048 lds
s_add_u32 s48, s48, 81920
v_cvt_pk_f16_f32 v191, v30, v31
v_lshlrev_b32 v24, 16, v192
v_and_b32 v25, 0xffff0000, v192
v_lshlrev_b32 v26, 16, v193
v_and_b32 v27, 0xffff0000, v193
v_lshlrev_b32 v28, 16, v194
v_and_b32 v29, 0xffff0000, v194
v_lshlrev_b32 v30, 16, v195
v_and_b32 v31, 0xffff0000, v195
s_add_u32 m0, s39, 12288
s_nop 0
buffer_load_dwordx4 v232, s[24:27], s48 offen offset:0 lds
v_pk_fma_f32 v[24:25], v[24:25], v[66:67], v[66:67] op_sel:[0,0,1] op_sel_hi:[1,0,1]
v_pk_fma_f32 v[26:27], v[26:27], v[66:67], v[66:67] op_sel:[0,0,1] op_sel_hi:[1,0,1]
v_pk_fma_f32 v[28:29], v[28:29], v[66:67], v[66:67] op_sel:[0,0,1] op_sel_hi:[1,0,1]
v_pk_fma_f32 v[30:31], v[30:31], v[66:67], v[66:67] op_sel:[0,0,1] op_sel_hi:[1,0,1]
v_cvt_pk_f16_f32 v192, v24, v25
v_cvt_pk_f16_f32 v193, v26, v27
v_cvt_pk_f16_f32 v194, v28, v29
v_cvt_pk_f16_f32 v195, v30, v31
v_lshlrev_b32 v24, 16, v196
buffer_load_dwordx4 v233, s[24:27], s48 offen offset:1024 lds
v_and_b32 v25, 0xffff0000, v196
v_lshlrev_b32 v26, 16, v197
v_and_b32 v27, 0xffff0000, v197
v_lshlrev_b32 v28, 16, v198
v_and_b32 v29, 0xffff0000, v198
v_lshlrev_b32 v30, 16, v199
v_and_b32 v31, 0xffff0000, v199
v_pk_fma_f32 v[24:25], v[24:25], v[66:67], v[66:67] op_sel:[0,0,1] op_sel_hi:[1,0,1]
v_pk_fma_f32 v[26:27], v[26:27], v[66:67], v[66:67] op_sel:[0,0,1] op_sel_hi:[1,0,1]
buffer_load_dwordx4 v234, s[24:27], s48 offen offset:2048 lds
s_add_u32 s48, s48, 81920
v_pk_fma_f32 v[28:29], v[28:29], v[66:67], v[66:67] op_sel:[0,0,1] op_sel_hi:[1,0,1]
v_pk_fma_f32 v[30:31], v[30:31], v[66:67], v[66:67] op_sel:[0,0,1] op_sel_hi:[1,0,1]
v_pk_fma_f32 v[80:81], v[80:81], v[66:67], v[66:67] op_sel:[0,0,1] op_sel_hi:[1,0,1]
v_pk_fma_f32 v[82:83], v[82:83], v[66:67], v[66:67] op_sel:[0,0,1] op_sel_hi:[1,0,1]
v_pk_fma_f32 v[180:181], v[180:181], v[66:67], v[66:67] op_sel:[0,0,1] op_sel_hi:[1,0,1]
v_pk_fma_f32 v[182:183], v[182:183], v[66:67], v[66:67] op_sel:[0,0,1] op_sel_hi:[1,0,1]
v_cvt_pk_f16_f32 v196, v24, v25
v_cvt_pk_f16_f32 v197, v26, v27
v_cvt_pk_f16_f32 v198, v28, v29
v_cvt_pk_f16_f32 v199, v30, v31
L_bodyj:
s_and_b32 s12, s40, 0xff
s_bfe_u32 s13, s40, 0x80008
s_bfe_u32 s14, s40, 0x80010
s_lshr_b32 s15, s40, 24
s_waitcnt vmcnt(7)
v_xor_b32 v40, s12, v40
v_xor_b32 v41, s13, v41
v_xor_b32 v42, s14, v42
v_xor_b32 v43, s15, v43
v_xor_b32 v44, s12, v44
v_xor_b32 v45, s13, v45
v_xor_b32 v46, s14, v46
v_xor_b32 v47, s15, v47
v_xor_b32 v48, s12, v48
v_xor_b32 v49, s13, v49
v_xor_b32 v50, s14, v50
v_xor_b32 v51, s15, v51
v_xor_b32 v52, v19, v52
v_xor_b32 v53, v19, v53
v_xor_b32 v54, v19, v54
v_or3_b32 v64, v40, v41, v42
v_or3_b32 v65, v43, v44, v45
v_or3_b32 v64, v64, v46, v47
v_or3_b32 v65, v65, v48, v49
v_or3_b32 v64, v64, v50, v51
v_or3_b32 v65, v65, v52, v53
v_or3_b32 v64, v64, v65, v54
v_and_b32 v64, 0xff, v64
v_cmp_ne_u32 vcc, 0, v64
s_cbranch_vccnz L_ga_retry
L_ga_ok:
v_pk_add_f32 v[40:41], v[40:41], v[44:45]
v_pk_add_f32 v[42:43], v[42:43], v[46:47]
v_add_f32 v52, v52, v53
v_pk_add_f32 v[40:41], v[40:41], v[48:49]
v_pk_add_f32 v[42:43], v[42:43], v[50:51]
v_add_f32 v52, v52, v54
v_cvt_pk_bf16_f32 v44, v40, v41
v_cvt_pk_bf16_f32 v45, v42, v43
v_cvt_pk_bf16_f32 v52, v52, v52
v_lshlrev_b32 v40, 16, v44
v_and_b32 v41, 0xffff0000, v44
v_lshlrev_b32 v42, 16, v45
v_and_b32 v43, 0xffff0000, v45
v_lshlrev_b32 v52, 16, v52
v_pk_add_f32 v[40:41], v[40:41], v[252:253] op_sel_hi:[1,0]
v_pk_add_f32 v[42:43], v[42:43], v[252:253] op_sel_hi:[1,0]
v_add_f32 v52, v52, v252
v_cvt_pk_bf16_f32 v44, v40, v41
v_cvt_pk_bf16_f32 v45, v42, v43
v_cvt_pk_bf16_f32 v52, v52, v52
v_lshlrev_b32 v40, 16, v44
v_and_b32 v41, 0xffff0000, v44
v_lshlrev_b32 v42, 16, v45
v_and_b32 v43, 0xffff0000, v45
v_lshlrev_b32 v52, 16, v52
ds_write_b128 v251, v[40:43]
ds_write_b32 v250, v52
s_waitcnt vmcnt(6)
v_cmp_ne_u32 vcc, s40, v71
s_cbranch_vccnz L_fg_retry
L_fg_ok:
s_waitcnt lgkmcnt(0)
s_barrier
buffer_load_dwordx4 a[40:43], v5, s[4:7], s59 offen offset:0 sc1
ds_read_b128 v[200:203], v10 offset:2560
ds_read_b128 v[204:207], v10 offset:2576
ds_read_b128 v[208:211], v10 offset:0
ds_read_b128 v[212:215], v10 offset:16
buffer_load_dwordx4 a[44:47], v5, s[4:7], s59 offen offset:256 sc1
s_mul_i32 s52, s96, 192
s_mul_i32 s49, s3, 3072
s_lshl_b32 s53, s47, 2
s_add_u32 s53, s53, s3
s_and_b32 s50, s53, 63
buffer_load_dwordx4 a[48:51], v5, s[4:7], s59 offen offset:512 sc1
s_waitcnt lgkmcnt(0)
v_pk_fma_f32 v[216:217], v[88:89], v[200:201], v[208:209]
v_cvt_pk_bf16_f32 v220, v216, v217
v_pk_fma_f32 v[218:219], v[90:91], v[202:203], v[210:211]
v_cvt_pk_bf16_f32 v221, v218, v219
buffer_load_dwordx4 a[52:55], v6, s[4:7], s59 offen offset:768 sc1
s_add_u32 s59, s59, 16384
v_pk_fma_f32 v[216:217], v[100:101], v[204:205], v[212:213]
v_cvt_pk_bf16_f32 v222, v216, v217
v_pk_fma_f32 v[218:219], v[102:103], v[206:207], v[214:215]
v_cvt_pk_bf16_f32 v223, v218, v219
ds_write_b128 v7, v[220:223] offset:0
buffer_load_dwordx4 a[56:59], v5, s[4:7], s59 offen offset:0 sc1
v_pk_fma_f32 v[216:217], v[92:93], v[200:201], v[208:209]
v_cvt_pk_bf16_f32 v224, v216, v217
v_pk_fma_f32 v[218:219], v[94:95], v[202:203], v[210:211]
v_cvt_pk_bf16_f32 v225, v218, v219
v_pk_fma_f32 v[216:217], v[120:121], v[204:205], v[212:213]
buffer_load_dwordx4 a[60:63], v5, s[4:7], s59 offen offset:256 sc1
v_cvt_pk_bf16_f32 v226, v216, v217
v_pk_fma_f32 v[218:219], v[122:123], v[206:207], v[214:215]
v_cvt_pk_bf16_f32 v227, v218, v219
ds_write_b128 v253, v[224:227] offset:0
v_pk_fma_f32 v[216:217], v[72:73], v[200:201], v[208:209]
buffer_load_dwordx4 a[64:67], v5, s[4:7], s59 offen offset:512 sc1
v_cvt_pk_bf16_f32 v220, v216, v217
v_pk_fma_f32 v[218:219], v[74:75], v[202:203], v[210:211]
v_cvt_pk_bf16_f32 v221, v218, v219
v_pk_fma_f32 v[216:217], v[140:141], v[204:205], v[212:213]
v_cvt_pk_bf16_f32 v222, v216, v217
buffer_load_dwordx4 a[68:71], v6, s[4:7], s59 offen offset:768 sc1
s_add_u32 s59, s59, 16384
v_pk_fma_f32 v[218:219], v[142:143], v[206:207], v[214:215]
v_cvt_pk_bf16_f32 v223, v218, v219
ds_write_b128 v254, v[220:223] offset:0
v_pk_fma_f32 v[216:217], v[76:77], v[200:201], v[208:209]
v_cvt_pk_bf16_f32 v224, v216, v217
buffer_load_dwordx4 a[72:75], v5, s[4:7], s59 offen offset:0 sc1
v_pk_fma_f32 v[218:219], v[78:79], v[202:203], v[210:211]
v_cvt_pk_bf16_f32 v225, v218, v219
v_pk_fma_f32 v[216:217], v[160:161], v[204:205], v[212:213]
v_cvt_pk_bf16_f32 v226, v216, v217
v_pk_fma_f32 v[218:219], v[162:163], v[206:207], v[214:215]
buffer_load_dwordx4 a[76:79], v5, s[4:7], s59 offen offset:256 sc1
v_cvt_pk_bf16_f32 v227, v218, v219
ds_write_b128 v244, v[224:227] offset:0
v_pk_fma_f32 v[216:217], v[80:81], v[200:201], v[208:209]
v_cvt_pk_bf16_f32 v220, v216, v217
v_pk_fma_f32 v[218:219], v[82:83], v[202:203], v[210:211]
buffer_load_dwordx4 a[80:83], v5, s[4:7], s59 offen offset:512 sc1
v_cvt_pk_bf16_f32 v221, v218, v219
v_pk_fma_f32 v[216:217], v[180:181], v[204:205], v[212:213]
v_cvt_pk_bf16_f32 v222, v216, v217
v_pk_fma_f32 v[218:219], v[182:183], v[206:207], v[214:215]
v_cvt_pk_bf16_f32 v223, v218, v219
buffer_load_dwordx4 a[84:87], v6, s[4:7], s59 offen offset:768 sc1
s_add_u32 s59, s59, 16384
ds_write_b128 v245, v[220:223] offset:0
ds_read_b128 v[200:203], v10 offset:3072
ds_read_b128 v[204:207], v10 offset:3088
ds_read_b128 v[208:211], v10 offset:512
ds_read_b128 v[212:215], v10 offset:528
s_lshl_b32 s50, s50, 5
s_lshr_b32 s54, s53, 6
s_add_u32 s54, s50, s54
s_mul_i32 s50, s54, 1280
s_add_u32 s50, s50, s52
s_lshl_b32 s51, s52, 1
s_add_u32 s51, s51, 65536
s_add_u32 s22, s51, 5120
s_mov_b32 s23, 917504
s_mul_i32 s12, s3, 2304
s_add_u32 s12, s12, 152320
s_add_u32 s13, s49, 122880
s_waitcnt lgkmcnt(4)
s_barrier
ds_read_b128 a[0:3], v8 offset:0
ds_read_b128 a[4:7], v8 offset:1024
ds_read_b128 a[8:11], v8 offset:2048
ds_read_b128 a[12:15], v8 offset:3072
ds_read_b128 a[16:19], v8 offset:4096
s_lshl_b32 s14, s53, 11
s_add_u32 s14, s14, 131072
s_mul_i32 s61, s3, 40
s_add_u32 s61, s61, 138240
s_waitcnt vmcnt(8) lgkmcnt(0)
v_mfma_f32_16x16x32_bf16 v[20:23], a[40:43], a[0:3], 0
ds_read_b128 a[20:23], v9 offset:5120
v_fma_mix_f32 v216, v104, v200, v208 op_sel:[0,0,0] op_sel_hi:[1,0,0]
v_mfma_f32_16x16x32_bf16 v[24:27], a[44:47], a[0:3], 0
buffer_load_dwordx4 a[88:91], v5, s[4:7], s59 offen offset:0 sc1
v_fma_mix_f32 v217, v104, v201, v209 op_sel:[1,0,0] op_sel_hi:[1,0,0]
v_mfma_f32_16x16x32_bf16 v[28:31], a[0:3], a[48:51], 0
ds_read_b128 a[24:27], v9 offset:6144
v_cvt_pk_bf16_f32 v220, v216, v217
v_mfma_f32_16x16x32_bf16 v[32:35], a[52:55], a[0:3], 0
ds_read_b128 a[28:31], v9 offset:7168
v_fma_mix_f32 v218, v105, v202, v210 op_sel:[0,0,0] op_sel_hi:[1,0,0]
v_mfma_f32_16x16x32_bf16 v[36:39], a[40:43], a[4:7], 0
ds_read_b128 a[32:35], v9 offset:8192
v_fma_mix_f32 v219, v105, v203, v211 op_sel:[1,0,0] op_sel_hi:[1,0,0]
v_mfma_f32_16x16x32_bf16 v[40:43], a[44:47], a[4:7], 0
buffer_load_dwordx4 a[92:95], v5, s[4:7], s59 offen offset:256 sc1
v_cvt_pk_bf16_f32 v221, v218, v219
v_mfma_f32_16x16x32_bf16 v[44:47], a[4:7], a[48:51], 0
ds_read_b128 a[36:39], v9 offset:9216
v_fma_mix_f32 v216, v106, v204, v212 op_sel:[0,0,0] op_sel_hi:[1,0,0]
v_mfma_f32_16x16x32_bf16 v[48:51], a[52:55], a[4:7], 0
v_fma_mix_f32 v217, v106, v205, v213 op_sel:[1,0,0] op_sel_hi:[1,0,0]
v_cvt_pk_bf16_f32 v222, v216, v217
v_mfma_f32_16x16x32_bf16 v[52:55], a[40:43], a[8:11], 0
v_fma_mix_f32 v218, v107, v206, v214 op_sel:[0,0,0] op_sel_hi:[1,0,0]
v_fma_mix_f32 v219, v107, v207, v215 op_sel:[1,0,0] op_sel_hi:[1,0,0]
v_mfma_f32_16x16x32_bf16 v[56:59], a[44:47], a[8:11], 0
buffer_load_dwordx4 a[96:99], v5, s[4:7], s59 offen offset:512 sc1
v_cvt_pk_bf16_f32 v223, v218, v219
v_mfma_f32_16x16x32_bf16 v[60:63], a[8:11], a[48:51], 0
v_fma_mix_f32 v216, v124, v200, v208 op_sel:[0,0,0] op_sel_hi:[1,0,0]
v_fma_mix_f32 v217, v124, v201, v209 op_sel:[1,0,0] op_sel_hi:[1,0,0]
v_mfma_f32_16x16x32_bf16 v[64:67], a[52:55], a[8:11], 0
ds_write_b128 v7, v[220:223] offset:20480
v_mfma_f32_16x16x32_bf16 v[68:71], a[40:43], a[12:15], 0
v_cvt_pk_bf16_f32 v224, v216, v217
v_fma_mix_f32 v218, v125, v202, v210 op_sel:[0,0,0] op_sel_hi:[1,0,0]
v_mfma_f32_16x16x32_bf16 v[72:75], a[44:47], a[12:15], 0
buffer_load_dwordx4 a[100:103], v6, s[4:7], s59 offen offset:768 sc1
s_add_u32 s59, s59, 16384
v_mfma_f32_16x16x32_bf16 v[76:79], a[12:15], a[48:51], 0
v_fma_mix_f32 v219, v125, v203, v211 op_sel:[1,0,0] op_sel_hi:[1,0,0]
v_cvt_pk_bf16_f32 v225, v218, v219
v_mfma_f32_16x16x32_bf16 v[80:83], a[52:55], a[12:15], 0
v_fma_mix_f32 v216, v126, v204, v212 op_sel:[0,0,0] op_sel_hi:[1,0,0]
v_fma_mix_f32 v217, v126, v205, v213 op_sel:[1,0,0] op_sel_hi:[1,0,0]
v_mfma_f32_16x16x32_bf16 v[84:87], a[40:43], a[16:19], 0
v_cvt_pk_bf16_f32 v226, v216, v217
v_fma_mix_f32 v218, v127, v206, v214 op_sel:[0,0,0] op_sel_hi:[1,0,0]
v_mfma_f32_16x16x32_bf16 v[88:91], a[44:47], a[16:19], 0
v_fma_mix_f32 v219, v127, v207, v215 op_sel:[1,0,0] op_sel_hi:[1,0,0]
v_cvt_pk_bf16_f32 v227, v218, v219
v_mfma_f32_16x16x32_bf16 v[92:95], a[16:19], a[48:51], 0
v_fma_mix_f32 v216, v144, v200, v208 op_sel:[0,0,0] op_sel_hi:[1,0,0]
v_fma_mix_f32 v217, v144, v201, v209 op_sel:[1,0,0] op_sel_hi:[1,0,0]
v_mfma_f32_16x16x32_bf16 v[96:99], a[52:55], a[16:19], 0
s_waitcnt vmcnt(8) lgkmcnt(1)
v_cvt_pk_bf16_f32 v220, v216, v217
v_fma_mix_f32 v218, v145, v202, v210 op_sel:[0,0,0] op_sel_hi:[1,0,0]
v_mfma_f32_16x16x32_bf16 v[20:23], a[56:59], a[20:23], v[20:23]
ds_read_b128 a[0:3], v8 offset:10240
v_fma_mix_f32 v219, v145, v203, v211 op_sel:[1,0,0] op_sel_hi:[1,0,0]
v_mfma_f32_16x16x32_bf16 v[24:27], a[60:63], a[20:23], v[24:27]
buffer_load_dwordx4 a[104:107], v5, s[4:7], s59 offen offset:0 sc1
v_cvt_pk_bf16_f32 v221, v218, v219
v_mfma_f32_16x16x32_bf16 v[28:31], a[20:23], a[64:67], v[28:31]
ds_read_b128 a[4:7], v8 offset:11264
v_fma_mix_f32 v216, v146, v204, v212 op_sel:[0,0,0] op_sel_hi:[1,0,0]
v_mfma_f32_16x16x32_bf16 v[32:35], a[68:71], a[20:23], v[32:35]
ds_read_b128 a[8:11], v8 offset:12288
v_fma_mix_f32 v217, v146, v205, v213 op_sel:[1,0,0] op_sel_hi:[1,0,0]
v_mfma_f32_16x16x32_bf16 v[36:39], a[56:59], a[24:27], v[36:39]
ds_read_b128 a[12:15], v8 offset:13312
v_cvt_pk_bf16_f32 v222, v216, v217
v_mfma_f32_16x16x32_bf16 v[40:43], a[60:63], a[24:27], v[40:43]
buffer_load_dwordx4 a[108:111], v5, s[4:7], s59 offen offset:256 sc1
v_fma_mix_f32 v218, v147, v206, v214 op_sel:[0,0,0] op_sel_hi:[1,0,0]
v_mfma_f32_16x16x32_bf16 v[44:47], a[24:27], a[64:67], v[44:47]
ds_read_b128 a[16:19], v8 offset:14336
v_fma_mix_f32 v219, v147, v207, v215 op_sel:[1,0,0] op_sel_hi:[1,0,0]
v_mfma_f32_16x16x32_bf16 v[48:51], a[68:71], a[24:27], v[48:51]
ds_write_b128 v253, v[224:227] offset:20480
v_mfma_f32_16x16x32_bf16 v[52:55], a[56:59], a[28:31], v[52:55]
v_cvt_pk_bf16_f32 v223, v218, v219
v_fma_mix_f32 v216, v164, v200, v208 op_sel:[0,0,0] op_sel_hi:[1,0,0]
v_mfma_f32_16x16x32_bf16 v[56:59], a[60:63], a[28:31], v[56:59]
buffer_load_dwordx4 a[112:115], v5, s[4:7], s59 offen offset:512 sc1
v_fma_mix_f32 v217, v164, v201, v209 op_sel:[1,0,0] op_sel_hi:[1,0,0]
v_mfma_f32_16x16x32_bf16 v[60:63], a[28:31], a[64:67], v[60:63]
v_cvt_pk_bf16_f32 v224, v216, v217
v_fma_mix_f32 v218, v165, v202, v210 op_sel:[0,0,0] op_sel_hi:[1,0,0]
v_mfma_f32_16x16x32_bf16 v[64:67], a[68:71], a[28:31], v[64:67]
ds_write_b128 v254, v[220:223] offset:20480
v_mfma_f32_16x16x32_bf16 v[68:71], a[56:59], a[32:35], v[68:71]
v_fma_mix_f32 v219, v165, v203, v211 op_sel:[1,0,0] op_sel_hi:[1,0,0]
v_cvt_pk_bf16_f32 v225, v218, v219
v_mfma_f32_16x16x32_bf16 v[72:75], a[60:63], a[32:35], v[72:75]
buffer_load_dwordx4 a[116:119], v6, s[4:7], s59 offen offset:768 sc1
s_add_u32 s59, s59, 16384
v_mfma_f32_16x16x32_bf16 v[76:79], a[32:35], a[64:67], v[76:79]
v_fma_mix_f32 v216, v166, v204, v212 op_sel:[0,0,0] op_sel_hi:[1,0,0]
v_fma_mix_f32 v217, v166, v205, v213 op_sel:[1,0,0] op_sel_hi:[1,0,0]
v_mfma_f32_16x16x32_bf16 v[80:83], a[68:71], a[32:35], v[80:83]
v_cvt_pk_bf16_f32 v226, v216, v217
v_fma_mix_f32 v218, v167, v206, v214 op_sel:[0,0,0] op_sel_hi:[1,0,0]
v_mfma_f32_16x16x32_bf16 v[84:87], a[56:59], a[36:39], v[84:87]
v_fma_mix_f32 v219, v167, v207, v215 op_sel:[1,0,0] op_sel_hi:[1,0,0]
v_cvt_pk_bf16_f32 v227, v218, v219
v_mfma_f32_16x16x32_bf16 v[88:91], a[60:63], a[36:39], v[88:91]
buffer_load_dwordx4 a[120:123], v5, s[4:7], s59 offen offset:0 sc1
v_fma_mix_f32 v216, v184, v200, v208 op_sel:[0,0,0] op_sel_hi:[1,0,0]
v_mfma_f32_16x16x32_bf16 v[92:95], a[36:39], a[64:67], v[92:95]
v_fma_mix_f32 v217, v184, v201, v209 op_sel:[1,0,0] op_sel_hi:[1,0,0]
v_cvt_pk_bf16_f32 v220, v216, v217
v_mfma_f32_16x16x32_bf16 v[96:99], a[68:71], a[36:39], v[96:99]
s_waitcnt vmcnt(9) lgkmcnt(2)
v_fma_mix_f32 v218, v185, v202, v210 op_sel:[0,0,0] op_sel_hi:[1,0,0]
v_fma_mix_f32 v219, v185, v203, v211 op_sel:[1,0,0] op_sel_hi:[1,0,0]
v_mfma_f32_16x16x32_bf16 v[20:23], a[72:75], a[0:3], v[20:23]
ds_read_b128 a[20:23], v9 offset:15360
v_cvt_pk_bf16_f32 v221, v218, v219
v_mfma_f32_16x16x32_bf16 v[24:27], a[76:79], a[0:3], v[24:27]
buffer_load_dwordx4 a[124:127], v5, s[4:7], s59 offen offset:256 sc1
v_fma_mix_f32 v216, v186, v204, v212 op_sel:[0,0,0] op_sel_hi:[1,0,0]
v_mfma_f32_16x16x32_bf16 v[28:31], a[0:3], a[80:83], v[28:31]
ds_read_b128 a[24:27], v9 offset:16384
v_fma_mix_f32 v217, v186, v205, v213 op_sel:[1,0,0] op_sel_hi:[1,0,0]
v_mfma_f32_16x16x32_bf16 v[32:35], a[84:87], a[0:3], v[32:35]
ds_read_b128 a[28:31], v9 offset:17408
v_cvt_pk_bf16_f32 v222, v216, v217
v_mfma_f32_16x16x32_bf16 v[36:39], a[72:75], a[4:7], v[36:39]
ds_read_b128 a[32:35], v9 offset:18432
v_fma_mix_f32 v218, v187, v206, v214 op_sel:[0,0,0] op_sel_hi:[1,0,0]
v_mfma_f32_16x16x32_bf16 v[40:43], a[76:79], a[4:7], v[40:43]
buffer_load_dwordx4 a[128:131], v5, s[4:7], s59 offen offset:512 sc1
v_fma_mix_f32 v219, v187, v207, v215 op_sel:[1,0,0] op_sel_hi:[1,0,0]
v_mfma_f32_16x16x32_bf16 v[44:47], a[4:7], a[80:83], v[44:47]
ds_read_b128 a[36:39], v9 offset:19456
v_cvt_pk_bf16_f32 v223, v218, v219
v_mfma_f32_16x16x32_bf16 v[48:51], a[84:87], a[4:7], v[48:51]
ds_write_b128 v244, v[224:227] offset:20480
v_mfma_f32_16x16x32_bf16 v[52:55], a[72:75], a[8:11], v[52:55]
v_bfe_u32 v228, v1, 2, 2
v_lshl_add_u32 v228, v3, 3, v228
v_mfma_f32_16x16x32_bf16 v[56:59], a[76:79], a[8:11], v[56:59]
buffer_load_dwordx4 a[132:135], v6, s[4:7], s59 offen offset:768 sc1
s_add_u32 s59, s59, 16384
v_mfma_f32_16x16x32_bf16 v[60:63], a[8:11], a[80:83], v[60:63]
v_mul_u32_u24 v228, 192, v228
v_and_b32 v229, 3, v1
v_mfma_f32_16x16x32_bf16 v[64:67], a[84:87], a[8:11], v[64:67]
ds_write_b128 v245, v[220:223] offset:20480
v_mfma_f32_16x16x32_bf16 v[68:71], a[72:75], a[12:15], v[68:71]
v_lshl_add_u32 v228, v229, 3, v228
v_and_b32 v229, 1, v3
v_mfma_f32_16x16x32_bf16 v[72:75], a[76:79], a[12:15], v[72:75]
buffer_load_dwordx4 a[136:139], v5, s[4:7], s59 offen offset:0 sc1
v_lshl_add_u32 v249, v229, 5, v228
v_mfma_f32_16x16x32_bf16 v[76:79], a[12:15], a[80:83], v[76:79]
v_xor_b32 v229, 1, v229
v_lshl_add_u32 v252, v229, 5, v228
v_mfma_f32_16x16x32_bf16 v[80:83], a[84:87], a[12:15], v[80:83]
ds_read_b128 v[200:203], v10 offset:3584
v_add_u32 v4, 61440, v8
v_mfma_f32_16x16x32_bf16 v[84:87], a[72:75], a[16:19], v[84:87]
ds_read_b128 v[204:207], v10 offset:3600
v_add_u32 v251, 61440, v9
v_mfma_f32_16x16x32_bf16 v[88:91], a[76:79], a[16:19], v[88:91]
ds_read_b128 v[208:211], v10 offset:1024
v_mfma_f32_16x16x32_bf16 v[92:95], a[16:19], a[80:83], v[92:95]
ds_read_b128 v[212:215], v10 offset:1040
v_mfma_f32_16x16x32_bf16 v[96:99], a[84:87], a[16:19], v[96:99]
s_waitcnt vmcnt(9) lgkmcnt(4)
s_barrier
v_mfma_f32_16x16x32_bf16 v[20:23], a[88:91], a[20:23], v[20:23]
ds_read_b128 a[0:3], v8 offset:20480
v_mfma_f32_16x16x32_bf16 v[24:27], a[92:95], a[20:23], v[24:27]
buffer_load_dwordx4 a[140:143], v5, s[4:7], s59 offen offset:256 sc1
v_mfma_f32_16x16x32_bf16 v[28:31], a[20:23], a[96:99], v[28:31]
ds_read_b128 a[4:7], v8 offset:21504
s_waitcnt lgkmcnt(2)
v_mfma_f32_16x16x32_bf16 v[32:35], a[100:103], a[20:23], v[32:35]
ds_read_b128 a[8:11], v8 offset:22528
v_fma_mix_f32 v216, v108, v200, v208 op_sel:[0,0,0] op_sel_hi:[1,0,0]
v_mfma_f32_16x16x32_bf16 v[36:39], a[88:91], a[24:27], v[36:39]
ds_read_b128 a[12:15], v8 offset:23552
v_fma_mix_f32 v217, v108, v201, v209 op_sel:[1,0,0] op_sel_hi:[1,0,0]
v_mfma_f32_16x16x32_bf16 v[40:43], a[92:95], a[24:27], v[40:43]
buffer_load_dwordx4 a[144:147], v5, s[4:7], s59 offen offset:512 sc1
v_cvt_pk_bf16_f32 v220, v216, v217
v_mfma_f32_16x16x32_bf16 v[44:47], a[24:27], a[96:99], v[44:47]
ds_read_b128 a[16:19], v8 offset:24576
v_fma_mix_f32 v218, v109, v202, v210 op_sel:[0,0,0] op_sel_hi:[1,0,0]
v_mfma_f32_16x16x32_bf16 v[48:51], a[100:103], a[24:27], v[48:51]
v_fma_mix_f32 v219, v109, v203, v211 op_sel:[1,0,0] op_sel_hi:[1,0,0]
v_cvt_pk_bf16_f32 v221, v218, v219
v_mfma_f32_16x16x32_bf16 v[52:55], a[88:91], a[28:31], v[52:55]
v_fma_mix_f32 v216, v110, v204, v212 op_sel:[0,0,0] op_sel_hi:[1,0,0]
v_fma_mix_f32 v217, v110, v205, v213 op_sel:[1,0,0] op_sel_hi:[1,0,0]
v_mfma_f32_16x16x32_bf16 v[56:59], a[92:95], a[28:31], v[56:59]
buffer_store_dwordx4 v[240:243], v246, s[4:7], s100 offen sc1
v_mfma_f32_16x16x32_bf16 v[60:63], a[28:31], a[96:99], v[60:63]
v_cvt_pk_bf16_f32 v222, v216, v217
v_fma_mix_f32 v218, v111, v206, v214 op_sel:[0,0,0] op_sel_hi:[1,0,0]
v_mfma_f32_16x16x32_bf16 v[64:67], a[100:103], a[28:31], v[64:67]
v_fma_mix_f32 v219, v111, v207, v215 op_sel:[1,0,0] op_sel_hi:[1,0,0]
v_cvt_pk_bf16_f32 v223, v218, v219
v_mfma_f32_16x16x32_bf16 v[68:71], a[88:91], a[32:35], v[68:71]
v_fma_mix_f32 v216, v128, v200, v208 op_sel:[0,0,0] op_sel_hi:[1,0,0]
v_fma_mix_f32 v217, v128, v201, v209 op_sel:[1,0,0] op_sel_hi:[1,0,0]
v_mfma_f32_16x16x32_bf16 v[72:75], a[92:95], a[32:35], v[72:75]
buffer_load_dwordx4 a[148:151], v6, s[4:7], s59 offen offset:768 sc1
s_add_u32 s59, s59, 16384
v_mfma_f32_16x16x32_bf16 v[76:79], a[32:35], a[96:99], v[76:79]
ds_write_b128 v7, v[220:223] offset:40960
v_mfma_f32_16x16x32_bf16 v[80:83], a[100:103], a[32:35], v[80:83]
v_cvt_pk_bf16_f32 v224, v216, v217
v_fma_mix_f32 v218, v129, v202, v210 op_sel:[0,0,0] op_sel_hi:[1,0,0]
v_mfma_f32_16x16x32_bf16 v[84:87], a[88:91], a[36:39], v[84:87]
v_fma_mix_f32 v219, v129, v203, v211 op_sel:[1,0,0] op_sel_hi:[1,0,0]
v_cvt_pk_bf16_f32 v225, v218, v219
v_mfma_f32_16x16x32_bf16 v[88:91], a[92:95], a[36:39], v[88:91]
buffer_load_dwordx4 a[152:155], v5, s[4:7], s59 offen offset:0 sc1
v_fma_mix_f32 v216, v130, v204, v212 op_sel:[0,0,0] op_sel_hi:[1,0,0]
v_mfma_f32_16x16x32_bf16 v[92:95], a[36:39], a[96:99], v[92:95]
v_fma_mix_f32 v217, v130, v205, v213 op_sel:[1,0,0] op_sel_hi:[1,0,0]
v_cvt_pk_bf16_f32 v226, v216, v217
v_mfma_f32_16x16x32_bf16 v[96:99], a[100:103], a[36:39], v[96:99]
s_waitcnt vmcnt(10) lgkmcnt(1)
v_fma_mix_f32 v218, v131, v206, v214 op_sel:[0,0,0] op_sel_hi:[1,0,0]
v_fma_mix_f32 v219, v131, v207, v215 op_sel:[1,0,0] op_sel_hi:[1,0,0]
v_mfma_f32_16x16x32_bf16 v[20:23], a[104:107], a[0:3], v[20:23]
ds_read_b128 a[20:23], v9 offset:25600
v_cvt_pk_bf16_f32 v227, v218, v219
v_mfma_f32_16x16x32_bf16 v[24:27], a[108:111], a[0:3], v[24:27]
buffer_load_dwordx4 a[156:159], v5, s[4:7], s59 offen offset:256 sc1
v_fma_mix_f32 v216, v148, v200, v208 op_sel:[0,0,0] op_sel_hi:[1,0,0]
v_mfma_f32_16x16x32_bf16 v[28:31], a[0:3], a[112:115], v[28:31]
ds_read_b128 a[24:27], v9 offset:26624
v_fma_mix_f32 v217, v148, v201, v209 op_sel:[1,0,0] op_sel_hi:[1,0,0]
v_mfma_f32_16x16x32_bf16 v[32:35], a[116:119], a[0:3], v[32:35]
ds_read_b128 a[28:31], v9 offset:27648
v_cvt_pk_bf16_f32 v220, v216, v217
v_mfma_f32_16x16x32_bf16 v[36:39], a[104:107], a[4:7], v[36:39]
ds_read_b128 a[32:35], v9 offset:28672
v_fma_mix_f32 v218, v149, v202, v210 op_sel:[0,0,0] op_sel_hi:[1,0,0]
v_mfma_f32_16x16x32_bf16 v[40:43], a[108:111], a[4:7], v[40:43]
buffer_load_dwordx4 a[160:163], v5, s[4:7], s59 offen offset:512 sc1
v_fma_mix_f32 v219, v149, v203, v211 op_sel:[1,0,0] op_sel_hi:[1,0,0]
v_mfma_f32_16x16x32_bf16 v[44:47], a[4:7], a[112:115], v[44:47]
ds_read_b128 a[36:39], v9 offset:29696
v_cvt_pk_bf16_f32 v221, v218, v219
v_mfma_f32_16x16x32_bf16 v[48:51], a[116:119], a[4:7], v[48:51]
ds_write_b128 v253, v[224:227] offset:40960
v_mfma_f32_16x16x32_bf16 v[52:55], a[104:107], a[8:11], v[52:55]
v_fma_mix_f32 v216, v150, v204, v212 op_sel:[0,0,0] op_sel_hi:[1,0,0]
v_fma_mix_f32 v217, v150, v205, v213 op_sel:[1,0,0] op_sel_hi:[1,0,0]
v_mfma_f32_16x16x32_bf16 v[56:59], a[108:111], a[8:11], v[56:59]
buffer_load_dwordx4 a[164:167], v6, s[4:7], s59 offen offset:768 sc1
s_add_u32 s59, s59, 16384
v_mfma_f32_16x16x32_bf16 v[60:63], a[8:11], a[112:115], v[60:63]
v_cvt_pk_bf16_f32 v222, v216, v217
v_fma_mix_f32 v218, v151, v206, v214 op_sel:[0,0,0] op_sel_hi:[1,0,0]
v_mfma_f32_16x16x32_bf16 v[64:67], a[116:119], a[8:11], v[64:67]
v_fma_mix_f32 v219, v151, v207, v215 op_sel:[1,0,0] op_sel_hi:[1,0,0]
v_cvt_pk_bf16_f32 v223, v218, v219
v_mfma_f32_16x16x32_bf16 v[68:71], a[104:107], a[12:15], v[68:71]
v_fma_mix_f32 v216, v168, v200, v208 op_sel:[0,0,0] op_sel_hi:[1,0,0]
v_fma_mix_f32 v217, v168, v201, v209 op_sel:[1,0,0] op_sel_hi:[1,0,0]
v_mfma_f32_16x16x32_bf16 v[72:75], a[108:111], a[12:15], v[72:75]
buffer_load_dwordx4 a[168:171], v5, s[4:7], s59 offen offset:0 sc1
v_cvt_pk_bf16_f32 v224, v216, v217
v_mfma_f32_16x16x32_bf16 v[76:79], a[12:15], a[112:115], v[76:79]
ds_write_b128 v254, v[220:223] offset:40960
v_mfma_f32_16x16x32_bf16 v[80:83], a[116:119], a[12:15], v[80:83]
v_fma_mix_f32 v218, v169, v202, v210 op_sel:[0,0,0] op_sel_hi:[1,0,0]
v_fma_mix_f32 v219, v169, v203, v211 op_sel:[1,0,0] op_sel_hi:[1,0,0]
v_mfma_f32_16x16x32_bf16 v[84:87], a[104:107], a[16:19], v[84:87]
v_cvt_pk_bf16_f32 v225, v218, v219
v_fma_mix_f32 v216, v170, v204, v212 op_sel:[0,0,0] op_sel_hi:[1,0,0]
v_mfma_f32_16x16x32_bf16 v[88:91], a[108:111], a[16:19], v[88:91]
buffer_load_dwordx4 a[172:175], v5, s[4:7], s59 offen offset:256 sc1
v_fma_mix_f32 v217, v170, v205, v213 op_sel:[1,0,0] op_sel_hi:[1,0,0]
v_mfma_f32_16x16x32_bf16 v[92:95], a[16:19], a[112:115], v[92:95]
v_cvt_pk_bf16_f32 v226, v216, v217
v_fma_mix_f32 v218, v171, v206, v214 op_sel:[0,0,0] op_sel_hi:[1,0,0]
v_mfma_f32_16x16x32_bf16 v[96:99], a[116:119], a[16:19], v[96:99]
s_waitcnt vmcnt(11) lgkmcnt(2)
v_fma_mix_f32 v219, v171, v207, v215 op_sel:[1,0,0] op_sel_hi:[1,0,0]
v_cvt_pk_bf16_f32 v227, v218, v219
v_mfma_f32_16x16x32_bf16 v[20:23], a[120:123], a[20:23], v[20:23]
ds_read_b128 a[0:3], v8 offset:30720
v_fma_mix_f32 v216, v188, v200, v208 op_sel:[0,0,0] op_sel_hi:[1,0,0]
v_mfma_f32_16x16x32_bf16 v[24:27], a[124:127], a[20:23], v[24:27]
buffer_load_dwordx4 a[176:179], v5, s[4:7], s59 offen offset:512 sc1
v_fma_mix_f32 v217, v188, v201, v209 op_sel:[1,0,0] op_sel_hi:[1,0,0]
v_mfma_f32_16x16x32_bf16 v[28:31], a[20:23], a[128:131], v[28:31]
ds_read_b128 a[4:7], v8 offset:31744
v_cvt_pk_bf16_f32 v220, v216, v217
v_mfma_f32_16x16x32_bf16 v[32:35], a[132:135], a[20:23], v[32:35]
ds_read_b128 a[8:11], v8 offset:32768
v_fma_mix_f32 v218, v189, v202, v210 op_sel:[0,0,0] op_sel_hi:[1,0,0]
v_mfma_f32_16x16x32_bf16 v[36:39], a[120:123], a[24:27], v[36:39]
ds_read_b128 a[12:15], v8 offset:33792
v_fma_mix_f32 v219, v189, v203, v211 op_sel:[1,0,0] op_sel_hi:[1,0,0]
v_mfma_f32_16x16x32_bf16 v[40:43], a[124:127], a[24:27], v[40:43]
buffer_load_dwordx4 a[180:183], v6, s[4:7], s59 offen offset:768 sc1
s_add_u32 s59, s59, 16384
v_mfma_f32_16x16x32_bf16 v[44:47], a[24:27], a[128:131], v[44:47]
ds_read_b128 a[16:19], v8 offset:34816
v_cvt_pk_bf16_f32 v221, v218, v219
v_mfma_f32_16x16x32_bf16 v[48:51], a[132:135], a[24:27], v[48:51]
ds_write_b128 v244, v[224:227] offset:40960
v_mfma_f32_16x16x32_bf16 v[52:55], a[120:123], a[28:31], v[52:55]
v_fma_mix_f32 v216, v190, v204, v212 op_sel:[0,0,0] op_sel_hi:[1,0,0]
v_fma_mix_f32 v217, v190, v205, v213 op_sel:[1,0,0] op_sel_hi:[1,0,0]
v_mfma_f32_16x16x32_bf16 v[56:59], a[124:127], a[28:31], v[56:59]
buffer_load_dwordx4 a[184:187], v5, s[4:7], s59 offen offset:0 sc1
v_cvt_pk_bf16_f32 v222, v216, v217
v_mfma_f32_16x16x32_bf16 v[60:63], a[28:31], a[128:131], v[60:63]
v_fma_mix_f32 v218, v191, v206, v214 op_sel:[0,0,0] op_sel_hi:[1,0,0]
v_fma_mix_f32 v219, v191, v207, v215 op_sel:[1,0,0] op_sel_hi:[1,0,0]
v_mfma_f32_16x16x32_bf16 v[64:67], a[132:135], a[28:31], v[64:67]
v_cvt_pk_bf16_f32 v223, v218, v219
v_add_u32 v7, 61440, v7
v_mfma_f32_16x16x32_bf16 v[68:71], a[120:123], a[32:35], v[68:71]
v_add_u32 v253, 61440, v253
v_add_u32 v254, 61440, v254
v_mfma_f32_16x16x32_bf16 v[72:75], a[124:127], a[32:35], v[72:75]
buffer_load_dwordx4 a[188:191], v5, s[4:7], s59 offen offset:256 sc1
v_add_u32 v244, 61440, v244
v_mfma_f32_16x16x32_bf16 v[76:79], a[32:35], a[128:131], v[76:79]
ds_write_b128 v245, v[220:223] offset:40960
v_mfma_f32_16x16x32_bf16 v[80:83], a[132:135], a[32:35], v[80:83]
v_add_u32 v245, 61440, v245
v_mfma_f32_16x16x32_bf16 v[84:87], a[120:123], a[36:39], v[84:87]
v_mfma_f32_16x16x32_bf16 v[88:91], a[124:127], a[36:39], v[88:91]
v_mfma_f32_16x16x32_bf16 v[92:95], a[36:39], a[128:131], v[92:95]
ds_read_b128 v[200:203], v10 offset:4096
v_mfma_f32_16x16x32_bf16 v[96:99], a[132:135], a[36:39], v[96:99]
s_waitcnt vmcnt(10) lgkmcnt(3)
v_mfma_f32_16x16x32_bf16 v[20:23], a[136:139], a[0:3], v[20:23]
ds_read_b128 a[20:23], v9 offset:35840
v_mfma_f32_16x16x32_bf16 v[24:27], a[140:143], a[0:3], v[24:27]
buffer_load_dwordx4 a[192:195], v5, s[4:7], s59 offen offset:512 sc1
v_mfma_f32_16x16x32_bf16 v[28:31], a[0:3], a[144:147], v[28:31]
ds_read_b128 a[24:27], v9 offset:36864
v_mfma_f32_16x16x32_bf16 v[32:35], a[148:151], a[0:3], v[32:35]
ds_read_b128 a[28:31], v9 offset:37888
v_mfma_f32_16x16x32_bf16 v[36:39], a[136:139], a[4:7], v[36:39]
ds_read_b128 a[32:35], v9 offset:38912
v_mfma_f32_16x16x32_bf16 v[40:43], a[140:143], a[4:7], v[40:43]
buffer_load_dwordx4 a[196:199], v6, s[4:7], s59 offen offset:768 sc1
s_add_u32 s59, s59, 16384
v_mfma_f32_16x16x32_bf16 v[44:47], a[4:7], a[144:147], v[44:47]
ds_read_b128 a[36:39], v9 offset:39936
v_mfma_f32_16x16x32_bf16 v[48:51], a[148:151], a[4:7], v[48:51]
ds_read_b128 v[204:207], v10 offset:4112
v_mfma_f32_16x16x32_bf16 v[52:55], a[136:139], a[8:11], v[52:55]
ds_read_b128 v[208:211], v10 offset:1536
v_mfma_f32_16x16x32_bf16 v[56:59], a[140:143], a[8:11], v[56:59]
buffer_load_dwordx4 a[200:203], v5, s[4:7], s59 offen offset:0 sc1
v_mfma_f32_16x16x32_bf16 v[60:63], a[8:11], a[144:147], v[60:63]
ds_read_b128 v[212:215], v10 offset:1552
v_mfma_f32_16x16x32_bf16 v[64:67], a[148:151], a[8:11], v[64:67]
v_mfma_f32_16x16x32_bf16 v[68:71], a[136:139], a[12:15], v[68:71]
v_mfma_f32_16x16x32_bf16 v[72:75], a[140:143], a[12:15], v[72:75]
buffer_load_dwordx4 a[204:207], v5, s[4:7], s59 offen offset:256 sc1
v_mfma_f32_16x16x32_bf16 v[76:79], a[12:15], a[144:147], v[76:79]
s_waitcnt lgkmcnt(0)
v_fma_mix_f32 v216, v112, v200, v208 op_sel:[0,0,0] op_sel_hi:[1,0,0]
v_fma_mix_f32 v217, v112, v201, v209 op_sel:[1,0,0] op_sel_hi:[1,0,0]
v_mfma_f32_16x16x32_bf16 v[80:83], a[148:151], a[12:15], v[80:83]
v_cvt_pk_bf16_f32 v220, v216, v217
v_fma_mix_f32 v218, v113, v202, v210 op_sel:[0,0,0] op_sel_hi:[1,0,0]
v_mfma_f32_16x16x32_bf16 v[84:87], a[136:139], a[16:19], v[84:87]
v_fma_mix_f32 v219, v113, v203, v211 op_sel:[1,0,0] op_sel_hi:[1,0,0]
v_cvt_pk_bf16_f32 v221, v218, v219
v_mfma_f32_16x16x32_bf16 v[88:91], a[140:143], a[16:19], v[88:91]
buffer_load_dwordx4 a[208:211], v5, s[4:7], s59 offen offset:512 sc1
v_fma_mix_f32 v216, v114, v204, v212 op_sel:[0,0,0] op_sel_hi:[1,0,0]
v_mfma_f32_16x16x32_bf16 v[92:95], a[16:19], a[144:147], v[92:95]
v_fma_mix_f32 v217, v114, v205, v213 op_sel:[1,0,0] op_sel_hi:[1,0,0]
v_cvt_pk_bf16_f32 v222, v216, v217
v_mfma_f32_16x16x32_bf16 v[96:99], a[148:151], a[16:19], v[96:99]
s_waitcnt vmcnt(11)
s_barrier
v_fma_mix_f32 v218, v115, v206, v214 op_sel:[0,0,0] op_sel_hi:[1,0,0]
v_mfma_f32_16x16x32_bf16 v[20:23], a[152:155], a[20:23], v[20:23]
ds_read_b128 a[0:3], v8 offset:40960
v_fma_mix_f32 v219, v115, v207, v215 op_sel:[1,0,0] op_sel_hi:[1,0,0]
v_mfma_f32_16x16x32_bf16 v[24:27], a[156:159], a[20:23], v[24:27]
buffer_load_dwordx4 a[212:215], v6, s[4:7], s59 offen offset:768 sc1
s_add_u32 s59, s59, 16384
v_mfma_f32_16x16x32_bf16 v[28:31], a[20:23], a[160:163], v[28:31]
ds_read_b128 a[4:7], v8 offset:41984
v_cvt_pk_bf16_f32 v223, v218, v219
v_mfma_f32_16x16x32_bf16 v[32:35], a[164:167], a[20:23], v[32:35]
ds_read_b128 a[8:11], v8 offset:43008
v_fma_mix_f32 v216, v132, v200, v208 op_sel:[0,0,0] op_sel_hi:[1,0,0]
v_mfma_f32_16x16x32_bf16 v[36:39], a[152:155], a[24:27], v[36:39]
ds_read_b128 a[12:15], v8 offset:44032
v_fma_mix_f32 v217, v132, v201, v209 op_sel:[1,0,0] op_sel_hi:[1,0,0]
v_mfma_f32_16x16x32_bf16 v[40:43], a[156:159], a[24:27], v[40:43]
buffer_load_dwordx4 a[216:219], v5, s[4:7], s59 offen offset:0 sc1
v_cvt_pk_bf16_f32 v224, v216, v217
v_mfma_f32_16x16x32_bf16 v[44:47], a[24:27], a[160:163], v[44:47]
ds_read_b128 a[16:19], v8 offset:45056
v_fma_mix_f32 v218, v133, v202, v210 op_sel:[0,0,0] op_sel_hi:[1,0,0]
v_mfma_f32_16x16x32_bf16 v[48:51], a[164:167], a[24:27], v[48:51]
ds_write_b128 v7, v[220:223] offset:0
v_mfma_f32_16x16x32_bf16 v[52:55], a[152:155], a[28:31], v[52:55]
v_fma_mix_f32 v219, v133, v203, v211 op_sel:[1,0,0] op_sel_hi:[1,0,0]
v_cvt_pk_bf16_f32 v225, v218, v219
v_mfma_f32_16x16x32_bf16 v[56:59], a[156:159], a[28:31], v[56:59]
buffer_load_dwordx4 a[220:223], v5, s[4:7], s59 offen offset:256 sc1
v_fma_mix_f32 v216, v134, v204, v212 op_sel:[0,0,0] op_sel_hi:[1,0,0]
v_mfma_f32_16x16x32_bf16 v[60:63], a[28:31], a[160:163], v[60:63]
v_fma_mix_f32 v217, v134, v205, v213 op_sel:[1,0,0] op_sel_hi:[1,0,0]
v_cvt_pk_bf16_f32 v226, v216, v217
v_mfma_f32_16x16x32_bf16 v[64:67], a[164:167], a[28:31], v[64:67]
v_fma_mix_f32 v218, v135, v206, v214 op_sel:[0,0,0] op_sel_hi:[1,0,0]
v_fma_mix_f32 v219, v135, v207, v215 op_sel:[1,0,0] op_sel_hi:[1,0,0]
v_mfma_f32_16x16x32_bf16 v[68:71], a[152:155], a[32:35], v[68:71]
v_cvt_pk_bf16_f32 v227, v218, v219
v_fma_mix_f32 v216, v152, v200, v208 op_sel:[0,0,0] op_sel_hi:[1,0,0]
v_mfma_f32_16x16x32_bf16 v[72:75], a[156:159], a[32:35], v[72:75]
buffer_load_dwordx4 a[224:227], v5, s[4:7], s59 offen offset:512 sc1
v_fma_mix_f32 v217, v152, v201, v209 op_sel:[1,0,0] op_sel_hi:[1,0,0]
v_mfma_f32_16x16x32_bf16 v[76:79], a[32:35], a[160:163], v[76:79]
ds_write_b128 v253, v[224:227] offset:0
v_mfma_f32_16x16x32_bf16 v[80:83], a[164:167], a[32:35], v[80:83]
v_cvt_pk_bf16_f32 v220, v216, v217
v_fma_mix_f32 v218, v153, v202, v210 op_sel:[0,0,0] op_sel_hi:[1,0,0]
v_mfma_f32_16x16x32_bf16 v[84:87], a[152:155], a[36:39], v[84:87]
v_fma_mix_f32 v219, v153, v203, v211 op_sel:[1,0,0] op_sel_hi:[1,0,0]
v_cvt_pk_bf16_f32 v221, v218, v219
v_mfma_f32_16x16x32_bf16 v[88:91], a[156:159], a[36:39], v[88:91]
v_fma_mix_f32 v216, v154, v204, v212 op_sel:[0,0,0] op_sel_hi:[1,0,0]
v_fma_mix_f32 v217, v154, v205, v213 op_sel:[1,0,0] op_sel_hi:[1,0,0]
v_mfma_f32_16x16x32_bf16 v[92:95], a[36:39], a[160:163], v[92:95]
v_cvt_pk_bf16_f32 v222, v216, v217
v_fma_mix_f32 v218, v155, v206, v214 op_sel:[0,0,0] op_sel_hi:[1,0,0]
v_mfma_f32_16x16x32_bf16 v[96:99], a[164:167], a[36:39], v[96:99]
s_waitcnt vmcnt(11) lgkmcnt(2)
v_fma_mix_f32 v219, v155, v207, v215 op_sel:[1,0,0] op_sel_hi:[1,0,0]
v_cvt_pk_bf16_f32 v223, v218, v219
v_mfma_f32_16x16x32_bf16 v[20:23], a[168:171], a[0:3], v[20:23]
ds_read_b128 a[20:23], v9 offset:46080
v_fma_mix_f32 v216, v172, v200, v208 op_sel:[0,0,0] op_sel_hi:[1,0,0]
v_mfma_f32_16x16x32_bf16 v[24:27], a[172:175], a[0:3], v[24:27]
buffer_load_dwordx4 a[228:231], v6, s[4:7], s59 offen offset:768 sc1
s_add_u32 s59, s59, 16384
v_mfma_f32_16x16x32_bf16 v[28:31], a[0:3], a[176:179], v[28:31]
ds_read_b128 a[24:27], v9 offset:47104
v_fma_mix_f32 v217, v172, v201, v209 op_sel:[1,0,0] op_sel_hi:[1,0,0]
v_mfma_f32_16x16x32_bf16 v[32:35], a[180:183], a[0:3], v[32:35]
ds_read_b128 a[28:31], v9 offset:48128
v_cvt_pk_bf16_f32 v224, v216, v217
v_mfma_f32_16x16x32_bf16 v[36:39], a[168:171], a[4:7], v[36:39]
ds_read_b128 a[32:35], v9 offset:49152
v_fma_mix_f32 v218, v173, v202, v210 op_sel:[0,0,0] op_sel_hi:[1,0,0]
v_mfma_f32_16x16x32_bf16 v[40:43], a[172:175], a[4:7], v[40:43]
buffer_load_dwordx4 a[40:43], v5, s[4:7], s59 offen offset:0 sc1
v_fma_mix_f32 v219, v173, v203, v211 op_sel:[1,0,0] op_sel_hi:[1,0,0]
v_mfma_f32_16x16x32_bf16 v[44:47], a[4:7], a[176:179], v[44:47]
ds_read_b128 a[36:39], v9 offset:50176
v_cvt_pk_bf16_f32 v225, v218, v219
v_mfma_f32_16x16x32_bf16 v[48:51], a[180:183], a[4:7], v[48:51]
ds_write_b128 v254, v[220:223] offset:0
v_mfma_f32_16x16x32_bf16 v[52:55], a[168:171], a[8:11], v[52:55]
v_fma_mix_f32 v216, v174, v204, v212 op_sel:[0,0,0] op_sel_hi:[1,0,0]
v_fma_mix_f32 v217, v174, v205, v213 op_sel:[1,0,0] op_sel_hi:[1,0,0]
v_mfma_f32_16x16x32_bf16 v[56:59], a[172:175], a[8:11], v[56:59]
buffer_load_dwordx4 a[44:47], v5, s[4:7], s59 offen offset:256 sc1
v_cvt_pk_bf16_f32 v226, v216, v217
v_mfma_f32_16x16x32_bf16 v[60:63], a[8:11], a[176:179], v[60:63]
v_fma_mix_f32 v218, v175, v206, v214 op_sel:[0,0,0] op_sel_hi:[1,0,0]
v_fma_mix_f32 v219, v175, v207, v215 op_sel:[1,0,0] op_sel_hi:[1,0,0]
v_mfma_f32_16x16x32_bf16 v[64:67], a[180:183], a[8:11], v[64:67]
v_cvt_pk_bf16_f32 v227, v218, v219
v_fma_mix_f32 v216, v192, v200, v208 op_sel:[0,0,0] op_sel_hi:[1,0,0]
v_mfma_f32_16x16x32_bf16 v[68:71], a[168:171], a[12:15], v[68:71]
v_fma_mix_f32 v217, v192, v201, v209 op_sel:[1,0,0] op_sel_hi:[1,0,0]
v_cvt_pk_bf16_f32 v220, v216, v217
v_mfma_f32_16x16x32_bf16 v[72:75], a[172:175], a[12:15], v[72:75]
buffer_load_dwordx4 a[48:51], v5, s[4:7], s59 offen offset:512 sc1
v_fma_mix_f32 v218, v193, v202, v210 op_sel:[0,0,0] op_sel_hi:[1,0,0]
v_mfma_f32_16x16x32_bf16 v[76:79], a[12:15], a[176:179], v[76:79]
ds_write_b128 v244, v[224:227] offset:0
v_mfma_f32_16x16x32_bf16 v[80:83], a[180:183], a[12:15], v[80:83]
v_fma_mix_f32 v219, v193, v203, v211 op_sel:[1,0,0] op_sel_hi:[1,0,0]
v_cvt_pk_bf16_f32 v221, v218, v219
v_mfma_f32_16x16x32_bf16 v[84:87], a[168:171], a[16:19], v[84:87]
v_fma_mix_f32 v216, v194, v204, v212 op_sel:[0,0,0] op_sel_hi:[1,0,0]
v_fma_mix_f32 v217, v194, v205, v213 op_sel:[1,0,0] op_sel_hi:[1,0,0]
v_mfma_f32_16x16x32_bf16 v[88:91], a[172:175], a[16:19], v[88:91]
buffer_load_dwordx4 a[52:55], v6, s[4:7], s59 offen offset:768 sc1
s_add_u32 s59, s59, 16384
v_mfma_f32_16x16x32_bf16 v[92:95], a[16:19], a[176:179], v[92:95]
v_cvt_pk_bf16_f32 v222, v216, v217
v_fma_mix_f32 v218, v195, v206, v214 op_sel:[0,0,0] op_sel_hi:[1,0,0]
v_mfma_f32_16x16x32_bf16 v[96:99], a[180:183], a[16:19], v[96:99]
s_waitcnt vmcnt(12) lgkmcnt(2)
v_fma_mix_f32 v219, v195, v207, v215 op_sel:[1,0,0] op_sel_hi:[1,0,0]
v_cvt_pk_bf16_f32 v223, v218, v219
v_mfma_f32_16x16x32_bf16 v[20:23], a[184:187], a[20:23], v[20:23]
ds_read_b128 a[0:3], v8 offset:51200
v_mfma_f32_16x16x32_bf16 v[24:27], a[188:191], a[20:23], v[24:27]
buffer_load_dwordx4 a[56:59], v5, s[4:7], s59 offen offset:0 sc1
v_mfma_f32_16x16x32_bf16 v[28:31], a[20:23], a[192:195], v[28:31]
ds_read_b128 a[4:7], v8 offset:52224
v_mfma_f32_16x16x32_bf16 v[32:35], a[196:199], a[20:23], v[32:35]
ds_read_b128 a[8:11], v8 offset:53248
v_mfma_f32_16x16x32_bf16 v[36:39], a[184:187], a[24:27], v[36:39]
ds_read_b128 a[12:15], v8 offset:54272
v_mfma_f32_16x16x32_bf16 v[40:43], a[188:191], a[24:27], v[40:43]
buffer_load_dwordx4 a[60:63], v5, s[4:7], s59 offen offset:256 sc1
v_mfma_f32_16x16x32_bf16 v[44:47], a[24:27], a[192:195], v[44:47]
ds_read_b128 a[16:19], v8 offset:55296
v_mfma_f32_16x16x32_bf16 v[48:51], a[196:199], a[24:27], v[48:51]
ds_write_b128 v245, v[220:223] offset:0
v_mfma_f32_16x16x32_bf16 v[52:55], a[184:187], a[28:31], v[52:55]
v_mfma_f32_16x16x32_bf16 v[56:59], a[188:191], a[28:31], v[56:59]
buffer_load_dwordx4 a[64:67], v5, s[4:7], s59 offen offset:512 sc1
v_mfma_f32_16x16x32_bf16 v[60:63], a[28:31], a[192:195], v[60:63]
v_mfma_f32_16x16x32_bf16 v[64:67], a[196:199], a[28:31], v[64:67]
ds_read_b128 v[200:203], v10 offset:4608
v_mfma_f32_16x16x32_bf16 v[68:71], a[184:187], a[32:35], v[68:71]
ds_read_b128 v[204:207], v10 offset:4624
v_mfma_f32_16x16x32_bf16 v[72:75], a[188:191], a[32:35], v[72:75]
buffer_load_dwordx4 a[68:71], v6, s[4:7], s59 offen offset:768 sc1
s_add_u32 s59, s59, 16384
v_mfma_f32_16x16x32_bf16 v[76:79], a[32:35], a[192:195], v[76:79]
ds_read_b128 v[208:211], v10 offset:2048
v_mfma_f32_16x16x32_bf16 v[80:83], a[196:199], a[32:35], v[80:83]
ds_read_b128 v[212:215], v10 offset:2064
v_mfma_f32_16x16x32_bf16 v[84:87], a[184:187], a[36:39], v[84:87]
v_mfma_f32_16x16x32_bf16 v[88:91], a[188:191], a[36:39], v[88:91]
buffer_load_dwordx4 a[72:75], v5, s[4:7], s59 offen offset:0 sc1
v_mfma_f32_16x16x32_bf16 v[92:95], a[36:39], a[192:195], v[92:95]
v_mfma_f32_16x16x32_bf16 v[96:99], a[196:199], a[36:39], v[96:99]
s_waitcnt vmcnt(13) lgkmcnt(5)
s_waitcnt lgkmcnt(0)
v_fma_mix_f32 v216, v116, v200, v208 op_sel:[0,0,0] op_sel_hi:[1,0,0]
v_mfma_f32_16x16x32_bf16 v[20:23], a[200:203], a[0:3], v[20:23]
ds_read_b128 a[20:23], v9 offset:56320
v_fma_mix_f32 v217, v116, v201, v209 op_sel:[1,0,0] op_sel_hi:[1,0,0]
v_mfma_f32_16x16x32_bf16 v[24:27], a[204:207], a[0:3], v[24:27]
buffer_load_dwordx4 a[76:79], v5, s[4:7], s59 offen offset:256 sc1
v_cvt_pk_bf16_f32 v220, v216, v217
v_mfma_f32_16x16x32_bf16 v[28:31], a[0:3], a[208:211], v[28:31]
ds_read_b128 a[24:27], v9 offset:57344
v_fma_mix_f32 v218, v117, v202, v210 op_sel:[0,0,0] op_sel_hi:[1,0,0]
v_mfma_f32_16x16x32_bf16 v[32:35], a[212:215], a[0:3], v[32:35]
ds_read_b128 a[28:31], v9 offset:58368
v_fma_mix_f32 v219, v117, v203, v211 op_sel:[1,0,0] op_sel_hi:[1,0,0]
v_mfma_f32_16x16x32_bf16 v[36:39], a[200:203], a[4:7], v[36:39]
ds_read_b128 a[32:35], v9 offset:59392
v_cvt_pk_bf16_f32 v221, v218, v219
v_mfma_f32_16x16x32_bf16 v[40:43], a[204:207], a[4:7], v[40:43]
buffer_load_dwordx4 a[80:83], v5, s[4:7], s59 offen offset:512 sc1
v_fma_mix_f32 v216, v118, v204, v212 op_sel:[0,0,0] op_sel_hi:[1,0,0]
v_mfma_f32_16x16x32_bf16 v[44:47], a[4:7], a[208:211], v[44:47]
ds_read_b128 a[36:39], v9 offset:60416
v_fma_mix_f32 v217, v118, v205, v213 op_sel:[1,0,0] op_sel_hi:[1,0,0]
v_mfma_f32_16x16x32_bf16 v[48:51], a[212:215], a[4:7], v[48:51]
v_cvt_pk_bf16_f32 v222, v216, v217
v_fma_mix_f32 v218, v119, v206, v214 op_sel:[0,0,0] op_sel_hi:[1,0,0]
v_mfma_f32_16x16x32_bf16 v[52:55], a[200:203], a[8:11], v[52:55]
v_fma_mix_f32 v219, v119, v207, v215 op_sel:[1,0,0] op_sel_hi:[1,0,0]
v_cvt_pk_bf16_f32 v223, v218, v219
v_mfma_f32_16x16x32_bf16 v[56:59], a[204:207], a[8:11], v[56:59]
buffer_load_dwordx4 a[84:87], v6, s[4:7], s59 offen offset:768 sc1
s_add_u32 s59, s59, 16384
v_mfma_f32_16x16x32_bf16 v[60:63], a[8:11], a[208:211], v[60:63]
ds_write_b128 v7, v[220:223] offset:20480
v_mfma_f32_16x16x32_bf16 v[64:67], a[212:215], a[8:11], v[64:67]
v_fma_mix_f32 v216, v136, v200, v208 op_sel:[0,0,0] op_sel_hi:[1,0,0]
v_fma_mix_f32 v217, v136, v201, v209 op_sel:[1,0,0] op_sel_hi:[1,0,0]
v_mfma_f32_16x16x32_bf16 v[68:71], a[200:203], a[12:15], v[68:71]
v_cvt_pk_bf16_f32 v224, v216, v217
v_fma_mix_f32 v218, v137, v202, v210 op_sel:[0,0,0] op_sel_hi:[1,0,0]
v_mfma_f32_16x16x32_bf16 v[72:75], a[204:207], a[12:15], v[72:75]
buffer_load_dwordx4 a[88:91], v5, s[4:7], s59 offen offset:0 sc1
v_fma_mix_f32 v219, v137, v203, v211 op_sel:[1,0,0] op_sel_hi:[1,0,0]
v_mfma_f32_16x16x32_bf16 v[76:79], a[12:15], a[208:211], v[76:79]
v_cvt_pk_bf16_f32 v225, v218, v219
v_fma_mix_f32 v216, v138, v204, v212 op_sel:[0,0,0] op_sel_hi:[1,0,0]
v_mfma_f32_16x16x32_bf16 v[80:83], a[212:215], a[12:15], v[80:83]
v_fma_mix_f32 v217, v138, v205, v213 op_sel:[1,0,0] op_sel_hi:[1,0,0]
v_cvt_pk_bf16_f32 v226, v216, v217
v_mfma_f32_16x16x32_bf16 v[84:87], a[200:203], a[16:19], v[84:87]
v_fma_mix_f32 v218, v139, v206, v214 op_sel:[0,0,0] op_sel_hi:[1,0,0]
v_fma_mix_f32 v219, v139, v207, v215 op_sel:[1,0,0] op_sel_hi:[1,0,0]
v_mfma_f32_16x16x32_bf16 v[88:91], a[204:207], a[16:19], v[88:91]
v_cvt_pk_bf16_f32 v227, v218, v219
v_fma_mix_f32 v216, v156, v200, v208 op_sel:[0,0,0] op_sel_hi:[1,0,0]
v_mfma_f32_16x16x32_bf16 v[92:95], a[16:19], a[208:211], v[92:95]
v_fma_mix_f32 v217, v156, v201, v209 op_sel:[1,0,0] op_sel_hi:[1,0,0]
v_cvt_pk_bf16_f32 v220, v216, v217
v_mfma_f32_16x16x32_bf16 v[96:99], a[212:215], a[16:19], v[96:99]
s_waitcnt vmcnt(13) lgkmcnt(1)
s_barrier
v_fma_mix_f32 v218, v157, v202, v210 op_sel:[0,0,0] op_sel_hi:[1,0,0]
v_mfma_f32_16x16x32_bf16 v[20:23], a[216:219], a[20:23], v[20:23]
ds_read_b128 a[0:3], v4 offset:0
v_fma_mix_f32 v219, v157, v203, v211 op_sel:[1,0,0] op_sel_hi:[1,0,0]
v_mfma_f32_16x16x32_bf16 v[24:27], a[220:223], a[20:23], v[24:27]
buffer_load_dwordx4 a[92:95], v5, s[4:7], s59 offen offset:256 sc1
v_cvt_pk_bf16_f32 v221, v218, v219
v_mfma_f32_16x16x32_bf16 v[28:31], a[20:23], a[224:227], v[28:31]
ds_read_b128 a[4:7], v4 offset:1024
v_fma_mix_f32 v216, v158, v204, v212 op_sel:[0,0,0] op_sel_hi:[1,0,0]
v_mfma_f32_16x16x32_bf16 v[32:35], a[228:231], a[20:23], v[32:35]
ds_read_b128 a[8:11], v4 offset:2048
v_fma_mix_f32 v217, v158, v205, v213 op_sel:[1,0,0] op_sel_hi:[1,0,0]
v_mfma_f32_16x16x32_bf16 v[36:39], a[216:219], a[24:27], v[36:39]
ds_read_b128 a[12:15], v4 offset:3072
v_cvt_pk_bf16_f32 v222, v216, v217
v_mfma_f32_16x16x32_bf16 v[40:43], a[220:223], a[24:27], v[40:43]
buffer_load_dwordx4 a[96:99], v5, s[4:7], s59 offen offset:512 sc1
v_fma_mix_f32 v218, v159, v206, v214 op_sel:[0,0,0] op_sel_hi:[1,0,0]
v_mfma_f32_16x16x32_bf16 v[44:47], a[24:27], a[224:227], v[44:47]
ds_read_b128 a[16:19], v4 offset:4096
v_fma_mix_f32 v219, v159, v207, v215 op_sel:[1,0,0] op_sel_hi:[1,0,0]
v_mfma_f32_16x16x32_bf16 v[48:51], a[228:231], a[24:27], v[48:51]
ds_write_b128 v253, v[224:227] offset:20480
v_mfma_f32_16x16x32_bf16 v[52:55], a[216:219], a[28:31], v[52:55]
v_cvt_pk_bf16_f32 v223, v218, v219
v_fma_mix_f32 v216, v176, v200, v208 op_sel:[0,0,0] op_sel_hi:[1,0,0]
v_mfma_f32_16x16x32_bf16 v[56:59], a[220:223], a[28:31], v[56:59]
buffer_load_dwordx4 a[100:103], v6, s[4:7], s59 offen offset:768 sc1
s_add_u32 s59, s59, 16384
v_mfma_f32_16x16x32_bf16 v[60:63], a[28:31], a[224:227], v[60:63]
v_fma_mix_f32 v217, v176, v201, v209 op_sel:[1,0,0] op_sel_hi:[1,0,0]
v_cvt_pk_bf16_f32 v224, v216, v217
v_mfma_f32_16x16x32_bf16 v[64:67], a[228:231], a[28:31], v[64:67]
ds_write_b128 v254, v[220:223] offset:20480
v_mfma_f32_16x16x32_bf16 v[68:71], a[216:219], a[32:35], v[68:71]
v_fma_mix_f32 v218, v177, v202, v210 op_sel:[0,0,0] op_sel_hi:[1,0,0]
v_fma_mix_f32 v219, v177, v203, v211 op_sel:[1,0,0] op_sel_hi:[1,0,0]
v_mfma_f32_16x16x32_bf16 v[72:75], a[220:223], a[32:35], v[72:75]
buffer_load_dwordx4 a[104:107], v5, s[4:7], s59 offen offset:0 sc1
v_cvt_pk_bf16_f32 v225, v218, v219
v_mfma_f32_16x16x32_bf16 v[76:79], a[32:35], a[224:227], v[76:79]
v_fma_mix_f32 v216, v178, v204, v212 op_sel:[0,0,0] op_sel_hi:[1,0,0]
v_fma_mix_f32 v217, v178, v205, v213 op_sel:[1,0,0] op_sel_hi:[1,0,0]
v_mfma_f32_16x16x32_bf16 v[80:83], a[228:231], a[32:35], v[80:83]
v_cvt_pk_bf16_f32 v226, v216, v217
v_fma_mix_f32 v218, v179, v206, v214 op_sel:[0,0,0] op_sel_hi:[1,0,0]
v_mfma_f32_16x16x32_bf16 v[84:87], a[216:219], a[36:39], v[84:87]
v_fma_mix_f32 v219, v179, v207, v215 op_sel:[1,0,0] op_sel_hi:[1,0,0]
v_cvt_pk_bf16_f32 v227, v218, v219
v_mfma_f32_16x16x32_bf16 v[88:91], a[220:223], a[36:39], v[88:91]
buffer_load_dwordx4 a[108:111], v5, s[4:7], s59 offen offset:256 sc1
v_fma_mix_f32 v216, v196, v200, v208 op_sel:[0,0,0] op_sel_hi:[1,0,0]
v_mfma_f32_16x16x32_bf16 v[92:95], a[36:39], a[224:227], v[92:95]
v_fma_mix_f32 v217, v196, v201, v209 op_sel:[1,0,0] op_sel_hi:[1,0,0]
v_cvt_pk_bf16_f32 v220, v216, v217
v_mfma_f32_16x16x32_bf16 v[96:99], a[228:231], a[36:39], v[96:99]
s_waitcnt vmcnt(14) lgkmcnt(2)
v_fma_mix_f32 v218, v197, v202, v210 op_sel:[0,0,0] op_sel_hi:[1,0,0]
v_fma_mix_f32 v219, v197, v203, v211 op_sel:[1,0,0] op_sel_hi:[1,0,0]
v_mfma_f32_16x16x32_bf16 v[20:23], a[40:43], a[0:3], v[20:23]
ds_read_b128 a[20:23], v251 offset:5120
v_cvt_pk_bf16_f32 v221, v218, v219
v_mfma_f32_16x16x32_bf16 v[24:27], a[44:47], a[0:3], v[24:27]
buffer_load_dwordx4 a[112:115], v5, s[4:7], s59 offen offset:512 sc1
v_fma_mix_f32 v216, v198, v204, v212 op_sel:[0,0,0] op_sel_hi:[1,0,0]
v_mfma_f32_16x16x32_bf16 v[28:31], a[0:3], a[48:51], v[28:31]
ds_read_b128 a[24:27], v251 offset:6144
v_fma_mix_f32 v217, v198, v205, v213 op_sel:[1,0,0] op_sel_hi:[1,0,0]
v_mfma_f32_16x16x32_bf16 v[32:35], a[52:55], a[0:3], v[32:35]
ds_read_b128 a[28:31], v251 offset:7168
v_cvt_pk_bf16_f32 v222, v216, v217
v_mfma_f32_16x16x32_bf16 v[36:39], a[40:43], a[4:7], v[36:39]
ds_read_b128 a[32:35], v251 offset:8192
v_fma_mix_f32 v218, v199, v206, v214 op_sel:[0,0,0] op_sel_hi:[1,0,0]
v_mfma_f32_16x16x32_bf16 v[40:43], a[44:47], a[4:7], v[40:43]
buffer_load_dwordx4 a[116:119], v6, s[4:7], s59 offen offset:768 sc1
s_add_u32 s59, s59, 16384
v_mfma_f32_16x16x32_bf16 v[44:47], a[4:7], a[48:51], v[44:47]
ds_read_b128 a[36:39], v251 offset:9216
v_fma_mix_f32 v219, v199, v207, v215 op_sel:[1,0,0] op_sel_hi:[1,0,0]
v_mfma_f32_16x16x32_bf16 v[48:51], a[52:55], a[4:7], v[48:51]
ds_read_b64_tr_b16 a[168:169], v249 offset:0
v_cvt_pk_bf16_f32 v223, v218, v219
v_mfma_f32_16x16x32_bf16 v[52:55], a[40:43], a[8:11], v[52:55]
ds_read_b64_tr_b16 a[170:171], v249 offset:768
v_add_u32 v253, 61440, v249
v_mfma_f32_16x16x32_bf16 v[56:59], a[44:47], a[8:11], v[56:59]
buffer_load_dwordx4 a[120:123], v5, s[4:7], s59 offen offset:0 sc1
v_add_u32 v254, 61440, v252
v_mfma_f32_16x16x32_bf16 v[60:63], a[8:11], a[48:51], v[60:63]
ds_read_b64_tr_b16 a[172:173], v252 offset:0
v_lshlrev_b32 v7, 4, v1
v_mfma_f32_16x16x32_bf16 v[64:67], a[52:55], a[8:11], v[64:67]
ds_read_b64_tr_b16 a[174:175], v252 offset:768
v_lshl_add_u32 v247, v3, 4, s12
v_mfma_f32_16x16x32_bf16 v[68:71], a[40:43], a[12:15], v[68:71]
ds_write_b128 v244, v[224:227] offset:20480
v_mfma_f32_16x16x32_bf16 v[72:75], a[44:47], a[12:15], v[72:75]
buffer_load_dwordx4 a[124:127], v5, s[4:7], s59 offen offset:256 sc1
v_mul_u32_u24 v228, 192, v2
v_mfma_f32_16x16x32_bf16 v[76:79], a[12:15], a[48:51], v[76:79]
v_lshl_add_u32 v228, v3, 3, v228
v_add_u32 v248, s13, v228
v_mfma_f32_16x16x32_bf16 v[80:83], a[52:55], a[12:15], v[80:83]
v_add_u32 v250, s13, v7
v_lshlrev_b32 v0, 2, v1
v_mfma_f32_16x16x32_bf16 v[84:87], a[40:43], a[16:19], v[84:87]
ds_write_b128 v245, v[220:223] offset:20480
v_mfma_f32_16x16x32_bf16 v[88:91], a[44:47], a[16:19], v[88:91]
v_add_u32 v227, s12, v7
v_min_u32 v226, 13, v1
v_mfma_f32_16x16x32_bf16 v[92:95], a[16:19], a[48:51], v[92:95]
v_lshlrev_b32 v226, 7, v226
v_lshlrev_b32 v181, 2, v3
v_mfma_f32_16x16x32_bf16 v[96:99], a[52:55], a[16:19], v[96:99]
s_waitcnt vmcnt(14) lgkmcnt(6)
v_sub_u32 v181, v2, v181
v_mov_b32 v168, 0xf0000000
v_mfma_f32_16x16x32_bf16 v[20:23], a[56:59], a[20:23], v[20:23]
ds_read_b128 a[0:3], v4 offset:10240
v_subrev_u32 v182, 0, v181
v_mfma_f32_16x16x32_bf16 v[24:27], a[60:63], a[20:23], v[24:27]
buffer_load_dwordx4 a[128:131], v5, s[4:7], s59 offen offset:512 sc1
v_bfe_i32 v182, v182, 3, 1
v_mfma_f32_16x16x32_bf16 v[28:31], a[20:23], a[64:67], v[28:31]
ds_read_b128 a[4:7], v4 offset:11264
v_and_b32 v164, v168, v182
v_mfma_f32_16x16x32_bf16 v[32:35], a[68:71], a[20:23], v[32:35]
ds_read_b128 a[8:11], v4 offset:12288
v_mov_b32 v176, 0x3f803f80
v_mfma_f32_16x16x32_bf16 v[36:39], a[56:59], a[24:27], v[36:39]
ds_read_b128 a[12:15], v4 offset:13312
v_subrev_u32 v182, 1, v181
v_mfma_f32_16x16x32_bf16 v[40:43], a[60:63], a[24:27], v[40:43]
buffer_load_dwordx4 a[132:135], v6, s[4:7], s59 offen offset:768 sc1
s_add_u32 s59, s59, 16384
v_mfma_f32_16x16x32_bf16 v[44:47], a[24:27], a[64:67], v[44:47]
ds_read_b128 a[16:19], v4 offset:14336
v_bfe_i32 v182, v182, 3, 1
v_mfma_f32_16x16x32_bf16 v[48:51], a[68:71], a[24:27], v[48:51]
ds_read_b64_tr_b16 a[176:177], v249 offset:64
v_and_b32 v165, v168, v182
v_mfma_f32_16x16x32_bf16 v[52:55], a[56:59], a[28:31], v[52:55]
ds_read_b64_tr_b16 a[178:179], v249 offset:832
v_mov_b32 v177, 0x3f803f80
v_mfma_f32_16x16x32_bf16 v[56:59], a[60:63], a[28:31], v[56:59]
buffer_load_dwordx4 a[136:139], v5, s[4:7], s59 offen offset:0 sc1
v_subrev_u32 v182, 2, v181
v_mfma_f32_16x16x32_bf16 v[60:63], a[28:31], a[64:67], v[60:63]
ds_read_b64_tr_b16 a[180:181], v252 offset:64
v_bfe_i32 v182, v182, 3, 1
v_mfma_f32_16x16x32_bf16 v[64:67], a[68:71], a[28:31], v[64:67]
ds_read_b64_tr_b16 a[182:183], v252 offset:832
v_and_b32 v166, v168, v182
v_mfma_f32_16x16x32_bf16 v[68:71], a[56:59], a[32:35], v[68:71]
v_mov_b32 v178, 0x3f803f80
v_subrev_u32 v182, 3, v181
v_mfma_f32_16x16x32_bf16 v[72:75], a[60:63], a[32:35], v[72:75]
buffer_load_dwordx4 a[140:143], v5, s[4:7], s59 offen offset:256 sc1
v_bfe_i32 v182, v182, 3, 1
v_mfma_f32_16x16x32_bf16 v[76:79], a[32:35], a[64:67], v[76:79]
v_and_b32 v167, v168, v182
v_mov_b32 v179, 0x3f803f80
v_mfma_f32_16x16x32_bf16 v[80:83], a[68:71], a[32:35], v[80:83]
v_and_b32 v181, 1, v1
v_lshlrev_b32 v181, 4, v181
v_mfma_f32_16x16x32_bf16 v[84:87], a[56:59], a[36:39], v[84:87]
v_mov_b32 v182, 0x3f80
v_lshlrev_b32 v182, v181, v182
v_mfma_f32_16x16x32_bf16 v[88:91], a[60:63], a[36:39], v[88:91]
buffer_load_dwordx4 a[144:147], v5, s[4:7], s59 offen offset:512 sc1
v_and_b32 v181, 0x32, v1
v_mfma_f32_16x16x32_bf16 v[92:95], a[36:39], a[64:67], v[92:95]
v_cmp_eq_u32 vcc, 0x30, v181
v_cmp_eq_u32 s[62:63], 50, v181
v_mfma_f32_16x16x32_bf16 v[96:99], a[68:71], a[36:39], v[96:99]
s_waitcnt vmcnt(15) lgkmcnt(4)
v_mul_u32_u24 v229, 176, v2
v_cndmask_b32 v174, 0, v182, vcc
v_mfma_f32_16x16x32_bf16 v[20:23], a[72:75], a[0:3], v[20:23]
ds_read_b128 a[20:23], v251 offset:15360
v_cndmask_b32 v175, 0, v182, s[62:63]
v_mfma_f32_16x16x32_bf16 v[24:27], a[76:79], a[0:3], v[24:27]
buffer_load_dwordx4 a[148:151], v6, s[4:7], s59 offen offset:768 sc1
s_add_u32 s59, s59, 16384
v_mfma_f32_16x16x32_bf16 v[28:31], a[0:3], a[80:83], v[28:31]
ds_read_b128 a[24:27], v251 offset:16384
v_add_u32 v229, s61, v229
v_mfma_f32_16x16x32_bf16 v[32:35], a[84:87], a[0:3], v[32:35]
ds_read_b128 a[28:31], v251 offset:17408
v_lshl_add_u32 v228, v3, 3, v229
v_mfma_f32_16x16x32_bf16 v[36:39], a[72:75], a[4:7], v[36:39]
ds_read_b128 a[32:35], v251 offset:18432
v_mov_b32 v122, 0
v_mfma_f32_16x16x32_bf16 v[40:43], a[76:79], a[4:7], v[40:43]
buffer_load_dwordx4 a[152:155], v5, s[4:7], s59 offen offset:0 sc1
v_mov_b32 v123, 0
v_mfma_f32_16x16x32_bf16 v[44:47], a[4:7], a[80:83], v[44:47]
ds_read_b128 a[36:39], v251 offset:19456
v_mov_b32 v126, 0
v_mfma_f32_16x16x32_bf16 v[48:51], a[84:87], a[4:7], v[48:51]
ds_read_b64_tr_b16 a[184:185], v249 offset:128
v_mov_b32 v127, 0
v_mfma_f32_16x16x32_bf16 v[52:55], a[72:75], a[8:11], v[52:55]
ds_read_b64_tr_b16 a[186:187], v249 offset:896
v_mov_b32 v130, 0
v_mfma_f32_16x16x32_bf16 v[56:59], a[76:79], a[8:11], v[56:59]
buffer_load_dwordx4 a[156:159], v5, s[4:7], s59 offen offset:256 sc1
v_mov_b32 v131, 0
v_mfma_f32_16x16x32_bf16 v[60:63], a[8:11], a[80:83], v[60:63]
ds_read_b64_tr_b16 a[188:189], v252 offset:128
v_mov_b32 v134, 0
v_mfma_f32_16x16x32_bf16 v[64:67], a[84:87], a[8:11], v[64:67]
ds_read_b64_tr_b16 a[190:191], v252 offset:896
v_mov_b32 v135, 0
v_mfma_f32_16x16x32_bf16 v[68:71], a[72:75], a[12:15], v[68:71]
v_mov_b32 v138, 0
v_mov_b32 v139, 0
v_mfma_f32_16x16x32_bf16 v[72:75], a[76:79], a[12:15], v[72:75]
buffer_load_dwordx4 a[160:163], v5, s[4:7], s59 offen offset:512 sc1
v_mfma_f32_16x16x32_bf16 v[76:79], a[12:15], a[80:83], v[76:79]
v_mfma_f32_16x16x32_bf16 v[80:83], a[84:87], a[12:15], v[80:83]
v_mfma_f32_16x16x32_bf16 v[84:87], a[72:75], a[16:19], v[84:87]
v_mfma_f32_16x16x32_bf16 v[88:91], a[76:79], a[16:19], v[88:91]
buffer_load_dwordx4 a[164:167], v6, s[4:7], s59 offen offset:768 sc1
s_add_u32 s59, s59, 16384
v_mfma_f32_16x16x32_bf16 v[92:95], a[16:19], a[80:83], v[92:95]
v_mfma_f32_16x16x32_bf16 v[96:99], a[84:87], a[16:19], v[96:99]
s_waitcnt vmcnt(16) lgkmcnt(4)
s_barrier
v_mfma_f32_16x16x32_bf16 v[20:23], a[88:91], a[20:23], v[20:23]
ds_read_b128 a[0:3], v4 offset:20480
s_add_u32 m0, s39, 24576
v_mfma_f32_16x16x32_bf16 v[24:27], a[92:95], a[20:23], v[24:27]
buffer_load_dwordx4 v232, s[24:27], s48 offen offset:0 lds
v_mfma_f32_16x16x32_bf16 v[28:31], a[20:23], a[96:99], v[28:31]
ds_read_b128 a[4:7], v4 offset:21504
v_mfma_f32_16x16x32_bf16 v[32:35], a[100:103], a[20:23], v[32:35]
ds_read_b128 a[8:11], v4 offset:22528
v_mfma_f32_16x16x32_bf16 v[36:39], a[88:91], a[24:27], v[36:39]
ds_read_b128 a[12:15], v4 offset:23552
v_mfma_f32_16x16x32_bf16 v[40:43], a[92:95], a[24:27], v[40:43]
buffer_load_dwordx4 v233, s[24:27], s48 offen offset:1024 lds
v_mfma_f32_16x16x32_bf16 v[44:47], a[24:27], a[96:99], v[44:47]
ds_read_b128 a[16:19], v4 offset:24576
v_mfma_f32_16x16x32_bf16 v[48:51], a[100:103], a[24:27], v[48:51]
ds_read_b64_tr_b16 a[192:193], v249 offset:6144
v_mfma_f32_16x16x32_bf16 v[52:55], a[88:91], a[28:31], v[52:55]
ds_read_b64_tr_b16 a[194:195], v249 offset:6912
v_mfma_f32_16x16x32_bf16 v[56:59], a[92:95], a[28:31], v[56:59]
buffer_load_dwordx4 v234, s[24:27], s48 offen offset:2048 lds
s_add_u32 s48, s48, 81920
v_mfma_f32_16x16x32_bf16 v[60:63], a[28:31], a[96:99], v[60:63]
ds_read_b64_tr_b16 a[196:197], v252 offset:6144
v_mfma_f32_16x16x32_bf16 v[64:67], a[100:103], a[28:31], v[64:67]
ds_read_b64_tr_b16 a[198:199], v252 offset:6912
v_mfma_f32_16x16x32_bf16 v[68:71], a[88:91], a[32:35], v[68:71]
ds_read_b64_tr_b16 a[206:207], v252 offset:6976
s_add_u32 m0, s39, 36864
v_mfma_f32_16x16x32_bf16 v[72:75], a[92:95], a[32:35], v[72:75]
buffer_load_dwordx4 v232, s[24:27], s48 offen offset:0 lds
v_mfma_f32_16x16x32_bf16 v[76:79], a[32:35], a[96:99], v[76:79]
ds_read_b64_tr_b16 a[200:201], v249 offset:6208
v_mfma_f32_16x16x32_bf16 v[80:83], a[100:103], a[32:35], v[80:83]
ds_read_b64_tr_b16 a[202:203], v249 offset:6976
v_mfma_f32_16x16x32_bf16 v[84:87], a[88:91], a[36:39], v[84:87]
ds_read_b64_tr_b16 a[208:209], v249 offset:6272
v_mfma_f32_16x16x32_bf16 v[88:91], a[92:95], a[36:39], v[88:91]
v_mfma_f32_16x16x32_bf16 v[92:95], a[36:39], a[96:99], v[92:95]
ds_read_b64_tr_b16 a[204:205], v252 offset:6208
v_mfma_f32_16x16x32_bf16 v[96:99], a[100:103], a[36:39], v[96:99]
s_waitcnt vmcnt(16) lgkmcnt(9)
v_mfma_f32_16x16x32_bf16 v[20:23], a[104:107], a[0:3], v[20:23]
ds_read_b128 a[20:23], v251 offset:25600
v_mfma_f32_16x16x32_bf16 v[24:27], a[108:111], a[0:3], v[24:27]
buffer_load_dwordx4 v233, s[24:27], s48 offen offset:1024 lds
v_mfma_f32_16x16x32_bf16 v[28:31], a[0:3], a[112:115], v[28:31]
ds_read_b128 a[24:27], v251 offset:26624
v_mfma_f32_16x16x32_bf16 v[32:35], a[116:119], a[0:3], v[32:35]
ds_read_b128 a[28:31], v251 offset:27648
v_mfma_f32_16x16x32_bf16 v[36:39], a[104:107], a[4:7], v[36:39]
ds_read_b128 a[32:35], v251 offset:28672
v_mfma_f32_16x16x32_bf16 v[40:43], a[108:111], a[4:7], v[40:43]
buffer_load_dwordx4 v234, s[24:27], s48 offen offset:2048 lds
s_add_u32 s48, s48, 81920
v_mfma_f32_16x16x32_bf16 v[44:47], a[4:7], a[112:115], v[44:47]
ds_read_b128 a[36:39], v251 offset:29696
v_mfma_f32_16x16x32_bf16 v[48:51], a[116:119], a[4:7], v[48:51]
ds_read_b64_tr_b16 a[210:211], v249 offset:7040
v_mfma_f32_16x16x32_bf16 v[52:55], a[104:107], a[8:11], v[52:55]
ds_read_b64_tr_b16 a[212:213], v252 offset:6272
s_add_u32 m0, s39, 49152
v_mfma_f32_16x16x32_bf16 v[56:59], a[108:111], a[8:11], v[56:59]
buffer_load_dwordx4 v232, s[24:27], s48 offen offset:0 lds
v_mfma_f32_16x16x32_bf16 v[60:63], a[8:11], a[112:115], v[60:63]
ds_read_b64_tr_b16 a[214:215], v252 offset:7040
v_mfma_f32_16x16x32_bf16 v[64:67], a[116:119], a[8:11], v[64:67]
ds_read_b64_tr_b16 a[216:217], v249 offset:12288
v_mfma_f32_16x16x32_bf16 v[68:71], a[104:107], a[12:15], v[68:71]
ds_read_b64_tr_b16 a[224:225], v249 offset:12352
v_mfma_f32_16x16x32_bf16 v[72:75], a[108:111], a[12:15], v[72:75]
buffer_load_dwordx4 v233, s[24:27], s48 offen offset:1024 lds
v_mfma_f32_16x16x32_bf16 v[76:79], a[12:15], a[112:115], v[76:79]
ds_read_b64_tr_b16 a[218:219], v249 offset:13056
v_mfma_f32_16x16x32_bf16 v[80:83], a[116:119], a[12:15], v[80:83]
ds_read_b64_tr_b16 a[220:221], v252 offset:12288
v_mfma_f32_16x16x32_bf16 v[84:87], a[104:107], a[16:19], v[84:87]
ds_read_b64_tr_b16 a[226:227], v249 offset:13120
v_mfma_f32_16x16x32_bf16 v[88:91], a[108:111], a[16:19], v[88:91]
buffer_load_dwordx4 v234, s[24:27], s48 offen offset:2048 lds
s_add_u32 s48, s48, 81920
v_mfma_f32_16x16x32_bf16 v[92:95], a[16:19], a[112:115], v[92:95]
ds_read_b64_tr_b16 a[222:223], v252 offset:13056
v_mfma_f32_16x16x32_bf16 v[96:99], a[116:119], a[16:19], v[96:99]
s_waitcnt vmcnt(17) lgkmcnt(9)
v_mfma_f32_16x16x32_bf16 v[20:23], a[120:123], a[20:23], v[20:23]
ds_read_b128 a[0:3], v4 offset:30720
s_add_u32 m0, s39, 61440
v_mfma_f32_16x16x32_bf16 v[24:27], a[124:127], a[20:23], v[24:27]
buffer_load_dwordx4 v232, s[24:27], s48 offen offset:0 lds
v_mfma_f32_16x16x32_bf16 v[28:31], a[20:23], a[128:131], v[28:31]
ds_read_b128 a[4:7], v4 offset:31744
v_mfma_f32_16x16x32_bf16 v[32:35], a[132:135], a[20:23], v[32:35]
ds_read_b128 a[8:11], v4 offset:32768
v_mfma_f32_16x16x32_bf16 v[36:39], a[120:123], a[24:27], v[36:39]
ds_read_b128 a[12:15], v4 offset:33792
v_mfma_f32_16x16x32_bf16 v[40:43], a[124:127], a[24:27], v[40:43]
buffer_load_dwordx4 v233, s[24:27], s48 offen offset:1024 lds
v_mfma_f32_16x16x32_bf16 v[44:47], a[24:27], a[128:131], v[44:47]
ds_read_b128 a[16:19], v4 offset:34816
v_mfma_f32_16x16x32_bf16 v[48:51], a[132:135], a[24:27], v[48:51]
ds_read_b64_tr_b16 a[228:229], v252 offset:12352
v_mfma_f32_16x16x32_bf16 v[52:55], a[120:123], a[28:31], v[52:55]
ds_read_b64_tr_b16 a[230:231], v252 offset:13120
v_mfma_f32_16x16x32_bf16 v[56:59], a[124:127], a[28:31], v[56:59]
buffer_load_dwordx4 v234, s[24:27], s48 offen offset:2048 lds
s_add_u32 s48, s48, 81920
v_mfma_f32_16x16x32_bf16 v[60:63], a[28:31], a[128:131], v[60:63]
ds_read_b64_tr_b16 a[232:233], v249 offset:12416
v_mfma_f32_16x16x32_bf16 v[64:67], a[132:135], a[28:31], v[64:67]
ds_read_b64_tr_b16 a[234:235], v249 offset:13184
v_mfma_f32_16x16x32_bf16 v[68:71], a[120:123], a[32:35], v[68:71]
ds_read_b64_tr_b16 a[242:243], v249 offset:19200
s_add_u32 m0, s49, 122880
v_mfma_f32_16x16x32_bf16 v[72:75], a[124:127], a[32:35], v[72:75]
buffer_load_dwordx4 v235, s[8:11], s50 offen offset:0 lds
v_mfma_f32_16x16x32_bf16 v[76:79], a[32:35], a[128:131], v[76:79]
ds_read_b64_tr_b16 a[236:237], v252 offset:12416
v_mfma_f32_16x16x32_bf16 v[80:83], a[132:135], a[32:35], v[80:83]
ds_read_b64_tr_b16 a[238:239], v252 offset:13184
v_mfma_f32_16x16x32_bf16 v[84:87], a[120:123], a[36:39], v[84:87]
ds_read_b64_tr_b16 a[244:245], v252 offset:18432
v_mfma_f32_16x16x32_bf16 v[88:91], a[124:127], a[36:39], v[88:91]
v_mfma_f32_16x16x32_bf16 v[92:95], a[36:39], a[128:131], v[92:95]
ds_read_b64_tr_b16 a[240:241], v249 offset:18432
v_mfma_f32_16x16x32_bf16 v[96:99], a[132:135], a[36:39], v[96:99]
s_waitcnt vmcnt(17) lgkmcnt(9)
v_mfma_f32_16x16x32_bf16 v[20:23], a[136:139], a[0:3], v[20:23]
ds_read_b128 a[20:23], v251 offset:35840
v_mfma_f32_16x16x32_bf16 v[24:27], a[140:143], a[0:3], v[24:27]
buffer_load_dwordx4 v236, s[8:11], s50 offen offset:1024 lds
v_mfma_f32_16x16x32_bf16 v[28:31], a[0:3], a[144:147], v[28:31]
ds_read_b128 a[24:27], v251 offset:36864
v_mfma_f32_16x16x32_bf16 v[32:35], a[148:151], a[0:3], v[32:35]
ds_read_b128 a[28:31], v251 offset:37888
v_mfma_f32_16x16x32_bf16 v[36:39], a[136:139], a[4:7], v[36:39]
ds_read_b128 a[32:35], v251 offset:38912
v_mfma_f32_16x16x32_bf16 v[40:43], a[140:143], a[4:7], v[40:43]
buffer_load_dwordx4 v237, s[8:11], s50 offen offset:2048 lds
v_mfma_f32_16x16x32_bf16 v[44:47], a[4:7], a[144:147], v[44:47]
ds_read_b128 a[36:39], v251 offset:39936
v_mfma_f32_16x16x32_bf16 v[48:51], a[148:151], a[4:7], v[48:51]
ds_read_b64_tr_b16 a[246:247], v252 offset:19200
v_mfma_f32_16x16x32_bf16 v[52:55], a[136:139], a[8:11], v[52:55]
ds_read_b64_tr_b16 a[248:249], v249 offset:18496
s_add_u32 m0, s39, 73728
v_mfma_f32_16x16x32_bf16 v[56:59], a[140:143], a[8:11], v[56:59]
buffer_load_dwordx4 v232, s[24:27], s48 offen offset:0 lds
v_mfma_f32_16x16x32_bf16 v[60:63], a[8:11], a[144:147], v[60:63]
ds_read_b64_tr_b16 a[250:251], v249 offset:19264
v_mfma_f32_16x16x32_bf16 v[64:67], a[148:151], a[8:11], v[64:67]
ds_read_b64_tr_b16 a[252:253], v252 offset:18496
v_mfma_f32_16x16x32_bf16 v[68:71], a[136:139], a[12:15], v[68:71]
ds_read_b64_tr_b16 a[44:45], v252 offset:18560
v_mfma_f32_16x16x32_bf16 v[72:75], a[140:143], a[12:15], v[72:75]
buffer_load_dwordx4 v233, s[24:27], s48 offen offset:1024 lds
v_mfma_f32_16x16x32_bf16 v[76:79], a[12:15], a[144:147], v[76:79]
ds_read_b64_tr_b16 a[254:255], v252 offset:19264
v_mfma_f32_16x16x32_bf16 v[80:83], a[148:151], a[12:15], v[80:83]
ds_read_b64_tr_b16 a[40:41], v249 offset:18560
v_mfma_f32_16x16x32_bf16 v[84:87], a[136:139], a[16:19], v[84:87]
ds_read_b64_tr_b16 a[46:47], v252 offset:19328
v_mfma_f32_16x16x32_bf16 v[88:91], a[140:143], a[16:19], v[88:91]
buffer_load_dwordx4 v234, s[24:27], s48 offen offset:2048 lds
s_add_u32 s48, s48, 81920
v_mfma_f32_16x16x32_bf16 v[92:95], a[16:19], a[144:147], v[92:95]
ds_read_b64_tr_b16 a[42:43], v249 offset:19328
v_mfma_f32_16x16x32_bf16 v[96:99], a[148:151], a[16:19], v[96:99]
s_waitcnt vmcnt(18) lgkmcnt(9)
s_barrier
s_mov_b32 s62, 1051011932
s_mov_b32 s63, 1051011932
s_mov_b32 s20, 0
s_mov_b32 s21, 0x00ff00ff
v_mfma_f32_16x16x32_bf16 v[32:35], a[164:167], a[20:23], v[32:35]
buffer_load_dwordx2 v[194:195], v231, s[4:7], s23 offen sc1
v_mfma_f32_16x16x32_bf16 v[48:51], a[164:167], a[24:27], v[48:51]
v_mfma_f32_16x16x32_bf16 v[64:67], a[164:167], a[28:31], v[64:67]
v_mfma_f32_16x16x32_bf16 v[80:83], a[164:167], a[32:35], v[80:83]
v_mfma_f32_16x16x32_bf16 v[20:23], a[152:155], a[20:23], v[20:23]
v_mfma_f32_16x16x32_bf16 v[24:27], a[156:159], a[20:23], v[24:27]
v_mfma_f32_16x16x32_bf16 v[36:39], a[152:155], a[24:27], v[36:39]
s_nop 0
v_cvt_pk_bf16_f32 v102, v32, v33
v_mfma_f32_16x16x32_bf16 v[40:43], a[156:159], a[24:27], v[40:43]
v_cvt_pk_bf16_f32 v103, v34, v35
v_cvt_pk_bf16_f32 v106, v48, v49
v_mfma_f32_16x16x32_bf16 v[52:55], a[152:155], a[28:31], v[52:55]
v_cvt_pk_bf16_f32 v107, v50, v51
v_cvt_pk_bf16_f32 v110, v64, v65
v_mfma_f32_16x16x32_bf16 v[56:59], a[156:159], a[28:31], v[56:59]
buffer_load_dwordx4 v[240:243], v238, s[4:7], s51 offen sc1
v_cvt_pk_bf16_f32 v111, v66, v67
v_cvt_pk_bf16_f32 v114, v80, v81
v_mfma_f32_16x16x32_bf16 v[68:71], a[152:155], a[32:35], v[68:71]
v_cvt_pk_bf16_f32 v115, v82, v83
v_permlane32_swap_b32 v122, v102
v_mfma_f32_16x16x32_bf16 v[72:75], a[156:159], a[32:35], v[72:75]
v_permlane32_swap_b32 v123, v103
v_permlane32_swap_b32 v126, v106
v_permlane32_swap_b32 v127, v107
v_permlane32_swap_b32 v130, v110
v_permlane32_swap_b32 v131, v111
v_permlane32_swap_b32 v134, v114
v_permlane32_swap_b32 v135, v115
v_cvt_pk_bf16_f32 v100, v24, v25
v_cvt_pk_bf16_f32 v101, v26, v27
v_cvt_pk_bf16_f32 v120, v20, v21
v_cvt_pk_bf16_f32 v121, v22, v23
buffer_load_dwordx4 v[190:193], v238, s[4:7], s22 offen sc1
v_cvt_pk_bf16_f32 v104, v40, v41
v_cvt_pk_bf16_f32 v105, v42, v43
v_cvt_pk_bf16_f32 v124, v36, v37
v_cvt_pk_bf16_f32 v125, v38, v39
v_cvt_pk_bf16_f32 v108, v56, v57
v_cvt_pk_bf16_f32 v109, v58, v59
v_cvt_pk_bf16_f32 v128, v52, v53
v_cvt_pk_bf16_f32 v129, v54, v55
v_cvt_pk_bf16_f32 v112, v72, v73
v_cvt_pk_bf16_f32 v113, v74, v75
v_cvt_pk_bf16_f32 v132, v68, v69
v_cvt_pk_bf16_f32 v133, v70, v71
v_mfma_f32_16x16x32_bf16 v[24:27], v[100:103], v[120:123], v[164:167]
v_mfma_f32_16x16x32_bf16 v[40:43], v[104:107], v[124:127], v[164:167]
buffer_load_dwordx2 v[244:245], v239, s[28:31], s52 offen
v_mfma_f32_16x16x32_bf16 v[36:39], v[100:103], v[124:127], v[164:167]
v_mfma_f32_16x16x32_bf16 v[56:59], v[108:111], v[128:131], v[164:167]
v_mfma_f32_16x16x32_bf16 v[52:55], v[104:107], v[128:131], v[164:167]
v_mfma_f32_16x16x32_bf16 v[72:75], v[112:115], v[132:135], v[164:167]
v_mfma_f32_16x16x32_bf16 v[68:71], v[108:111], v[132:135], v[164:167]
s_nop 0
v_cndmask_b32 v24, v24, v168, s[20:21]
v_cndmask_b32 v25, v25, v168, s[20:21]
v_cndmask_b32 v26, v26, v168, s[20:21]
v_cndmask_b32 v40, v40, v36, s[20:21]
v_cndmask_b32 v41, v41, v37, s[20:21]
v_cndmask_b32 v42, v42, v38, s[20:21]
v_cndmask_b32 v56, v56, v52, s[20:21]
v_cndmask_b32 v57, v57, v53, s[20:21]
v_cndmask_b32 v58, v58, v54, s[20:21]
v_cndmask_b32 v72, v72, v68, s[20:21]
v_cndmask_b32 v73, v73, v69, s[20:21]
v_cndmask_b32 v74, v74, v70, s[20:21]
buffer_load_dword v196, v226, s[4:7], s14 offen sc1
v_cndmask_b32 v27, v27, v168, s[20:21]
v_max3_f32 v180, v24, v25, v26
v_cndmask_b32 v43, v43, v39, s[20:21]
v_max3_f32 v181, v40, v41, v42
v_cndmask_b32 v59, v59, v55, s[20:21]
v_max3_f32 v182, v56, v57, v58
v_cndmask_b32 v75, v75, v71, s[20:21]
v_max3_f32 v183, v72, v73, v74
v_max_f32 v180, v180, v27
v_max_f32 v181, v181, v43
v_max_f32 v182, v182, v59
v_max_f32 v183, v183, v75
v_mfma_f32_16x16x32_bf16 v[96:99], a[164:167], a[36:39], v[96:99]
v_permlane32_swap_b32 v180, v182
v_permlane32_swap_b32 v181, v183
v_max_f32 v180, v180, v182
s_add_u32 m0, s39, 86016
v_max_f32 v181, v181, v183
buffer_load_dwordx4 v232, s[24:27], s48 offen offset:0 lds
v_mfma_f32_16x16x32_bf16 v[84:87], a[152:155], a[36:39], v[84:87]
v_permlane16_swap_b32 v180, v181
v_max_f32 v181, v180, v181
v_mul_f32 v180, s62, v181
v_mul_f32 v182, s62, v181
v_mfma_f32_16x16x32_bf16 v[88:91], a[156:159], a[36:39], v[88:91]
s_nop 0
v_permlane32_swap_b32 v180, v182
v_mfma_f32_16x16x32_bf16 v[28:31], a[20:23], a[160:163], v[28:31]
v_mov_b32 v181, v180
v_cvt_pk_bf16_f32 v118, v96, v97
v_mfma_f32_16x16x16_bf16 v[32:35], v[102:103], v[174:175], 0
v_cvt_pk_bf16_f32 v119, v98, v99
v_permlane16_swap_b32 v180, v181
v_mfma_f32_16x16x32_bf16 v[44:47], a[24:27], a[160:163], v[44:47]
buffer_load_dwordx4 v233, s[24:27], s48 offen offset:1024 lds
v_permlane32_swap_b32 v138, v118
v_permlane32_swap_b32 v139, v119
v_cvt_pk_bf16_f32 v116, v88, v89
v_pk_fma_f32 v[24:25], v[24:25], s[62:63], v[180:181] op_sel:[0,0,0] op_sel_hi:[1,0,0] neg_lo:[0,0,1] neg_hi:[0,0,1]
v_pk_fma_f32 v[26:27], v[26:27], s[62:63], v[180:181] op_sel:[0,0,0] op_sel_hi:[1,0,0] neg_lo:[0,0,1] neg_hi:[0,0,1]
v_cvt_pk_bf16_f32 v117, v90, v91
v_cvt_pk_bf16_f32 v136, v84, v85
v_cvt_pk_bf16_f32 v137, v86, v87
v_exp_f32 v24, v24
v_exp_f32 v25, v25
v_exp_f32 v26, v26
v_exp_f32 v27, v27
v_cvt_pk_bf16_f32 v143, v30, v31
v_mfma_f32_16x16x16_bf16 v[48:51], v[106:107], v[174:175], 0
buffer_load_dwordx4 v234, s[24:27], s48 offen offset:2048 lds
s_add_u32 s48, s48, 81920
v_cvt_pk_bf16_f32 v30, v24, v25
v_cvt_pk_bf16_f32 v31, v26, v27
v_mfma_f32_16x16x32_bf16 v[88:91], v[116:119], v[136:139], v[164:167]
v_cvt_pk_bf16_f32 v154, v32, v33
v_cvt_pk_bf16_f32 v155, v34, v35
v_mfma_f32_16x16x32_bf16 v[84:87], v[112:115], v[136:139], v[164:167]
v_cvt_pk_bf16_f32 v142, v28, v29
v_cvt_pk_bf16_f32 v145, v46, v47
v_mfma_f32_16x16x32_bf16 v[60:63], a[28:31], a[160:163], v[60:63]
v_mov_b32 v183, v182
v_cvt_pk_bf16_f32 v144, v44, v45
v_mfma_f32_16x16x16_bf16 v[32:35], v[176:177], v[30:31], 0
v_permlane16_swap_b32 v182, v183
s_add_u32 m0, s39, 98304
v_mfma_f32_16x16x16_bf16 v[20:23], v[142:143], v[30:31], 0
buffer_load_dwordx4 v232, s[24:27], s48 offen offset:0 lds
v_cvt_pk_bf16_f32 v156, v48, v49
v_cvt_pk_bf16_f32 v157, v50, v51
v_mfma_f32_16x16x16_bf16 v[64:67], v[110:111], v[174:175], 0
v_cndmask_b32 v88, v88, v84, s[20:21]
v_cndmask_b32 v89, v89, v85, s[20:21]
v_cndmask_b32 v90, v90, v86, s[20:21]
v_mfma_f32_16x16x16_bf16 v[24:27], v[154:155], v[30:31], 0
v_cndmask_b32 v91, v91, v87, s[20:21]
v_max3_f32 v184, v88, v89, v90
v_mfma_f32_16x16x32_bf16 v[76:79], a[32:35], a[160:163], v[76:79]
v_max_f32 v184, v184, v91
v_cvt_pk_bf16_f32 v147, v62, v63
v_mov_b32 v185, v184
v_rcp_f32 v32, v32
v_pk_fma_f32 v[40:41], v[40:41], s[62:63], v[180:181] op_sel:[0,0,1] op_sel_hi:[1,0,1] neg_lo:[0,0,1] neg_hi:[0,0,1]
v_pk_fma_f32 v[42:43], v[42:43], s[62:63], v[180:181] op_sel:[0,0,1] op_sel_hi:[1,0,1] neg_lo:[0,0,1] neg_hi:[0,0,1]
v_exp_f32 v40, v40
buffer_load_dwordx4 v233, s[24:27], s48 offen offset:1024 lds
v_exp_f32 v41, v41
v_exp_f32 v42, v42
v_exp_f32 v43, v43
v_cvt_pk_bf16_f32 v46, v40, v41
v_cvt_pk_bf16_f32 v47, v42, v43
v_cndmask_b32 v44, 0, v46, s[20:21]
v_cndmask_b32 v45, 0, v47, s[20:21]
v_xor_b32 v46, v44, v46
v_xor_b32 v47, v45, v47
v_pk_fma_f32 v[56:57], v[56:57], s[62:63], v[182:183] op_sel:[0,0,0] op_sel_hi:[1,0,0] neg_lo:[0,0,1] neg_hi:[0,0,1]
v_pk_fma_f32 v[58:59], v[58:59], s[62:63], v[182:183] op_sel:[0,0,0] op_sel_hi:[1,0,0] neg_lo:[0,0,1] neg_hi:[0,0,1]
v_mfma_f32_16x16x32_bf16 v[48:51], v[176:179], v[44:47], 0
v_exp_f32 v56, v56
v_exp_f32 v57, v57
v_exp_f32 v58, v58
v_exp_f32 v59, v59
v_cvt_pk_bf16_f32 v146, v60, v61
buffer_load_dwordx4 v234, s[24:27], s48 offen offset:2048 lds
s_add_u32 s48, s48, 81920
v_mfma_f32_16x16x32_bf16 v[36:39], v[142:145], v[44:47], 0
v_cvt_pk_bf16_f32 v62, v56, v57
v_cvt_pk_bf16_f32 v63, v58, v59
v_cndmask_b32 v60, 0, v62, s[20:21]
v_cndmask_b32 v61, 0, v63, s[20:21]
v_mfma_f32_16x16x16_bf16 v[80:83], v[114:115], v[174:175], 0
v_permlane32_swap_b32 v184, v185
v_xor_b32 v62, v60, v62
v_xor_b32 v63, v61, v63
v_cvt_pk_bf16_f32 v158, v64, v65
v_pk_mul_f32 v[20:21], v[20:21], v[32:33] op_sel_hi:[1,0]
v_pk_mul_f32 v[22:23], v[22:23], v[32:33] op_sel_hi:[1,0]
v_cvt_pk_bf16_f32 v20, v20, v21
v_cvt_pk_bf16_f32 v159, v66, v67
v_max_f32 v184, v184, v185
v_cvt_pk_bf16_f32 v21, v22, v23
v_mfma_f32_16x16x32_bf16 v[40:43], v[154:157], v[44:47], 0
ds_write_b64 v228, v[20:21] offset:0
v_mfma_f32_16x16x32_bf16 v[92:95], a[36:39], a[160:163], v[92:95]
v_mov_b32 v185, v184
v_cvt_pk_bf16_f32 v149, v78, v79
v_mfma_f32_16x16x32_bf16 v[64:67], v[176:179], v[60:63], 0
v_rcp_f32 v48, v48
v_cvt_pk_bf16_f32 v148, v76, v77
v_permlane16_swap_b32 v184, v185
v_pk_fma_f32 v[72:73], v[72:73], s[62:63], v[182:183] op_sel:[0,0,1] op_sel_hi:[1,0,1] neg_lo:[0,0,1] neg_hi:[0,0,1]
v_pk_fma_f32 v[74:75], v[74:75], s[62:63], v[182:183] op_sel:[0,0,1] op_sel_hi:[1,0,1] neg_lo:[0,0,1] neg_hi:[0,0,1]
v_exp_f32 v72, v72
v_exp_f32 v73, v73
v_exp_f32 v74, v74
v_exp_f32 v75, v75
v_pk_mul_f32 v[24:25], v[24:25], v[32:33] op_sel_hi:[1,0]
v_pk_mul_f32 v[26:27], v[26:27], v[32:33] op_sel_hi:[1,0]
v_cvt_pk_bf16_f32 v24, v24, v25
v_cvt_pk_bf16_f32 v25, v26, v27
v_mfma_f32_16x16x32_bf16 v[52:55], v[144:147], v[60:63], 0
ds_write_b64 v229, v[24:25] offset:32
v_cvt_pk_bf16_f32 v78, v72, v73
v_cvt_pk_bf16_f32 v79, v74, v75
v_cndmask_b32 v76, 0, v78, s[20:21]
v_cndmask_b32 v77, 0, v79, s[20:21]
v_mfma_f32_16x16x16_bf16 v[96:99], v[118:119], v[174:175], 0
v_max_f32 v184, v184, v185
v_xor_b32 v78, v76, v78
v_xor_b32 v79, v77, v79
v_mul_f32 v184, s62, v184
v_cvt_pk_bf16_f32 v160, v80, v81
v_pk_mul_f32 v[36:37], v[36:37], v[48:49] op_sel_hi:[1,0]
v_pk_mul_f32 v[38:39], v[38:39], v[48:49] op_sel_hi:[1,0]
v_cvt_pk_bf16_f32 v36, v36, v37
v_cvt_pk_bf16_f32 v161, v82, v83
v_cvt_pk_bf16_f32 v37, v38, v39
v_mfma_f32_16x16x32_bf16 v[56:59], v[156:159], v[60:63], 0
ds_write_b64 v228, v[36:37] offset:2816
v_mfma_f32_16x16x32_bf16 v[80:83], v[176:179], v[76:79], 0
v_cvt_pk_bf16_f32 v151, v94, v95
v_rcp_f32 v64, v64
v_cvt_pk_bf16_f32 v150, v92, v93
v_mfma_f32_16x16x32_bf16 v[68:71], v[146:149], v[76:79], 0
v_cvt_pk_bf16_f32 v162, v96, v97
v_cvt_pk_bf16_f32 v163, v98, v99
v_mfma_f32_16x16x32_bf16 v[72:75], v[158:161], v[76:79], 0
s_nop 0
v_rcp_f32 v80, v80
v_pk_fma_f32 v[88:89], v[88:89], s[62:63], v[184:185] op_sel:[0,0,0] op_sel_hi:[1,0,0] neg_lo:[0,0,1] neg_hi:[0,0,1]
v_pk_fma_f32 v[90:91], v[90:91], s[62:63], v[184:185] op_sel:[0,0,0] op_sel_hi:[1,0,0] neg_lo:[0,0,1] neg_hi:[0,0,1]
v_exp_f32 v88, v88
v_exp_f32 v89, v89
v_exp_f32 v90, v90
v_exp_f32 v91, v91
v_pk_mul_f32 v[40:41], v[40:41], v[48:49] op_sel_hi:[1,0]
v_pk_mul_f32 v[42:43], v[42:43], v[48:49] op_sel_hi:[1,0]
v_cvt_pk_bf16_f32 v40, v40, v41
v_cvt_pk_bf16_f32 v41, v42, v43
v_cvt_pk_bf16_f32 v94, v88, v89
v_cvt_pk_bf16_f32 v95, v90, v91
ds_write_b64 v229, v[40:41] offset:2848
v_cndmask_b32 v92, 0, v94, s[20:21]
v_cndmask_b32 v93, 0, v95, s[20:21]
v_pk_mul_f32 v[52:53], v[52:53], v[64:65] op_sel_hi:[1,0]
v_xor_b32 v94, v92, v94
v_xor_b32 v95, v93, v95
v_pk_mul_f32 v[54:55], v[54:55], v[64:65] op_sel_hi:[1,0]
v_cvt_pk_bf16_f32 v52, v52, v53
v_cvt_pk_bf16_f32 v53, v54, v55
ds_write_b64 v228, v[52:53] offset:5632
v_mfma_f32_16x16x32_bf16 v[96:99], v[176:179], v[92:95], 0
v_mfma_f32_16x16x32_bf16 v[84:87], v[148:151], v[92:95], 0
v_mfma_f32_16x16x32_bf16 v[88:91], v[160:163], v[92:95], 0
v_pk_mul_f32 v[56:57], v[56:57], v[64:65] op_sel_hi:[1,0]
v_pk_mul_f32 v[58:59], v[58:59], v[64:65] op_sel_hi:[1,0]
v_cvt_pk_bf16_f32 v56, v56, v57
v_cvt_pk_bf16_f32 v57, v58, v59
ds_write_b64 v229, v[56:57] offset:5664
v_pk_mul_f32 v[68:69], v[68:69], v[80:81] op_sel_hi:[1,0]
v_pk_mul_f32 v[70:71], v[70:71], v[80:81] op_sel_hi:[1,0]
v_cvt_pk_bf16_f32 v68, v68, v69
v_cvt_pk_bf16_f32 v69, v70, v71
ds_write_b64 v228, v[68:69] offset:8448
v_pk_mul_f32 v[72:73], v[72:73], v[80:81] op_sel_hi:[1,0]
v_pk_mul_f32 v[74:75], v[74:75], v[80:81] op_sel_hi:[1,0]
v_cvt_pk_bf16_f32 v72, v72, v73
v_rcp_f32 v96, v96
v_cvt_pk_bf16_f32 v73, v74, v75
ds_write_b64 v229, v[72:73] offset:8480
v_pk_mul_f32 v[84:85], v[84:85], v[96:97] op_sel_hi:[1,0]
v_pk_mul_f32 v[86:87], v[86:87], v[96:97] op_sel_hi:[1,0]
v_cvt_pk_bf16_f32 v84, v84, v85
v_cvt_pk_bf16_f32 v85, v86, v87
ds_write_b64 v228, v[84:85] offset:11264
v_pk_mul_f32 v[88:89], v[88:89], v[96:97] op_sel_hi:[1,0]
v_pk_mul_f32 v[90:91], v[90:91], v[96:97] op_sel_hi:[1,0]
v_cvt_pk_bf16_f32 v88, v88, v89
v_cvt_pk_bf16_f32 v89, v90, v91
ds_write_b64 v229, v[88:89] offset:11296
s_waitcnt vmcnt(17) lgkmcnt(0)
s_barrier
ds_read_b128 v[20:23], v15 offset:0
ds_read_b128 v[24:27], v16 offset:256
ds_read_b128 v[28:31], v17 offset:512
ds_read_b128 v[32:35], v18 offset:768
s_mul_i32 s56, s53, 20480
s_add_u32 s56, s56, 4194304
s_mov_b32 s55, 0x05040100
s_add_u32 s57, s56, 4096
s_add_u32 s58, s56, 8192
s_add_u32 s59, s56, 12288
s_add_u32 s60, s56, 16384
s_waitcnt lgkmcnt(3)
buffer_store_dwordx4 v[20:23], v11, s[4:7], s46 offen sc1
s_waitcnt lgkmcnt(2)
buffer_store_dwordx4 v[24:27], v12, s[4:7], s46 offen sc1
s_waitcnt lgkmcnt(1)
buffer_store_dwordx4 v[28:31], v13, s[4:7], s46 offen sc1
s_waitcnt lgkmcnt(0)
buffer_store_dwordx4 v[32:35], v14, s[4:7], s46 offen sc1
s_waitcnt vmcnt(10)
v_perm_b32 v36, v241, v240, s55
v_perm_b32 v37, v243, v242, s55
v_xor_b32 v36, s40, v36
v_xor_b32 v37, s40, v37
v_or_b32 v38, v36, v37
v_perm_b32 v36, v191, v190, s55
v_perm_b32 v37, v193, v192, s55
v_xor_b32 v36, s40, v36
v_xor_b32 v37, s40, v37
v_or3_b32 v38, v38, v36, v37
v_and_b32 v38, v38, v230
v_xor_b32 v37, s40, v194
v_or_b32 v38, v38, v37
v_cmp_ne_u32 vcc, 0, v38
s_cbranch_vccnz L_mv_retry
L_mv_ok:
v_cmp_ne_u32 vcc, s19, v195
v_and_b32 v240, 0xffff0000, v240
v_and_b32 v241, 0xffff0000, v241
v_and_b32 v242, 0xffff0000, v242
v_and_b32 v243, 0xffff0000, v243
v_and_b32 v190, 0xffff0000, v190
v_and_b32 v191, 0xffff0000, v191
v_and_b32 v192, 0xffff0000, v192
v_and_b32 v193, 0xffff0000, v193
s_lshr_b32 s15, vcc_lo, 16
v_lshlrev_b32 v40, 16, v244
v_and_b32 v41, 0xffff0000, v244
v_lshlrev_b32 v42, 16, v245
v_and_b32 v43, 0xffff0000, v245
v_pk_mul_f32 v[40:41], v[40:41], v[190:191]
v_pk_mul_f32 v[42:43], v[42:43], v[192:193]
s_mov_b32 exec_hi, 0xffff
ds_write_b128 v227, v[40:43] offset:1536
ds_write_b128 v227, v[240:243]
ds_write_b128 v227, v[190:193] offset:768
s_mov_b32 exec_hi, -1
s_add_u32 m0, s39, 110592
s_nop 0
buffer_load_dwordx4 v232, s[24:27], s48 offen offset:0 lds
ds_read_b128 v[204:207], v247 offset:1536
ds_read_b128 v[208:211], v247 offset:1600
ds_read_b128 v[212:215], v247 offset:1664
ds_read_b128 v[216:219], v247 offset:1728
ds_read_b128 v[220:223], v247 offset:1792
ds_read_b128 v[224:227], v247 offset:1856
buffer_load_dwordx4 v233, s[24:27], s48 offen offset:1024 lds
ds_read_b64 v[80:81], v248 offset:0
ds_read_b64 v[82:83], v248 offset:32
ds_read_b64 v[84:85], v248 offset:64
ds_read_b64 v[86:87], v248 offset:96
ds_read_b64 v[88:89], v248 offset:128
ds_read_b64 v[90:91], v248 offset:160
buffer_load_dwordx4 v234, s[24:27], s48 offen offset:2048 lds
s_add_u32 s48, s48, 81920
ds_read_b64_tr_b16 a[48:49], v249 offset:24576
ds_read_b64_tr_b16 a[50:51], v249 offset:25344
ds_read_b64_tr_b16 a[52:53], v252 offset:24576
ds_read_b64_tr_b16 a[54:55], v252 offset:25344
ds_read_b64_tr_b16 a[56:57], v249 offset:24640
ds_read_b64_tr_b16 a[58:59], v249 offset:25408
ds_read_b64_tr_b16 a[60:61], v252 offset:24640
ds_read_b64_tr_b16 a[62:63], v252 offset:25408
ds_read_b64_tr_b16 a[64:65], v249 offset:24704
ds_read_b64_tr_b16 a[66:67], v249 offset:25472
ds_read_b64_tr_b16 a[68:69], v252 offset:24704
ds_read_b64_tr_b16 a[70:71], v252 offset:25472
ds_read_b64_tr_b16 a[72:73], v249 offset:30720
ds_read_b64_tr_b16 a[74:75], v249 offset:31488
ds_read_b64_tr_b16 a[76:77], v252 offset:30720
ds_read_b64_tr_b16 a[78:79], v252 offset:31488
ds_read_b64_tr_b16 a[80:81], v249 offset:30784
ds_read_b64_tr_b16 a[82:83], v249 offset:31552
ds_read_b64_tr_b16 a[84:85], v252 offset:30784
ds_read_b64_tr_b16 a[86:87], v252 offset:31552
ds_read_b64_tr_b16 a[88:89], v249 offset:30848
ds_read_b64_tr_b16 a[90:91], v249 offset:31616
ds_read_b64_tr_b16 a[92:93], v252 offset:30848
ds_read_b64_tr_b16 a[94:95], v252 offset:31616
ds_read_b64_tr_b16 a[96:97], v249 offset:36864
ds_read_b64_tr_b16 a[98:99], v249 offset:37632
ds_read_b64_tr_b16 a[100:101], v252 offset:36864
ds_read_b64_tr_b16 a[102:103], v252 offset:37632
ds_read_b64_tr_b16 a[104:105], v249 offset:36928
ds_read_b64_tr_b16 a[106:107], v249 offset:37696
ds_read_b64_tr_b16 a[108:109], v252 offset:36928
ds_read_b64_tr_b16 a[110:111], v252 offset:37696
ds_read_b64_tr_b16 a[112:113], v249 offset:36992
ds_read_b64_tr_b16 a[114:115], v249 offset:37760
ds_read_b64_tr_b16 a[116:117], v252 offset:36992
ds_read_b64_tr_b16 a[118:119], v252 offset:37760
ds_read_b64_tr_b16 a[120:121], v249 offset:43008
ds_read_b64_tr_b16 a[122:123], v249 offset:43776
ds_read_b64_tr_b16 a[124:125], v252 offset:43008
ds_read_b64_tr_b16 a[126:127], v252 offset:43776
ds_read_b64_tr_b16 a[128:129], v249 offset:43072
ds_read_b64_tr_b16 a[130:131], v249 offset:43840
ds_read_b64_tr_b16 a[132:133], v252 offset:43072
ds_read_b64_tr_b16 a[134:135], v252 offset:43840
ds_read_b64_tr_b16 a[136:137], v249 offset:43136
ds_read_b64_tr_b16 a[138:139], v249 offset:43904
ds_read_b64_tr_b16 a[140:141], v252 offset:43136
ds_read_b64_tr_b16 a[142:143], v252 offset:43904
ds_read_b64_tr_b16 a[144:145], v249 offset:49152
ds_read_b64_tr_b16 a[146:147], v249 offset:49920
ds_read_b64_tr_b16 a[148:149], v252 offset:49152
ds_read_b64_tr_b16 a[150:151], v252 offset:49920
ds_read_b64_tr_b16 a[152:153], v249 offset:49216
ds_read_b64_tr_b16 a[154:155], v249 offset:49984
ds_read_b64_tr_b16 a[156:157], v252 offset:49216
ds_read_b64_tr_b16 a[158:159], v252 offset:49984
ds_read_b64_tr_b16 a[160:161], v249 offset:49280
ds_read_b64_tr_b16 a[162:163], v249 offset:50048
buffer_load_dwordx4 v[100:103], v7, s[4:7], s56 offen offset:0 sc1
ds_read_b64_tr_b16 a[164:165], v252 offset:49280
ds_read_b64_tr_b16 a[166:167], v252 offset:50048
ds_read_b64_tr_b16 a[0:1], v249 offset:55296
ds_read_b64_tr_b16 a[2:3], v249 offset:56064
buffer_load_dwordx4 v[104:107], v7, s[4:7], s56 offen offset:1024 sc1
ds_read_b64_tr_b16 a[4:5], v252 offset:55296
ds_read_b64_tr_b16 a[6:7], v252 offset:56064
ds_read_b64_tr_b16 a[8:9], v249 offset:55360
ds_read_b64_tr_b16 a[10:11], v249 offset:56128
buffer_load_dwordx4 v[108:111], v7, s[4:7], s56 offen offset:2048 sc1
ds_read_b64_tr_b16 a[12:13], v252 offset:55360
ds_read_b64_tr_b16 a[14:15], v252 offset:56128
ds_read_b64_tr_b16 a[16:17], v249 offset:55424
ds_read_b64_tr_b16 a[18:19], v249 offset:56192
buffer_load_dwordx4 v[112:115], v7, s[4:7], s56 offen offset:3072 sc1
ds_read_b64_tr_b16 a[20:21], v252 offset:55424
ds_read_b64_tr_b16 a[22:23], v252 offset:56192
ds_read_b64_tr_b16 a[24:25], v253 offset:0
ds_read_b64_tr_b16 a[26:27], v253 offset:768
buffer_load_dwordx4 v[116:119], v7, s[4:7], s57 offen offset:0 sc1
ds_read_b64_tr_b16 a[28:29], v254 offset:0
ds_read_b64_tr_b16 a[30:31], v254 offset:768
ds_read_b64_tr_b16 a[32:33], v253 offset:64
ds_read_b64_tr_b16 a[34:35], v253 offset:832
buffer_load_dwordx4 v[120:123], v7, s[4:7], s57 offen offset:1024 sc1
s_waitcnt lgkmcnt(15)
v_pk_add_f32 v[94:95], v[204:205], v[206:207]
v_pk_add_f32 v[94:95], v[94:95], v[208:209]
v_pk_add_f32 v[94:95], v[94:95], v[210:211]
buffer_load_dwordx4 v[124:127], v7, s[4:7], s57 offen offset:2048 sc1
v_pk_add_f32 v[94:95], v[94:95], v[212:213]
v_pk_add_f32 v[94:95], v[94:95], v[214:215]
v_pk_add_f32 v[94:95], v[94:95], v[216:217]
v_pk_add_f32 v[94:95], v[94:95], v[218:219]
buffer_load_dwordx4 v[128:131], v7, s[4:7], s57 offen offset:3072 sc1
v_pk_add_f32 v[94:95], v[94:95], v[220:221]
v_pk_add_f32 v[94:95], v[94:95], v[222:223]
v_pk_add_f32 v[94:95], v[94:95], v[224:225]
v_pk_add_f32 v[94:95], v[94:95], v[226:227]
v_add_f32 v95, v94, v95
s_waitcnt vmcnt(6) lgkmcnt(0)
v_max3_u32 v92, v100, v101, v102
v_max3_u32 v93, v103, v104, v105
v_max3_u32 v92, v92, v106, v107
v_max_u32 v92, v92, v93
v_cmp_eq_u32 vcc, -1, v92
s_cbranch_vccnz L_o0_retry
L_o0_ok:
v_mfma_f32_16x16x32_bf16 v[20:23], a[168:171], v[100:103], 0
ds_read_b64_tr_b16 a[168:169], v254 offset:64
buffer_load_dwordx4 v[132:135], v7, s[4:7], s58 offen offset:0 sc1
v_mfma_f32_16x16x32_bf16 v[24:27], a[172:175], v[100:103], 0
ds_read_b64_tr_b16 a[170:171], v254 offset:832
buffer_load_dwordx4 v[136:139], v7, s[4:7], s58 offen offset:1024 sc1
v_mfma_f32_16x16x32_bf16 v[28:31], a[176:179], v[100:103], 0
ds_read_b64_tr_b16 a[172:173], v253 offset:128
s_barrier
v_mfma_f32_16x16x32_bf16 v[32:35], a[180:183], v[100:103], 0
ds_read_b64_tr_b16 a[174:175], v253 offset:896
s_waitcnt vmcnt(6)
v_mfma_f32_16x16x32_bf16 v[36:39], a[184:187], v[100:103], 0
ds_read_b64_tr_b16 a[176:177], v254 offset:128
v_max3_u32 v92, v108, v109, v110
v_mfma_f32_16x16x32_bf16 v[40:43], a[188:191], v[100:103], 0
ds_read_b64_tr_b16 a[178:179], v254 offset:896
v_max3_u32 v93, v111, v112, v113
v_mfma_f32_16x16x32_bf16 v[20:23], a[192:195], v[104:107], v[20:23]
ds_read_b64_tr_b16 a[180:181], v253 offset:6144
v_max3_u32 v92, v92, v114, v115
v_mfma_f32_16x16x32_bf16 v[24:27], a[196:199], v[104:107], v[24:27]
ds_read_b64_tr_b16 a[182:183], v253 offset:6912
v_max_u32 v92, v92, v93
v_mfma_f32_16x16x32_bf16 v[28:31], a[200:203], v[104:107], v[28:31]
ds_read_b64_tr_b16 a[184:185], v254 offset:6144
v_lshlrev_b32 v68, 16, v80
v_mfma_f32_16x16x32_bf16 v[32:35], a[204:207], v[104:107], v[32:35]
ds_read_b64_tr_b16 a[186:187], v254 offset:6912
v_cmp_eq_u32 vcc, -1, v92
v_mfma_f32_16x16x32_bf16 v[36:39], a[208:211], v[104:107], v[36:39]
ds_read_b64_tr_b16 a[188:189], v253 offset:6208
v_and_b32 v69, 0xffff0000, v80
v_mfma_f32_16x16x32_bf16 v[40:43], a[212:215], v[104:107], v[40:43]
ds_read_b64_tr_b16 a[190:191], v253 offset:6976
s_cbranch_vccnz L_o1_retry
L_o1_ok:
v_mfma_f32_16x16x32_bf16 v[20:23], a[216:219], v[108:111], v[20:23]
ds_read_b64_tr_b16 a[192:193], v254 offset:6208
buffer_load_dwordx4 v[140:143], v7, s[4:7], s58 offen offset:2048 sc1
v_mfma_f32_16x16x32_bf16 v[24:27], a[220:223], v[108:111], v[24:27]
ds_read_b64_tr_b16 a[194:195], v254 offset:6976
buffer_load_dwordx4 v[144:147], v7, s[4:7], s58 offen offset:3072 sc1
v_mfma_f32_16x16x32_bf16 v[28:31], a[224:227], v[108:111], v[28:31]
ds_read_b64_tr_b16 a[196:197], v253 offset:6272
v_lshlrev_b32 v70, 16, v81
v_mfma_f32_16x16x32_bf16 v[32:35], a[228:231], v[108:111], v[32:35]
ds_read_b64_tr_b16 a[198:199], v253 offset:7040
s_waitcnt vmcnt(6)
v_mfma_f32_16x16x32_bf16 v[36:39], a[232:235], v[108:111], v[36:39]
ds_read_b64_tr_b16 a[200:201], v254 offset:6272
v_max3_u32 v92, v116, v117, v118
v_mfma_f32_16x16x32_bf16 v[40:43], a[236:239], v[108:111], v[40:43]
ds_read_b64_tr_b16 a[202:203], v254 offset:7040
v_max3_u32 v93, v119, v120, v121
v_mfma_f32_16x16x32_bf16 v[20:23], a[240:243], v[112:115], v[20:23]
ds_read_b64_tr_b16 a[204:205], v253 offset:12288
v_max3_u32 v92, v92, v122, v123
v_mfma_f32_16x16x32_bf16 v[24:27], a[244:247], v[112:115], v[24:27]
ds_read_b64_tr_b16 a[206:207], v253 offset:13056
v_max_u32 v92, v92, v93
v_mfma_f32_16x16x32_bf16 v[28:31], a[248:251], v[112:115], v[28:31]
ds_read_b64_tr_b16 a[208:209], v254 offset:12288
v_and_b32 v71, 0xffff0000, v81
v_mfma_f32_16x16x32_bf16 v[32:35], a[252:255], v[112:115], v[32:35]
ds_read_b64_tr_b16 a[210:211], v254 offset:13056
v_cmp_eq_u32 vcc, -1, v92
v_mfma_f32_16x16x32_bf16 v[36:39], a[40:43], v[112:115], v[36:39]
ds_read_b64_tr_b16 a[212:213], v253 offset:12352
v_lshlrev_b32 v72, 16, v82
v_mfma_f32_16x16x32_bf16 v[40:43], a[44:47], v[112:115], v[40:43]
ds_read_b64_tr_b16 a[214:215], v253 offset:13120
s_cbranch_vccnz L_o2_retry
L_o2_ok:
v_mfma_f32_16x16x32_bf16 v[20:23], a[48:51], v[116:119], v[20:23]
ds_read_b64_tr_b16 a[216:217], v254 offset:12352
buffer_load_dwordx4 v[148:151], v7, s[4:7], s59 offen offset:0 sc1
v_mfma_f32_16x16x32_bf16 v[24:27], a[52:55], v[116:119], v[24:27]
ds_read_b64_tr_b16 a[218:219], v254 offset:13120
buffer_load_dwordx4 v[152:155], v7, s[4:7], s59 offen offset:1024 sc1
v_mfma_f32_16x16x32_bf16 v[28:31], a[56:59], v[116:119], v[28:31]
ds_read_b64_tr_b16 a[220:221], v253 offset:12416
v_and_b32 v73, 0xffff0000, v82
v_mfma_f32_16x16x32_bf16 v[32:35], a[60:63], v[116:119], v[32:35]
ds_read_b64_tr_b16 a[222:223], v253 offset:13184
s_waitcnt vmcnt(6)
v_mfma_f32_16x16x32_bf16 v[36:39], a[64:67], v[116:119], v[36:39]
ds_read_b64_tr_b16 a[224:225], v254 offset:12416
v_max3_u32 v92, v124, v125, v126
v_mfma_f32_16x16x32_bf16 v[40:43], a[68:71], v[116:119], v[40:43]
ds_read_b64_tr_b16 a[226:227], v254 offset:13184
v_max3_u32 v93, v127, v128, v129
v_mfma_f32_16x16x32_bf16 v[20:23], a[72:75], v[120:123], v[20:23]
ds_read_b64_tr_b16 a[228:229], v253 offset:18432
v_max3_u32 v92, v92, v130, v131
v_mfma_f32_16x16x32_bf16 v[24:27], a[76:79], v[120:123], v[24:27]
ds_read_b64_tr_b16 a[230:231], v253 offset:19200
v_max_u32 v92, v92, v93
v_mfma_f32_16x16x32_bf16 v[28:31], a[80:83], v[120:123], v[28:31]
ds_read_b64_tr_b16 a[232:233], v254 offset:18432
v_lshlrev_b32 v74, 16, v83
v_mfma_f32_16x16x32_bf16 v[32:35], a[84:87], v[120:123], v[32:35]
ds_read_b64_tr_b16 a[234:235], v254 offset:19200
v_cmp_eq_u32 vcc, -1, v92
v_mfma_f32_16x16x32_bf16 v[36:39], a[88:91], v[120:123], v[36:39]
ds_read_b64_tr_b16 a[236:237], v253 offset:18496
v_and_b32 v75, 0xffff0000, v83
v_mfma_f32_16x16x32_bf16 v[40:43], a[92:95], v[120:123], v[40:43]
ds_read_b64_tr_b16 a[238:239], v253 offset:19264
s_cbranch_vccnz L_o3_retry
L_o3_ok:
v_mfma_f32_16x16x32_bf16 v[20:23], a[96:99], v[124:127], v[20:23]
ds_read_b64_tr_b16 a[240:241], v254 offset:18496
buffer_load_dwordx4 v[156:159], v7, s[4:7], s59 offen offset:2048 sc1
v_mfma_f32_16x16x32_bf16 v[24:27], a[100:103], v[124:127], v[24:27]
ds_read_b64_tr_b16 a[242:243], v254 offset:19264
buffer_load_dwordx4 v[160:163], v7, s[4:7], s59 offen offset:3072 sc1
v_mfma_f32_16x16x32_bf16 v[28:31], a[104:107], v[124:127], v[28:31]
ds_read_b64_tr_b16 a[244:245], v253 offset:18560
v_lshlrev_b32 v76, 16, v84
v_mfma_f32_16x16x32_bf16 v[32:35], a[108:111], v[124:127], v[32:35]
ds_read_b64_tr_b16 a[246:247], v253 offset:19328
s_waitcnt vmcnt(6)
v_mfma_f32_16x16x32_bf16 v[36:39], a[112:115], v[124:127], v[36:39]
ds_read_b64_tr_b16 a[248:249], v254 offset:18560
v_max3_u32 v92, v132, v133, v134
v_mfma_f32_16x16x32_bf16 v[40:43], a[116:119], v[124:127], v[40:43]
ds_read_b64_tr_b16 a[250:251], v254 offset:19328
v_max3_u32 v93, v135, v136, v137
v_mfma_f32_16x16x32_bf16 v[20:23], a[120:123], v[128:131], v[20:23]
ds_read_b64_tr_b16 a[252:253], v253 offset:24576
v_max3_u32 v92, v92, v138, v139
v_mfma_f32_16x16x32_bf16 v[24:27], a[124:127], v[128:131], v[24:27]
ds_read_b64_tr_b16 a[254:255], v253 offset:25344
v_max_u32 v92, v92, v93
v_mfma_f32_16x16x32_bf16 v[28:31], a[128:131], v[128:131], v[28:31]
ds_read_b64_tr_b16 a[40:41], v254 offset:24576
v_and_b32 v77, 0xffff0000, v84
v_mfma_f32_16x16x32_bf16 v[32:35], a[132:135], v[128:131], v[32:35]
ds_read_b64_tr_b16 a[42:43], v254 offset:25344
v_cmp_eq_u32 vcc, -1, v92
v_mfma_f32_16x16x32_bf16 v[36:39], a[136:139], v[128:131], v[36:39]
ds_read_b64_tr_b16 a[44:45], v253 offset:24640
v_lshlrev_b32 v78, 16, v85
v_mfma_f32_16x16x32_bf16 v[40:43], a[140:143], v[128:131], v[40:43]
ds_read_b64_tr_b16 a[46:47], v253 offset:25408
s_cbranch_vccnz L_o4_retry
L_o4_ok:
v_mfma_f32_16x16x32_bf16 v[20:23], a[144:147], v[132:135], v[20:23]
ds_read_b64_tr_b16 a[48:49], v254 offset:24640
buffer_load_dwordx4 v[164:167], v7, s[4:7], s60 offen offset:0 sc1
v_mfma_f32_16x16x32_bf16 v[24:27], a[148:151], v[132:135], v[24:27]
ds_read_b64_tr_b16 a[50:51], v254 offset:25408
buffer_load_dwordx4 v[168:171], v7, s[4:7], s60 offen offset:1024 sc1
v_mfma_f32_16x16x32_bf16 v[28:31], a[152:155], v[132:135], v[28:31]
ds_read_b64_tr_b16 a[52:53], v253 offset:24704
v_and_b32 v79, 0xffff0000, v85
v_mfma_f32_16x16x32_bf16 v[32:35], a[156:159], v[132:135], v[32:35]
ds_read_b64_tr_b16 a[54:55], v253 offset:25472
s_waitcnt vmcnt(6)
v_mfma_f32_16x16x32_bf16 v[36:39], a[160:163], v[132:135], v[36:39]
ds_read_b64_tr_b16 a[56:57], v254 offset:24704
v_max3_u32 v92, v140, v141, v142
v_mfma_f32_16x16x32_bf16 v[40:43], a[164:167], v[132:135], v[40:43]
ds_read_b64_tr_b16 a[58:59], v254 offset:25472
v_max3_u32 v93, v143, v144, v145
v_mfma_f32_16x16x32_bf16 v[20:23], a[0:3], v[136:139], v[20:23]
ds_read_b64_tr_b16 a[60:61], v253 offset:30720
v_max3_u32 v92, v92, v146, v147
v_mfma_f32_16x16x32_bf16 v[24:27], a[4:7], v[136:139], v[24:27]
ds_read_b64_tr_b16 a[62:63], v253 offset:31488
v_max_u32 v92, v92, v93
v_mfma_f32_16x16x32_bf16 v[28:31], a[8:11], v[136:139], v[28:31]
ds_read_b64_tr_b16 a[64:65], v254 offset:30720
v_lshlrev_b32 v80, 16, v86
v_mfma_f32_16x16x32_bf16 v[32:35], a[12:15], v[136:139], v[32:35]
ds_read_b64_tr_b16 a[66:67], v254 offset:31488
v_cmp_eq_u32 vcc, -1, v92
v_mfma_f32_16x16x32_bf16 v[36:39], a[16:19], v[136:139], v[36:39]
ds_read_b64_tr_b16 a[68:69], v253 offset:30784
v_and_b32 v81, 0xffff0000, v86
v_mfma_f32_16x16x32_bf16 v[40:43], a[20:23], v[136:139], v[40:43]
ds_read_b64_tr_b16 a[70:71], v253 offset:31552
s_cbranch_vccnz L_o5_retry
L_o5_ok:
v_mfma_f32_16x16x32_bf16 v[20:23], a[24:27], v[140:143], v[20:23]
ds_read_b64_tr_b16 a[72:73], v254 offset:30784
buffer_load_dwordx4 v[172:175], v7, s[4:7], s60 offen offset:2048 sc1
v_mfma_f32_16x16x32_bf16 v[24:27], a[28:31], v[140:143], v[24:27]
ds_read_b64_tr_b16 a[74:75], v254 offset:31552
buffer_load_dwordx4 v[176:179], v7, s[4:7], s60 offen offset:3072 sc1
v_mfma_f32_16x16x32_bf16 v[28:31], a[32:35], v[140:143], v[28:31]
ds_read_b64_tr_b16 a[76:77], v253 offset:30848
s_waitcnt lgkmcnt(15)
v_mfma_f32_16x16x32_bf16 v[32:35], a[168:171], v[140:143], v[32:35]
ds_read_b64_tr_b16 a[78:79], v253 offset:31616
s_waitcnt vmcnt(6)
v_mfma_f32_16x16x32_bf16 v[36:39], a[172:175], v[140:143], v[36:39]
ds_read_b64_tr_b16 a[80:81], v254 offset:30848
v_max3_u32 v92, v148, v149, v150
v_mfma_f32_16x16x32_bf16 v[40:43], a[176:179], v[140:143], v[40:43]
ds_read_b64_tr_b16 a[82:83], v254 offset:31616
v_max3_u32 v93, v151, v152, v153
v_mfma_f32_16x16x32_bf16 v[20:23], a[180:183], v[144:147], v[20:23]
ds_read_b64_tr_b16 a[84:85], v253 offset:36864
v_max3_u32 v92, v92, v154, v155
v_mfma_f32_16x16x32_bf16 v[24:27], a[184:187], v[144:147], v[24:27]
ds_read_b64_tr_b16 a[86:87], v253 offset:37632
v_max_u32 v92, v92, v93
v_mfma_f32_16x16x32_bf16 v[28:31], a[188:191], v[144:147], v[28:31]
ds_read_b64_tr_b16 a[88:89], v254 offset:36864
v_mfma_f32_16x16x32_bf16 v[32:35], a[192:195], v[144:147], v[32:35]
ds_read_b64_tr_b16 a[90:91], v254 offset:37632
v_cmp_eq_u32 vcc, -1, v92
v_mfma_f32_16x16x32_bf16 v[36:39], a[196:199], v[144:147], v[36:39]
ds_read_b64_tr_b16 a[92:93], v253 offset:36928
v_lshlrev_b32 v82, 16, v87
v_mfma_f32_16x16x32_bf16 v[40:43], a[200:203], v[144:147], v[40:43]
ds_read_b64_tr_b16 a[94:95], v253 offset:37696
s_cbranch_vccnz L_o6_retry
L_o6_ok:
v_mfma_f32_16x16x32_bf16 v[20:23], a[204:207], v[148:151], v[20:23]
ds_read_b64_tr_b16 a[96:97], v254 offset:36928
v_and_b32 v83, 0xffff0000, v87
v_mfma_f32_16x16x32_bf16 v[24:27], a[208:211], v[148:151], v[24:27]
ds_read_b64_tr_b16 a[98:99], v254 offset:37696
v_lshlrev_b32 v84, 16, v88
v_mfma_f32_16x16x32_bf16 v[28:31], a[212:215], v[148:151], v[28:31]
ds_read_b64_tr_b16 a[100:101], v253 offset:36992
v_mfma_f32_16x16x32_bf16 v[32:35], a[216:219], v[148:151], v[32:35]
ds_read_b64_tr_b16 a[102:103], v253 offset:37760
s_waitcnt vmcnt(4)
v_mfma_f32_16x16x32_bf16 v[36:39], a[220:223], v[148:151], v[36:39]
ds_read_b64_tr_b16 a[104:105], v254 offset:36992
v_max3_u32 v92, v156, v157, v158
v_mfma_f32_16x16x32_bf16 v[40:43], a[224:227], v[148:151], v[40:43]
ds_read_b64_tr_b16 a[106:107], v254 offset:37760
v_max3_u32 v93, v159, v160, v161
v_mfma_f32_16x16x32_bf16 v[20:23], a[228:231], v[152:155], v[20:23]
ds_read_b64_tr_b16 a[108:109], v253 offset:43008
v_max3_u32 v92, v92, v162, v163
v_mfma_f32_16x16x32_bf16 v[24:27], a[232:235], v[152:155], v[24:27]
ds_read_b64_tr_b16 a[110:111], v253 offset:43776
v_max_u32 v92, v92, v93
v_mfma_f32_16x16x32_bf16 v[28:31], a[236:239], v[152:155], v[28:31]
ds_read_b64_tr_b16 a[112:113], v254 offset:43008
v_mfma_f32_16x16x32_bf16 v[32:35], a[240:243], v[152:155], v[32:35]
ds_read_b64_tr_b16 a[114:115], v254 offset:43776
v_cmp_eq_u32 vcc, -1, v92
v_mfma_f32_16x16x32_bf16 v[36:39], a[244:247], v[152:155], v[36:39]
ds_read_b64_tr_b16 a[116:117], v253 offset:43072
v_and_b32 v85, 0xffff0000, v88
v_mfma_f32_16x16x32_bf16 v[40:43], a[248:251], v[152:155], v[40:43]
ds_read_b64_tr_b16 a[118:119], v253 offset:43840
s_cbranch_vccnz L_o7_retry
L_o7_ok:
v_mfma_f32_16x16x32_bf16 v[20:23], a[252:255], v[156:159], v[20:23]
ds_read_b64_tr_b16 a[120:121], v254 offset:43072
v_lshlrev_b32 v86, 16, v89
v_mfma_f32_16x16x32_bf16 v[24:27], a[40:43], v[156:159], v[24:27]
ds_read_b64_tr_b16 a[122:123], v254 offset:43840
v_and_b32 v87, 0xffff0000, v89
v_mfma_f32_16x16x32_bf16 v[28:31], a[44:47], v[156:159], v[28:31]
ds_read_b64_tr_b16 a[124:125], v253 offset:43136
s_waitcnt lgkmcnt(15)
v_mfma_f32_16x16x32_bf16 v[32:35], a[48:51], v[156:159], v[32:35]
ds_read_b64_tr_b16 a[126:127], v253 offset:43904
s_waitcnt vmcnt(2)
v_mfma_f32_16x16x32_bf16 v[36:39], a[52:55], v[156:159], v[36:39]
ds_read_b64_tr_b16 a[128:129], v254 offset:43136
v_max3_u32 v92, v164, v165, v166
v_mfma_f32_16x16x32_bf16 v[40:43], a[56:59], v[156:159], v[40:43]
ds_read_b64_tr_b16 a[130:131], v254 offset:43904
v_max3_u32 v93, v167, v168, v169
v_mfma_f32_16x16x32_bf16 v[20:23], a[60:63], v[160:163], v[20:23]
ds_read_b64_tr_b16 a[132:133], v253 offset:49152
v_max3_u32 v92, v92, v170, v171
v_mfma_f32_16x16x32_bf16 v[24:27], a[64:67], v[160:163], v[24:27]
ds_read_b64_tr_b16 a[134:135], v253 offset:49920
v_max_u32 v92, v92, v93
v_mfma_f32_16x16x32_bf16 v[28:31], a[68:71], v[160:163], v[28:31]
ds_read_b64_tr_b16 a[136:137], v254 offset:49152
v_mfma_f32_16x16x32_bf16 v[32:35], a[72:75], v[160:163], v[32:35]
ds_read_b64_tr_b16 a[138:139], v254 offset:49920
v_cmp_eq_u32 vcc, -1, v92
v_mfma_f32_16x16x32_bf16 v[36:39], a[76:79], v[160:163], v[36:39]
ds_read_b64_tr_b16 a[140:141], v253 offset:49216
v_lshlrev_b32 v88, 16, v90
v_mfma_f32_16x16x32_bf16 v[40:43], a[80:83], v[160:163], v[40:43]
ds_read_b64_tr_b16 a[142:143], v253 offset:49984
s_cbranch_vccnz L_o8_retry
L_o8_ok:
v_mfma_f32_16x16x32_bf16 v[20:23], a[84:87], v[164:167], v[20:23]
ds_read_b64_tr_b16 a[144:145], v254 offset:49216
v_and_b32 v89, 0xffff0000, v90
v_mfma_f32_16x16x32_bf16 v[24:27], a[88:91], v[164:167], v[24:27]
ds_read_b64_tr_b16 a[146:147], v254 offset:49984
v_lshlrev_b32 v90, 16, v91
v_mfma_f32_16x16x32_bf16 v[28:31], a[92:95], v[164:167], v[28:31]
ds_read_b64_tr_b16 a[148:149], v253 offset:49280
s_waitcnt lgkmcnt(15)
v_mfma_f32_16x16x32_bf16 v[32:35], a[96:99], v[164:167], v[32:35]
ds_read_b64_tr_b16 a[150:151], v253 offset:50048
s_waitcnt vmcnt(0)
v_mfma_f32_16x16x32_bf16 v[36:39], a[100:103], v[164:167], v[36:39]
ds_read_b64_tr_b16 a[152:153], v254 offset:49280
v_max3_u32 v92, v172, v173, v174
v_mfma_f32_16x16x32_bf16 v[40:43], a[104:107], v[164:167], v[40:43]
ds_read_b64_tr_b16 a[154:155], v254 offset:50048
v_max3_u32 v93, v175, v176, v177
v_mfma_f32_16x16x32_bf16 v[20:23], a[108:111], v[168:171], v[20:23]
ds_read_b64_tr_b16 a[156:157], v253 offset:55296
v_max3_u32 v92, v92, v178, v179
v_mfma_f32_16x16x32_bf16 v[24:27], a[112:115], v[168:171], v[24:27]
ds_read_b64_tr_b16 a[158:159], v253 offset:56064
v_max_u32 v92, v92, v93
v_mfma_f32_16x16x32_bf16 v[28:31], a[116:119], v[168:171], v[28:31]
ds_read_b64_tr_b16 a[160:161], v254 offset:55296
s_waitcnt lgkmcnt(9)
v_mfma_f32_16x16x32_bf16 v[32:35], a[120:123], v[168:171], v[32:35]
ds_read_b64_tr_b16 a[162:163], v254 offset:56064
v_cmp_eq_u32 vcc, -1, v92
v_mfma_f32_16x16x32_bf16 v[36:39], a[124:127], v[168:171], v[36:39]
ds_read_b64_tr_b16 a[164:165], v253 offset:55360
v_and_b32 v91, 0xffff0000, v91
v_mfma_f32_16x16x32_bf16 v[40:43], a[128:131], v[168:171], v[40:43]
ds_read_b64_tr_b16 a[166:167], v253 offset:56128
s_cbranch_vccnz L_o9_retry
L_o9_ok:
v_mfma_f32_16x16x32_bf16 v[20:23], a[132:135], v[172:175], v[20:23]
ds_read_b64_tr_b16 a[0:1], v254 offset:55360
v_mfma_f32_16x16x32_bf16 v[24:27], a[136:139], v[172:175], v[24:27]
ds_read_b64_tr_b16 a[2:3], v254 offset:56128
v_mfma_f32_16x16x32_bf16 v[28:31], a[140:143], v[172:175], v[28:31]
ds_read_b64_tr_b16 a[4:5], v253 offset:55424
s_waitcnt lgkmcnt(9)
v_mfma_f32_16x16x32_bf16 v[32:35], a[144:147], v[172:175], v[32:35]
ds_read_b64_tr_b16 a[6:7], v253 offset:56192
v_mfma_f32_16x16x32_bf16 v[36:39], a[148:151], v[172:175], v[36:39]
ds_read_b64_tr_b16 a[8:9], v254 offset:55424
v_mfma_f32_16x16x32_bf16 v[40:43], a[152:155], v[172:175], v[40:43]
ds_read_b64_tr_b16 a[10:11], v254 offset:56192
s_waitcnt lgkmcnt(6)
v_mfma_f32_16x16x32_bf16 v[20:23], a[156:159], v[176:179], v[20:23]
ds_read_b128 v[180:183], v247 offset:0
v_mfma_f32_16x16x32_bf16 v[24:27], a[160:163], v[176:179], v[24:27]
ds_read_b128 v[184:187], v247 offset:64
v_mfma_f32_16x16x32_bf16 v[28:31], a[164:167], v[176:179], v[28:31]
ds_read_b128 v[188:191], v247 offset:128
s_waitcnt lgkmcnt(3)
v_mfma_f32_16x16x32_bf16 v[32:35], a[0:3], v[176:179], v[32:35]
ds_read_b128 v[192:195], v247 offset:192
v_mfma_f32_16x16x32_bf16 v[36:39], a[4:7], v[176:179], v[36:39]
ds_read_b128 v[196:199], v247 offset:256
v_mfma_f32_16x16x32_bf16 v[40:43], a[8:11], v[176:179], v[40:43]
ds_read_b128 v[200:203], v247 offset:320
s_lshl_b32 s57, s96, 8
s_add_u32 s57, s57, s14
s_mov_b32 s55, 0xffffff00
s_cmp_eq_u32 s15, 0
s_waitcnt lgkmcnt(4)
v_pk_fma_f32 v[20:21], v[20:21], v[180:181], v[68:69]
v_pk_fma_f32 v[22:23], v[22:23], v[182:183], v[70:71]
v_pk_mul_f32 v[46:47], v[20:21], v[20:21]
v_pk_mul_f32 v[48:49], v[20:21], v[204:205]
v_pk_fma_f32 v[24:25], v[24:25], v[184:185], v[72:73]
v_pk_add_f32 v[44:45], v[20:21], v[22:23]
v_pk_fma_f32 v[46:47], v[22:23], v[22:23], v[46:47]
v_pk_fma_f32 v[48:49], v[22:23], v[206:207], v[48:49]
v_pk_fma_f32 v[26:27], v[26:27], v[186:187], v[74:75]
v_pk_add_f32 v[44:45], v[44:45], v[24:25]
v_pk_fma_f32 v[46:47], v[24:25], v[24:25], v[46:47]
v_pk_fma_f32 v[48:49], v[24:25], v[208:209], v[48:49]
s_waitcnt lgkmcnt(2)
v_pk_fma_f32 v[28:29], v[28:29], v[188:189], v[76:77]
v_pk_add_f32 v[44:45], v[44:45], v[26:27]
v_pk_fma_f32 v[46:47], v[26:27], v[26:27], v[46:47]
v_pk_fma_f32 v[48:49], v[26:27], v[210:211], v[48:49]
v_pk_fma_f32 v[30:31], v[30:31], v[190:191], v[78:79]
v_pk_add_f32 v[44:45], v[44:45], v[28:29]
v_pk_fma_f32 v[46:47], v[28:29], v[28:29], v[46:47]
v_pk_fma_f32 v[48:49], v[28:29], v[212:213], v[48:49]
v_pk_fma_f32 v[32:33], v[32:33], v[192:193], v[80:81]
v_pk_add_f32 v[44:45], v[44:45], v[30:31]
v_pk_fma_f32 v[46:47], v[30:31], v[30:31], v[46:47]
v_pk_fma_f32 v[48:49], v[30:31], v[214:215], v[48:49]
v_pk_fma_f32 v[34:35], v[34:35], v[194:195], v[82:83]
v_pk_add_f32 v[44:45], v[44:45], v[32:33]
v_pk_fma_f32 v[46:47], v[32:33], v[32:33], v[46:47]
v_pk_fma_f32 v[48:49], v[32:33], v[216:217], v[48:49]
s_waitcnt lgkmcnt(0)
v_pk_fma_f32 v[36:37], v[36:37], v[196:197], v[84:85]
v_pk_add_f32 v[44:45], v[44:45], v[34:35]
v_pk_fma_f32 v[46:47], v[34:35], v[34:35], v[46:47]
v_pk_fma_f32 v[48:49], v[34:35], v[218:219], v[48:49]
v_pk_fma_f32 v[38:39], v[38:39], v[198:199], v[86:87]
v_pk_add_f32 v[44:45], v[44:45], v[36:37]
v_pk_fma_f32 v[46:47], v[36:37], v[36:37], v[46:47]
v_pk_fma_f32 v[48:49], v[36:37], v[220:221], v[48:49]
v_pk_fma_f32 v[40:41], v[40:41], v[200:201], v[88:89]
v_pk_add_f32 v[44:45], v[44:45], v[38:39]
v_pk_fma_f32 v[46:47], v[38:39], v[38:39], v[46:47]
v_pk_fma_f32 v[48:49], v[38:39], v[222:223], v[48:49]
v_pk_fma_f32 v[42:43], v[42:43], v[202:203], v[90:91]
v_pk_add_f32 v[44:45], v[44:45], v[40:41]
v_pk_fma_f32 v[46:47], v[40:41], v[40:41], v[46:47]
v_pk_fma_f32 v[48:49], v[40:41], v[224:225], v[48:49]
v_pk_fma_f32 v[48:49], v[42:43], v[226:227], v[48:49]
v_pk_add_f32 v[44:45], v[44:45], v[42:43]
v_pk_fma_f32 v[46:47], v[42:43], v[42:43], v[46:47]
v_add_f32 v48, v48, v49
v_add_f32 v44, v44, v45
v_add_f32 v46, v46, v47
v_permlane32_swap_b32 v48, v95
s_nop 0
v_permlane32_swap_b32 v44, v46
v_add_f32 v48, v48, v95
v_add_f32 v44, v44, v46
s_nop 1
v_permlane16_swap_b32 v44, v48
v_add_f32 v44, v44, v48
v_and_or_b32 v44, v44, s55, v19
s_cbranch_scc0 L_st_slow
buffer_store_dword v44, v0, s[4:7], s57 offen
L_st_j:
ds_read_b128 v[100:103], v247 offset:768
ds_read_b128 v[104:107], v247 offset:832
ds_read_b128 v[108:111], v247 offset:896
ds_read_b128 v[112:115], v247 offset:960
ds_read_b128 v[116:119], v247 offset:1024
ds_read_b128 v[120:123], v247 offset:1088
ds_read_b128 v[124:127], v247 offset:384
ds_read_b128 v[128:131], v247 offset:448
ds_read_b128 v[132:135], v247 offset:512
ds_read_b128 v[136:139], v247 offset:576
ds_read_b128 v[140:143], v247 offset:640
ds_read_b128 v[144:147], v247 offset:704
ds_read_b128 v[148:151], v247 offset:1152
ds_read_b128 v[152:155], v247 offset:1216
ds_read_b128 v[156:159], v247 offset:1280
ds_read_b128 v[160:163], v247 offset:1344
ds_read_b128 v[164:167], v247 offset:1408
ds_read_b128 v[168:171], v247 offset:1472
s_lshl_b32 s57, s3, 2
s_add_u32 s57, s57, 135168
v_mov_b32 v54, s57
v_and_b32 v55, 12, v0
v_add_u32 v55, 135168, v55
v_lshrrev_b32 v65, 3, v1
v_mul_u32_u24 v65, 384, v65
v_lshrrev_b32 v66, 5, v1
v_mul_u32_u24 v66, 6144, v66
v_add3_u32 v65, v65, v66, v7
L_st_p:
buffer_load_dword v180, v0, s[4:7], s14 offen offset:0 sc1
buffer_load_dword v181, v0, s[4:7], s14 offen offset:256 sc1
buffer_load_dword v182, v0, s[4:7], s14 offen offset:512 sc1
buffer_load_dword v183, v0, s[4:7], s14 offen offset:768 sc1
buffer_load_dword v184, v0, s[4:7], s14 offen offset:1024 sc1
buffer_load_dword v185, v0, s[4:7], s14 offen offset:1280 sc1
buffer_load_dword v186, v0, s[4:7], s14 offen offset:1536 sc1
s_waitcnt vmcnt(0)
v_xor_b32 v44, v180, v19
v_xor_b32 v45, v181, v19
v_xor_b32 v46, v182, v19
v_xor_b32 v47, v183, v19
v_xor_b32 v48, v184, v19
v_xor_b32 v49, v185, v19
v_xor_b32 v50, v186, v19
v_or3_b32 v52, v44, v45, v46
v_or3_b32 v53, v47, v48, v49
v_or3_b32 v52, v52, v53, v50
v_and_b32 v52, 0xff, v52
v_cmp_ne_u32 vcc, 0, v52
s_cbranch_vccz L_st_ok
s_add_u32 s97, s97, 1
s_cmp_le_u32 s97, 65536
s_cbranch_scc1 L_st_p
L_st_ok:
v_pk_add_f32 v[44:45], v[44:45], v[46:47]
v_add_f32 v48, v48, v50
v_pk_add_f32 v[44:45], v[44:45], v[48:49]
v_add_f32 v46, v44, v45
v_add_f32 v44, v44, v45
s_nop 1
v_permlane32_swap_b32 v44, v46
v_mov_b32 v45, v44
v_mov_b32 v47, v46
s_nop 0
v_permlane16_swap_b32 v44, v45
v_permlane16_swap_b32 v46, v47
v_mul_f32 v44, 0x3acccccd, v44
v_mul_f32 v46, 0x3acccccd, v46
v_fma_f32 v46, -v44, v44, v46
v_fma_f32 v45, -v44, v47, v45
v_max_f32 v46, 0, v46
v_add_f32 v46, 0x3727c5ac, v46
v_rsq_f32 v48, v46
s_nop 0
v_mul_f32 v45, v45, v48
v_mul_f32 v49, -v44, v48
v_pk_fma_f32 v[68:69], v[20:21], v[48:49], v[48:49] op_sel:[0,0,1] op_sel_hi:[1,0,1]
v_max_f32_dpp v46, v45, v45 row_ror:8 row_mask:0xf bank_mask:0xf
v_pk_fma_f32 v[70:71], v[22:23], v[48:49], v[48:49] op_sel:[0,0,1] op_sel_hi:[1,0,1]
v_pk_fma_f32 v[72:73], v[24:25], v[48:49], v[48:49] op_sel:[0,0,1] op_sel_hi:[1,0,1]
v_max_f32_dpp v46, v46, v46 row_ror:4 row_mask:0xf bank_mask:0xf
v_pk_fma_f32 v[74:75], v[26:27], v[48:49], v[48:49] op_sel:[0,0,1] op_sel_hi:[1,0,1]
v_pk_fma_f32 v[76:77], v[28:29], v[48:49], v[48:49] op_sel:[0,0,1] op_sel_hi:[1,0,1]
v_max_f32_dpp v46, v46, v46 row_ror:2 row_mask:0xf bank_mask:0xf
v_pk_fma_f32 v[78:79], v[30:31], v[48:49], v[48:49] op_sel:[0,0,1] op_sel_hi:[1,0,1]
v_pk_fma_f32 v[80:81], v[32:33], v[48:49], v[48:49] op_sel:[0,0,1] op_sel_hi:[1,0,1]
v_max_f32_dpp v46, v46, v46 row_ror:1 row_mask:0xf bank_mask:0xf
ds_write_b32 v54, v46
v_pk_fma_f32 v[82:83], v[34:35], v[48:49], v[48:49] op_sel:[0,0,1] op_sel_hi:[1,0,1]
v_pk_fma_f32 v[84:85], v[36:37], v[48:49], v[48:49] op_sel:[0,0,1] op_sel_hi:[1,0,1]
v_pk_fma_f32 v[86:87], v[38:39], v[48:49], v[48:49] op_sel:[0,0,1] op_sel_hi:[1,0,1]
v_pk_fma_f32 v[88:89], v[40:41], v[48:49], v[48:49] op_sel:[0,0,1] op_sel_hi:[1,0,1]
v_pk_fma_f32 v[90:91], v[42:43], v[48:49], v[48:49] op_sel:[0,0,1] op_sel_hi:[1,0,1]
s_waitcnt lgkmcnt(0)
s_barrier
ds_read_b32 v52, v55
v_pk_fma_f32 v[68:69], v[68:69], v[100:101], v[124:125]
v_pk_fma_f32 v[70:71], v[70:71], v[102:103], v[126:127]
v_pk_fma_f32 v[72:73], v[72:73], v[104:105], v[128:129]
v_pk_fma_f32 v[74:75], v[74:75], v[106:107], v[130:131]
v_pk_fma_f32 v[76:77], v[76:77], v[108:109], v[132:133]
v_pk_fma_f32 v[78:79], v[78:79], v[110:111], v[134:135]
v_pk_fma_f32 v[80:81], v[80:81], v[112:113], v[136:137]
v_pk_fma_f32 v[82:83], v[82:83], v[114:115], v[138:139]
v_pk_fma_f32 v[84:85], v[84:85], v[116:117], v[140:141]
v_pk_fma_f32 v[86:87], v[86:87], v[118:119], v[142:143]
v_pk_fma_f32 v[88:89], v[88:89], v[120:121], v[144:145]
v_pk_fma_f32 v[90:91], v[90:91], v[122:123], v[146:147]
s_waitcnt lgkmcnt(0)
v_max_f32_dpp v53, v52, v52 quad_perm:[1,0,3,2] row_mask:0xf bank_mask:0xf
s_nop 1
v_max_f32_dpp v53, v53, v53 quad_perm:[2,3,0,1] row_mask:0xf bank_mask:0xf
v_cmp_eq_f32 vcc, v53, v52
v_cmp_eq_f32 s[58:59], v53, v45
s_ff1_i32_b64 s57, vcc
s_and_b32 s57, s57, 3
s_cmp_eq_u32 s57, s3
s_cbranch_scc0 L_nowin
s_ff1_i32_b64 s57, s[58:59]
s_and_b32 s57, s57, 15
s_cmp_eq_u32 s96, 0
s_cbranch_scc0 L_nocand
s_lshl_b32 s58, s57, 1
s_add_u32 s58, s58, s54
v_mov_b32 v56, v53
v_mov_b32 v57, s58
v_mov_b32 v58, s40
v_mov_b32 v59, s53
s_mul_i32 s58, s47, 2048
s_andn2_b32 s59, s58, 8191
s_add_u32 s58, s58, s59
s_add_u32 s58, s58, 7602176
buffer_store_dwordx4 v[56:59], v65, s[4:7], s58 offen sc1
L_nocand:
s_mov_b32 s58, 0x00010001
s_lshl_b32 exec_lo, s58, s57
s_lshl_b32 exec_hi, s58, s57
s_lshl_b32 s58, s47, 11
s_lshl_b32 s59, s96, 8
s_add_u32 s58, s58, s59
s_lshl_b32 s59, s58, 1
s_andn2_b32 s60, s58, 8191
s_add_u32 s58, s58, s60
s_add_u32 s58, s58, 7733248
s_add_u32 s56, s58, 8192
s_add_u32 s59, s59, 524288
v_lshlrev_b32 v54, 3, v3
v_lshlrev_b32 v55, 4, v3
v_cvt_pk_bf16_f32 v172, v68, v69
v_cvt_pk_bf16_f32 v173, v70, v71
buffer_store_dwordx2 v[172:173], v54, s[4:7], s58 offen offset:0 sc1
buffer_store_dwordx2 v[172:173], v54, s[4:7], s56 offen offset:0 sc1
v_cvt_pk_bf16_f32 v174, v72, v73
v_cvt_pk_bf16_f32 v175, v74, v75
buffer_store_dwordx2 v[174:175], v54, s[4:7], s58 offen offset:32 sc1
buffer_store_dwordx2 v[174:175], v54, s[4:7], s56 offen offset:32 sc1
v_cvt_pk_bf16_f32 v176, v76, v77
v_cvt_pk_bf16_f32 v177, v78, v79
buffer_store_dwordx2 v[176:177], v54, s[4:7], s58 offen offset:64 sc1
buffer_store_dwordx2 v[176:177], v54, s[4:7], s56 offen offset:64 sc1
v_cvt_pk_bf16_f32 v178, v80, v81
v_cvt_pk_bf16_f32 v179, v82, v83
buffer_store_dwordx2 v[178:179], v54, s[4:7], s58 offen offset:96 sc1
buffer_store_dwordx2 v[178:179], v54, s[4:7], s56 offen offset:96 sc1
v_cvt_pk_bf16_f32 v172, v84, v85
v_cvt_pk_bf16_f32 v173, v86, v87
buffer_store_dwordx2 v[172:173], v54, s[4:7], s58 offen offset:128 sc1
buffer_store_dwordx2 v[172:173], v54, s[4:7], s56 offen offset:128 sc1
v_cvt_pk_bf16_f32 v174, v88, v89
v_cvt_pk_bf16_f32 v175, v90, v91
buffer_store_dwordx2 v[174:175], v54, s[4:7], s58 offen offset:160 sc1
buffer_store_dwordx2 v[174:175], v54, s[4:7], s56 offen offset:160 sc1
s_and_b32 s60, s40, 0xff
s_bfe_u32 s61, s40, 0x80008
s_bfe_u32 s62, s40, 0x80010
s_lshr_b32 s63, s40, 24
v_mov_b32 v60, s55
v_pk_fma_f32 v[100:101], v[68:69], v[148:149], v[20:21]
v_pk_fma_f32 v[102:103], v[70:71], v[150:151], v[22:23]
v_and_or_b32 v100, v100, v60, s60
v_and_or_b32 v101, v101, v60, s61
v_and_or_b32 v102, v102, v60, s62
v_and_or_b32 v103, v103, v60, s63
buffer_store_dwordx4 v[100:103], v55, s[4:7], s59 offen offset:0 sc1
v_pk_fma_f32 v[104:105], v[72:73], v[152:153], v[24:25]
v_pk_fma_f32 v[106:107], v[74:75], v[154:155], v[26:27]
v_and_or_b32 v104, v104, v60, s60
v_and_or_b32 v105, v105, v60, s61
v_and_or_b32 v106, v106, v60, s62
v_and_or_b32 v107, v107, v60, s63
buffer_store_dwordx4 v[104:107], v55, s[4:7], s59 offen offset:64 sc1
v_pk_fma_f32 v[108:109], v[76:77], v[156:157], v[28:29]
v_pk_fma_f32 v[110:111], v[78:79], v[158:159], v[30:31]
v_and_or_b32 v108, v108, v60, s60
v_and_or_b32 v109, v109, v60, s61
v_and_or_b32 v110, v110, v60, s62
v_and_or_b32 v111, v111, v60, s63
buffer_store_dwordx4 v[108:111], v55, s[4:7], s59 offen offset:128 sc1
v_pk_fma_f32 v[112:113], v[80:81], v[160:161], v[32:33]
v_pk_fma_f32 v[114:115], v[82:83], v[162:163], v[34:35]
v_and_or_b32 v112, v112, v60, s60
v_and_or_b32 v113, v113, v60, s61
v_and_or_b32 v114, v114, v60, s62
v_and_or_b32 v115, v115, v60, s63
buffer_store_dwordx4 v[112:115], v55, s[4:7], s59 offen offset:192 sc1
v_pk_fma_f32 v[116:117], v[84:85], v[164:165], v[36:37]
v_pk_fma_f32 v[118:119], v[86:87], v[166:167], v[38:39]
v_and_or_b32 v116, v116, v60, s60
v_and_or_b32 v117, v117, v60, s61
v_and_or_b32 v118, v118, v60, s62
v_and_or_b32 v119, v119, v60, s63
buffer_store_dwordx4 v[116:119], v55, s[4:7], s59 offen offset:256 sc1
v_pk_fma_f32 v[120:121], v[88:89], v[168:169], v[40:41]
v_pk_fma_f32 v[122:123], v[90:91], v[170:171], v[42:43]
v_and_or_b32 v120, v120, v60, s60
v_and_or_b32 v121, v121, v60, s61
v_and_or_b32 v122, v122, v60, s62
v_and_or_b32 v123, v123, v60, s63
buffer_store_dwordx4 v[120:123], v55, s[4:7], s59 offen offset:320 sc1
s_mov_b64 exec, -1
s_mul_i32 s57, s57, 12
v_subrev_u32 v56, s57, v1
v_add_u32 v56, 0, v56
v_cmp_gt_u32 vcc, 12, v56
s_nop 1
v_cndmask_b32 v235, v235, v255, vcc
v_subrev_u32 v56, s57, v1
v_add_u32 v56, 64, v56
v_cmp_gt_u32 vcc, 12, v56
s_nop 1
v_cndmask_b32 v236, v236, v255, vcc
v_subrev_u32 v56, s57, v1
v_add_u32 v56, 128, v56
v_cmp_gt_u32 vcc, 12, v56
s_nop 1
v_cndmask_b32 v237, v237, v255, vcc
L_nowin:
v_pk_fma_f32 v[20:21], v[68:69], v[148:149], v[20:21]
v_pk_fma_f32 v[22:23], v[70:71], v[150:151], v[22:23]
v_cvt_pk_bf16_f32 v20, v20, v21
v_cvt_pk_bf16_f32 v21, v22, v23
ds_write_b64 v248, v[20:21] offset:0
v_pk_fma_f32 v[24:25], v[72:73], v[152:153], v[24:25]
v_pk_fma_f32 v[26:27], v[74:75], v[154:155], v[26:27]
v_cvt_pk_bf16_f32 v24, v24, v25
v_cvt_pk_bf16_f32 v25, v26, v27
ds_write_b64 v248, v[24:25] offset:32
v_pk_fma_f32 v[28:29], v[76:77], v[156:157], v[28:29]
v_pk_fma_f32 v[30:31], v[78:79], v[158:159], v[30:31]
v_cvt_pk_bf16_f32 v28, v28, v29
v_cvt_pk_bf16_f32 v29, v30, v31
ds_write_b64 v248, v[28:29] offset:64
v_pk_fma_f32 v[32:33], v[80:81], v[160:161], v[32:33]
v_pk_fma_f32 v[34:35], v[82:83], v[162:163], v[34:35]
v_cvt_pk_bf16_f32 v32, v32, v33
v_cvt_pk_bf16_f32 v33, v34, v35
ds_write_b64 v248, v[32:33] offset:96
v_pk_fma_f32 v[36:37], v[84:85], v[164:165], v[36:37]
v_pk_fma_f32 v[38:39], v[86:87], v[166:167], v[38:39]
v_cvt_pk_bf16_f32 v36, v36, v37
v_cvt_pk_bf16_f32 v37, v38, v39
ds_write_b64 v248, v[36:37] offset:128
v_pk_fma_f32 v[40:41], v[88:89], v[168:169], v[40:41]
v_pk_fma_f32 v[42:43], v[90:91], v[170:171], v[42:43]
v_cvt_pk_bf16_f32 v40, v40, v41
v_cvt_pk_bf16_f32 v41, v42, v43
ds_write_b64 v248, v[40:41] offset:160
s_waitcnt lgkmcnt(0)
ds_read_b128 v[44:47], v250 offset:0
ds_read_b128 v[48:51], v250 offset:1024
ds_read_b128 v[52:55], v250 offset:2048
s_waitcnt lgkmcnt(2)
buffer_store_dwordx4 v[44:47], v235, s[32:35], s50 offen offset:0 sc1
s_waitcnt lgkmcnt(1)
buffer_store_dwordx4 v[48:51], v236, s[32:35], s50 offen offset:1024 sc1
s_waitcnt lgkmcnt(0)
buffer_store_dwordx4 v[52:55], v237, s[32:35], s50 offen offset:2048 sc1
s_branch L_fin
L_bodyM:
v_bfe_u32 v32, v1, 2, 2
v_lshrrev_b32 v33, 1, v32
v_and_b32 v34, 1, v3
v_lshl_or_b32 v33, v34, 1, v33
v_xor_b32 v33, s3, v33
v_and_b32 v34, 3, v1
v_lshlrev_b32 v34, 3, v34
v_lshl_add_u32 v33, v33, 5, v34
v_lshl_add_u32 v32, v3, 3, v32
v_lshl_add_u32 v35, v32, 7, v33
s_lshl_b32 s22, s50, 8
s_lshl_b32 s23, s3, 6
s_add_u32 s22, s22, s23
s_add_u32 s22, s22, 4096
s_lshl_b32 s55, s3, 9
s_add_u32 s55, s55, 28672
v_add_u32 v39, s55, v39
v_lshl_add_u32 v37, v3, 4, s55
v_lshlrev_b32 v38, 2, v1
s_cmp_lt_u32 s98, 220
s_cselect_b32 s55, 16, 0
v_cmp_gt_u32 vcc, s55, v1
s_mov_b32 s54, 0xffffff00
s_waitcnt vmcnt(12)
v_cndmask_b32 v38, v255, v38, vcc
v_lshlrev_b32 v44, 16, v40
v_and_b32 v45, 0xffff0000, v40
v_lshlrev_b32 v46, 16, v41
v_and_b32 v47, 0xffff0000, v41
v_mul_f32 v48, 0xbfb8aa3b, v44
v_mul_f32 v49, 0xbfb8aa3b, v45
v_mul_f32 v50, 0xbfb8aa3b, v46
v_mul_f32 v51, 0xbfb8aa3b, v47
v_exp_f32 v48, v48
v_exp_f32 v49, v49
v_exp_f32 v50, v50
v_exp_f32 v51, v51
v_add_f32 v48, 1.0, v48
v_add_f32 v49, 1.0, v49
v_add_f32 v50, 1.0, v50
v_add_f32 v51, 1.0, v51
v_rcp_f32 v48, v48
v_rcp_f32 v49, v49
v_rcp_f32 v50, v50
v_rcp_f32 v51, v51
v_mul_f32 v44, v44, v48
v_mul_f32 v45, v45, v49
v_mul_f32 v46, v46, v50
v_mul_f32 v47, v47, v51
v_cvt_pk_bf16_f32 v40, v44, v45
v_cvt_pk_bf16_f32 v41, v46, v47
ds_write_b64 v39, v[40:41]
s_waitcnt lgkmcnt(0)
ds_read_b128 v[200:203], v37 offset:0
ds_read_b128 v[204:207], v37 offset:64
ds_read_b128 v[208:211], v37 offset:128
ds_read_b128 v[212:215], v37 offset:192
ds_read_b128 v[216:219], v37 offset:256
ds_read_b128 v[220:223], v37 offset:320
ds_read_b128 v[224:227], v37 offset:384
s_waitcnt vmcnt(7)
s_mov_b32 s55, 0x3f803f80
v_mfma_f32_16x16x32_bf16 v[20:23], a[236:239], v[100:103], 0
v_lshlrev_b32 v24, 16, v104
v_and_b32 v25, 0xffff0000, v104
v_mfma_f32_16x16x32_bf16 v[20:23], a[236:239], v[104:107], v[20:23]
v_lshlrev_b32 v26, 16, v105
v_and_b32 v27, 0xffff0000, v105
v_mfma_f32_16x16x32_bf16 v[20:23], a[236:239], v[108:111], v[20:23]
v_lshlrev_b32 v28, 16, v106
v_and_b32 v29, 0xffff0000, v106
v_mfma_f32_16x16x32_bf16 v[20:23], a[236:239], v[112:115], v[20:23]
v_lshlrev_b32 v30, 16, v107
v_and_b32 v31, 0xffff0000, v107
v_mfma_f32_16x16x32_bf16 v[20:23], a[236:239], v[116:119], v[20:23]
v_lshlrev_b32 v88, 16, v100
v_and_b32 v89, 0xffff0000, v100
v_lshlrev_b32 v90, 16, v101
v_and_b32 v91, 0xffff0000, v101
v_dot2_f32_bf16 v96, v100, v100, 0
v_dot2_f32_bf16 v97, v101, v101, 0
v_dot2_f32_bf16 v96, v102, v102, v96
v_dot2_f32_bf16 v97, v103, v103, v97
v_dot2_f32_bf16 v96, v104, v104, v96
v_dot2_f32_bf16 v97, v105, v105, v97
v_dot2_f32_bf16 v96, v106, v106, v96
v_dot2_f32_bf16 v97, v107, v107, v97
v_dot2_f32_bf16 v96, v108, v108, v96
v_dot2_f32_bf16 v97, v109, v109, v97
v_dot2_f32_bf16 v96, v110, v110, v96
v_dot2_f32_bf16 v97, v111, v111, v97
v_dot2_f32_bf16 v96, v112, v112, v96
v_dot2_f32_bf16 v97, v113, v113, v97
v_dot2_f32_bf16 v96, v114, v114, v96
v_dot2_f32_bf16 v97, v115, v115, v97
v_dot2_f32_bf16 v96, v116, v116, v96
v_dot2_f32_bf16 v97, v117, v117, v97
v_dot2_f32_bf16 v96, v118, v118, v96
v_dot2_f32_bf16 v97, v119, v119, v97
v_add_f32_dpp v20, v20, v20 row_ror:8 row_mask:0xf bank_mask:0xf
v_lshlrev_b32 v100, 16, v102
v_and_b32 v101, 0xffff0000, v102
v_add_f32 v96, v96, v97
v_add_f32_dpp v20, v20, v20 row_ror:4 row_mask:0xf bank_mask:0xf
v_lshlrev_b32 v102, 16, v103
v_add_f32_dpp v96, v96, v96 row_ror:8 row_mask:0xf bank_mask:0xf
v_add_f32_dpp v20, v20, v20 row_ror:2 row_mask:0xf bank_mask:0xf
v_and_b32 v103, 0xffff0000, v103
v_add_f32_dpp v96, v96, v96 row_ror:4 row_mask:0xf bank_mask:0xf
v_add_f32_dpp v20, v20, v20 row_ror:1 row_mask:0xf bank_mask:0xf
v_mul_f32 v20, 0x3acccccd, v20
v_add_f32_dpp v96, v96, v96 row_ror:2 row_mask:0xf bank_mask:0xf
s_nop 1
v_add_f32_dpp v96, v96, v96 row_ror:1 row_mask:0xf bank_mask:0xf
v_mul_f32 v96, 0x3acccccd, v96
v_fma_f32 v96, -v20, v20, v96
v_max_f32 v96, 0, v96
v_add_f32 v96, 0x3727c5ac, v96
v_rsq_f32 v96, v96
s_nop 0
v_mul_f32 v97, -v20, v96
buffer_load_dwordx4 v[120:123], v4, s[8:11], s61 offen offset:0
v_pk_fma_f32 v[24:25], v[24:25], v[96:97], v[96:97] op_sel:[0,0,1] op_sel_hi:[1,0,1]
v_pk_fma_f32 v[26:27], v[26:27], v[96:97], v[96:97] op_sel:[0,0,1] op_sel_hi:[1,0,1]
v_pk_fma_f32 v[28:29], v[28:29], v[96:97], v[96:97] op_sel:[0,0,1] op_sel_hi:[1,0,1]
v_pk_fma_f32 v[30:31], v[30:31], v[96:97], v[96:97] op_sel:[0,0,1] op_sel_hi:[1,0,1]
v_cvt_pk_f16_f32 v104, v24, v25
v_cvt_pk_f16_f32 v105, v26, v27
v_cvt_pk_f16_f32 v106, v28, v29
v_cvt_pk_f16_f32 v107, v30, v31
v_lshlrev_b32 v24, 16, v108
v_and_b32 v25, 0xffff0000, v108
v_lshlrev_b32 v26, 16, v109
v_and_b32 v27, 0xffff0000, v109
buffer_load_dwordx4 v[124:127], v4, s[8:11], s61 offen offset:256
v_lshlrev_b32 v28, 16, v110
v_and_b32 v29, 0xffff0000, v110
v_lshlrev_b32 v30, 16, v111
v_and_b32 v31, 0xffff0000, v111
v_pk_fma_f32 v[24:25], v[24:25], v[96:97], v[96:97] op_sel:[0,0,1] op_sel_hi:[1,0,1]
v_pk_fma_f32 v[26:27], v[26:27], v[96:97], v[96:97] op_sel:[0,0,1] op_sel_hi:[1,0,1]
v_pk_fma_f32 v[28:29], v[28:29], v[96:97], v[96:97] op_sel:[0,0,1] op_sel_hi:[1,0,1]
v_pk_fma_f32 v[30:31], v[30:31], v[96:97], v[96:97] op_sel:[0,0,1] op_sel_hi:[1,0,1]
v_cvt_pk_f16_f32 v108, v24, v25
v_cvt_pk_f16_f32 v109, v26, v27
v_cvt_pk_f16_f32 v110, v28, v29
v_cvt_pk_f16_f32 v111, v30, v31
buffer_load_dwordx4 v[128:131], v4, s[8:11], s61 offen offset:512
v_lshlrev_b32 v24, 16, v112
v_and_b32 v25, 0xffff0000, v112
v_lshlrev_b32 v26, 16, v113
v_and_b32 v27, 0xffff0000, v113
v_lshlrev_b32 v28, 16, v114
v_and_b32 v29, 0xffff0000, v114
v_lshlrev_b32 v30, 16, v115
v_and_b32 v31, 0xffff0000, v115
v_pk_fma_f32 v[24:25], v[24:25], v[96:97], v[96:97] op_sel:[0,0,1] op_sel_hi:[1,0,1]
v_pk_fma_f32 v[26:27], v[26:27], v[96:97], v[96:97] op_sel:[0,0,1] op_sel_hi:[1,0,1]
v_pk_fma_f32 v[28:29], v[28:29], v[96:97], v[96:97] op_sel:[0,0,1] op_sel_hi:[1,0,1]
v_pk_fma_f32 v[30:31], v[30:31], v[96:97], v[96:97] op_sel:[0,0,1] op_sel_hi:[1,0,1]
buffer_load_dwordx4 v[132:135], v4, s[8:11], s61 offen offset:768
v_cvt_pk_f16_f32 v112, v24, v25
v_cvt_pk_f16_f32 v113, v26, v27
v_cvt_pk_f16_f32 v114, v28, v29
v_cvt_pk_f16_f32 v115, v30, v31
v_lshlrev_b32 v24, 16, v116
v_and_b32 v25, 0xffff0000, v116
v_lshlrev_b32 v26, 16, v117
v_and_b32 v27, 0xffff0000, v117
v_lshlrev_b32 v28, 16, v118
v_and_b32 v29, 0xffff0000, v118
v_lshlrev_b32 v30, 16, v119
v_and_b32 v31, 0xffff0000, v119
buffer_load_dwordx4 v[136:139], v4, s[8:11], s61 offen offset:1024
s_bfe_u32 s61, s62, 262152
s_mul_i32 s61, s61, 40960
s_add_u32 s61, s61, s45
v_pk_fma_f32 v[24:25], v[24:25], v[96:97], v[96:97] op_sel:[0,0,1] op_sel_hi:[1,0,1]
v_pk_fma_f32 v[26:27], v[26:27], v[96:97], v[96:97] op_sel:[0,0,1] op_sel_hi:[1,0,1]
v_pk_fma_f32 v[28:29], v[28:29], v[96:97], v[96:97] op_sel:[0,0,1] op_sel_hi:[1,0,1]
v_pk_fma_f32 v[30:31], v[30:31], v[96:97], v[96:97] op_sel:[0,0,1] op_sel_hi:[1,0,1]
v_pk_fma_f32 v[88:89], v[88:89], v[96:97], v[96:97] op_sel:[0,0,1] op_sel_hi:[1,0,1]
v_pk_fma_f32 v[90:91], v[90:91], v[96:97], v[96:97] op_sel:[0,0,1] op_sel_hi:[1,0,1]
v_pk_fma_f32 v[100:101], v[100:101], v[96:97], v[96:97] op_sel:[0,0,1] op_sel_hi:[1,0,1]
v_pk_fma_f32 v[102:103], v[102:103], v[96:97], v[96:97] op_sel:[0,0,1] op_sel_hi:[1,0,1]
v_cvt_pk_f16_f32 v116, v24, v25
v_cvt_pk_f16_f32 v117, v26, v27
v_cvt_pk_f16_f32 v118, v28, v29
v_cvt_pk_f16_f32 v119, v30, v31
s_waitcnt vmcnt(5)
v_readfirstlane_b32 s41, v42
s_barrier
ds_read_b64_tr_b16 v[60:61], v35 offset:0
ds_read_b64_tr_b16 v[62:63], v35 offset:512
ds_read_b64_tr_b16 v[64:65], v35 offset:4096
ds_read_b64_tr_b16 v[66:67], v35 offset:4608
ds_read_b64_tr_b16 v[68:69], v35 offset:8192
ds_read_b64_tr_b16 v[70:71], v35 offset:8704
ds_read_b64_tr_b16 v[72:73], v35 offset:12288
ds_read_b64_tr_b16 v[74:75], v35 offset:12800
ds_read_b64_tr_b16 v[76:77], v35 offset:16384
ds_read_b64_tr_b16 v[78:79], v35 offset:16896
ds_read_b64_tr_b16 v[80:81], v35 offset:20480
ds_read_b64_tr_b16 v[82:83], v35 offset:20992
ds_read_b64_tr_b16 v[84:85], v35 offset:24576
ds_read_b64_tr_b16 v[86:87], v35 offset:25088
s_mul_i32 s40, s41, 0x9E3779B1
s_add_u32 s40, s40, 0x85EBCA6B
v_and_b32 v33, 3, v1
v_lshlrev_b32 v33, 3, v33
v_lshrrev_b32 v19, v33, s40
v_and_b32 v19, 0xff, v19
v_mov_b32 v240, s40
v_mov_b32 v241, s19
v_mov_b32 v242, s40
v_mov_b32 v243, s40
s_waitcnt lgkmcnt(12)
v_mfma_f32_16x16x32_bf16 v[56:59], v[200:203], v[60:63], 0
s_waitcnt lgkmcnt(10)
v_mfma_f32_16x16x32_bf16 v[56:59], v[204:207], v[64:67], v[56:59]
s_waitcnt lgkmcnt(8)
v_mfma_f32_16x16x32_bf16 v[56:59], v[208:211], v[68:71], v[56:59]
s_waitcnt lgkmcnt(6)
v_mfma_f32_16x16x32_bf16 v[56:59], v[212:215], v[72:75], v[56:59]
s_waitcnt lgkmcnt(4)
v_mfma_f32_16x16x32_bf16 v[56:59], v[216:219], v[76:79], v[56:59]
s_waitcnt lgkmcnt(2)
v_mfma_f32_16x16x32_bf16 v[56:59], v[220:223], v[80:83], v[56:59]
s_waitcnt lgkmcnt(0)
v_mfma_f32_16x16x32_bf16 v[56:59], v[224:227], v[84:87], v[56:59]
s_nop 7
v_and_or_b32 v56, v56, s54, v19
buffer_store_dword v56, v38, s[4:7], s22 offen sc1
buffer_load_dwordx4 v[140:143], v4, s[8:11], s61 offen offset:0
buffer_load_dwordx4 v[144:147], v4, s[8:11], s61 offen offset:256
buffer_load_dwordx4 v[148:151], v4, s[8:11], s61 offen offset:512
buffer_load_dwordx4 v[152:155], v4, s[8:11], s61 offen offset:768
buffer_load_dwordx4 v[156:159], v4, s[8:11], s61 offen offset:1024
s_bfe_u32 s61, s62, 262156
s_mul_i32 s61, s61, 40960
s_add_u32 s61, s61, s45
s_waitcnt vmcnt(6)
s_mov_b32 s55, 0x3f803f80
buffer_load_dwordx4 v[160:163], v4, s[8:11], s61 offen offset:0
v_mfma_f32_16x16x32_bf16 v[20:23], a[236:239], v[120:123], 0
v_lshlrev_b32 v24, 16, v124
v_and_b32 v25, 0xffff0000, v124
v_mfma_f32_16x16x32_bf16 v[20:23], a[236:239], v[124:127], v[20:23]
v_lshlrev_b32 v26, 16, v125
v_and_b32 v27, 0xffff0000, v125
v_mfma_f32_16x16x32_bf16 v[20:23], a[236:239], v[128:131], v[20:23]
v_lshlrev_b32 v28, 16, v126
v_and_b32 v29, 0xffff0000, v126
v_mfma_f32_16x16x32_bf16 v[20:23], a[236:239], v[132:135], v[20:23]
v_lshlrev_b32 v30, 16, v127
v_and_b32 v31, 0xffff0000, v127
v_mfma_f32_16x16x32_bf16 v[20:23], a[236:239], v[136:139], v[20:23]
v_lshlrev_b32 v92, 16, v120
v_and_b32 v93, 0xffff0000, v120
v_lshlrev_b32 v94, 16, v121
v_and_b32 v95, 0xffff0000, v121
v_dot2_f32_bf16 v98, v120, v120, 0
v_dot2_f32_bf16 v99, v121, v121, 0
v_dot2_f32_bf16 v98, v122, v122, v98
v_dot2_f32_bf16 v99, v123, v123, v99
v_dot2_f32_bf16 v98, v124, v124, v98
v_dot2_f32_bf16 v99, v125, v125, v99
buffer_load_dwordx4 v[164:167], v4, s[8:11], s61 offen offset:256
v_dot2_f32_bf16 v98, v126, v126, v98
v_dot2_f32_bf16 v99, v127, v127, v99
v_dot2_f32_bf16 v98, v128, v128, v98
v_dot2_f32_bf16 v99, v129, v129, v99
v_dot2_f32_bf16 v98, v130, v130, v98
v_dot2_f32_bf16 v99, v131, v131, v99
v_dot2_f32_bf16 v98, v132, v132, v98
v_dot2_f32_bf16 v99, v133, v133, v99
v_dot2_f32_bf16 v98, v134, v134, v98
v_dot2_f32_bf16 v99, v135, v135, v99
v_dot2_f32_bf16 v98, v136, v136, v98
v_dot2_f32_bf16 v99, v137, v137, v99
v_dot2_f32_bf16 v98, v138, v138, v98
v_dot2_f32_bf16 v99, v139, v139, v99
v_add_f32_dpp v20, v20, v20 row_ror:8 row_mask:0xf bank_mask:0xf
v_lshlrev_b32 v120, 16, v122
v_and_b32 v121, 0xffff0000, v122
v_add_f32 v98, v98, v99
v_add_f32_dpp v20, v20, v20 row_ror:4 row_mask:0xf bank_mask:0xf
v_lshlrev_b32 v122, 16, v123
v_add_f32_dpp v98, v98, v98 row_ror:8 row_mask:0xf bank_mask:0xf
v_add_f32_dpp v20, v20, v20 row_ror:2 row_mask:0xf bank_mask:0xf
v_and_b32 v123, 0xffff0000, v123
v_add_f32_dpp v98, v98, v98 row_ror:4 row_mask:0xf bank_mask:0xf
buffer_load_dwordx4 v[168:171], v4, s[8:11], s61 offen offset:512
v_add_f32_dpp v20, v20, v20 row_ror:1 row_mask:0xf bank_mask:0xf
v_mul_f32 v20, 0x3acccccd, v20
v_add_f32_dpp v98, v98, v98 row_ror:2 row_mask:0xf bank_mask:0xf
s_nop 1
v_add_f32_dpp v98, v98, v98 row_ror:1 row_mask:0xf bank_mask:0xf
v_mul_f32 v98, 0x3acccccd, v98
v_fma_f32 v98, -v20, v20, v98
v_max_f32 v98, 0, v98
v_add_f32 v98, 0x3727c5ac, v98
v_rsq_f32 v98, v98
s_nop 0
v_mul_f32 v99, -v20, v98
v_pk_fma_f32 v[24:25], v[24:25], v[98:99], v[98:99] op_sel:[0,0,1] op_sel_hi:[1,0,1]
v_pk_fma_f32 v[26:27], v[26:27], v[98:99], v[98:99] op_sel:[0,0,1] op_sel_hi:[1,0,1]
v_pk_fma_f32 v[28:29], v[28:29], v[98:99], v[98:99] op_sel:[0,0,1] op_sel_hi:[1,0,1]
v_pk_fma_f32 v[30:31], v[30:31], v[98:99], v[98:99] op_sel:[0,0,1] op_sel_hi:[1,0,1]
v_cvt_pk_f16_f32 v124, v24, v25
v_cvt_pk_f16_f32 v125, v26, v27
v_cvt_pk_f16_f32 v126, v28, v29
v_cvt_pk_f16_f32 v127, v30, v31
v_lshlrev_b32 v24, 16, v128
v_and_b32 v25, 0xffff0000, v128
v_lshlrev_b32 v26, 16, v129
v_and_b32 v27, 0xffff0000, v129
v_lshlrev_b32 v28, 16, v130
buffer_load_dwordx4 v[172:175], v4, s[8:11], s61 offen offset:768
v_and_b32 v29, 0xffff0000, v130
v_lshlrev_b32 v30, 16, v131
v_and_b32 v31, 0xffff0000, v131
v_pk_fma_f32 v[24:25], v[24:25], v[98:99], v[98:99] op_sel:[0,0,1] op_sel_hi:[1,0,1]
v_pk_fma_f32 v[26:27], v[26:27], v[98:99], v[98:99] op_sel:[0,0,1] op_sel_hi:[1,0,1]
v_pk_fma_f32 v[28:29], v[28:29], v[98:99], v[98:99] op_sel:[0,0,1] op_sel_hi:[1,0,1]
v_pk_fma_f32 v[30:31], v[30:31], v[98:99], v[98:99] op_sel:[0,0,1] op_sel_hi:[1,0,1]
v_cvt_pk_f16_f32 v128, v24, v25
v_cvt_pk_f16_f32 v129, v26, v27
v_cvt_pk_f16_f32 v130, v28, v29
v_cvt_pk_f16_f32 v131, v30, v31
v_lshlrev_b32 v24, 16, v132
v_and_b32 v25, 0xffff0000, v132
v_lshlrev_b32 v26, 16, v133
v_and_b32 v27, 0xffff0000, v133
v_lshlrev_b32 v28, 16, v134
v_and_b32 v29, 0xffff0000, v134
v_lshlrev_b32 v30, 16, v135
v_and_b32 v31, 0xffff0000, v135
v_pk_fma_f32 v[24:25], v[24:25], v[98:99], v[98:99] op_sel:[0,0,1] op_sel_hi:[1,0,1]
v_pk_fma_f32 v[26:27], v[26:27], v[98:99], v[98:99] op_sel:[0,0,1] op_sel_hi:[1,0,1]
v_pk_fma_f32 v[28:29], v[28:29], v[98:99], v[98:99] op_sel:[0,0,1] op_sel_hi:[1,0,1]
v_pk_fma_f32 v[30:31], v[30:31], v[98:99], v[98:99] op_sel:[0,0,1] op_sel_hi:[1,0,1]
buffer_load_dwordx4 v[176:179], v4, s[8:11], s61 offen offset:1024
s_bfe_u32 s61, s62, 262160
s_mul_i32 s61, s61, 40960
s_add_u32 s61, s61, s45
v_cvt_pk_f16_f32 v132, v24, v25
v_cvt_pk_f16_f32 v133, v26, v27
v_cvt_pk_f16_f32 v134, v28, v29
v_cvt_pk_f16_f32 v135, v30, v31
v_lshlrev_b32 v24, 16, v136
v_and_b32 v25, 0xffff0000, v136
v_lshlrev_b32 v26, 16, v137
v_and_b32 v27, 0xffff0000, v137
v_lshlrev_b32 v28, 16, v138
v_and_b32 v29, 0xffff0000, v138
v_lshlrev_b32 v30, 16, v139
v_and_b32 v31, 0xffff0000, v139
v_pk_fma_f32 v[24:25], v[24:25], v[98:99], v[98:99] op_sel:[0,0,1] op_sel_hi:[1,0,1]
v_pk_fma_f32 v[26:27], v[26:27], v[98:99], v[98:99] op_sel:[0,0,1] op_sel_hi:[1,0,1]
v_pk_fma_f32 v[28:29], v[28:29], v[98:99], v[98:99] op_sel:[0,0,1] op_sel_hi:[1,0,1]
v_pk_fma_f32 v[30:31], v[30:31], v[98:99], v[98:99] op_sel:[0,0,1] op_sel_hi:[1,0,1]
v_pk_fma_f32 v[92:93], v[92:93], v[98:99], v[98:99] op_sel:[0,0,1] op_sel_hi:[1,0,1]
v_pk_fma_f32 v[94:95], v[94:95], v[98:99], v[98:99] op_sel:[0,0,1] op_sel_hi:[1,0,1]
v_pk_fma_f32 v[120:121], v[120:121], v[98:99], v[98:99] op_sel:[0,0,1] op_sel_hi:[1,0,1]
v_pk_fma_f32 v[122:123], v[122:123], v[98:99], v[98:99] op_sel:[0,0,1] op_sel_hi:[1,0,1]
v_cvt_pk_f16_f32 v136, v24, v25
v_cvt_pk_f16_f32 v137, v26, v27
v_cvt_pk_f16_f32 v138, v28, v29
v_cvt_pk_f16_f32 v139, v30, v31
s_barrier
s_waitcnt vmcnt(5)
s_mov_b32 s55, 0x3f803f80
buffer_load_dwordx4 v[180:183], v4, s[8:11], s61 offen offset:0
v_mfma_f32_16x16x32_bf16 v[20:23], a[236:239], v[140:143], 0
v_lshlrev_b32 v24, 16, v144
v_and_b32 v25, 0xffff0000, v144
v_mfma_f32_16x16x32_bf16 v[20:23], a[236:239], v[144:147], v[20:23]
v_lshlrev_b32 v26, 16, v145
v_and_b32 v27, 0xffff0000, v145
v_mfma_f32_16x16x32_bf16 v[20:23], a[236:239], v[148:151], v[20:23]
v_lshlrev_b32 v28, 16, v146
v_and_b32 v29, 0xffff0000, v146
v_mfma_f32_16x16x32_bf16 v[20:23], a[236:239], v[152:155], v[20:23]
buffer_load_dwordx4 v[184:187], v4, s[8:11], s61 offen offset:256
v_lshlrev_b32 v30, 16, v147
v_and_b32 v31, 0xffff0000, v147
v_mfma_f32_16x16x32_bf16 v[20:23], a[236:239], v[156:159], v[20:23]
v_lshlrev_b32 v72, 16, v140
v_and_b32 v73, 0xffff0000, v140
v_lshlrev_b32 v74, 16, v141
v_and_b32 v75, 0xffff0000, v141
v_dot2_f32_bf16 v84, v140, v140, 0
v_dot2_f32_bf16 v85, v141, v141, 0
buffer_load_dwordx4 v[188:191], v4, s[8:11], s61 offen offset:512
v_dot2_f32_bf16 v84, v142, v142, v84
v_dot2_f32_bf16 v85, v143, v143, v85
v_dot2_f32_bf16 v84, v144, v144, v84
v_dot2_f32_bf16 v85, v145, v145, v85
v_dot2_f32_bf16 v84, v146, v146, v84
v_dot2_f32_bf16 v85, v147, v147, v85
v_dot2_f32_bf16 v84, v148, v148, v84
v_dot2_f32_bf16 v85, v149, v149, v85
v_dot2_f32_bf16 v84, v150, v150, v84
v_dot2_f32_bf16 v85, v151, v151, v85
buffer_load_dwordx4 v[192:195], v4, s[8:11], s61 offen offset:768
v_dot2_f32_bf16 v84, v152, v152, v84
v_dot2_f32_bf16 v85, v153, v153, v85
v_dot2_f32_bf16 v84, v154, v154, v84
v_dot2_f32_bf16 v85, v155, v155, v85
v_dot2_f32_bf16 v84, v156, v156, v84
v_dot2_f32_bf16 v85, v157, v157, v85
v_dot2_f32_bf16 v84, v158, v158, v84
v_dot2_f32_bf16 v85, v159, v159, v85
v_add_f32_dpp v20, v20, v20 row_ror:8 row_mask:0xf bank_mask:0xf
v_lshlrev_b32 v140, 16, v142
buffer_load_dwordx4 v[196:199], v4, s[8:11], s61 offen offset:1024
v_and_b32 v141, 0xffff0000, v142
v_add_f32 v84, v84, v85
v_add_f32_dpp v20, v20, v20 row_ror:4 row_mask:0xf bank_mask:0xf
v_lshlrev_b32 v142, 16, v143
v_add_f32_dpp v84, v84, v84 row_ror:8 row_mask:0xf bank_mask:0xf
v_add_f32_dpp v20, v20, v20 row_ror:2 row_mask:0xf bank_mask:0xf
v_and_b32 v143, 0xffff0000, v143
v_add_f32_dpp v84, v84, v84 row_ror:4 row_mask:0xf bank_mask:0xf
v_add_f32_dpp v20, v20, v20 row_ror:1 row_mask:0xf bank_mask:0xf
buffer_store_dwordx4 a[232:235], v11, s[4:7], s46 offen sc1
v_mul_f32 v20, 0x3acccccd, v20
v_add_f32_dpp v84, v84, v84 row_ror:2 row_mask:0xf bank_mask:0xf
s_nop 1
v_add_f32_dpp v84, v84, v84 row_ror:1 row_mask:0xf bank_mask:0xf
v_mul_f32 v84, 0x3acccccd, v84
v_fma_f32 v84, -v20, v20, v84
v_max_f32 v84, 0, v84
v_add_f32 v84, 0x3727c5ac, v84
v_rsq_f32 v84, v84
s_nop 0
v_mul_f32 v85, -v20, v84
v_pk_fma_f32 v[24:25], v[24:25], v[84:85], v[84:85] op_sel:[0,0,1] op_sel_hi:[1,0,1]
buffer_store_dwordx4 a[232:235], v12, s[4:7], s46 offen sc1
v_pk_fma_f32 v[26:27], v[26:27], v[84:85], v[84:85] op_sel:[0,0,1] op_sel_hi:[1,0,1]
v_pk_fma_f32 v[28:29], v[28:29], v[84:85], v[84:85] op_sel:[0,0,1] op_sel_hi:[1,0,1]
v_pk_fma_f32 v[30:31], v[30:31], v[84:85], v[84:85] op_sel:[0,0,1] op_sel_hi:[1,0,1]
v_cvt_pk_f16_f32 v144, v24, v25
v_cvt_pk_f16_f32 v145, v26, v27
v_cvt_pk_f16_f32 v146, v28, v29
v_cvt_pk_f16_f32 v147, v30, v31
v_lshlrev_b32 v24, 16, v148
v_and_b32 v25, 0xffff0000, v148
v_lshlrev_b32 v26, 16, v149
buffer_store_dwordx4 a[232:235], v13, s[4:7], s46 offen sc1
v_and_b32 v27, 0xffff0000, v149
v_lshlrev_b32 v28, 16, v150
v_and_b32 v29, 0xffff0000, v150
v_lshlrev_b32 v30, 16, v151
v_and_b32 v31, 0xffff0000, v151
v_pk_fma_f32 v[24:25], v[24:25], v[84:85], v[84:85] op_sel:[0,0,1] op_sel_hi:[1,0,1]
v_pk_fma_f32 v[26:27], v[26:27], v[84:85], v[84:85] op_sel:[0,0,1] op_sel_hi:[1,0,1]
v_pk_fma_f32 v[28:29], v[28:29], v[84:85], v[84:85] op_sel:[0,0,1] op_sel_hi:[1,0,1]
v_pk_fma_f32 v[30:31], v[30:31], v[84:85], v[84:85] op_sel:[0,0,1] op_sel_hi:[1,0,1]
v_cvt_pk_f16_f32 v148, v24, v25
buffer_store_dwordx4 a[232:235], v14, s[4:7], s46 offen sc1
v_cvt_pk_f16_f32 v149, v26, v27
v_cvt_pk_f16_f32 v150, v28, v29
v_cvt_pk_f16_f32 v151, v30, v31
v_lshlrev_b32 v24, 16, v152
v_and_b32 v25, 0xffff0000, v152
v_lshlrev_b32 v26, 16, v153
v_and_b32 v27, 0xffff0000, v153
v_lshlrev_b32 v28, 16, v154
v_and_b32 v29, 0xffff0000, v154
buffer_store_dwordx4 a[232:235], v246, s[4:7], s18 offen sc1
v_lshlrev_b32 v30, 16, v155
v_and_b32 v31, 0xffff0000, v155
v_pk_fma_f32 v[24:25], v[24:25], v[84:85], v[84:85] op_sel:[0,0,1] op_sel_hi:[1,0,1]
v_pk_fma_f32 v[26:27], v[26:27], v[84:85], v[84:85] op_sel:[0,0,1] op_sel_hi:[1,0,1]
v_pk_fma_f32 v[28:29], v[28:29], v[84:85], v[84:85] op_sel:[0,0,1] op_sel_hi:[1,0,1]
v_pk_fma_f32 v[30:31], v[30:31], v[84:85], v[84:85] op_sel:[0,0,1] op_sel_hi:[1,0,1]
v_cvt_pk_f16_f32 v152, v24, v25
v_cvt_pk_f16_f32 v153, v26, v27
v_cvt_pk_f16_f32 v154, v28, v29
v_cvt_pk_f16_f32 v155, v30, v31
s_add_u32 s37, s18, 8192
buffer_store_dwordx4 a[232:235], v246, s[4:7], s37 offen sc1
v_lshlrev_b32 v24, 16, v156
v_and_b32 v25, 0xffff0000, v156
v_lshlrev_b32 v26, 16, v157
v_and_b32 v27, 0xffff0000, v157
v_lshlrev_b32 v28, 16, v158
v_and_b32 v29, 0xffff0000, v158
v_lshlrev_b32 v30, 16, v159
v_and_b32 v31, 0xffff0000, v159
v_pk_fma_f32 v[24:25], v[24:25], v[84:85], v[84:85] op_sel:[0,0,1] op_sel_hi:[1,0,1]
v_pk_fma_f32 v[26:27], v[26:27], v[84:85], v[84:85] op_sel:[0,0,1] op_sel_hi:[1,0,1]
s_lshl_b32 s37, s47, 2
s_add_u32 s37, s37, s3
s_lshl_b32 s37, s37, 3
s_add_u32 s37, s37, s96
s_lshl_b32 s37, s37, 8
s_add_u32 s37, s37, 131072
v_lshlrev_b32 v69, 2, v1
v_xor_b32 v70, 0xff, v19
buffer_store_dword v70, v69, s[4:7], s37 offen sc1
v_pk_fma_f32 v[28:29], v[28:29], v[84:85], v[84:85] op_sel:[0,0,1] op_sel_hi:[1,0,1]
v_pk_fma_f32 v[30:31], v[30:31], v[84:85], v[84:85] op_sel:[0,0,1] op_sel_hi:[1,0,1]
v_pk_fma_f32 v[72:73], v[72:73], v[84:85], v[84:85] op_sel:[0,0,1] op_sel_hi:[1,0,1]
v_pk_fma_f32 v[74:75], v[74:75], v[84:85], v[84:85] op_sel:[0,0,1] op_sel_hi:[1,0,1]
v_pk_fma_f32 v[140:141], v[140:141], v[84:85], v[84:85] op_sel:[0,0,1] op_sel_hi:[1,0,1]
v_pk_fma_f32 v[142:143], v[142:143], v[84:85], v[84:85] op_sel:[0,0,1] op_sel_hi:[1,0,1]
v_cvt_pk_f16_f32 v156, v24, v25
v_cvt_pk_f16_f32 v157, v26, v27
v_cvt_pk_f16_f32 v158, v28, v29
v_cvt_pk_f16_f32 v159, v30, v31
s_waitcnt vmcnt(12)
s_mov_b32 s55, 0x3f803f80
v_mfma_f32_16x16x32_bf16 v[20:23], a[236:239], v[160:163], 0
v_lshlrev_b32 v24, 16, v164
v_and_b32 v25, 0xffff0000, v164
v_mfma_f32_16x16x32_bf16 v[20:23], a[236:239], v[164:167], v[20:23]
v_lshlrev_b32 v26, 16, v165
v_and_b32 v27, 0xffff0000, v165
v_mfma_f32_16x16x32_bf16 v[20:23], a[236:239], v[168:171], v[20:23]
v_lshlrev_b32 v28, 16, v166
v_and_b32 v29, 0xffff0000, v166
v_mfma_f32_16x16x32_bf16 v[20:23], a[236:239], v[172:175], v[20:23]
v_lshlrev_b32 v30, 16, v167
v_and_b32 v31, 0xffff0000, v167
v_mfma_f32_16x16x32_bf16 v[20:23], a[236:239], v[176:179], v[20:23]
v_lshlrev_b32 v76, 16, v160
v_and_b32 v77, 0xffff0000, v160
v_lshlrev_b32 v78, 16, v161
v_and_b32 v79, 0xffff0000, v161
v_dot2_f32_bf16 v86, v160, v160, 0
v_dot2_f32_bf16 v87, v161, v161, 0
v_dot2_f32_bf16 v86, v162, v162, v86
v_dot2_f32_bf16 v87, v163, v163, v87
v_dot2_f32_bf16 v86, v164, v164, v86
v_dot2_f32_bf16 v87, v165, v165, v87
v_dot2_f32_bf16 v86, v166, v166, v86
v_dot2_f32_bf16 v87, v167, v167, v87
v_dot2_f32_bf16 v86, v168, v168, v86
v_dot2_f32_bf16 v87, v169, v169, v87
v_dot2_f32_bf16 v86, v170, v170, v86
v_dot2_f32_bf16 v87, v171, v171, v87
v_dot2_f32_bf16 v86, v172, v172, v86
v_dot2_f32_bf16 v87, v173, v173, v87
v_dot2_f32_bf16 v86, v174, v174, v86
v_dot2_f32_bf16 v87, v175, v175, v87
v_dot2_f32_bf16 v86, v176, v176, v86
v_dot2_f32_bf16 v87, v177, v177, v87
v_dot2_f32_bf16 v86, v178, v178, v86
v_dot2_f32_bf16 v87, v179, v179, v87
v_add_f32_dpp v20, v20, v20 row_ror:8 row_mask:0xf bank_mask:0xf
v_lshlrev_b32 v160, 16, v162
v_and_b32 v161, 0xffff0000, v162
v_add_f32 v86, v86, v87
v_add_f32_dpp v20, v20, v20 row_ror:4 row_mask:0xf bank_mask:0xf
v_lshlrev_b32 v162, 16, v163
v_add_f32_dpp v86, v86, v86 row_ror:8 row_mask:0xf bank_mask:0xf
v_add_f32_dpp v20, v20, v20 row_ror:2 row_mask:0xf bank_mask:0xf
v_and_b32 v163, 0xffff0000, v163
v_add_f32_dpp v86, v86, v86 row_ror:4 row_mask:0xf bank_mask:0xf
v_add_f32_dpp v20, v20, v20 row_ror:1 row_mask:0xf bank_mask:0xf
v_mul_f32 v20, 0x3acccccd, v20
v_add_f32_dpp v86, v86, v86 row_ror:2 row_mask:0xf bank_mask:0xf
s_nop 1
v_add_f32_dpp v86, v86, v86 row_ror:1 row_mask:0xf bank_mask:0xf
v_mul_f32 v86, 0x3acccccd, v86
v_fma_f32 v86, -v20, v20, v86
v_max_f32 v86, 0, v86
v_add_f32 v86, 0x3727c5ac, v86
v_rsq_f32 v86, v86
s_nop 0
v_mul_f32 v87, -v20, v86
v_pk_fma_f32 v[24:25], v[24:25], v[86:87], v[86:87] op_sel:[0,0,1] op_sel_hi:[1,0,1]
v_pk_fma_f32 v[26:27], v[26:27], v[86:87], v[86:87] op_sel:[0,0,1] op_sel_hi:[1,0,1]
v_pk_fma_f32 v[28:29], v[28:29], v[86:87], v[86:87] op_sel:[0,0,1] op_sel_hi:[1,0,1]
v_pk_fma_f32 v[30:31], v[30:31], v[86:87], v[86:87] op_sel:[0,0,1] op_sel_hi:[1,0,1]
v_cvt_pk_f16_f32 v164, v24, v25
v_cvt_pk_f16_f32 v165, v26, v27
v_cvt_pk_f16_f32 v166, v28, v29
v_cvt_pk_f16_f32 v167, v30, v31
v_lshlrev_b32 v24, 16, v168
v_and_b32 v25, 0xffff0000, v168
v_lshlrev_b32 v26, 16, v169
v_and_b32 v27, 0xffff0000, v169
v_lshlrev_b32 v28, 16, v170
v_and_b32 v29, 0xffff0000, v170
v_lshlrev_b32 v30, 16, v171
v_and_b32 v31, 0xffff0000, v171
v_pk_fma_f32 v[24:25], v[24:25], v[86:87], v[86:87] op_sel:[0,0,1] op_sel_hi:[1,0,1]
v_pk_fma_f32 v[26:27], v[26:27], v[86:87], v[86:87] op_sel:[0,0,1] op_sel_hi:[1,0,1]
v_pk_fma_f32 v[28:29], v[28:29], v[86:87], v[86:87] op_sel:[0,0,1] op_sel_hi:[1,0,1]
v_pk_fma_f32 v[30:31], v[30:31], v[86:87], v[86:87] op_sel:[0,0,1] op_sel_hi:[1,0,1]
v_cvt_pk_f16_f32 v168, v24, v25
v_cvt_pk_f16_f32 v169, v26, v27
v_cvt_pk_f16_f32 v170, v28, v29
v_cvt_pk_f16_f32 v171, v30, v31
v_lshlrev_b32 v24, 16, v172
v_and_b32 v25, 0xffff0000, v172
v_lshlrev_b32 v26, 16, v173
v_and_b32 v27, 0xffff0000, v173
v_lshlrev_b32 v28, 16, v174
v_and_b32 v29, 0xffff0000, v174
v_lshlrev_b32 v30, 16, v175
v_and_b32 v31, 0xffff0000, v175
v_pk_fma_f32 v[24:25], v[24:25], v[86:87], v[86:87] op_sel:[0,0,1] op_sel_hi:[1,0,1]
v_pk_fma_f32 v[26:27], v[26:27], v[86:87], v[86:87] op_sel:[0,0,1] op_sel_hi:[1,0,1]
v_pk_fma_f32 v[28:29], v[28:29], v[86:87], v[86:87] op_sel:[0,0,1] op_sel_hi:[1,0,1]
v_pk_fma_f32 v[30:31], v[30:31], v[86:87], v[86:87] op_sel:[0,0,1] op_sel_hi:[1,0,1]
v_cvt_pk_f16_f32 v172, v24, v25
v_cvt_pk_f16_f32 v173, v26, v27
v_cvt_pk_f16_f32 v174, v28, v29
v_cvt_pk_f16_f32 v175, v30, v31
v_lshlrev_b32 v24, 16, v176
v_and_b32 v25, 0xffff0000, v176
v_lshlrev_b32 v26, 16, v177
v_and_b32 v27, 0xffff0000, v177
v_lshlrev_b32 v28, 16, v178
v_and_b32 v29, 0xffff0000, v178
v_lshlrev_b32 v30, 16, v179
v_and_b32 v31, 0xffff0000, v179
v_pk_fma_f32 v[24:25], v[24:25], v[86:87], v[86:87] op_sel:[0,0,1] op_sel_hi:[1,0,1]
v_pk_fma_f32 v[26:27], v[26:27], v[86:87], v[86:87] op_sel:[0,0,1] op_sel_hi:[1,0,1]
v_pk_fma_f32 v[28:29], v[28:29], v[86:87], v[86:87] op_sel:[0,0,1] op_sel_hi:[1,0,1]
v_pk_fma_f32 v[30:31], v[30:31], v[86:87], v[86:87] op_sel:[0,0,1] op_sel_hi:[1,0,1]
v_pk_fma_f32 v[76:77], v[76:77], v[86:87], v[86:87] op_sel:[0,0,1] op_sel_hi:[1,0,1]
v_pk_fma_f32 v[78:79], v[78:79], v[86:87], v[86:87] op_sel:[0,0,1] op_sel_hi:[1,0,1]
v_pk_fma_f32 v[160:161], v[160:161], v[86:87], v[86:87] op_sel:[0,0,1] op_sel_hi:[1,0,1]
v_pk_fma_f32 v[162:163], v[162:163], v[86:87], v[86:87] op_sel:[0,0,1] op_sel_hi:[1,0,1]
v_cvt_pk_f16_f32 v176, v24, v25
v_cvt_pk_f16_f32 v177, v26, v27
v_cvt_pk_f16_f32 v178, v28, v29
v_cvt_pk_f16_f32 v179, v30, v31
buffer_load_dwordx4 v[40:43], v248, s[4:7], s56 offen sc1
s_waitcnt vmcnt(8)
s_mov_b32 s55, 0x3f803f80
v_mfma_f32_16x16x32_bf16 v[20:23], a[236:239], v[180:183], 0
v_lshlrev_b32 v24, 16, v184
v_and_b32 v25, 0xffff0000, v184
v_mfma_f32_16x16x32_bf16 v[20:23], a[236:239], v[184:187], v[20:23]
v_lshlrev_b32 v26, 16, v185
v_and_b32 v27, 0xffff0000, v185
v_mfma_f32_16x16x32_bf16 v[20:23], a[236:239], v[188:191], v[20:23]
buffer_load_dwordx4 v[44:47], v248, s[4:7], s57 offen sc1
v_lshlrev_b32 v28, 16, v186
v_and_b32 v29, 0xffff0000, v186
v_mfma_f32_16x16x32_bf16 v[20:23], a[236:239], v[192:195], v[20:23]
v_lshlrev_b32 v30, 16, v187
v_and_b32 v31, 0xffff0000, v187
v_mfma_f32_16x16x32_bf16 v[20:23], a[236:239], v[196:199], v[20:23]
v_lshlrev_b32 v80, 16, v180
v_and_b32 v81, 0xffff0000, v180
v_lshlrev_b32 v82, 16, v181
buffer_load_dwordx4 v[48:51], v248, s[4:7], s58 offen sc1
v_and_b32 v83, 0xffff0000, v181
v_dot2_f32_bf16 v66, v180, v180, 0
v_dot2_f32_bf16 v67, v181, v181, 0
v_dot2_f32_bf16 v66, v182, v182, v66
v_dot2_f32_bf16 v67, v183, v183, v67
v_dot2_f32_bf16 v66, v184, v184, v66
v_dot2_f32_bf16 v67, v185, v185, v67
v_dot2_f32_bf16 v66, v186, v186, v66
v_dot2_f32_bf16 v67, v187, v187, v67
buffer_load_dword v52, v249, s[4:7], s56 offen sc1
v_dot2_f32_bf16 v66, v188, v188, v66
v_dot2_f32_bf16 v67, v189, v189, v67
v_dot2_f32_bf16 v66, v190, v190, v66
v_dot2_f32_bf16 v67, v191, v191, v67
v_dot2_f32_bf16 v66, v192, v192, v66
v_dot2_f32_bf16 v67, v193, v193, v67
v_dot2_f32_bf16 v66, v194, v194, v66
v_dot2_f32_bf16 v67, v195, v195, v67
v_dot2_f32_bf16 v66, v196, v196, v66
buffer_load_dword v53, v249, s[4:7], s57 offen sc1
v_dot2_f32_bf16 v67, v197, v197, v67
v_dot2_f32_bf16 v66, v198, v198, v66
v_dot2_f32_bf16 v67, v199, v199, v67
v_add_f32_dpp v20, v20, v20 row_ror:8 row_mask:0xf bank_mask:0xf
v_lshlrev_b32 v180, 16, v182
v_and_b32 v181, 0xffff0000, v182
v_add_f32 v66, v66, v67
v_add_f32_dpp v20, v20, v20 row_ror:4 row_mask:0xf bank_mask:0xf
v_lshlrev_b32 v182, 16, v183
buffer_load_dword v54, v249, s[4:7], s58 offen sc1
v_add_f32_dpp v66, v66, v66 row_ror:8 row_mask:0xf bank_mask:0xf
v_add_f32_dpp v20, v20, v20 row_ror:2 row_mask:0xf bank_mask:0xf
v_and_b32 v183, 0xffff0000, v183
v_add_f32_dpp v66, v66, v66 row_ror:4 row_mask:0xf bank_mask:0xf
v_add_f32_dpp v20, v20, v20 row_ror:1 row_mask:0xf bank_mask:0xf
v_mul_f32 v20, 0x3acccccd, v20
v_add_f32_dpp v66, v66, v66 row_ror:2 row_mask:0xf bank_mask:0xf
s_nop 1
v_add_f32_dpp v66, v66, v66 row_ror:1 row_mask:0xf bank_mask:0xf
v_mul_f32 v66, 0x3acccccd, v66
buffer_load_dword v71, v247, s[4:7], s60 offen sc1
v_fma_f32 v66, -v20, v20, v66
v_max_f32 v66, 0, v66
v_add_f32 v66, 0x3727c5ac, v66
v_rsq_f32 v66, v66
s_nop 0
v_mul_f32 v67, -v20, v66
v_pk_fma_f32 v[24:25], v[24:25], v[66:67], v[66:67] op_sel:[0,0,1] op_sel_hi:[1,0,1]
v_pk_fma_f32 v[26:27], v[26:27], v[66:67], v[66:67] op_sel:[0,0,1] op_sel_hi:[1,0,1]
v_pk_fma_f32 v[28:29], v[28:29], v[66:67], v[66:67] op_sel:[0,0,1] op_sel_hi:[1,0,1]
v_pk_fma_f32 v[30:31], v[30:31], v[66:67], v[66:67] op_sel:[0,0,1] op_sel_hi:[1,0,1]
v_cvt_pk_f16_f32 v184, v24, v25
s_add_u32 m0, s39, 0
s_nop 0
buffer_load_dwordx4 v232, s[24:27], s48 offen offset:0 lds
v_cvt_pk_f16_f32 v185, v26, v27
v_cvt_pk_f16_f32 v186, v28, v29
v_cvt_pk_f16_f32 v187, v30, v31
v_lshlrev_b32 v24, 16, v188
v_and_b32 v25, 0xffff0000, v188
v_lshlrev_b32 v26, 16, v189
v_and_b32 v27, 0xffff0000, v189
v_lshlrev_b32 v28, 16, v190
v_and_b32 v29, 0xffff0000, v190
buffer_load_dwordx4 v233, s[24:27], s48 offen offset:1024 lds
v_lshlrev_b32 v30, 16, v191
v_and_b32 v31, 0xffff0000, v191
v_pk_fma_f32 v[24:25], v[24:25], v[66:67], v[66:67] op_sel:[0,0,1] op_sel_hi:[1,0,1]
v_pk_fma_f32 v[26:27], v[26:27], v[66:67], v[66:67] op_sel:[0,0,1] op_sel_hi:[1,0,1]
v_pk_fma_f32 v[28:29], v[28:29], v[66:67], v[66:67] op_sel:[0,0,1] op_sel_hi:[1,0,1]
v_pk_fma_f32 v[30:31], v[30:31], v[66:67], v[66:67] op_sel:[0,0,1] op_sel_hi:[1,0,1]
v_cvt_pk_f16_f32 v188, v24, v25
v_cvt_pk_f16_f32 v189, v26, v27
v_cvt_pk_f16_f32 v190, v28, v29
buffer_load_dwordx4 v234, s[24:27], s48 offen offset:2048 lds
s_add_u32 s48, s48, 81920
v_cvt_pk_f16_f32 v191, v30, v31
v_lshlrev_b32 v24, 16, v192
v_and_b32 v25, 0xffff0000, v192
v_lshlrev_b32 v26, 16, v193
v_and_b32 v27, 0xffff0000, v193
v_lshlrev_b32 v28, 16, v194
v_and_b32 v29, 0xffff0000, v194
v_lshlrev_b32 v30, 16, v195
v_and_b32 v31, 0xffff0000, v195
s_add_u32 m0, s39, 12288
s_nop 0
buffer_load_dwordx4 v232, s[24:27], s48 offen offset:0 lds
v_pk_fma_f32 v[24:25], v[24:25], v[66:67], v[66:67] op_sel:[0,0,1] op_sel_hi:[1,0,1]
v_pk_fma_f32 v[26:27], v[26:27], v[66:67], v[66:67] op_sel:[0,0,1] op_sel_hi:[1,0,1]
v_pk_fma_f32 v[28:29], v[28:29], v[66:67], v[66:67] op_sel:[0,0,1] op_sel_hi:[1,0,1]
v_pk_fma_f32 v[30:31], v[30:31], v[66:67], v[66:67] op_sel:[0,0,1] op_sel_hi:[1,0,1]
v_cvt_pk_f16_f32 v192, v24, v25
v_cvt_pk_f16_f32 v193, v26, v27
v_cvt_pk_f16_f32 v194, v28, v29
v_cvt_pk_f16_f32 v195, v30, v31
v_lshlrev_b32 v24, 16, v196
buffer_load_dwordx4 v233, s[24:27], s48 offen offset:1024 lds
v_and_b32 v25, 0xffff0000, v196
v_lshlrev_b32 v26, 16, v197
v_and_b32 v27, 0xffff0000, v197
v_lshlrev_b32 v28, 16, v198
v_and_b32 v29, 0xffff0000, v198
v_lshlrev_b32 v30, 16, v199
v_and_b32 v31, 0xffff0000, v199
v_pk_fma_f32 v[24:25], v[24:25], v[66:67], v[66:67] op_sel:[0,0,1] op_sel_hi:[1,0,1]
v_pk_fma_f32 v[26:27], v[26:27], v[66:67], v[66:67] op_sel:[0,0,1] op_sel_hi:[1,0,1]
buffer_load_dwordx4 v234, s[24:27], s48 offen offset:2048 lds
s_add_u32 s48, s48, 81920
v_pk_fma_f32 v[28:29], v[28:29], v[66:67], v[66:67] op_sel:[0,0,1] op_sel_hi:[1,0,1]
v_pk_fma_f32 v[30:31], v[30:31], v[66:67], v[66:67] op_sel:[0,0,1] op_sel_hi:[1,0,1]
v_pk_fma_f32 v[80:81], v[80:81], v[66:67], v[66:67] op_sel:[0,0,1] op_sel_hi:[1,0,1]
v_pk_fma_f32 v[82:83], v[82:83], v[66:67], v[66:67] op_sel:[0,0,1] op_sel_hi:[1,0,1]
v_pk_fma_f32 v[180:181], v[180:181], v[66:67], v[66:67] op_sel:[0,0,1] op_sel_hi:[1,0,1]
v_pk_fma_f32 v[182:183], v[182:183], v[66:67], v[66:67] op_sel:[0,0,1] op_sel_hi:[1,0,1]
v_cvt_pk_f16_f32 v196, v24, v25
v_cvt_pk_f16_f32 v197, v26, v27
v_cvt_pk_f16_f32 v198, v28, v29
v_cvt_pk_f16_f32 v199, v30, v31
s_branch L_bodyj
L_ga_retry:
buffer_load_dwordx4 v[40:43], v248, s[4:7], s56 offen sc1
buffer_load_dwordx4 v[44:47], v248, s[4:7], s57 offen sc1
buffer_load_dwordx4 v[48:51], v248, s[4:7], s58 offen sc1
buffer_load_dword v52, v249, s[4:7], s56 offen sc1
buffer_load_dword v53, v249, s[4:7], s57 offen sc1
buffer_load_dword v54, v249, s[4:7], s58 offen sc1
s_waitcnt vmcnt(0)
v_xor_b32 v40, s12, v40
v_xor_b32 v41, s13, v41
v_xor_b32 v42, s14, v42
v_xor_b32 v43, s15, v43
v_xor_b32 v44, s12, v44
v_xor_b32 v45, s13, v45
v_xor_b32 v46, s14, v46
v_xor_b32 v47, s15, v47
v_xor_b32 v48, s12, v48
v_xor_b32 v49, s13, v49
v_xor_b32 v50, s14, v50
v_xor_b32 v51, s15, v51
v_xor_b32 v52, v19, v52
v_xor_b32 v53, v19, v53
v_xor_b32 v54, v19, v54
v_or3_b32 v64, v40, v41, v42
v_or3_b32 v65, v43, v44, v45
v_or3_b32 v64, v64, v46, v47
v_or3_b32 v65, v65, v48, v49
v_or3_b32 v64, v64, v50, v51
v_or3_b32 v65, v65, v52, v53
v_or3_b32 v64, v64, v65, v54
v_and_b32 v64, 0xff, v64
v_cmp_ne_u32 vcc, 0, v64
s_add_u32 s97, s97, 1
s_cmp_gt_u32 s97, 65536
s_cbranch_scc1 L_ga_ok
s_cbranch_vccnz L_ga_retry
s_branch L_ga_ok
L_fg_retry:
buffer_load_dword v71, v247, s[4:7], s60 offen sc1
s_waitcnt vmcnt(0)
v_cmp_ne_u32 vcc, s40, v71
s_add_u32 s97, s97, 1
s_cmp_gt_u32 s97, 65536
s_cbranch_scc1 L_fg_ok
s_cbranch_vccnz L_fg_retry
s_branch L_fg_ok
L_mv_retry:
buffer_load_dwordx2 v[194:195], v231, s[4:7], s23 offen sc1
buffer_load_dwordx4 v[240:243], v238, s[4:7], s51 offen sc1
buffer_load_dwordx4 v[190:193], v238, s[4:7], s22 offen sc1
s_waitcnt vmcnt(0)
v_perm_b32 v36, v241, v240, s55
v_perm_b32 v37, v243, v242, s55
v_xor_b32 v36, s40, v36
v_xor_b32 v37, s40, v37
v_or_b32 v38, v36, v37
v_perm_b32 v36, v191, v190, s55
v_perm_b32 v37, v193, v192, s55
v_xor_b32 v36, s40, v36
v_xor_b32 v37, s40, v37
v_or3_b32 v38, v38, v36, v37
v_and_b32 v38, v38, v230
v_xor_b32 v37, s40, v194
v_or_b32 v38, v38, v37
v_cmp_ne_u32 vcc, 0, v38
s_add_u32 s97, s97, 1
s_cmp_gt_u32 s97, 65536
s_cbranch_scc1 L_mv_ok
s_cbranch_vccnz L_mv_retry
s_branch L_mv_ok
L_o0_retry:
buffer_load_dwordx4 v[100:103], v7, s[4:7], s56 offen offset:0 sc1
buffer_load_dwordx4 v[104:107], v7, s[4:7], s56 offen offset:1024 sc1
buffer_load_dwordx4 v[108:111], v7, s[4:7], s56 offen offset:2048 sc1
buffer_load_dwordx4 v[112:115], v7, s[4:7], s56 offen offset:3072 sc1
buffer_load_dwordx4 v[116:119], v7, s[4:7], s57 offen offset:0 sc1
buffer_load_dwordx4 v[120:123], v7, s[4:7], s57 offen offset:1024 sc1
buffer_load_dwordx4 v[124:127], v7, s[4:7], s57 offen offset:2048 sc1
buffer_load_dwordx4 v[128:131], v7, s[4:7], s57 offen offset:3072 sc1
s_waitcnt vmcnt(6)
v_max3_u32 v92, v100, v101, v102
v_max3_u32 v93, v103, v104, v105
v_max3_u32 v92, v92, v106, v107
v_max_u32 v92, v92, v93
v_cmp_eq_u32 vcc, -1, v92
s_add_u32 s97, s97, 1
s_cmp_gt_u32 s97, 65536
s_cbranch_scc1 L_o0_ok
s_cbranch_vccnz L_o0_retry
s_branch L_o0_ok
L_o1_retry:
buffer_load_dwordx4 v[108:111], v7, s[4:7], s56 offen offset:2048 sc1
buffer_load_dwordx4 v[112:115], v7, s[4:7], s56 offen offset:3072 sc1
buffer_load_dwordx4 v[116:119], v7, s[4:7], s57 offen offset:0 sc1
buffer_load_dwordx4 v[120:123], v7, s[4:7], s57 offen offset:1024 sc1
buffer_load_dwordx4 v[124:127], v7, s[4:7], s57 offen offset:2048 sc1
buffer_load_dwordx4 v[128:131], v7, s[4:7], s57 offen offset:3072 sc1
buffer_load_dwordx4 v[132:135], v7, s[4:7], s58 offen offset:0 sc1
buffer_load_dwordx4 v[136:139], v7, s[4:7], s58 offen offset:1024 sc1
s_waitcnt vmcnt(6)
v_max3_u32 v92, v108, v109, v110
v_max3_u32 v93, v111, v112, v113
v_max3_u32 v92, v92, v114, v115
v_max_u32 v92, v92, v93
v_cmp_eq_u32 vcc, -1, v92
s_add_u32 s97, s97, 1
s_cmp_gt_u32 s97, 65536
s_cbranch_scc1 L_o1_ok
s_cbranch_vccnz L_o1_retry
s_branch L_o1_ok
L_o2_retry:
buffer_load_dwordx4 v[116:119], v7, s[4:7], s57 offen offset:0 sc1
buffer_load_dwordx4 v[120:123], v7, s[4:7], s57 offen offset:1024 sc1
buffer_load_dwordx4 v[124:127], v7, s[4:7], s57 offen offset:2048 sc1
buffer_load_dwordx4 v[128:131], v7, s[4:7], s57 offen offset:3072 sc1
buffer_load_dwordx4 v[132:135], v7, s[4:7], s58 offen offset:0 sc1
buffer_load_dwordx4 v[136:139], v7, s[4:7], s58 offen offset:1024 sc1
buffer_load_dwordx4 v[140:143], v7, s[4:7], s58 offen offset:2048 sc1
buffer_load_dwordx4 v[144:147], v7, s[4:7], s58 offen offset:3072 sc1
s_waitcnt vmcnt(6)
v_max3_u32 v92, v116, v117, v118
v_max3_u32 v93, v119, v120, v121
v_max3_u32 v92, v92, v122, v123
v_max_u32 v92, v92, v93
v_cmp_eq_u32 vcc, -1, v92
s_add_u32 s97, s97, 1
s_cmp_gt_u32 s97, 65536
s_cbranch_scc1 L_o2_ok
s_cbranch_vccnz L_o2_retry
s_branch L_o2_ok
L_o3_retry:
buffer_load_dwordx4 v[124:127], v7, s[4:7], s57 offen offset:2048 sc1
buffer_load_dwordx4 v[128:131], v7, s[4:7], s57 offen offset:3072 sc1
buffer_load_dwordx4 v[132:135], v7, s[4:7], s58 offen offset:0 sc1
buffer_load_dwordx4 v[136:139], v7, s[4:7], s58 offen offset:1024 sc1
buffer_load_dwordx4 v[140:143], v7, s[4:7], s58 offen offset:2048 sc1
buffer_load_dwordx4 v[144:147], v7, s[4:7], s58 offen offset:3072 sc1
buffer_load_dwordx4 v[148:151], v7, s[4:7], s59 offen offset:0 sc1
buffer_load_dwordx4 v[152:155], v7, s[4:7], s59 offen offset:1024 sc1
s_waitcnt vmcnt(6)
v_max3_u32 v92, v124, v125, v126
v_max3_u32 v93, v127, v128, v129
v_max3_u32 v92, v92, v130, v131
v_max_u32 v92, v92, v93
v_cmp_eq_u32 vcc, -1, v92
s_add_u32 s97, s97, 1
s_cmp_gt_u32 s97, 65536
s_cbranch_scc1 L_o3_ok
s_cbranch_vccnz L_o3_retry
s_branch L_o3_ok
L_o4_retry:
buffer_load_dwordx4 v[132:135], v7, s[4:7], s58 offen offset:0 sc1
buffer_load_dwordx4 v[136:139], v7, s[4:7], s58 offen offset:1024 sc1
buffer_load_dwordx4 v[140:143], v7, s[4:7], s58 offen offset:2048 sc1
buffer_load_dwordx4 v[144:147], v7, s[4:7], s58 offen offset:3072 sc1
buffer_load_dwordx4 v[148:151], v7, s[4:7], s59 offen offset:0 sc1
buffer_load_dwordx4 v[152:155], v7, s[4:7], s59 offen offset:1024 sc1
buffer_load_dwordx4 v[156:159], v7, s[4:7], s59 offen offset:2048 sc1
buffer_load_dwordx4 v[160:163], v7, s[4:7], s59 offen offset:3072 sc1
s_waitcnt vmcnt(6)
v_max3_u32 v92, v132, v133, v134
v_max3_u32 v93, v135, v136, v137
v_max3_u32 v92, v92, v138, v139
v_max_u32 v92, v92, v93
v_cmp_eq_u32 vcc, -1, v92
s_add_u32 s97, s97, 1
s_cmp_gt_u32 s97, 65536
s_cbranch_scc1 L_o4_ok
s_cbranch_vccnz L_o4_retry
s_branch L_o4_ok
L_o5_retry:
buffer_load_dwordx4 v[140:143], v7, s[4:7], s58 offen offset:2048 sc1
buffer_load_dwordx4 v[144:147], v7, s[4:7], s58 offen offset:3072 sc1
buffer_load_dwordx4 v[148:151], v7, s[4:7], s59 offen offset:0 sc1
buffer_load_dwordx4 v[152:155], v7, s[4:7], s59 offen offset:1024 sc1
buffer_load_dwordx4 v[156:159], v7, s[4:7], s59 offen offset:2048 sc1
buffer_load_dwordx4 v[160:163], v7, s[4:7], s59 offen offset:3072 sc1
buffer_load_dwordx4 v[164:167], v7, s[4:7], s60 offen offset:0 sc1
buffer_load_dwordx4 v[168:171], v7, s[4:7], s60 offen offset:1024 sc1
s_waitcnt vmcnt(6)
v_max3_u32 v92, v140, v141, v142
v_max3_u32 v93, v143, v144, v145
v_max3_u32 v92, v92, v146, v147
v_max_u32 v92, v92, v93
v_cmp_eq_u32 vcc, -1, v92
s_add_u32 s97, s97, 1
s_cmp_gt_u32 s97, 65536
s_cbranch_scc1 L_o5_ok
s_cbranch_vccnz L_o5_retry
s_branch L_o5_ok
L_o6_retry:
buffer_load_dwordx4 v[148:151], v7, s[4:7], s59 offen offset:0 sc1
buffer_load_dwordx4 v[152:155], v7, s[4:7], s59 offen offset:1024 sc1
buffer_load_dwordx4 v[156:159], v7, s[4:7], s59 offen offset:2048 sc1
buffer_load_dwordx4 v[160:163], v7, s[4:7], s59 offen offset:3072 sc1
buffer_load_dwordx4 v[164:167], v7, s[4:7], s60 offen offset:0 sc1
buffer_load_dwordx4 v[168:171], v7, s[4:7], s60 offen offset:1024 sc1
buffer_load_dwordx4 v[172:175], v7, s[4:7], s60 offen offset:2048 sc1
buffer_load_dwordx4 v[176:179], v7, s[4:7], s60 offen offset:3072 sc1
s_waitcnt vmcnt(6)
v_max3_u32 v92, v148, v149, v150
v_max3_u32 v93, v151, v152, v153
v_max3_u32 v92, v92, v154, v155
v_max_u32 v92, v92, v93
v_cmp_eq_u32 vcc, -1, v92
s_add_u32 s97, s97, 1
s_cmp_gt_u32 s97, 65536
s_cbranch_scc1 L_o6_ok
s_cbranch_vccnz L_o6_retry
s_branch L_o6_ok
L_o7_retry:
buffer_load_dwordx4 v[156:159], v7, s[4:7], s59 offen offset:2048 sc1
buffer_load_dwordx4 v[160:163], v7, s[4:7], s59 offen offset:3072 sc1
buffer_load_dwordx4 v[164:167], v7, s[4:7], s60 offen offset:0 sc1
buffer_load_dwordx4 v[168:171], v7, s[4:7], s60 offen offset:1024 sc1
buffer_load_dwordx4 v[172:175], v7, s[4:7], s60 offen offset:2048 sc1
buffer_load_dwordx4 v[176:179], v7, s[4:7], s60 offen offset:3072 sc1
s_waitcnt vmcnt(4)
v_max3_u32 v92, v156, v157, v158
v_max3_u32 v93, v159, v160, v161
v_max3_u32 v92, v92, v162, v163
v_max_u32 v92, v92, v93
v_cmp_eq_u32 vcc, -1, v92
s_add_u32 s97, s97, 1
s_cmp_gt_u32 s97, 65536
s_cbranch_scc1 L_o7_ok
s_cbranch_vccnz L_o7_retry
s_branch L_o7_ok
L_o8_retry:
buffer_load_dwordx4 v[164:167], v7, s[4:7], s60 offen offset:0 sc1
buffer_load_dwordx4 v[168:171], v7, s[4:7], s60 offen offset:1024 sc1
buffer_load_dwordx4 v[172:175], v7, s[4:7], s60 offen offset:2048 sc1
buffer_load_dwordx4 v[176:179], v7, s[4:7], s60 offen offset:3072 sc1
s_waitcnt vmcnt(2)
v_max3_u32 v92, v164, v165, v166
v_max3_u32 v93, v167, v168, v169
v_max3_u32 v92, v92, v170, v171
v_max_u32 v92, v92, v93
v_cmp_eq_u32 vcc, -1, v92
s_add_u32 s97, s97, 1
s_cmp_gt_u32 s97, 65536
s_cbranch_scc1 L_o8_ok
s_cbranch_vccnz L_o8_retry
s_branch L_o8_ok
L_o9_retry:
buffer_load_dwordx4 v[172:175], v7, s[4:7], s60 offen offset:2048 sc1
buffer_load_dwordx4 v[176:179], v7, s[4:7], s60 offen offset:3072 sc1
s_waitcnt vmcnt(0)
v_max3_u32 v92, v172, v173, v174
v_max3_u32 v93, v175, v176, v177
v_max3_u32 v92, v92, v178, v179
v_max_u32 v92, v92, v93
v_cmp_eq_u32 vcc, -1, v92
s_add_u32 s97, s97, 1
s_cmp_gt_u32 s97, 65536
s_cbranch_scc1 L_o9_ok
s_cbranch_vccnz L_o9_retry
s_branch L_o9_ok
L_st_slow:
buffer_store_dword v44, v0, s[4:7], s57 offen sc1
s_branch L_st_j
L_svc:
s_sub_u32 s44, s2, 224
v_lshlrev_b32 v28, 3, v0
s_waitcnt lgkmcnt(0)
s_mov_b32 s16, s22
s_mov_b32 s17, s23
s_mov_b32 s22, 1280
s_mov_b32 s23, 0x20000
buffer_load_dwordx2 v[40:41], v28, s[20:23], 0 offen
buffer_load_dword v42, v29, s[4:7], 0 offen sc1
s_load_dwordx2 s[8:9], s[0:1], 40
s_load_dwordx2 s[12:13], s[0:1], 48
s_load_dwordx2 s[36:37], s[0:1], 56
s_load_dwordx2 s[24:25], s[0:1], 16
s_load_dwordx2 s[28:29], s[0:1], 32
s_load_dwordx2 s[32:33], s[0:1], 80
s_mov_b32 s18, 4915200
s_mov_b32 s19, 0x20000
s_mov_b32 s26, 819200
s_mov_b32 s27, 0x20000
s_mov_b32 s30, 1280
s_mov_b32 s31, 0x20000
s_mov_b32 s34, 2621440
s_mov_b32 s35, 0x20000
s_mov_b32 s10, 2211840
s_mov_b32 s11, 0x20000
s_mov_b32 s14, 2211840
s_mov_b32 s15, 0x20000
s_mov_b32 s38, 2211840
s_mov_b32 s39, 0x20000
v_bfe_u32 v32, v1, 2, 2
v_lshrrev_b32 v33, 1, v32
v_and_b32 v34, 1, v3
v_lshl_or_b32 v33, v34, 1, v33
v_xor_b32 v33, s3, v33
v_and_b32 v34, 3, v1
v_lshlrev_b32 v34, 3, v34
v_lshl_add_u32 v33, v33, 5, v34
v_lshl_add_u32 v32, v3, 3, v32
v_lshl_add_u32 v6, v32, 7, v33
s_mov_b32 s97, 0
s_mov_b32 s98, 0x0c0c0400
s_mov_b32 s99, 0x04000c0c
v_add_u32 v7, 40960, v6
v_add_u32 v9, 81920, v6
v_add_u32 v10, 81920+40960, v6
s_mul_i32 s55, s3, 320
s_add_u32 s55, s55, 81920
v_mul_u32_u24 v32, 1280, v32
v_add3_u32 v11, v32, v34, s55
s_and_b32 s55, s3, 1
s_lshl_b32 s55, s55, 2
v_and_b32 v30, 1, v3
v_lshl_or_b32 v30, v30, 1, s55
v_and_b32 v31, 7, v1
v_xor_b32 v31, v30, v31
v_lshlrev_b32 v31, 4, v31
v_lshrrev_b32 v30, 3, v1
v_mad_u32_u24 v4, v30, 60, 0
v_lshl_add_u32 v4, v4, 7, v31
v_mad_u32_u24 v5, v30, 27, 0
v_lshl_add_u32 v5, v5, 7, v31
v_lshlrev_b32 v8, 4, v1
v_lshlrev_b32 v12, 2, v1
v_mov_b32 v255, 1073741824
s_lshr_b32 s101, s42, 2
s_xor_b32 s101, s101, 0
s_mul_i32 s101, s101, 8192
s_add_u32 s100, s101, 7733248
s_waitcnt lgkmcnt(0)
s_cmp_ge_u32 s44, 27
s_cbranch_scc1 L_fz
s_lshl_b32 s55, s44, 2
s_add_u32 s55, s55, s3
s_mul_i32 s55, s55, 7680
v_lshlrev_b32 v33, 7, v1
s_mov_b32 exec_hi, 0xfffffff
buffer_load_dword v184, v33, s[24:27], s55 offen
s_mov_b32 exec_hi, -1
s_lshl_b32 s50, s44, 7
s_mul_i32 s55, s3, 61440
s_add_u32 s50, s50, s55
s_add_u32 s50, s50, 2560
s_add_u32 m0, s49, 0
s_nop 0
buffer_load_dwordx4 v4, s[16:19], s50 offen nt lds
s_add_u32 m0, m0, 4096
s_add_u32 s50, s50, 245760
buffer_load_dwordx4 v4, s[16:19], s50 offen nt lds
s_add_u32 m0, m0, 4096
s_add_u32 s50, s50, 245760
buffer_load_dwordx4 v4, s[16:19], s50 offen nt lds
s_add_u32 m0, m0, 4096
s_add_u32 s50, s50, 245760
buffer_load_dwordx4 v4, s[16:19], s50 offen nt lds
s_add_u32 m0, m0, 4096
s_add_u32 s50, s50, 245760
buffer_load_dwordx4 v4, s[16:19], s50 offen nt lds
s_add_u32 m0, m0, 4096
s_add_u32 s50, s50, 245760
buffer_load_dwordx4 v4, s[16:19], s50 offen nt lds
s_add_u32 m0, m0, 4096
s_add_u32 s50, s50, 245760
buffer_load_dwordx4 v4, s[16:19], s50 offen nt lds
s_add_u32 m0, m0, 4096
s_add_u32 s50, s50, 245760
buffer_load_dwordx4 v4, s[16:19], s50 offen nt lds
s_add_u32 m0, m0, 4096
s_add_u32 s50, s50, 245760
buffer_load_dwordx4 v4, s[16:19], s50 offen nt lds
s_add_u32 m0, m0, 4096
s_add_u32 s50, s50, 245760
buffer_load_dwordx4 v4, s[16:19], s50 offen nt lds
s_add_u32 m0, m0, 4096
s_add_u32 s50, s50, 245760
buffer_load_dwordx4 v4, s[16:19], s50 offen nt lds
s_add_u32 m0, m0, 4096
s_add_u32 s50, s50, 245760
buffer_load_dwordx4 v4, s[16:19], s50 offen nt lds
s_add_u32 m0, m0, 4096
s_add_u32 s50, s50, 245760
buffer_load_dwordx4 v4, s[16:19], s50 offen nt lds
s_add_u32 m0, m0, 4096
s_add_u32 s50, s50, 245760
buffer_load_dwordx4 v4, s[16:19], s50 offen nt lds
s_add_u32 m0, m0, 4096
s_add_u32 s50, s50, 245760
buffer_load_dwordx4 v4, s[16:19], s50 offen nt lds
s_add_u32 m0, m0, 4096
s_add_u32 s50, s50, 245760
buffer_load_dwordx4 v4, s[16:19], s50 offen nt lds
s_add_u32 m0, m0, 4096
s_add_u32 s50, s50, 245760
buffer_load_dwordx4 v4, s[16:19], s50 offen nt lds
s_add_u32 m0, m0, 4096
s_add_u32 s50, s50, 245760
buffer_load_dwordx4 v4, s[16:19], s50 offen nt lds
s_add_u32 m0, m0, 4096
s_add_u32 s50, s50, 245760
buffer_load_dwordx4 v4, s[16:19], s50 offen nt lds
s_add_u32 m0, m0, 4096
s_add_u32 s50, s50, 245760
buffer_load_dwordx4 v4, s[16:19], s50 offen nt lds
s_waitcnt vmcnt(21)
v_readfirstlane_b32 s41, v42
v_lshlrev_b32 v44, 16, v40
v_and_b32 v45, 0xffff0000, v40
v_lshlrev_b32 v46, 16, v41
v_and_b32 v47, 0xffff0000, v41
v_mul_f32 v48, 0xbfb8aa3b, v44
v_mul_f32 v49, 0xbfb8aa3b, v45
v_mul_f32 v50, 0xbfb8aa3b, v46
v_mul_f32 v51, 0xbfb8aa3b, v47
v_exp_f32 v48, v48
v_exp_f32 v49, v49
v_exp_f32 v50, v50
v_exp_f32 v51, v51
v_add_f32 v48, 1.0, v48
v_add_f32 v49, 1.0, v49
v_add_f32 v50, 1.0, v50
v_add_f32 v51, 1.0, v51
v_rcp_f32 v48, v48
v_rcp_f32 v49, v49
v_rcp_f32 v50, v50
v_rcp_f32 v51, v51
v_mul_f32 v44, v44, v48
v_mul_f32 v45, v45, v49
v_mul_f32 v46, v46, v50
v_mul_f32 v47, v47, v51
v_cvt_pk_bf16_f32 v40, v44, v45
v_cvt_pk_bf16_f32 v41, v46, v47
v_add_u32 v28, 99840, v28
ds_write_b64 v28, v[40:41]
v_lshlrev_b32 v28, 4, v3
v_add_u32 v28, 99840, v28
s_mul_i32 s40, s41, 0x9E3779B1
s_add_u32 s40, s40, 0x85EBCA6B
v_and_b32 v33, 3, v1
v_lshlrev_b32 v33, 3, v33
v_lshrrev_b32 v19, v33, s40
v_and_b32 v19, 0xff, v19
v_mov_b32 v240, s40
v_mov_b32 v241, s19
v_mov_b32 v242, s40
v_mov_b32 v243, s40
v_and_b32 v30, 1, v1
v_lshlrev_b32 v30, 4, v30
v_lshrrev_b32 v13, v30, s40
v_and_b32 v13, 0xffff, v13
s_waitcnt lgkmcnt(0)
s_barrier
ds_read_b128 v[100:103], v28 offset:0
ds_read_b128 v[104:107], v28 offset:64
ds_read_b128 v[108:111], v28 offset:128
ds_read_b128 v[112:115], v28 offset:192
ds_read_b128 v[116:119], v28 offset:256
ds_read_b128 v[120:123], v28 offset:320
ds_read_b128 v[124:127], v28 offset:384
ds_read_b128 v[128:131], v28 offset:448
ds_read_b128 v[132:135], v28 offset:512
ds_read_b128 v[136:139], v28 offset:576
ds_read_b128 v[140:143], v28 offset:640
ds_read_b128 v[144:147], v28 offset:704
ds_read_b128 v[148:151], v28 offset:768
ds_read_b128 v[152:155], v28 offset:832
ds_read_b128 v[156:159], v28 offset:896
ds_read_b128 v[160:163], v28 offset:960
ds_read_b128 v[164:167], v28 offset:1024
ds_read_b128 v[168:171], v28 offset:1088
ds_read_b128 v[172:175], v28 offset:1152
ds_read_b128 v[176:179], v28 offset:1216
s_waitcnt lgkmcnt(0)
s_barrier
s_lshl_b32 s60, s44, 10
s_andn2_b32 s61, s60, 0x1fff
s_add_u32 s60, s60, s61
s_add_u32 s60, s60, 8126464
s_add_u32 s61, s60, 8192
v_cmp_gt_u32 vcc, 64, v0
s_nop 1
v_cndmask_b32 v30, v255, v8, vcc
buffer_store_dwordx4 v[240:243], v30, s[4:7], s60 offen sc1
buffer_store_dwordx4 v[240:243], v30, s[4:7], s61 offen sc1
s_lshl_b32 s51, s44, 7
s_mul_i32 s55, s3, 27648
s_add_u32 s51, s51, s55
s_mov_b32 s52, s51
s_add_u32 m0, s49, 81920
s_nop 0
buffer_load_dwordx4 v5, s[8:11], s51 offen nt lds
s_add_u32 m0, m0, 4096
s_add_u32 s51, s51, 110592
buffer_load_dwordx4 v5, s[8:11], s51 offen nt lds
s_add_u32 m0, m0, 4096
s_add_u32 s51, s51, 110592
buffer_load_dwordx4 v5, s[8:11], s51 offen nt lds
s_add_u32 m0, m0, 4096
s_add_u32 s51, s51, 110592
buffer_load_dwordx4 v5, s[8:11], s51 offen nt lds
s_add_u32 m0, m0, 4096
s_add_u32 s51, s51, 110592
buffer_load_dwordx4 v5, s[8:11], s51 offen nt lds
s_add_u32 m0, m0, 4096
s_add_u32 s51, s51, 110592
buffer_load_dwordx4 v5, s[8:11], s51 offen nt lds
s_add_u32 m0, m0, 4096
s_add_u32 s51, s51, 110592
buffer_load_dwordx4 v5, s[8:11], s51 offen nt lds
s_add_u32 m0, m0, 4096
s_add_u32 s51, s51, 110592
buffer_load_dwordx4 v5, s[8:11], s51 offen nt lds
s_add_u32 m0, m0, 4096
s_add_u32 s51, s51, 110592
buffer_load_dwordx4 v5, s[8:11], s51 offen nt lds
s_add_u32 m0, m0, 4096
s_add_u32 s51, s51, 110592
buffer_load_dwordx4 v5, s[8:11], s51 offen nt lds
s_add_u32 m0, m0, 4096
s_add_u32 s51, s51, 110592
buffer_load_dwordx4 v5, s[8:11], s51 offen nt lds
s_add_u32 m0, m0, 4096
s_add_u32 s51, s51, 110592
buffer_load_dwordx4 v5, s[8:11], s51 offen nt lds
s_add_u32 m0, m0, 4096
s_add_u32 s51, s51, 110592
buffer_load_dwordx4 v5, s[8:11], s51 offen nt lds
s_add_u32 m0, m0, 4096
s_add_u32 s51, s51, 110592
buffer_load_dwordx4 v5, s[8:11], s51 offen nt lds
s_add_u32 m0, m0, 4096
s_add_u32 s51, s51, 110592
buffer_load_dwordx4 v5, s[8:11], s51 offen nt lds
s_add_u32 m0, m0, 4096
s_add_u32 s51, s51, 110592
buffer_load_dwordx4 v5, s[8:11], s51 offen nt lds
s_add_u32 m0, m0, 4096
s_add_u32 s51, s51, 110592
buffer_load_dwordx4 v5, s[8:11], s51 offen nt lds
s_add_u32 m0, m0, 4096
s_add_u32 s51, s51, 110592
buffer_load_dwordx4 v5, s[8:11], s51 offen nt lds
s_add_u32 m0, m0, 4096
s_add_u32 s51, s51, 110592
buffer_load_dwordx4 v5, s[8:11], s51 offen nt lds
s_add_u32 m0, m0, 4096
s_add_u32 s51, s51, 110592
buffer_load_dwordx4 v5, s[8:11], s51 offen nt lds
s_waitcnt vmcnt(22)
s_barrier
ds_read_b64_tr_b16 v[20:21], v6 offset:0
ds_read_b64_tr_b16 v[22:23], v6 offset:512
ds_read_b64_tr_b16 v[24:25], v6 offset:4096
ds_read_b64_tr_b16 v[26:27], v6 offset:4608
ds_read_b64_tr_b16 v[28:29], v6 offset:8192
ds_read_b64_tr_b16 v[30:31], v6 offset:8704
ds_read_b64_tr_b16 v[32:33], v6 offset:12288
ds_read_b64_tr_b16 v[34:35], v6 offset:12800
ds_read_b64_tr_b16 v[36:37], v6 offset:16384
ds_read_b64_tr_b16 v[38:39], v6 offset:16896
ds_read_b64_tr_b16 v[40:41], v6 offset:20480
ds_read_b64_tr_b16 v[42:43], v6 offset:20992
ds_read_b64_tr_b16 v[44:45], v6 offset:24576
ds_read_b64_tr_b16 v[46:47], v6 offset:25088
ds_read_b64_tr_b16 v[48:49], v6 offset:28672
ds_read_b64_tr_b16 v[50:51], v6 offset:29184
ds_read_b64_tr_b16 v[52:53], v6 offset:32768
ds_read_b64_tr_b16 v[54:55], v6 offset:33280
ds_read_b64_tr_b16 v[56:57], v6 offset:36864
ds_read_b64_tr_b16 v[58:59], v6 offset:37376
ds_read_b64_tr_b16 v[60:61], v7 offset:0
ds_read_b64_tr_b16 v[62:63], v7 offset:512
ds_read_b64_tr_b16 v[64:65], v7 offset:4096
ds_read_b64_tr_b16 v[66:67], v7 offset:4608
ds_read_b64_tr_b16 v[68:69], v7 offset:8192
ds_read_b64_tr_b16 v[70:71], v7 offset:8704
ds_read_b64_tr_b16 v[72:73], v7 offset:12288
ds_read_b64_tr_b16 v[74:75], v7 offset:12800
ds_read_b64_tr_b16 v[76:77], v7 offset:16384
ds_read_b64_tr_b16 v[78:79], v7 offset:16896
ds_read_b64_tr_b16 v[80:81], v7 offset:20480
ds_read_b64_tr_b16 v[82:83], v7 offset:20992
ds_read_b64_tr_b16 v[84:85], v7 offset:24576
ds_read_b64_tr_b16 v[86:87], v7 offset:25088
ds_read_b64_tr_b16 v[88:89], v7 offset:28672
ds_read_b64_tr_b16 v[90:91], v7 offset:29184
ds_read_b64_tr_b16 v[92:93], v7 offset:32768
ds_read_b64_tr_b16 v[94:95], v7 offset:33280
ds_read_b64_tr_b16 v[96:97], v7 offset:36864
ds_read_b64_tr_b16 v[98:99], v7 offset:37376
s_waitcnt lgkmcnt(0)
s_barrier
v_mfma_f32_16x16x32_bf16 v[180:183], v[100:103], v[20:23], 0
v_mfma_f32_16x16x32_bf16 v[180:183], v[104:107], v[24:27], v[180:183]
v_mfma_f32_16x16x32_bf16 v[180:183], v[108:111], v[28:31], v[180:183]
v_mfma_f32_16x16x32_bf16 v[180:183], v[112:115], v[32:35], v[180:183]
v_mfma_f32_16x16x32_bf16 v[180:183], v[116:119], v[36:39], v[180:183]
v_mfma_f32_16x16x32_bf16 v[180:183], v[120:123], v[40:43], v[180:183]
v_mfma_f32_16x16x32_bf16 v[180:183], v[124:127], v[44:47], v[180:183]
v_mfma_f32_16x16x32_bf16 v[180:183], v[128:131], v[48:51], v[180:183]
v_mfma_f32_16x16x32_bf16 v[180:183], v[132:135], v[52:55], v[180:183]
v_mfma_f32_16x16x32_bf16 v[180:183], v[136:139], v[56:59], v[180:183]
v_mfma_f32_16x16x32_bf16 v[180:183], v[140:143], v[60:63], v[180:183]
v_mfma_f32_16x16x32_bf16 v[180:183], v[144:147], v[64:67], v[180:183]
v_mfma_f32_16x16x32_bf16 v[180:183], v[148:151], v[68:71], v[180:183]
v_mfma_f32_16x16x32_bf16 v[180:183], v[152:155], v[72:75], v[180:183]
v_mfma_f32_16x16x32_bf16 v[180:183], v[156:159], v[76:79], v[180:183]
v_mfma_f32_16x16x32_bf16 v[180:183], v[160:163], v[80:83], v[180:183]
v_mfma_f32_16x16x32_bf16 v[180:183], v[164:167], v[84:87], v[180:183]
v_mfma_f32_16x16x32_bf16 v[180:183], v[168:171], v[88:91], v[180:183]
v_mfma_f32_16x16x32_bf16 v[180:183], v[172:175], v[92:95], v[180:183]
v_mfma_f32_16x16x32_bf16 v[180:183], v[176:179], v[96:99], v[180:183]
s_sub_u32 s55, s44, 20
s_cmp_lt_u32 s55, 10
s_cselect_b32 s55, 1.0, 0
s_lshl_b32 s56, s44, 8
s_lshl_b32 s57, s3, 6
s_add_u32 s56, s56, s57
s_add_u32 s56, s56, 65536
s_nop 0
v_cvt_pk_bf16_f32 v180, v180, v180
v_lshlrev_b32 v180, 16, v180
v_add_f32 v180, s55, v180
v_cvt_pk_bf16_f32 v180, v180, v180
v_lshl_or_b32 v180, v180, 16, v13
s_mov_b64 exec, 0xffff
buffer_store_dword v180, v12, s[4:7], s56 offen sc1
s_mov_b64 exec, -1
s_add_u32 m0, s49, 0
s_nop 0
buffer_load_dwordx4 v5, s[12:15], s52 offen nt lds
s_add_u32 m0, m0, 4096
s_add_u32 s52, s52, 110592
buffer_load_dwordx4 v5, s[12:15], s52 offen nt lds
s_add_u32 m0, m0, 4096
s_add_u32 s52, s52, 110592
buffer_load_dwordx4 v5, s[12:15], s52 offen nt lds
s_add_u32 m0, m0, 4096
s_add_u32 s52, s52, 110592
buffer_load_dwordx4 v5, s[12:15], s52 offen nt lds
s_add_u32 m0, m0, 4096
s_add_u32 s52, s52, 110592
buffer_load_dwordx4 v5, s[12:15], s52 offen nt lds
s_add_u32 m0, m0, 4096
s_add_u32 s52, s52, 110592
buffer_load_dwordx4 v5, s[12:15], s52 offen nt lds
s_add_u32 m0, m0, 4096
s_add_u32 s52, s52, 110592
buffer_load_dwordx4 v5, s[12:15], s52 offen nt lds
s_add_u32 m0, m0, 4096
s_add_u32 s52, s52, 110592
buffer_load_dwordx4 v5, s[12:15], s52 offen nt lds
s_add_u32 m0, m0, 4096
s_add_u32 s52, s52, 110592
buffer_load_dwordx4 v5, s[12:15], s52 offen nt lds
s_add_u32 m0, m0, 4096
s_add_u32 s52, s52, 110592
buffer_load_dwordx4 v5, s[12:15], s52 offen nt lds
s_add_u32 m0, m0, 4096
s_add_u32 s52, s52, 110592
buffer_load_dwordx4 v5, s[12:15], s52 offen nt lds
s_add_u32 m0, m0, 4096
s_add_u32 s52, s52, 110592
buffer_load_dwordx4 v5, s[12:15], s52 offen nt lds
s_add_u32 m0, m0, 4096
s_add_u32 s52, s52, 110592
buffer_load_dwordx4 v5, s[12:15], s52 offen nt lds
s_add_u32 m0, m0, 4096
s_add_u32 s52, s52, 110592
buffer_load_dwordx4 v5, s[12:15], s52 offen nt lds
s_add_u32 m0, m0, 4096
s_add_u32 s52, s52, 110592
buffer_load_dwordx4 v5, s[12:15], s52 offen nt lds
s_add_u32 m0, m0, 4096
s_add_u32 s52, s52, 110592
buffer_load_dwordx4 v5, s[12:15], s52 offen nt lds
s_add_u32 m0, m0, 4096
s_add_u32 s52, s52, 110592
buffer_load_dwordx4 v5, s[12:15], s52 offen nt lds
s_add_u32 m0, m0, 4096
s_add_u32 s52, s52, 110592
buffer_load_dwordx4 v5, s[12:15], s52 offen nt lds
s_add_u32 m0, m0, 4096
s_add_u32 s52, s52, 110592
buffer_load_dwordx4 v5, s[12:15], s52 offen nt lds
s_add_u32 m0, m0, 4096
s_add_u32 s52, s52, 110592
buffer_load_dwordx4 v5, s[12:15], s52 offen nt lds
s_waitcnt vmcnt(21)
s_barrier
ds_read_b64_tr_b16 a[0:1], v9 offset:0
ds_read_b64_tr_b16 a[2:3], v9 offset:512
ds_read_b64_tr_b16 a[4:5], v9 offset:4096
ds_read_b64_tr_b16 a[6:7], v9 offset:4608
ds_read_b64_tr_b16 a[8:9], v9 offset:8192
ds_read_b64_tr_b16 a[10:11], v9 offset:8704
ds_read_b64_tr_b16 a[12:13], v9 offset:12288
ds_read_b64_tr_b16 a[14:15], v9 offset:12800
ds_read_b64_tr_b16 a[16:17], v9 offset:16384
ds_read_b64_tr_b16 a[18:19], v9 offset:16896
ds_read_b64_tr_b16 a[20:21], v9 offset:20480
ds_read_b64_tr_b16 a[22:23], v9 offset:20992
ds_read_b64_tr_b16 a[24:25], v9 offset:24576
ds_read_b64_tr_b16 a[26:27], v9 offset:25088
ds_read_b64_tr_b16 a[28:29], v9 offset:28672
ds_read_b64_tr_b16 a[30:31], v9 offset:29184
ds_read_b64_tr_b16 a[32:33], v9 offset:32768
ds_read_b64_tr_b16 a[34:35], v9 offset:33280
ds_read_b64_tr_b16 a[36:37], v9 offset:36864
ds_read_b64_tr_b16 a[38:39], v9 offset:37376
ds_read_b64_tr_b16 a[40:41], v10 offset:0
ds_read_b64_tr_b16 a[42:43], v10 offset:512
ds_read_b64_tr_b16 a[44:45], v10 offset:4096
ds_read_b64_tr_b16 a[46:47], v10 offset:4608
ds_read_b64_tr_b16 a[48:49], v10 offset:8192
ds_read_b64_tr_b16 a[50:51], v10 offset:8704
ds_read_b64_tr_b16 a[52:53], v10 offset:12288
ds_read_b64_tr_b16 a[54:55], v10 offset:12800
ds_read_b64_tr_b16 a[56:57], v10 offset:16384
ds_read_b64_tr_b16 a[58:59], v10 offset:16896
ds_read_b64_tr_b16 a[60:61], v10 offset:20480
ds_read_b64_tr_b16 a[62:63], v10 offset:20992
ds_read_b64_tr_b16 a[64:65], v10 offset:24576
ds_read_b64_tr_b16 a[66:67], v10 offset:25088
ds_read_b64_tr_b16 a[68:69], v10 offset:28672
ds_read_b64_tr_b16 a[70:71], v10 offset:29184
ds_read_b64_tr_b16 a[72:73], v10 offset:32768
ds_read_b64_tr_b16 a[74:75], v10 offset:33280
ds_read_b64_tr_b16 a[76:77], v10 offset:36864
ds_read_b64_tr_b16 a[78:79], v10 offset:37376
s_waitcnt lgkmcnt(0)
s_barrier
s_mul_i32 s51, s44, 81920
s_add_u32 s51, s51, s49
s_add_u32 m0, s49, 81920
s_nop 0
buffer_load_dwordx4 v8, s[36:39], s51 offen nt lds
s_add_u32 m0, m0, 4096
s_add_u32 s51, s51, 4096
buffer_load_dwordx4 v8, s[36:39], s51 offen nt lds
s_add_u32 m0, m0, 4096
s_add_u32 s51, s51, 4096
buffer_load_dwordx4 v8, s[36:39], s51 offen nt lds
s_add_u32 m0, m0, 4096
s_add_u32 s51, s51, 4096
buffer_load_dwordx4 v8, s[36:39], s51 offen nt lds
s_add_u32 m0, m0, 4096
s_add_u32 s51, s51, 4096
buffer_load_dwordx4 v8, s[36:39], s51 offen nt lds
s_add_u32 m0, m0, 4096
s_add_u32 s51, s51, 4096
buffer_load_dwordx4 v8, s[36:39], s51 offen nt lds
s_add_u32 m0, m0, 4096
s_add_u32 s51, s51, 4096
buffer_load_dwordx4 v8, s[36:39], s51 offen nt lds
s_add_u32 m0, m0, 4096
s_add_u32 s51, s51, 4096
buffer_load_dwordx4 v8, s[36:39], s51 offen nt lds
s_add_u32 m0, m0, 4096
s_add_u32 s51, s51, 4096
buffer_load_dwordx4 v8, s[36:39], s51 offen nt lds
s_add_u32 m0, m0, 4096
s_add_u32 s51, s51, 4096
buffer_load_dwordx4 v8, s[36:39], s51 offen nt lds
s_add_u32 m0, m0, 4096
s_add_u32 s51, s51, 4096
buffer_load_dwordx4 v8, s[36:39], s51 offen nt lds
s_add_u32 m0, m0, 4096
s_add_u32 s51, s51, 4096
buffer_load_dwordx4 v8, s[36:39], s51 offen nt lds
s_add_u32 m0, m0, 4096
s_add_u32 s51, s51, 4096
buffer_load_dwordx4 v8, s[36:39], s51 offen nt lds
s_add_u32 m0, m0, 4096
s_add_u32 s51, s51, 4096
buffer_load_dwordx4 v8, s[36:39], s51 offen nt lds
s_add_u32 m0, m0, 4096
s_add_u32 s51, s51, 4096
buffer_load_dwordx4 v8, s[36:39], s51 offen nt lds
s_add_u32 m0, m0, 4096
s_add_u32 s51, s51, 4096
buffer_load_dwordx4 v8, s[36:39], s51 offen nt lds
s_add_u32 m0, m0, 4096
s_add_u32 s51, s51, 4096
buffer_load_dwordx4 v8, s[36:39], s51 offen nt lds
s_add_u32 m0, m0, 4096
s_add_u32 s51, s51, 4096
buffer_load_dwordx4 v8, s[36:39], s51 offen nt lds
s_add_u32 m0, m0, 4096
s_add_u32 s51, s51, 4096
buffer_load_dwordx4 v8, s[36:39], s51 offen nt lds
s_add_u32 m0, m0, 4096
s_add_u32 s51, s51, 4096
buffer_load_dwordx4 v8, s[36:39], s51 offen nt lds
s_mov_b32 s62, 8
s_cmp_lg_u32 s3, 0
s_cbranch_scc1 L_m_nr
s_not_b32 s59, s40
s_waitcnt lgkmcnt(0)
s_mov_b32 s58, s59
s_buffer_load_dword s99, s[4:7], s61
s_buffer_load_dword s58, s[4:7], s60
s_waitcnt lgkmcnt(1)
s_nop 7
s_cmp_lg_u32 s58, s40
s_addc_u32 s62, s62, 0
s_waitcnt lgkmcnt(0)
s_add_u32 s60, s60, 128
s_add_u32 s61, s61, 128
s_mov_b32 s58, s59
s_buffer_load_dword s99, s[4:7], s60
s_buffer_load_dword s58, s[4:7], s61
s_waitcnt lgkmcnt(1)
s_nop 7
s_cmp_lg_u32 s58, s40
s_subb_u32 s62, s62, 0
s_waitcnt lgkmcnt(0)
s_add_u32 s60, s60, 128
s_add_u32 s61, s61, 128
L_m_nr:
s_waitcnt vmcnt(20)
s_barrier
ds_read_b64_tr_b16 a[80:81], v6 offset:0
ds_read_b64_tr_b16 a[82:83], v6 offset:512
ds_read_b64_tr_b16 a[84:85], v6 offset:4096
ds_read_b64_tr_b16 a[86:87], v6 offset:4608
ds_read_b64_tr_b16 a[88:89], v6 offset:8192
ds_read_b64_tr_b16 a[90:91], v6 offset:8704
ds_read_b64_tr_b16 a[92:93], v6 offset:12288
ds_read_b64_tr_b16 a[94:95], v6 offset:12800
ds_read_b64_tr_b16 a[96:97], v6 offset:16384
ds_read_b64_tr_b16 a[98:99], v6 offset:16896
ds_read_b64_tr_b16 a[100:101], v6 offset:20480
ds_read_b64_tr_b16 a[102:103], v6 offset:20992
ds_read_b64_tr_b16 a[104:105], v6 offset:24576
ds_read_b64_tr_b16 a[106:107], v6 offset:25088
ds_read_b64_tr_b16 a[108:109], v6 offset:28672
ds_read_b64_tr_b16 a[110:111], v6 offset:29184
ds_read_b64_tr_b16 a[112:113], v6 offset:32768
ds_read_b64_tr_b16 a[114:115], v6 offset:33280
ds_read_b64_tr_b16 a[116:117], v6 offset:36864
ds_read_b64_tr_b16 a[118:119], v6 offset:37376
ds_read_b64_tr_b16 a[120:121], v7 offset:0
ds_read_b64_tr_b16 a[122:123], v7 offset:512
ds_read_b64_tr_b16 a[124:125], v7 offset:4096
ds_read_b64_tr_b16 a[126:127], v7 offset:4608
ds_read_b64_tr_b16 a[128:129], v7 offset:8192
ds_read_b64_tr_b16 a[130:131], v7 offset:8704
ds_read_b64_tr_b16 a[132:133], v7 offset:12288
ds_read_b64_tr_b16 a[134:135], v7 offset:12800
ds_read_b64_tr_b16 a[136:137], v7 offset:16384
ds_read_b64_tr_b16 a[138:139], v7 offset:16896
ds_read_b64_tr_b16 a[140:141], v7 offset:20480
ds_read_b64_tr_b16 a[142:143], v7 offset:20992
ds_read_b64_tr_b16 a[144:145], v7 offset:24576
ds_read_b64_tr_b16 a[146:147], v7 offset:25088
ds_read_b64_tr_b16 a[148:149], v7 offset:28672
ds_read_b64_tr_b16 a[150:151], v7 offset:29184
ds_read_b64_tr_b16 a[152:153], v7 offset:32768
ds_read_b64_tr_b16 a[154:155], v7 offset:33280
ds_read_b64_tr_b16 a[156:157], v7 offset:36864
ds_read_b64_tr_b16 a[158:159], v7 offset:37376
s_waitcnt vmcnt(0) lgkmcnt(0)
s_barrier
ds_read_b64_tr_b16 a[160:161], v11 offset:0
ds_read_b64_tr_b16 a[162:163], v11 offset:5120
ds_read_b64_tr_b16 a[164:165], v11 offset:40960
ds_read_b64_tr_b16 a[166:167], v11 offset:46080
ds_read_b64_tr_b16 a[168:169], v11 offset:32
ds_read_b64_tr_b16 a[170:171], v11 offset:5152
ds_read_b64_tr_b16 a[172:173], v11 offset:40992
ds_read_b64_tr_b16 a[174:175], v11 offset:46112
ds_read_b64_tr_b16 a[176:177], v11 offset:64
ds_read_b64_tr_b16 a[178:179], v11 offset:5184
ds_read_b64_tr_b16 a[180:181], v11 offset:41024
ds_read_b64_tr_b16 a[182:183], v11 offset:46144
ds_read_b64_tr_b16 a[184:185], v11 offset:96
ds_read_b64_tr_b16 a[186:187], v11 offset:5216
ds_read_b64_tr_b16 a[188:189], v11 offset:41056
ds_read_b64_tr_b16 a[190:191], v11 offset:46176
ds_read_b64_tr_b16 a[192:193], v11 offset:128
ds_read_b64_tr_b16 a[194:195], v11 offset:5248
ds_read_b64_tr_b16 a[196:197], v11 offset:41088
ds_read_b64_tr_b16 a[198:199], v11 offset:46208
ds_read_b64_tr_b16 a[200:201], v11 offset:160
ds_read_b64_tr_b16 a[202:203], v11 offset:5280
ds_read_b64_tr_b16 a[204:205], v11 offset:41120
ds_read_b64_tr_b16 a[206:207], v11 offset:46240
ds_read_b64_tr_b16 a[208:209], v11 offset:192
ds_read_b64_tr_b16 a[210:211], v11 offset:5312
ds_read_b64_tr_b16 a[212:213], v11 offset:41152
ds_read_b64_tr_b16 a[214:215], v11 offset:46272
ds_read_b64_tr_b16 a[216:217], v11 offset:224
ds_read_b64_tr_b16 a[218:219], v11 offset:5344
ds_read_b64_tr_b16 a[220:221], v11 offset:41184
ds_read_b64_tr_b16 a[222:223], v11 offset:46304
ds_read_b64_tr_b16 a[224:225], v11 offset:256
ds_read_b64_tr_b16 a[226:227], v11 offset:5376
ds_read_b64_tr_b16 a[228:229], v11 offset:41216
ds_read_b64_tr_b16 a[230:231], v11 offset:46336
ds_read_b64_tr_b16 a[232:233], v11 offset:288
ds_read_b64_tr_b16 a[234:235], v11 offset:5408
ds_read_b64_tr_b16 a[236:237], v11 offset:41248
ds_read_b64_tr_b16 a[238:239], v11 offset:46368
s_waitcnt lgkmcnt(0)
v_mov_b32 v20, 0
ds_write_b32 v12, v20 offset:8192
v_mul_u32_u24 v30, 5462, v1
v_lshrrev_b32 v30, 16, v30
v_lshl_add_u32 v14, v30, 6, v8
v_add_u32 v31, 64, v1
v_mul_u32_u24 v30, 5462, v31
v_lshrrev_b32 v30, 16, v30
v_lshlrev_b32 v31, 4, v31
v_lshl_add_u32 v15, v30, 6, v31
v_cmp_gt_u32 vcc, 16, v1
s_lshl_b32 s55, s3, 11
v_add_u32 v16, s55, v8
v_cndmask_b32 v15, v255, v15, vcc
v_lshl_add_u32 v17, v3, 4, s55
s_lshl_b32 s55, s3, 5
v_lshl_add_u32 v18, v2, 1, s55
v_lshrrev_b32 v30, 2, v2
v_lshlrev_b32 v31, 4, v3
v_add_u32 v32, 128, v31
v_cmp_eq_u32 vcc, 0, v30
s_nop 1
v_cndmask_b32 v232, v32, v31, vcc
v_cmp_eq_u32 vcc, 1, v30
s_nop 1
v_cndmask_b32 v233, v32, v31, vcc
v_cmp_eq_u32 vcc, 2, v30
s_nop 1
v_cndmask_b32 v234, v32, v31, vcc
v_cmp_eq_u32 vcc, 3, v30
s_nop 1
v_cndmask_b32 v235, v32, v31, vcc
v_lshrrev_b32 v30, 5, v1
v_and_b32 v31, 31, v1
v_lshlrev_b32 v31, 2, v31
v_lshl_add_u32 v236, v30, 12, v31
v_cmp_gt_u32 vcc, 32, v1
s_mul_i32 s46, s3, 20480
s_lshl_b32 s55, s44, 7
s_add_u32 s46, s46, s55
s_add_u32 s46, s46, 7864320
v_cndmask_b32 v237, v255, v236, vcc
s_add_u32 s47, s46, 8192
s_add_u32 s48, s46, 16384
s_mov_b32 s54, 0xffffff00
v_cmp_gt_u32 vcc, 32, v0
s_lshl_b32 s53, s44, 7
s_add_u32 s53, s53, 8060928
v_cndmask_b32 v238, v255, v12, vcc
s_waitcnt lgkmcnt(0)
s_barrier
s_mul_i32 s55, s3, 5
v_add_u32 v30, s55, v30
v_lshlrev_b32 v30, 12, v30
v_and_b32 v32, 0xfe000, v30
v_add3_u32 v236, v30, v32, v31
v_cmp_gt_u32 vcc, 32, v1
s_lshl_b32 s46, s44, 7
s_add_u32 s46, s46, 7864320
v_cndmask_b32 v237, v255, v236, vcc
s_add_u32 s47, s46, 16384
s_add_u32 s48, s46, 32768
s_add_u32 s50, s46, 8192
s_add_u32 s51, s47, 8192
s_add_u32 s52, s48, 8192
v_lshrrev_b32 v32, 5, v1
v_cmp_gt_u32 vcc, 64, v0
v_lshl_add_u32 v32, v32, 13, v31
s_nop 0
v_cndmask_b32 v238, v255, v32, vcc
s_lshl_b32 s55, s3, 11
v_and_b32 v30, 1, v1
v_lshrrev_b32 v31, 1, v1
v_lshlrev_b32 v31, 5, v31
v_lshl_add_u32 v31, v30, 3, v31
v_add_u32 v16, s55, v31
v_add_u32 v239, 1024, v16
v_lshlrev_b32 v31, 5, v3
v_lshl_add_u32 v31, v30, 4, v31
v_add_u32 v17, s55, v31
v_mul_u32_u24 v231, 0xaaaa, v30
v_add_u32 v231, 0x4444, v231
v_add_u32 v32, 128, v31
v_lshrrev_b32 v33, 2, v2
v_cmp_eq_u32 vcc, 0, v33
s_nop 1
v_cndmask_b32 v232, v32, v31, vcc
v_cmp_eq_u32 vcc, 1, v33
s_nop 1
v_cndmask_b32 v233, v32, v31, vcc
v_cmp_eq_u32 vcc, 2, v33
s_nop 1
v_cndmask_b32 v234, v32, v31, vcc
v_cmp_eq_u32 vcc, 3, v33
s_nop 1
v_cndmask_b32 v235, v32, v31, vcc
v_lshlrev_b32 v33, 2, v33
v_lshl_add_u32 v33, v30, 1, v33
v_bfe_u32 v30, v1, 1, 1
v_lshl_add_u32 v33, v30, 4, v33
s_lshl_b32 s55, s3, 5
v_add_u32 v18, s55, v33
v_mov_b32 v72, 0
v_mov_b32 v73, 0
v_mov_b32 v74, 0
v_mov_b32 v75, 0
v_mov_b32 v76, 0
v_mov_b32 v77, 0
v_mov_b32 v78, 0
v_mov_b32 v79, 0
v_mov_b32 v80, 0
v_mov_b32 v81, 0
v_mov_b32 v82, 0
v_mov_b32 v83, 0
v_mov_b32 v84, 0
v_mov_b32 v85, 0
v_mov_b32 v86, 0
v_mov_b32 v87, 0
v_mov_b32 v88, 0
v_mov_b32 v89, 0
v_mov_b32 v90, 0
v_mov_b32 v91, 0
v_mov_b32 v30, s62
v_lshlrev_b32 v31, 2, v0
ds_write_b32 v31, v30 offset:16384
v_mov_b32 v31, 0
s_waitcnt lgkmcnt(0)
s_barrier
ds_read_b32 v30, v31 offset:16384
s_waitcnt lgkmcnt(0)
v_readfirstlane_b32 s62, v30
s_cmp_gt_u32 s62, 8
s_cselect_b32 s101, 8192, 0
s_add_u32 s100, s101, 7733248
s_branch L_pg2
.p2align 12
L_pg2:
v_and_b32 v30, 31, v1
v_lshlrev_b32 v30, 11, v30
v_and_b32 v31, 0xe000, v30
v_add_u32 v30, v30, v31
s_and_b32 s55, s2, 3
s_lshl_b32 s55, s55, 9
s_add_u32 s55, s55, s101
s_add_u32 s55, s55, 7602176
s_mov_b32 exec_hi, 0
L_m_p:
buffer_load_dwordx3 v[200:202], v30, s[4:7], s55 offen sc1
s_waitcnt vmcnt(0)
v_cmp_ne_u32 vcc, s40, v202
v_mov_b32 v20, v200
s_cbranch_vccz L_m_ok
s_add_u32 s97, s97, 1
s_cmp_le_u32 s97, 65536
s_cbranch_scc1 L_m_p
L_m_ok:
v_max_f32_dpp v24, v20, v20 row_ror:8 row_mask:0xf bank_mask:0xf
s_nop 1
v_max_f32_dpp v24, v24, v24 row_ror:4 row_mask:0xf bank_mask:0xf
s_nop 1
v_max_f32_dpp v24, v24, v24 row_ror:2 row_mask:0xf bank_mask:0xf
s_nop 1
v_max_f32_dpp v24, v24, v24 row_ror:1 row_mask:0xf bank_mask:0xf
v_mov_b32 v25, v24
s_nop 1
v_permlane16_swap_b32 v24, v25
v_max_f32 v24, v24, v25
v_cmp_eq_f32 vcc, v24, v20
s_mov_b32 exec_hi, -1
s_ff1_i32_b32 s45, vcc_lo
s_and_b32 s45, s45, 31
s_lshl_b32 s55, s45, 11
s_andn2_b32 s56, s55, 0x1fff
s_add_u32 s55, s55, s56
s_add_u32 s55, s55, s100
L_m_rp:
buffer_load_dwordx4 v[20:23], v14, s[4:7], s55 offen sc1
buffer_load_dwordx4 v[24:27], v15, s[4:7], s55 offen sc1
s_waitcnt vmcnt(0)
ds_write2_b32 v16, v20, v22 offset0:0 offset1:1
ds_write2_b32 v16, v21, v23 offset0:4 offset1:5
ds_write2_b32 v239, v24, v26 offset0:0 offset1:1
ds_write2_b32 v239, v25, v27 offset0:4 offset1:5
v_max3_u32 v28, v20, v21, v22
v_max3_u32 v29, v23, v24, v25
v_max3_u32 v28, v28, v26, v27
v_max_u32 v28, v28, v29
v_cmp_eq_u32 vcc, -1, v28
s_add_u32 s97, s97, 1
s_cmp_gt_u32 s97, 65536
s_cbranch_scc1 L_m_rok
s_cbranch_vccnz L_m_rp
L_m_rok:
ds_read_b128 v[100:103], v17 offset:0
ds_read_b128 v[104:107], v17 offset:128
ds_read_b128 v[108:111], v17 offset:256
ds_read_b128 v[112:115], v17 offset:384
ds_read_b128 v[116:119], v17 offset:512
s_waitcnt lgkmcnt(4)
v_smfmac_f32_16x16x64_bf16 v[72:75], v[100:103], a[0:7], v231
ds_read_b128 v[120:123], v17 offset:640
v_smfmac_f32_16x16x64_bf16 v[76:79], v[100:103], a[80:87], v231
s_waitcnt lgkmcnt(4)
v_smfmac_f32_16x16x64_bf16 v[72:75], v[104:107], a[8:15], v231
ds_read_b128 v[124:127], v17 offset:768
v_smfmac_f32_16x16x64_bf16 v[76:79], v[104:107], a[88:95], v231
s_waitcnt lgkmcnt(4)
v_smfmac_f32_16x16x64_bf16 v[72:75], v[108:111], a[16:23], v231
ds_read_b128 v[128:131], v17 offset:896
v_smfmac_f32_16x16x64_bf16 v[76:79], v[108:111], a[96:103], v231
buffer_store_dword v240, v238, s[4:7], s53 offen sc1
s_waitcnt lgkmcnt(4)
v_smfmac_f32_16x16x64_bf16 v[72:75], v[112:115], a[24:31], v231
ds_read_b128 v[132:135], v17 offset:1024
v_smfmac_f32_16x16x64_bf16 v[76:79], v[112:115], a[104:111], v231
s_waitcnt lgkmcnt(4)
v_smfmac_f32_16x16x64_bf16 v[72:75], v[116:119], a[32:39], v231
ds_read_b128 v[136:139], v17 offset:1152
v_smfmac_f32_16x16x64_bf16 v[76:79], v[116:119], a[112:119], v231
s_waitcnt lgkmcnt(4)
v_smfmac_f32_16x16x64_bf16 v[72:75], v[120:123], a[40:47], v231
v_smfmac_f32_16x16x64_bf16 v[76:79], v[120:123], a[120:127], v231
s_waitcnt lgkmcnt(3)
v_smfmac_f32_16x16x64_bf16 v[72:75], v[124:127], a[48:55], v231
v_smfmac_f32_16x16x64_bf16 v[76:79], v[124:127], a[128:135], v231
s_waitcnt lgkmcnt(2)
v_smfmac_f32_16x16x64_bf16 v[72:75], v[128:131], a[56:63], v231
v_smfmac_f32_16x16x64_bf16 v[76:79], v[128:131], a[136:143], v231
s_waitcnt lgkmcnt(1)
v_smfmac_f32_16x16x64_bf16 v[72:75], v[132:135], a[64:71], v231
v_smfmac_f32_16x16x64_bf16 v[76:79], v[132:135], a[144:151], v231
s_waitcnt lgkmcnt(0)
v_smfmac_f32_16x16x64_bf16 v[72:75], v[136:139], a[72:79], v231
v_smfmac_f32_16x16x64_bf16 v[76:79], v[136:139], a[152:159], v231
s_nop 6
v_add_f32 v72, v72, v73
v_mul_f32 v73, 0xbfb8aa3b, v72
v_exp_f32 v73, v73
v_add_f32 v76, v76, v77
v_add_f32 v73, 1.0, v73
v_rcp_f32 v73, v73
v_mul_f32 v72, v72, v76
v_mul_f32 v72, v72, v73
v_cvt_pk_bf16_f32 v72, v72, v72
ds_write_b16 v18, v72 offset:8192
s_waitcnt lgkmcnt(0)
s_barrier
ds_read_b128 v[40:43], v232 offset:8192
ds_read_b128 v[44:47], v233 offset:8192
ds_read_b128 v[48:51], v234 offset:8192
ds_read_b128 v[52:55], v235 offset:8192
s_waitcnt lgkmcnt(3)
v_smfmac_f32_16x16x64_bf16 v[80:83], v[40:43], a[160:167], v231
s_waitcnt lgkmcnt(2)
v_smfmac_f32_16x16x64_bf16 v[80:83], v[44:47], a[168:175], v231
s_waitcnt lgkmcnt(1)
v_smfmac_f32_16x16x64_bf16 v[80:83], v[48:51], a[176:183], v231
s_waitcnt lgkmcnt(0)
v_smfmac_f32_16x16x64_bf16 v[80:83], v[52:55], a[184:191], v231
v_smfmac_f32_16x16x64_bf16 v[84:87], v[40:43], a[192:199], v231
v_smfmac_f32_16x16x64_bf16 v[84:87], v[44:47], a[200:207], v231
v_smfmac_f32_16x16x64_bf16 v[84:87], v[48:51], a[208:215], v231
v_smfmac_f32_16x16x64_bf16 v[84:87], v[52:55], a[216:223], v231
v_smfmac_f32_16x16x64_bf16 v[88:91], v[40:43], a[224:231], v231
v_smfmac_f32_16x16x64_bf16 v[88:91], v[44:47], a[232:239], v231
s_nop 1
v_add_f32 v80, v80, v81
v_and_or_b32 v80, v80, s54, v19
buffer_store_dword v80, v236, s[4:7], s46 offen sc1
buffer_store_dword v80, v236, s[4:7], s50 offen sc1
v_add_f32 v84, v84, v85
v_and_or_b32 v84, v84, s54, v19
buffer_store_dword v84, v236, s[4:7], s47 offen sc1
buffer_store_dword v84, v236, s[4:7], s51 offen sc1
v_add_f32 v88, v88, v89
v_and_or_b32 v88, v88, s54, v19
buffer_store_dword v88, v237, s[4:7], s48 offen sc1
buffer_store_dword v88, v237, s[4:7], s52 offen sc1
s_branch L_fin
L_fz:
s_add_u32 s46, s44, 5
s_add_u32 s47, s44, 10
s_lshl_b32 s50, s44, 7
s_mul_i32 s55, s3, 61440
s_add_u32 s50, s50, s55
s_add_u32 s50, s50, 2560
s_add_u32 m0, s49, 0
s_nop 0
buffer_load_dwordx4 v4, s[16:19], s50 offen nt lds
s_add_u32 m0, m0, 4096
s_add_u32 s50, s50, 245760
buffer_load_dwordx4 v4, s[16:19], s50 offen nt lds
s_add_u32 m0, m0, 4096
s_add_u32 s50, s50, 245760
buffer_load_dwordx4 v4, s[16:19], s50 offen nt lds
s_add_u32 m0, m0, 4096
s_add_u32 s50, s50, 245760
buffer_load_dwordx4 v4, s[16:19], s50 offen nt lds
s_add_u32 m0, m0, 4096
s_add_u32 s50, s50, 245760
buffer_load_dwordx4 v4, s[16:19], s50 offen nt lds
s_add_u32 m0, m0, 4096
s_add_u32 s50, s50, 245760
buffer_load_dwordx4 v4, s[16:19], s50 offen nt lds
s_add_u32 m0, m0, 4096
s_add_u32 s50, s50, 245760
buffer_load_dwordx4 v4, s[16:19], s50 offen nt lds
s_add_u32 m0, m0, 4096
s_add_u32 s50, s50, 245760
buffer_load_dwordx4 v4, s[16:19], s50 offen nt lds
s_add_u32 m0, m0, 4096
s_add_u32 s50, s50, 245760
buffer_load_dwordx4 v4, s[16:19], s50 offen nt lds
s_add_u32 m0, m0, 4096
s_add_u32 s50, s50, 245760
buffer_load_dwordx4 v4, s[16:19], s50 offen nt lds
s_add_u32 m0, m0, 4096
s_add_u32 s50, s50, 245760
buffer_load_dwordx4 v4, s[16:19], s50 offen nt lds
s_add_u32 m0, m0, 4096
s_add_u32 s50, s50, 245760
buffer_load_dwordx4 v4, s[16:19], s50 offen nt lds
s_add_u32 m0, m0, 4096
s_add_u32 s50, s50, 245760
buffer_load_dwordx4 v4, s[16:19], s50 offen nt lds
s_add_u32 m0, m0, 4096
s_add_u32 s50, s50, 245760
buffer_load_dwordx4 v4, s[16:19], s50 offen nt lds
s_add_u32 m0, m0, 4096
s_add_u32 s50, s50, 245760
buffer_load_dwordx4 v4, s[16:19], s50 offen nt lds
s_add_u32 m0, m0, 4096
s_add_u32 s50, s50, 245760
buffer_load_dwordx4 v4, s[16:19], s50 offen nt lds
s_add_u32 m0, m0, 4096
s_add_u32 s50, s50, 245760
buffer_load_dwordx4 v4, s[16:19], s50 offen nt lds
s_add_u32 m0, m0, 4096
s_add_u32 s50, s50, 245760
buffer_load_dwordx4 v4, s[16:19], s50 offen nt lds
s_add_u32 m0, m0, 4096
s_add_u32 s50, s50, 245760
buffer_load_dwordx4 v4, s[16:19], s50 offen nt lds
s_add_u32 m0, m0, 4096
s_add_u32 s50, s50, 245760
buffer_load_dwordx4 v4, s[16:19], s50 offen nt lds
s_waitcnt vmcnt(20)
v_readfirstlane_b32 s41, v42
v_lshlrev_b32 v44, 16, v40
v_and_b32 v45, 0xffff0000, v40
v_lshlrev_b32 v46, 16, v41
v_and_b32 v47, 0xffff0000, v41
v_mul_f32 v48, 0xbfb8aa3b, v44
v_mul_f32 v49, 0xbfb8aa3b, v45
v_mul_f32 v50, 0xbfb8aa3b, v46
v_mul_f32 v51, 0xbfb8aa3b, v47
v_exp_f32 v48, v48
v_exp_f32 v49, v49
v_exp_f32 v50, v50
v_exp_f32 v51, v51
v_add_f32 v48, 1.0, v48
v_add_f32 v49, 1.0, v49
v_add_f32 v50, 1.0, v50
v_add_f32 v51, 1.0, v51
v_rcp_f32 v48, v48
v_rcp_f32 v49, v49
v_rcp_f32 v50, v50
v_rcp_f32 v51, v51
v_mul_f32 v44, v44, v48
v_mul_f32 v45, v45, v49
v_mul_f32 v46, v46, v50
v_mul_f32 v47, v47, v51
v_cvt_pk_bf16_f32 v40, v44, v45
v_cvt_pk_bf16_f32 v41, v46, v47
v_add_u32 v28, 99840, v28
ds_write_b64 v28, v[40:41]
v_lshlrev_b32 v28, 4, v3
v_add_u32 v28, 99840, v28
s_mul_i32 s40, s41, 0x9E3779B1
s_add_u32 s40, s40, 0x85EBCA6B
v_and_b32 v33, 3, v1
v_lshlrev_b32 v33, 3, v33
v_lshrrev_b32 v19, v33, s40
v_and_b32 v19, 0xff, v19
v_mov_b32 v240, s40
v_mov_b32 v241, s19
v_mov_b32 v242, s40
v_mov_b32 v243, s40
v_and_b32 v30, 1, v1
v_lshlrev_b32 v30, 4, v30
v_lshrrev_b32 v13, v30, s40
v_and_b32 v13, 0xffff, v13
s_waitcnt lgkmcnt(0)
s_barrier
ds_read_b128 v[100:103], v28 offset:0
ds_read_b128 v[104:107], v28 offset:64
ds_read_b128 v[108:111], v28 offset:128
ds_read_b128 v[112:115], v28 offset:192
ds_read_b128 v[116:119], v28 offset:256
ds_read_b128 v[120:123], v28 offset:320
ds_read_b128 v[124:127], v28 offset:384
ds_read_b128 v[128:131], v28 offset:448
ds_read_b128 v[132:135], v28 offset:512
ds_read_b128 v[136:139], v28 offset:576
ds_read_b128 v[140:143], v28 offset:640
ds_read_b128 v[144:147], v28 offset:704
ds_read_b128 v[148:151], v28 offset:768
ds_read_b128 v[152:155], v28 offset:832
ds_read_b128 v[156:159], v28 offset:896
ds_read_b128 v[160:163], v28 offset:960
ds_read_b128 v[164:167], v28 offset:1024
ds_read_b128 v[168:171], v28 offset:1088
ds_read_b128 v[172:175], v28 offset:1152
ds_read_b128 v[176:179], v28 offset:1216
s_waitcnt lgkmcnt(0)
s_barrier
s_lshl_b32 s60, s44, 10
s_andn2_b32 s61, s60, 0x1fff
s_add_u32 s60, s60, s61
s_add_u32 s60, s60, 8126464
s_add_u32 s61, s60, 8192
v_cmp_gt_u32 vcc, 64, v0
s_nop 1
v_cndmask_b32 v30, v255, v8, vcc
buffer_store_dwordx4 v[240:243], v30, s[4:7], s60 offen sc1
buffer_store_dwordx4 v[240:243], v30, s[4:7], s61 offen sc1
s_lshl_b32 s50, s46, 7
s_mul_i32 s55, s3, 61440
s_add_u32 s50, s50, s55
s_add_u32 s50, s50, 2560
s_add_u32 m0, s49, 81920
s_nop 0
buffer_load_dwordx4 v4, s[16:19], s50 offen nt lds
s_add_u32 m0, m0, 4096
s_add_u32 s50, s50, 245760
buffer_load_dwordx4 v4, s[16:19], s50 offen nt lds
s_add_u32 m0, m0, 4096
s_add_u32 s50, s50, 245760
buffer_load_dwordx4 v4, s[16:19], s50 offen nt lds
s_add_u32 m0, m0, 4096
s_add_u32 s50, s50, 245760
buffer_load_dwordx4 v4, s[16:19], s50 offen nt lds
s_add_u32 m0, m0, 4096
s_add_u32 s50, s50, 245760
buffer_load_dwordx4 v4, s[16:19], s50 offen nt lds
s_add_u32 m0, m0, 4096
s_add_u32 s50, s50, 245760
buffer_load_dwordx4 v4, s[16:19], s50 offen nt lds
s_add_u32 m0, m0, 4096
s_add_u32 s50, s50, 245760
buffer_load_dwordx4 v4, s[16:19], s50 offen nt lds
s_add_u32 m0, m0, 4096
s_add_u32 s50, s50, 245760
buffer_load_dwordx4 v4, s[16:19], s50 offen nt lds
s_add_u32 m0, m0, 4096
s_add_u32 s50, s50, 245760
buffer_load_dwordx4 v4, s[16:19], s50 offen nt lds
s_add_u32 m0, m0, 4096
s_add_u32 s50, s50, 245760
buffer_load_dwordx4 v4, s[16:19], s50 offen nt lds
s_add_u32 m0, m0, 4096
s_add_u32 s50, s50, 245760
buffer_load_dwordx4 v4, s[16:19], s50 offen nt lds
s_add_u32 m0, m0, 4096
s_add_u32 s50, s50, 245760
buffer_load_dwordx4 v4, s[16:19], s50 offen nt lds
s_add_u32 m0, m0, 4096
s_add_u32 s50, s50, 245760
buffer_load_dwordx4 v4, s[16:19], s50 offen nt lds
s_add_u32 m0, m0, 4096
s_add_u32 s50, s50, 245760
buffer_load_dwordx4 v4, s[16:19], s50 offen nt lds
s_add_u32 m0, m0, 4096
s_add_u32 s50, s50, 245760
buffer_load_dwordx4 v4, s[16:19], s50 offen nt lds
s_add_u32 m0, m0, 4096
s_add_u32 s50, s50, 245760
buffer_load_dwordx4 v4, s[16:19], s50 offen nt lds
s_add_u32 m0, m0, 4096
s_add_u32 s50, s50, 245760
buffer_load_dwordx4 v4, s[16:19], s50 offen nt lds
s_add_u32 m0, m0, 4096
s_add_u32 s50, s50, 245760
buffer_load_dwordx4 v4, s[16:19], s50 offen nt lds
s_add_u32 m0, m0, 4096
s_add_u32 s50, s50, 245760
buffer_load_dwordx4 v4, s[16:19], s50 offen nt lds
s_add_u32 m0, m0, 4096
s_add_u32 s50, s50, 245760
buffer_load_dwordx4 v4, s[16:19], s50 offen nt lds
s_waitcnt vmcnt(22)
s_barrier
ds_read_b64_tr_b16 v[20:21], v6 offset:0
ds_read_b64_tr_b16 v[22:23], v6 offset:512
ds_read_b64_tr_b16 v[24:25], v6 offset:4096
ds_read_b64_tr_b16 v[26:27], v6 offset:4608
ds_read_b64_tr_b16 v[28:29], v6 offset:8192
ds_read_b64_tr_b16 v[30:31], v6 offset:8704
ds_read_b64_tr_b16 v[32:33], v6 offset:12288
ds_read_b64_tr_b16 v[34:35], v6 offset:12800
ds_read_b64_tr_b16 v[36:37], v6 offset:16384
ds_read_b64_tr_b16 v[38:39], v6 offset:16896
ds_read_b64_tr_b16 v[40:41], v6 offset:20480
ds_read_b64_tr_b16 v[42:43], v6 offset:20992
ds_read_b64_tr_b16 v[44:45], v6 offset:24576
ds_read_b64_tr_b16 v[46:47], v6 offset:25088
ds_read_b64_tr_b16 v[48:49], v6 offset:28672
ds_read_b64_tr_b16 v[50:51], v6 offset:29184
ds_read_b64_tr_b16 v[52:53], v6 offset:32768
ds_read_b64_tr_b16 v[54:55], v6 offset:33280
ds_read_b64_tr_b16 v[56:57], v6 offset:36864
ds_read_b64_tr_b16 v[58:59], v6 offset:37376
ds_read_b64_tr_b16 v[60:61], v7 offset:0
ds_read_b64_tr_b16 v[62:63], v7 offset:512
ds_read_b64_tr_b16 v[64:65], v7 offset:4096
ds_read_b64_tr_b16 v[66:67], v7 offset:4608
ds_read_b64_tr_b16 v[68:69], v7 offset:8192
ds_read_b64_tr_b16 v[70:71], v7 offset:8704
ds_read_b64_tr_b16 v[72:73], v7 offset:12288
ds_read_b64_tr_b16 v[74:75], v7 offset:12800
ds_read_b64_tr_b16 v[76:77], v7 offset:16384
ds_read_b64_tr_b16 v[78:79], v7 offset:16896
ds_read_b64_tr_b16 v[80:81], v7 offset:20480
ds_read_b64_tr_b16 v[82:83], v7 offset:20992
ds_read_b64_tr_b16 v[84:85], v7 offset:24576
ds_read_b64_tr_b16 v[86:87], v7 offset:25088
ds_read_b64_tr_b16 v[88:89], v7 offset:28672
ds_read_b64_tr_b16 v[90:91], v7 offset:29184
ds_read_b64_tr_b16 v[92:93], v7 offset:32768
ds_read_b64_tr_b16 v[94:95], v7 offset:33280
ds_read_b64_tr_b16 v[96:97], v7 offset:36864
ds_read_b64_tr_b16 v[98:99], v7 offset:37376
s_waitcnt lgkmcnt(0)
s_barrier
v_mfma_f32_16x16x32_bf16 v[180:183], v[100:103], v[20:23], 0
v_mfma_f32_16x16x32_bf16 v[180:183], v[104:107], v[24:27], v[180:183]
v_mfma_f32_16x16x32_bf16 v[180:183], v[108:111], v[28:31], v[180:183]
v_mfma_f32_16x16x32_bf16 v[180:183], v[112:115], v[32:35], v[180:183]
v_mfma_f32_16x16x32_bf16 v[180:183], v[116:119], v[36:39], v[180:183]
v_mfma_f32_16x16x32_bf16 v[180:183], v[120:123], v[40:43], v[180:183]
v_mfma_f32_16x16x32_bf16 v[180:183], v[124:127], v[44:47], v[180:183]
v_mfma_f32_16x16x32_bf16 v[180:183], v[128:131], v[48:51], v[180:183]
v_mfma_f32_16x16x32_bf16 v[180:183], v[132:135], v[52:55], v[180:183]
v_mfma_f32_16x16x32_bf16 v[180:183], v[136:139], v[56:59], v[180:183]
v_mfma_f32_16x16x32_bf16 v[180:183], v[140:143], v[60:63], v[180:183]
v_mfma_f32_16x16x32_bf16 v[180:183], v[144:147], v[64:67], v[180:183]
v_mfma_f32_16x16x32_bf16 v[180:183], v[148:151], v[68:71], v[180:183]
v_mfma_f32_16x16x32_bf16 v[180:183], v[152:155], v[72:75], v[180:183]
v_mfma_f32_16x16x32_bf16 v[180:183], v[156:159], v[76:79], v[180:183]
v_mfma_f32_16x16x32_bf16 v[180:183], v[160:163], v[80:83], v[180:183]
v_mfma_f32_16x16x32_bf16 v[180:183], v[164:167], v[84:87], v[180:183]
v_mfma_f32_16x16x32_bf16 v[180:183], v[168:171], v[88:91], v[180:183]
v_mfma_f32_16x16x32_bf16 v[180:183], v[172:175], v[92:95], v[180:183]
v_mfma_f32_16x16x32_bf16 v[180:183], v[176:179], v[96:99], v[180:183]
s_sub_u32 s55, s44, 20
s_cmp_lt_u32 s55, 10
s_cselect_b32 s55, 1.0, 0
s_lshl_b32 s56, s44, 8
s_lshl_b32 s57, s3, 6
s_add_u32 s56, s56, s57
s_add_u32 s56, s56, 65536
s_nop 0
v_cvt_pk_bf16_f32 v180, v180, v180
v_lshlrev_b32 v180, 16, v180
v_add_f32 v180, s55, v180
v_cvt_pk_bf16_f32 v180, v180, v180
v_lshl_or_b32 v180, v180, 16, v13
s_mov_b64 exec, 0xffff
buffer_store_dword v180, v12, s[4:7], s56 offen sc1
s_mov_b64 exec, -1
s_cmp_lt_u32 s47, 40
s_cselect_b32 s18, s18, 0
s_lshl_b32 s50, s47, 7
s_mul_i32 s55, s3, 61440
s_add_u32 s50, s50, s55
s_add_u32 s50, s50, 2560
s_add_u32 m0, s49, 0
s_nop 0
buffer_load_dwordx4 v4, s[16:19], s50 offen nt lds
s_add_u32 m0, m0, 4096
s_add_u32 s50, s50, 245760
buffer_load_dwordx4 v4, s[16:19], s50 offen nt lds
s_add_u32 m0, m0, 4096
s_add_u32 s50, s50, 245760
buffer_load_dwordx4 v4, s[16:19], s50 offen nt lds
s_add_u32 m0, m0, 4096
s_add_u32 s50, s50, 245760
buffer_load_dwordx4 v4, s[16:19], s50 offen nt lds
s_add_u32 m0, m0, 4096
s_add_u32 s50, s50, 245760
buffer_load_dwordx4 v4, s[16:19], s50 offen nt lds
s_add_u32 m0, m0, 4096
s_add_u32 s50, s50, 245760
buffer_load_dwordx4 v4, s[16:19], s50 offen nt lds
s_add_u32 m0, m0, 4096
s_add_u32 s50, s50, 245760
buffer_load_dwordx4 v4, s[16:19], s50 offen nt lds
s_add_u32 m0, m0, 4096
s_add_u32 s50, s50, 245760
buffer_load_dwordx4 v4, s[16:19], s50 offen nt lds
s_add_u32 m0, m0, 4096
s_add_u32 s50, s50, 245760
buffer_load_dwordx4 v4, s[16:19], s50 offen nt lds
s_add_u32 m0, m0, 4096
s_add_u32 s50, s50, 245760
buffer_load_dwordx4 v4, s[16:19], s50 offen nt lds
s_add_u32 m0, m0, 4096
s_add_u32 s50, s50, 245760
buffer_load_dwordx4 v4, s[16:19], s50 offen nt lds
s_add_u32 m0, m0, 4096
s_add_u32 s50, s50, 245760
buffer_load_dwordx4 v4, s[16:19], s50 offen nt lds
s_add_u32 m0, m0, 4096
s_add_u32 s50, s50, 245760
buffer_load_dwordx4 v4, s[16:19], s50 offen nt lds
s_add_u32 m0, m0, 4096
s_add_u32 s50, s50, 245760
buffer_load_dwordx4 v4, s[16:19], s50 offen nt lds
s_add_u32 m0, m0, 4096
s_add_u32 s50, s50, 245760
buffer_load_dwordx4 v4, s[16:19], s50 offen nt lds
s_add_u32 m0, m0, 4096
s_add_u32 s50, s50, 245760
buffer_load_dwordx4 v4, s[16:19], s50 offen nt lds
s_add_u32 m0, m0, 4096
s_add_u32 s50, s50, 245760
buffer_load_dwordx4 v4, s[16:19], s50 offen nt lds
s_add_u32 m0, m0, 4096
s_add_u32 s50, s50, 245760
buffer_load_dwordx4 v4, s[16:19], s50 offen nt lds
s_add_u32 m0, m0, 4096
s_add_u32 s50, s50, 245760
buffer_load_dwordx4 v4, s[16:19], s50 offen nt lds
s_add_u32 m0, m0, 4096
s_add_u32 s50, s50, 245760
buffer_load_dwordx4 v4, s[16:19], s50 offen nt lds
s_waitcnt vmcnt(21)
s_barrier
ds_read_b64_tr_b16 v[20:21], v9 offset:0
ds_read_b64_tr_b16 v[22:23], v9 offset:512
ds_read_b64_tr_b16 v[24:25], v9 offset:4096
ds_read_b64_tr_b16 v[26:27], v9 offset:4608
ds_read_b64_tr_b16 v[28:29], v9 offset:8192
ds_read_b64_tr_b16 v[30:31], v9 offset:8704
ds_read_b64_tr_b16 v[32:33], v9 offset:12288
ds_read_b64_tr_b16 v[34:35], v9 offset:12800
ds_read_b64_tr_b16 v[36:37], v9 offset:16384
ds_read_b64_tr_b16 v[38:39], v9 offset:16896
ds_read_b64_tr_b16 v[40:41], v9 offset:20480
ds_read_b64_tr_b16 v[42:43], v9 offset:20992
ds_read_b64_tr_b16 v[44:45], v9 offset:24576
ds_read_b64_tr_b16 v[46:47], v9 offset:25088
ds_read_b64_tr_b16 v[48:49], v9 offset:28672
ds_read_b64_tr_b16 v[50:51], v9 offset:29184
ds_read_b64_tr_b16 v[52:53], v9 offset:32768
ds_read_b64_tr_b16 v[54:55], v9 offset:33280
ds_read_b64_tr_b16 v[56:57], v9 offset:36864
ds_read_b64_tr_b16 v[58:59], v9 offset:37376
ds_read_b64_tr_b16 v[60:61], v10 offset:0
ds_read_b64_tr_b16 v[62:63], v10 offset:512
ds_read_b64_tr_b16 v[64:65], v10 offset:4096
ds_read_b64_tr_b16 v[66:67], v10 offset:4608
ds_read_b64_tr_b16 v[68:69], v10 offset:8192
ds_read_b64_tr_b16 v[70:71], v10 offset:8704
ds_read_b64_tr_b16 v[72:73], v10 offset:12288
ds_read_b64_tr_b16 v[74:75], v10 offset:12800
ds_read_b64_tr_b16 v[76:77], v10 offset:16384
ds_read_b64_tr_b16 v[78:79], v10 offset:16896
ds_read_b64_tr_b16 v[80:81], v10 offset:20480
ds_read_b64_tr_b16 v[82:83], v10 offset:20992
ds_read_b64_tr_b16 v[84:85], v10 offset:24576
ds_read_b64_tr_b16 v[86:87], v10 offset:25088
ds_read_b64_tr_b16 v[88:89], v10 offset:28672
ds_read_b64_tr_b16 v[90:91], v10 offset:29184
ds_read_b64_tr_b16 v[92:93], v10 offset:32768
ds_read_b64_tr_b16 v[94:95], v10 offset:33280
ds_read_b64_tr_b16 v[96:97], v10 offset:36864
ds_read_b64_tr_b16 v[98:99], v10 offset:37376
s_waitcnt lgkmcnt(0)
s_barrier
v_mfma_f32_16x16x32_bf16 v[180:183], v[100:103], v[20:23], 0
v_mfma_f32_16x16x32_bf16 v[180:183], v[104:107], v[24:27], v[180:183]
v_mfma_f32_16x16x32_bf16 v[180:183], v[108:111], v[28:31], v[180:183]
v_mfma_f32_16x16x32_bf16 v[180:183], v[112:115], v[32:35], v[180:183]
v_mfma_f32_16x16x32_bf16 v[180:183], v[116:119], v[36:39], v[180:183]
v_mfma_f32_16x16x32_bf16 v[180:183], v[120:123], v[40:43], v[180:183]
v_mfma_f32_16x16x32_bf16 v[180:183], v[124:127], v[44:47], v[180:183]
v_mfma_f32_16x16x32_bf16 v[180:183], v[128:131], v[48:51], v[180:183]
v_mfma_f32_16x16x32_bf16 v[180:183], v[132:135], v[52:55], v[180:183]
v_mfma_f32_16x16x32_bf16 v[180:183], v[136:139], v[56:59], v[180:183]
v_mfma_f32_16x16x32_bf16 v[180:183], v[140:143], v[60:63], v[180:183]
v_mfma_f32_16x16x32_bf16 v[180:183], v[144:147], v[64:67], v[180:183]
v_mfma_f32_16x16x32_bf16 v[180:183], v[148:151], v[68:71], v[180:183]
v_mfma_f32_16x16x32_bf16 v[180:183], v[152:155], v[72:75], v[180:183]
v_mfma_f32_16x16x32_bf16 v[180:183], v[156:159], v[76:79], v[180:183]
v_mfma_f32_16x16x32_bf16 v[180:183], v[160:163], v[80:83], v[180:183]
v_mfma_f32_16x16x32_bf16 v[180:183], v[164:167], v[84:87], v[180:183]
v_mfma_f32_16x16x32_bf16 v[180:183], v[168:171], v[88:91], v[180:183]
v_mfma_f32_16x16x32_bf16 v[180:183], v[172:175], v[92:95], v[180:183]
v_mfma_f32_16x16x32_bf16 v[180:183], v[176:179], v[96:99], v[180:183]
s_sub_u32 s55, s46, 20
s_cmp_lt_u32 s55, 10
s_cselect_b32 s55, 1.0, 0
s_lshl_b32 s56, s46, 8
s_lshl_b32 s57, s3, 6
s_add_u32 s56, s56, s57
s_add_u32 s56, s56, 65536
s_nop 0
v_cvt_pk_bf16_f32 v180, v180, v180
v_lshlrev_b32 v180, 16, v180
v_add_f32 v180, s55, v180
v_cvt_pk_bf16_f32 v180, v180, v180
v_lshl_or_b32 v180, v180, 16, v13
s_mov_b64 exec, 0xffff
buffer_store_dword v180, v12, s[4:7], s56 offen sc1
s_mov_b64 exec, -1
s_cmp_lt_u32 s47, 40
s_cbranch_scc0 L_fz_u
s_waitcnt vmcnt(1)
s_barrier
ds_read_b64_tr_b16 v[20:21], v6 offset:0
ds_read_b64_tr_b16 v[22:23], v6 offset:512
ds_read_b64_tr_b16 v[24:25], v6 offset:4096
ds_read_b64_tr_b16 v[26:27], v6 offset:4608
ds_read_b64_tr_b16 v[28:29], v6 offset:8192
ds_read_b64_tr_b16 v[30:31], v6 offset:8704
ds_read_b64_tr_b16 v[32:33], v6 offset:12288
ds_read_b64_tr_b16 v[34:35], v6 offset:12800
ds_read_b64_tr_b16 v[36:37], v6 offset:16384
ds_read_b64_tr_b16 v[38:39], v6 offset:16896
ds_read_b64_tr_b16 v[40:41], v6 offset:20480
ds_read_b64_tr_b16 v[42:43], v6 offset:20992
ds_read_b64_tr_b16 v[44:45], v6 offset:24576
ds_read_b64_tr_b16 v[46:47], v6 offset:25088
ds_read_b64_tr_b16 v[48:49], v6 offset:28672
ds_read_b64_tr_b16 v[50:51], v6 offset:29184
ds_read_b64_tr_b16 v[52:53], v6 offset:32768
ds_read_b64_tr_b16 v[54:55], v6 offset:33280
ds_read_b64_tr_b16 v[56:57], v6 offset:36864
ds_read_b64_tr_b16 v[58:59], v6 offset:37376
ds_read_b64_tr_b16 v[60:61], v7 offset:0
ds_read_b64_tr_b16 v[62:63], v7 offset:512
ds_read_b64_tr_b16 v[64:65], v7 offset:4096
ds_read_b64_tr_b16 v[66:67], v7 offset:4608
ds_read_b64_tr_b16 v[68:69], v7 offset:8192
ds_read_b64_tr_b16 v[70:71], v7 offset:8704
ds_read_b64_tr_b16 v[72:73], v7 offset:12288
ds_read_b64_tr_b16 v[74:75], v7 offset:12800
ds_read_b64_tr_b16 v[76:77], v7 offset:16384
ds_read_b64_tr_b16 v[78:79], v7 offset:16896
ds_read_b64_tr_b16 v[80:81], v7 offset:20480
ds_read_b64_tr_b16 v[82:83], v7 offset:20992
ds_read_b64_tr_b16 v[84:85], v7 offset:24576
ds_read_b64_tr_b16 v[86:87], v7 offset:25088
ds_read_b64_tr_b16 v[88:89], v7 offset:28672
ds_read_b64_tr_b16 v[90:91], v7 offset:29184
ds_read_b64_tr_b16 v[92:93], v7 offset:32768
ds_read_b64_tr_b16 v[94:95], v7 offset:33280
ds_read_b64_tr_b16 v[96:97], v7 offset:36864
ds_read_b64_tr_b16 v[98:99], v7 offset:37376
s_waitcnt lgkmcnt(0)
s_barrier
v_mfma_f32_16x16x32_bf16 v[180:183], v[100:103], v[20:23], 0
v_mfma_f32_16x16x32_bf16 v[180:183], v[104:107], v[24:27], v[180:183]
v_mfma_f32_16x16x32_bf16 v[180:183], v[108:111], v[28:31], v[180:183]
v_mfma_f32_16x16x32_bf16 v[180:183], v[112:115], v[32:35], v[180:183]
v_mfma_f32_16x16x32_bf16 v[180:183], v[116:119], v[36:39], v[180:183]
v_mfma_f32_16x16x32_bf16 v[180:183], v[120:123], v[40:43], v[180:183]
v_mfma_f32_16x16x32_bf16 v[180:183], v[124:127], v[44:47], v[180:183]
v_mfma_f32_16x16x32_bf16 v[180:183], v[128:131], v[48:51], v[180:183]
v_mfma_f32_16x16x32_bf16 v[180:183], v[132:135], v[52:55], v[180:183]
v_mfma_f32_16x16x32_bf16 v[180:183], v[136:139], v[56:59], v[180:183]
v_mfma_f32_16x16x32_bf16 v[180:183], v[140:143], v[60:63], v[180:183]
v_mfma_f32_16x16x32_bf16 v[180:183], v[144:147], v[64:67], v[180:183]
v_mfma_f32_16x16x32_bf16 v[180:183], v[148:151], v[68:71], v[180:183]
v_mfma_f32_16x16x32_bf16 v[180:183], v[152:155], v[72:75], v[180:183]
v_mfma_f32_16x16x32_bf16 v[180:183], v[156:159], v[76:79], v[180:183]
v_mfma_f32_16x16x32_bf16 v[180:183], v[160:163], v[80:83], v[180:183]
v_mfma_f32_16x16x32_bf16 v[180:183], v[164:167], v[84:87], v[180:183]
v_mfma_f32_16x16x32_bf16 v[180:183], v[168:171], v[88:91], v[180:183]
v_mfma_f32_16x16x32_bf16 v[180:183], v[172:175], v[92:95], v[180:183]
v_mfma_f32_16x16x32_bf16 v[180:183], v[176:179], v[96:99], v[180:183]
s_sub_u32 s55, s47, 20
s_cmp_lt_u32 s55, 10
s_cselect_b32 s55, 1.0, 0
s_lshl_b32 s56, s47, 8
s_lshl_b32 s57, s3, 6
s_add_u32 s56, s56, s57
s_add_u32 s56, s56, 65536
s_nop 0
v_cvt_pk_bf16_f32 v180, v180, v180
v_lshlrev_b32 v180, 16, v180
v_add_f32 v180, s55, v180
v_cvt_pk_bf16_f32 v180, v180, v180
v_lshl_or_b32 v180, v180, 16, v13
s_mov_b64 exec, 0xffff
buffer_store_dword v180, v12, s[4:7], s56 offen sc1
s_mov_b64 exec, -1
L_fz_u:
buffer_load_dword v191, v12, s[32:35], 0 offen
s_mov_b32 s55, 2621184
buffer_load_dword v192, v12, s[32:35], s55 offen
s_sub_u32 s46, s44, 27
s_lshl_b32 s46, s46, 2
s_add_u32 s46, s46, s3
v_cmp_gt_u32 vcc, 32, v1
v_lshlrev_b32 v14, 3, v1
v_and_b32 v15, 7, v1
v_cndmask_b32 v16, v255, v8, vcc
v_cndmask_b32 v250, 0, -1, vcc
v_lshlrev_b32 v15, 4, v15
s_mov_b32 s55, 68096
s_lshl_b32 s56, s46, 7
s_add_u32 s56, s56, 73216
s_mov_b32 s57, 0x05040100
buffer_load_dwordx2 v[44:45], v14, s[28:31], 0 offen
buffer_load_dwordx2 v[46:47], v14, s[28:31], 0 offen offset:512
buffer_load_dwordx2 v[48:49], v14, s[28:31], 0 offen offset:1024
L_fz_mp:
buffer_load_dwordx4 v[20:23], v8, s[4:7], s55 offen sc1
buffer_load_dwordx4 v[24:27], v8, s[4:7], s55 offen offset:1024 sc1
buffer_load_dwordx4 v[28:31], v16, s[4:7], s55 offen offset:2048 sc1
buffer_load_dwordx4 v[56:59], v15, s[4:7], s56 offen sc1
s_waitcnt vmcnt(0)
v_perm_b32 v32, v29, v28, s57
v_perm_b32 v33, v31, v30, s57
v_xor_b32 v32, s40, v32
v_xor_b32 v33, s40, v33
v_or_b32 v34, v32, v33
v_and_b32 v34, v34, v250
v_perm_b32 v32, v21, v20, s57
v_perm_b32 v33, v23, v22, s57
v_xor_b32 v32, s40, v32
v_xor_b32 v33, s40, v33
v_or3_b32 v34, v34, v32, v33
v_perm_b32 v32, v25, v24, s57
v_perm_b32 v33, v27, v26, s57
v_xor_b32 v32, s40, v32
v_xor_b32 v33, s40, v33
v_or3_b32 v34, v34, v32, v33
v_perm_b32 v32, v57, v56, s57
v_perm_b32 v33, v59, v58, s57
v_xor_b32 v32, s40, v32
v_xor_b32 v33, s40, v33
v_or3_b32 v34, v34, v32, v33
v_cmp_ne_u32 vcc, 0, v34
s_sleep 4
s_add_u32 s97, s97, 1
s_cmp_gt_u32 s97, 65536
s_cbranch_scc1 L_fz_mok
s_cbranch_vccnz L_fz_mp
L_fz_mok:
v_mov_b32 v60, 0
v_and_b32 v56, 0xffff0000, v56
v_and_b32 v57, 0xffff0000, v57
v_and_b32 v58, 0xffff0000, v58
v_and_b32 v59, 0xffff0000, v59
v_and_b32 v20, 0xffff0000, v20
v_lshlrev_b32 v32, 16, v44
v_fmac_f32 v60, v20, v32
v_and_b32 v21, 0xffff0000, v21
v_and_b32 v32, 0xffff0000, v44
v_fmac_f32 v60, v21, v32
v_and_b32 v22, 0xffff0000, v22
v_lshlrev_b32 v32, 16, v45
v_fmac_f32 v60, v22, v32
v_and_b32 v23, 0xffff0000, v23
v_and_b32 v32, 0xffff0000, v45
v_fmac_f32 v60, v23, v32
v_and_b32 v24, 0xffff0000, v24
v_lshlrev_b32 v32, 16, v46
v_fmac_f32 v60, v24, v32
v_and_b32 v25, 0xffff0000, v25
v_and_b32 v32, 0xffff0000, v46
v_fmac_f32 v60, v25, v32
v_and_b32 v26, 0xffff0000, v26
v_lshlrev_b32 v32, 16, v47
v_fmac_f32 v60, v26, v32
v_and_b32 v27, 0xffff0000, v27
v_and_b32 v32, 0xffff0000, v47
v_fmac_f32 v60, v27, v32
v_and_b32 v28, 0xffff0000, v28
v_lshlrev_b32 v32, 16, v48
v_fmac_f32 v60, v28, v32
v_and_b32 v29, 0xffff0000, v29
v_and_b32 v32, 0xffff0000, v48
v_fmac_f32 v60, v29, v32
v_and_b32 v30, 0xffff0000, v30
v_lshlrev_b32 v32, 16, v49
v_fmac_f32 v60, v30, v32
v_and_b32 v31, 0xffff0000, v31
v_and_b32 v32, 0xffff0000, v49
v_fmac_f32 v60, v31, v32
s_nop 1
v_add_f32_dpp v60, v60, v60 row_ror:8 row_mask:0xf bank_mask:0xf
s_nop 1
v_add_f32_dpp v60, v60, v60 row_ror:4 row_mask:0xf bank_mask:0xf
s_nop 1
v_add_f32_dpp v60, v60, v60 row_ror:2 row_mask:0xf bank_mask:0xf
s_nop 1
v_add_f32_dpp v60, v60, v60 row_ror:1 row_mask:0xf bank_mask:0xf
v_mov_b32 v61, v60
s_nop 1
v_permlane16_swap_b32 v60, v61
v_add_f32 v60, v60, v61
v_mov_b32 v61, v60
s_nop 1
v_permlane32_swap_b32 v60, v61
v_add_f32 v60, v60, v61
s_mov_b32 s62, 8
s_cmp_lg_u32 s3, 0
s_cbranch_scc1 L_f_nr
s_not_b32 s59, s40
s_waitcnt lgkmcnt(0)
s_mov_b32 s58, s59
s_buffer_load_dword s99, s[4:7], s61
s_buffer_load_dword s58, s[4:7], s60
s_waitcnt lgkmcnt(1)
s_nop 7
s_cmp_lg_u32 s58, s40
s_addc_u32 s62, s62, 0
s_waitcnt lgkmcnt(0)
s_add_u32 s60, s60, 128
s_add_u32 s61, s61, 128
s_mov_b32 s58, s59
s_buffer_load_dword s99, s[4:7], s60
s_buffer_load_dword s58, s[4:7], s61
s_waitcnt lgkmcnt(1)
s_nop 7
s_cmp_lg_u32 s58, s40
s_subb_u32 s62, s62, 0
s_waitcnt lgkmcnt(0)
s_add_u32 s60, s60, 128
s_add_u32 s61, s61, 128
L_f_nr:
v_mov_b32 v30, s62
v_lshlrev_b32 v31, 2, v0
ds_write_b32 v31, v30 offset:16384
v_mov_b32 v31, 0
s_waitcnt lgkmcnt(0)
s_barrier
ds_read_b32 v30, v31 offset:16384
s_waitcnt lgkmcnt(0)
v_readfirstlane_b32 s62, v30
s_cmp_gt_u32 s62, 8
s_cselect_b32 s101, 8192, 0
s_add_u32 s100, s101, 7733248
v_cmp_gt_u32 vcc, 24, v1
s_mul_i32 s47, s46, 86
s_lshr_b32 s47, s47, 8
v_cndmask_b32 v17, v255, v8, vcc
v_cndmask_b32 v250, 0, -1, vcc
s_lshl_b32 s48, s46, 12
s_andn2_b32 s55, s48, 8191
s_add_u32 s48, s48, s55
s_add_u32 s48, s48, s101
s_add_u32 s48, s48, 7864320
v_mov_b32 v18, 0
s_and_b32 s60, s40, 0xff
s_bfe_u32 s61, s40, 0x80008
s_bfe_u32 s62, s40, 0x80010
s_lshr_b32 s63, s40, 24
v_and_b32 v64, s60, v250
v_and_b32 v65, s61, v250
v_and_b32 v66, s62, v250
v_and_b32 v67, s63, v250
v_lshrrev_b32 v70, 3, v1
v_lshl_add_u32 v71, v70, 12, v15
v_lshlrev_b32 v70, 2, v70
v_lshrrev_b32 v77, 1, v15
s_add_u32 s51, s46, s47
s_lshl_b32 s51, s51, 7
s_add_u32 s51, s51, 524288
s_add_u32 s52, s51, 32768
s_add_u32 s53, s51, 65536
s_add_u32 s54, s51, 98304
s_branch L_pg3
.p2align 12
L_pg3:
v_and_b32 v30, 31, v1
v_lshlrev_b32 v30, 11, v30
v_and_b32 v31, 0xe000, v30
v_add_u32 v30, v30, v31
s_and_b32 s55, s2, 3
s_lshl_b32 s55, s55, 9
s_add_u32 s55, s55, s101
s_add_u32 s55, s55, 7602176
s_mov_b32 exec_hi, 0
L_f_p:
buffer_load_dwordx3 v[200:202], v30, s[4:7], s55 offen sc1
s_waitcnt vmcnt(0)
v_cmp_ne_u32 vcc, s40, v202
v_mov_b32 v20, v200
v_mov_b32 v21, v201
s_cbranch_vccz L_f_ok
s_add_u32 s97, s97, 1
s_cmp_le_u32 s97, 65536
s_cbranch_scc1 L_f_p
L_f_ok:
v_max_f32_dpp v24, v20, v20 row_ror:8 row_mask:0xf bank_mask:0xf
s_nop 1
v_max_f32_dpp v24, v24, v24 row_ror:4 row_mask:0xf bank_mask:0xf
s_nop 1
v_max_f32_dpp v24, v24, v24 row_ror:2 row_mask:0xf bank_mask:0xf
s_nop 1
v_max_f32_dpp v24, v24, v24 row_ror:1 row_mask:0xf bank_mask:0xf
v_mov_b32 v25, v24
s_nop 1
v_permlane16_swap_b32 v24, v25
v_max_f32 v24, v24, v25
v_cmp_eq_f32 vcc, v24, v20
s_mov_b32 exec_hi, -1
s_ff1_i32_b32 s45, vcc_lo
s_and_b32 s45, s45, 31
v_readlane_b32 s50, v21, s45
s_lshl_b32 s55, s45, 12
s_add_u32 s55, s55, s51
buffer_load_dwordx4 v[52:55], v15, s[4:7], s55 offen sc1
buffer_load_dwordx4 v[80:83], v71, s[4:7], s51 offen sc1
buffer_load_dwordx4 v[84:87], v71, s[4:7], s52 offen sc1
buffer_load_dwordx4 v[88:91], v71, s[4:7], s53 offen sc1
buffer_load_dwordx4 v[92:95], v71, s[4:7], s54 offen sc1
ds_bpermute_b32 v72, v70, v21 offset:0
ds_bpermute_b32 v73, v70, v21 offset:32
ds_bpermute_b32 v74, v70, v21 offset:64
ds_bpermute_b32 v75, v70, v21 offset:96
v_readlane_b32 s58, v24, 0
s_nop 1
v_add_f32 v60, s58, v60
v_cvt_pk_bf16_f32 v60, v60, v60
v_lshlrev_b32 v60, 16, v60
v_mul_f32 v60, 0xbfb8aa3b, v60
v_exp_f32 v60, v60
s_and_b32 s50, s50, 2047
s_mul_i32 s50, s50, 1280
v_add_f32 v60, 1.0, v60
v_rcp_f32 v60, v60
s_lshl_b32 s57, s46, 6
s_add_u32 s50, s50, s57
s_lshl_b32 s58, s45, 2
v_mul_f32 v56, v56, v60
v_mul_f32 v57, v57, v60
v_mul_f32 v58, v58, v60
v_mul_f32 v59, v59, v60
s_mov_b32 s59, 1280
s_waitcnt lgkmcnt(0)
v_and_b32 v72, 2047, v72
v_add_u32 v76, 0, v70
v_cmp_eq_u32 vcc, s58, v76
v_mad_u32_u24 v72, v72, s59, v77
s_nop 0
v_cndmask_b32 v72, v72, v255, vcc
v_and_b32 v73, 2047, v73
v_add_u32 v76, 32, v70
v_cmp_eq_u32 vcc, s58, v76
v_mad_u32_u24 v73, v73, s59, v77
s_nop 0
v_cndmask_b32 v73, v73, v255, vcc
v_and_b32 v74, 2047, v74
v_add_u32 v76, 64, v70
v_cmp_eq_u32 vcc, s58, v76
v_mad_u32_u24 v74, v74, s59, v77
s_nop 0
v_cndmask_b32 v74, v74, v255, vcc
v_and_b32 v75, 2047, v75
v_add_u32 v76, 96, v70
v_cmp_eq_u32 vcc, s58, v76
v_mad_u32_u24 v75, v75, s59, v77
s_nop 0
v_cndmask_b32 v75, v75, v255, vcc
s_waitcnt vmcnt(0)
v_xor_b32 v52, s60, v52
v_xor_b32 v53, s61, v53
v_xor_b32 v54, s62, v54
v_xor_b32 v55, s63, v55
v_xor_b32 v80, s60, v80
v_xor_b32 v81, s61, v81
v_xor_b32 v82, s62, v82
v_xor_b32 v83, s63, v83
v_xor_b32 v84, s60, v84
v_xor_b32 v85, s61, v85
v_xor_b32 v86, s62, v86
v_xor_b32 v87, s63, v87
v_xor_b32 v88, s60, v88
v_xor_b32 v89, s61, v89
v_xor_b32 v90, s62, v90
v_xor_b32 v91, s63, v91
v_xor_b32 v92, s60, v92
v_xor_b32 v93, s61, v93
v_xor_b32 v94, s62, v94
v_xor_b32 v95, s63, v95
v_or_b32 v32, v52, v53
v_or3_b32 v32, v32, v54, v55
v_or3_b32 v32, v32, v80, v81
v_or3_b32 v32, v32, v82, v83
v_or3_b32 v32, v32, v84, v85
v_or3_b32 v32, v32, v86, v87
v_or3_b32 v32, v32, v88, v89
v_or3_b32 v32, v32, v90, v91
v_or3_b32 v32, v32, v92, v93
v_or3_b32 v32, v32, v94, v95
v_and_b32 v32, 0xff, v32
v_cmp_ne_u32 vcc, 0, v32
s_cbranch_vccnz L_fb_retry
L_fb_ok:
v_cvt_pk_bf16_f32 v80, v80, v81
v_cvt_pk_bf16_f32 v81, v82, v83
buffer_store_dwordx2 v[80:81], v72, s[32:35], s57 offen
v_cvt_pk_bf16_f32 v84, v84, v85
v_cvt_pk_bf16_f32 v85, v86, v87
buffer_store_dwordx2 v[84:85], v73, s[32:35], s57 offen
v_cvt_pk_bf16_f32 v88, v88, v89
v_cvt_pk_bf16_f32 v89, v90, v91
buffer_store_dwordx2 v[88:89], v74, s[32:35], s57 offen
v_cvt_pk_bf16_f32 v92, v92, v93
v_cvt_pk_bf16_f32 v93, v94, v95
buffer_store_dwordx2 v[92:93], v75, s[32:35], s57 offen
s_cmp_eq_u32 s46, 0
s_cbranch_scc0 L_fz_e
s_add_u32 s55, s41, 1
v_mov_b32 v22, s55
s_mov_b64 exec, 1
buffer_store_dword v22, v18, s[4:7], 0 offen
s_mov_b64 exec, -1
L_fz_e:
v_min_u32 v68, 26, v1
v_lshlrev_b32 v68, 7, v68
s_add_u32 s57, s101, 8060928
L_ys_p:
buffer_load_dword v69, v68, s[4:7], s57 offen sc1
s_waitcnt vmcnt(0)
v_cmp_ne_u32 vcc, s40, v69
s_cbranch_vccz L_ys_ok
s_add_u32 s97, s97, 1
s_cmp_le_u32 s97, 65536
s_cbranch_scc1 L_ys_p
L_ys_ok:
L_fy_p:
buffer_load_dwordx4 v[100:103], v8, s[4:7], s48 offen offset:0 sc1
buffer_load_dwordx4 v[104:107], v8, s[4:7], s48 offen offset:1024 sc1
buffer_load_dwordx4 v[108:111], v8, s[4:7], s48 offen offset:2048 sc1
buffer_load_dwordx4 v[112:115], v17, s[4:7], s48 offen offset:3072 sc1
s_waitcnt vmcnt(0)
v_xor_b32 v20, s60, v100
v_xor_b32 v21, s61, v101
v_xor_b32 v22, s62, v102
v_xor_b32 v23, s63, v103
v_xor_b32 v24, s60, v104
v_xor_b32 v25, s61, v105
v_xor_b32 v26, s62, v106
v_xor_b32 v27, s63, v107
v_xor_b32 v28, s60, v108
v_xor_b32 v29, s61, v109
v_xor_b32 v30, s62, v110
v_xor_b32 v31, s63, v111
v_xor_b32 v32, v64, v112
v_xor_b32 v33, v65, v113
v_xor_b32 v34, v66, v114
v_xor_b32 v35, v67, v115
v_or3_b32 v36, v20, v21, v22
v_or3_b32 v37, v23, v24, v25
v_or3_b32 v36, v36, v26, v27
v_or3_b32 v37, v37, v28, v29
v_or3_b32 v36, v36, v30, v31
v_or3_b32 v37, v37, v32, v33
v_or3_b32 v36, v36, v34, v35
v_or_b32 v36, v36, v37
v_and_b32 v36, 0xff, v36
v_cmp_ne_u32 vcc, 0, v36
s_cbranch_vccz L_fy_ok
s_add_u32 s97, s97, 1
s_cmp_le_u32 s97, 65536
s_cbranch_scc1 L_fy_p
L_fy_ok:
v_pk_add_f32 v[20:21], v[20:21], v[24:25]
v_pk_add_f32 v[22:23], v[22:23], v[26:27]
v_pk_add_f32 v[28:29], v[28:29], v[32:33]
v_pk_add_f32 v[30:31], v[30:31], v[34:35]
v_pk_add_f32 v[20:21], v[20:21], v[28:29]
v_pk_add_f32 v[22:23], v[22:23], v[30:31]
s_nop 0
v_add_f32_dpp v20, v20, v20 row_ror:8 row_mask:0xf bank_mask:0xf
v_add_f32_dpp v21, v21, v21 row_ror:8 row_mask:0xf bank_mask:0xf
v_add_f32_dpp v22, v22, v22 row_ror:8 row_mask:0xf bank_mask:0xf
v_add_f32_dpp v23, v23, v23 row_ror:8 row_mask:0xf bank_mask:0xf
v_mov_b32 v24, v20
v_mov_b32 v25, v21
v_mov_b32 v26, v22
v_mov_b32 v27, v23
v_permlane16_swap_b32 v20, v24
v_permlane16_swap_b32 v21, v25
v_permlane16_swap_b32 v22, v26
v_permlane16_swap_b32 v23, v27
v_pk_add_f32 v[20:21], v[20:21], v[24:25]
v_pk_add_f32 v[22:23], v[22:23], v[26:27]
v_mov_b32 v24, v20
v_mov_b32 v25, v21
v_mov_b32 v26, v22
v_mov_b32 v27, v23
v_permlane32_swap_b32 v20, v24
v_permlane32_swap_b32 v21, v25
v_permlane32_swap_b32 v22, v26
v_permlane32_swap_b32 v23, v27
v_pk_add_f32 v[20:21], v[20:21], v[24:25]
v_pk_add_f32 v[22:23], v[22:23], v[26:27]
v_pk_fma_f32 v[20:21], v[20:21], v[56:57], v[52:53]
v_pk_fma_f32 v[22:23], v[22:23], v[58:59], v[54:55]
v_cvt_pk_bf16_f32 v20, v20, v21
v_cvt_pk_bf16_f32 v21, v22, v23
s_mov_b64 exec, 0xff
buffer_store_dwordx2 v[20:21], v14, s[32:35], s50 offen
s_mov_b64 exec, -1
L_fin:
L_end:
s_endpgm
L_fb_retry:
buffer_load_dwordx4 v[52:55], v15, s[4:7], s55 offen sc1
buffer_load_dwordx4 v[80:83], v71, s[4:7], s51 offen sc1
buffer_load_dwordx4 v[84:87], v71, s[4:7], s52 offen sc1
buffer_load_dwordx4 v[88:91], v71, s[4:7], s53 offen sc1
buffer_load_dwordx4 v[92:95], v71, s[4:7], s54 offen sc1
s_waitcnt vmcnt(0)
v_xor_b32 v52, s60, v52
v_xor_b32 v53, s61, v53
v_xor_b32 v54, s62, v54
v_xor_b32 v55, s63, v55
v_xor_b32 v80, s60, v80
v_xor_b32 v81, s61, v81
v_xor_b32 v82, s62, v82
v_xor_b32 v83, s63, v83
v_xor_b32 v84, s60, v84
v_xor_b32 v85, s61, v85
v_xor_b32 v86, s62, v86
v_xor_b32 v87, s63, v87
v_xor_b32 v88, s60, v88
v_xor_b32 v89, s61, v89
v_xor_b32 v90, s62, v90
v_xor_b32 v91, s63, v91
v_xor_b32 v92, s60, v92
v_xor_b32 v93, s61, v93
v_xor_b32 v94, s62, v94
v_xor_b32 v95, s63, v95
v_or_b32 v32, v52, v53
v_or3_b32 v32, v32, v54, v55
v_or3_b32 v32, v32, v80, v81
v_or3_b32 v32, v32, v82, v83
v_or3_b32 v32, v32, v84, v85
v_or3_b32 v32, v32, v86, v87
v_or3_b32 v32, v32, v88, v89
v_or3_b32 v32, v32, v90, v91
v_or3_b32 v32, v32, v92, v93
v_or3_b32 v32, v32, v94, v95
v_and_b32 v32, 0xff, v32
v_cmp_ne_u32 vcc, 0, v32
s_add_u32 s97, s97, 1
s_cmp_gt_u32 s97, 65536
s_cbranch_scc1 L_fb_ok
s_cbranch_vccnz L_fb_retry
s_branch L_fb_ok
.fill (adaLN_cond__sliding_local_dilated__moe_arch_mod__prompt_kernel + 66048 - .) / 4, 4, 0xbf800000
.section .rodata,"a"
.p2align 6
.amdhsa_kernel adaLN_cond__sliding_local_dilated__moe_arch_mod__prompt_kernel
  .amdhsa_next_free_vgpr 512
  .amdhsa_next_free_sgpr 102
  .amdhsa_accum_offset 256
  .amdhsa_group_segment_fixed_size 0
  .amdhsa_kernarg_size 104
  .amdhsa_user_sgpr_count 2
  .amdhsa_user_sgpr_kernarg_segment_ptr 1
  .amdhsa_system_sgpr_workgroup_id_x 1
  .amdhsa_float_denorm_mode_32 3
  .amdhsa_float_denorm_mode_16_64 3
.end_amdhsa_kernel
```
